```python
import torch

def _softmax(x, axis=-1):
    return torch.softmax(x, dim=axis)
def _gelu(x):
    return torch.nn.functional.gelu(x, approximate="tanh")
def _silu(x):
    return torch.nn.functional.silu(x)
def _sigmoid(x):
    return torch.sigmoid(x)
def _layernorm(x, axis=-1, eps=1e-5):
    m = x.mean(dim=axis, keepdim=True)
    v = x.var(dim=axis, keepdim=True, unbiased=False)
    return (x - m) / torch.sqrt(v + eps)
def _scatter_add(tgt, idx, src, axis=0):
    return tgt.clone().index_add_(axis, idx, src)
def _segment_sum(src, seg, n):
    out = torch.zeros((n,) + src.shape[1:], dtype=src.dtype)
    return out.index_add_(0, seg, src)
def _pad(x, pw):
    flat = tuple(v for pair in reversed(pw) for v in pair)
    return torch.nn.functional.pad(x, flat)

kernel_name = 'interleave_layers__sliding_block__moe_arch_mod__prompt'

def setup_inputs():

    _w = (lambda a: (lambda t: t.to(torch.bfloat16) if t.is_floating_point() else t)(torch.as_tensor(a)))
    def _A_setup():
        B, S, D = 1, 2048, 1024
        return {
            "x": _w((lambda *s: torch.randn(*s, dtype=torch.bfloat16) * 0.05)(B, S, D)),
            "wqkv": _w((lambda *s: torch.randn(*s, dtype=torch.bfloat16) * 0.05)(D, 3 * D)),
            "wo": _w((lambda *s: torch.randn(*s, dtype=torch.bfloat16) * 0.05)(D, D)),
        }
    _A_in = _A_setup()

    def _B_setup():
        B, S, D, F, C = 1, 2048, 1024, 3584, 1
        return {
            "x": _w((lambda *s: torch.randn(*s, dtype=torch.bfloat16) * 0.05)(B, S, D)),
            "w_r": _w((lambda *s: torch.randn(*s, dtype=torch.bfloat16) * 1.6)(D)),
            "w_gate": _w((lambda *s: torch.randn(*s, dtype=torch.bfloat16) * 0.1)(D, F)),
            "w_up": _w((lambda *s: torch.randn(*s, dtype=torch.bfloat16) * 0.1)(D, F)),
            "w_down": _w((lambda *s: torch.randn(*s, dtype=torch.bfloat16) * 0.1)(F, D)),
        }
    _B_in = _B_setup()

    return {
        "A_x": _A_in["x"],
        "A_wqkv": _A_in["wqkv"],
        "A_wo": _A_in["wo"],
        "B_x": _B_in["x"],
        "B_w_r": _B_in["w_r"],
        "B_w_gate": _B_in["w_gate"],
        "B_w_up": _B_in["w_up"],
        "B_w_down": _B_in["w_down"],
    }

def reference(A_x, A_wqkv, A_wo, B_x, B_w_r, B_w_gate, B_w_up, B_w_down):
    def _A_ref(x, wqkv, wo):
        B, S, D = x.shape
        H = 32; Dh = D // H; W = 256
        qkv = (lambda x, *d: x.permute(*d))((x @ wqkv).reshape(B, S, 3, H, Dh), 2, 0, 3, 1, 4)
        q, k, v = qkv[0], qkv[1], qkv[2]
        scores = torch.einsum("bhqd,bhkd->bhqk", q, k) * (Dh ** -0.5)
        idx = torch.arange(S)
        mask = (idx[:, None] - idx[None, :] >= 0) & (idx[:, None] - idx[None, :] < W)
        scores = torch.where(mask[None, None], scores, -1e9)
        p = _softmax(scores, axis=-1)
        o = torch.einsum("bhqk,bhkd->bhqd", p, v)
        return (lambda x, *d: x.permute(*d))(o, 0, 2, 1, 3).reshape(B, S, D) @ wo

    def _B_ref(x, w_r, w_gate, w_up, w_down):
        B, S, D = x.shape
        C = 1
        r = x @ w_r
        idx = torch.argsort(-r, axis=-1)[:, :C]
        idx_e = (lambda x, n, axis: torch.repeat_interleave(x, n, dim=axis))(idx.reshape(B, C, 1), D, axis=2)
        x_sel = (lambda x, i, axis: torch.take_along_dim(x, i, dim=axis))(x, idx_e, axis=1)
        g = _silu(x_sel @ w_gate)
        u = x_sel @ w_up
        y = (g * u) @ w_down
        r_sel = _sigmoid((lambda x, i, axis: torch.take_along_dim(x, i, dim=axis))(r, idx, axis=1))
        y = y * r_sel.reshape(B, C, 1)
        b_off = (torch.arange(B) * S).reshape(B, 1)
        flat_idx = (idx + b_off).reshape(B * C)
        zero = (x * 0.0).reshape(B * S, D)
        upd = _scatter_add(zero, flat_idx, y.reshape(B * C, D), axis=0)
        return x + upd.reshape(B, S, D)

    x = A_x
    x = x + _A_ref(_layernorm(x, axis=-1), A_wqkv, A_wo)
    x = x + _B_ref(_layernorm(x, axis=-1), B_w_r, B_w_gate, B_w_up, B_w_down)
    x = x + _A_ref(_layernorm(x, axis=-1), A_wqkv, A_wo)
    x = x + _B_ref(_layernorm(x, axis=-1), B_w_r, B_w_gate, B_w_up, B_w_down)
    return x
```

```asm
; @launch kernel=prep_kernel grid=(256,1,1) block=(512,1,1) lds=16384
; @launch kernel=qkv0_kernel grid=(256,1,1) block=(512,1,1) lds=163840
; @launch kernel=attn0_kernel grid=(256,1,1) block=(512,1,1) lds=98304
; @launch kernel=wo0_kernel grid=(256,1,1) block=(512,1,1) lds=163840
; @launch kernel=ffn0_kernel grid=(256,1,1) block=(512,1,1) lds=49152
; @launch kernel=fix0_kernel grid=(1,1,1) block=(256,1,1) lds=1024
; @launch kernel=qkv1_kernel grid=(256,1,1) block=(512,1,1) lds=163840
; @launch kernel=attn1_kernel grid=(256,1,1) block=(512,1,1) lds=98304
; @launch kernel=wo1_kernel grid=(256,1,1) block=(512,1,1) lds=163840
; @launch kernel=ffn1_kernel grid=(256,1,1) block=(512,1,1) lds=49152
; @launch kernel=fix1_kernel grid=(1,1,1) block=(256,1,1) lds=1024
.amdgcn_target "amdgcn-amd-amdhsa--gfx950"
.text
.globl prep_kernel
.p2align 8
.type prep_kernel,@function
prep_kernel:
    s_cmp_ge_u32 s2, 256
    s_cbranch_scc1 prep_kernel_end
    s_load_dwordx4 s[4:7], s[0:1], 0
    s_load_dwordx2 s[8:9], s[0:1], 80
    v_lshrrev_b32 v1, 6, v0
    v_and_b32 v2, 63, v0
    v_readfirstlane_b32 s3, v1
    s_waitcnt lgkmcnt(0)
    s_mov_b32 s12, s4
    s_mov_b32 s13, s5
    s_mov_b32 s14, 0x400000
    s_mov_b32 s15, 0x20000
    s_mov_b32 s16, s6
    s_mov_b32 s17, s7
    s_mov_b32 s18, 0x600000
    s_mov_b32 s19, 0x20000
    s_mov_b32 s20, s8
    s_mov_b32 s21, s9
    s_mov_b32 s22, 0x8000000
    s_mov_b32 s23, 0x20000
    s_lshl_b32 s24, s2, 3
    s_add_u32 s24, s24, s3
    s_lshl_b32 s25, s24, 11
    v_lshlrev_b32 v3, 4, v2
    buffer_load_dwordx4 v[4:7], v3, s[12:15], s25 offen
    buffer_load_dwordx4 v[8:11], v3, s[12:15], s25 offen offset:1024
    s_mul_i32 s26, s2, 0x5556
    s_lshr_b32 s26, s26, 18
    s_mul_i32 s27, s26, 12
    s_sub_u32 s27, s2, s27
    s_lshl_b32 s28, s26, 6
    s_lshl_b32 s29, s3, 3
    s_add_u32 s28, s28, s29
    s_mul_i32 s28, s28, 6144
    s_lshl_b32 s29, s27, 9
    s_add_u32 s28, s28, s29
    v_lshrrev_b32 v12, 5, v2
    v_mul_u32_u24 v12, 6144, v12
    v_and_b32 v13, 31, v2
    v_lshl_add_u32 v12, v13, 4, v12
    buffer_load_dwordx4 v[16:19], v12, s[16:19], s28 offen
    s_add_u32 s28, s28, 12288
    buffer_load_dwordx4 v[20:23], v12, s[16:19], s28 offen
    s_add_u32 s28, s28, 12288
    buffer_load_dwordx4 v[24:27], v12, s[16:19], s28 offen
    s_add_u32 s28, s28, 12288
    buffer_load_dwordx4 v[28:31], v12, s[16:19], s28 offen
    s_add_u32 s28, s28, 12288
    v_mov_b32 v40, 0
    v_mov_b32 v41, 0
    s_lshr_b32 s30, s2, 7
    s_mul_i32 s30, s30, 33554432
    s_and_b32 s31, s2, 127
    s_lshl_b32 s31, s31, 10
    s_add_u32 s30, s30, s31
    s_add_u32 s30, s30, 0x1400000
    v_lshlrev_b32 v42, 1, v0
    v_and_b32 v42, 0x3fc, v42
    buffer_store_dword v40, v42, s[20:23], s30 offen
    s_waitcnt vmcnt(5)
    v_mov_b32 v32, 0
    v_mov_b32 v33, 0
    v_lshlrev_b32 v34, 16, v4
    v_and_b32 v35, 0xffff0000, v4
    v_add_f32 v32, v32, v34
    v_fmac_f32 v33, v34, v34
    v_add_f32 v32, v32, v35
    v_fmac_f32 v33, v35, v35
    v_lshlrev_b32 v34, 16, v5
    v_and_b32 v35, 0xffff0000, v5
    v_add_f32 v32, v32, v34
    v_fmac_f32 v33, v34, v34
    v_add_f32 v32, v32, v35
    v_fmac_f32 v33, v35, v35
    v_lshlrev_b32 v34, 16, v6
    v_and_b32 v35, 0xffff0000, v6
    v_add_f32 v32, v32, v34
    v_fmac_f32 v33, v34, v34
    v_add_f32 v32, v32, v35
    v_fmac_f32 v33, v35, v35
    v_lshlrev_b32 v34, 16, v7
    v_and_b32 v35, 0xffff0000, v7
    v_add_f32 v32, v32, v34
    v_fmac_f32 v33, v34, v34
    v_add_f32 v32, v32, v35
    v_fmac_f32 v33, v35, v35
    v_lshlrev_b32 v34, 16, v8
    v_and_b32 v35, 0xffff0000, v8
    v_add_f32 v32, v32, v34
    v_fmac_f32 v33, v34, v34
    v_add_f32 v32, v32, v35
    v_fmac_f32 v33, v35, v35
    v_lshlrev_b32 v34, 16, v9
    v_and_b32 v35, 0xffff0000, v9
    v_add_f32 v32, v32, v34
    v_fmac_f32 v33, v34, v34
    v_add_f32 v32, v32, v35
    v_fmac_f32 v33, v35, v35
    v_lshlrev_b32 v34, 16, v10
    v_and_b32 v35, 0xffff0000, v10
    v_add_f32 v32, v32, v34
    v_fmac_f32 v33, v34, v34
    v_add_f32 v32, v32, v35
    v_fmac_f32 v33, v35, v35
    v_lshlrev_b32 v34, 16, v11
    v_and_b32 v35, 0xffff0000, v11
    v_add_f32 v32, v32, v34
    v_fmac_f32 v33, v34, v34
    v_add_f32 v32, v32, v35
    v_fmac_f32 v33, v35, v35
    s_nop 0
    v_add_f32_dpp v32, v32, v32 quad_perm:[1,0,3,2] row_mask:0xf bank_mask:0xf
    s_nop 1
    v_add_f32_dpp v32, v32, v32 quad_perm:[2,3,0,1] row_mask:0xf bank_mask:0xf
    s_nop 1
    v_add_f32_dpp v32, v32, v32 row_half_mirror row_mask:0xf bank_mask:0xf
    s_nop 1
    v_add_f32_dpp v32, v32, v32 row_mirror row_mask:0xf bank_mask:0xf
    v_mov_b32 v36, v32
    s_nop 1
    v_permlane16_swap_b32 v32, v36
    v_add_f32 v32, v32, v36
    v_mov_b32 v36, v32
    s_nop 1
    v_permlane32_swap_b32 v32, v36
    v_add_f32 v32, v32, v36
    v_add_f32_dpp v33, v33, v33 quad_perm:[1,0,3,2] row_mask:0xf bank_mask:0xf
    s_nop 1
    v_add_f32_dpp v33, v33, v33 quad_perm:[2,3,0,1] row_mask:0xf bank_mask:0xf
    s_nop 1
    v_add_f32_dpp v33, v33, v33 row_half_mirror row_mask:0xf bank_mask:0xf
    s_nop 1
    v_add_f32_dpp v33, v33, v33 row_mirror row_mask:0xf bank_mask:0xf
    v_mov_b32 v36, v33
    s_nop 1
    v_permlane16_swap_b32 v33, v36
    v_add_f32 v33, v33, v36
    v_mov_b32 v36, v33
    s_nop 1
    v_permlane32_swap_b32 v33, v36
    v_add_f32 v33, v33, v36
    v_mul_f32 v32, 0x3a800000, v32
    v_mul_f32 v33, 0x3a800000, v33
    v_fma_f32 v33, -v32, v32, v33
    v_max_f32 v33, 0, v33
    v_add_f32 v33, 0x3727c5ac, v33
    v_rsq_f32 v33, v33
    s_lshl_b32 s24, s24, 2
    s_add_u32 s24, s24, 0x1440000
    v_lshlrev_b32 v37, 13, v2
    v_cmp_eq_u32 vcc, 0, v2
    s_nop 1
    v_cndmask_b32 v33, v32, v33, vcc
    s_mov_b64 exec, 3
    buffer_store_dword v33, v37, s[20:23], s24 offen
    s_mov_b64 exec, -1
    s_waitcnt vmcnt(2)
    v_lshlrev_b32 v44, 16, v16
    v_and_b32 v45, 0xffff0000, v16
    v_lshlrev_b32 v34, 16, v20
    v_and_b32 v35, 0xffff0000, v20
    v_add_f32 v44, v44, v34
    v_add_f32 v45, v45, v35
    v_lshlrev_b32 v34, 16, v24
    v_and_b32 v35, 0xffff0000, v24
    v_add_f32 v44, v44, v34
    v_add_f32 v45, v45, v35
    v_lshlrev_b32 v34, 16, v28
    v_and_b32 v35, 0xffff0000, v28
    v_add_f32 v44, v44, v34
    v_add_f32 v45, v45, v35
    v_lshlrev_b32 v46, 16, v17
    v_and_b32 v47, 0xffff0000, v17
    v_lshlrev_b32 v34, 16, v21
    v_and_b32 v35, 0xffff0000, v21
    v_add_f32 v46, v46, v34
    v_add_f32 v47, v47, v35
    v_lshlrev_b32 v34, 16, v25
    v_and_b32 v35, 0xffff0000, v25
    v_add_f32 v46, v46, v34
    v_add_f32 v47, v47, v35
    v_lshlrev_b32 v34, 16, v29
    v_and_b32 v35, 0xffff0000, v29
    v_add_f32 v46, v46, v34
    v_add_f32 v47, v47, v35
    v_lshlrev_b32 v48, 16, v18
    v_and_b32 v49, 0xffff0000, v18
    v_lshlrev_b32 v34, 16, v22
    v_and_b32 v35, 0xffff0000, v22
    v_add_f32 v48, v48, v34
    v_add_f32 v49, v49, v35
    v_lshlrev_b32 v34, 16, v26
    v_and_b32 v35, 0xffff0000, v26
    v_add_f32 v48, v48, v34
    v_add_f32 v49, v49, v35
    v_lshlrev_b32 v34, 16, v30
    v_and_b32 v35, 0xffff0000, v30
    v_add_f32 v48, v48, v34
    v_add_f32 v49, v49, v35
    v_lshlrev_b32 v50, 16, v19
    v_and_b32 v51, 0xffff0000, v19
    v_lshlrev_b32 v34, 16, v23
    v_and_b32 v35, 0xffff0000, v23
    v_add_f32 v50, v50, v34
    v_add_f32 v51, v51, v35
    v_lshlrev_b32 v34, 16, v27
    v_and_b32 v35, 0xffff0000, v27
    v_add_f32 v50, v50, v34
    v_add_f32 v51, v51, v35
    v_lshlrev_b32 v34, 16, v31
    v_and_b32 v35, 0xffff0000, v31
    v_add_f32 v50, v50, v34
    v_add_f32 v51, v51, v35
    v_lshlrev_b32 v52, 5, v0
    ds_write_b128 v52, v[44:47]
    ds_write_b128 v52, v[48:51] offset:16
    s_waitcnt lgkmcnt(0)
    s_barrier
    s_cmp_ge_u32 s3, 4
    s_cbranch_scc1 prep_kernel_end
    s_cmp_ge_u32 s2, 192
    s_cbranch_scc1 prep_kernel_end
    v_lshlrev_b32 v52, 2, v0
    ds_read_b32 v16, v52 offset:0
    ds_read_b32 v17, v52 offset:1024
    ds_read_b32 v18, v52 offset:2048
    ds_read_b32 v19, v52 offset:3072
    ds_read_b32 v20, v52 offset:4096
    ds_read_b32 v21, v52 offset:5120
    ds_read_b32 v22, v52 offset:6144
    ds_read_b32 v23, v52 offset:7168
    ds_read_b32 v24, v52 offset:8192
    ds_read_b32 v25, v52 offset:9216
    ds_read_b32 v26, v52 offset:10240
    ds_read_b32 v27, v52 offset:11264
    ds_read_b32 v28, v52 offset:12288
    ds_read_b32 v29, v52 offset:13312
    ds_read_b32 v30, v52 offset:14336
    ds_read_b32 v31, v52 offset:15360
    s_waitcnt lgkmcnt(0)
    v_add_f32 v16, v16, v17
    v_add_f32 v16, v16, v18
    v_add_f32 v16, v16, v19
    v_add_f32 v16, v16, v20
    v_add_f32 v16, v16, v21
    v_add_f32 v16, v16, v22
    v_add_f32 v16, v16, v23
    v_add_f32 v16, v16, v24
    v_add_f32 v16, v16, v25
    v_add_f32 v16, v16, v26
    v_add_f32 v16, v16, v27
    v_add_f32 v16, v16, v28
    v_add_f32 v16, v16, v29
    v_add_f32 v16, v16, v30
    v_add_f32 v16, v16, v31
    s_mul_i32 s26, s26, 12288
    s_lshl_b32 s27, s27, 10
    s_add_u32 s26, s26, s27
    s_add_u32 s26, s26, 0x4000000
    buffer_store_dword v16, v52, s[20:23], s26 offen
prep_kernel_end:
    s_endpgm
.globl qkv0_kernel
.p2align 8
.type qkv0_kernel,@function
qkv0_kernel:
    s_cmp_ge_u32 s2, 256
    s_cbranch_scc1 qkv0_kernel_end
    s_load_dwordx4 s[4:7], s[0:1], 0
    s_load_dwordx2 s[8:9], s[0:1], 80
    v_lshrrev_b32 v1, 6, v0
    v_and_b32 v2, 63, v0
    v_readfirstlane_b32 s3, v1
    s_and_b32 s24, s2, 7
    s_lshr_b32 s25, s2, 3
    s_lshr_b32 s26, s24, 2
    s_lshl_b32 s26, s26, 3
    s_and_b32 s27, s25, 7
    s_add_u32 s26, s26, s27
    s_and_b32 s27, s24, 3
    s_lshl_b32 s27, s27, 2
    s_lshr_b32 s25, s25, 3
    s_add_u32 s27, s27, s25
    s_waitcnt lgkmcnt(0)
    s_mov_b32 s20, s8
    s_mov_b32 s21, s9
    s_mov_b32 s22, 0x8000000
    s_mov_b32 s23, 0x20000
    s_cmp_lt_u32 s3, 4
    s_cbranch_scc1 qkv0_kernel_cons
    s_mov_b32 s12, s4
    s_mov_b32 s13, s5
    s_mov_b32 s14, 0x400000
    s_mov_b32 s15, 0x20000
    s_mov_b32 s16, s6
    s_mov_b32 s17, s7
    s_mov_b32 s18, 0x600000
    s_mov_b32 s19, 0x20000
    s_sub_u32 s3, s3, 4
    s_and_b32 s28, s3, 1
    s_lshl_b32 s28, s28, 2
    v_lshrrev_b32 v3, 4, v2
    v_add_u32 v3, s28, v3
    v_xor_b32 v3, v3, v2
    v_and_b32 v3, 7, v3
    v_lshlrev_b32 v3, 4, v3
    v_lshrrev_b32 v4, 3, v2
    v_lshl_add_u32 v3, v4, 11, v3
    s_lshl_b32 s28, s3, 14
    v_add_u32 v3, s28, v3
    s_lshl_b32 s30, s26, 18
    v_lshrrev_b32 v4, 3, v2
    s_lshl_b32 s28, s3, 3
    v_add_u32 v4, s28, v4
    v_mul_u32_u24 v4, 6144, v4
    v_lshrrev_b32 v5, 2, v2
    v_and_b32 v5, 4, v5
    v_xor_b32 v5, v5, v2
    v_and_b32 v5, 7, v5
    v_lshl_add_u32 v4, v5, 4, v4
    s_lshl_b32 s31, s27, 7
    s_lshl_b32 s32, s3, 10
    v_subrev_u32 v7, 256, v0
    v_lshrrev_b32 v8, 6, v7
    v_lshlrev_b32 v8, 12, v8
    v_lshl_add_u32 v8, v2, 2, v8
    s_lshl_b32 s33, s27, 8
    s_add_u32 s33, s33, 0x4000000
    buffer_load_dword v16, v8, s[20:23], s33 offen
    s_add_u32 s33, s33, 12288
    buffer_load_dword v17, v8, s[20:23], s33 offen
    s_add_u32 s33, s33, 12288
    buffer_load_dword v18, v8, s[20:23], s33 offen
    s_add_u32 s33, s33, 12288
    buffer_load_dword v19, v8, s[20:23], s33 offen
    s_add_u32 s33, s33, 12288
    buffer_load_dword v20, v8, s[20:23], s33 offen
    s_add_u32 s33, s33, 12288
    buffer_load_dword v21, v8, s[20:23], s33 offen
    s_add_u32 s33, s33, 12288
    buffer_load_dword v22, v8, s[20:23], s33 offen
    s_add_u32 s33, s33, 12288
    buffer_load_dword v23, v8, s[20:23], s33 offen
    s_add_u32 s33, s33, 12288
    buffer_load_dword v24, v8, s[20:23], s33 offen
    s_add_u32 s33, s33, 12288
    buffer_load_dword v25, v8, s[20:23], s33 offen
    s_add_u32 s33, s33, 12288
    buffer_load_dword v26, v8, s[20:23], s33 offen
    s_add_u32 s33, s33, 12288
    buffer_load_dword v27, v8, s[20:23], s33 offen
    s_add_u32 s33, s33, 12288
    buffer_load_dword v28, v8, s[20:23], s33 offen
    s_add_u32 s33, s33, 12288
    buffer_load_dword v29, v8, s[20:23], s33 offen
    s_add_u32 s33, s33, 12288
    buffer_load_dword v30, v8, s[20:23], s33 offen
    s_add_u32 s33, s33, 12288
    buffer_load_dword v31, v8, s[20:23], s33 offen
    s_add_u32 s33, s33, 12288
    v_lshrrev_b32 v9, 7, v7
    v_lshlrev_b32 v9, 13, v9
    v_and_b32 v10, 127, v7
    v_lshl_add_u32 v9, v10, 2, v9
    s_lshl_b32 s33, s26, 9
    s_add_u32 s33, s33, 0x1440000
    buffer_load_dword v32, v9, s[20:23], s33 offen
    s_mov_b32 s36, 4
qkv0_kernel_lpro:
    s_mov_b32 m0, s32
    s_mov_b32 s34, s30
    buffer_load_dwordx4 v3, s[12:15], s34 offen lds
    s_add_u32 m0, m0, 4096
    s_add_u32 s34, s34, 65536
    buffer_load_dwordx4 v3, s[12:15], s34 offen lds
    s_add_u32 m0, m0, 4096
    s_add_u32 s34, s34, 65536
    buffer_load_dwordx4 v3, s[12:15], s34 offen lds
    s_add_u32 m0, m0, 4096
    s_add_u32 s34, s34, 65536
    buffer_load_dwordx4 v3, s[12:15], s34 offen lds
    s_add_u32 m0, m0, 4096
    s_mov_b32 s34, s31
    buffer_load_dwordx4 v4, s[16:19], s34 offen lds
    s_add_u32 m0, m0, 4096
    s_add_u32 s34, s34, 196608
    buffer_load_dwordx4 v4, s[16:19], s34 offen lds
    s_add_u32 m0, m0, 4096
    s_sub_u32 s34, s34, 194560
    buffer_load_dwordx4 v4, s[16:19], s34 offen lds
    s_add_u32 m0, m0, 4096
    s_add_u32 s34, s34, 196608
    buffer_load_dwordx4 v4, s[16:19], s34 offen lds
    s_add_u32 m0, m0, 4096
    s_sub_u32 s34, s34, 194560
    buffer_load_dwordx4 v4, s[16:19], s34 offen lds
    s_add_u32 m0, m0, 4096
    s_add_u32 s34, s34, 196608
    buffer_load_dwordx4 v4, s[16:19], s34 offen lds
    s_add_u32 s30, s30, 128
    s_add_u32 s31, s31, 393216
    s_add_u32 s32, s32, 40960
    s_cmp_ge_u32 s32, 163840
    s_cselect_b32 s35, 163840, 0
    s_sub_u32 s32, s32, s35
    s_sub_u32 s36, s36, 1
    s_cmp_lg_u32 s36, 0
    s_cbranch_scc1 qkv0_kernel_lpro
    s_waitcnt vmcnt(30)
    v_add_f32 v16, v16, v17
    v_add_f32 v16, v16, v18
    v_add_f32 v16, v16, v19
    v_add_f32 v16, v16, v20
    v_add_f32 v16, v16, v21
    v_add_f32 v16, v16, v22
    v_add_f32 v16, v16, v23
    v_add_f32 v16, v16, v24
    v_add_f32 v16, v16, v25
    v_add_f32 v16, v16, v26
    v_add_f32 v16, v16, v27
    v_add_f32 v16, v16, v28
    v_add_f32 v16, v16, v29
    v_add_f32 v16, v16, v30
    v_add_f32 v16, v16, v31
    s_barrier
    s_mov_b32 s36, 12
qkv0_kernel_lloop:
    s_waitcnt vmcnt(20)
    s_barrier
    s_mov_b32 m0, s32
    s_mov_b32 s34, s30
    buffer_load_dwordx4 v3, s[12:15], s34 offen lds
    s_add_u32 m0, m0, 4096
    s_add_u32 s34, s34, 65536
    buffer_load_dwordx4 v3, s[12:15], s34 offen lds
    s_add_u32 m0, m0, 4096
    s_add_u32 s34, s34, 65536
    buffer_load_dwordx4 v3, s[12:15], s34 offen lds
    s_add_u32 m0, m0, 4096
    s_add_u32 s34, s34, 65536
    buffer_load_dwordx4 v3, s[12:15], s34 offen lds
    s_add_u32 m0, m0, 4096
    s_mov_b32 s34, s31
    buffer_load_dwordx4 v4, s[16:19], s34 offen lds
    s_add_u32 m0, m0, 4096
    s_add_u32 s34, s34, 196608
    buffer_load_dwordx4 v4, s[16:19], s34 offen lds
    s_add_u32 m0, m0, 4096
    s_sub_u32 s34, s34, 194560
    buffer_load_dwordx4 v4, s[16:19], s34 offen lds
    s_add_u32 m0, m0, 4096
    s_add_u32 s34, s34, 196608
    buffer_load_dwordx4 v4, s[16:19], s34 offen lds
    s_add_u32 m0, m0, 4096
    s_sub_u32 s34, s34, 194560
    buffer_load_dwordx4 v4, s[16:19], s34 offen lds
    s_add_u32 m0, m0, 4096
    s_add_u32 s34, s34, 196608
    buffer_load_dwordx4 v4, s[16:19], s34 offen lds
    s_add_u32 s30, s30, 128
    s_add_u32 s31, s31, 393216
    s_add_u32 s32, s32, 40960
    s_cmp_ge_u32 s32, 163840
    s_cselect_b32 s35, 163840, 0
    s_sub_u32 s32, s32, s35
    s_sub_u32 s36, s36, 1
    s_cmp_lg_u32 s36, 0
    s_cbranch_scc1 qkv0_kernel_lloop
    s_waitcnt vmcnt(20)
    s_barrier
    v_lshlrev_b32 v11, 2, v7
    ds_write_b32 v11, v32
    ds_write_b32 v11, v16 offset:1024
    s_waitcnt vmcnt(10)
    s_barrier
    s_waitcnt vmcnt(0)
    s_barrier
    s_waitcnt lgkmcnt(0)
    s_barrier
    s_endpgm
qkv0_kernel_cons:
    v_mov_b32 v146, v2
    s_and_b32 s28, s3, 1
    s_lshr_b32 s29, s3, 1
    v_and_b32 v3, 31, v2
    v_lshrrev_b32 v4, 5, v2
    v_lshrrev_b32 v5, 1, v3
    v_and_b32 v5, 7, v5
    v_xor_b32 v5, v5, v4
    v_lshlrev_b32 v5, 4, v5
    v_lshl_add_u32 v5, v3, 7, v5
    s_lshl_b32 s30, s28, 13
    v_add_u32 v136, s30, v5
    v_xor_b32 v137, 32, v136
    v_xor_b32 v138, 64, v136
    v_xor_b32 v139, 96, v136
    v_bfe_u32 v5, v2, 2, 2
    v_lshl_add_u32 v6, v4, 3, v5
    v_lshlrev_b32 v6, 7, v6
    v_lshrrev_b32 v5, 1, v5
    v_xor_b32 v5, s29, v5
    v_lshl_add_u32 v6, v5, 6, v6
    v_bfe_u32 v5, v2, 4, 1
    v_lshl_add_u32 v6, v5, 5, v6
    v_and_b32 v5, 3, v2
    v_lshl_add_u32 v6, v5, 3, v6
    v_add_u32 v140, 16384, v6
    v_mov_b32 v141, v136
    v_mov_b32 v142, v137
    v_mov_b32 v143, v138
    v_mov_b32 v144, v139
    v_mov_b32 v145, v140
    v_mov_b32 v0, 0
    v_mov_b32 v1, 0
    v_mov_b32 v2, 0
    v_mov_b32 v3, 0
    v_mov_b32 v4, 0
    v_mov_b32 v5, 0
    v_mov_b32 v6, 0
    v_mov_b32 v7, 0
    v_mov_b32 v8, 0
    v_mov_b32 v9, 0
    v_mov_b32 v10, 0
    v_mov_b32 v11, 0
    v_mov_b32 v12, 0
    v_mov_b32 v13, 0
    v_mov_b32 v14, 0
    v_mov_b32 v15, 0
    v_mov_b32 v16, 0
    v_mov_b32 v17, 0
    v_mov_b32 v18, 0
    v_mov_b32 v19, 0
    v_mov_b32 v20, 0
    v_mov_b32 v21, 0
    v_mov_b32 v22, 0
    v_mov_b32 v23, 0
    v_mov_b32 v24, 0
    v_mov_b32 v25, 0
    v_mov_b32 v26, 0
    v_mov_b32 v27, 0
    v_mov_b32 v28, 0
    v_mov_b32 v29, 0
    v_mov_b32 v30, 0
    v_mov_b32 v31, 0
    v_mov_b32 v32, 0
    v_mov_b32 v33, 0
    v_mov_b32 v34, 0
    v_mov_b32 v35, 0
    v_mov_b32 v36, 0
    v_mov_b32 v37, 0
    v_mov_b32 v38, 0
    v_mov_b32 v39, 0
    v_mov_b32 v40, 0
    v_mov_b32 v41, 0
    v_mov_b32 v42, 0
    v_mov_b32 v43, 0
    v_mov_b32 v44, 0
    v_mov_b32 v45, 0
    v_mov_b32 v46, 0
    v_mov_b32 v47, 0
    v_mov_b32 v48, 0
    v_mov_b32 v49, 0
    v_mov_b32 v50, 0
    v_mov_b32 v51, 0
    v_mov_b32 v52, 0
    v_mov_b32 v53, 0
    v_mov_b32 v54, 0
    v_mov_b32 v55, 0
    v_mov_b32 v56, 0
    v_mov_b32 v57, 0
    v_mov_b32 v58, 0
    v_mov_b32 v59, 0
    v_mov_b32 v60, 0
    v_mov_b32 v61, 0
    v_mov_b32 v62, 0
    v_mov_b32 v63, 0
    v_mov_b32 v64, 0
    v_mov_b32 v65, 0
    v_mov_b32 v66, 0
    v_mov_b32 v67, 0
    v_mov_b32 v68, 0
    v_mov_b32 v69, 0
    v_mov_b32 v70, 0
    v_mov_b32 v71, 0
    v_mov_b32 v72, 0
    v_mov_b32 v73, 0
    v_mov_b32 v74, 0
    v_mov_b32 v75, 0
    v_mov_b32 v76, 0
    v_mov_b32 v77, 0
    v_mov_b32 v78, 0
    v_mov_b32 v79, 0
    v_mov_b32 v80, 0
    v_mov_b32 v81, 0
    v_mov_b32 v82, 0
    v_mov_b32 v83, 0
    v_mov_b32 v84, 0
    v_mov_b32 v85, 0
    v_mov_b32 v86, 0
    v_mov_b32 v87, 0
    v_mov_b32 v88, 0
    v_mov_b32 v89, 0
    v_mov_b32 v90, 0
    v_mov_b32 v91, 0
    v_mov_b32 v92, 0
    v_mov_b32 v93, 0
    v_mov_b32 v94, 0
    v_mov_b32 v95, 0
    s_mov_b32 s31, 0
    s_mov_b32 s36, 16
    s_barrier
    ds_read_b128 v[96:99], v141
    ds_read_b128 v[100:103], v141 offset:4096
    ds_read_b64_tr_b16 v[104:105], v145 offset:0
    ds_read_b64_tr_b16 v[106:107], v145 offset:512
    ds_read_b64_tr_b16 v[108:109], v145 offset:8192
    ds_read_b64_tr_b16 v[110:111], v145 offset:8704
    ds_read_b64_tr_b16 v[112:113], v145 offset:16384
    ds_read_b64_tr_b16 v[114:115], v145 offset:16896
qkv0_kernel_cloop:
    s_waitcnt lgkmcnt(0)
    v_mfma_f32_32x32x16_bf16 v[0:15], v[104:107], v[96:99], v[0:15]
    ds_read_b128 v[116:119], v142
    ds_read_b64_tr_b16 v[124:125], v145 offset:2048
    ds_read_b64_tr_b16 v[126:127], v145 offset:2560
    v_mfma_f32_32x32x16_bf16 v[16:31], v[104:107], v[100:103], v[16:31]
    ds_read_b128 v[120:123], v142 offset:4096
    ds_read_b64_tr_b16 v[128:129], v145 offset:10240
    ds_read_b64_tr_b16 v[130:131], v145 offset:10752
    v_mfma_f32_32x32x16_bf16 v[32:47], v[108:111], v[96:99], v[32:47]
    ds_read_b64_tr_b16 v[132:133], v145 offset:18432
    ds_read_b64_tr_b16 v[134:135], v145 offset:18944
    v_mfma_f32_32x32x16_bf16 v[48:63], v[108:111], v[100:103], v[48:63]
    v_mfma_f32_32x32x16_bf16 v[64:79], v[96:99], v[112:115], v[64:79]
    v_mfma_f32_32x32x16_bf16 v[80:95], v[100:103], v[112:115], v[80:95]
    s_waitcnt lgkmcnt(0)
    v_mfma_f32_32x32x16_bf16 v[0:15], v[124:127], v[116:119], v[0:15]
    ds_read_b128 v[96:99], v143
    ds_read_b64_tr_b16 v[104:105], v145 offset:4096
    ds_read_b64_tr_b16 v[106:107], v145 offset:4608
    v_mfma_f32_32x32x16_bf16 v[16:31], v[124:127], v[120:123], v[16:31]
    ds_read_b128 v[100:103], v143 offset:4096
    ds_read_b64_tr_b16 v[108:109], v145 offset:12288
    ds_read_b64_tr_b16 v[110:111], v145 offset:12800
    v_mfma_f32_32x32x16_bf16 v[32:47], v[128:131], v[116:119], v[32:47]
    ds_read_b64_tr_b16 v[112:113], v145 offset:20480
    ds_read_b64_tr_b16 v[114:115], v145 offset:20992
    v_mfma_f32_32x32x16_bf16 v[48:63], v[128:131], v[120:123], v[48:63]
    v_mfma_f32_32x32x16_bf16 v[64:79], v[116:119], v[132:135], v[64:79]
    v_mfma_f32_32x32x16_bf16 v[80:95], v[120:123], v[132:135], v[80:95]
    s_waitcnt lgkmcnt(0)
    v_mfma_f32_32x32x16_bf16 v[0:15], v[104:107], v[96:99], v[0:15]
    ds_read_b128 v[116:119], v144
    ds_read_b64_tr_b16 v[124:125], v145 offset:6144
    ds_read_b64_tr_b16 v[126:127], v145 offset:6656
    v_mfma_f32_32x32x16_bf16 v[16:31], v[104:107], v[100:103], v[16:31]
    ds_read_b128 v[120:123], v144 offset:4096
    ds_read_b64_tr_b16 v[128:129], v145 offset:14336
    ds_read_b64_tr_b16 v[130:131], v145 offset:14848
    v_mfma_f32_32x32x16_bf16 v[32:47], v[108:111], v[96:99], v[32:47]
    ds_read_b64_tr_b16 v[132:133], v145 offset:22528
    ds_read_b64_tr_b16 v[134:135], v145 offset:23040
    v_mfma_f32_32x32x16_bf16 v[48:63], v[108:111], v[100:103], v[48:63]
    v_mfma_f32_32x32x16_bf16 v[64:79], v[96:99], v[112:115], v[64:79]
    v_mfma_f32_32x32x16_bf16 v[80:95], v[100:103], v[112:115], v[80:95]
    s_waitcnt lgkmcnt(0)
    v_mfma_f32_32x32x16_bf16 v[0:15], v[124:127], v[116:119], v[0:15]
    s_barrier
    s_add_u32 s31, s31, 40960
    s_cmp_ge_u32 s31, 163840
    s_cselect_b32 s31, 0, s31
    v_add_u32 v141, s31, v136
    v_add_u32 v145, s31, v140
    ds_read_b128 v[96:99], v141
    ds_read_b64_tr_b16 v[104:105], v145 offset:0
    ds_read_b64_tr_b16 v[106:107], v145 offset:512
    v_mfma_f32_32x32x16_bf16 v[16:31], v[124:127], v[120:123], v[16:31]
    ds_read_b128 v[100:103], v141 offset:4096
    ds_read_b64_tr_b16 v[108:109], v145 offset:8192
    ds_read_b64_tr_b16 v[110:111], v145 offset:8704
    v_mfma_f32_32x32x16_bf16 v[32:47], v[128:131], v[116:119], v[32:47]
    ds_read_b64_tr_b16 v[112:113], v145 offset:16384
    ds_read_b64_tr_b16 v[114:115], v145 offset:16896
    v_mfma_f32_32x32x16_bf16 v[48:63], v[128:131], v[120:123], v[48:63]
    v_add_u32 v142, s31, v137
    v_add_u32 v143, s31, v138
    v_add_u32 v144, s31, v139
    s_sub_u32 s36, s36, 1
    s_cmp_lg_u32 s36, 0
    v_mfma_f32_32x32x16_bf16 v[64:79], v[116:119], v[132:135], v[64:79]
    v_mfma_f32_32x32x16_bf16 v[80:95], v[120:123], v[132:135], v[80:95]
    s_cbranch_scc1 qkv0_kernel_cloop
    s_waitcnt lgkmcnt(0)
    v_and_b32 v96, 31, v146
    v_lshrrev_b32 v97, 5, v146
    s_lshl_b32 s30, s28, 8
    s_add_u32 s30, s30, 0
    v_lshl_add_u32 v98, v96, 2, s30
    v_lshl_add_u32 v99, v97, 4, s30
    s_lshl_b32 s30, s29, 7
    s_add_u32 s30, s30, 1024
    v_lshl_add_u32 v100, v97, 4, s30
    v_lshl_add_u32 v101, v96, 2, s30
    ds_read_b32 v104, v98
    ds_read_b32 v106, v98 offset:128
    ds_read_b32 v108, v98 offset:512
    ds_read_b32 v110, v98 offset:640
    ds_read_b32 v112, v101 offset:512
    ds_read_b128 v[116:119], v100 offset:0
    ds_read_b128 v[120:123], v100 offset:32
    ds_read_b128 v[124:127], v100 offset:64
    ds_read_b128 v[128:131], v100 offset:96
    ds_read_b128 v[132:135], v100 offset:256
    ds_read_b128 v[136:139], v100 offset:288
    ds_read_b128 v[140:143], v100 offset:320
    ds_read_b128 v[144:147], v100 offset:352
    ds_read_b128 v[148:151], v99 offset:0
    ds_read_b128 v[180:183], v99 offset:512
    ds_read_b128 v[152:155], v99 offset:32
    ds_read_b128 v[184:187], v99 offset:544
    ds_read_b128 v[156:159], v99 offset:64
    ds_read_b128 v[188:191], v99 offset:576
    ds_read_b128 v[160:163], v99 offset:96
    ds_read_b128 v[192:195], v99 offset:608
    ds_read_b128 v[164:167], v99 offset:128
    ds_read_b128 v[196:199], v99 offset:640
    ds_read_b128 v[168:171], v99 offset:160
    ds_read_b128 v[200:203], v99 offset:672
    ds_read_b128 v[172:175], v99 offset:192
    ds_read_b128 v[204:207], v99 offset:704
    ds_read_b128 v[176:179], v99 offset:224
    ds_read_b128 v[208:211], v99 offset:736
    s_lshl_b32 s30, s27, 1
    s_add_u32 s30, s30, s29
    s_lshl_b32 s30, s30, 6
    s_lshl_b32 s31, s26, 2
    s_add_u32 s30, s30, s31
    s_lshl_b32 s31, s28, 1
    s_add_u32 s30, s30, s31
    s_lshl_b32 s31, s30, 11
    s_add_u32 s31, s31, 0x0
    s_lshl_b32 s32, s30, 12
    s_add_u32 s32, s32, 0x400000
    s_add_u32 s33, s32, 4096
    v_lshlrev_b32 v96, 4, v146
    s_waitcnt lgkmcnt(15)
    v_mul_f32 v114, 0x3e8293ee, v104
    v_mul_f32 v102, 0x3e8293ee, v106
    v_pk_fma_f32 v[0:1], v[116:117], v[108:109], v[0:1] op_sel_hi:[1,0,1] neg_lo:[0,1,0] neg_hi:[0,1,0]
    v_pk_fma_f32 v[2:3], v[118:119], v[108:109], v[2:3] op_sel_hi:[1,0,1] neg_lo:[0,1,0] neg_hi:[0,1,0]
    v_pk_fma_f32 v[4:5], v[120:121], v[108:109], v[4:5] op_sel_hi:[1,0,1] neg_lo:[0,1,0] neg_hi:[0,1,0]
    v_pk_fma_f32 v[6:7], v[122:123], v[108:109], v[6:7] op_sel_hi:[1,0,1] neg_lo:[0,1,0] neg_hi:[0,1,0]
    v_pk_fma_f32 v[8:9], v[124:125], v[108:109], v[8:9] op_sel_hi:[1,0,1] neg_lo:[0,1,0] neg_hi:[0,1,0]
    v_pk_fma_f32 v[10:11], v[126:127], v[108:109], v[10:11] op_sel_hi:[1,0,1] neg_lo:[0,1,0] neg_hi:[0,1,0]
    v_pk_fma_f32 v[12:13], v[128:129], v[108:109], v[12:13] op_sel_hi:[1,0,1] neg_lo:[0,1,0] neg_hi:[0,1,0]
    v_pk_fma_f32 v[14:15], v[130:131], v[108:109], v[14:15] op_sel_hi:[1,0,1] neg_lo:[0,1,0] neg_hi:[0,1,0]
    v_pk_mul_f32 v[0:1], v[0:1], v[114:115] op_sel_hi:[1,0]
    v_pk_mul_f32 v[2:3], v[2:3], v[114:115] op_sel_hi:[1,0]
    v_pk_mul_f32 v[4:5], v[4:5], v[114:115] op_sel_hi:[1,0]
    v_pk_mul_f32 v[6:7], v[6:7], v[114:115] op_sel_hi:[1,0]
    v_pk_mul_f32 v[8:9], v[8:9], v[114:115] op_sel_hi:[1,0]
    v_pk_mul_f32 v[10:11], v[10:11], v[114:115] op_sel_hi:[1,0]
    v_pk_mul_f32 v[12:13], v[12:13], v[114:115] op_sel_hi:[1,0]
    v_pk_mul_f32 v[14:15], v[14:15], v[114:115] op_sel_hi:[1,0]
    v_cvt_pk_bf16_f32 v0, v0, v1
    v_cvt_pk_bf16_f32 v1, v2, v3
    v_cvt_pk_bf16_f32 v2, v4, v5
    v_cvt_pk_bf16_f32 v3, v6, v7
    v_cvt_pk_bf16_f32 v4, v8, v9
    v_cvt_pk_bf16_f32 v5, v10, v11
    v_cvt_pk_bf16_f32 v6, v12, v13
    v_cvt_pk_bf16_f32 v7, v14, v15
    buffer_store_dwordx4 v[0:3], v96, s[20:23], s31 offen offset:0
    buffer_store_dwordx4 v[4:7], v96, s[20:23], s31 offen offset:1024
    v_pk_fma_f32 v[16:17], v[116:117], v[110:111], v[16:17] op_sel_hi:[1,0,1] neg_lo:[0,1,0] neg_hi:[0,1,0]
    v_pk_fma_f32 v[18:19], v[118:119], v[110:111], v[18:19] op_sel_hi:[1,0,1] neg_lo:[0,1,0] neg_hi:[0,1,0]
    v_pk_fma_f32 v[20:21], v[120:121], v[110:111], v[20:21] op_sel_hi:[1,0,1] neg_lo:[0,1,0] neg_hi:[0,1,0]
    v_pk_fma_f32 v[22:23], v[122:123], v[110:111], v[22:23] op_sel_hi:[1,0,1] neg_lo:[0,1,0] neg_hi:[0,1,0]
    v_pk_fma_f32 v[24:25], v[124:125], v[110:111], v[24:25] op_sel_hi:[1,0,1] neg_lo:[0,1,0] neg_hi:[0,1,0]
    v_pk_fma_f32 v[26:27], v[126:127], v[110:111], v[26:27] op_sel_hi:[1,0,1] neg_lo:[0,1,0] neg_hi:[0,1,0]
    v_pk_fma_f32 v[28:29], v[128:129], v[110:111], v[28:29] op_sel_hi:[1,0,1] neg_lo:[0,1,0] neg_hi:[0,1,0]
    v_pk_fma_f32 v[30:31], v[130:131], v[110:111], v[30:31] op_sel_hi:[1,0,1] neg_lo:[0,1,0] neg_hi:[0,1,0]
    v_pk_mul_f32 v[16:17], v[16:17], v[102:103] op_sel_hi:[1,0]
    v_pk_mul_f32 v[18:19], v[18:19], v[102:103] op_sel_hi:[1,0]
    v_pk_mul_f32 v[20:21], v[20:21], v[102:103] op_sel_hi:[1,0]
    v_pk_mul_f32 v[22:23], v[22:23], v[102:103] op_sel_hi:[1,0]
    v_pk_mul_f32 v[24:25], v[24:25], v[102:103] op_sel_hi:[1,0]
    v_pk_mul_f32 v[26:27], v[26:27], v[102:103] op_sel_hi:[1,0]
    v_pk_mul_f32 v[28:29], v[28:29], v[102:103] op_sel_hi:[1,0]
    v_pk_mul_f32 v[30:31], v[30:31], v[102:103] op_sel_hi:[1,0]
    v_cvt_pk_bf16_f32 v16, v16, v17
    v_cvt_pk_bf16_f32 v17, v18, v19
    v_cvt_pk_bf16_f32 v18, v20, v21
    v_cvt_pk_bf16_f32 v19, v22, v23
    v_cvt_pk_bf16_f32 v20, v24, v25
    v_cvt_pk_bf16_f32 v21, v26, v27
    v_cvt_pk_bf16_f32 v22, v28, v29
    v_cvt_pk_bf16_f32 v23, v30, v31
    buffer_store_dwordx4 v[16:19], v96, s[20:23], s31 offen offset:2048
    buffer_store_dwordx4 v[20:23], v96, s[20:23], s31 offen offset:3072
    v_pk_fma_f32 v[32:33], v[132:133], v[108:109], v[32:33] op_sel_hi:[1,0,1] neg_lo:[0,1,0] neg_hi:[0,1,0]
    v_pk_fma_f32 v[34:35], v[134:135], v[108:109], v[34:35] op_sel_hi:[1,0,1] neg_lo:[0,1,0] neg_hi:[0,1,0]
    v_pk_fma_f32 v[36:37], v[136:137], v[108:109], v[36:37] op_sel_hi:[1,0,1] neg_lo:[0,1,0] neg_hi:[0,1,0]
    v_pk_fma_f32 v[38:39], v[138:139], v[108:109], v[38:39] op_sel_hi:[1,0,1] neg_lo:[0,1,0] neg_hi:[0,1,0]
    v_pk_fma_f32 v[40:41], v[140:141], v[108:109], v[40:41] op_sel_hi:[1,0,1] neg_lo:[0,1,0] neg_hi:[0,1,0]
    v_pk_fma_f32 v[42:43], v[142:143], v[108:109], v[42:43] op_sel_hi:[1,0,1] neg_lo:[0,1,0] neg_hi:[0,1,0]
    v_pk_fma_f32 v[44:45], v[144:145], v[108:109], v[44:45] op_sel_hi:[1,0,1] neg_lo:[0,1,0] neg_hi:[0,1,0]
    v_pk_fma_f32 v[46:47], v[146:147], v[108:109], v[46:47] op_sel_hi:[1,0,1] neg_lo:[0,1,0] neg_hi:[0,1,0]
    v_pk_mul_f32 v[32:33], v[32:33], v[104:105] op_sel_hi:[1,0]
    v_pk_mul_f32 v[34:35], v[34:35], v[104:105] op_sel_hi:[1,0]
    v_pk_mul_f32 v[36:37], v[36:37], v[104:105] op_sel_hi:[1,0]
    v_pk_mul_f32 v[38:39], v[38:39], v[104:105] op_sel_hi:[1,0]
    v_pk_mul_f32 v[40:41], v[40:41], v[104:105] op_sel_hi:[1,0]
    v_pk_mul_f32 v[42:43], v[42:43], v[104:105] op_sel_hi:[1,0]
    v_pk_mul_f32 v[44:45], v[44:45], v[104:105] op_sel_hi:[1,0]
    v_pk_mul_f32 v[46:47], v[46:47], v[104:105] op_sel_hi:[1,0]
    v_cvt_pk_bf16_f32 v32, v32, v33
    v_cvt_pk_bf16_f32 v33, v34, v35
    v_cvt_pk_bf16_f32 v34, v36, v37
    v_cvt_pk_bf16_f32 v35, v38, v39
    v_cvt_pk_bf16_f32 v36, v40, v41
    v_cvt_pk_bf16_f32 v37, v42, v43
    v_cvt_pk_bf16_f32 v38, v44, v45
    v_cvt_pk_bf16_f32 v39, v46, v47
    buffer_store_dwordx4 v[32:35], v96, s[20:23], s32 offen offset:0
    buffer_store_dwordx4 v[36:39], v96, s[20:23], s32 offen offset:1024
    v_pk_fma_f32 v[48:49], v[132:133], v[110:111], v[48:49] op_sel_hi:[1,0,1] neg_lo:[0,1,0] neg_hi:[0,1,0]
    v_pk_fma_f32 v[50:51], v[134:135], v[110:111], v[50:51] op_sel_hi:[1,0,1] neg_lo:[0,1,0] neg_hi:[0,1,0]
    v_pk_fma_f32 v[52:53], v[136:137], v[110:111], v[52:53] op_sel_hi:[1,0,1] neg_lo:[0,1,0] neg_hi:[0,1,0]
    v_pk_fma_f32 v[54:55], v[138:139], v[110:111], v[54:55] op_sel_hi:[1,0,1] neg_lo:[0,1,0] neg_hi:[0,1,0]
    v_pk_fma_f32 v[56:57], v[140:141], v[110:111], v[56:57] op_sel_hi:[1,0,1] neg_lo:[0,1,0] neg_hi:[0,1,0]
    v_pk_fma_f32 v[58:59], v[142:143], v[110:111], v[58:59] op_sel_hi:[1,0,1] neg_lo:[0,1,0] neg_hi:[0,1,0]
    v_pk_fma_f32 v[60:61], v[144:145], v[110:111], v[60:61] op_sel_hi:[1,0,1] neg_lo:[0,1,0] neg_hi:[0,1,0]
    v_pk_fma_f32 v[62:63], v[146:147], v[110:111], v[62:63] op_sel_hi:[1,0,1] neg_lo:[0,1,0] neg_hi:[0,1,0]
    v_pk_mul_f32 v[48:49], v[48:49], v[106:107] op_sel_hi:[1,0]
    v_pk_mul_f32 v[50:51], v[50:51], v[106:107] op_sel_hi:[1,0]
    v_pk_mul_f32 v[52:53], v[52:53], v[106:107] op_sel_hi:[1,0]
    v_pk_mul_f32 v[54:55], v[54:55], v[106:107] op_sel_hi:[1,0]
    v_pk_mul_f32 v[56:57], v[56:57], v[106:107] op_sel_hi:[1,0]
    v_pk_mul_f32 v[58:59], v[58:59], v[106:107] op_sel_hi:[1,0]
    v_pk_mul_f32 v[60:61], v[60:61], v[106:107] op_sel_hi:[1,0]
    v_pk_mul_f32 v[62:63], v[62:63], v[106:107] op_sel_hi:[1,0]
    v_cvt_pk_bf16_f32 v48, v48, v49
    v_cvt_pk_bf16_f32 v49, v50, v51
    v_cvt_pk_bf16_f32 v50, v52, v53
    v_cvt_pk_bf16_f32 v51, v54, v55
    v_cvt_pk_bf16_f32 v52, v56, v57
    v_cvt_pk_bf16_f32 v53, v58, v59
    v_cvt_pk_bf16_f32 v54, v60, v61
    v_cvt_pk_bf16_f32 v55, v62, v63
    buffer_store_dwordx4 v[48:51], v96, s[20:23], s33 offen offset:0
    buffer_store_dwordx4 v[52:55], v96, s[20:23], s33 offen offset:1024
    s_waitcnt lgkmcnt(0)
    v_pk_fma_f32 v[64:65], v[180:181], v[112:113], v[64:65] op_sel_hi:[1,0,1] neg_lo:[0,1,0] neg_hi:[0,1,0]
    v_pk_fma_f32 v[66:67], v[182:183], v[112:113], v[66:67] op_sel_hi:[1,0,1] neg_lo:[0,1,0] neg_hi:[0,1,0]
    v_pk_fma_f32 v[68:69], v[184:185], v[112:113], v[68:69] op_sel_hi:[1,0,1] neg_lo:[0,1,0] neg_hi:[0,1,0]
    v_pk_fma_f32 v[70:71], v[186:187], v[112:113], v[70:71] op_sel_hi:[1,0,1] neg_lo:[0,1,0] neg_hi:[0,1,0]
    v_pk_fma_f32 v[72:73], v[188:189], v[112:113], v[72:73] op_sel_hi:[1,0,1] neg_lo:[0,1,0] neg_hi:[0,1,0]
    v_pk_fma_f32 v[74:75], v[190:191], v[112:113], v[74:75] op_sel_hi:[1,0,1] neg_lo:[0,1,0] neg_hi:[0,1,0]
    v_pk_fma_f32 v[76:77], v[192:193], v[112:113], v[76:77] op_sel_hi:[1,0,1] neg_lo:[0,1,0] neg_hi:[0,1,0]
    v_pk_fma_f32 v[78:79], v[194:195], v[112:113], v[78:79] op_sel_hi:[1,0,1] neg_lo:[0,1,0] neg_hi:[0,1,0]
    v_pk_mul_f32 v[64:65], v[64:65], v[148:149]
    v_pk_mul_f32 v[66:67], v[66:67], v[150:151]
    v_pk_mul_f32 v[68:69], v[68:69], v[152:153]
    v_pk_mul_f32 v[70:71], v[70:71], v[154:155]
    v_pk_mul_f32 v[72:73], v[72:73], v[156:157]
    v_pk_mul_f32 v[74:75], v[74:75], v[158:159]
    v_pk_mul_f32 v[76:77], v[76:77], v[160:161]
    v_pk_mul_f32 v[78:79], v[78:79], v[162:163]
    v_cvt_pk_bf16_f32 v64, v64, v65
    v_cvt_pk_bf16_f32 v65, v66, v67
    v_cvt_pk_bf16_f32 v66, v68, v69
    v_cvt_pk_bf16_f32 v67, v70, v71
    v_cvt_pk_bf16_f32 v68, v72, v73
    v_cvt_pk_bf16_f32 v69, v74, v75
    v_cvt_pk_bf16_f32 v70, v76, v77
    v_cvt_pk_bf16_f32 v71, v78, v79
    buffer_store_dwordx4 v[64:67], v96, s[20:23], s32 offen offset:2048
    buffer_store_dwordx4 v[68:71], v96, s[20:23], s32 offen offset:3072
    v_pk_fma_f32 v[80:81], v[196:197], v[112:113], v[80:81] op_sel_hi:[1,0,1] neg_lo:[0,1,0] neg_hi:[0,1,0]
    v_pk_fma_f32 v[82:83], v[198:199], v[112:113], v[82:83] op_sel_hi:[1,0,1] neg_lo:[0,1,0] neg_hi:[0,1,0]
    v_pk_fma_f32 v[84:85], v[200:201], v[112:113], v[84:85] op_sel_hi:[1,0,1] neg_lo:[0,1,0] neg_hi:[0,1,0]
    v_pk_fma_f32 v[86:87], v[202:203], v[112:113], v[86:87] op_sel_hi:[1,0,1] neg_lo:[0,1,0] neg_hi:[0,1,0]
    v_pk_fma_f32 v[88:89], v[204:205], v[112:113], v[88:89] op_sel_hi:[1,0,1] neg_lo:[0,1,0] neg_hi:[0,1,0]
    v_pk_fma_f32 v[90:91], v[206:207], v[112:113], v[90:91] op_sel_hi:[1,0,1] neg_lo:[0,1,0] neg_hi:[0,1,0]
    v_pk_fma_f32 v[92:93], v[208:209], v[112:113], v[92:93] op_sel_hi:[1,0,1] neg_lo:[0,1,0] neg_hi:[0,1,0]
    v_pk_fma_f32 v[94:95], v[210:211], v[112:113], v[94:95] op_sel_hi:[1,0,1] neg_lo:[0,1,0] neg_hi:[0,1,0]
    v_pk_mul_f32 v[80:81], v[80:81], v[164:165]
    v_pk_mul_f32 v[82:83], v[82:83], v[166:167]
    v_pk_mul_f32 v[84:85], v[84:85], v[168:169]
    v_pk_mul_f32 v[86:87], v[86:87], v[170:171]
    v_pk_mul_f32 v[88:89], v[88:89], v[172:173]
    v_pk_mul_f32 v[90:91], v[90:91], v[174:175]
    v_pk_mul_f32 v[92:93], v[92:93], v[176:177]
    v_pk_mul_f32 v[94:95], v[94:95], v[178:179]
    v_cvt_pk_bf16_f32 v80, v80, v81
    v_cvt_pk_bf16_f32 v81, v82, v83
    v_cvt_pk_bf16_f32 v82, v84, v85
    v_cvt_pk_bf16_f32 v83, v86, v87
    v_cvt_pk_bf16_f32 v84, v88, v89
    v_cvt_pk_bf16_f32 v85, v90, v91
    v_cvt_pk_bf16_f32 v86, v92, v93
    v_cvt_pk_bf16_f32 v87, v94, v95
    buffer_store_dwordx4 v[80:83], v96, s[20:23], s33 offen offset:2048
    buffer_store_dwordx4 v[84:87], v96, s[20:23], s33 offen offset:3072
qkv0_kernel_end:
    s_endpgm
.globl attn0_kernel
.p2align 8
.type attn0_kernel,@function
attn0_kernel:
    s_cmp_ge_u32 s2, 256
    s_cbranch_scc1 attn0_kernel_end
    s_load_dwordx2 s[8:9], s[0:1], 80
    v_lshrrev_b32 v1, 6, v0
    v_and_b32 v2, 63, v0
    v_readfirstlane_b32 s3, v1
    s_and_b32 s24, s2, 7
    s_lshr_b32 s25, s2, 3
    s_lshr_b32 s26, s24, 2
    s_lshl_b32 s26, s26, 3
    s_and_b32 s27, s25, 7
    s_add_u32 s26, s26, s27
    s_and_b32 s27, s24, 3
    s_lshl_b32 s27, s27, 2
    s_lshr_b32 s25, s25, 3
    s_add_u32 s27, s27, s25
    s_lshr_b32 s28, s3, 2
    s_and_b32 s29, s3, 3
    s_lshl_b32 s30, s27, 1
    s_add_u32 s30, s30, s28
    s_lshl_b32 s31, s26, 2
    s_add_u32 s37, s31, s29
    v_lshlrev_b32 v3, 4, v2
    s_waitcnt lgkmcnt(0)
    s_mov_b32 s20, s8
    s_mov_b32 s21, s9
    s_mov_b32 s22, 0x8000000
    s_mov_b32 s23, 0x20000
    s_lshl_b32 s32, s30, 6
    s_add_u32 s33, s32, s37
    s_lshl_b32 s33, s33, 11
    s_add_u32 s33, s33, 0x0
    buffer_load_dwordx4 v[4:7], v3, s[20:23], s33 offen
    buffer_load_dwordx4 v[8:11], v3, s[20:23], s33 offen offset:1024
    s_mul_i32 s34, s29, 3
    s_mul_i32 s35, s28, 12
    s_add_u32 s35, s35, s34
    s_lshl_b32 s35, s35, 12
    s_add_u32 s34, s34, s31
    s_sub_u32 s34, s34, 8
    s_max_i32 s36, s34, 0
    s_add_u32 s36, s36, s32
    s_lshl_b32 s36, s36, 12
    s_add_u32 s36, s36, 0x400000
    s_mov_b32 m0, s35
    s_add_u32 s34, s34, 1
    buffer_load_dwordx4 v3, s[20:23], s36 offen offset:0 lds
    buffer_load_dwordx4 v3, s[20:23], s36 offen offset:1024 lds
    buffer_load_dwordx4 v3, s[20:23], s36 offen offset:2048 lds
    buffer_load_dwordx4 v3, s[20:23], s36 offen offset:3072 lds
    s_add_u32 s35, s35, 4096
    s_max_i32 s36, s34, 0
    s_add_u32 s36, s36, s32
    s_lshl_b32 s36, s36, 12
    s_add_u32 s36, s36, 0x400000
    s_mov_b32 m0, s35
    s_add_u32 s34, s34, 1
    buffer_load_dwordx4 v3, s[20:23], s36 offen offset:0 lds
    buffer_load_dwordx4 v3, s[20:23], s36 offen offset:1024 lds
    buffer_load_dwordx4 v3, s[20:23], s36 offen offset:2048 lds
    buffer_load_dwordx4 v3, s[20:23], s36 offen offset:3072 lds
    s_add_u32 s35, s35, 4096
    s_max_i32 s36, s34, 0
    s_add_u32 s36, s36, s32
    s_lshl_b32 s36, s36, 12
    s_add_u32 s36, s36, 0x400000
    s_mov_b32 m0, s35
    s_add_u32 s34, s34, 1
    buffer_load_dwordx4 v3, s[20:23], s36 offen offset:0 lds
    buffer_load_dwordx4 v3, s[20:23], s36 offen offset:1024 lds
    buffer_load_dwordx4 v3, s[20:23], s36 offen offset:2048 lds
    buffer_load_dwordx4 v3, s[20:23], s36 offen offset:3072 lds
    s_add_u32 s35, s35, 4096
    s_mov_b32 s40, 0xffffffff
    s_mov_b32 s41, 0xfffffff0
    s_mov_b32 s42, 0xfffffffe
    s_mov_b32 s43, 0xffffffe0
    s_mov_b32 s44, 0xfffffffc
    s_mov_b32 s45, 0xffffffc0
    s_mov_b32 s46, 0xfffffff8
    s_mov_b32 s47, 0xffffff80
    s_mov_b32 s48, 0xffffff00
    s_mov_b32 s49, 0xfffff000
    s_mov_b32 s50, 0xfffffe00
    s_mov_b32 s51, 0xffffe000
    s_mov_b32 s52, 0xfffffc00
    s_mov_b32 s53, 0xffffc000
    s_mov_b32 s54, 0xfffff800
    s_mov_b32 s55, 0xffff8000
    s_mov_b32 s56, 0xffff0000
    s_mov_b32 s57, 0xfff00000
    s_mov_b32 s58, 0xfffe0000
    s_mov_b32 s59, 0xffe00000
    s_mov_b32 s60, 0xfffc0000
    s_mov_b32 s61, 0xffc00000
    s_mov_b32 s62, 0xfff80000
    s_mov_b32 s63, 0xff800000
    s_mov_b32 s64, 0xff000000
    s_mov_b32 s65, 0xf0000000
    s_mov_b32 s66, 0xfe000000
    s_mov_b32 s67, 0xe0000000
    s_mov_b32 s68, 0xfc000000
    s_mov_b32 s69, 0xc0000000
    s_mov_b32 s70, 0xf8000000
    s_mov_b32 s71, 0x80000000
    v_mov_b32 v20, 0xffff
    v_mov_b32 v21, 0xffff0000
    v_cndmask_b32 v22, 0, v20, s[40:41]
    v_cndmask_b32 v23, 0, v21, s[42:43]
    v_or_b32 v12, v22, v23
    v_cndmask_b32 v22, 0, v20, s[44:45]
    v_cndmask_b32 v23, 0, v21, s[46:47]
    v_or_b32 v13, v22, v23
    v_cndmask_b32 v22, 0, v20, s[48:49]
    v_cndmask_b32 v23, 0, v21, s[50:51]
    v_or_b32 v14, v22, v23
    v_cndmask_b32 v22, 0, v20, s[52:53]
    v_cndmask_b32 v23, 0, v21, s[54:55]
    v_or_b32 v15, v22, v23
    v_cndmask_b32 v22, 0, v20, s[56:57]
    v_cndmask_b32 v23, 0, v21, s[58:59]
    v_or_b32 v16, v22, v23
    v_cndmask_b32 v22, 0, v20, s[60:61]
    v_cndmask_b32 v23, 0, v21, s[62:63]
    v_or_b32 v17, v22, v23
    v_cndmask_b32 v22, 0, v20, s[64:65]
    v_cndmask_b32 v23, 0, v21, s[66:67]
    v_or_b32 v18, v22, v23
    v_cndmask_b32 v22, 0, v20, s[68:69]
    v_cndmask_b32 v23, 0, v21, s[70:71]
    v_or_b32 v19, v22, v23
    s_mul_i32 s34, s28, 12
    s_add_u32 s34, s34, s29
    s_lshl_b32 s34, s34, 12
    v_add_u32 v20, s34, v3
    v_mov_b32 v24, 0
    v_mov_b32 v25, 0
    v_mov_b32 v26, 0
    v_mov_b32 v27, 0
    v_mov_b32 v28, 0
    v_mov_b32 v29, 0
    v_mov_b32 v30, 0
    v_mov_b32 v31, 0
    v_mov_b32 v32, 0
    v_mov_b32 v33, 0
    v_mov_b32 v34, 0
    v_mov_b32 v35, 0
    v_mov_b32 v36, 0
    v_mov_b32 v37, 0
    v_mov_b32 v38, 0
    v_mov_b32 v39, 0
    s_waitcnt vmcnt(0)
    s_barrier
    ds_read_b128 v[104:107], v20 offset:32768
    ds_read_b128 v[108:111], v20 offset:33792
    ds_read_b128 v[112:115], v20 offset:28672
    ds_read_b128 v[116:119], v20 offset:29696
    s_waitcnt lgkmcnt(2)
    v_mfma_f32_32x32x16_bf16 v[40:55], v[104:107], v[4:7], 0
    v_mfma_f32_32x32x16_bf16 v[40:55], v[108:111], v[8:11], v[40:55]
    ds_read_b128 v[104:107], v20 offset:24576
    ds_read_b128 v[108:111], v20 offset:25600
    s_cmp_eq_u32 s37, 0
    s_cbranch_scc0 attn0_kernel_a1
    v_mov_b32 v24, 0xf149f2ca
    v_mov_b32 v25, 0xf149f2ca
    v_mov_b32 v26, 0xf149f2ca
    v_mov_b32 v27, 0xf149f2ca
    v_mov_b32 v28, 0xf149f2ca
    v_mov_b32 v29, 0xf149f2ca
    v_mov_b32 v30, 0xf149f2ca
    v_mov_b32 v31, 0xf149f2ca
    v_mov_b32 v32, 0xf149f2ca
    v_mov_b32 v33, 0xf149f2ca
    v_mov_b32 v34, 0xf149f2ca
    v_mov_b32 v35, 0xf149f2ca
    v_mov_b32 v36, 0xf149f2ca
    v_mov_b32 v37, 0xf149f2ca
    v_mov_b32 v38, 0xf149f2ca
    v_mov_b32 v39, 0xf149f2ca
attn0_kernel_a1:
    s_waitcnt lgkmcnt(2)
    s_nop 0
    v_mfma_f32_32x32x16_bf16 v[72:87], v[112:115], v[4:7], v[24:39]
    v_mfma_f32_32x32x16_bf16 v[72:87], v[116:119], v[8:11], v[72:87]
    ds_read_b128 v[112:115], v20 offset:20480
    ds_read_b128 v[116:119], v20 offset:21504
    s_cmp_eq_u32 s37, 1
    s_cbranch_scc0 attn0_kernel_a2
    s_nop 1
    v_mov_b32 v24, 0xf149f2ca
    v_mov_b32 v25, 0xf149f2ca
    v_mov_b32 v26, 0xf149f2ca
    v_mov_b32 v27, 0xf149f2ca
    v_mov_b32 v28, 0xf149f2ca
    v_mov_b32 v29, 0xf149f2ca
    v_mov_b32 v30, 0xf149f2ca
    v_mov_b32 v31, 0xf149f2ca
    v_mov_b32 v32, 0xf149f2ca
    v_mov_b32 v33, 0xf149f2ca
    v_mov_b32 v34, 0xf149f2ca
    v_mov_b32 v35, 0xf149f2ca
    v_mov_b32 v36, 0xf149f2ca
    v_mov_b32 v37, 0xf149f2ca
    v_mov_b32 v38, 0xf149f2ca
    v_mov_b32 v39, 0xf149f2ca
attn0_kernel_a2:
    s_waitcnt lgkmcnt(2)
    s_nop 0
    v_mfma_f32_32x32x16_bf16 v[56:71], v[104:107], v[4:7], v[24:39]
    v_mfma_f32_32x32x16_bf16 v[56:71], v[108:111], v[8:11], v[56:71]
    s_nop 3
    v_max_f32 v21, v72, v73
    v_max3_f32 v21, v21, v74, v75
    v_max3_f32 v21, v21, v76, v77
    v_max3_f32 v21, v21, v78, v79
    v_max3_f32 v21, v21, v80, v81
    v_max3_f32 v21, v21, v82, v83
    v_max3_f32 v21, v21, v84, v85
    v_max3_f32 v21, v21, v86, v87
    ds_read_b128 v[104:107], v20 offset:16384
    ds_read_b128 v[108:111], v20 offset:17408
    s_cmp_eq_u32 s37, 2
    s_cbranch_scc0 attn0_kernel_a3
    v_mov_b32 v24, 0xf149f2ca
    v_mov_b32 v25, 0xf149f2ca
    v_mov_b32 v26, 0xf149f2ca
    v_mov_b32 v27, 0xf149f2ca
    v_mov_b32 v28, 0xf149f2ca
    v_mov_b32 v29, 0xf149f2ca
    v_mov_b32 v30, 0xf149f2ca
    v_mov_b32 v31, 0xf149f2ca
    v_mov_b32 v32, 0xf149f2ca
    v_mov_b32 v33, 0xf149f2ca
    v_mov_b32 v34, 0xf149f2ca
    v_mov_b32 v35, 0xf149f2ca
    v_mov_b32 v36, 0xf149f2ca
    v_mov_b32 v37, 0xf149f2ca
    v_mov_b32 v38, 0xf149f2ca
    v_mov_b32 v39, 0xf149f2ca
attn0_kernel_a3:
    s_waitcnt lgkmcnt(2)
    s_nop 0
    v_mfma_f32_32x32x16_bf16 v[72:87], v[112:115], v[4:7], v[24:39]
    v_mfma_f32_32x32x16_bf16 v[72:87], v[116:119], v[8:11], v[72:87]
    v_max3_f32 v21, v21, v56, v57
    v_max3_f32 v21, v21, v58, v59
    v_max3_f32 v21, v21, v60, v61
    v_max3_f32 v21, v21, v62, v63
    v_max3_f32 v21, v21, v64, v65
    v_max3_f32 v21, v21, v66, v67
    v_max3_f32 v21, v21, v68, v69
    v_max3_f32 v21, v21, v70, v71
    ds_read_b128 v[112:115], v20 offset:12288
    ds_read_b128 v[116:119], v20 offset:13312
    s_cmp_eq_u32 s37, 3
    s_cbranch_scc0 attn0_kernel_a4
    v_mov_b32 v24, 0xf149f2ca
    v_mov_b32 v25, 0xf149f2ca
    v_mov_b32 v26, 0xf149f2ca
    v_mov_b32 v27, 0xf149f2ca
    v_mov_b32 v28, 0xf149f2ca
    v_mov_b32 v29, 0xf149f2ca
    v_mov_b32 v30, 0xf149f2ca
    v_mov_b32 v31, 0xf149f2ca
    v_mov_b32 v32, 0xf149f2ca
    v_mov_b32 v33, 0xf149f2ca
    v_mov_b32 v34, 0xf149f2ca
    v_mov_b32 v35, 0xf149f2ca
    v_mov_b32 v36, 0xf149f2ca
    v_mov_b32 v37, 0xf149f2ca
    v_mov_b32 v38, 0xf149f2ca
    v_mov_b32 v39, 0xf149f2ca
attn0_kernel_a4:
    s_waitcnt lgkmcnt(2)
    s_nop 0
    v_mfma_f32_32x32x16_bf16 v[56:71], v[104:107], v[4:7], v[24:39]
    v_mfma_f32_32x32x16_bf16 v[56:71], v[108:111], v[8:11], v[56:71]
    v_max3_f32 v21, v21, v72, v73
    v_max3_f32 v21, v21, v74, v75
    v_max3_f32 v21, v21, v76, v77
    v_max3_f32 v21, v21, v78, v79
    v_max3_f32 v21, v21, v80, v81
    v_max3_f32 v21, v21, v82, v83
    v_max3_f32 v21, v21, v84, v85
    v_max3_f32 v21, v21, v86, v87
    ds_read_b128 v[104:107], v20 offset:8192
    ds_read_b128 v[108:111], v20 offset:9216
    s_cmp_eq_u32 s37, 4
    s_cbranch_scc0 attn0_kernel_a5
    v_mov_b32 v24, 0xf149f2ca
    v_mov_b32 v25, 0xf149f2ca
    v_mov_b32 v26, 0xf149f2ca
    v_mov_b32 v27, 0xf149f2ca
    v_mov_b32 v28, 0xf149f2ca
    v_mov_b32 v29, 0xf149f2ca
    v_mov_b32 v30, 0xf149f2ca
    v_mov_b32 v31, 0xf149f2ca
    v_mov_b32 v32, 0xf149f2ca
    v_mov_b32 v33, 0xf149f2ca
    v_mov_b32 v34, 0xf149f2ca
    v_mov_b32 v35, 0xf149f2ca
    v_mov_b32 v36, 0xf149f2ca
    v_mov_b32 v37, 0xf149f2ca
    v_mov_b32 v38, 0xf149f2ca
    v_mov_b32 v39, 0xf149f2ca
attn0_kernel_a5:
    s_waitcnt lgkmcnt(2)
    s_nop 0
    v_mfma_f32_32x32x16_bf16 v[72:87], v[112:115], v[4:7], v[24:39]
    v_mfma_f32_32x32x16_bf16 v[72:87], v[116:119], v[8:11], v[72:87]
    v_max3_f32 v21, v21, v56, v57
    v_max3_f32 v21, v21, v58, v59
    v_max3_f32 v21, v21, v60, v61
    v_max3_f32 v21, v21, v62, v63
    v_max3_f32 v21, v21, v64, v65
    v_max3_f32 v21, v21, v66, v67
    v_max3_f32 v21, v21, v68, v69
    v_max3_f32 v21, v21, v70, v71
    ds_read_b128 v[112:115], v20 offset:4096
    ds_read_b128 v[116:119], v20 offset:5120
    s_cmp_eq_u32 s37, 5
    s_cbranch_scc0 attn0_kernel_a6
    v_mov_b32 v24, 0xf149f2ca
    v_mov_b32 v25, 0xf149f2ca
    v_mov_b32 v26, 0xf149f2ca
    v_mov_b32 v27, 0xf149f2ca
    v_mov_b32 v28, 0xf149f2ca
    v_mov_b32 v29, 0xf149f2ca
    v_mov_b32 v30, 0xf149f2ca
    v_mov_b32 v31, 0xf149f2ca
    v_mov_b32 v32, 0xf149f2ca
    v_mov_b32 v33, 0xf149f2ca
    v_mov_b32 v34, 0xf149f2ca
    v_mov_b32 v35, 0xf149f2ca
    v_mov_b32 v36, 0xf149f2ca
    v_mov_b32 v37, 0xf149f2ca
    v_mov_b32 v38, 0xf149f2ca
    v_mov_b32 v39, 0xf149f2ca
attn0_kernel_a6:
    s_waitcnt lgkmcnt(2)
    s_nop 0
    v_mfma_f32_32x32x16_bf16 v[56:71], v[104:107], v[4:7], v[24:39]
    v_mfma_f32_32x32x16_bf16 v[56:71], v[108:111], v[8:11], v[56:71]
    v_max3_f32 v21, v21, v72, v73
    v_max3_f32 v21, v21, v74, v75
    v_max3_f32 v21, v21, v76, v77
    v_max3_f32 v21, v21, v78, v79
    v_max3_f32 v21, v21, v80, v81
    v_max3_f32 v21, v21, v82, v83
    v_max3_f32 v21, v21, v84, v85
    v_max3_f32 v21, v21, v86, v87
    ds_read_b128 v[104:107], v20 offset:0
    ds_read_b128 v[108:111], v20 offset:1024
    s_cmp_eq_u32 s37, 6
    s_cbranch_scc0 attn0_kernel_a7
    v_mov_b32 v24, 0xf149f2ca
    v_mov_b32 v25, 0xf149f2ca
    v_mov_b32 v26, 0xf149f2ca
    v_mov_b32 v27, 0xf149f2ca
    v_mov_b32 v28, 0xf149f2ca
    v_mov_b32 v29, 0xf149f2ca
    v_mov_b32 v30, 0xf149f2ca
    v_mov_b32 v31, 0xf149f2ca
    v_mov_b32 v32, 0xf149f2ca
    v_mov_b32 v33, 0xf149f2ca
    v_mov_b32 v34, 0xf149f2ca
    v_mov_b32 v35, 0xf149f2ca
    v_mov_b32 v36, 0xf149f2ca
    v_mov_b32 v37, 0xf149f2ca
    v_mov_b32 v38, 0xf149f2ca
    v_mov_b32 v39, 0xf149f2ca
attn0_kernel_a7:
    s_waitcnt lgkmcnt(2)
    s_nop 0
    v_mfma_f32_32x32x16_bf16 v[72:87], v[112:115], v[4:7], v[24:39]
    v_mfma_f32_32x32x16_bf16 v[72:87], v[116:119], v[8:11], v[72:87]
    v_max3_f32 v21, v21, v56, v57
    v_max3_f32 v21, v21, v58, v59
    v_max3_f32 v21, v21, v60, v61
    v_max3_f32 v21, v21, v62, v63
    v_max3_f32 v21, v21, v64, v65
    v_max3_f32 v21, v21, v66, v67
    v_max3_f32 v21, v21, v68, v69
    v_max3_f32 v21, v21, v70, v71
    s_cmp_eq_u32 s37, 7
    s_cbranch_scc0 attn0_kernel_a8
    v_mov_b32 v24, 0xf149f2ca
    v_mov_b32 v25, 0xf149f2ca
    v_mov_b32 v26, 0xf149f2ca
    v_mov_b32 v27, 0xf149f2ca
    v_mov_b32 v28, 0xf149f2ca
    v_mov_b32 v29, 0xf149f2ca
    v_mov_b32 v30, 0xf149f2ca
    v_mov_b32 v31, 0xf149f2ca
    v_mov_b32 v32, 0xf149f2ca
    v_mov_b32 v33, 0xf149f2ca
    v_mov_b32 v34, 0xf149f2ca
    v_mov_b32 v35, 0xf149f2ca
    v_mov_b32 v36, 0xf149f2ca
    v_mov_b32 v37, 0xf149f2ca
    v_mov_b32 v38, 0xf149f2ca
    v_mov_b32 v39, 0xf149f2ca
attn0_kernel_a8:
    s_waitcnt lgkmcnt(0)
    s_nop 0
    v_mfma_f32_32x32x16_bf16 v[56:71], v[104:107], v[4:7], v[24:39]
    v_mfma_f32_32x32x16_bf16 v[56:71], v[108:111], v[8:11], v[56:71]
    v_max3_f32 v21, v21, v72, v73
    v_max3_f32 v21, v21, v74, v75
    v_max3_f32 v21, v21, v76, v77
    v_max3_f32 v21, v21, v78, v79
    v_max3_f32 v21, v21, v80, v81
    v_max3_f32 v21, v21, v82, v83
    v_max3_f32 v21, v21, v84, v85
    v_max3_f32 v21, v21, v86, v87
    ds_read_b128 v[112:115], v20 offset:28672
    ds_read_b128 v[116:119], v20 offset:29696
    ds_read_b128 v[120:123], v20 offset:34816
    ds_read_b128 v[124:127], v20 offset:35840
    ds_read_b128 v[128:131], v20 offset:2048
    ds_read_b128 v[132:135], v20 offset:3072
    v_cndmask_b32 v40, v56, v40, s[40:41]
    v_cndmask_b32 v41, v57, v41, s[42:43]
    v_cndmask_b32 v42, v58, v42, s[44:45]
    v_cndmask_b32 v43, v59, v43, s[46:47]
    v_cndmask_b32 v44, v60, v44, s[48:49]
    v_cndmask_b32 v45, v61, v45, s[50:51]
    v_cndmask_b32 v46, v62, v46, s[52:53]
    v_cndmask_b32 v47, v63, v47, s[54:55]
    v_cndmask_b32 v48, v64, v48, s[56:57]
    v_cndmask_b32 v49, v65, v49, s[58:59]
    v_cndmask_b32 v50, v66, v50, s[60:61]
    v_cndmask_b32 v51, v67, v51, s[62:63]
    v_cndmask_b32 v52, v68, v52, s[64:65]
    v_cndmask_b32 v53, v69, v53, s[66:67]
    v_cndmask_b32 v54, v70, v54, s[68:69]
    v_cndmask_b32 v55, v71, v55, s[70:71]
    v_max3_f32 v21, v21, v40, v41
    v_max3_f32 v21, v21, v42, v43
    v_max3_f32 v21, v21, v44, v45
    v_max3_f32 v21, v21, v46, v47
    v_max3_f32 v21, v21, v48, v49
    v_max3_f32 v21, v21, v50, v51
    v_max3_f32 v21, v21, v52, v53
    v_max3_f32 v21, v21, v54, v55
    v_mov_b32 v152, v21
    s_nop 1
    v_permlane32_swap_b32 v21, v152
    v_max_f32 v21, v21, v152
    v_sub_f32 v24, 0, v21
    v_sub_f32 v25, 0, v21
    v_sub_f32 v26, 0, v21
    v_sub_f32 v27, 0, v21
    v_sub_f32 v28, 0, v21
    v_sub_f32 v29, 0, v21
    v_sub_f32 v30, 0, v21
    v_sub_f32 v31, 0, v21
    v_sub_f32 v32, 0, v21
    v_sub_f32 v33, 0, v21
    v_sub_f32 v34, 0, v21
    v_sub_f32 v35, 0, v21
    v_sub_f32 v36, 0, v21
    v_sub_f32 v37, 0, v21
    v_sub_f32 v38, 0, v21
    v_sub_f32 v39, 0, v21
    s_cmp_eq_u32 s37, 0
    s_cbranch_scc0 attn0_kernel_b1
    v_mov_b32 v24, 0xf149f2ca
    v_mov_b32 v25, 0xf149f2ca
    v_mov_b32 v26, 0xf149f2ca
    v_mov_b32 v27, 0xf149f2ca
    v_mov_b32 v28, 0xf149f2ca
    v_mov_b32 v29, 0xf149f2ca
    v_mov_b32 v30, 0xf149f2ca
    v_mov_b32 v31, 0xf149f2ca
    v_mov_b32 v32, 0xf149f2ca
    v_mov_b32 v33, 0xf149f2ca
    v_mov_b32 v34, 0xf149f2ca
    v_mov_b32 v35, 0xf149f2ca
    v_mov_b32 v36, 0xf149f2ca
    v_mov_b32 v37, 0xf149f2ca
    v_mov_b32 v38, 0xf149f2ca
    v_mov_b32 v39, 0xf149f2ca
attn0_kernel_b1:
    s_waitcnt lgkmcnt(4)
    s_nop 0
    v_mfma_f32_32x32x16_bf16 v[72:87], v[112:115], v[4:7], v[24:39]
    v_mfma_f32_32x32x16_bf16 v[72:87], v[116:119], v[8:11], v[72:87]
    ds_read_b128 v[104:107], v20 offset:24576
    ds_read_b128 v[108:111], v20 offset:25600
    v_sub_f32 v40, v40, v21
    v_sub_f32 v41, v41, v21
    v_sub_f32 v42, v42, v21
    v_sub_f32 v43, v43, v21
    v_sub_f32 v44, v44, v21
    v_sub_f32 v45, v45, v21
    v_sub_f32 v46, v46, v21
    v_sub_f32 v47, v47, v21
    v_sub_f32 v48, v48, v21
    v_sub_f32 v49, v49, v21
    v_sub_f32 v50, v50, v21
    v_sub_f32 v51, v51, v21
    v_sub_f32 v52, v52, v21
    v_sub_f32 v53, v53, v21
    v_sub_f32 v54, v54, v21
    v_sub_f32 v55, v55, v21
    v_exp_f32 v40, v40
    v_exp_f32 v41, v41
    v_exp_f32 v42, v42
    v_exp_f32 v43, v43
    v_exp_f32 v44, v44
    v_exp_f32 v45, v45
    v_exp_f32 v46, v46
    v_exp_f32 v47, v47
    v_exp_f32 v48, v48
    v_exp_f32 v49, v49
    v_exp_f32 v50, v50
    v_exp_f32 v51, v51
    v_exp_f32 v52, v52
    v_exp_f32 v53, v53
    v_exp_f32 v54, v54
    v_exp_f32 v55, v55
    v_add_f32 v22, v40, v41
    v_add_f32 v23, v42, v43
    v_add_f32 v22, v22, v44
    v_add_f32 v23, v23, v45
    v_add_f32 v22, v22, v46
    v_add_f32 v23, v23, v47
    v_add_f32 v22, v22, v48
    v_add_f32 v23, v23, v49
    v_add_f32 v22, v22, v50
    v_add_f32 v23, v23, v51
    v_add_f32 v22, v22, v52
    v_add_f32 v23, v23, v53
    v_add_f32 v22, v22, v54
    v_add_f32 v23, v23, v55
    v_cvt_pk_bf16_f32 v144, v40, v41
    v_cvt_pk_bf16_f32 v145, v42, v43
    v_cvt_pk_bf16_f32 v146, v44, v45
    v_cvt_pk_bf16_f32 v147, v46, v47
    v_cvt_pk_bf16_f32 v148, v48, v49
    v_cvt_pk_bf16_f32 v149, v50, v51
    v_cvt_pk_bf16_f32 v150, v52, v53
    v_cvt_pk_bf16_f32 v151, v54, v55
    v_and_b32 v136, v144, v12
    v_and_b32 v137, v145, v13
    v_and_b32 v138, v146, v14
    v_and_b32 v139, v147, v15
    v_and_b32 v140, v148, v16
    v_and_b32 v141, v149, v17
    v_and_b32 v142, v150, v18
    v_and_b32 v143, v151, v19
    v_xor_b32 v144, v144, v136
    v_xor_b32 v145, v145, v137
    v_xor_b32 v146, v146, v138
    v_xor_b32 v147, v147, v139
    v_xor_b32 v148, v148, v140
    v_xor_b32 v149, v149, v141
    v_xor_b32 v150, v150, v142
    v_xor_b32 v151, v151, v143
    s_waitcnt lgkmcnt(2)
    v_mfma_f32_32x32x16_bf16 v[88:103], v[120:123], v[136:139], 0
    v_mfma_f32_32x32x16_bf16 v[88:103], v[124:127], v[140:143], v[88:103]
    v_mfma_f32_32x32x16_bf16 v[88:103], v[128:131], v[144:147], v[88:103]
    v_mfma_f32_32x32x16_bf16 v[88:103], v[132:135], v[148:151], v[88:103]
    ds_read_b128 v[128:131], v20 offset:30720
    ds_read_b128 v[132:135], v20 offset:31744
    s_cmp_eq_u32 s37, 1
    s_cbranch_scc0 attn0_kernel_b2
    v_mov_b32 v24, 0xf149f2ca
    v_mov_b32 v25, 0xf149f2ca
    v_mov_b32 v26, 0xf149f2ca
    v_mov_b32 v27, 0xf149f2ca
    v_mov_b32 v28, 0xf149f2ca
    v_mov_b32 v29, 0xf149f2ca
    v_mov_b32 v30, 0xf149f2ca
    v_mov_b32 v31, 0xf149f2ca
    v_mov_b32 v32, 0xf149f2ca
    v_mov_b32 v33, 0xf149f2ca
    v_mov_b32 v34, 0xf149f2ca
    v_mov_b32 v35, 0xf149f2ca
    v_mov_b32 v36, 0xf149f2ca
    v_mov_b32 v37, 0xf149f2ca
    v_mov_b32 v38, 0xf149f2ca
    v_mov_b32 v39, 0xf149f2ca
attn0_kernel_b2:
    s_waitcnt lgkmcnt(2)
    s_nop 0
    v_mfma_f32_32x32x16_bf16 v[56:71], v[104:107], v[4:7], v[24:39]
    v_mfma_f32_32x32x16_bf16 v[56:71], v[108:111], v[8:11], v[56:71]
    ds_read_b128 v[112:115], v20 offset:20480
    ds_read_b128 v[116:119], v20 offset:21504
    v_exp_f32 v72, v72
    v_exp_f32 v73, v73
    v_exp_f32 v74, v74
    v_exp_f32 v75, v75
    v_exp_f32 v76, v76
    v_exp_f32 v77, v77
    v_exp_f32 v78, v78
    v_exp_f32 v79, v79
    v_exp_f32 v80, v80
    v_exp_f32 v81, v81
    v_exp_f32 v82, v82
    v_exp_f32 v83, v83
    v_exp_f32 v84, v84
    v_exp_f32 v85, v85
    v_exp_f32 v86, v86
    v_exp_f32 v87, v87
    v_add_f32 v22, v22, v72
    v_add_f32 v23, v23, v73
    v_add_f32 v22, v22, v74
    v_add_f32 v23, v23, v75
    v_add_f32 v22, v22, v76
    v_add_f32 v23, v23, v77
    v_add_f32 v22, v22, v78
    v_add_f32 v23, v23, v79
    v_add_f32 v22, v22, v80
    v_add_f32 v23, v23, v81
    v_add_f32 v22, v22, v82
    v_add_f32 v23, v23, v83
    v_add_f32 v22, v22, v84
    v_add_f32 v23, v23, v85
    v_add_f32 v22, v22, v86
    v_add_f32 v23, v23, v87
    v_cvt_pk_bf16_f32 v144, v72, v73
    v_cvt_pk_bf16_f32 v145, v74, v75
    v_cvt_pk_bf16_f32 v146, v76, v77
    v_cvt_pk_bf16_f32 v147, v78, v79
    v_cvt_pk_bf16_f32 v148, v80, v81
    v_cvt_pk_bf16_f32 v149, v82, v83
    v_cvt_pk_bf16_f32 v150, v84, v85
    v_cvt_pk_bf16_f32 v151, v86, v87
    s_waitcnt lgkmcnt(2)
    v_mfma_f32_32x32x16_bf16 v[88:103], v[128:131], v[144:147], v[88:103]
    v_mfma_f32_32x32x16_bf16 v[88:103], v[132:135], v[148:151], v[88:103]
    ds_read_b128 v[120:123], v20 offset:26624
    ds_read_b128 v[124:127], v20 offset:27648
    s_cmp_eq_u32 s37, 2
    s_cbranch_scc0 attn0_kernel_b3
    v_mov_b32 v24, 0xf149f2ca
    v_mov_b32 v25, 0xf149f2ca
    v_mov_b32 v26, 0xf149f2ca
    v_mov_b32 v27, 0xf149f2ca
    v_mov_b32 v28, 0xf149f2ca
    v_mov_b32 v29, 0xf149f2ca
    v_mov_b32 v30, 0xf149f2ca
    v_mov_b32 v31, 0xf149f2ca
    v_mov_b32 v32, 0xf149f2ca
    v_mov_b32 v33, 0xf149f2ca
    v_mov_b32 v34, 0xf149f2ca
    v_mov_b32 v35, 0xf149f2ca
    v_mov_b32 v36, 0xf149f2ca
    v_mov_b32 v37, 0xf149f2ca
    v_mov_b32 v38, 0xf149f2ca
    v_mov_b32 v39, 0xf149f2ca
attn0_kernel_b3:
    s_waitcnt lgkmcnt(2)
    s_nop 0
    v_mfma_f32_32x32x16_bf16 v[72:87], v[112:115], v[4:7], v[24:39]
    v_mfma_f32_32x32x16_bf16 v[72:87], v[116:119], v[8:11], v[72:87]
    ds_read_b128 v[104:107], v20 offset:16384
    ds_read_b128 v[108:111], v20 offset:17408
    v_exp_f32 v56, v56
    v_exp_f32 v57, v57
    v_exp_f32 v58, v58
    v_exp_f32 v59, v59
    v_exp_f32 v60, v60
    v_exp_f32 v61, v61
    v_exp_f32 v62, v62
    v_exp_f32 v63, v63
    v_exp_f32 v64, v64
    v_exp_f32 v65, v65
    v_exp_f32 v66, v66
    v_exp_f32 v67, v67
    v_exp_f32 v68, v68
    v_exp_f32 v69, v69
    v_exp_f32 v70, v70
    v_exp_f32 v71, v71
    v_add_f32 v22, v22, v56
    v_add_f32 v23, v23, v57
    v_add_f32 v22, v22, v58
    v_add_f32 v23, v23, v59
    v_add_f32 v22, v22, v60
    v_add_f32 v23, v23, v61
    v_add_f32 v22, v22, v62
    v_add_f32 v23, v23, v63
    v_add_f32 v22, v22, v64
    v_add_f32 v23, v23, v65
    v_add_f32 v22, v22, v66
    v_add_f32 v23, v23, v67
    v_add_f32 v22, v22, v68
    v_add_f32 v23, v23, v69
    v_add_f32 v22, v22, v70
    v_add_f32 v23, v23, v71
    v_cvt_pk_bf16_f32 v136, v56, v57
    v_cvt_pk_bf16_f32 v137, v58, v59
    v_cvt_pk_bf16_f32 v138, v60, v61
    v_cvt_pk_bf16_f32 v139, v62, v63
    v_cvt_pk_bf16_f32 v140, v64, v65
    v_cvt_pk_bf16_f32 v141, v66, v67
    v_cvt_pk_bf16_f32 v142, v68, v69
    v_cvt_pk_bf16_f32 v143, v70, v71
    s_waitcnt lgkmcnt(2)
    v_mfma_f32_32x32x16_bf16 v[88:103], v[120:123], v[136:139], v[88:103]
    v_mfma_f32_32x32x16_bf16 v[88:103], v[124:127], v[140:143], v[88:103]
    ds_read_b128 v[128:131], v20 offset:22528
    ds_read_b128 v[132:135], v20 offset:23552
    s_cmp_eq_u32 s37, 3
    s_cbranch_scc0 attn0_kernel_b4
    v_mov_b32 v24, 0xf149f2ca
    v_mov_b32 v25, 0xf149f2ca
    v_mov_b32 v26, 0xf149f2ca
    v_mov_b32 v27, 0xf149f2ca
    v_mov_b32 v28, 0xf149f2ca
    v_mov_b32 v29, 0xf149f2ca
    v_mov_b32 v30, 0xf149f2ca
    v_mov_b32 v31, 0xf149f2ca
    v_mov_b32 v32, 0xf149f2ca
    v_mov_b32 v33, 0xf149f2ca
    v_mov_b32 v34, 0xf149f2ca
    v_mov_b32 v35, 0xf149f2ca
    v_mov_b32 v36, 0xf149f2ca
    v_mov_b32 v37, 0xf149f2ca
    v_mov_b32 v38, 0xf149f2ca
    v_mov_b32 v39, 0xf149f2ca
attn0_kernel_b4:
    s_waitcnt lgkmcnt(2)
    s_nop 0
    v_mfma_f32_32x32x16_bf16 v[56:71], v[104:107], v[4:7], v[24:39]
    v_mfma_f32_32x32x16_bf16 v[56:71], v[108:111], v[8:11], v[56:71]
    ds_read_b128 v[112:115], v20 offset:12288
    ds_read_b128 v[116:119], v20 offset:13312
    v_exp_f32 v72, v72
    v_exp_f32 v73, v73
    v_exp_f32 v74, v74
    v_exp_f32 v75, v75
    v_exp_f32 v76, v76
    v_exp_f32 v77, v77
    v_exp_f32 v78, v78
    v_exp_f32 v79, v79
    v_exp_f32 v80, v80
    v_exp_f32 v81, v81
    v_exp_f32 v82, v82
    v_exp_f32 v83, v83
    v_exp_f32 v84, v84
    v_exp_f32 v85, v85
    v_exp_f32 v86, v86
    v_exp_f32 v87, v87
    v_add_f32 v22, v22, v72
    v_add_f32 v23, v23, v73
    v_add_f32 v22, v22, v74
    v_add_f32 v23, v23, v75
    v_add_f32 v22, v22, v76
    v_add_f32 v23, v23, v77
    v_add_f32 v22, v22, v78
    v_add_f32 v23, v23, v79
    v_add_f32 v22, v22, v80
    v_add_f32 v23, v23, v81
    v_add_f32 v22, v22, v82
    v_add_f32 v23, v23, v83
    v_add_f32 v22, v22, v84
    v_add_f32 v23, v23, v85
    v_add_f32 v22, v22, v86
    v_add_f32 v23, v23, v87
    v_cvt_pk_bf16_f32 v144, v72, v73
    v_cvt_pk_bf16_f32 v145, v74, v75
    v_cvt_pk_bf16_f32 v146, v76, v77
    v_cvt_pk_bf16_f32 v147, v78, v79
    v_cvt_pk_bf16_f32 v148, v80, v81
    v_cvt_pk_bf16_f32 v149, v82, v83
    v_cvt_pk_bf16_f32 v150, v84, v85
    v_cvt_pk_bf16_f32 v151, v86, v87
    s_waitcnt lgkmcnt(2)
    v_mfma_f32_32x32x16_bf16 v[88:103], v[128:131], v[144:147], v[88:103]
    v_mfma_f32_32x32x16_bf16 v[88:103], v[132:135], v[148:151], v[88:103]
    ds_read_b128 v[120:123], v20 offset:18432
    ds_read_b128 v[124:127], v20 offset:19456
    s_cmp_eq_u32 s37, 4
    s_cbranch_scc0 attn0_kernel_b5
    v_mov_b32 v24, 0xf149f2ca
    v_mov_b32 v25, 0xf149f2ca
    v_mov_b32 v26, 0xf149f2ca
    v_mov_b32 v27, 0xf149f2ca
    v_mov_b32 v28, 0xf149f2ca
    v_mov_b32 v29, 0xf149f2ca
    v_mov_b32 v30, 0xf149f2ca
    v_mov_b32 v31, 0xf149f2ca
    v_mov_b32 v32, 0xf149f2ca
    v_mov_b32 v33, 0xf149f2ca
    v_mov_b32 v34, 0xf149f2ca
    v_mov_b32 v35, 0xf149f2ca
    v_mov_b32 v36, 0xf149f2ca
    v_mov_b32 v37, 0xf149f2ca
    v_mov_b32 v38, 0xf149f2ca
    v_mov_b32 v39, 0xf149f2ca
attn0_kernel_b5:
    s_waitcnt lgkmcnt(2)
    s_nop 0
    v_mfma_f32_32x32x16_bf16 v[72:87], v[112:115], v[4:7], v[24:39]
    v_mfma_f32_32x32x16_bf16 v[72:87], v[116:119], v[8:11], v[72:87]
    ds_read_b128 v[104:107], v20 offset:8192
    ds_read_b128 v[108:111], v20 offset:9216
    v_exp_f32 v56, v56
    v_exp_f32 v57, v57
    v_exp_f32 v58, v58
    v_exp_f32 v59, v59
    v_exp_f32 v60, v60
    v_exp_f32 v61, v61
    v_exp_f32 v62, v62
    v_exp_f32 v63, v63
    v_exp_f32 v64, v64
    v_exp_f32 v65, v65
    v_exp_f32 v66, v66
    v_exp_f32 v67, v67
    v_exp_f32 v68, v68
    v_exp_f32 v69, v69
    v_exp_f32 v70, v70
    v_exp_f32 v71, v71
    v_add_f32 v22, v22, v56
    v_add_f32 v23, v23, v57
    v_add_f32 v22, v22, v58
    v_add_f32 v23, v23, v59
    v_add_f32 v22, v22, v60
    v_add_f32 v23, v23, v61
    v_add_f32 v22, v22, v62
    v_add_f32 v23, v23, v63
    v_add_f32 v22, v22, v64
    v_add_f32 v23, v23, v65
    v_add_f32 v22, v22, v66
    v_add_f32 v23, v23, v67
    v_add_f32 v22, v22, v68
    v_add_f32 v23, v23, v69
    v_add_f32 v22, v22, v70
    v_add_f32 v23, v23, v71
    v_cvt_pk_bf16_f32 v136, v56, v57
    v_cvt_pk_bf16_f32 v137, v58, v59
    v_cvt_pk_bf16_f32 v138, v60, v61
    v_cvt_pk_bf16_f32 v139, v62, v63
    v_cvt_pk_bf16_f32 v140, v64, v65
    v_cvt_pk_bf16_f32 v141, v66, v67
    v_cvt_pk_bf16_f32 v142, v68, v69
    v_cvt_pk_bf16_f32 v143, v70, v71
    s_waitcnt lgkmcnt(2)
    v_mfma_f32_32x32x16_bf16 v[88:103], v[120:123], v[136:139], v[88:103]
    v_mfma_f32_32x32x16_bf16 v[88:103], v[124:127], v[140:143], v[88:103]
    ds_read_b128 v[128:131], v20 offset:14336
    ds_read_b128 v[132:135], v20 offset:15360
    s_cmp_eq_u32 s37, 5
    s_cbranch_scc0 attn0_kernel_b6
    v_mov_b32 v24, 0xf149f2ca
    v_mov_b32 v25, 0xf149f2ca
    v_mov_b32 v26, 0xf149f2ca
    v_mov_b32 v27, 0xf149f2ca
    v_mov_b32 v28, 0xf149f2ca
    v_mov_b32 v29, 0xf149f2ca
    v_mov_b32 v30, 0xf149f2ca
    v_mov_b32 v31, 0xf149f2ca
    v_mov_b32 v32, 0xf149f2ca
    v_mov_b32 v33, 0xf149f2ca
    v_mov_b32 v34, 0xf149f2ca
    v_mov_b32 v35, 0xf149f2ca
    v_mov_b32 v36, 0xf149f2ca
    v_mov_b32 v37, 0xf149f2ca
    v_mov_b32 v38, 0xf149f2ca
    v_mov_b32 v39, 0xf149f2ca
attn0_kernel_b6:
    s_waitcnt lgkmcnt(2)
    s_nop 0
    v_mfma_f32_32x32x16_bf16 v[56:71], v[104:107], v[4:7], v[24:39]
    v_mfma_f32_32x32x16_bf16 v[56:71], v[108:111], v[8:11], v[56:71]
    ds_read_b128 v[112:115], v20 offset:4096
    ds_read_b128 v[116:119], v20 offset:5120
    v_exp_f32 v72, v72
    v_exp_f32 v73, v73
    v_exp_f32 v74, v74
    v_exp_f32 v75, v75
    v_exp_f32 v76, v76
    v_exp_f32 v77, v77
    v_exp_f32 v78, v78
    v_exp_f32 v79, v79
    v_exp_f32 v80, v80
    v_exp_f32 v81, v81
    v_exp_f32 v82, v82
    v_exp_f32 v83, v83
    v_exp_f32 v84, v84
    v_exp_f32 v85, v85
    v_exp_f32 v86, v86
    v_exp_f32 v87, v87
    v_add_f32 v22, v22, v72
    v_add_f32 v23, v23, v73
    v_add_f32 v22, v22, v74
    v_add_f32 v23, v23, v75
    v_add_f32 v22, v22, v76
    v_add_f32 v23, v23, v77
    v_add_f32 v22, v22, v78
    v_add_f32 v23, v23, v79
    v_add_f32 v22, v22, v80
    v_add_f32 v23, v23, v81
    v_add_f32 v22, v22, v82
    v_add_f32 v23, v23, v83
    v_add_f32 v22, v22, v84
    v_add_f32 v23, v23, v85
    v_add_f32 v22, v22, v86
    v_add_f32 v23, v23, v87
    v_cvt_pk_bf16_f32 v144, v72, v73
    v_cvt_pk_bf16_f32 v145, v74, v75
    v_cvt_pk_bf16_f32 v146, v76, v77
    v_cvt_pk_bf16_f32 v147, v78, v79
    v_cvt_pk_bf16_f32 v148, v80, v81
    v_cvt_pk_bf16_f32 v149, v82, v83
    v_cvt_pk_bf16_f32 v150, v84, v85
    v_cvt_pk_bf16_f32 v151, v86, v87
    s_waitcnt lgkmcnt(2)
    v_mfma_f32_32x32x16_bf16 v[88:103], v[128:131], v[144:147], v[88:103]
    v_mfma_f32_32x32x16_bf16 v[88:103], v[132:135], v[148:151], v[88:103]
    ds_read_b128 v[120:123], v20 offset:10240
    ds_read_b128 v[124:127], v20 offset:11264
    s_cmp_eq_u32 s37, 6
    s_cbranch_scc0 attn0_kernel_b7
    v_mov_b32 v24, 0xf149f2ca
    v_mov_b32 v25, 0xf149f2ca
    v_mov_b32 v26, 0xf149f2ca
    v_mov_b32 v27, 0xf149f2ca
    v_mov_b32 v28, 0xf149f2ca
    v_mov_b32 v29, 0xf149f2ca
    v_mov_b32 v30, 0xf149f2ca
    v_mov_b32 v31, 0xf149f2ca
    v_mov_b32 v32, 0xf149f2ca
    v_mov_b32 v33, 0xf149f2ca
    v_mov_b32 v34, 0xf149f2ca
    v_mov_b32 v35, 0xf149f2ca
    v_mov_b32 v36, 0xf149f2ca
    v_mov_b32 v37, 0xf149f2ca
    v_mov_b32 v38, 0xf149f2ca
    v_mov_b32 v39, 0xf149f2ca
attn0_kernel_b7:
    s_waitcnt lgkmcnt(2)
    s_nop 0
    v_mfma_f32_32x32x16_bf16 v[72:87], v[112:115], v[4:7], v[24:39]
    v_mfma_f32_32x32x16_bf16 v[72:87], v[116:119], v[8:11], v[72:87]
    v_exp_f32 v56, v56
    v_exp_f32 v57, v57
    v_exp_f32 v58, v58
    v_exp_f32 v59, v59
    v_exp_f32 v60, v60
    v_exp_f32 v61, v61
    v_exp_f32 v62, v62
    v_exp_f32 v63, v63
    v_exp_f32 v64, v64
    v_exp_f32 v65, v65
    v_exp_f32 v66, v66
    v_exp_f32 v67, v67
    v_exp_f32 v68, v68
    v_exp_f32 v69, v69
    v_exp_f32 v70, v70
    v_exp_f32 v71, v71
    v_add_f32 v22, v22, v56
    v_add_f32 v23, v23, v57
    v_add_f32 v22, v22, v58
    v_add_f32 v23, v23, v59
    v_add_f32 v22, v22, v60
    v_add_f32 v23, v23, v61
    v_add_f32 v22, v22, v62
    v_add_f32 v23, v23, v63
    v_add_f32 v22, v22, v64
    v_add_f32 v23, v23, v65
    v_add_f32 v22, v22, v66
    v_add_f32 v23, v23, v67
    v_add_f32 v22, v22, v68
    v_add_f32 v23, v23, v69
    v_add_f32 v22, v22, v70
    v_add_f32 v23, v23, v71
    v_cvt_pk_bf16_f32 v136, v56, v57
    v_cvt_pk_bf16_f32 v137, v58, v59
    v_cvt_pk_bf16_f32 v138, v60, v61
    v_cvt_pk_bf16_f32 v139, v62, v63
    v_cvt_pk_bf16_f32 v140, v64, v65
    v_cvt_pk_bf16_f32 v141, v66, v67
    v_cvt_pk_bf16_f32 v142, v68, v69
    v_cvt_pk_bf16_f32 v143, v70, v71
    s_waitcnt lgkmcnt(0)
    v_mfma_f32_32x32x16_bf16 v[88:103], v[120:123], v[136:139], v[88:103]
    v_mfma_f32_32x32x16_bf16 v[88:103], v[124:127], v[140:143], v[88:103]
    ds_read_b128 v[128:131], v20 offset:6144
    ds_read_b128 v[132:135], v20 offset:7168
    v_exp_f32 v72, v72
    v_exp_f32 v73, v73
    v_exp_f32 v74, v74
    v_exp_f32 v75, v75
    v_exp_f32 v76, v76
    v_exp_f32 v77, v77
    v_exp_f32 v78, v78
    v_exp_f32 v79, v79
    v_exp_f32 v80, v80
    v_exp_f32 v81, v81
    v_exp_f32 v82, v82
    v_exp_f32 v83, v83
    v_exp_f32 v84, v84
    v_exp_f32 v85, v85
    v_exp_f32 v86, v86
    v_exp_f32 v87, v87
    v_add_f32 v22, v22, v72
    v_add_f32 v23, v23, v73
    v_add_f32 v22, v22, v74
    v_add_f32 v23, v23, v75
    v_add_f32 v22, v22, v76
    v_add_f32 v23, v23, v77
    v_add_f32 v22, v22, v78
    v_add_f32 v23, v23, v79
    v_add_f32 v22, v22, v80
    v_add_f32 v23, v23, v81
    v_add_f32 v22, v22, v82
    v_add_f32 v23, v23, v83
    v_add_f32 v22, v22, v84
    v_add_f32 v23, v23, v85
    v_add_f32 v22, v22, v86
    v_add_f32 v23, v23, v87
    v_cvt_pk_bf16_f32 v144, v72, v73
    v_cvt_pk_bf16_f32 v145, v74, v75
    v_cvt_pk_bf16_f32 v146, v76, v77
    v_cvt_pk_bf16_f32 v147, v78, v79
    v_cvt_pk_bf16_f32 v148, v80, v81
    v_cvt_pk_bf16_f32 v149, v82, v83
    v_cvt_pk_bf16_f32 v150, v84, v85
    v_cvt_pk_bf16_f32 v151, v86, v87
    s_waitcnt lgkmcnt(0)
    v_mfma_f32_32x32x16_bf16 v[88:103], v[128:131], v[144:147], v[88:103]
    v_mfma_f32_32x32x16_bf16 v[88:103], v[132:135], v[148:151], v[88:103]
    v_add_f32 v22, v22, v23
    v_mov_b32 v152, v22
    s_nop 1
    v_permlane32_swap_b32 v22, v152
    v_add_f32 v22, v22, v152
    v_rcp_f32 v22, v22
    s_lshl_b32 s33, s37, 16
    s_lshl_b32 s34, s30, 11
    s_add_u32 s33, s33, s34
    s_add_u32 s33, s33, 0xc00000
    s_nop 0
    v_mul_f32 v88, v88, v22
    v_mul_f32 v89, v89, v22
    v_mul_f32 v90, v90, v22
    v_mul_f32 v91, v91, v22
    v_mul_f32 v92, v92, v22
    v_mul_f32 v93, v93, v22
    v_mul_f32 v94, v94, v22
    v_mul_f32 v95, v95, v22
    v_mul_f32 v96, v96, v22
    v_mul_f32 v97, v97, v22
    v_mul_f32 v98, v98, v22
    v_mul_f32 v99, v99, v22
    v_mul_f32 v100, v100, v22
    v_mul_f32 v101, v101, v22
    v_mul_f32 v102, v102, v22
    v_mul_f32 v103, v103, v22
    v_cvt_pk_bf16_f32 v88, v88, v89
    v_cvt_pk_bf16_f32 v89, v90, v91
    v_cvt_pk_bf16_f32 v90, v92, v93
    v_cvt_pk_bf16_f32 v91, v94, v95
    v_cvt_pk_bf16_f32 v92, v96, v97
    v_cvt_pk_bf16_f32 v93, v98, v99
    v_cvt_pk_bf16_f32 v94, v100, v101
    v_cvt_pk_bf16_f32 v95, v102, v103
    buffer_store_dwordx4 v[88:91], v3, s[20:23], s33 offen
    buffer_store_dwordx4 v[92:95], v3, s[20:23], s33 offen offset:1024
attn0_kernel_end:
    s_endpgm
.globl wo0_kernel
.p2align 8
.type wo0_kernel,@function
wo0_kernel:
    s_cmp_ge_u32 s2, 256
    s_cbranch_scc1 wo0_kernel_end
    s_load_dwordx2 s[4:5], s[0:1], 0
    s_load_dwordx2 s[6:7], s[0:1], 16
    s_load_dwordx2 s[8:9], s[0:1], 80
    s_load_dwordx2 s[10:11], s[0:1], 32
    v_lshrrev_b32 v1, 6, v0
    v_and_b32 v2, 63, v0
    v_readfirstlane_b32 s3, v1
    s_and_b32 s24, s2, 7
    s_lshr_b32 s25, s2, 3
    s_lshl_b32 s26, s24, 1
    s_and_b32 s27, s25, 1
    s_add_u32 s26, s26, s27
    s_lshr_b32 s27, s25, 1
    s_and_b32 s28, s3, 3
    s_lshr_b32 s29, s3, 2
    v_bfe_u32 v4, v2, 3, 2
    v_lshrrev_b32 v5, 5, v2
    v_lshl_add_u32 v4, v5, 3, v4
    s_lshr_b32 s30, s3, 1
    s_lshl_b32 s30, s30, 4
    s_and_b32 s31, s3, 1
    s_lshl_b32 s31, s31, 2
    s_add_u32 s30, s30, s31
    v_add_u32 v4, s30, v4
    v_lshlrev_b32 v4, 11, v4
    v_lshrrev_b32 v6, 2, v2
    v_and_b32 v6, 4, v6
    v_xor_b32 v6, v6, v2
    v_and_b32 v6, 7, v6
    v_lshl_add_u32 v4, v6, 4, v4
    v_lshlrev_b32 v3, 4, v2
    s_waitcnt lgkmcnt(0)
    s_mov_b32 s12, s4
    s_mov_b32 s13, s5
    s_mov_b32 s14, 0x400000
    s_mov_b32 s15, 0x20000
    s_mov_b32 s16, s6
    s_mov_b32 s17, s7
    s_mov_b32 s18, 0x200000
    s_mov_b32 s19, 0x20000
    s_mov_b32 s20, s8
    s_mov_b32 s21, s9
    s_mov_b32 s22, 0x8000000
    s_mov_b32 s23, 0x20000
    s_mov_b32 s40, s10
    s_mov_b32 s41, s11
    s_mov_b32 s42, 0x800
    s_mov_b32 s43, 0x20000
    s_lshl_b32 s30, s27, 7
    s_lshl_b32 s31, s3, 10
    s_mov_b32 m0, s31
    s_nop 0
    buffer_load_dwordx4 v4, s[16:19], s30 offen lds
    s_add_u32 m0, m0, 8192
    s_add_u32 s30, s30, 131072
    buffer_load_dwordx4 v4, s[16:19], s30 offen lds
    s_add_u32 m0, m0, 8192
    s_add_u32 s30, s30, 131072
    buffer_load_dwordx4 v4, s[16:19], s30 offen lds
    s_add_u32 m0, m0, 8192
    s_add_u32 s30, s30, 131072
    buffer_load_dwordx4 v4, s[16:19], s30 offen lds
    s_add_u32 m0, m0, 8192
    s_add_u32 s30, s30, 131072
    buffer_load_dwordx4 v4, s[16:19], s30 offen lds
    s_add_u32 m0, m0, 8192
    s_add_u32 s30, s30, 131072
    buffer_load_dwordx4 v4, s[16:19], s30 offen lds
    s_add_u32 m0, m0, 8192
    s_add_u32 s30, s30, 131072
    buffer_load_dwordx4 v4, s[16:19], s30 offen lds
    s_add_u32 m0, m0, 8192
    s_add_u32 s30, s30, 131072
    buffer_load_dwordx4 v4, s[16:19], s30 offen lds
    s_add_u32 m0, m0, 8192
    s_add_u32 s30, s30, 131072
    buffer_load_dwordx4 v4, s[16:19], s30 offen lds
    s_add_u32 m0, m0, 8192
    s_add_u32 s30, s30, 131072
    buffer_load_dwordx4 v4, s[16:19], s30 offen lds
    s_add_u32 m0, m0, 8192
    s_add_u32 s30, s30, 131072
    buffer_load_dwordx4 v4, s[16:19], s30 offen lds
    s_add_u32 m0, m0, 8192
    s_add_u32 s30, s30, 131072
    buffer_load_dwordx4 v4, s[16:19], s30 offen lds
    s_add_u32 m0, m0, 8192
    s_add_u32 s30, s30, 131072
    buffer_load_dwordx4 v4, s[16:19], s30 offen lds
    s_add_u32 m0, m0, 8192
    s_add_u32 s30, s30, 131072
    buffer_load_dwordx4 v4, s[16:19], s30 offen lds
    s_add_u32 m0, m0, 8192
    s_add_u32 s30, s30, 131072
    buffer_load_dwordx4 v4, s[16:19], s30 offen lds
    s_add_u32 m0, m0, 8192
    s_add_u32 s30, s30, 131072
    buffer_load_dwordx4 v4, s[16:19], s30 offen lds
    v_and_b32 v7, 31, v2
    s_lshl_b32 s32, s26, 2
    s_add_u32 s32, s32, s28
    s_lshl_b32 s33, s27, 7
    s_lshl_b32 s34, s29, 6
    s_add_u32 s33, s33, s34
    v_lshlrev_b32 v8, 3, v5
    buffer_load_dwordx2 v[48:49], v8, s[40:43], s33 offen offset:0
    buffer_load_dwordx2 v[50:51], v8, s[40:43], s33 offen offset:16
    buffer_load_dwordx2 v[52:53], v8, s[40:43], s33 offen offset:32
    buffer_load_dwordx2 v[54:55], v8, s[40:43], s33 offen offset:48
    s_lshl_b32 s35, s26, 4
    s_add_u32 s35, s35, s27
    s_lshl_b32 s35, s35, 14
    s_lshl_b32 s34, s28, 12
    s_add_u32 s35, s35, s34
    s_lshl_b32 s34, s29, 11
    s_add_u32 s35, s35, s34
    v_lshl_add_u32 v9, v7, 11, v8
    s_lshl_b32 s34, s32, 16
    s_add_u32 s34, s34, s33
    buffer_load_dwordx2 v[40:41], v9, s[12:15], s34 offen offset:0
    buffer_load_dwordx2 v[42:43], v9, s[12:15], s34 offen offset:16
    buffer_load_dwordx2 v[44:45], v9, s[12:15], s34 offen offset:32
    buffer_load_dwordx2 v[46:47], v9, s[12:15], s34 offen offset:48
    s_lshl_b32 s36, s32, 16
    s_lshl_b32 s34, s29, 15
    s_add_u32 s36, s36, s34
    s_add_u32 s36, s36, 0xc00000
    buffer_load_dwordx4 v[64:67], v3, s[20:23], s36 offen offset:0
    buffer_load_dwordx4 v[68:71], v3, s[20:23], s36 offen offset:1024
    buffer_load_dwordx4 v[72:75], v3, s[20:23], s36 offen offset:2048
    buffer_load_dwordx4 v[76:79], v3, s[20:23], s36 offen offset:3072
    s_add_u32 s36, s36, 4096
    buffer_load_dwordx4 v[80:83], v3, s[20:23], s36 offen offset:0
    buffer_load_dwordx4 v[84:87], v3, s[20:23], s36 offen offset:1024
    buffer_load_dwordx4 v[88:91], v3, s[20:23], s36 offen offset:2048
    buffer_load_dwordx4 v[92:95], v3, s[20:23], s36 offen offset:3072
    s_add_u32 s36, s36, 4096
    buffer_load_dwordx4 v[96:99], v3, s[20:23], s36 offen offset:0
    buffer_load_dwordx4 v[100:103], v3, s[20:23], s36 offen offset:1024
    buffer_load_dwordx4 v[104:107], v3, s[20:23], s36 offen offset:2048
    buffer_load_dwordx4 v[108:111], v3, s[20:23], s36 offen offset:3072
    s_add_u32 s36, s36, 4096
    buffer_load_dwordx4 v[112:115], v3, s[20:23], s36 offen offset:0
    buffer_load_dwordx4 v[116:119], v3, s[20:23], s36 offen offset:1024
    buffer_load_dwordx4 v[120:123], v3, s[20:23], s36 offen offset:2048
    buffer_load_dwordx4 v[124:127], v3, s[20:23], s36 offen offset:3072
    s_add_u32 s36, s36, 4096
    buffer_load_dwordx4 v[128:131], v3, s[20:23], s36 offen offset:0
    buffer_load_dwordx4 v[132:135], v3, s[20:23], s36 offen offset:1024
    buffer_load_dwordx4 v[136:139], v3, s[20:23], s36 offen offset:2048
    buffer_load_dwordx4 v[140:143], v3, s[20:23], s36 offen offset:3072
    s_add_u32 s36, s36, 4096
    buffer_load_dwordx4 v[144:147], v3, s[20:23], s36 offen offset:0
    buffer_load_dwordx4 v[148:151], v3, s[20:23], s36 offen offset:1024
    buffer_load_dwordx4 v[152:155], v3, s[20:23], s36 offen offset:2048
    buffer_load_dwordx4 v[156:159], v3, s[20:23], s36 offen offset:3072
    s_add_u32 s36, s36, 4096
    buffer_load_dwordx4 v[160:163], v3, s[20:23], s36 offen offset:0
    buffer_load_dwordx4 v[164:167], v3, s[20:23], s36 offen offset:1024
    buffer_load_dwordx4 v[168:171], v3, s[20:23], s36 offen offset:2048
    buffer_load_dwordx4 v[172:175], v3, s[20:23], s36 offen offset:3072
    s_add_u32 s36, s36, 4096
    buffer_load_dwordx4 v[176:179], v3, s[20:23], s36 offen offset:0
    buffer_load_dwordx4 v[180:183], v3, s[20:23], s36 offen offset:1024
    buffer_load_dwordx4 v[184:187], v3, s[20:23], s36 offen offset:2048
    buffer_load_dwordx4 v[188:191], v3, s[20:23], s36 offen offset:3072
    v_bfe_u32 v10, v2, 2, 2
    v_lshl_add_u32 v11, v5, 3, v10
    v_lshlrev_b32 v11, 7, v11
    v_lshrrev_b32 v10, 1, v10
    v_xor_b32 v10, s29, v10
    v_lshl_add_u32 v11, v10, 6, v11
    v_bfe_u32 v10, v2, 4, 1
    v_lshl_add_u32 v11, v10, 5, v11
    v_and_b32 v10, 3, v2
    v_lshl_add_u32 v11, v10, 3, v11
    s_lshl_b32 s34, s29, 16
    v_add_u32 v58, s34, v11
    v_xor_b32 v59, 64, v58
    v_mov_b32 v60, v7
    v_mov_b32 v61, v5
    v_mov_b32 v62, v3
    s_waitcnt vmcnt(40)
    s_barrier
    ds_read_b64_tr_b16 v[192:193], v58 offset:0
    ds_read_b64_tr_b16 v[194:195], v58 offset:512
    ds_read_b64_tr_b16 v[196:197], v59 offset:0
    ds_read_b64_tr_b16 v[198:199], v59 offset:512
    ds_read_b64_tr_b16 v[200:201], v58 offset:2048
    ds_read_b64_tr_b16 v[202:203], v58 offset:2560
    ds_read_b64_tr_b16 v[204:205], v59 offset:2048
    ds_read_b64_tr_b16 v[206:207], v59 offset:2560
    ds_read_b64_tr_b16 v[208:209], v58 offset:4096
    ds_read_b64_tr_b16 v[210:211], v58 offset:4608
    ds_read_b64_tr_b16 v[212:213], v59 offset:4096
    ds_read_b64_tr_b16 v[214:215], v59 offset:4608
    s_waitcnt vmcnt(31) lgkmcnt(8)
    v_mfma_f32_32x32x16_bf16 v[0:15], v[192:195], v[64:67], 0
    v_mfma_f32_32x32x16_bf16 v[16:31], v[196:199], v[64:67], 0
    ds_read_b64_tr_b16 v[192:193], v58 offset:6144
    ds_read_b64_tr_b16 v[194:195], v58 offset:6656
    ds_read_b64_tr_b16 v[196:197], v59 offset:6144
    ds_read_b64_tr_b16 v[198:199], v59 offset:6656
    s_waitcnt vmcnt(30) lgkmcnt(8)
    v_mfma_f32_32x32x16_bf16 v[0:15], v[200:203], v[68:71], v[0:15]
    v_mfma_f32_32x32x16_bf16 v[16:31], v[204:207], v[68:71], v[16:31]
    ds_read_b64_tr_b16 v[200:201], v58 offset:8192
    ds_read_b64_tr_b16 v[202:203], v58 offset:8704
    ds_read_b64_tr_b16 v[204:205], v59 offset:8192
    ds_read_b64_tr_b16 v[206:207], v59 offset:8704
    s_waitcnt vmcnt(29) lgkmcnt(8)
    v_mfma_f32_32x32x16_bf16 v[0:15], v[208:211], v[72:75], v[0:15]
    v_mfma_f32_32x32x16_bf16 v[16:31], v[212:215], v[72:75], v[16:31]
    ds_read_b64_tr_b16 v[208:209], v58 offset:10240
    ds_read_b64_tr_b16 v[210:211], v58 offset:10752
    ds_read_b64_tr_b16 v[212:213], v59 offset:10240
    ds_read_b64_tr_b16 v[214:215], v59 offset:10752
    s_waitcnt vmcnt(28) lgkmcnt(8)
    v_mfma_f32_32x32x16_bf16 v[0:15], v[192:195], v[76:79], v[0:15]
    v_mfma_f32_32x32x16_bf16 v[16:31], v[196:199], v[76:79], v[16:31]
    ds_read_b64_tr_b16 v[192:193], v58 offset:12288
    ds_read_b64_tr_b16 v[194:195], v58 offset:12800
    ds_read_b64_tr_b16 v[196:197], v59 offset:12288
    ds_read_b64_tr_b16 v[198:199], v59 offset:12800
    s_waitcnt vmcnt(27) lgkmcnt(8)
    v_mfma_f32_32x32x16_bf16 v[0:15], v[200:203], v[80:83], v[0:15]
    v_mfma_f32_32x32x16_bf16 v[16:31], v[204:207], v[80:83], v[16:31]
    ds_read_b64_tr_b16 v[200:201], v58 offset:14336
    ds_read_b64_tr_b16 v[202:203], v58 offset:14848
    ds_read_b64_tr_b16 v[204:205], v59 offset:14336
    ds_read_b64_tr_b16 v[206:207], v59 offset:14848
    s_waitcnt vmcnt(26) lgkmcnt(8)
    v_mfma_f32_32x32x16_bf16 v[0:15], v[208:211], v[84:87], v[0:15]
    v_mfma_f32_32x32x16_bf16 v[16:31], v[212:215], v[84:87], v[16:31]
    ds_read_b64_tr_b16 v[208:209], v58 offset:16384
    ds_read_b64_tr_b16 v[210:211], v58 offset:16896
    ds_read_b64_tr_b16 v[212:213], v59 offset:16384
    ds_read_b64_tr_b16 v[214:215], v59 offset:16896
    s_waitcnt vmcnt(25) lgkmcnt(8)
    v_mfma_f32_32x32x16_bf16 v[0:15], v[192:195], v[88:91], v[0:15]
    v_mfma_f32_32x32x16_bf16 v[16:31], v[196:199], v[88:91], v[16:31]
    ds_read_b64_tr_b16 v[192:193], v58 offset:18432
    ds_read_b64_tr_b16 v[194:195], v58 offset:18944
    ds_read_b64_tr_b16 v[196:197], v59 offset:18432
    ds_read_b64_tr_b16 v[198:199], v59 offset:18944
    s_waitcnt vmcnt(24) lgkmcnt(8)
    v_mfma_f32_32x32x16_bf16 v[0:15], v[200:203], v[92:95], v[0:15]
    v_mfma_f32_32x32x16_bf16 v[16:31], v[204:207], v[92:95], v[16:31]
    ds_read_b64_tr_b16 v[200:201], v58 offset:20480
    ds_read_b64_tr_b16 v[202:203], v58 offset:20992
    ds_read_b64_tr_b16 v[204:205], v59 offset:20480
    ds_read_b64_tr_b16 v[206:207], v59 offset:20992
    s_waitcnt vmcnt(23) lgkmcnt(8)
    v_mfma_f32_32x32x16_bf16 v[0:15], v[208:211], v[96:99], v[0:15]
    v_mfma_f32_32x32x16_bf16 v[16:31], v[212:215], v[96:99], v[16:31]
    ds_read_b64_tr_b16 v[208:209], v58 offset:22528
    ds_read_b64_tr_b16 v[210:211], v58 offset:23040
    ds_read_b64_tr_b16 v[212:213], v59 offset:22528
    ds_read_b64_tr_b16 v[214:215], v59 offset:23040
    s_waitcnt vmcnt(22) lgkmcnt(8)
    v_mfma_f32_32x32x16_bf16 v[0:15], v[192:195], v[100:103], v[0:15]
    v_mfma_f32_32x32x16_bf16 v[16:31], v[196:199], v[100:103], v[16:31]
    ds_read_b64_tr_b16 v[192:193], v58 offset:24576
    ds_read_b64_tr_b16 v[194:195], v58 offset:25088
    ds_read_b64_tr_b16 v[196:197], v59 offset:24576
    ds_read_b64_tr_b16 v[198:199], v59 offset:25088
    s_waitcnt vmcnt(21) lgkmcnt(8)
    v_mfma_f32_32x32x16_bf16 v[0:15], v[200:203], v[104:107], v[0:15]
    v_mfma_f32_32x32x16_bf16 v[16:31], v[204:207], v[104:107], v[16:31]
    ds_read_b64_tr_b16 v[200:201], v58 offset:26624
    ds_read_b64_tr_b16 v[202:203], v58 offset:27136
    ds_read_b64_tr_b16 v[204:205], v59 offset:26624
    ds_read_b64_tr_b16 v[206:207], v59 offset:27136
    s_waitcnt vmcnt(20) lgkmcnt(8)
    v_mfma_f32_32x32x16_bf16 v[0:15], v[208:211], v[108:111], v[0:15]
    v_mfma_f32_32x32x16_bf16 v[16:31], v[212:215], v[108:111], v[16:31]
    ds_read_b64_tr_b16 v[208:209], v58 offset:28672
    ds_read_b64_tr_b16 v[210:211], v58 offset:29184
    ds_read_b64_tr_b16 v[212:213], v59 offset:28672
    ds_read_b64_tr_b16 v[214:215], v59 offset:29184
    s_waitcnt vmcnt(19) lgkmcnt(8)
    v_mfma_f32_32x32x16_bf16 v[0:15], v[192:195], v[112:115], v[0:15]
    v_mfma_f32_32x32x16_bf16 v[16:31], v[196:199], v[112:115], v[16:31]
    ds_read_b64_tr_b16 v[192:193], v58 offset:30720
    ds_read_b64_tr_b16 v[194:195], v58 offset:31232
    ds_read_b64_tr_b16 v[196:197], v59 offset:30720
    ds_read_b64_tr_b16 v[198:199], v59 offset:31232
    s_waitcnt vmcnt(18) lgkmcnt(8)
    v_mfma_f32_32x32x16_bf16 v[0:15], v[200:203], v[116:119], v[0:15]
    v_mfma_f32_32x32x16_bf16 v[16:31], v[204:207], v[116:119], v[16:31]
    ds_read_b64_tr_b16 v[200:201], v58 offset:32768
    ds_read_b64_tr_b16 v[202:203], v58 offset:33280
    ds_read_b64_tr_b16 v[204:205], v59 offset:32768
    ds_read_b64_tr_b16 v[206:207], v59 offset:33280
    s_waitcnt vmcnt(17) lgkmcnt(8)
    v_mfma_f32_32x32x16_bf16 v[0:15], v[208:211], v[120:123], v[0:15]
    v_mfma_f32_32x32x16_bf16 v[16:31], v[212:215], v[120:123], v[16:31]
    ds_read_b64_tr_b16 v[208:209], v58 offset:34816
    ds_read_b64_tr_b16 v[210:211], v58 offset:35328
    ds_read_b64_tr_b16 v[212:213], v59 offset:34816
    ds_read_b64_tr_b16 v[214:215], v59 offset:35328
    s_waitcnt vmcnt(16) lgkmcnt(8)
    v_mfma_f32_32x32x16_bf16 v[0:15], v[192:195], v[124:127], v[0:15]
    v_mfma_f32_32x32x16_bf16 v[16:31], v[196:199], v[124:127], v[16:31]
    ds_read_b64_tr_b16 v[192:193], v58 offset:36864
    ds_read_b64_tr_b16 v[194:195], v58 offset:37376
    ds_read_b64_tr_b16 v[196:197], v59 offset:36864
    ds_read_b64_tr_b16 v[198:199], v59 offset:37376
    s_waitcnt vmcnt(15) lgkmcnt(8)
    v_mfma_f32_32x32x16_bf16 v[0:15], v[200:203], v[128:131], v[0:15]
    v_mfma_f32_32x32x16_bf16 v[16:31], v[204:207], v[128:131], v[16:31]
    ds_read_b64_tr_b16 v[200:201], v58 offset:38912
    ds_read_b64_tr_b16 v[202:203], v58 offset:39424
    ds_read_b64_tr_b16 v[204:205], v59 offset:38912
    ds_read_b64_tr_b16 v[206:207], v59 offset:39424
    s_waitcnt vmcnt(14) lgkmcnt(8)
    v_mfma_f32_32x32x16_bf16 v[0:15], v[208:211], v[132:135], v[0:15]
    v_mfma_f32_32x32x16_bf16 v[16:31], v[212:215], v[132:135], v[16:31]
    ds_read_b64_tr_b16 v[208:209], v58 offset:40960
    ds_read_b64_tr_b16 v[210:211], v58 offset:41472
    ds_read_b64_tr_b16 v[212:213], v59 offset:40960
    ds_read_b64_tr_b16 v[214:215], v59 offset:41472
    s_waitcnt vmcnt(13) lgkmcnt(8)
    v_mfma_f32_32x32x16_bf16 v[0:15], v[192:195], v[136:139], v[0:15]
    v_mfma_f32_32x32x16_bf16 v[16:31], v[196:199], v[136:139], v[16:31]
    ds_read_b64_tr_b16 v[192:193], v58 offset:43008
    ds_read_b64_tr_b16 v[194:195], v58 offset:43520
    ds_read_b64_tr_b16 v[196:197], v59 offset:43008
    ds_read_b64_tr_b16 v[198:199], v59 offset:43520
    s_waitcnt vmcnt(12) lgkmcnt(8)
    v_mfma_f32_32x32x16_bf16 v[0:15], v[200:203], v[140:143], v[0:15]
    v_mfma_f32_32x32x16_bf16 v[16:31], v[204:207], v[140:143], v[16:31]
    ds_read_b64_tr_b16 v[200:201], v58 offset:45056
    ds_read_b64_tr_b16 v[202:203], v58 offset:45568
    ds_read_b64_tr_b16 v[204:205], v59 offset:45056
    ds_read_b64_tr_b16 v[206:207], v59 offset:45568
    s_waitcnt vmcnt(11) lgkmcnt(8)
    v_mfma_f32_32x32x16_bf16 v[0:15], v[208:211], v[144:147], v[0:15]
    v_mfma_f32_32x32x16_bf16 v[16:31], v[212:215], v[144:147], v[16:31]
    ds_read_b64_tr_b16 v[208:209], v58 offset:47104
    ds_read_b64_tr_b16 v[210:211], v58 offset:47616
    ds_read_b64_tr_b16 v[212:213], v59 offset:47104
    ds_read_b64_tr_b16 v[214:215], v59 offset:47616
    s_waitcnt vmcnt(10) lgkmcnt(8)
    v_mfma_f32_32x32x16_bf16 v[0:15], v[192:195], v[148:151], v[0:15]
    v_mfma_f32_32x32x16_bf16 v[16:31], v[196:199], v[148:151], v[16:31]
    ds_read_b64_tr_b16 v[192:193], v58 offset:49152
    ds_read_b64_tr_b16 v[194:195], v58 offset:49664
    ds_read_b64_tr_b16 v[196:197], v59 offset:49152
    ds_read_b64_tr_b16 v[198:199], v59 offset:49664
    s_waitcnt vmcnt(9) lgkmcnt(8)
    v_mfma_f32_32x32x16_bf16 v[0:15], v[200:203], v[152:155], v[0:15]
    v_mfma_f32_32x32x16_bf16 v[16:31], v[204:207], v[152:155], v[16:31]
    ds_read_b64_tr_b16 v[200:201], v58 offset:51200
    ds_read_b64_tr_b16 v[202:203], v58 offset:51712
    ds_read_b64_tr_b16 v[204:205], v59 offset:51200
    ds_read_b64_tr_b16 v[206:207], v59 offset:51712
    s_waitcnt vmcnt(8) lgkmcnt(8)
    v_mfma_f32_32x32x16_bf16 v[0:15], v[208:211], v[156:159], v[0:15]
    v_mfma_f32_32x32x16_bf16 v[16:31], v[212:215], v[156:159], v[16:31]
    ds_read_b64_tr_b16 v[208:209], v58 offset:53248
    ds_read_b64_tr_b16 v[210:211], v58 offset:53760
    ds_read_b64_tr_b16 v[212:213], v59 offset:53248
    ds_read_b64_tr_b16 v[214:215], v59 offset:53760
    s_waitcnt vmcnt(7) lgkmcnt(8)
    v_mfma_f32_32x32x16_bf16 v[0:15], v[192:195], v[160:163], v[0:15]
    v_mfma_f32_32x32x16_bf16 v[16:31], v[196:199], v[160:163], v[16:31]
    ds_read_b64_tr_b16 v[192:193], v58 offset:55296
    ds_read_b64_tr_b16 v[194:195], v58 offset:55808
    ds_read_b64_tr_b16 v[196:197], v59 offset:55296
    ds_read_b64_tr_b16 v[198:199], v59 offset:55808
    s_waitcnt vmcnt(6) lgkmcnt(8)
    v_mfma_f32_32x32x16_bf16 v[0:15], v[200:203], v[164:167], v[0:15]
    v_mfma_f32_32x32x16_bf16 v[16:31], v[204:207], v[164:167], v[16:31]
    ds_read_b64_tr_b16 v[200:201], v58 offset:57344
    ds_read_b64_tr_b16 v[202:203], v58 offset:57856
    ds_read_b64_tr_b16 v[204:205], v59 offset:57344
    ds_read_b64_tr_b16 v[206:207], v59 offset:57856
    s_waitcnt vmcnt(5) lgkmcnt(8)
    v_mfma_f32_32x32x16_bf16 v[0:15], v[208:211], v[168:171], v[0:15]
    v_mfma_f32_32x32x16_bf16 v[16:31], v[212:215], v[168:171], v[16:31]
    ds_read_b64_tr_b16 v[208:209], v58 offset:59392
    ds_read_b64_tr_b16 v[210:211], v58 offset:59904
    ds_read_b64_tr_b16 v[212:213], v59 offset:59392
    ds_read_b64_tr_b16 v[214:215], v59 offset:59904
    s_waitcnt vmcnt(4) lgkmcnt(8)
    v_mfma_f32_32x32x16_bf16 v[0:15], v[192:195], v[172:175], v[0:15]
    v_mfma_f32_32x32x16_bf16 v[16:31], v[196:199], v[172:175], v[16:31]
    ds_read_b64_tr_b16 v[192:193], v58 offset:61440
    ds_read_b64_tr_b16 v[194:195], v58 offset:61952
    ds_read_b64_tr_b16 v[196:197], v59 offset:61440
    ds_read_b64_tr_b16 v[198:199], v59 offset:61952
    s_waitcnt vmcnt(3) lgkmcnt(8)
    v_mfma_f32_32x32x16_bf16 v[0:15], v[200:203], v[176:179], v[0:15]
    v_mfma_f32_32x32x16_bf16 v[16:31], v[204:207], v[176:179], v[16:31]
    ds_read_b64_tr_b16 v[200:201], v58 offset:63488
    ds_read_b64_tr_b16 v[202:203], v58 offset:64000
    ds_read_b64_tr_b16 v[204:205], v59 offset:63488
    ds_read_b64_tr_b16 v[206:207], v59 offset:64000
    s_waitcnt vmcnt(2) lgkmcnt(8)
    v_mfma_f32_32x32x16_bf16 v[0:15], v[208:211], v[180:183], v[0:15]
    v_mfma_f32_32x32x16_bf16 v[16:31], v[212:215], v[180:183], v[16:31]
    s_waitcnt vmcnt(1) lgkmcnt(4)
    v_mfma_f32_32x32x16_bf16 v[0:15], v[192:195], v[184:187], v[0:15]
    v_mfma_f32_32x32x16_bf16 v[16:31], v[196:199], v[184:187], v[16:31]
    s_waitcnt vmcnt(0) lgkmcnt(0)
    v_mfma_f32_32x32x16_bf16 v[0:15], v[200:203], v[188:191], v[0:15]
    v_mfma_f32_32x32x16_bf16 v[16:31], v[204:207], v[188:191], v[16:31]
    s_lshl_b32 s34, s3, 12
    s_add_u32 s34, s34, 131072
    v_add_u32 v63, s34, v62
    s_nop 8
    ds_write_b128 v63, v[16:19] offset:0
    ds_write_b128 v63, v[20:23] offset:1024
    ds_write_b128 v63, v[24:27] offset:2048
    ds_write_b128 v63, v[28:31] offset:3072
    v_xor_b32 v63, 16384, v63
    v_lshlrev_b32 v64, 16, v40
    v_and_b32 v65, 0xffff0000, v40
    v_lshlrev_b32 v80, 16, v48
    v_and_b32 v81, 0xffff0000, v48
    v_lshlrev_b32 v66, 16, v41
    v_and_b32 v67, 0xffff0000, v41
    v_lshlrev_b32 v82, 16, v49
    v_and_b32 v83, 0xffff0000, v49
    v_lshlrev_b32 v68, 16, v42
    v_and_b32 v69, 0xffff0000, v42
    v_lshlrev_b32 v84, 16, v50
    v_and_b32 v85, 0xffff0000, v50
    v_lshlrev_b32 v70, 16, v43
    v_and_b32 v71, 0xffff0000, v43
    v_lshlrev_b32 v86, 16, v51
    v_and_b32 v87, 0xffff0000, v51
    v_lshlrev_b32 v72, 16, v44
    v_and_b32 v73, 0xffff0000, v44
    v_lshlrev_b32 v88, 16, v52
    v_and_b32 v89, 0xffff0000, v52
    v_lshlrev_b32 v74, 16, v45
    v_and_b32 v75, 0xffff0000, v45
    v_lshlrev_b32 v90, 16, v53
    v_and_b32 v91, 0xffff0000, v53
    v_lshlrev_b32 v76, 16, v46
    v_and_b32 v77, 0xffff0000, v46
    v_lshlrev_b32 v92, 16, v54
    v_and_b32 v93, 0xffff0000, v54
    v_lshlrev_b32 v78, 16, v47
    v_and_b32 v79, 0xffff0000, v47
    v_lshlrev_b32 v94, 16, v55
    v_and_b32 v95, 0xffff0000, v55
    v_add_f32 v0, v0, v64
    v_add_f32 v1, v1, v65
    v_add_f32 v2, v2, v66
    v_add_f32 v3, v3, v67
    v_add_f32 v4, v4, v68
    v_add_f32 v5, v5, v69
    v_add_f32 v6, v6, v70
    v_add_f32 v7, v7, v71
    v_add_f32 v8, v8, v72
    v_add_f32 v9, v9, v73
    v_add_f32 v10, v10, v74
    v_add_f32 v11, v11, v75
    v_add_f32 v12, v12, v76
    v_add_f32 v13, v13, v77
    v_add_f32 v14, v14, v78
    v_add_f32 v15, v15, v79
    s_waitcnt lgkmcnt(0)
    s_barrier
    ds_read_b128 v[16:19], v63 offset:0
    ds_read_b128 v[20:23], v63 offset:1024
    ds_read_b128 v[24:27], v63 offset:2048
    ds_read_b128 v[28:31], v63 offset:3072
    s_waitcnt lgkmcnt(0)
    v_add_f32 v0, v0, v16
    v_add_f32 v1, v1, v17
    v_add_f32 v2, v2, v18
    v_add_f32 v3, v3, v19
    v_add_f32 v4, v4, v20
    v_add_f32 v5, v5, v21
    v_add_f32 v6, v6, v22
    v_add_f32 v7, v7, v23
    v_add_f32 v8, v8, v24
    v_add_f32 v9, v9, v25
    v_add_f32 v10, v10, v26
    v_add_f32 v11, v11, v27
    v_add_f32 v12, v12, v28
    v_add_f32 v13, v13, v29
    v_add_f32 v14, v14, v30
    v_add_f32 v15, v15, v31
    v_cvt_pk_bf16_f32 v32, v0, v1
    v_cvt_pk_bf16_f32 v33, v2, v3
    v_cvt_pk_bf16_f32 v34, v4, v5
    v_cvt_pk_bf16_f32 v35, v6, v7
    v_cvt_pk_bf16_f32 v36, v8, v9
    v_cvt_pk_bf16_f32 v37, v10, v11
    v_cvt_pk_bf16_f32 v38, v12, v13
    v_cvt_pk_bf16_f32 v39, v14, v15
    s_add_u32 s34, s35, 0x1000000
    buffer_store_dwordx4 v[32:35], v62, s[20:23], s34 offen
    buffer_store_dwordx4 v[36:39], v62, s[20:23], s34 offen offset:1024
    v_add_f32 v40, v0, v1
    v_mul_f32 v41, v0, v0
    v_mul_f32 v42, v0, v80
    v_fmac_f32 v41, v1, v1
    v_fmac_f32 v42, v1, v81
    v_add_f32 v40, v40, v2
    v_fmac_f32 v41, v2, v2
    v_fmac_f32 v42, v2, v82
    v_add_f32 v40, v40, v3
    v_fmac_f32 v41, v3, v3
    v_fmac_f32 v42, v3, v83
    v_add_f32 v40, v40, v4
    v_fmac_f32 v41, v4, v4
    v_fmac_f32 v42, v4, v84
    v_add_f32 v40, v40, v5
    v_fmac_f32 v41, v5, v5
    v_fmac_f32 v42, v5, v85
    v_add_f32 v40, v40, v6
    v_fmac_f32 v41, v6, v6
    v_fmac_f32 v42, v6, v86
    v_add_f32 v40, v40, v7
    v_fmac_f32 v41, v7, v7
    v_fmac_f32 v42, v7, v87
    v_add_f32 v40, v40, v8
    v_fmac_f32 v41, v8, v8
    v_fmac_f32 v42, v8, v88
    v_add_f32 v40, v40, v9
    v_fmac_f32 v41, v9, v9
    v_fmac_f32 v42, v9, v89
    v_add_f32 v40, v40, v10
    v_fmac_f32 v41, v10, v10
    v_fmac_f32 v42, v10, v90
    v_add_f32 v40, v40, v11
    v_fmac_f32 v41, v11, v11
    v_fmac_f32 v42, v11, v91
    v_add_f32 v40, v40, v12
    v_fmac_f32 v41, v12, v12
    v_fmac_f32 v42, v12, v92
    v_add_f32 v40, v40, v13
    v_fmac_f32 v41, v13, v13
    v_fmac_f32 v42, v13, v93
    v_add_f32 v40, v40, v14
    v_fmac_f32 v41, v14, v14
    v_fmac_f32 v42, v14, v94
    v_add_f32 v40, v40, v15
    v_fmac_f32 v41, v15, v15
    v_fmac_f32 v42, v15, v95
    v_mov_b32 v43, v42
    v_permlane32_swap_b32 v40, v41
    s_nop 0
    v_permlane32_swap_b32 v42, v43
    v_add_f32 v40, v40, v41
    v_add_f32 v42, v42, v43
    v_lshlrev_b32 v44, 2, v60
    v_lshl_add_u32 v45, v61, 13, v44
    s_lshl_b32 s34, s32, 7
    s_add_u32 s34, s34, 0x1400000
    buffer_atomic_add_f32 v40, v45, s[20:23], s34 offen sc1
    s_add_u32 s34, s34, 16384
    s_mov_b64 exec, 0xffffffff
    buffer_atomic_add_f32 v42, v44, s[20:23], s34 offen sc1
wo0_kernel_end:
    s_endpgm
.globl ffn0_kernel
.p2align 8
.type ffn0_kernel,@function
ffn0_kernel:
    s_cmp_ge_u32 s2, 256
    s_cbranch_scc1 ffn0_kernel_end
    s_load_dwordx4 s[4:7], s[0:1], 32
    s_load_dwordx4 s[8:11], s[0:1], 48
    s_load_dwordx2 s[44:45], s[0:1], 64
    s_load_dwordx2 s[46:47], s[0:1], 80
    v_lshrrev_b32 v1, 6, v0
    v_and_b32 v2, 63, v0
    v_readfirstlane_b32 s3, v1
    s_and_b32 s24, s2, 7
    s_lshr_b32 s25, s2, 3
    s_mul_i32 s26, s24, 28
    s_add_u32 s26, s26, s25
    s_waitcnt lgkmcnt(0)
    s_mov_b32 s12, s4
    s_mov_b32 s13, s5
    s_mov_b32 s14, 0x800
    s_mov_b32 s15, 0x20000
    s_mov_b32 s20, s46
    s_mov_b32 s21, s47
    s_mov_b32 s22, 0x8000000
    s_mov_b32 s23, 0x20000
    s_mov_b32 s28, s10
    s_mov_b32 s29, s11
    s_mov_b32 s30, 0x700000
    s_mov_b32 s31, 0x20000
    s_cmp_lt_u32 s3, 4
    s_cselect_b32 s16, s6, s8
    s_cselect_b32 s17, s7, s9
    s_mov_b32 s18, 7340032
    s_mov_b32 s19, 0x20000
    v_lshlrev_b32 v3, 4, v0
    s_mov_b32 s27, 0x1400000
    buffer_load_dwordx4 v[8:11], v3, s[20:23], s27 offen
    s_add_u32 s27, s27, 8192
    buffer_load_dwordx4 v[12:15], v3, s[20:23], s27 offen
    s_add_u32 s27, s27, 8192
    buffer_load_dwordx4 v[16:19], v3, s[20:23], s27 offen
    v_lshlrev_b32 v4, 5, v2
    buffer_load_dwordx4 v[20:23], v4, s[12:15], 0 offen
    buffer_load_dwordx4 v[24:27], v4, s[12:15], 0 offen offset:16
    s_cmp_lt_u32 s25, 28
    s_cselect_b32 s33, 0, 0x10000000
    v_lshrrev_b32 v5, 1, v2
    v_mul_u32_u24 v5, 7168, v5
    v_and_b32 v6, 1, v2
    v_lshl_add_u32 v5, v6, 4, v5
    v_add_u32 v5, s33, v5
    s_and_b32 s34, s3, 3
    s_mul_i32 s34, s34, 1835008
    s_lshl_b32 s35, s26, 5
    s_add_u32 s34, s34, s35
    buffer_load_dwordx4 v[32:35], v5, s[16:19], s34 offen
    s_add_u32 s34, s34, 229376
    buffer_load_dwordx4 v[36:39], v5, s[16:19], s34 offen
    s_add_u32 s34, s34, 229376
    buffer_load_dwordx4 v[40:43], v5, s[16:19], s34 offen
    s_add_u32 s34, s34, 229376
    buffer_load_dwordx4 v[44:47], v5, s[16:19], s34 offen
    s_add_u32 s34, s34, 229376
    buffer_load_dwordx4 v[48:51], v5, s[16:19], s34 offen
    s_add_u32 s34, s34, 229376
    buffer_load_dwordx4 v[52:55], v5, s[16:19], s34 offen
    s_add_u32 s34, s34, 229376
    buffer_load_dwordx4 v[56:59], v5, s[16:19], s34 offen
    s_add_u32 s34, s34, 229376
    buffer_load_dwordx4 v[60:63], v5, s[16:19], s34 offen
    v_lshrrev_b32 v6, 4, v2
    v_lshlrev_b32 v6, 11, v6
    v_and_b32 v7, 15, v2
    v_lshl_add_u32 v6, v7, 4, v6
    v_add_u32 v6, s33, v6
    s_lshl_b32 s34, s26, 15
    s_lshl_b32 s35, s3, 8
    s_add_u32 s34, s34, s35
    buffer_load_dwordx4 v[64:67], v6, s[28:31], s34 offen
    s_add_u32 s34, s34, 8192
    buffer_load_dwordx4 v[68:71], v6, s[28:31], s34 offen
    s_add_u32 s34, s34, 8192
    buffer_load_dwordx4 v[72:75], v6, s[28:31], s34 offen
    s_add_u32 s34, s34, 8192
    buffer_load_dwordx4 v[76:79], v6, s[28:31], s34 offen
    s_waitcnt vmcnt(12)
    v_mov_b32 v28, 0
    v_lshlrev_b32 v29, 16, v20
    v_and_b32 v30, 0xffff0000, v20
    v_add_f32 v28, v28, v29
    v_add_f32 v28, v28, v30
    v_lshlrev_b32 v29, 16, v21
    v_and_b32 v30, 0xffff0000, v21
    v_add_f32 v28, v28, v29
    v_add_f32 v28, v28, v30
    v_lshlrev_b32 v29, 16, v22
    v_and_b32 v30, 0xffff0000, v22
    v_add_f32 v28, v28, v29
    v_add_f32 v28, v28, v30
    v_lshlrev_b32 v29, 16, v23
    v_and_b32 v30, 0xffff0000, v23
    v_add_f32 v28, v28, v29
    v_add_f32 v28, v28, v30
    v_lshlrev_b32 v29, 16, v24
    v_and_b32 v30, 0xffff0000, v24
    v_add_f32 v28, v28, v29
    v_add_f32 v28, v28, v30
    v_lshlrev_b32 v29, 16, v25
    v_and_b32 v30, 0xffff0000, v25
    v_add_f32 v28, v28, v29
    v_add_f32 v28, v28, v30
    v_lshlrev_b32 v29, 16, v26
    v_and_b32 v30, 0xffff0000, v26
    v_add_f32 v28, v28, v29
    v_add_f32 v28, v28, v30
    v_lshlrev_b32 v29, 16, v27
    v_and_b32 v30, 0xffff0000, v27
    v_add_f32 v28, v28, v29
    v_add_f32 v28, v28, v30
    s_nop 1
    v_add_f32_dpp v28, v28, v28 quad_perm:[1,0,3,2] row_mask:0xf bank_mask:0xf
    s_nop 1
    v_add_f32_dpp v28, v28, v28 quad_perm:[2,3,0,1] row_mask:0xf bank_mask:0xf
    s_nop 1
    v_add_f32_dpp v28, v28, v28 row_half_mirror row_mask:0xf bank_mask:0xf
    s_nop 1
    v_add_f32_dpp v28, v28, v28 row_mirror row_mask:0xf bank_mask:0xf
    v_mov_b32 v29, v28
    s_nop 1
    v_permlane16_swap_b32 v28, v29
    v_add_f32 v28, v28, v29
    v_mov_b32 v29, v28
    s_nop 1
    v_permlane32_swap_b32 v28, v29
    v_add_f32 v28, v28, v29
    v_mul_f32 v8, 0x3a800000, v8
    v_mul_f32 v20, 0x3a800000, v12
    v_fma_f32 v20, -v8, v8, v20
    v_max_f32 v20, 0, v20
    v_add_f32 v12, 0x3727c5ac, v20
    v_rsq_f32 v12, v12
    v_fma_f32 v16, -v8, v28, v16
    v_mul_f32 v16, v16, v12
    v_mul_f32 v9, 0x3a800000, v9
    v_mul_f32 v21, 0x3a800000, v13
    v_fma_f32 v21, -v9, v9, v21
    v_max_f32 v21, 0, v21
    v_add_f32 v13, 0x3727c5ac, v21
    v_rsq_f32 v13, v13
    v_fma_f32 v17, -v9, v28, v17
    v_mul_f32 v17, v17, v13
    v_mul_f32 v10, 0x3a800000, v10
    v_mul_f32 v22, 0x3a800000, v14
    v_fma_f32 v22, -v10, v10, v22
    v_max_f32 v22, 0, v22
    v_add_f32 v14, 0x3727c5ac, v22
    v_rsq_f32 v14, v14
    v_fma_f32 v18, -v10, v28, v18
    v_mul_f32 v18, v18, v14
    v_mul_f32 v11, 0x3a800000, v11
    v_mul_f32 v23, 0x3a800000, v15
    v_fma_f32 v23, -v11, v11, v23
    v_max_f32 v23, 0, v23
    v_add_f32 v15, 0x3727c5ac, v23
    v_rsq_f32 v15, v15
    v_fma_f32 v19, -v11, v28, v19
    v_mul_f32 v19, v19, v15
    ds_write_b128 v3, v[8:11]
    ds_write_b128 v3, v[12:15] offset:8192
    ds_write_b128 v3, v[16:19] offset:16384
    v_add_f32 v84, 1.0, v12
    v_mul_f32 v88, v8, v12
    v_sub_f32 v88, 0, v88
    v_mul_f32 v80, v84, v84
    v_mul_f32 v80, v80, v20
    v_add_f32 v80, 0x3727c5ac, v80
    v_rsq_f32 v80, v80
    s_nop 0
    v_mul_f32 v80, v80, v84
    v_add_f32 v85, 1.0, v13
    v_mul_f32 v89, v9, v13
    v_sub_f32 v89, 0, v89
    v_mul_f32 v81, v85, v85
    v_mul_f32 v81, v81, v21
    v_add_f32 v81, 0x3727c5ac, v81
    v_rsq_f32 v81, v81
    s_nop 0
    v_mul_f32 v81, v81, v85
    v_add_f32 v86, 1.0, v14
    v_mul_f32 v90, v10, v14
    v_sub_f32 v90, 0, v90
    v_mul_f32 v82, v86, v86
    v_mul_f32 v82, v82, v22
    v_add_f32 v82, 0x3727c5ac, v82
    v_rsq_f32 v82, v82
    s_nop 0
    v_mul_f32 v82, v82, v86
    v_add_f32 v87, 1.0, v15
    v_mul_f32 v91, v11, v15
    v_sub_f32 v91, 0, v91
    v_mul_f32 v83, v87, v87
    v_mul_f32 v83, v83, v23
    v_add_f32 v83, 0x3727c5ac, v83
    v_rsq_f32 v83, v83
    s_nop 0
    v_mul_f32 v83, v83, v87
    v_lshrrev_b32 v29, 1, v0
    v_cmp_eq_u32 vcc, s2, v29
    s_and_saveexec_b64 s[36:37], vcc
    s_mov_b32 s27, 0x3440000
    buffer_store_dwordx4 v[80:83], v3, s[20:23], s27 offen
    s_add_u32 s27, s27, 8192
    buffer_store_dwordx4 v[8:11], v3, s[20:23], s27 offen
    s_add_u32 s27, s27, 8192
    buffer_store_dwordx4 v[84:87], v3, s[20:23], s27 offen
    s_add_u32 s27, s27, 8192
    buffer_store_dwordx4 v[88:91], v3, s[20:23], s27 offen
    s_mov_b64 exec, s[36:37]
    v_max3_f32 v29, v16, v17, v18
    v_max_f32 v29, v29, v19
    s_nop 1
    v_max_f32_dpp v29, v29, v29 quad_perm:[1,0,3,2] row_mask:0xf bank_mask:0xf
    s_nop 1
    v_max_f32_dpp v29, v29, v29 quad_perm:[2,3,0,1] row_mask:0xf bank_mask:0xf
    s_nop 1
    v_max_f32_dpp v29, v29, v29 row_half_mirror row_mask:0xf bank_mask:0xf
    s_nop 1
    v_max_f32_dpp v29, v29, v29 row_mirror row_mask:0xf bank_mask:0xf
    v_mov_b32 v30, v29
    s_nop 1
    v_permlane16_swap_b32 v29, v30
    v_max_f32 v29, v29, v30
    v_mov_b32 v30, v29
    s_nop 1
    v_permlane32_swap_b32 v29, v30
    v_max_f32 v29, v29, v30
    v_lshlrev_b32 v30, 2, v1
    ds_write_b32 v30, v29 offset:24576
    v_mov_b32 v31, 0x7fffffff
    v_mov_b32 v30, 0
    ds_write_b32 v30, v31 offset:24640
    s_waitcnt lgkmcnt(0)
    s_barrier
    ds_read_b128 v[92:95], v30 offset:24576
    ds_read_b128 v[96:99], v30 offset:24592
    s_waitcnt lgkmcnt(0)
    v_max3_f32 v29, v92, v93, v94
    v_max3_f32 v29, v29, v95, v96
    v_max3_f32 v29, v29, v97, v98
    v_max_f32 v29, v29, v99
    v_lshlrev_b32 v92, 2, v0
    v_cmp_eq_f32 vcc, v29, v19
    v_add_u32 v93, 3, v92
    s_nop 0
    v_cndmask_b32 v31, v31, v93, vcc
    v_cmp_eq_f32 vcc, v29, v18
    v_add_u32 v93, 2, v92
    s_nop 0
    v_cndmask_b32 v31, v31, v93, vcc
    v_cmp_eq_f32 vcc, v29, v17
    v_add_u32 v93, 1, v92
    s_nop 0
    v_cndmask_b32 v31, v31, v93, vcc
    v_cmp_eq_f32 vcc, v29, v16
    v_add_u32 v93, 0, v92
    s_nop 0
    v_cndmask_b32 v31, v31, v93, vcc
    v_cmp_gt_u32 vcc, 0x7fffffff, v31
    s_and_saveexec_b64 s[36:37], vcc
    ds_min_u32 v30, v31 offset:24640
    s_mov_b64 exec, s[36:37]
    s_waitcnt lgkmcnt(0)
    s_barrier
    ds_read_b32 v31, v30 offset:24640
    s_waitcnt lgkmcnt(0)
    v_and_b32 v31, 2047, v31
    v_lshlrev_b32 v92, 2, v31
    ds_read_b32 v93, v92
    ds_read_b32 v94, v92 offset:8192
    v_lshrrev_b32 v95, 7, v31
    v_lshlrev_b32 v95, 18, v95
    v_bfe_u32 v96, v31, 5, 2
    v_lshl_add_u32 v95, v96, 12, v95
    v_and_b32 v96, 31, v31
    v_lshl_add_u32 v95, v96, 4, v95
    v_bfe_u32 v96, v0, 3, 4
    v_lshl_add_u32 v95, v96, 14, v95
    v_and_b32 v96, 7, v0
    v_lshl_add_u32 v95, v96, 9, v95
    s_mov_b32 s27, 0x1000000
    buffer_load_dwordx4 v[108:111], v95, s[20:23], s27 offen
    s_waitcnt lgkmcnt(0)
    v_mov_b32 v112, v31
    v_mov_b32 v113, v29
    v_mov_b32 v114, v93
    v_mov_b32 v115, v94
    v_or_b32 v96, s2, v0
    v_cmp_eq_u32 vcc, 0, v96
    s_and_saveexec_b64 s[36:37], vcc
    s_mov_b32 s27, 0x1450000
    buffer_store_dwordx4 v[112:115], v30, s[20:23], s27 offen
    s_mov_b64 exec, s[36:37]
    s_waitcnt vmcnt(1)
    v_lshlrev_b32 v120, 16, v108
    v_and_b32 v121, 0xffff0000, v108
    v_lshlrev_b32 v122, 16, v109
    v_and_b32 v123, 0xffff0000, v109
    v_lshlrev_b32 v124, 16, v110
    v_and_b32 v125, 0xffff0000, v110
    v_lshlrev_b32 v126, 16, v111
    v_and_b32 v127, 0xffff0000, v111
    v_sub_f32 v120, v120, v93
    v_mul_f32 v120, v120, v94
    v_sub_f32 v121, v121, v93
    v_mul_f32 v121, v121, v94
    v_sub_f32 v122, v122, v93
    v_mul_f32 v122, v122, v94
    v_sub_f32 v123, v123, v93
    v_mul_f32 v123, v123, v94
    v_sub_f32 v124, v124, v93
    v_mul_f32 v124, v124, v94
    v_sub_f32 v125, v125, v93
    v_mul_f32 v125, v125, v94
    v_sub_f32 v126, v126, v93
    v_mul_f32 v126, v126, v94
    v_sub_f32 v127, v127, v93
    v_mul_f32 v127, v127, v94
    v_lshrrev_b32 v96, 1, v0
    v_lshlrev_b32 v96, 6, v96
    v_and_b32 v97, 1, v0
    v_lshl_add_u32 v96, v97, 4, v96
    v_cmp_gt_u32 vcc, 128, v0
    s_and_saveexec_b64 s[36:37], vcc
    ds_write_b128 v96, v[120:123] offset:32768
    ds_write_b128 v96, v[124:127] offset:32800
    s_mov_b64 exec, s[36:37]
    s_waitcnt lgkmcnt(0)
    s_barrier
    s_and_b32 s34, s3, 3
    s_lshl_b32 s34, s34, 10
    v_lshrrev_b32 v96, 1, v2
    v_lshl_add_u32 v96, v96, 2, s34
    ds_read_b32 v108, v96 offset:32768
    ds_read_b32 v109, v96 offset:32896
    ds_read_b32 v110, v96 offset:33024
    ds_read_b32 v111, v96 offset:33152
    ds_read_b32 v112, v96 offset:33280
    ds_read_b32 v113, v96 offset:33408
    ds_read_b32 v114, v96 offset:33536
    ds_read_b32 v115, v96 offset:33664
    s_waitcnt lgkmcnt(0)
    v_lshlrev_b32 v116, 16, v32
    v_and_b32 v117, 0xffff0000, v32
    v_mul_f32 v120, v116, v108
    v_mul_f32 v121, v117, v108
    v_lshlrev_b32 v116, 16, v33
    v_and_b32 v117, 0xffff0000, v33
    v_mul_f32 v122, v116, v108
    v_mul_f32 v123, v117, v108
    v_lshlrev_b32 v116, 16, v34
    v_and_b32 v117, 0xffff0000, v34
    v_mul_f32 v124, v116, v108
    v_mul_f32 v125, v117, v108
    v_lshlrev_b32 v116, 16, v35
    v_and_b32 v117, 0xffff0000, v35
    v_mul_f32 v126, v116, v108
    v_mul_f32 v127, v117, v108
    v_lshlrev_b32 v116, 16, v36
    v_and_b32 v117, 0xffff0000, v36
    v_fmac_f32 v120, v116, v109
    v_fmac_f32 v121, v117, v109
    v_lshlrev_b32 v116, 16, v37
    v_and_b32 v117, 0xffff0000, v37
    v_fmac_f32 v122, v116, v109
    v_fmac_f32 v123, v117, v109
    v_lshlrev_b32 v116, 16, v38
    v_and_b32 v117, 0xffff0000, v38
    v_fmac_f32 v124, v116, v109
    v_fmac_f32 v125, v117, v109
    v_lshlrev_b32 v116, 16, v39
    v_and_b32 v117, 0xffff0000, v39
    v_fmac_f32 v126, v116, v109
    v_fmac_f32 v127, v117, v109
    v_lshlrev_b32 v116, 16, v40
    v_and_b32 v117, 0xffff0000, v40
    v_fmac_f32 v120, v116, v110
    v_fmac_f32 v121, v117, v110
    v_lshlrev_b32 v116, 16, v41
    v_and_b32 v117, 0xffff0000, v41
    v_fmac_f32 v122, v116, v110
    v_fmac_f32 v123, v117, v110
    v_lshlrev_b32 v116, 16, v42
    v_and_b32 v117, 0xffff0000, v42
    v_fmac_f32 v124, v116, v110
    v_fmac_f32 v125, v117, v110
    v_lshlrev_b32 v116, 16, v43
    v_and_b32 v117, 0xffff0000, v43
    v_fmac_f32 v126, v116, v110
    v_fmac_f32 v127, v117, v110
    v_lshlrev_b32 v116, 16, v44
    v_and_b32 v117, 0xffff0000, v44
    v_fmac_f32 v120, v116, v111
    v_fmac_f32 v121, v117, v111
    v_lshlrev_b32 v116, 16, v45
    v_and_b32 v117, 0xffff0000, v45
    v_fmac_f32 v122, v116, v111
    v_fmac_f32 v123, v117, v111
    v_lshlrev_b32 v116, 16, v46
    v_and_b32 v117, 0xffff0000, v46
    v_fmac_f32 v124, v116, v111
    v_fmac_f32 v125, v117, v111
    v_lshlrev_b32 v116, 16, v47
    v_and_b32 v117, 0xffff0000, v47
    v_fmac_f32 v126, v116, v111
    v_fmac_f32 v127, v117, v111
    v_lshlrev_b32 v116, 16, v48
    v_and_b32 v117, 0xffff0000, v48
    v_fmac_f32 v120, v116, v112
    v_fmac_f32 v121, v117, v112
    v_lshlrev_b32 v116, 16, v49
    v_and_b32 v117, 0xffff0000, v49
    v_fmac_f32 v122, v116, v112
    v_fmac_f32 v123, v117, v112
    v_lshlrev_b32 v116, 16, v50
    v_and_b32 v117, 0xffff0000, v50
    v_fmac_f32 v124, v116, v112
    v_fmac_f32 v125, v117, v112
    v_lshlrev_b32 v116, 16, v51
    v_and_b32 v117, 0xffff0000, v51
    v_fmac_f32 v126, v116, v112
    v_fmac_f32 v127, v117, v112
    v_lshlrev_b32 v116, 16, v52
    v_and_b32 v117, 0xffff0000, v52
    v_fmac_f32 v120, v116, v113
    v_fmac_f32 v121, v117, v113
    v_lshlrev_b32 v116, 16, v53
    v_and_b32 v117, 0xffff0000, v53
    v_fmac_f32 v122, v116, v113
    v_fmac_f32 v123, v117, v113
    v_lshlrev_b32 v116, 16, v54
    v_and_b32 v117, 0xffff0000, v54
    v_fmac_f32 v124, v116, v113
    v_fmac_f32 v125, v117, v113
    v_lshlrev_b32 v116, 16, v55
    v_and_b32 v117, 0xffff0000, v55
    v_fmac_f32 v126, v116, v113
    v_fmac_f32 v127, v117, v113
    v_lshlrev_b32 v116, 16, v56
    v_and_b32 v117, 0xffff0000, v56
    v_fmac_f32 v120, v116, v114
    v_fmac_f32 v121, v117, v114
    v_lshlrev_b32 v116, 16, v57
    v_and_b32 v117, 0xffff0000, v57
    v_fmac_f32 v122, v116, v114
    v_fmac_f32 v123, v117, v114
    v_lshlrev_b32 v116, 16, v58
    v_and_b32 v117, 0xffff0000, v58
    v_fmac_f32 v124, v116, v114
    v_fmac_f32 v125, v117, v114
    v_lshlrev_b32 v116, 16, v59
    v_and_b32 v117, 0xffff0000, v59
    v_fmac_f32 v126, v116, v114
    v_fmac_f32 v127, v117, v114
    v_lshlrev_b32 v116, 16, v60
    v_and_b32 v117, 0xffff0000, v60
    v_fmac_f32 v120, v116, v115
    v_fmac_f32 v121, v117, v115
    v_lshlrev_b32 v116, 16, v61
    v_and_b32 v117, 0xffff0000, v61
    v_fmac_f32 v122, v116, v115
    v_fmac_f32 v123, v117, v115
    v_lshlrev_b32 v116, 16, v62
    v_and_b32 v117, 0xffff0000, v62
    v_fmac_f32 v124, v116, v115
    v_fmac_f32 v125, v117, v115
    v_lshlrev_b32 v116, 16, v63
    v_and_b32 v117, 0xffff0000, v63
    v_fmac_f32 v126, v116, v115
    v_fmac_f32 v127, v117, v115
    v_permlane32_swap_b32 v120, v124
    v_permlane32_swap_b32 v121, v125
    v_permlane32_swap_b32 v122, v126
    v_permlane32_swap_b32 v123, v127
    v_add_f32 v120, v120, v124
    v_add_f32 v121, v121, v125
    v_add_f32 v122, v122, v126
    v_add_f32 v123, v123, v127
    s_nop 0
    v_permlane16_swap_b32 v120, v122
    v_permlane16_swap_b32 v121, v123
    v_add_f32 v120, v120, v122
    v_add_f32 v121, v121, v123
    s_nop 0
    v_add_f32_dpp v120, v120, v120 quad_perm:[2,3,0,1] row_mask:0xf bank_mask:0xf
    v_add_f32_dpp v121, v121, v121 quad_perm:[2,3,0,1] row_mask:0xf bank_mask:0xf
    s_nop 0
    v_add_f32_dpp v120, v120, v120 row_ror:4 row_mask:0xf bank_mask:0xf
    v_add_f32_dpp v121, v121, v121 row_ror:4 row_mask:0xf bank_mask:0xf
    s_nop 0
    v_add_f32_dpp v120, v120, v120 row_ror:8 row_mask:0xf bank_mask:0xf
    v_add_f32_dpp v121, v121, v121 row_ror:8 row_mask:0xf bank_mask:0xf
    v_and_b32 v96, 1, v2
    v_lshrrev_b32 v97, 4, v2
    v_lshlrev_b32 v97, 3, v97
    v_lshl_add_u32 v96, v96, 5, v97
    s_lshl_b32 s34, s3, 6
    v_add_u32 v96, s34, v96
    ds_write_b64 v96, v[120:121] offset:40960
    s_waitcnt lgkmcnt(0)
    s_barrier
    v_and_b32 v96, 15, v2
    v_lshlrev_b32 v96, 2, v96
    ds_read_b32 v108, v96 offset:40960
    ds_read_b32 v109, v96 offset:41024
    ds_read_b32 v110, v96 offset:41088
    ds_read_b32 v111, v96 offset:41152
    ds_read_b32 v112, v96 offset:41216
    ds_read_b32 v113, v96 offset:41280
    ds_read_b32 v114, v96 offset:41344
    ds_read_b32 v115, v96 offset:41408
    s_waitcnt lgkmcnt(0)
    v_add_f32 v108, v108, v109
    v_add_f32 v110, v110, v111
    v_add_f32 v112, v112, v113
    v_add_f32 v114, v114, v115
    v_add_f32 v108, v108, v110
    v_add_f32 v112, v112, v114
    v_mul_f32 v109, 0xbfb8aa3b, v108
    v_exp_f32 v109, v109
    s_nop 0
    v_add_f32 v109, 1.0, v109
    v_rcp_f32 v109, v109
    s_nop 0
    v_mul_f32 v108, v108, v109
    v_mul_f32 v108, v108, v112
    v_lshrrev_b32 v96, 4, v2
    v_lshlrev_b32 v96, 2, v96
    ds_bpermute_b32 v112, v96, v108 offset:0
    ds_bpermute_b32 v113, v96, v108 offset:16
    ds_bpermute_b32 v114, v96, v108 offset:32
    ds_bpermute_b32 v115, v96, v108 offset:48
    s_waitcnt lgkmcnt(0)
    v_lshlrev_b32 v116, 16, v64
    v_and_b32 v117, 0xffff0000, v64
    v_mul_f32 v120, v116, v112
    v_mul_f32 v121, v117, v112
    v_lshlrev_b32 v116, 16, v65
    v_and_b32 v117, 0xffff0000, v65
    v_mul_f32 v122, v116, v112
    v_mul_f32 v123, v117, v112
    v_lshlrev_b32 v116, 16, v66
    v_and_b32 v117, 0xffff0000, v66
    v_mul_f32 v124, v116, v112
    v_mul_f32 v125, v117, v112
    v_lshlrev_b32 v116, 16, v67
    v_and_b32 v117, 0xffff0000, v67
    v_mul_f32 v126, v116, v112
    v_mul_f32 v127, v117, v112
    v_lshlrev_b32 v116, 16, v68
    v_and_b32 v117, 0xffff0000, v68
    v_fmac_f32 v120, v116, v113
    v_fmac_f32 v121, v117, v113
    v_lshlrev_b32 v116, 16, v69
    v_and_b32 v117, 0xffff0000, v69
    v_fmac_f32 v122, v116, v113
    v_fmac_f32 v123, v117, v113
    v_lshlrev_b32 v116, 16, v70
    v_and_b32 v117, 0xffff0000, v70
    v_fmac_f32 v124, v116, v113
    v_fmac_f32 v125, v117, v113
    v_lshlrev_b32 v116, 16, v71
    v_and_b32 v117, 0xffff0000, v71
    v_fmac_f32 v126, v116, v113
    v_fmac_f32 v127, v117, v113
    v_lshlrev_b32 v116, 16, v72
    v_and_b32 v117, 0xffff0000, v72
    v_fmac_f32 v120, v116, v114
    v_fmac_f32 v121, v117, v114
    v_lshlrev_b32 v116, 16, v73
    v_and_b32 v117, 0xffff0000, v73
    v_fmac_f32 v122, v116, v114
    v_fmac_f32 v123, v117, v114
    v_lshlrev_b32 v116, 16, v74
    v_and_b32 v117, 0xffff0000, v74
    v_fmac_f32 v124, v116, v114
    v_fmac_f32 v125, v117, v114
    v_lshlrev_b32 v116, 16, v75
    v_and_b32 v117, 0xffff0000, v75
    v_fmac_f32 v126, v116, v114
    v_fmac_f32 v127, v117, v114
    v_lshlrev_b32 v116, 16, v76
    v_and_b32 v117, 0xffff0000, v76
    v_fmac_f32 v120, v116, v115
    v_fmac_f32 v121, v117, v115
    v_lshlrev_b32 v116, 16, v77
    v_and_b32 v117, 0xffff0000, v77
    v_fmac_f32 v122, v116, v115
    v_fmac_f32 v123, v117, v115
    v_lshlrev_b32 v116, 16, v78
    v_and_b32 v117, 0xffff0000, v78
    v_fmac_f32 v124, v116, v115
    v_fmac_f32 v125, v117, v115
    v_lshlrev_b32 v116, 16, v79
    v_and_b32 v117, 0xffff0000, v79
    v_fmac_f32 v126, v116, v115
    v_fmac_f32 v127, v117, v115
    v_permlane32_swap_b32 v120, v124
    v_permlane32_swap_b32 v121, v125
    v_permlane32_swap_b32 v122, v126
    v_permlane32_swap_b32 v123, v127
    v_add_f32 v120, v120, v124
    v_add_f32 v121, v121, v125
    v_add_f32 v122, v122, v126
    v_add_f32 v123, v123, v127
    s_nop 0
    v_permlane16_swap_b32 v120, v122
    v_permlane16_swap_b32 v121, v123
    v_add_f32 v120, v120, v122
    v_add_f32 v121, v121, v123
    s_cmp_ge_u32 s25, 28
    s_cbranch_scc1 ffn0_kernel_end
    v_and_b32 v96, 15, v2
    v_lshlrev_b32 v96, 5, v96
    v_lshrrev_b32 v97, 4, v2
    v_lshl_add_u32 v96, v97, 3, v96
    s_and_b32 s34, s26, 15
    s_lshl_b32 s34, s34, 12
    s_lshl_b32 s35, s3, 9
    s_add_u32 s34, s34, s35
    s_add_u32 s34, s34, 0x1410000
    buffer_atomic_add_f32 v120, v96, s[20:23], s34 offen sc1
    buffer_atomic_add_f32 v121, v96, s[20:23], s34 offen offset:4 sc1
ffn0_kernel_end:
    s_endpgm
.globl fix0_kernel
.p2align 8
.type fix0_kernel,@function
fix0_kernel:
    s_cmp_ge_u32 s2, 1
    s_cbranch_scc1 fix0_kernel_end
    s_load_dwordx2 s[44:45], s[0:1], 64
    s_load_dwordx2 s[46:47], s[0:1], 80
    s_waitcnt lgkmcnt(0)
    s_mov_b32 s20, s46
    s_mov_b32 s21, s47
    s_mov_b32 s22, 0x8000000
    s_mov_b32 s23, 0x20000
    s_mov_b32 s48, s44
    s_mov_b32 s49, s45
    s_mov_b32 s50, 0x400000
    s_mov_b32 s51, 0x20000
    v_mov_b32 v1, 0
    s_mov_b32 s27, 0x1450000
    buffer_load_dwordx4 v[4:7], v1, s[20:23], s27 offen
    v_lshlrev_b32 v2, 4, v0
    s_mov_b32 s27, 0x1410000
    buffer_load_dwordx4 v[16:19], v2, s[20:23], s27 offen
    s_add_u32 s27, s27, 4096
    buffer_load_dwordx4 v[20:23], v2, s[20:23], s27 offen
    s_add_u32 s27, s27, 4096
    buffer_load_dwordx4 v[24:27], v2, s[20:23], s27 offen
    s_add_u32 s27, s27, 4096
    buffer_load_dwordx4 v[28:31], v2, s[20:23], s27 offen
    s_add_u32 s27, s27, 4096
    buffer_load_dwordx4 v[32:35], v2, s[20:23], s27 offen
    s_add_u32 s27, s27, 4096
    buffer_load_dwordx4 v[36:39], v2, s[20:23], s27 offen
    s_add_u32 s27, s27, 4096
    buffer_load_dwordx4 v[40:43], v2, s[20:23], s27 offen
    s_add_u32 s27, s27, 4096
    buffer_load_dwordx4 v[44:47], v2, s[20:23], s27 offen
    s_add_u32 s27, s27, 4096
    buffer_load_dwordx4 v[48:51], v2, s[20:23], s27 offen
    s_add_u32 s27, s27, 4096
    buffer_load_dwordx4 v[52:55], v2, s[20:23], s27 offen
    s_add_u32 s27, s27, 4096
    buffer_load_dwordx4 v[56:59], v2, s[20:23], s27 offen
    s_add_u32 s27, s27, 4096
    buffer_load_dwordx4 v[60:63], v2, s[20:23], s27 offen
    s_add_u32 s27, s27, 4096
    buffer_load_dwordx4 v[64:67], v2, s[20:23], s27 offen
    s_add_u32 s27, s27, 4096
    buffer_load_dwordx4 v[68:71], v2, s[20:23], s27 offen
    s_add_u32 s27, s27, 4096
    buffer_load_dwordx4 v[72:75], v2, s[20:23], s27 offen
    s_add_u32 s27, s27, 4096
    buffer_load_dwordx4 v[76:79], v2, s[20:23], s27 offen
    s_add_u32 s27, s27, 4096
    s_waitcnt vmcnt(16)
    v_and_b32 v4, 2047, v4
    v_lshrrev_b32 v8, 7, v4
    v_lshlrev_b32 v8, 18, v8
    v_bfe_u32 v9, v4, 5, 2
    v_lshl_add_u32 v8, v9, 12, v8
    v_and_b32 v9, 31, v4
    v_lshl_add_u32 v8, v9, 4, v8
    v_lshrrev_b32 v9, 4, v0
    v_lshl_add_u32 v8, v9, 14, v8
    v_bfe_u32 v9, v0, 2, 2
    v_lshl_add_u32 v8, v9, 10, v8
    v_and_b32 v9, 1, v0
    v_lshl_add_u32 v8, v9, 9, v8
    v_bfe_u32 v9, v0, 1, 1
    v_lshl_add_u32 v8, v9, 3, v8
    s_mov_b32 s28, 0x1000000
    buffer_load_dwordx2 v[10:11], v8, s[20:23], s28 offen
    v_mul_f32 v5, 0xbfb8aa3b, v5
    v_exp_f32 v5, v5
    s_nop 0
    v_add_f32 v5, 1.0, v5
    v_rcp_f32 v5, v5
    v_mul_f32 v6, v6, v7
    v_add_f32 v7, 1.0, v7
    s_waitcnt vmcnt(0)
    v_add_f32 v16, v16, v20
    v_add_f32 v17, v17, v21
    v_add_f32 v18, v18, v22
    v_add_f32 v19, v19, v23
    v_add_f32 v16, v16, v24
    v_add_f32 v17, v17, v25
    v_add_f32 v18, v18, v26
    v_add_f32 v19, v19, v27
    v_add_f32 v16, v16, v28
    v_add_f32 v17, v17, v29
    v_add_f32 v18, v18, v30
    v_add_f32 v19, v19, v31
    v_add_f32 v16, v16, v32
    v_add_f32 v17, v17, v33
    v_add_f32 v18, v18, v34
    v_add_f32 v19, v19, v35
    v_add_f32 v16, v16, v36
    v_add_f32 v17, v17, v37
    v_add_f32 v18, v18, v38
    v_add_f32 v19, v19, v39
    v_add_f32 v16, v16, v40
    v_add_f32 v17, v17, v41
    v_add_f32 v18, v18, v42
    v_add_f32 v19, v19, v43
    v_add_f32 v16, v16, v44
    v_add_f32 v17, v17, v45
    v_add_f32 v18, v18, v46
    v_add_f32 v19, v19, v47
    v_add_f32 v16, v16, v48
    v_add_f32 v17, v17, v49
    v_add_f32 v18, v18, v50
    v_add_f32 v19, v19, v51
    v_add_f32 v16, v16, v52
    v_add_f32 v17, v17, v53
    v_add_f32 v18, v18, v54
    v_add_f32 v19, v19, v55
    v_add_f32 v16, v16, v56
    v_add_f32 v17, v17, v57
    v_add_f32 v18, v18, v58
    v_add_f32 v19, v19, v59
    v_add_f32 v16, v16, v60
    v_add_f32 v17, v17, v61
    v_add_f32 v18, v18, v62
    v_add_f32 v19, v19, v63
    v_add_f32 v16, v16, v64
    v_add_f32 v17, v17, v65
    v_add_f32 v18, v18, v66
    v_add_f32 v19, v19, v67
    v_add_f32 v16, v16, v68
    v_add_f32 v17, v17, v69
    v_add_f32 v18, v18, v70
    v_add_f32 v19, v19, v71
    v_add_f32 v16, v16, v72
    v_add_f32 v17, v17, v73
    v_add_f32 v18, v18, v74
    v_add_f32 v19, v19, v75
    v_add_f32 v16, v16, v76
    v_add_f32 v17, v17, v77
    v_add_f32 v18, v18, v78
    v_add_f32 v19, v19, v79
    v_lshlrev_b32 v12, 16, v10
    v_and_b32 v13, 0xffff0000, v10
    v_lshlrev_b32 v14, 16, v11
    v_and_b32 v15, 0xffff0000, v11
    v_fma_f32 v12, v12, v7, -v6
    v_fmac_f32 v12, v16, v5
    v_fma_f32 v13, v13, v7, -v6
    v_fmac_f32 v13, v17, v5
    v_fma_f32 v14, v14, v7, -v6
    v_fmac_f32 v14, v18, v5
    v_fma_f32 v15, v15, v7, -v6
    v_fmac_f32 v15, v19, v5
    v_cvt_pk_bf16_f32 v10, v12, v13
    v_cvt_pk_bf16_f32 v11, v14, v15
    buffer_store_dwordx2 v[10:11], v8, s[20:23], s28 offen
    v_add_f32 v20, v12, v13
    v_add_f32 v20, v20, v14
    v_add_f32 v20, v20, v15
    v_mul_f32 v21, v12, v12
    v_fmac_f32 v21, v13, v13
    v_fmac_f32 v21, v14, v14
    v_fmac_f32 v21, v15, v15
    v_add_f32_dpp v20, v20, v20 quad_perm:[1,0,3,2] row_mask:0xf bank_mask:0xf
    s_nop 1
    v_add_f32_dpp v20, v20, v20 quad_perm:[2,3,0,1] row_mask:0xf bank_mask:0xf
    s_nop 1
    v_add_f32_dpp v20, v20, v20 row_half_mirror row_mask:0xf bank_mask:0xf
    s_nop 1
    v_add_f32_dpp v20, v20, v20 row_mirror row_mask:0xf bank_mask:0xf
    v_mov_b32 v22, v20
    s_nop 1
    v_permlane16_swap_b32 v20, v22
    v_add_f32 v20, v20, v22
    v_mov_b32 v22, v20
    s_nop 1
    v_permlane32_swap_b32 v20, v22
    v_add_f32 v20, v20, v22
    v_add_f32_dpp v21, v21, v21 quad_perm:[1,0,3,2] row_mask:0xf bank_mask:0xf
    s_nop 1
    v_add_f32_dpp v21, v21, v21 quad_perm:[2,3,0,1] row_mask:0xf bank_mask:0xf
    s_nop 1
    v_add_f32_dpp v21, v21, v21 row_half_mirror row_mask:0xf bank_mask:0xf
    s_nop 1
    v_add_f32_dpp v21, v21, v21 row_mirror row_mask:0xf bank_mask:0xf
    v_mov_b32 v22, v21
    s_nop 1
    v_permlane16_swap_b32 v21, v22
    v_add_f32 v21, v21, v22
    v_mov_b32 v22, v21
    s_nop 1
    v_permlane32_swap_b32 v21, v22
    v_add_f32 v21, v21, v22
    v_lshrrev_b32 v22, 6, v0
    v_lshlrev_b32 v22, 3, v22
    ds_write_b64 v22, v[20:21]
    s_waitcnt lgkmcnt(0)
    s_barrier
    ds_read_b128 v[24:27], v1
    ds_read_b128 v[28:31], v1 offset:16
    s_waitcnt lgkmcnt(0)
    v_add_f32 v20, v24, v26
    v_add_f32 v21, v25, v27
    v_add_f32 v20, v20, v28
    v_add_f32 v21, v21, v29
    v_add_f32 v20, v20, v30
    v_add_f32 v21, v21, v31
    v_mul_f32 v20, 0x3a800000, v20
    v_mul_f32 v21, 0x3a800000, v21
    v_fma_f32 v21, -v20, v20, v21
    v_max_f32 v21, 0, v21
    v_add_f32 v21, 0x3727c5ac, v21
    v_rsq_f32 v21, v21
    v_cmp_eq_u32 vcc, 1, v0
    s_nop 1
    v_cndmask_b32 v21, v21, v20, vcc
    v_cmp_eq_u32 vcc, 2, v0
    s_nop 1
    v_cndmask_b32 v21, v21, 1.0, vcc
    v_cmp_eq_u32 vcc, 3, v0
    s_nop 1
    v_cndmask_b32 v21, v21, 0, vcc
    v_lshlrev_b32 v22, 13, v0
    v_lshl_add_u32 v22, v4, 2, v22
    v_cmp_gt_u32 vcc, 4, v0
    s_and_saveexec_b64 s[36:37], vcc
    s_mov_b32 s27, 0x3440000
    buffer_store_dword v21, v22, s[20:23], s27 offen
fix0_kernel_end:
    s_endpgm
.globl qkv1_kernel
.p2align 8
.type qkv1_kernel,@function
qkv1_kernel:
    s_cmp_ge_u32 s2, 256
    s_cbranch_scc1 qkv1_kernel_end
    s_load_dwordx4 s[4:7], s[0:1], 0
    s_load_dwordx2 s[8:9], s[0:1], 80
    v_lshrrev_b32 v1, 6, v0
    v_and_b32 v2, 63, v0
    v_readfirstlane_b32 s3, v1
    s_and_b32 s24, s2, 7
    s_lshr_b32 s25, s2, 3
    s_lshr_b32 s26, s24, 2
    s_lshl_b32 s26, s26, 3
    s_and_b32 s27, s25, 7
    s_add_u32 s26, s26, s27
    s_and_b32 s27, s24, 3
    s_lshl_b32 s27, s27, 2
    s_lshr_b32 s25, s25, 3
    s_add_u32 s27, s27, s25
    s_waitcnt lgkmcnt(0)
    s_mov_b32 s20, s8
    s_mov_b32 s21, s9
    s_mov_b32 s22, 0x8000000
    s_mov_b32 s23, 0x20000
    s_cmp_lt_u32 s3, 4
    s_cbranch_scc1 qkv1_kernel_cons
    s_add_u32 s12, s8, 0x1000000
    s_addc_u32 s13, s9, 0
    s_mov_b32 s14, 0x400000
    s_mov_b32 s15, 0x20000
    s_mov_b32 s16, s6
    s_mov_b32 s17, s7
    s_mov_b32 s18, 0x600000
    s_mov_b32 s19, 0x20000
    s_sub_u32 s3, s3, 4
    s_lshl_b32 s28, s3, 10
    v_lshlrev_b32 v3, 4, v2
    v_add_u32 v3, s28, v3
    s_lshl_b32 s30, s26, 18
    v_lshrrev_b32 v4, 3, v2
    v_and_b32 v5, 3, v4
    v_lshrrev_b32 v6, 5, v2
    v_lshl_add_u32 v4, v6, 3, v5
    s_lshr_b32 s28, s3, 1
    s_lshl_b32 s28, s28, 4
    s_and_b32 s29, s3, 1
    s_lshl_b32 s29, s29, 2
    s_add_u32 s28, s28, s29
    v_add_u32 v4, s28, v4
    v_mul_u32_u24 v4, 6144, v4
    v_lshrrev_b32 v5, 2, v2
    v_and_b32 v5, 4, v5
    v_xor_b32 v5, v5, v2
    v_and_b32 v5, 7, v5
    v_lshl_add_u32 v4, v5, 4, v4
    s_lshl_b32 s31, s27, 7
    s_lshl_b32 s32, s3, 10
    v_subrev_u32 v7, 256, v0
    v_lshrrev_b32 v8, 6, v7
    v_lshlrev_b32 v8, 12, v8
    v_lshl_add_u32 v8, v2, 2, v8
    s_lshl_b32 s33, s27, 8
    s_add_u32 s33, s33, 0x4000000
    buffer_load_dword v16, v8, s[20:23], s33 offen
    s_add_u32 s33, s33, 12288
    buffer_load_dword v17, v8, s[20:23], s33 offen
    s_add_u32 s33, s33, 12288
    buffer_load_dword v18, v8, s[20:23], s33 offen
    s_add_u32 s33, s33, 12288
    buffer_load_dword v19, v8, s[20:23], s33 offen
    s_add_u32 s33, s33, 12288
    buffer_load_dword v20, v8, s[20:23], s33 offen
    s_add_u32 s33, s33, 12288
    buffer_load_dword v21, v8, s[20:23], s33 offen
    s_add_u32 s33, s33, 12288
    buffer_load_dword v22, v8, s[20:23], s33 offen
    s_add_u32 s33, s33, 12288
    buffer_load_dword v23, v8, s[20:23], s33 offen
    s_add_u32 s33, s33, 12288
    buffer_load_dword v24, v8, s[20:23], s33 offen
    s_add_u32 s33, s33, 12288
    buffer_load_dword v25, v8, s[20:23], s33 offen
    s_add_u32 s33, s33, 12288
    buffer_load_dword v26, v8, s[20:23], s33 offen
    s_add_u32 s33, s33, 12288
    buffer_load_dword v27, v8, s[20:23], s33 offen
    s_add_u32 s33, s33, 12288
    buffer_load_dword v28, v8, s[20:23], s33 offen
    s_add_u32 s33, s33, 12288
    buffer_load_dword v29, v8, s[20:23], s33 offen
    s_add_u32 s33, s33, 12288
    buffer_load_dword v30, v8, s[20:23], s33 offen
    s_add_u32 s33, s33, 12288
    buffer_load_dword v31, v8, s[20:23], s33 offen
    s_add_u32 s33, s33, 12288
    v_lshrrev_b32 v9, 7, v7
    v_lshlrev_b32 v9, 13, v9
    v_and_b32 v10, 127, v7
    v_lshl_add_u32 v9, v10, 2, v9
    s_lshl_b32 s33, s26, 9
    s_add_u32 s33, s33, 0x3440000
    buffer_load_dword v32, v9, s[20:23], s33 offen
    s_mov_b32 s36, 4
qkv1_kernel_lpro:
    s_mov_b32 m0, s32
    s_mov_b32 s34, s30
    buffer_load_dwordx4 v3, s[12:15], s34 offen lds
    s_add_u32 m0, m0, 4096
    s_add_u32 s34, s34, 4096
    buffer_load_dwordx4 v3, s[12:15], s34 offen lds
    s_add_u32 m0, m0, 4096
    s_add_u32 s34, s34, 4096
    buffer_load_dwordx4 v3, s[12:15], s34 offen lds
    s_add_u32 m0, m0, 4096
    s_add_u32 s34, s34, 4096
    buffer_load_dwordx4 v3, s[12:15], s34 offen lds
    s_add_u32 m0, m0, 4096
    s_mov_b32 s34, s31
    buffer_load_dwordx4 v4, s[16:19], s34 offen lds
    s_add_u32 m0, m0, 4096
    s_add_u32 s34, s34, 196608
    buffer_load_dwordx4 v4, s[16:19], s34 offen lds
    s_add_u32 m0, m0, 4096
    s_sub_u32 s34, s34, 194560
    buffer_load_dwordx4 v4, s[16:19], s34 offen lds
    s_add_u32 m0, m0, 4096
    s_add_u32 s34, s34, 196608
    buffer_load_dwordx4 v4, s[16:19], s34 offen lds
    s_add_u32 m0, m0, 4096
    s_sub_u32 s34, s34, 194560
    buffer_load_dwordx4 v4, s[16:19], s34 offen lds
    s_add_u32 m0, m0, 4096
    s_add_u32 s34, s34, 196608
    buffer_load_dwordx4 v4, s[16:19], s34 offen lds
    s_add_u32 s30, s30, 16384
    s_add_u32 s31, s31, 393216
    s_add_u32 s32, s32, 40960
    s_cmp_ge_u32 s32, 163840
    s_cselect_b32 s35, 163840, 0
    s_sub_u32 s32, s32, s35
    s_sub_u32 s36, s36, 1
    s_cmp_lg_u32 s36, 0
    s_cbranch_scc1 qkv1_kernel_lpro
    s_waitcnt vmcnt(30)
    v_add_f32 v16, v16, v17
    v_add_f32 v16, v16, v18
    v_add_f32 v16, v16, v19
    v_add_f32 v16, v16, v20
    v_add_f32 v16, v16, v21
    v_add_f32 v16, v16, v22
    v_add_f32 v16, v16, v23
    v_add_f32 v16, v16, v24
    v_add_f32 v16, v16, v25
    v_add_f32 v16, v16, v26
    v_add_f32 v16, v16, v27
    v_add_f32 v16, v16, v28
    v_add_f32 v16, v16, v29
    v_add_f32 v16, v16, v30
    v_add_f32 v16, v16, v31
    s_barrier
    s_mov_b32 s36, 12
qkv1_kernel_lloop:
    s_waitcnt vmcnt(20)
    s_barrier
    s_mov_b32 m0, s32
    s_mov_b32 s34, s30
    buffer_load_dwordx4 v3, s[12:15], s34 offen lds
    s_add_u32 m0, m0, 4096
    s_add_u32 s34, s34, 4096
    buffer_load_dwordx4 v3, s[12:15], s34 offen lds
    s_add_u32 m0, m0, 4096
    s_add_u32 s34, s34, 4096
    buffer_load_dwordx4 v3, s[12:15], s34 offen lds
    s_add_u32 m0, m0, 4096
    s_add_u32 s34, s34, 4096
    buffer_load_dwordx4 v3, s[12:15], s34 offen lds
    s_add_u32 m0, m0, 4096
    s_mov_b32 s34, s31
    buffer_load_dwordx4 v4, s[16:19], s34 offen lds
    s_add_u32 m0, m0, 4096
    s_add_u32 s34, s34, 196608
    buffer_load_dwordx4 v4, s[16:19], s34 offen lds
    s_add_u32 m0, m0, 4096
    s_sub_u32 s34, s34, 194560
    buffer_load_dwordx4 v4, s[16:19], s34 offen lds
    s_add_u32 m0, m0, 4096
    s_add_u32 s34, s34, 196608
    buffer_load_dwordx4 v4, s[16:19], s34 offen lds
    s_add_u32 m0, m0, 4096
    s_sub_u32 s34, s34, 194560
    buffer_load_dwordx4 v4, s[16:19], s34 offen lds
    s_add_u32 m0, m0, 4096
    s_add_u32 s34, s34, 196608
    buffer_load_dwordx4 v4, s[16:19], s34 offen lds
    s_add_u32 s30, s30, 16384
    s_add_u32 s31, s31, 393216
    s_add_u32 s32, s32, 40960
    s_cmp_ge_u32 s32, 163840
    s_cselect_b32 s35, 163840, 0
    s_sub_u32 s32, s32, s35
    s_sub_u32 s36, s36, 1
    s_cmp_lg_u32 s36, 0
    s_cbranch_scc1 qkv1_kernel_lloop
    s_waitcnt vmcnt(20)
    s_barrier
    v_lshlrev_b32 v11, 2, v7
    ds_write_b32 v11, v32
    ds_write_b32 v11, v16 offset:1024
    s_waitcnt vmcnt(10)
    s_barrier
    s_waitcnt vmcnt(0)
    s_barrier
    s_waitcnt lgkmcnt(0)
    s_barrier
    s_endpgm
qkv1_kernel_cons:
    v_mov_b32 v146, v2
    s_and_b32 s28, s3, 1
    s_lshr_b32 s29, s3, 1
    v_and_b32 v3, 31, v2
    v_lshrrev_b32 v4, 5, v2
    s_lshl_b32 s30, s28, 13
    v_lshlrev_b32 v5, 4, v2
    v_add_u32 v136, s30, v5
    v_add_u32 v137, 1024, v136
    v_add_u32 v138, 2048, v136
    v_add_u32 v139, 3072, v136
    v_bfe_u32 v5, v2, 2, 2
    v_lshl_add_u32 v6, v4, 3, v5
    v_lshlrev_b32 v6, 7, v6
    v_lshrrev_b32 v5, 1, v5
    v_xor_b32 v5, s29, v5
    v_lshl_add_u32 v6, v5, 6, v6
    v_bfe_u32 v5, v2, 4, 1
    v_lshl_add_u32 v6, v5, 5, v6
    v_and_b32 v5, 3, v2
    v_lshl_add_u32 v6, v5, 3, v6
    v_add_u32 v140, 16384, v6
    v_mov_b32 v141, v136
    v_mov_b32 v142, v137
    v_mov_b32 v143, v138
    v_mov_b32 v144, v139
    v_mov_b32 v145, v140
    v_mov_b32 v0, 0
    v_mov_b32 v1, 0
    v_mov_b32 v2, 0
    v_mov_b32 v3, 0
    v_mov_b32 v4, 0
    v_mov_b32 v5, 0
    v_mov_b32 v6, 0
    v_mov_b32 v7, 0
    v_mov_b32 v8, 0
    v_mov_b32 v9, 0
    v_mov_b32 v10, 0
    v_mov_b32 v11, 0
    v_mov_b32 v12, 0
    v_mov_b32 v13, 0
    v_mov_b32 v14, 0
    v_mov_b32 v15, 0
    v_mov_b32 v16, 0
    v_mov_b32 v17, 0
    v_mov_b32 v18, 0
    v_mov_b32 v19, 0
    v_mov_b32 v20, 0
    v_mov_b32 v21, 0
    v_mov_b32 v22, 0
    v_mov_b32 v23, 0
    v_mov_b32 v24, 0
    v_mov_b32 v25, 0
    v_mov_b32 v26, 0
    v_mov_b32 v27, 0
    v_mov_b32 v28, 0
    v_mov_b32 v29, 0
    v_mov_b32 v30, 0
    v_mov_b32 v31, 0
    v_mov_b32 v32, 0
    v_mov_b32 v33, 0
    v_mov_b32 v34, 0
    v_mov_b32 v35, 0
    v_mov_b32 v36, 0
    v_mov_b32 v37, 0
    v_mov_b32 v38, 0
    v_mov_b32 v39, 0
    v_mov_b32 v40, 0
    v_mov_b32 v41, 0
    v_mov_b32 v42, 0
    v_mov_b32 v43, 0
    v_mov_b32 v44, 0
    v_mov_b32 v45, 0
    v_mov_b32 v46, 0
    v_mov_b32 v47, 0
    v_mov_b32 v48, 0
    v_mov_b32 v49, 0
    v_mov_b32 v50, 0
    v_mov_b32 v51, 0
    v_mov_b32 v52, 0
    v_mov_b32 v53, 0
    v_mov_b32 v54, 0
    v_mov_b32 v55, 0
    v_mov_b32 v56, 0
    v_mov_b32 v57, 0
    v_mov_b32 v58, 0
    v_mov_b32 v59, 0
    v_mov_b32 v60, 0
    v_mov_b32 v61, 0
    v_mov_b32 v62, 0
    v_mov_b32 v63, 0
    v_mov_b32 v64, 0
    v_mov_b32 v65, 0
    v_mov_b32 v66, 0
    v_mov_b32 v67, 0
    v_mov_b32 v68, 0
    v_mov_b32 v69, 0
    v_mov_b32 v70, 0
    v_mov_b32 v71, 0
    v_mov_b32 v72, 0
    v_mov_b32 v73, 0
    v_mov_b32 v74, 0
    v_mov_b32 v75, 0
    v_mov_b32 v76, 0
    v_mov_b32 v77, 0
    v_mov_b32 v78, 0
    v_mov_b32 v79, 0
    v_mov_b32 v80, 0
    v_mov_b32 v81, 0
    v_mov_b32 v82, 0
    v_mov_b32 v83, 0
    v_mov_b32 v84, 0
    v_mov_b32 v85, 0
    v_mov_b32 v86, 0
    v_mov_b32 v87, 0
    v_mov_b32 v88, 0
    v_mov_b32 v89, 0
    v_mov_b32 v90, 0
    v_mov_b32 v91, 0
    v_mov_b32 v92, 0
    v_mov_b32 v93, 0
    v_mov_b32 v94, 0
    v_mov_b32 v95, 0
    s_mov_b32 s31, 0
    s_mov_b32 s36, 16
    s_barrier
    ds_read_b128 v[96:99], v141
    ds_read_b128 v[100:103], v141 offset:4096
    ds_read_b64_tr_b16 v[104:105], v145 offset:0
    ds_read_b64_tr_b16 v[106:107], v145 offset:512
    ds_read_b64_tr_b16 v[108:109], v145 offset:8192
    ds_read_b64_tr_b16 v[110:111], v145 offset:8704
    ds_read_b64_tr_b16 v[112:113], v145 offset:16384
    ds_read_b64_tr_b16 v[114:115], v145 offset:16896
qkv1_kernel_cloop:
    s_waitcnt lgkmcnt(0)
    v_mfma_f32_32x32x16_bf16 v[0:15], v[104:107], v[96:99], v[0:15]
    ds_read_b128 v[116:119], v142
    ds_read_b64_tr_b16 v[124:125], v145 offset:2048
    ds_read_b64_tr_b16 v[126:127], v145 offset:2560
    v_mfma_f32_32x32x16_bf16 v[16:31], v[104:107], v[100:103], v[16:31]
    ds_read_b128 v[120:123], v142 offset:4096
    ds_read_b64_tr_b16 v[128:129], v145 offset:10240
    ds_read_b64_tr_b16 v[130:131], v145 offset:10752
    v_mfma_f32_32x32x16_bf16 v[32:47], v[108:111], v[96:99], v[32:47]
    ds_read_b64_tr_b16 v[132:133], v145 offset:18432
    ds_read_b64_tr_b16 v[134:135], v145 offset:18944
    v_mfma_f32_32x32x16_bf16 v[48:63], v[108:111], v[100:103], v[48:63]
    v_mfma_f32_32x32x16_bf16 v[64:79], v[96:99], v[112:115], v[64:79]
    v_mfma_f32_32x32x16_bf16 v[80:95], v[100:103], v[112:115], v[80:95]
    s_waitcnt lgkmcnt(0)
    v_mfma_f32_32x32x16_bf16 v[0:15], v[124:127], v[116:119], v[0:15]
    ds_read_b128 v[96:99], v143
    ds_read_b64_tr_b16 v[104:105], v145 offset:4096
    ds_read_b64_tr_b16 v[106:107], v145 offset:4608
    v_mfma_f32_32x32x16_bf16 v[16:31], v[124:127], v[120:123], v[16:31]
    ds_read_b128 v[100:103], v143 offset:4096
    ds_read_b64_tr_b16 v[108:109], v145 offset:12288
    ds_read_b64_tr_b16 v[110:111], v145 offset:12800
    v_mfma_f32_32x32x16_bf16 v[32:47], v[128:131], v[116:119], v[32:47]
    ds_read_b64_tr_b16 v[112:113], v145 offset:20480
    ds_read_b64_tr_b16 v[114:115], v145 offset:20992
    v_mfma_f32_32x32x16_bf16 v[48:63], v[128:131], v[120:123], v[48:63]
    v_mfma_f32_32x32x16_bf16 v[64:79], v[116:119], v[132:135], v[64:79]
    v_mfma_f32_32x32x16_bf16 v[80:95], v[120:123], v[132:135], v[80:95]
    s_waitcnt lgkmcnt(0)
    v_mfma_f32_32x32x16_bf16 v[0:15], v[104:107], v[96:99], v[0:15]
    ds_read_b128 v[116:119], v144
    ds_read_b64_tr_b16 v[124:125], v145 offset:6144
    ds_read_b64_tr_b16 v[126:127], v145 offset:6656
    v_mfma_f32_32x32x16_bf16 v[16:31], v[104:107], v[100:103], v[16:31]
    ds_read_b128 v[120:123], v144 offset:4096
    ds_read_b64_tr_b16 v[128:129], v145 offset:14336
    ds_read_b64_tr_b16 v[130:131], v145 offset:14848
    v_mfma_f32_32x32x16_bf16 v[32:47], v[108:111], v[96:99], v[32:47]
    ds_read_b64_tr_b16 v[132:133], v145 offset:22528
    ds_read_b64_tr_b16 v[134:135], v145 offset:23040
    v_mfma_f32_32x32x16_bf16 v[48:63], v[108:111], v[100:103], v[48:63]
    v_mfma_f32_32x32x16_bf16 v[64:79], v[96:99], v[112:115], v[64:79]
    v_mfma_f32_32x32x16_bf16 v[80:95], v[100:103], v[112:115], v[80:95]
    s_waitcnt lgkmcnt(0)
    v_mfma_f32_32x32x16_bf16 v[0:15], v[124:127], v[116:119], v[0:15]
    s_barrier
    s_add_u32 s31, s31, 40960
    s_cmp_ge_u32 s31, 163840
    s_cselect_b32 s31, 0, s31
    v_add_u32 v141, s31, v136
    v_add_u32 v145, s31, v140
    ds_read_b128 v[96:99], v141
    ds_read_b64_tr_b16 v[104:105], v145 offset:0
    ds_read_b64_tr_b16 v[106:107], v145 offset:512
    v_mfma_f32_32x32x16_bf16 v[16:31], v[124:127], v[120:123], v[16:31]
    ds_read_b128 v[100:103], v141 offset:4096
    ds_read_b64_tr_b16 v[108:109], v145 offset:8192
    ds_read_b64_tr_b16 v[110:111], v145 offset:8704
    v_mfma_f32_32x32x16_bf16 v[32:47], v[128:131], v[116:119], v[32:47]
    ds_read_b64_tr_b16 v[112:113], v145 offset:16384
    ds_read_b64_tr_b16 v[114:115], v145 offset:16896
    v_mfma_f32_32x32x16_bf16 v[48:63], v[128:131], v[120:123], v[48:63]
    v_add_u32 v142, s31, v137
    v_add_u32 v143, s31, v138
    v_add_u32 v144, s31, v139
    s_sub_u32 s36, s36, 1
    s_cmp_lg_u32 s36, 0
    v_mfma_f32_32x32x16_bf16 v[64:79], v[116:119], v[132:135], v[64:79]
    v_mfma_f32_32x32x16_bf16 v[80:95], v[120:123], v[132:135], v[80:95]
    s_cbranch_scc1 qkv1_kernel_cloop
    s_waitcnt lgkmcnt(0)
    v_and_b32 v96, 31, v146
    v_lshrrev_b32 v97, 5, v146
    s_lshl_b32 s30, s28, 8
    s_add_u32 s30, s30, 0
    v_lshl_add_u32 v98, v96, 2, s30
    v_lshl_add_u32 v99, v97, 4, s30
    s_lshl_b32 s30, s29, 7
    s_add_u32 s30, s30, 1024
    v_lshl_add_u32 v100, v97, 4, s30
    v_lshl_add_u32 v101, v96, 2, s30
    ds_read_b32 v104, v98
    ds_read_b32 v106, v98 offset:128
    ds_read_b32 v108, v98 offset:512
    ds_read_b32 v110, v98 offset:640
    ds_read_b32 v112, v101 offset:512
    ds_read_b128 v[116:119], v100 offset:0
    ds_read_b128 v[120:123], v100 offset:32
    ds_read_b128 v[124:127], v100 offset:64
    ds_read_b128 v[128:131], v100 offset:96
    ds_read_b128 v[132:135], v100 offset:256
    ds_read_b128 v[136:139], v100 offset:288
    ds_read_b128 v[140:143], v100 offset:320
    ds_read_b128 v[144:147], v100 offset:352
    ds_read_b128 v[148:151], v99 offset:0
    ds_read_b128 v[180:183], v99 offset:512
    ds_read_b128 v[152:155], v99 offset:32
    ds_read_b128 v[184:187], v99 offset:544
    ds_read_b128 v[156:159], v99 offset:64
    ds_read_b128 v[188:191], v99 offset:576
    ds_read_b128 v[160:163], v99 offset:96
    ds_read_b128 v[192:195], v99 offset:608
    ds_read_b128 v[164:167], v99 offset:128
    ds_read_b128 v[196:199], v99 offset:640
    ds_read_b128 v[168:171], v99 offset:160
    ds_read_b128 v[200:203], v99 offset:672
    ds_read_b128 v[172:175], v99 offset:192
    ds_read_b128 v[204:207], v99 offset:704
    ds_read_b128 v[176:179], v99 offset:224
    ds_read_b128 v[208:211], v99 offset:736
    s_lshl_b32 s30, s27, 1
    s_add_u32 s30, s30, s29
    s_lshl_b32 s30, s30, 6
    s_lshl_b32 s31, s26, 2
    s_add_u32 s30, s30, s31
    s_lshl_b32 s31, s28, 1
    s_add_u32 s30, s30, s31
    s_lshl_b32 s31, s30, 11
    s_add_u32 s31, s31, 0x2000000
    s_lshl_b32 s32, s30, 12
    s_add_u32 s32, s32, 0x2400000
    s_add_u32 s33, s32, 4096
    v_lshlrev_b32 v96, 4, v146
    s_waitcnt lgkmcnt(15)
    v_mul_f32 v114, 0x3e8293ee, v104
    v_mul_f32 v102, 0x3e8293ee, v106
    v_pk_fma_f32 v[0:1], v[116:117], v[108:109], v[0:1] op_sel_hi:[1,0,1] neg_lo:[0,1,0] neg_hi:[0,1,0]
    v_pk_fma_f32 v[2:3], v[118:119], v[108:109], v[2:3] op_sel_hi:[1,0,1] neg_lo:[0,1,0] neg_hi:[0,1,0]
    v_pk_fma_f32 v[4:5], v[120:121], v[108:109], v[4:5] op_sel_hi:[1,0,1] neg_lo:[0,1,0] neg_hi:[0,1,0]
    v_pk_fma_f32 v[6:7], v[122:123], v[108:109], v[6:7] op_sel_hi:[1,0,1] neg_lo:[0,1,0] neg_hi:[0,1,0]
    v_pk_fma_f32 v[8:9], v[124:125], v[108:109], v[8:9] op_sel_hi:[1,0,1] neg_lo:[0,1,0] neg_hi:[0,1,0]
    v_pk_fma_f32 v[10:11], v[126:127], v[108:109], v[10:11] op_sel_hi:[1,0,1] neg_lo:[0,1,0] neg_hi:[0,1,0]
    v_pk_fma_f32 v[12:13], v[128:129], v[108:109], v[12:13] op_sel_hi:[1,0,1] neg_lo:[0,1,0] neg_hi:[0,1,0]
    v_pk_fma_f32 v[14:15], v[130:131], v[108:109], v[14:15] op_sel_hi:[1,0,1] neg_lo:[0,1,0] neg_hi:[0,1,0]
    v_pk_mul_f32 v[0:1], v[0:1], v[114:115] op_sel_hi:[1,0]
    v_pk_mul_f32 v[2:3], v[2:3], v[114:115] op_sel_hi:[1,0]
    v_pk_mul_f32 v[4:5], v[4:5], v[114:115] op_sel_hi:[1,0]
    v_pk_mul_f32 v[6:7], v[6:7], v[114:115] op_sel_hi:[1,0]
    v_pk_mul_f32 v[8:9], v[8:9], v[114:115] op_sel_hi:[1,0]
    v_pk_mul_f32 v[10:11], v[10:11], v[114:115] op_sel_hi:[1,0]
    v_pk_mul_f32 v[12:13], v[12:13], v[114:115] op_sel_hi:[1,0]
    v_pk_mul_f32 v[14:15], v[14:15], v[114:115] op_sel_hi:[1,0]
    v_cvt_pk_bf16_f32 v0, v0, v1
    v_cvt_pk_bf16_f32 v1, v2, v3
    v_cvt_pk_bf16_f32 v2, v4, v5
    v_cvt_pk_bf16_f32 v3, v6, v7
    v_cvt_pk_bf16_f32 v4, v8, v9
    v_cvt_pk_bf16_f32 v5, v10, v11
    v_cvt_pk_bf16_f32 v6, v12, v13
    v_cvt_pk_bf16_f32 v7, v14, v15
    buffer_store_dwordx4 v[0:3], v96, s[20:23], s31 offen offset:0
    buffer_store_dwordx4 v[4:7], v96, s[20:23], s31 offen offset:1024
    v_pk_fma_f32 v[16:17], v[116:117], v[110:111], v[16:17] op_sel_hi:[1,0,1] neg_lo:[0,1,0] neg_hi:[0,1,0]
    v_pk_fma_f32 v[18:19], v[118:119], v[110:111], v[18:19] op_sel_hi:[1,0,1] neg_lo:[0,1,0] neg_hi:[0,1,0]
    v_pk_fma_f32 v[20:21], v[120:121], v[110:111], v[20:21] op_sel_hi:[1,0,1] neg_lo:[0,1,0] neg_hi:[0,1,0]
    v_pk_fma_f32 v[22:23], v[122:123], v[110:111], v[22:23] op_sel_hi:[1,0,1] neg_lo:[0,1,0] neg_hi:[0,1,0]
    v_pk_fma_f32 v[24:25], v[124:125], v[110:111], v[24:25] op_sel_hi:[1,0,1] neg_lo:[0,1,0] neg_hi:[0,1,0]
    v_pk_fma_f32 v[26:27], v[126:127], v[110:111], v[26:27] op_sel_hi:[1,0,1] neg_lo:[0,1,0] neg_hi:[0,1,0]
    v_pk_fma_f32 v[28:29], v[128:129], v[110:111], v[28:29] op_sel_hi:[1,0,1] neg_lo:[0,1,0] neg_hi:[0,1,0]
    v_pk_fma_f32 v[30:31], v[130:131], v[110:111], v[30:31] op_sel_hi:[1,0,1] neg_lo:[0,1,0] neg_hi:[0,1,0]
    v_pk_mul_f32 v[16:17], v[16:17], v[102:103] op_sel_hi:[1,0]
    v_pk_mul_f32 v[18:19], v[18:19], v[102:103] op_sel_hi:[1,0]
    v_pk_mul_f32 v[20:21], v[20:21], v[102:103] op_sel_hi:[1,0]
    v_pk_mul_f32 v[22:23], v[22:23], v[102:103] op_sel_hi:[1,0]
    v_pk_mul_f32 v[24:25], v[24:25], v[102:103] op_sel_hi:[1,0]
    v_pk_mul_f32 v[26:27], v[26:27], v[102:103] op_sel_hi:[1,0]
    v_pk_mul_f32 v[28:29], v[28:29], v[102:103] op_sel_hi:[1,0]
    v_pk_mul_f32 v[30:31], v[30:31], v[102:103] op_sel_hi:[1,0]
    v_cvt_pk_bf16_f32 v16, v16, v17
    v_cvt_pk_bf16_f32 v17, v18, v19
    v_cvt_pk_bf16_f32 v18, v20, v21
    v_cvt_pk_bf16_f32 v19, v22, v23
    v_cvt_pk_bf16_f32 v20, v24, v25
    v_cvt_pk_bf16_f32 v21, v26, v27
    v_cvt_pk_bf16_f32 v22, v28, v29
    v_cvt_pk_bf16_f32 v23, v30, v31
    buffer_store_dwordx4 v[16:19], v96, s[20:23], s31 offen offset:2048
    buffer_store_dwordx4 v[20:23], v96, s[20:23], s31 offen offset:3072
    v_pk_fma_f32 v[32:33], v[132:133], v[108:109], v[32:33] op_sel_hi:[1,0,1] neg_lo:[0,1,0] neg_hi:[0,1,0]
    v_pk_fma_f32 v[34:35], v[134:135], v[108:109], v[34:35] op_sel_hi:[1,0,1] neg_lo:[0,1,0] neg_hi:[0,1,0]
    v_pk_fma_f32 v[36:37], v[136:137], v[108:109], v[36:37] op_sel_hi:[1,0,1] neg_lo:[0,1,0] neg_hi:[0,1,0]
    v_pk_fma_f32 v[38:39], v[138:139], v[108:109], v[38:39] op_sel_hi:[1,0,1] neg_lo:[0,1,0] neg_hi:[0,1,0]
    v_pk_fma_f32 v[40:41], v[140:141], v[108:109], v[40:41] op_sel_hi:[1,0,1] neg_lo:[0,1,0] neg_hi:[0,1,0]
    v_pk_fma_f32 v[42:43], v[142:143], v[108:109], v[42:43] op_sel_hi:[1,0,1] neg_lo:[0,1,0] neg_hi:[0,1,0]
    v_pk_fma_f32 v[44:45], v[144:145], v[108:109], v[44:45] op_sel_hi:[1,0,1] neg_lo:[0,1,0] neg_hi:[0,1,0]
    v_pk_fma_f32 v[46:47], v[146:147], v[108:109], v[46:47] op_sel_hi:[1,0,1] neg_lo:[0,1,0] neg_hi:[0,1,0]
    v_pk_mul_f32 v[32:33], v[32:33], v[104:105] op_sel_hi:[1,0]
    v_pk_mul_f32 v[34:35], v[34:35], v[104:105] op_sel_hi:[1,0]
    v_pk_mul_f32 v[36:37], v[36:37], v[104:105] op_sel_hi:[1,0]
    v_pk_mul_f32 v[38:39], v[38:39], v[104:105] op_sel_hi:[1,0]
    v_pk_mul_f32 v[40:41], v[40:41], v[104:105] op_sel_hi:[1,0]
    v_pk_mul_f32 v[42:43], v[42:43], v[104:105] op_sel_hi:[1,0]
    v_pk_mul_f32 v[44:45], v[44:45], v[104:105] op_sel_hi:[1,0]
    v_pk_mul_f32 v[46:47], v[46:47], v[104:105] op_sel_hi:[1,0]
    v_cvt_pk_bf16_f32 v32, v32, v33
    v_cvt_pk_bf16_f32 v33, v34, v35
    v_cvt_pk_bf16_f32 v34, v36, v37
    v_cvt_pk_bf16_f32 v35, v38, v39
    v_cvt_pk_bf16_f32 v36, v40, v41
    v_cvt_pk_bf16_f32 v37, v42, v43
    v_cvt_pk_bf16_f32 v38, v44, v45
    v_cvt_pk_bf16_f32 v39, v46, v47
    buffer_store_dwordx4 v[32:35], v96, s[20:23], s32 offen offset:0
    buffer_store_dwordx4 v[36:39], v96, s[20:23], s32 offen offset:1024
    v_pk_fma_f32 v[48:49], v[132:133], v[110:111], v[48:49] op_sel_hi:[1,0,1] neg_lo:[0,1,0] neg_hi:[0,1,0]
    v_pk_fma_f32 v[50:51], v[134:135], v[110:111], v[50:51] op_sel_hi:[1,0,1] neg_lo:[0,1,0] neg_hi:[0,1,0]
    v_pk_fma_f32 v[52:53], v[136:137], v[110:111], v[52:53] op_sel_hi:[1,0,1] neg_lo:[0,1,0] neg_hi:[0,1,0]
    v_pk_fma_f32 v[54:55], v[138:139], v[110:111], v[54:55] op_sel_hi:[1,0,1] neg_lo:[0,1,0] neg_hi:[0,1,0]
    v_pk_fma_f32 v[56:57], v[140:141], v[110:111], v[56:57] op_sel_hi:[1,0,1] neg_lo:[0,1,0] neg_hi:[0,1,0]
    v_pk_fma_f32 v[58:59], v[142:143], v[110:111], v[58:59] op_sel_hi:[1,0,1] neg_lo:[0,1,0] neg_hi:[0,1,0]
    v_pk_fma_f32 v[60:61], v[144:145], v[110:111], v[60:61] op_sel_hi:[1,0,1] neg_lo:[0,1,0] neg_hi:[0,1,0]
    v_pk_fma_f32 v[62:63], v[146:147], v[110:111], v[62:63] op_sel_hi:[1,0,1] neg_lo:[0,1,0] neg_hi:[0,1,0]
    v_pk_mul_f32 v[48:49], v[48:49], v[106:107] op_sel_hi:[1,0]
    v_pk_mul_f32 v[50:51], v[50:51], v[106:107] op_sel_hi:[1,0]
    v_pk_mul_f32 v[52:53], v[52:53], v[106:107] op_sel_hi:[1,0]
    v_pk_mul_f32 v[54:55], v[54:55], v[106:107] op_sel_hi:[1,0]
    v_pk_mul_f32 v[56:57], v[56:57], v[106:107] op_sel_hi:[1,0]
    v_pk_mul_f32 v[58:59], v[58:59], v[106:107] op_sel_hi:[1,0]
    v_pk_mul_f32 v[60:61], v[60:61], v[106:107] op_sel_hi:[1,0]
    v_pk_mul_f32 v[62:63], v[62:63], v[106:107] op_sel_hi:[1,0]
    v_cvt_pk_bf16_f32 v48, v48, v49
    v_cvt_pk_bf16_f32 v49, v50, v51
    v_cvt_pk_bf16_f32 v50, v52, v53
    v_cvt_pk_bf16_f32 v51, v54, v55
    v_cvt_pk_bf16_f32 v52, v56, v57
    v_cvt_pk_bf16_f32 v53, v58, v59
    v_cvt_pk_bf16_f32 v54, v60, v61
    v_cvt_pk_bf16_f32 v55, v62, v63
    buffer_store_dwordx4 v[48:51], v96, s[20:23], s33 offen offset:0
    buffer_store_dwordx4 v[52:55], v96, s[20:23], s33 offen offset:1024
    s_waitcnt lgkmcnt(0)
    v_pk_fma_f32 v[64:65], v[180:181], v[112:113], v[64:65] op_sel_hi:[1,0,1] neg_lo:[0,1,0] neg_hi:[0,1,0]
    v_pk_fma_f32 v[66:67], v[182:183], v[112:113], v[66:67] op_sel_hi:[1,0,1] neg_lo:[0,1,0] neg_hi:[0,1,0]
    v_pk_fma_f32 v[68:69], v[184:185], v[112:113], v[68:69] op_sel_hi:[1,0,1] neg_lo:[0,1,0] neg_hi:[0,1,0]
    v_pk_fma_f32 v[70:71], v[186:187], v[112:113], v[70:71] op_sel_hi:[1,0,1] neg_lo:[0,1,0] neg_hi:[0,1,0]
    v_pk_fma_f32 v[72:73], v[188:189], v[112:113], v[72:73] op_sel_hi:[1,0,1] neg_lo:[0,1,0] neg_hi:[0,1,0]
    v_pk_fma_f32 v[74:75], v[190:191], v[112:113], v[74:75] op_sel_hi:[1,0,1] neg_lo:[0,1,0] neg_hi:[0,1,0]
    v_pk_fma_f32 v[76:77], v[192:193], v[112:113], v[76:77] op_sel_hi:[1,0,1] neg_lo:[0,1,0] neg_hi:[0,1,0]
    v_pk_fma_f32 v[78:79], v[194:195], v[112:113], v[78:79] op_sel_hi:[1,0,1] neg_lo:[0,1,0] neg_hi:[0,1,0]
    v_pk_mul_f32 v[64:65], v[64:65], v[148:149]
    v_pk_mul_f32 v[66:67], v[66:67], v[150:151]
    v_pk_mul_f32 v[68:69], v[68:69], v[152:153]
    v_pk_mul_f32 v[70:71], v[70:71], v[154:155]
    v_pk_mul_f32 v[72:73], v[72:73], v[156:157]
    v_pk_mul_f32 v[74:75], v[74:75], v[158:159]
    v_pk_mul_f32 v[76:77], v[76:77], v[160:161]
    v_pk_mul_f32 v[78:79], v[78:79], v[162:163]
    v_cvt_pk_bf16_f32 v64, v64, v65
    v_cvt_pk_bf16_f32 v65, v66, v67
    v_cvt_pk_bf16_f32 v66, v68, v69
    v_cvt_pk_bf16_f32 v67, v70, v71
    v_cvt_pk_bf16_f32 v68, v72, v73
    v_cvt_pk_bf16_f32 v69, v74, v75
    v_cvt_pk_bf16_f32 v70, v76, v77
    v_cvt_pk_bf16_f32 v71, v78, v79
    buffer_store_dwordx4 v[64:67], v96, s[20:23], s32 offen offset:2048
    buffer_store_dwordx4 v[68:71], v96, s[20:23], s32 offen offset:3072
    v_pk_fma_f32 v[80:81], v[196:197], v[112:113], v[80:81] op_sel_hi:[1,0,1] neg_lo:[0,1,0] neg_hi:[0,1,0]
    v_pk_fma_f32 v[82:83], v[198:199], v[112:113], v[82:83] op_sel_hi:[1,0,1] neg_lo:[0,1,0] neg_hi:[0,1,0]
    v_pk_fma_f32 v[84:85], v[200:201], v[112:113], v[84:85] op_sel_hi:[1,0,1] neg_lo:[0,1,0] neg_hi:[0,1,0]
    v_pk_fma_f32 v[86:87], v[202:203], v[112:113], v[86:87] op_sel_hi:[1,0,1] neg_lo:[0,1,0] neg_hi:[0,1,0]
    v_pk_fma_f32 v[88:89], v[204:205], v[112:113], v[88:89] op_sel_hi:[1,0,1] neg_lo:[0,1,0] neg_hi:[0,1,0]
    v_pk_fma_f32 v[90:91], v[206:207], v[112:113], v[90:91] op_sel_hi:[1,0,1] neg_lo:[0,1,0] neg_hi:[0,1,0]
    v_pk_fma_f32 v[92:93], v[208:209], v[112:113], v[92:93] op_sel_hi:[1,0,1] neg_lo:[0,1,0] neg_hi:[0,1,0]
    v_pk_fma_f32 v[94:95], v[210:211], v[112:113], v[94:95] op_sel_hi:[1,0,1] neg_lo:[0,1,0] neg_hi:[0,1,0]
    v_pk_mul_f32 v[80:81], v[80:81], v[164:165]
    v_pk_mul_f32 v[82:83], v[82:83], v[166:167]
    v_pk_mul_f32 v[84:85], v[84:85], v[168:169]
    v_pk_mul_f32 v[86:87], v[86:87], v[170:171]
    v_pk_mul_f32 v[88:89], v[88:89], v[172:173]
    v_pk_mul_f32 v[90:91], v[90:91], v[174:175]
    v_pk_mul_f32 v[92:93], v[92:93], v[176:177]
    v_pk_mul_f32 v[94:95], v[94:95], v[178:179]
    v_cvt_pk_bf16_f32 v80, v80, v81
    v_cvt_pk_bf16_f32 v81, v82, v83
    v_cvt_pk_bf16_f32 v82, v84, v85
    v_cvt_pk_bf16_f32 v83, v86, v87
    v_cvt_pk_bf16_f32 v84, v88, v89
    v_cvt_pk_bf16_f32 v85, v90, v91
    v_cvt_pk_bf16_f32 v86, v92, v93
    v_cvt_pk_bf16_f32 v87, v94, v95
    buffer_store_dwordx4 v[80:83], v96, s[20:23], s33 offen offset:2048
    buffer_store_dwordx4 v[84:87], v96, s[20:23], s33 offen offset:3072
qkv1_kernel_end:
    s_endpgm
.globl attn1_kernel
.p2align 8
.type attn1_kernel,@function
attn1_kernel:
    s_cmp_ge_u32 s2, 256
    s_cbranch_scc1 attn1_kernel_end
    s_load_dwordx2 s[8:9], s[0:1], 80
    v_lshrrev_b32 v1, 6, v0
    v_and_b32 v2, 63, v0
    v_readfirstlane_b32 s3, v1
    s_and_b32 s24, s2, 7
    s_lshr_b32 s25, s2, 3
    s_lshr_b32 s26, s24, 2
    s_lshl_b32 s26, s26, 3
    s_and_b32 s27, s25, 7
    s_add_u32 s26, s26, s27
    s_and_b32 s27, s24, 3
    s_lshl_b32 s27, s27, 2
    s_lshr_b32 s25, s25, 3
    s_add_u32 s27, s27, s25
    s_lshr_b32 s28, s3, 2
    s_and_b32 s29, s3, 3
    s_lshl_b32 s30, s27, 1
    s_add_u32 s30, s30, s28
    s_lshl_b32 s31, s26, 2
    s_add_u32 s37, s31, s29
    v_lshlrev_b32 v3, 4, v2
    s_waitcnt lgkmcnt(0)
    s_mov_b32 s20, s8
    s_mov_b32 s21, s9
    s_mov_b32 s22, 0x8000000
    s_mov_b32 s23, 0x20000
    s_lshl_b32 s32, s30, 6
    s_add_u32 s33, s32, s37
    s_lshl_b32 s33, s33, 11
    s_add_u32 s33, s33, 0x2000000
    buffer_load_dwordx4 v[4:7], v3, s[20:23], s33 offen
    buffer_load_dwordx4 v[8:11], v3, s[20:23], s33 offen offset:1024
    s_mul_i32 s34, s29, 3
    s_mul_i32 s35, s28, 12
    s_add_u32 s35, s35, s34
    s_lshl_b32 s35, s35, 12
    s_add_u32 s34, s34, s31
    s_sub_u32 s34, s34, 8
    s_max_i32 s36, s34, 0
    s_add_u32 s36, s36, s32
    s_lshl_b32 s36, s36, 12
    s_add_u32 s36, s36, 0x2400000
    s_mov_b32 m0, s35
    s_add_u32 s34, s34, 1
    buffer_load_dwordx4 v3, s[20:23], s36 offen offset:0 lds
    buffer_load_dwordx4 v3, s[20:23], s36 offen offset:1024 lds
    buffer_load_dwordx4 v3, s[20:23], s36 offen offset:2048 lds
    buffer_load_dwordx4 v3, s[20:23], s36 offen offset:3072 lds
    s_add_u32 s35, s35, 4096
    s_max_i32 s36, s34, 0
    s_add_u32 s36, s36, s32
    s_lshl_b32 s36, s36, 12
    s_add_u32 s36, s36, 0x2400000
    s_mov_b32 m0, s35
    s_add_u32 s34, s34, 1
    buffer_load_dwordx4 v3, s[20:23], s36 offen offset:0 lds
    buffer_load_dwordx4 v3, s[20:23], s36 offen offset:1024 lds
    buffer_load_dwordx4 v3, s[20:23], s36 offen offset:2048 lds
    buffer_load_dwordx4 v3, s[20:23], s36 offen offset:3072 lds
    s_add_u32 s35, s35, 4096
    s_max_i32 s36, s34, 0
    s_add_u32 s36, s36, s32
    s_lshl_b32 s36, s36, 12
    s_add_u32 s36, s36, 0x2400000
    s_mov_b32 m0, s35
    s_add_u32 s34, s34, 1
    buffer_load_dwordx4 v3, s[20:23], s36 offen offset:0 lds
    buffer_load_dwordx4 v3, s[20:23], s36 offen offset:1024 lds
    buffer_load_dwordx4 v3, s[20:23], s36 offen offset:2048 lds
    buffer_load_dwordx4 v3, s[20:23], s36 offen offset:3072 lds
    s_add_u32 s35, s35, 4096
    s_mov_b32 s40, 0xffffffff
    s_mov_b32 s41, 0xfffffff0
    s_mov_b32 s42, 0xfffffffe
    s_mov_b32 s43, 0xffffffe0
    s_mov_b32 s44, 0xfffffffc
    s_mov_b32 s45, 0xffffffc0
    s_mov_b32 s46, 0xfffffff8
    s_mov_b32 s47, 0xffffff80
    s_mov_b32 s48, 0xffffff00
    s_mov_b32 s49, 0xfffff000
    s_mov_b32 s50, 0xfffffe00
    s_mov_b32 s51, 0xffffe000
    s_mov_b32 s52, 0xfffffc00
    s_mov_b32 s53, 0xffffc000
    s_mov_b32 s54, 0xfffff800
    s_mov_b32 s55, 0xffff8000
    s_mov_b32 s56, 0xffff0000
    s_mov_b32 s57, 0xfff00000
    s_mov_b32 s58, 0xfffe0000
    s_mov_b32 s59, 0xffe00000
    s_mov_b32 s60, 0xfffc0000
    s_mov_b32 s61, 0xffc00000
    s_mov_b32 s62, 0xfff80000
    s_mov_b32 s63, 0xff800000
    s_mov_b32 s64, 0xff000000
    s_mov_b32 s65, 0xf0000000
    s_mov_b32 s66, 0xfe000000
    s_mov_b32 s67, 0xe0000000
    s_mov_b32 s68, 0xfc000000
    s_mov_b32 s69, 0xc0000000
    s_mov_b32 s70, 0xf8000000
    s_mov_b32 s71, 0x80000000
    v_mov_b32 v20, 0xffff
    v_mov_b32 v21, 0xffff0000
    v_cndmask_b32 v22, 0, v20, s[40:41]
    v_cndmask_b32 v23, 0, v21, s[42:43]
    v_or_b32 v12, v22, v23
    v_cndmask_b32 v22, 0, v20, s[44:45]
    v_cndmask_b32 v23, 0, v21, s[46:47]
    v_or_b32 v13, v22, v23
    v_cndmask_b32 v22, 0, v20, s[48:49]
    v_cndmask_b32 v23, 0, v21, s[50:51]
    v_or_b32 v14, v22, v23
    v_cndmask_b32 v22, 0, v20, s[52:53]
    v_cndmask_b32 v23, 0, v21, s[54:55]
    v_or_b32 v15, v22, v23
    v_cndmask_b32 v22, 0, v20, s[56:57]
    v_cndmask_b32 v23, 0, v21, s[58:59]
    v_or_b32 v16, v22, v23
    v_cndmask_b32 v22, 0, v20, s[60:61]
    v_cndmask_b32 v23, 0, v21, s[62:63]
    v_or_b32 v17, v22, v23
    v_cndmask_b32 v22, 0, v20, s[64:65]
    v_cndmask_b32 v23, 0, v21, s[66:67]
    v_or_b32 v18, v22, v23
    v_cndmask_b32 v22, 0, v20, s[68:69]
    v_cndmask_b32 v23, 0, v21, s[70:71]
    v_or_b32 v19, v22, v23
    s_mul_i32 s34, s28, 12
    s_add_u32 s34, s34, s29
    s_lshl_b32 s34, s34, 12
    v_add_u32 v20, s34, v3
    v_mov_b32 v24, 0
    v_mov_b32 v25, 0
    v_mov_b32 v26, 0
    v_mov_b32 v27, 0
    v_mov_b32 v28, 0
    v_mov_b32 v29, 0
    v_mov_b32 v30, 0
    v_mov_b32 v31, 0
    v_mov_b32 v32, 0
    v_mov_b32 v33, 0
    v_mov_b32 v34, 0
    v_mov_b32 v35, 0
    v_mov_b32 v36, 0
    v_mov_b32 v37, 0
    v_mov_b32 v38, 0
    v_mov_b32 v39, 0
    s_waitcnt vmcnt(0)
    s_barrier
    ds_read_b128 v[104:107], v20 offset:32768
    ds_read_b128 v[108:111], v20 offset:33792
    ds_read_b128 v[112:115], v20 offset:28672
    ds_read_b128 v[116:119], v20 offset:29696
    s_waitcnt lgkmcnt(2)
    v_mfma_f32_32x32x16_bf16 v[40:55], v[104:107], v[4:7], 0
    v_mfma_f32_32x32x16_bf16 v[40:55], v[108:111], v[8:11], v[40:55]
    ds_read_b128 v[104:107], v20 offset:24576
    ds_read_b128 v[108:111], v20 offset:25600
    s_cmp_eq_u32 s37, 0
    s_cbranch_scc0 attn1_kernel_a1
    v_mov_b32 v24, 0xf149f2ca
    v_mov_b32 v25, 0xf149f2ca
    v_mov_b32 v26, 0xf149f2ca
    v_mov_b32 v27, 0xf149f2ca
    v_mov_b32 v28, 0xf149f2ca
    v_mov_b32 v29, 0xf149f2ca
    v_mov_b32 v30, 0xf149f2ca
    v_mov_b32 v31, 0xf149f2ca
    v_mov_b32 v32, 0xf149f2ca
    v_mov_b32 v33, 0xf149f2ca
    v_mov_b32 v34, 0xf149f2ca
    v_mov_b32 v35, 0xf149f2ca
    v_mov_b32 v36, 0xf149f2ca
    v_mov_b32 v37, 0xf149f2ca
    v_mov_b32 v38, 0xf149f2ca
    v_mov_b32 v39, 0xf149f2ca
attn1_kernel_a1:
    s_waitcnt lgkmcnt(2)
    s_nop 0
    v_mfma_f32_32x32x16_bf16 v[72:87], v[112:115], v[4:7], v[24:39]
    v_mfma_f32_32x32x16_bf16 v[72:87], v[116:119], v[8:11], v[72:87]
    ds_read_b128 v[112:115], v20 offset:20480
    ds_read_b128 v[116:119], v20 offset:21504
    s_cmp_eq_u32 s37, 1
    s_cbranch_scc0 attn1_kernel_a2
    s_nop 1
    v_mov_b32 v24, 0xf149f2ca
    v_mov_b32 v25, 0xf149f2ca
    v_mov_b32 v26, 0xf149f2ca
    v_mov_b32 v27, 0xf149f2ca
    v_mov_b32 v28, 0xf149f2ca
    v_mov_b32 v29, 0xf149f2ca
    v_mov_b32 v30, 0xf149f2ca
    v_mov_b32 v31, 0xf149f2ca
    v_mov_b32 v32, 0xf149f2ca
    v_mov_b32 v33, 0xf149f2ca
    v_mov_b32 v34, 0xf149f2ca
    v_mov_b32 v35, 0xf149f2ca
    v_mov_b32 v36, 0xf149f2ca
    v_mov_b32 v37, 0xf149f2ca
    v_mov_b32 v38, 0xf149f2ca
    v_mov_b32 v39, 0xf149f2ca
attn1_kernel_a2:
    s_waitcnt lgkmcnt(2)
    s_nop 0
    v_mfma_f32_32x32x16_bf16 v[56:71], v[104:107], v[4:7], v[24:39]
    v_mfma_f32_32x32x16_bf16 v[56:71], v[108:111], v[8:11], v[56:71]
    s_nop 3
    v_max_f32 v21, v72, v73
    v_max3_f32 v21, v21, v74, v75
    v_max3_f32 v21, v21, v76, v77
    v_max3_f32 v21, v21, v78, v79
    v_max3_f32 v21, v21, v80, v81
    v_max3_f32 v21, v21, v82, v83
    v_max3_f32 v21, v21, v84, v85
    v_max3_f32 v21, v21, v86, v87
    ds_read_b128 v[104:107], v20 offset:16384
    ds_read_b128 v[108:111], v20 offset:17408
    s_cmp_eq_u32 s37, 2
    s_cbranch_scc0 attn1_kernel_a3
    v_mov_b32 v24, 0xf149f2ca
    v_mov_b32 v25, 0xf149f2ca
    v_mov_b32 v26, 0xf149f2ca
    v_mov_b32 v27, 0xf149f2ca
    v_mov_b32 v28, 0xf149f2ca
    v_mov_b32 v29, 0xf149f2ca
    v_mov_b32 v30, 0xf149f2ca
    v_mov_b32 v31, 0xf149f2ca
    v_mov_b32 v32, 0xf149f2ca
    v_mov_b32 v33, 0xf149f2ca
    v_mov_b32 v34, 0xf149f2ca
    v_mov_b32 v35, 0xf149f2ca
    v_mov_b32 v36, 0xf149f2ca
    v_mov_b32 v37, 0xf149f2ca
    v_mov_b32 v38, 0xf149f2ca
    v_mov_b32 v39, 0xf149f2ca
attn1_kernel_a3:
    s_waitcnt lgkmcnt(2)
    s_nop 0
    v_mfma_f32_32x32x16_bf16 v[72:87], v[112:115], v[4:7], v[24:39]
    v_mfma_f32_32x32x16_bf16 v[72:87], v[116:119], v[8:11], v[72:87]
    v_max3_f32 v21, v21, v56, v57
    v_max3_f32 v21, v21, v58, v59
    v_max3_f32 v21, v21, v60, v61
    v_max3_f32 v21, v21, v62, v63
    v_max3_f32 v21, v21, v64, v65
    v_max3_f32 v21, v21, v66, v67
    v_max3_f32 v21, v21, v68, v69
    v_max3_f32 v21, v21, v70, v71
    ds_read_b128 v[112:115], v20 offset:12288
    ds_read_b128 v[116:119], v20 offset:13312
    s_cmp_eq_u32 s37, 3
    s_cbranch_scc0 attn1_kernel_a4
    v_mov_b32 v24, 0xf149f2ca
    v_mov_b32 v25, 0xf149f2ca
    v_mov_b32 v26, 0xf149f2ca
    v_mov_b32 v27, 0xf149f2ca
    v_mov_b32 v28, 0xf149f2ca
    v_mov_b32 v29, 0xf149f2ca
    v_mov_b32 v30, 0xf149f2ca
    v_mov_b32 v31, 0xf149f2ca
    v_mov_b32 v32, 0xf149f2ca
    v_mov_b32 v33, 0xf149f2ca
    v_mov_b32 v34, 0xf149f2ca
    v_mov_b32 v35, 0xf149f2ca
    v_mov_b32 v36, 0xf149f2ca
    v_mov_b32 v37, 0xf149f2ca
    v_mov_b32 v38, 0xf149f2ca
    v_mov_b32 v39, 0xf149f2ca
attn1_kernel_a4:
    s_waitcnt lgkmcnt(2)
    s_nop 0
    v_mfma_f32_32x32x16_bf16 v[56:71], v[104:107], v[4:7], v[24:39]
    v_mfma_f32_32x32x16_bf16 v[56:71], v[108:111], v[8:11], v[56:71]
    v_max3_f32 v21, v21, v72, v73
    v_max3_f32 v21, v21, v74, v75
    v_max3_f32 v21, v21, v76, v77
    v_max3_f32 v21, v21, v78, v79
    v_max3_f32 v21, v21, v80, v81
    v_max3_f32 v21, v21, v82, v83
    v_max3_f32 v21, v21, v84, v85
    v_max3_f32 v21, v21, v86, v87
    ds_read_b128 v[104:107], v20 offset:8192
    ds_read_b128 v[108:111], v20 offset:9216
    s_cmp_eq_u32 s37, 4
    s_cbranch_scc0 attn1_kernel_a5
    v_mov_b32 v24, 0xf149f2ca
    v_mov_b32 v25, 0xf149f2ca
    v_mov_b32 v26, 0xf149f2ca
    v_mov_b32 v27, 0xf149f2ca
    v_mov_b32 v28, 0xf149f2ca
    v_mov_b32 v29, 0xf149f2ca
    v_mov_b32 v30, 0xf149f2ca
    v_mov_b32 v31, 0xf149f2ca
    v_mov_b32 v32, 0xf149f2ca
    v_mov_b32 v33, 0xf149f2ca
    v_mov_b32 v34, 0xf149f2ca
    v_mov_b32 v35, 0xf149f2ca
    v_mov_b32 v36, 0xf149f2ca
    v_mov_b32 v37, 0xf149f2ca
    v_mov_b32 v38, 0xf149f2ca
    v_mov_b32 v39, 0xf149f2ca
attn1_kernel_a5:
    s_waitcnt lgkmcnt(2)
    s_nop 0
    v_mfma_f32_32x32x16_bf16 v[72:87], v[112:115], v[4:7], v[24:39]
    v_mfma_f32_32x32x16_bf16 v[72:87], v[116:119], v[8:11], v[72:87]
    v_max3_f32 v21, v21, v56, v57
    v_max3_f32 v21, v21, v58, v59
    v_max3_f32 v21, v21, v60, v61
    v_max3_f32 v21, v21, v62, v63
    v_max3_f32 v21, v21, v64, v65
    v_max3_f32 v21, v21, v66, v67
    v_max3_f32 v21, v21, v68, v69
    v_max3_f32 v21, v21, v70, v71
    ds_read_b128 v[112:115], v20 offset:4096
    ds_read_b128 v[116:119], v20 offset:5120
    s_cmp_eq_u32 s37, 5
    s_cbranch_scc0 attn1_kernel_a6
    v_mov_b32 v24, 0xf149f2ca
    v_mov_b32 v25, 0xf149f2ca
    v_mov_b32 v26, 0xf149f2ca
    v_mov_b32 v27, 0xf149f2ca
    v_mov_b32 v28, 0xf149f2ca
    v_mov_b32 v29, 0xf149f2ca
    v_mov_b32 v30, 0xf149f2ca
    v_mov_b32 v31, 0xf149f2ca
    v_mov_b32 v32, 0xf149f2ca
    v_mov_b32 v33, 0xf149f2ca
    v_mov_b32 v34, 0xf149f2ca
    v_mov_b32 v35, 0xf149f2ca
    v_mov_b32 v36, 0xf149f2ca
    v_mov_b32 v37, 0xf149f2ca
    v_mov_b32 v38, 0xf149f2ca
    v_mov_b32 v39, 0xf149f2ca
attn1_kernel_a6:
    s_waitcnt lgkmcnt(2)
    s_nop 0
    v_mfma_f32_32x32x16_bf16 v[56:71], v[104:107], v[4:7], v[24:39]
    v_mfma_f32_32x32x16_bf16 v[56:71], v[108:111], v[8:11], v[56:71]
    v_max3_f32 v21, v21, v72, v73
    v_max3_f32 v21, v21, v74, v75
    v_max3_f32 v21, v21, v76, v77
    v_max3_f32 v21, v21, v78, v79
    v_max3_f32 v21, v21, v80, v81
    v_max3_f32 v21, v21, v82, v83
    v_max3_f32 v21, v21, v84, v85
    v_max3_f32 v21, v21, v86, v87
    ds_read_b128 v[104:107], v20 offset:0
    ds_read_b128 v[108:111], v20 offset:1024
    s_cmp_eq_u32 s37, 6
    s_cbranch_scc0 attn1_kernel_a7
    v_mov_b32 v24, 0xf149f2ca
    v_mov_b32 v25, 0xf149f2ca
    v_mov_b32 v26, 0xf149f2ca
    v_mov_b32 v27, 0xf149f2ca
    v_mov_b32 v28, 0xf149f2ca
    v_mov_b32 v29, 0xf149f2ca
    v_mov_b32 v30, 0xf149f2ca
    v_mov_b32 v31, 0xf149f2ca
    v_mov_b32 v32, 0xf149f2ca
    v_mov_b32 v33, 0xf149f2ca
    v_mov_b32 v34, 0xf149f2ca
    v_mov_b32 v35, 0xf149f2ca
    v_mov_b32 v36, 0xf149f2ca
    v_mov_b32 v37, 0xf149f2ca
    v_mov_b32 v38, 0xf149f2ca
    v_mov_b32 v39, 0xf149f2ca
attn1_kernel_a7:
    s_waitcnt lgkmcnt(2)
    s_nop 0
    v_mfma_f32_32x32x16_bf16 v[72:87], v[112:115], v[4:7], v[24:39]
    v_mfma_f32_32x32x16_bf16 v[72:87], v[116:119], v[8:11], v[72:87]
    v_max3_f32 v21, v21, v56, v57
    v_max3_f32 v21, v21, v58, v59
    v_max3_f32 v21, v21, v60, v61
    v_max3_f32 v21, v21, v62, v63
    v_max3_f32 v21, v21, v64, v65
    v_max3_f32 v21, v21, v66, v67
    v_max3_f32 v21, v21, v68, v69
    v_max3_f32 v21, v21, v70, v71
    s_cmp_eq_u32 s37, 7
    s_cbranch_scc0 attn1_kernel_a8
    v_mov_b32 v24, 0xf149f2ca
    v_mov_b32 v25, 0xf149f2ca
    v_mov_b32 v26, 0xf149f2ca
    v_mov_b32 v27, 0xf149f2ca
    v_mov_b32 v28, 0xf149f2ca
    v_mov_b32 v29, 0xf149f2ca
    v_mov_b32 v30, 0xf149f2ca
    v_mov_b32 v31, 0xf149f2ca
    v_mov_b32 v32, 0xf149f2ca
    v_mov_b32 v33, 0xf149f2ca
    v_mov_b32 v34, 0xf149f2ca
    v_mov_b32 v35, 0xf149f2ca
    v_mov_b32 v36, 0xf149f2ca
    v_mov_b32 v37, 0xf149f2ca
    v_mov_b32 v38, 0xf149f2ca
    v_mov_b32 v39, 0xf149f2ca
attn1_kernel_a8:
    s_waitcnt lgkmcnt(0)
    s_nop 0
    v_mfma_f32_32x32x16_bf16 v[56:71], v[104:107], v[4:7], v[24:39]
    v_mfma_f32_32x32x16_bf16 v[56:71], v[108:111], v[8:11], v[56:71]
    v_max3_f32 v21, v21, v72, v73
    v_max3_f32 v21, v21, v74, v75
    v_max3_f32 v21, v21, v76, v77
    v_max3_f32 v21, v21, v78, v79
    v_max3_f32 v21, v21, v80, v81
    v_max3_f32 v21, v21, v82, v83
    v_max3_f32 v21, v21, v84, v85
    v_max3_f32 v21, v21, v86, v87
    ds_read_b128 v[112:115], v20 offset:28672
    ds_read_b128 v[116:119], v20 offset:29696
    ds_read_b128 v[120:123], v20 offset:34816
    ds_read_b128 v[124:127], v20 offset:35840
    ds_read_b128 v[128:131], v20 offset:2048
    ds_read_b128 v[132:135], v20 offset:3072
    v_cndmask_b32 v40, v56, v40, s[40:41]
    v_cndmask_b32 v41, v57, v41, s[42:43]
    v_cndmask_b32 v42, v58, v42, s[44:45]
    v_cndmask_b32 v43, v59, v43, s[46:47]
    v_cndmask_b32 v44, v60, v44, s[48:49]
    v_cndmask_b32 v45, v61, v45, s[50:51]
    v_cndmask_b32 v46, v62, v46, s[52:53]
    v_cndmask_b32 v47, v63, v47, s[54:55]
    v_cndmask_b32 v48, v64, v48, s[56:57]
    v_cndmask_b32 v49, v65, v49, s[58:59]
    v_cndmask_b32 v50, v66, v50, s[60:61]
    v_cndmask_b32 v51, v67, v51, s[62:63]
    v_cndmask_b32 v52, v68, v52, s[64:65]
    v_cndmask_b32 v53, v69, v53, s[66:67]
    v_cndmask_b32 v54, v70, v54, s[68:69]
    v_cndmask_b32 v55, v71, v55, s[70:71]
    v_max3_f32 v21, v21, v40, v41
    v_max3_f32 v21, v21, v42, v43
    v_max3_f32 v21, v21, v44, v45
    v_max3_f32 v21, v21, v46, v47
    v_max3_f32 v21, v21, v48, v49
    v_max3_f32 v21, v21, v50, v51
    v_max3_f32 v21, v21, v52, v53
    v_max3_f32 v21, v21, v54, v55
    v_mov_b32 v152, v21
    s_nop 1
    v_permlane32_swap_b32 v21, v152
    v_max_f32 v21, v21, v152
    v_sub_f32 v24, 0, v21
    v_sub_f32 v25, 0, v21
    v_sub_f32 v26, 0, v21
    v_sub_f32 v27, 0, v21
    v_sub_f32 v28, 0, v21
    v_sub_f32 v29, 0, v21
    v_sub_f32 v30, 0, v21
    v_sub_f32 v31, 0, v21
    v_sub_f32 v32, 0, v21
    v_sub_f32 v33, 0, v21
    v_sub_f32 v34, 0, v21
    v_sub_f32 v35, 0, v21
    v_sub_f32 v36, 0, v21
    v_sub_f32 v37, 0, v21
    v_sub_f32 v38, 0, v21
    v_sub_f32 v39, 0, v21
    s_cmp_eq_u32 s37, 0
    s_cbranch_scc0 attn1_kernel_b1
    v_mov_b32 v24, 0xf149f2ca
    v_mov_b32 v25, 0xf149f2ca
    v_mov_b32 v26, 0xf149f2ca
    v_mov_b32 v27, 0xf149f2ca
    v_mov_b32 v28, 0xf149f2ca
    v_mov_b32 v29, 0xf149f2ca
    v_mov_b32 v30, 0xf149f2ca
    v_mov_b32 v31, 0xf149f2ca
    v_mov_b32 v32, 0xf149f2ca
    v_mov_b32 v33, 0xf149f2ca
    v_mov_b32 v34, 0xf149f2ca
    v_mov_b32 v35, 0xf149f2ca
    v_mov_b32 v36, 0xf149f2ca
    v_mov_b32 v37, 0xf149f2ca
    v_mov_b32 v38, 0xf149f2ca
    v_mov_b32 v39, 0xf149f2ca
attn1_kernel_b1:
    s_waitcnt lgkmcnt(4)
    s_nop 0
    v_mfma_f32_32x32x16_bf16 v[72:87], v[112:115], v[4:7], v[24:39]
    v_mfma_f32_32x32x16_bf16 v[72:87], v[116:119], v[8:11], v[72:87]
    ds_read_b128 v[104:107], v20 offset:24576
    ds_read_b128 v[108:111], v20 offset:25600
    v_sub_f32 v40, v40, v21
    v_sub_f32 v41, v41, v21
    v_sub_f32 v42, v42, v21
    v_sub_f32 v43, v43, v21
    v_sub_f32 v44, v44, v21
    v_sub_f32 v45, v45, v21
    v_sub_f32 v46, v46, v21
    v_sub_f32 v47, v47, v21
    v_sub_f32 v48, v48, v21
    v_sub_f32 v49, v49, v21
    v_sub_f32 v50, v50, v21
    v_sub_f32 v51, v51, v21
    v_sub_f32 v52, v52, v21
    v_sub_f32 v53, v53, v21
    v_sub_f32 v54, v54, v21
    v_sub_f32 v55, v55, v21
    v_exp_f32 v40, v40
    v_exp_f32 v41, v41
    v_exp_f32 v42, v42
    v_exp_f32 v43, v43
    v_exp_f32 v44, v44
    v_exp_f32 v45, v45
    v_exp_f32 v46, v46
    v_exp_f32 v47, v47
    v_exp_f32 v48, v48
    v_exp_f32 v49, v49
    v_exp_f32 v50, v50
    v_exp_f32 v51, v51
    v_exp_f32 v52, v52
    v_exp_f32 v53, v53
    v_exp_f32 v54, v54
    v_exp_f32 v55, v55
    v_add_f32 v22, v40, v41
    v_add_f32 v23, v42, v43
    v_add_f32 v22, v22, v44
    v_add_f32 v23, v23, v45
    v_add_f32 v22, v22, v46
    v_add_f32 v23, v23, v47
    v_add_f32 v22, v22, v48
    v_add_f32 v23, v23, v49
    v_add_f32 v22, v22, v50
    v_add_f32 v23, v23, v51
    v_add_f32 v22, v22, v52
    v_add_f32 v23, v23, v53
    v_add_f32 v22, v22, v54
    v_add_f32 v23, v23, v55
    v_cvt_pk_bf16_f32 v144, v40, v41
    v_cvt_pk_bf16_f32 v145, v42, v43
    v_cvt_pk_bf16_f32 v146, v44, v45
    v_cvt_pk_bf16_f32 v147, v46, v47
    v_cvt_pk_bf16_f32 v148, v48, v49
    v_cvt_pk_bf16_f32 v149, v50, v51
    v_cvt_pk_bf16_f32 v150, v52, v53
    v_cvt_pk_bf16_f32 v151, v54, v55
    v_and_b32 v136, v144, v12
    v_and_b32 v137, v145, v13
    v_and_b32 v138, v146, v14
    v_and_b32 v139, v147, v15
    v_and_b32 v140, v148, v16
    v_and_b32 v141, v149, v17
    v_and_b32 v142, v150, v18
    v_and_b32 v143, v151, v19
    v_xor_b32 v144, v144, v136
    v_xor_b32 v145, v145, v137
    v_xor_b32 v146, v146, v138
    v_xor_b32 v147, v147, v139
    v_xor_b32 v148, v148, v140
    v_xor_b32 v149, v149, v141
    v_xor_b32 v150, v150, v142
    v_xor_b32 v151, v151, v143
    s_waitcnt lgkmcnt(2)
    v_mfma_f32_32x32x16_bf16 v[88:103], v[120:123], v[136:139], 0
    v_mfma_f32_32x32x16_bf16 v[88:103], v[124:127], v[140:143], v[88:103]
    v_mfma_f32_32x32x16_bf16 v[88:103], v[128:131], v[144:147], v[88:103]
    v_mfma_f32_32x32x16_bf16 v[88:103], v[132:135], v[148:151], v[88:103]
    ds_read_b128 v[128:131], v20 offset:30720
    ds_read_b128 v[132:135], v20 offset:31744
    s_cmp_eq_u32 s37, 1
    s_cbranch_scc0 attn1_kernel_b2
    v_mov_b32 v24, 0xf149f2ca
    v_mov_b32 v25, 0xf149f2ca
    v_mov_b32 v26, 0xf149f2ca
    v_mov_b32 v27, 0xf149f2ca
    v_mov_b32 v28, 0xf149f2ca
    v_mov_b32 v29, 0xf149f2ca
    v_mov_b32 v30, 0xf149f2ca
    v_mov_b32 v31, 0xf149f2ca
    v_mov_b32 v32, 0xf149f2ca
    v_mov_b32 v33, 0xf149f2ca
    v_mov_b32 v34, 0xf149f2ca
    v_mov_b32 v35, 0xf149f2ca
    v_mov_b32 v36, 0xf149f2ca
    v_mov_b32 v37, 0xf149f2ca
    v_mov_b32 v38, 0xf149f2ca
    v_mov_b32 v39, 0xf149f2ca
attn1_kernel_b2:
    s_waitcnt lgkmcnt(2)
    s_nop 0
    v_mfma_f32_32x32x16_bf16 v[56:71], v[104:107], v[4:7], v[24:39]
    v_mfma_f32_32x32x16_bf16 v[56:71], v[108:111], v[8:11], v[56:71]
    ds_read_b128 v[112:115], v20 offset:20480
    ds_read_b128 v[116:119], v20 offset:21504
    v_exp_f32 v72, v72
    v_exp_f32 v73, v73
    v_exp_f32 v74, v74
    v_exp_f32 v75, v75
    v_exp_f32 v76, v76
    v_exp_f32 v77, v77
    v_exp_f32 v78, v78
    v_exp_f32 v79, v79
    v_exp_f32 v80, v80
    v_exp_f32 v81, v81
    v_exp_f32 v82, v82
    v_exp_f32 v83, v83
    v_exp_f32 v84, v84
    v_exp_f32 v85, v85
    v_exp_f32 v86, v86
    v_exp_f32 v87, v87
    v_add_f32 v22, v22, v72
    v_add_f32 v23, v23, v73
    v_add_f32 v22, v22, v74
    v_add_f32 v23, v23, v75
    v_add_f32 v22, v22, v76
    v_add_f32 v23, v23, v77
    v_add_f32 v22, v22, v78
    v_add_f32 v23, v23, v79
    v_add_f32 v22, v22, v80
    v_add_f32 v23, v23, v81
    v_add_f32 v22, v22, v82
    v_add_f32 v23, v23, v83
    v_add_f32 v22, v22, v84
    v_add_f32 v23, v23, v85
    v_add_f32 v22, v22, v86
    v_add_f32 v23, v23, v87
    v_cvt_pk_bf16_f32 v144, v72, v73
    v_cvt_pk_bf16_f32 v145, v74, v75
    v_cvt_pk_bf16_f32 v146, v76, v77
    v_cvt_pk_bf16_f32 v147, v78, v79
    v_cvt_pk_bf16_f32 v148, v80, v81
    v_cvt_pk_bf16_f32 v149, v82, v83
    v_cvt_pk_bf16_f32 v150, v84, v85
    v_cvt_pk_bf16_f32 v151, v86, v87
    s_waitcnt lgkmcnt(2)
    v_mfma_f32_32x32x16_bf16 v[88:103], v[128:131], v[144:147], v[88:103]
    v_mfma_f32_32x32x16_bf16 v[88:103], v[132:135], v[148:151], v[88:103]
    ds_read_b128 v[120:123], v20 offset:26624
    ds_read_b128 v[124:127], v20 offset:27648
    s_cmp_eq_u32 s37, 2
    s_cbranch_scc0 attn1_kernel_b3
    v_mov_b32 v24, 0xf149f2ca
    v_mov_b32 v25, 0xf149f2ca
    v_mov_b32 v26, 0xf149f2ca
    v_mov_b32 v27, 0xf149f2ca
    v_mov_b32 v28, 0xf149f2ca
    v_mov_b32 v29, 0xf149f2ca
    v_mov_b32 v30, 0xf149f2ca
    v_mov_b32 v31, 0xf149f2ca
    v_mov_b32 v32, 0xf149f2ca
    v_mov_b32 v33, 0xf149f2ca
    v_mov_b32 v34, 0xf149f2ca
    v_mov_b32 v35, 0xf149f2ca
    v_mov_b32 v36, 0xf149f2ca
    v_mov_b32 v37, 0xf149f2ca
    v_mov_b32 v38, 0xf149f2ca
    v_mov_b32 v39, 0xf149f2ca
attn1_kernel_b3:
    s_waitcnt lgkmcnt(2)
    s_nop 0
    v_mfma_f32_32x32x16_bf16 v[72:87], v[112:115], v[4:7], v[24:39]
    v_mfma_f32_32x32x16_bf16 v[72:87], v[116:119], v[8:11], v[72:87]
    ds_read_b128 v[104:107], v20 offset:16384
    ds_read_b128 v[108:111], v20 offset:17408
    v_exp_f32 v56, v56
    v_exp_f32 v57, v57
    v_exp_f32 v58, v58
    v_exp_f32 v59, v59
    v_exp_f32 v60, v60
    v_exp_f32 v61, v61
    v_exp_f32 v62, v62
    v_exp_f32 v63, v63
    v_exp_f32 v64, v64
    v_exp_f32 v65, v65
    v_exp_f32 v66, v66
    v_exp_f32 v67, v67
    v_exp_f32 v68, v68
    v_exp_f32 v69, v69
    v_exp_f32 v70, v70
    v_exp_f32 v71, v71
    v_add_f32 v22, v22, v56
    v_add_f32 v23, v23, v57
    v_add_f32 v22, v22, v58
    v_add_f32 v23, v23, v59
    v_add_f32 v22, v22, v60
    v_add_f32 v23, v23, v61
    v_add_f32 v22, v22, v62
    v_add_f32 v23, v23, v63
    v_add_f32 v22, v22, v64
    v_add_f32 v23, v23, v65
    v_add_f32 v22, v22, v66
    v_add_f32 v23, v23, v67
    v_add_f32 v22, v22, v68
    v_add_f32 v23, v23, v69
    v_add_f32 v22, v22, v70
    v_add_f32 v23, v23, v71
    v_cvt_pk_bf16_f32 v136, v56, v57
    v_cvt_pk_bf16_f32 v137, v58, v59
    v_cvt_pk_bf16_f32 v138, v60, v61
    v_cvt_pk_bf16_f32 v139, v62, v63
    v_cvt_pk_bf16_f32 v140, v64, v65
    v_cvt_pk_bf16_f32 v141, v66, v67
    v_cvt_pk_bf16_f32 v142, v68, v69
    v_cvt_pk_bf16_f32 v143, v70, v71
    s_waitcnt lgkmcnt(2)
    v_mfma_f32_32x32x16_bf16 v[88:103], v[120:123], v[136:139], v[88:103]
    v_mfma_f32_32x32x16_bf16 v[88:103], v[124:127], v[140:143], v[88:103]
    ds_read_b128 v[128:131], v20 offset:22528
    ds_read_b128 v[132:135], v20 offset:23552
    s_cmp_eq_u32 s37, 3
    s_cbranch_scc0 attn1_kernel_b4
    v_mov_b32 v24, 0xf149f2ca
    v_mov_b32 v25, 0xf149f2ca
    v_mov_b32 v26, 0xf149f2ca
    v_mov_b32 v27, 0xf149f2ca
    v_mov_b32 v28, 0xf149f2ca
    v_mov_b32 v29, 0xf149f2ca
    v_mov_b32 v30, 0xf149f2ca
    v_mov_b32 v31, 0xf149f2ca
    v_mov_b32 v32, 0xf149f2ca
    v_mov_b32 v33, 0xf149f2ca
    v_mov_b32 v34, 0xf149f2ca
    v_mov_b32 v35, 0xf149f2ca
    v_mov_b32 v36, 0xf149f2ca
    v_mov_b32 v37, 0xf149f2ca
    v_mov_b32 v38, 0xf149f2ca
    v_mov_b32 v39, 0xf149f2ca
attn1_kernel_b4:
    s_waitcnt lgkmcnt(2)
    s_nop 0
    v_mfma_f32_32x32x16_bf16 v[56:71], v[104:107], v[4:7], v[24:39]
    v_mfma_f32_32x32x16_bf16 v[56:71], v[108:111], v[8:11], v[56:71]
    ds_read_b128 v[112:115], v20 offset:12288
    ds_read_b128 v[116:119], v20 offset:13312
    v_exp_f32 v72, v72
    v_exp_f32 v73, v73
    v_exp_f32 v74, v74
    v_exp_f32 v75, v75
    v_exp_f32 v76, v76
    v_exp_f32 v77, v77
    v_exp_f32 v78, v78
    v_exp_f32 v79, v79
    v_exp_f32 v80, v80
    v_exp_f32 v81, v81
    v_exp_f32 v82, v82
    v_exp_f32 v83, v83
    v_exp_f32 v84, v84
    v_exp_f32 v85, v85
    v_exp_f32 v86, v86
    v_exp_f32 v87, v87
    v_add_f32 v22, v22, v72
    v_add_f32 v23, v23, v73
    v_add_f32 v22, v22, v74
    v_add_f32 v23, v23, v75
    v_add_f32 v22, v22, v76
    v_add_f32 v23, v23, v77
    v_add_f32 v22, v22, v78
    v_add_f32 v23, v23, v79
    v_add_f32 v22, v22, v80
    v_add_f32 v23, v23, v81
    v_add_f32 v22, v22, v82
    v_add_f32 v23, v23, v83
    v_add_f32 v22, v22, v84
    v_add_f32 v23, v23, v85
    v_add_f32 v22, v22, v86
    v_add_f32 v23, v23, v87
    v_cvt_pk_bf16_f32 v144, v72, v73
    v_cvt_pk_bf16_f32 v145, v74, v75
    v_cvt_pk_bf16_f32 v146, v76, v77
    v_cvt_pk_bf16_f32 v147, v78, v79
    v_cvt_pk_bf16_f32 v148, v80, v81
    v_cvt_pk_bf16_f32 v149, v82, v83
    v_cvt_pk_bf16_f32 v150, v84, v85
    v_cvt_pk_bf16_f32 v151, v86, v87
    s_waitcnt lgkmcnt(2)
    v_mfma_f32_32x32x16_bf16 v[88:103], v[128:131], v[144:147], v[88:103]
    v_mfma_f32_32x32x16_bf16 v[88:103], v[132:135], v[148:151], v[88:103]
    ds_read_b128 v[120:123], v20 offset:18432
    ds_read_b128 v[124:127], v20 offset:19456
    s_cmp_eq_u32 s37, 4
    s_cbranch_scc0 attn1_kernel_b5
    v_mov_b32 v24, 0xf149f2ca
    v_mov_b32 v25, 0xf149f2ca
    v_mov_b32 v26, 0xf149f2ca
    v_mov_b32 v27, 0xf149f2ca
    v_mov_b32 v28, 0xf149f2ca
    v_mov_b32 v29, 0xf149f2ca
    v_mov_b32 v30, 0xf149f2ca
    v_mov_b32 v31, 0xf149f2ca
    v_mov_b32 v32, 0xf149f2ca
    v_mov_b32 v33, 0xf149f2ca
    v_mov_b32 v34, 0xf149f2ca
    v_mov_b32 v35, 0xf149f2ca
    v_mov_b32 v36, 0xf149f2ca
    v_mov_b32 v37, 0xf149f2ca
    v_mov_b32 v38, 0xf149f2ca
    v_mov_b32 v39, 0xf149f2ca
attn1_kernel_b5:
    s_waitcnt lgkmcnt(2)
    s_nop 0
    v_mfma_f32_32x32x16_bf16 v[72:87], v[112:115], v[4:7], v[24:39]
    v_mfma_f32_32x32x16_bf16 v[72:87], v[116:119], v[8:11], v[72:87]
    ds_read_b128 v[104:107], v20 offset:8192
    ds_read_b128 v[108:111], v20 offset:9216
    v_exp_f32 v56, v56
    v_exp_f32 v57, v57
    v_exp_f32 v58, v58
    v_exp_f32 v59, v59
    v_exp_f32 v60, v60
    v_exp_f32 v61, v61
    v_exp_f32 v62, v62
    v_exp_f32 v63, v63
    v_exp_f32 v64, v64
    v_exp_f32 v65, v65
    v_exp_f32 v66, v66
    v_exp_f32 v67, v67
    v_exp_f32 v68, v68
    v_exp_f32 v69, v69
    v_exp_f32 v70, v70
    v_exp_f32 v71, v71
    v_add_f32 v22, v22, v56
    v_add_f32 v23, v23, v57
    v_add_f32 v22, v22, v58
    v_add_f32 v23, v23, v59
    v_add_f32 v22, v22, v60
    v_add_f32 v23, v23, v61
    v_add_f32 v22, v22, v62
    v_add_f32 v23, v23, v63
    v_add_f32 v22, v22, v64
    v_add_f32 v23, v23, v65
    v_add_f32 v22, v22, v66
    v_add_f32 v23, v23, v67
    v_add_f32 v22, v22, v68
    v_add_f32 v23, v23, v69
    v_add_f32 v22, v22, v70
    v_add_f32 v23, v23, v71
    v_cvt_pk_bf16_f32 v136, v56, v57
    v_cvt_pk_bf16_f32 v137, v58, v59
    v_cvt_pk_bf16_f32 v138, v60, v61
    v_cvt_pk_bf16_f32 v139, v62, v63
    v_cvt_pk_bf16_f32 v140, v64, v65
    v_cvt_pk_bf16_f32 v141, v66, v67
    v_cvt_pk_bf16_f32 v142, v68, v69
    v_cvt_pk_bf16_f32 v143, v70, v71
    s_waitcnt lgkmcnt(2)
    v_mfma_f32_32x32x16_bf16 v[88:103], v[120:123], v[136:139], v[88:103]
    v_mfma_f32_32x32x16_bf16 v[88:103], v[124:127], v[140:143], v[88:103]
    ds_read_b128 v[128:131], v20 offset:14336
    ds_read_b128 v[132:135], v20 offset:15360
    s_cmp_eq_u32 s37, 5
    s_cbranch_scc0 attn1_kernel_b6
    v_mov_b32 v24, 0xf149f2ca
    v_mov_b32 v25, 0xf149f2ca
    v_mov_b32 v26, 0xf149f2ca
    v_mov_b32 v27, 0xf149f2ca
    v_mov_b32 v28, 0xf149f2ca
    v_mov_b32 v29, 0xf149f2ca
    v_mov_b32 v30, 0xf149f2ca
    v_mov_b32 v31, 0xf149f2ca
    v_mov_b32 v32, 0xf149f2ca
    v_mov_b32 v33, 0xf149f2ca
    v_mov_b32 v34, 0xf149f2ca
    v_mov_b32 v35, 0xf149f2ca
    v_mov_b32 v36, 0xf149f2ca
    v_mov_b32 v37, 0xf149f2ca
    v_mov_b32 v38, 0xf149f2ca
    v_mov_b32 v39, 0xf149f2ca
attn1_kernel_b6:
    s_waitcnt lgkmcnt(2)
    s_nop 0
    v_mfma_f32_32x32x16_bf16 v[56:71], v[104:107], v[4:7], v[24:39]
    v_mfma_f32_32x32x16_bf16 v[56:71], v[108:111], v[8:11], v[56:71]
    ds_read_b128 v[112:115], v20 offset:4096
    ds_read_b128 v[116:119], v20 offset:5120
    v_exp_f32 v72, v72
    v_exp_f32 v73, v73
    v_exp_f32 v74, v74
    v_exp_f32 v75, v75
    v_exp_f32 v76, v76
    v_exp_f32 v77, v77
    v_exp_f32 v78, v78
    v_exp_f32 v79, v79
    v_exp_f32 v80, v80
    v_exp_f32 v81, v81
    v_exp_f32 v82, v82
    v_exp_f32 v83, v83
    v_exp_f32 v84, v84
    v_exp_f32 v85, v85
    v_exp_f32 v86, v86
    v_exp_f32 v87, v87
    v_add_f32 v22, v22, v72
    v_add_f32 v23, v23, v73
    v_add_f32 v22, v22, v74
    v_add_f32 v23, v23, v75
    v_add_f32 v22, v22, v76
    v_add_f32 v23, v23, v77
    v_add_f32 v22, v22, v78
    v_add_f32 v23, v23, v79
    v_add_f32 v22, v22, v80
    v_add_f32 v23, v23, v81
    v_add_f32 v22, v22, v82
    v_add_f32 v23, v23, v83
    v_add_f32 v22, v22, v84
    v_add_f32 v23, v23, v85
    v_add_f32 v22, v22, v86
    v_add_f32 v23, v23, v87
    v_cvt_pk_bf16_f32 v144, v72, v73
    v_cvt_pk_bf16_f32 v145, v74, v75
    v_cvt_pk_bf16_f32 v146, v76, v77
    v_cvt_pk_bf16_f32 v147, v78, v79
    v_cvt_pk_bf16_f32 v148, v80, v81
    v_cvt_pk_bf16_f32 v149, v82, v83
    v_cvt_pk_bf16_f32 v150, v84, v85
    v_cvt_pk_bf16_f32 v151, v86, v87
    s_waitcnt lgkmcnt(2)
    v_mfma_f32_32x32x16_bf16 v[88:103], v[128:131], v[144:147], v[88:103]
    v_mfma_f32_32x32x16_bf16 v[88:103], v[132:135], v[148:151], v[88:103]
    ds_read_b128 v[120:123], v20 offset:10240
    ds_read_b128 v[124:127], v20 offset:11264
    s_cmp_eq_u32 s37, 6
    s_cbranch_scc0 attn1_kernel_b7
    v_mov_b32 v24, 0xf149f2ca
    v_mov_b32 v25, 0xf149f2ca
    v_mov_b32 v26, 0xf149f2ca
    v_mov_b32 v27, 0xf149f2ca
    v_mov_b32 v28, 0xf149f2ca
    v_mov_b32 v29, 0xf149f2ca
    v_mov_b32 v30, 0xf149f2ca
    v_mov_b32 v31, 0xf149f2ca
    v_mov_b32 v32, 0xf149f2ca
    v_mov_b32 v33, 0xf149f2ca
    v_mov_b32 v34, 0xf149f2ca
    v_mov_b32 v35, 0xf149f2ca
    v_mov_b32 v36, 0xf149f2ca
    v_mov_b32 v37, 0xf149f2ca
    v_mov_b32 v38, 0xf149f2ca
    v_mov_b32 v39, 0xf149f2ca
attn1_kernel_b7:
    s_waitcnt lgkmcnt(2)
    s_nop 0
    v_mfma_f32_32x32x16_bf16 v[72:87], v[112:115], v[4:7], v[24:39]
    v_mfma_f32_32x32x16_bf16 v[72:87], v[116:119], v[8:11], v[72:87]
    v_exp_f32 v56, v56
    v_exp_f32 v57, v57
    v_exp_f32 v58, v58
    v_exp_f32 v59, v59
    v_exp_f32 v60, v60
    v_exp_f32 v61, v61
    v_exp_f32 v62, v62
    v_exp_f32 v63, v63
    v_exp_f32 v64, v64
    v_exp_f32 v65, v65
    v_exp_f32 v66, v66
    v_exp_f32 v67, v67
    v_exp_f32 v68, v68
    v_exp_f32 v69, v69
    v_exp_f32 v70, v70
    v_exp_f32 v71, v71
    v_add_f32 v22, v22, v56
    v_add_f32 v23, v23, v57
    v_add_f32 v22, v22, v58
    v_add_f32 v23, v23, v59
    v_add_f32 v22, v22, v60
    v_add_f32 v23, v23, v61
    v_add_f32 v22, v22, v62
    v_add_f32 v23, v23, v63
    v_add_f32 v22, v22, v64
    v_add_f32 v23, v23, v65
    v_add_f32 v22, v22, v66
    v_add_f32 v23, v23, v67
    v_add_f32 v22, v22, v68
    v_add_f32 v23, v23, v69
    v_add_f32 v22, v22, v70
    v_add_f32 v23, v23, v71
    v_cvt_pk_bf16_f32 v136, v56, v57
    v_cvt_pk_bf16_f32 v137, v58, v59
    v_cvt_pk_bf16_f32 v138, v60, v61
    v_cvt_pk_bf16_f32 v139, v62, v63
    v_cvt_pk_bf16_f32 v140, v64, v65
    v_cvt_pk_bf16_f32 v141, v66, v67
    v_cvt_pk_bf16_f32 v142, v68, v69
    v_cvt_pk_bf16_f32 v143, v70, v71
    s_waitcnt lgkmcnt(0)
    v_mfma_f32_32x32x16_bf16 v[88:103], v[120:123], v[136:139], v[88:103]
    v_mfma_f32_32x32x16_bf16 v[88:103], v[124:127], v[140:143], v[88:103]
    ds_read_b128 v[128:131], v20 offset:6144
    ds_read_b128 v[132:135], v20 offset:7168
    v_exp_f32 v72, v72
    v_exp_f32 v73, v73
    v_exp_f32 v74, v74
    v_exp_f32 v75, v75
    v_exp_f32 v76, v76
    v_exp_f32 v77, v77
    v_exp_f32 v78, v78
    v_exp_f32 v79, v79
    v_exp_f32 v80, v80
    v_exp_f32 v81, v81
    v_exp_f32 v82, v82
    v_exp_f32 v83, v83
    v_exp_f32 v84, v84
    v_exp_f32 v85, v85
    v_exp_f32 v86, v86
    v_exp_f32 v87, v87
    v_add_f32 v22, v22, v72
    v_add_f32 v23, v23, v73
    v_add_f32 v22, v22, v74
    v_add_f32 v23, v23, v75
    v_add_f32 v22, v22, v76
    v_add_f32 v23, v23, v77
    v_add_f32 v22, v22, v78
    v_add_f32 v23, v23, v79
    v_add_f32 v22, v22, v80
    v_add_f32 v23, v23, v81
    v_add_f32 v22, v22, v82
    v_add_f32 v23, v23, v83
    v_add_f32 v22, v22, v84
    v_add_f32 v23, v23, v85
    v_add_f32 v22, v22, v86
    v_add_f32 v23, v23, v87
    v_cvt_pk_bf16_f32 v144, v72, v73
    v_cvt_pk_bf16_f32 v145, v74, v75
    v_cvt_pk_bf16_f32 v146, v76, v77
    v_cvt_pk_bf16_f32 v147, v78, v79
    v_cvt_pk_bf16_f32 v148, v80, v81
    v_cvt_pk_bf16_f32 v149, v82, v83
    v_cvt_pk_bf16_f32 v150, v84, v85
    v_cvt_pk_bf16_f32 v151, v86, v87
    s_waitcnt lgkmcnt(0)
    v_mfma_f32_32x32x16_bf16 v[88:103], v[128:131], v[144:147], v[88:103]
    v_mfma_f32_32x32x16_bf16 v[88:103], v[132:135], v[148:151], v[88:103]
    v_add_f32 v22, v22, v23
    v_mov_b32 v152, v22
    s_nop 1
    v_permlane32_swap_b32 v22, v152
    v_add_f32 v22, v22, v152
    v_rcp_f32 v22, v22
    s_lshl_b32 s33, s37, 16
    s_lshl_b32 s34, s30, 11
    s_add_u32 s33, s33, s34
    s_add_u32 s33, s33, 0x2c00000
    s_nop 0
    v_mul_f32 v88, v88, v22
    v_mul_f32 v89, v89, v22
    v_mul_f32 v90, v90, v22
    v_mul_f32 v91, v91, v22
    v_mul_f32 v92, v92, v22
    v_mul_f32 v93, v93, v22
    v_mul_f32 v94, v94, v22
    v_mul_f32 v95, v95, v22
    v_mul_f32 v96, v96, v22
    v_mul_f32 v97, v97, v22
    v_mul_f32 v98, v98, v22
    v_mul_f32 v99, v99, v22
    v_mul_f32 v100, v100, v22
    v_mul_f32 v101, v101, v22
    v_mul_f32 v102, v102, v22
    v_mul_f32 v103, v103, v22
    v_cvt_pk_bf16_f32 v88, v88, v89
    v_cvt_pk_bf16_f32 v89, v90, v91
    v_cvt_pk_bf16_f32 v90, v92, v93
    v_cvt_pk_bf16_f32 v91, v94, v95
    v_cvt_pk_bf16_f32 v92, v96, v97
    v_cvt_pk_bf16_f32 v93, v98, v99
    v_cvt_pk_bf16_f32 v94, v100, v101
    v_cvt_pk_bf16_f32 v95, v102, v103
    buffer_store_dwordx4 v[88:91], v3, s[20:23], s33 offen
    buffer_store_dwordx4 v[92:95], v3, s[20:23], s33 offen offset:1024
attn1_kernel_end:
    s_endpgm
.globl wo1_kernel
.p2align 8
.type wo1_kernel,@function
wo1_kernel:
    s_cmp_ge_u32 s2, 256
    s_cbranch_scc1 wo1_kernel_end
    s_load_dwordx2 s[4:5], s[0:1], 0
    s_load_dwordx2 s[6:7], s[0:1], 16
    s_load_dwordx2 s[8:9], s[0:1], 80
    s_load_dwordx2 s[10:11], s[0:1], 32
    v_lshrrev_b32 v1, 6, v0
    v_and_b32 v2, 63, v0
    v_readfirstlane_b32 s3, v1
    s_and_b32 s24, s2, 7
    s_lshr_b32 s25, s2, 3
    s_lshl_b32 s26, s24, 1
    s_and_b32 s27, s25, 1
    s_add_u32 s26, s26, s27
    s_lshr_b32 s27, s25, 1
    s_and_b32 s28, s3, 3
    s_lshr_b32 s29, s3, 2
    v_bfe_u32 v4, v2, 3, 2
    v_lshrrev_b32 v5, 5, v2
    v_lshl_add_u32 v4, v5, 3, v4
    s_lshr_b32 s30, s3, 1
    s_lshl_b32 s30, s30, 4
    s_and_b32 s31, s3, 1
    s_lshl_b32 s31, s31, 2
    s_add_u32 s30, s30, s31
    v_add_u32 v4, s30, v4
    v_lshlrev_b32 v4, 11, v4
    v_lshrrev_b32 v6, 2, v2
    v_and_b32 v6, 4, v6
    v_xor_b32 v6, v6, v2
    v_and_b32 v6, 7, v6
    v_lshl_add_u32 v4, v6, 4, v4
    v_lshlrev_b32 v3, 4, v2
    s_waitcnt lgkmcnt(0)
    s_mov_b32 s12, s4
    s_mov_b32 s13, s5
    s_mov_b32 s14, 0x400000
    s_mov_b32 s15, 0x20000
    s_mov_b32 s16, s6
    s_mov_b32 s17, s7
    s_mov_b32 s18, 0x200000
    s_mov_b32 s19, 0x20000
    s_mov_b32 s20, s8
    s_mov_b32 s21, s9
    s_mov_b32 s22, 0x8000000
    s_mov_b32 s23, 0x20000
    s_mov_b32 s40, s10
    s_mov_b32 s41, s11
    s_mov_b32 s42, 0x800
    s_mov_b32 s43, 0x20000
    s_lshl_b32 s30, s27, 7
    s_lshl_b32 s31, s3, 10
    s_mov_b32 m0, s31
    s_nop 0
    buffer_load_dwordx4 v4, s[16:19], s30 offen lds
    s_add_u32 m0, m0, 8192
    s_add_u32 s30, s30, 131072
    buffer_load_dwordx4 v4, s[16:19], s30 offen lds
    s_add_u32 m0, m0, 8192
    s_add_u32 s30, s30, 131072
    buffer_load_dwordx4 v4, s[16:19], s30 offen lds
    s_add_u32 m0, m0, 8192
    s_add_u32 s30, s30, 131072
    buffer_load_dwordx4 v4, s[16:19], s30 offen lds
    s_add_u32 m0, m0, 8192
    s_add_u32 s30, s30, 131072
    buffer_load_dwordx4 v4, s[16:19], s30 offen lds
    s_add_u32 m0, m0, 8192
    s_add_u32 s30, s30, 131072
    buffer_load_dwordx4 v4, s[16:19], s30 offen lds
    s_add_u32 m0, m0, 8192
    s_add_u32 s30, s30, 131072
    buffer_load_dwordx4 v4, s[16:19], s30 offen lds
    s_add_u32 m0, m0, 8192
    s_add_u32 s30, s30, 131072
    buffer_load_dwordx4 v4, s[16:19], s30 offen lds
    s_add_u32 m0, m0, 8192
    s_add_u32 s30, s30, 131072
    buffer_load_dwordx4 v4, s[16:19], s30 offen lds
    s_add_u32 m0, m0, 8192
    s_add_u32 s30, s30, 131072
    buffer_load_dwordx4 v4, s[16:19], s30 offen lds
    s_add_u32 m0, m0, 8192
    s_add_u32 s30, s30, 131072
    buffer_load_dwordx4 v4, s[16:19], s30 offen lds
    s_add_u32 m0, m0, 8192
    s_add_u32 s30, s30, 131072
    buffer_load_dwordx4 v4, s[16:19], s30 offen lds
    s_add_u32 m0, m0, 8192
    s_add_u32 s30, s30, 131072
    buffer_load_dwordx4 v4, s[16:19], s30 offen lds
    s_add_u32 m0, m0, 8192
    s_add_u32 s30, s30, 131072
    buffer_load_dwordx4 v4, s[16:19], s30 offen lds
    s_add_u32 m0, m0, 8192
    s_add_u32 s30, s30, 131072
    buffer_load_dwordx4 v4, s[16:19], s30 offen lds
    s_add_u32 m0, m0, 8192
    s_add_u32 s30, s30, 131072
    buffer_load_dwordx4 v4, s[16:19], s30 offen lds
    v_and_b32 v7, 31, v2
    s_lshl_b32 s32, s26, 2
    s_add_u32 s32, s32, s28
    s_lshl_b32 s33, s27, 7
    s_lshl_b32 s34, s29, 6
    s_add_u32 s33, s33, s34
    v_lshlrev_b32 v8, 3, v5
    buffer_load_dwordx2 v[48:49], v8, s[40:43], s33 offen offset:0
    buffer_load_dwordx2 v[50:51], v8, s[40:43], s33 offen offset:16
    buffer_load_dwordx2 v[52:53], v8, s[40:43], s33 offen offset:32
    buffer_load_dwordx2 v[54:55], v8, s[40:43], s33 offen offset:48
    s_lshl_b32 s35, s26, 4
    s_add_u32 s35, s35, s27
    s_lshl_b32 s35, s35, 14
    s_lshl_b32 s34, s28, 12
    s_add_u32 s35, s35, s34
    s_lshl_b32 s34, s29, 11
    s_add_u32 s35, s35, s34
    s_add_u32 s34, s35, 0x1000000
    buffer_load_dwordx4 v[40:43], v3, s[20:23], s34 offen
    buffer_load_dwordx4 v[44:47], v3, s[20:23], s34 offen offset:1024
    v_lshlrev_b32 v9, 2, v7
    s_lshl_b32 s34, s32, 7
    s_add_u32 s34, s34, 0x3444000
    buffer_load_dword v56, v9, s[20:23], s34 offen
    s_add_u32 s34, s34, 8192
    buffer_load_dword v57, v9, s[20:23], s34 offen
    s_lshl_b32 s36, s32, 16
    s_lshl_b32 s34, s29, 15
    s_add_u32 s36, s36, s34
    s_add_u32 s36, s36, 0x2c00000
    buffer_load_dwordx4 v[64:67], v3, s[20:23], s36 offen offset:0
    buffer_load_dwordx4 v[68:71], v3, s[20:23], s36 offen offset:1024
    buffer_load_dwordx4 v[72:75], v3, s[20:23], s36 offen offset:2048
    buffer_load_dwordx4 v[76:79], v3, s[20:23], s36 offen offset:3072
    s_add_u32 s36, s36, 4096
    buffer_load_dwordx4 v[80:83], v3, s[20:23], s36 offen offset:0
    buffer_load_dwordx4 v[84:87], v3, s[20:23], s36 offen offset:1024
    buffer_load_dwordx4 v[88:91], v3, s[20:23], s36 offen offset:2048
    buffer_load_dwordx4 v[92:95], v3, s[20:23], s36 offen offset:3072
    s_add_u32 s36, s36, 4096
    buffer_load_dwordx4 v[96:99], v3, s[20:23], s36 offen offset:0
    buffer_load_dwordx4 v[100:103], v3, s[20:23], s36 offen offset:1024
    buffer_load_dwordx4 v[104:107], v3, s[20:23], s36 offen offset:2048
    buffer_load_dwordx4 v[108:111], v3, s[20:23], s36 offen offset:3072
    s_add_u32 s36, s36, 4096
    buffer_load_dwordx4 v[112:115], v3, s[20:23], s36 offen offset:0
    buffer_load_dwordx4 v[116:119], v3, s[20:23], s36 offen offset:1024
    buffer_load_dwordx4 v[120:123], v3, s[20:23], s36 offen offset:2048
    buffer_load_dwordx4 v[124:127], v3, s[20:23], s36 offen offset:3072
    s_add_u32 s36, s36, 4096
    buffer_load_dwordx4 v[128:131], v3, s[20:23], s36 offen offset:0
    buffer_load_dwordx4 v[132:135], v3, s[20:23], s36 offen offset:1024
    buffer_load_dwordx4 v[136:139], v3, s[20:23], s36 offen offset:2048
    buffer_load_dwordx4 v[140:143], v3, s[20:23], s36 offen offset:3072
    s_add_u32 s36, s36, 4096
    buffer_load_dwordx4 v[144:147], v3, s[20:23], s36 offen offset:0
    buffer_load_dwordx4 v[148:151], v3, s[20:23], s36 offen offset:1024
    buffer_load_dwordx4 v[152:155], v3, s[20:23], s36 offen offset:2048
    buffer_load_dwordx4 v[156:159], v3, s[20:23], s36 offen offset:3072
    s_add_u32 s36, s36, 4096
    buffer_load_dwordx4 v[160:163], v3, s[20:23], s36 offen offset:0
    buffer_load_dwordx4 v[164:167], v3, s[20:23], s36 offen offset:1024
    buffer_load_dwordx4 v[168:171], v3, s[20:23], s36 offen offset:2048
    buffer_load_dwordx4 v[172:175], v3, s[20:23], s36 offen offset:3072
    s_add_u32 s36, s36, 4096
    buffer_load_dwordx4 v[176:179], v3, s[20:23], s36 offen offset:0
    buffer_load_dwordx4 v[180:183], v3, s[20:23], s36 offen offset:1024
    buffer_load_dwordx4 v[184:187], v3, s[20:23], s36 offen offset:2048
    buffer_load_dwordx4 v[188:191], v3, s[20:23], s36 offen offset:3072
    v_bfe_u32 v10, v2, 2, 2
    v_lshl_add_u32 v11, v5, 3, v10
    v_lshlrev_b32 v11, 7, v11
    v_lshrrev_b32 v10, 1, v10
    v_xor_b32 v10, s29, v10
    v_lshl_add_u32 v11, v10, 6, v11
    v_bfe_u32 v10, v2, 4, 1
    v_lshl_add_u32 v11, v10, 5, v11
    v_and_b32 v10, 3, v2
    v_lshl_add_u32 v11, v10, 3, v11
    s_lshl_b32 s34, s29, 16
    v_add_u32 v58, s34, v11
    v_xor_b32 v59, 64, v58
    v_mov_b32 v60, v7
    v_mov_b32 v61, v5
    v_mov_b32 v62, v3
    s_waitcnt vmcnt(40)
    s_barrier
    ds_read_b64_tr_b16 v[192:193], v58 offset:0
    ds_read_b64_tr_b16 v[194:195], v58 offset:512
    ds_read_b64_tr_b16 v[196:197], v59 offset:0
    ds_read_b64_tr_b16 v[198:199], v59 offset:512
    ds_read_b64_tr_b16 v[200:201], v58 offset:2048
    ds_read_b64_tr_b16 v[202:203], v58 offset:2560
    ds_read_b64_tr_b16 v[204:205], v59 offset:2048
    ds_read_b64_tr_b16 v[206:207], v59 offset:2560
    ds_read_b64_tr_b16 v[208:209], v58 offset:4096
    ds_read_b64_tr_b16 v[210:211], v58 offset:4608
    ds_read_b64_tr_b16 v[212:213], v59 offset:4096
    ds_read_b64_tr_b16 v[214:215], v59 offset:4608
    s_waitcnt vmcnt(31) lgkmcnt(8)
    v_mfma_f32_32x32x16_bf16 v[0:15], v[192:195], v[64:67], 0
    v_mfma_f32_32x32x16_bf16 v[16:31], v[196:199], v[64:67], 0
    ds_read_b64_tr_b16 v[192:193], v58 offset:6144
    ds_read_b64_tr_b16 v[194:195], v58 offset:6656
    ds_read_b64_tr_b16 v[196:197], v59 offset:6144
    ds_read_b64_tr_b16 v[198:199], v59 offset:6656
    s_waitcnt vmcnt(30) lgkmcnt(8)
    v_mfma_f32_32x32x16_bf16 v[0:15], v[200:203], v[68:71], v[0:15]
    v_mfma_f32_32x32x16_bf16 v[16:31], v[204:207], v[68:71], v[16:31]
    ds_read_b64_tr_b16 v[200:201], v58 offset:8192
    ds_read_b64_tr_b16 v[202:203], v58 offset:8704
    ds_read_b64_tr_b16 v[204:205], v59 offset:8192
    ds_read_b64_tr_b16 v[206:207], v59 offset:8704
    s_waitcnt vmcnt(29) lgkmcnt(8)
    v_mfma_f32_32x32x16_bf16 v[0:15], v[208:211], v[72:75], v[0:15]
    v_mfma_f32_32x32x16_bf16 v[16:31], v[212:215], v[72:75], v[16:31]
    ds_read_b64_tr_b16 v[208:209], v58 offset:10240
    ds_read_b64_tr_b16 v[210:211], v58 offset:10752
    ds_read_b64_tr_b16 v[212:213], v59 offset:10240
    ds_read_b64_tr_b16 v[214:215], v59 offset:10752
    s_waitcnt vmcnt(28) lgkmcnt(8)
    v_mfma_f32_32x32x16_bf16 v[0:15], v[192:195], v[76:79], v[0:15]
    v_mfma_f32_32x32x16_bf16 v[16:31], v[196:199], v[76:79], v[16:31]
    ds_read_b64_tr_b16 v[192:193], v58 offset:12288
    ds_read_b64_tr_b16 v[194:195], v58 offset:12800
    ds_read_b64_tr_b16 v[196:197], v59 offset:12288
    ds_read_b64_tr_b16 v[198:199], v59 offset:12800
    s_waitcnt vmcnt(27) lgkmcnt(8)
    v_mfma_f32_32x32x16_bf16 v[0:15], v[200:203], v[80:83], v[0:15]
    v_mfma_f32_32x32x16_bf16 v[16:31], v[204:207], v[80:83], v[16:31]
    ds_read_b64_tr_b16 v[200:201], v58 offset:14336
    ds_read_b64_tr_b16 v[202:203], v58 offset:14848
    ds_read_b64_tr_b16 v[204:205], v59 offset:14336
    ds_read_b64_tr_b16 v[206:207], v59 offset:14848
    s_waitcnt vmcnt(26) lgkmcnt(8)
    v_mfma_f32_32x32x16_bf16 v[0:15], v[208:211], v[84:87], v[0:15]
    v_mfma_f32_32x32x16_bf16 v[16:31], v[212:215], v[84:87], v[16:31]
    ds_read_b64_tr_b16 v[208:209], v58 offset:16384
    ds_read_b64_tr_b16 v[210:211], v58 offset:16896
    ds_read_b64_tr_b16 v[212:213], v59 offset:16384
    ds_read_b64_tr_b16 v[214:215], v59 offset:16896
    s_waitcnt vmcnt(25) lgkmcnt(8)
    v_mfma_f32_32x32x16_bf16 v[0:15], v[192:195], v[88:91], v[0:15]
    v_mfma_f32_32x32x16_bf16 v[16:31], v[196:199], v[88:91], v[16:31]
    ds_read_b64_tr_b16 v[192:193], v58 offset:18432
    ds_read_b64_tr_b16 v[194:195], v58 offset:18944
    ds_read_b64_tr_b16 v[196:197], v59 offset:18432
    ds_read_b64_tr_b16 v[198:199], v59 offset:18944
    s_waitcnt vmcnt(24) lgkmcnt(8)
    v_mfma_f32_32x32x16_bf16 v[0:15], v[200:203], v[92:95], v[0:15]
    v_mfma_f32_32x32x16_bf16 v[16:31], v[204:207], v[92:95], v[16:31]
    ds_read_b64_tr_b16 v[200:201], v58 offset:20480
    ds_read_b64_tr_b16 v[202:203], v58 offset:20992
    ds_read_b64_tr_b16 v[204:205], v59 offset:20480
    ds_read_b64_tr_b16 v[206:207], v59 offset:20992
    s_waitcnt vmcnt(23) lgkmcnt(8)
    v_mfma_f32_32x32x16_bf16 v[0:15], v[208:211], v[96:99], v[0:15]
    v_mfma_f32_32x32x16_bf16 v[16:31], v[212:215], v[96:99], v[16:31]
    ds_read_b64_tr_b16 v[208:209], v58 offset:22528
    ds_read_b64_tr_b16 v[210:211], v58 offset:23040
    ds_read_b64_tr_b16 v[212:213], v59 offset:22528
    ds_read_b64_tr_b16 v[214:215], v59 offset:23040
    s_waitcnt vmcnt(22) lgkmcnt(8)
    v_mfma_f32_32x32x16_bf16 v[0:15], v[192:195], v[100:103], v[0:15]
    v_mfma_f32_32x32x16_bf16 v[16:31], v[196:199], v[100:103], v[16:31]
    ds_read_b64_tr_b16 v[192:193], v58 offset:24576
    ds_read_b64_tr_b16 v[194:195], v58 offset:25088
    ds_read_b64_tr_b16 v[196:197], v59 offset:24576
    ds_read_b64_tr_b16 v[198:199], v59 offset:25088
    s_waitcnt vmcnt(21) lgkmcnt(8)
    v_mfma_f32_32x32x16_bf16 v[0:15], v[200:203], v[104:107], v[0:15]
    v_mfma_f32_32x32x16_bf16 v[16:31], v[204:207], v[104:107], v[16:31]
    ds_read_b64_tr_b16 v[200:201], v58 offset:26624
    ds_read_b64_tr_b16 v[202:203], v58 offset:27136
    ds_read_b64_tr_b16 v[204:205], v59 offset:26624
    ds_read_b64_tr_b16 v[206:207], v59 offset:27136
    s_waitcnt vmcnt(20) lgkmcnt(8)
    v_mfma_f32_32x32x16_bf16 v[0:15], v[208:211], v[108:111], v[0:15]
    v_mfma_f32_32x32x16_bf16 v[16:31], v[212:215], v[108:111], v[16:31]
    ds_read_b64_tr_b16 v[208:209], v58 offset:28672
    ds_read_b64_tr_b16 v[210:211], v58 offset:29184
    ds_read_b64_tr_b16 v[212:213], v59 offset:28672
    ds_read_b64_tr_b16 v[214:215], v59 offset:29184
    s_waitcnt vmcnt(19) lgkmcnt(8)
    v_mfma_f32_32x32x16_bf16 v[0:15], v[192:195], v[112:115], v[0:15]
    v_mfma_f32_32x32x16_bf16 v[16:31], v[196:199], v[112:115], v[16:31]
    ds_read_b64_tr_b16 v[192:193], v58 offset:30720
    ds_read_b64_tr_b16 v[194:195], v58 offset:31232
    ds_read_b64_tr_b16 v[196:197], v59 offset:30720
    ds_read_b64_tr_b16 v[198:199], v59 offset:31232
    s_waitcnt vmcnt(18) lgkmcnt(8)
    v_mfma_f32_32x32x16_bf16 v[0:15], v[200:203], v[116:119], v[0:15]
    v_mfma_f32_32x32x16_bf16 v[16:31], v[204:207], v[116:119], v[16:31]
    ds_read_b64_tr_b16 v[200:201], v58 offset:32768
    ds_read_b64_tr_b16 v[202:203], v58 offset:33280
    ds_read_b64_tr_b16 v[204:205], v59 offset:32768
    ds_read_b64_tr_b16 v[206:207], v59 offset:33280
    s_waitcnt vmcnt(17) lgkmcnt(8)
    v_mfma_f32_32x32x16_bf16 v[0:15], v[208:211], v[120:123], v[0:15]
    v_mfma_f32_32x32x16_bf16 v[16:31], v[212:215], v[120:123], v[16:31]
    ds_read_b64_tr_b16 v[208:209], v58 offset:34816
    ds_read_b64_tr_b16 v[210:211], v58 offset:35328
    ds_read_b64_tr_b16 v[212:213], v59 offset:34816
    ds_read_b64_tr_b16 v[214:215], v59 offset:35328
    s_waitcnt vmcnt(16) lgkmcnt(8)
    v_mfma_f32_32x32x16_bf16 v[0:15], v[192:195], v[124:127], v[0:15]
    v_mfma_f32_32x32x16_bf16 v[16:31], v[196:199], v[124:127], v[16:31]
    ds_read_b64_tr_b16 v[192:193], v58 offset:36864
    ds_read_b64_tr_b16 v[194:195], v58 offset:37376
    ds_read_b64_tr_b16 v[196:197], v59 offset:36864
    ds_read_b64_tr_b16 v[198:199], v59 offset:37376
    s_waitcnt vmcnt(15) lgkmcnt(8)
    v_mfma_f32_32x32x16_bf16 v[0:15], v[200:203], v[128:131], v[0:15]
    v_mfma_f32_32x32x16_bf16 v[16:31], v[204:207], v[128:131], v[16:31]
    ds_read_b64_tr_b16 v[200:201], v58 offset:38912
    ds_read_b64_tr_b16 v[202:203], v58 offset:39424
    ds_read_b64_tr_b16 v[204:205], v59 offset:38912
    ds_read_b64_tr_b16 v[206:207], v59 offset:39424
    s_waitcnt vmcnt(14) lgkmcnt(8)
    v_mfma_f32_32x32x16_bf16 v[0:15], v[208:211], v[132:135], v[0:15]
    v_mfma_f32_32x32x16_bf16 v[16:31], v[212:215], v[132:135], v[16:31]
    ds_read_b64_tr_b16 v[208:209], v58 offset:40960
    ds_read_b64_tr_b16 v[210:211], v58 offset:41472
    ds_read_b64_tr_b16 v[212:213], v59 offset:40960
    ds_read_b64_tr_b16 v[214:215], v59 offset:41472
    s_waitcnt vmcnt(13) lgkmcnt(8)
    v_mfma_f32_32x32x16_bf16 v[0:15], v[192:195], v[136:139], v[0:15]
    v_mfma_f32_32x32x16_bf16 v[16:31], v[196:199], v[136:139], v[16:31]
    ds_read_b64_tr_b16 v[192:193], v58 offset:43008
    ds_read_b64_tr_b16 v[194:195], v58 offset:43520
    ds_read_b64_tr_b16 v[196:197], v59 offset:43008
    ds_read_b64_tr_b16 v[198:199], v59 offset:43520
    s_waitcnt vmcnt(12) lgkmcnt(8)
    v_mfma_f32_32x32x16_bf16 v[0:15], v[200:203], v[140:143], v[0:15]
    v_mfma_f32_32x32x16_bf16 v[16:31], v[204:207], v[140:143], v[16:31]
    ds_read_b64_tr_b16 v[200:201], v58 offset:45056
    ds_read_b64_tr_b16 v[202:203], v58 offset:45568
    ds_read_b64_tr_b16 v[204:205], v59 offset:45056
    ds_read_b64_tr_b16 v[206:207], v59 offset:45568
    s_waitcnt vmcnt(11) lgkmcnt(8)
    v_mfma_f32_32x32x16_bf16 v[0:15], v[208:211], v[144:147], v[0:15]
    v_mfma_f32_32x32x16_bf16 v[16:31], v[212:215], v[144:147], v[16:31]
    ds_read_b64_tr_b16 v[208:209], v58 offset:47104
    ds_read_b64_tr_b16 v[210:211], v58 offset:47616
    ds_read_b64_tr_b16 v[212:213], v59 offset:47104
    ds_read_b64_tr_b16 v[214:215], v59 offset:47616
    s_waitcnt vmcnt(10) lgkmcnt(8)
    v_mfma_f32_32x32x16_bf16 v[0:15], v[192:195], v[148:151], v[0:15]
    v_mfma_f32_32x32x16_bf16 v[16:31], v[196:199], v[148:151], v[16:31]
    ds_read_b64_tr_b16 v[192:193], v58 offset:49152
    ds_read_b64_tr_b16 v[194:195], v58 offset:49664
    ds_read_b64_tr_b16 v[196:197], v59 offset:49152
    ds_read_b64_tr_b16 v[198:199], v59 offset:49664
    s_waitcnt vmcnt(9) lgkmcnt(8)
    v_mfma_f32_32x32x16_bf16 v[0:15], v[200:203], v[152:155], v[0:15]
    v_mfma_f32_32x32x16_bf16 v[16:31], v[204:207], v[152:155], v[16:31]
    ds_read_b64_tr_b16 v[200:201], v58 offset:51200
    ds_read_b64_tr_b16 v[202:203], v58 offset:51712
    ds_read_b64_tr_b16 v[204:205], v59 offset:51200
    ds_read_b64_tr_b16 v[206:207], v59 offset:51712
    s_waitcnt vmcnt(8) lgkmcnt(8)
    v_mfma_f32_32x32x16_bf16 v[0:15], v[208:211], v[156:159], v[0:15]
    v_mfma_f32_32x32x16_bf16 v[16:31], v[212:215], v[156:159], v[16:31]
    ds_read_b64_tr_b16 v[208:209], v58 offset:53248
    ds_read_b64_tr_b16 v[210:211], v58 offset:53760
    ds_read_b64_tr_b16 v[212:213], v59 offset:53248
    ds_read_b64_tr_b16 v[214:215], v59 offset:53760
    s_waitcnt vmcnt(7) lgkmcnt(8)
    v_mfma_f32_32x32x16_bf16 v[0:15], v[192:195], v[160:163], v[0:15]
    v_mfma_f32_32x32x16_bf16 v[16:31], v[196:199], v[160:163], v[16:31]
    ds_read_b64_tr_b16 v[192:193], v58 offset:55296
    ds_read_b64_tr_b16 v[194:195], v58 offset:55808
    ds_read_b64_tr_b16 v[196:197], v59 offset:55296
    ds_read_b64_tr_b16 v[198:199], v59 offset:55808
    s_waitcnt vmcnt(6) lgkmcnt(8)
    v_mfma_f32_32x32x16_bf16 v[0:15], v[200:203], v[164:167], v[0:15]
    v_mfma_f32_32x32x16_bf16 v[16:31], v[204:207], v[164:167], v[16:31]
    ds_read_b64_tr_b16 v[200:201], v58 offset:57344
    ds_read_b64_tr_b16 v[202:203], v58 offset:57856
    ds_read_b64_tr_b16 v[204:205], v59 offset:57344
    ds_read_b64_tr_b16 v[206:207], v59 offset:57856
    s_waitcnt vmcnt(5) lgkmcnt(8)
    v_mfma_f32_32x32x16_bf16 v[0:15], v[208:211], v[168:171], v[0:15]
    v_mfma_f32_32x32x16_bf16 v[16:31], v[212:215], v[168:171], v[16:31]
    ds_read_b64_tr_b16 v[208:209], v58 offset:59392
    ds_read_b64_tr_b16 v[210:211], v58 offset:59904
    ds_read_b64_tr_b16 v[212:213], v59 offset:59392
    ds_read_b64_tr_b16 v[214:215], v59 offset:59904
    s_waitcnt vmcnt(4) lgkmcnt(8)
    v_mfma_f32_32x32x16_bf16 v[0:15], v[192:195], v[172:175], v[0:15]
    v_mfma_f32_32x32x16_bf16 v[16:31], v[196:199], v[172:175], v[16:31]
    ds_read_b64_tr_b16 v[192:193], v58 offset:61440
    ds_read_b64_tr_b16 v[194:195], v58 offset:61952
    ds_read_b64_tr_b16 v[196:197], v59 offset:61440
    ds_read_b64_tr_b16 v[198:199], v59 offset:61952
    s_waitcnt vmcnt(3) lgkmcnt(8)
    v_mfma_f32_32x32x16_bf16 v[0:15], v[200:203], v[176:179], v[0:15]
    v_mfma_f32_32x32x16_bf16 v[16:31], v[204:207], v[176:179], v[16:31]
    ds_read_b64_tr_b16 v[200:201], v58 offset:63488
    ds_read_b64_tr_b16 v[202:203], v58 offset:64000
    ds_read_b64_tr_b16 v[204:205], v59 offset:63488
    ds_read_b64_tr_b16 v[206:207], v59 offset:64000
    s_waitcnt vmcnt(2) lgkmcnt(8)
    v_mfma_f32_32x32x16_bf16 v[0:15], v[208:211], v[180:183], v[0:15]
    v_mfma_f32_32x32x16_bf16 v[16:31], v[212:215], v[180:183], v[16:31]
    s_waitcnt vmcnt(1) lgkmcnt(4)
    v_mfma_f32_32x32x16_bf16 v[0:15], v[192:195], v[184:187], v[0:15]
    v_mfma_f32_32x32x16_bf16 v[16:31], v[196:199], v[184:187], v[16:31]
    s_waitcnt vmcnt(0) lgkmcnt(0)
    v_mfma_f32_32x32x16_bf16 v[0:15], v[200:203], v[188:191], v[0:15]
    v_mfma_f32_32x32x16_bf16 v[16:31], v[204:207], v[188:191], v[16:31]
    s_lshl_b32 s34, s3, 12
    s_add_u32 s34, s34, 131072
    v_add_u32 v63, s34, v62
    s_nop 8
    ds_write_b128 v63, v[16:19] offset:0
    ds_write_b128 v63, v[20:23] offset:1024
    ds_write_b128 v63, v[24:27] offset:2048
    ds_write_b128 v63, v[28:31] offset:3072
    v_xor_b32 v63, 16384, v63
    v_lshlrev_b32 v64, 16, v40
    v_and_b32 v65, 0xffff0000, v40
    v_lshlrev_b32 v80, 16, v48
    v_and_b32 v81, 0xffff0000, v48
    v_lshlrev_b32 v66, 16, v41
    v_and_b32 v67, 0xffff0000, v41
    v_lshlrev_b32 v82, 16, v49
    v_and_b32 v83, 0xffff0000, v49
    v_lshlrev_b32 v68, 16, v42
    v_and_b32 v69, 0xffff0000, v42
    v_lshlrev_b32 v84, 16, v50
    v_and_b32 v85, 0xffff0000, v50
    v_lshlrev_b32 v70, 16, v43
    v_and_b32 v71, 0xffff0000, v43
    v_lshlrev_b32 v86, 16, v51
    v_and_b32 v87, 0xffff0000, v51
    v_lshlrev_b32 v72, 16, v44
    v_and_b32 v73, 0xffff0000, v44
    v_lshlrev_b32 v88, 16, v52
    v_and_b32 v89, 0xffff0000, v52
    v_lshlrev_b32 v74, 16, v45
    v_and_b32 v75, 0xffff0000, v45
    v_lshlrev_b32 v90, 16, v53
    v_and_b32 v91, 0xffff0000, v53
    v_lshlrev_b32 v76, 16, v46
    v_and_b32 v77, 0xffff0000, v46
    v_lshlrev_b32 v92, 16, v54
    v_and_b32 v93, 0xffff0000, v54
    v_lshlrev_b32 v78, 16, v47
    v_and_b32 v79, 0xffff0000, v47
    v_lshlrev_b32 v94, 16, v55
    v_and_b32 v95, 0xffff0000, v55
    v_fma_f32 v64, v64, v56, v57
    v_fma_f32 v65, v65, v56, v57
    v_fma_f32 v66, v66, v56, v57
    v_fma_f32 v67, v67, v56, v57
    v_fma_f32 v68, v68, v56, v57
    v_fma_f32 v69, v69, v56, v57
    v_fma_f32 v70, v70, v56, v57
    v_fma_f32 v71, v71, v56, v57
    v_fma_f32 v72, v72, v56, v57
    v_fma_f32 v73, v73, v56, v57
    v_fma_f32 v74, v74, v56, v57
    v_fma_f32 v75, v75, v56, v57
    v_fma_f32 v76, v76, v56, v57
    v_fma_f32 v77, v77, v56, v57
    v_fma_f32 v78, v78, v56, v57
    v_fma_f32 v79, v79, v56, v57
    v_add_f32 v0, v0, v64
    v_add_f32 v1, v1, v65
    v_add_f32 v2, v2, v66
    v_add_f32 v3, v3, v67
    v_add_f32 v4, v4, v68
    v_add_f32 v5, v5, v69
    v_add_f32 v6, v6, v70
    v_add_f32 v7, v7, v71
    v_add_f32 v8, v8, v72
    v_add_f32 v9, v9, v73
    v_add_f32 v10, v10, v74
    v_add_f32 v11, v11, v75
    v_add_f32 v12, v12, v76
    v_add_f32 v13, v13, v77
    v_add_f32 v14, v14, v78
    v_add_f32 v15, v15, v79
    s_waitcnt lgkmcnt(0)
    s_barrier
    ds_read_b128 v[16:19], v63 offset:0
    ds_read_b128 v[20:23], v63 offset:1024
    ds_read_b128 v[24:27], v63 offset:2048
    ds_read_b128 v[28:31], v63 offset:3072
    s_waitcnt lgkmcnt(0)
    v_add_f32 v0, v0, v16
    v_add_f32 v1, v1, v17
    v_add_f32 v2, v2, v18
    v_add_f32 v3, v3, v19
    v_add_f32 v4, v4, v20
    v_add_f32 v5, v5, v21
    v_add_f32 v6, v6, v22
    v_add_f32 v7, v7, v23
    v_add_f32 v8, v8, v24
    v_add_f32 v9, v9, v25
    v_add_f32 v10, v10, v26
    v_add_f32 v11, v11, v27
    v_add_f32 v12, v12, v28
    v_add_f32 v13, v13, v29
    v_add_f32 v14, v14, v30
    v_add_f32 v15, v15, v31
    v_cvt_pk_bf16_f32 v32, v0, v1
    v_cvt_pk_bf16_f32 v33, v2, v3
    v_cvt_pk_bf16_f32 v34, v4, v5
    v_cvt_pk_bf16_f32 v35, v6, v7
    v_cvt_pk_bf16_f32 v36, v8, v9
    v_cvt_pk_bf16_f32 v37, v10, v11
    v_cvt_pk_bf16_f32 v38, v12, v13
    v_cvt_pk_bf16_f32 v39, v14, v15
    s_add_u32 s34, s35, 0x3000000
    buffer_store_dwordx4 v[32:35], v62, s[20:23], s34 offen
    buffer_store_dwordx4 v[36:39], v62, s[20:23], s34 offen offset:1024
    v_add_f32 v40, v0, v1
    v_mul_f32 v41, v0, v0
    v_mul_f32 v42, v0, v80
    v_fmac_f32 v41, v1, v1
    v_fmac_f32 v42, v1, v81
    v_add_f32 v40, v40, v2
    v_fmac_f32 v41, v2, v2
    v_fmac_f32 v42, v2, v82
    v_add_f32 v40, v40, v3
    v_fmac_f32 v41, v3, v3
    v_fmac_f32 v42, v3, v83
    v_add_f32 v40, v40, v4
    v_fmac_f32 v41, v4, v4
    v_fmac_f32 v42, v4, v84
    v_add_f32 v40, v40, v5
    v_fmac_f32 v41, v5, v5
    v_fmac_f32 v42, v5, v85
    v_add_f32 v40, v40, v6
    v_fmac_f32 v41, v6, v6
    v_fmac_f32 v42, v6, v86
    v_add_f32 v40, v40, v7
    v_fmac_f32 v41, v7, v7
    v_fmac_f32 v42, v7, v87
    v_add_f32 v40, v40, v8
    v_fmac_f32 v41, v8, v8
    v_fmac_f32 v42, v8, v88
    v_add_f32 v40, v40, v9
    v_fmac_f32 v41, v9, v9
    v_fmac_f32 v42, v9, v89
    v_add_f32 v40, v40, v10
    v_fmac_f32 v41, v10, v10
    v_fmac_f32 v42, v10, v90
    v_add_f32 v40, v40, v11
    v_fmac_f32 v41, v11, v11
    v_fmac_f32 v42, v11, v91
    v_add_f32 v40, v40, v12
    v_fmac_f32 v41, v12, v12
    v_fmac_f32 v42, v12, v92
    v_add_f32 v40, v40, v13
    v_fmac_f32 v41, v13, v13
    v_fmac_f32 v42, v13, v93
    v_add_f32 v40, v40, v14
    v_fmac_f32 v41, v14, v14
    v_fmac_f32 v42, v14, v94
    v_add_f32 v40, v40, v15
    v_fmac_f32 v41, v15, v15
    v_fmac_f32 v42, v15, v95
    v_mov_b32 v43, v42
    v_permlane32_swap_b32 v40, v41
    s_nop 0
    v_permlane32_swap_b32 v42, v43
    v_add_f32 v40, v40, v41
    v_add_f32 v42, v42, v43
    v_lshlrev_b32 v44, 2, v60
    v_lshl_add_u32 v45, v61, 13, v44
    s_lshl_b32 s34, s32, 7
    s_add_u32 s34, s34, 0x3400000
    buffer_atomic_add_f32 v40, v45, s[20:23], s34 offen sc1
    s_add_u32 s34, s34, 16384
    s_mov_b64 exec, 0xffffffff
    buffer_atomic_add_f32 v42, v44, s[20:23], s34 offen sc1
wo1_kernel_end:
    s_endpgm
.globl ffn1_kernel
.p2align 8
.type ffn1_kernel,@function
ffn1_kernel:
    s_cmp_ge_u32 s2, 256
    s_cbranch_scc1 ffn1_kernel_end
    s_load_dwordx4 s[4:7], s[0:1], 32
    s_load_dwordx4 s[8:11], s[0:1], 48
    s_load_dwordx2 s[44:45], s[0:1], 64
    s_load_dwordx2 s[46:47], s[0:1], 80
    v_lshrrev_b32 v1, 6, v0
    v_and_b32 v2, 63, v0
    v_readfirstlane_b32 s3, v1
    s_and_b32 s24, s2, 7
    s_lshr_b32 s25, s2, 3
    s_mul_i32 s26, s24, 28
    s_add_u32 s26, s26, s25
    s_waitcnt lgkmcnt(0)
    s_mov_b32 s12, s4
    s_mov_b32 s13, s5
    s_mov_b32 s14, 0x800
    s_mov_b32 s15, 0x20000
    s_mov_b32 s20, s46
    s_mov_b32 s21, s47
    s_mov_b32 s22, 0x8000000
    s_mov_b32 s23, 0x20000
    s_mov_b32 s28, s10
    s_mov_b32 s29, s11
    s_mov_b32 s30, 0x700000
    s_mov_b32 s31, 0x20000
    s_cmp_lt_u32 s3, 4
    s_cselect_b32 s16, s6, s8
    s_cselect_b32 s17, s7, s9
    s_mov_b32 s18, 7340032
    s_mov_b32 s19, 0x20000
    v_lshlrev_b32 v3, 4, v0
    s_mov_b32 s27, 0x3400000
    buffer_load_dwordx4 v[8:11], v3, s[20:23], s27 offen
    s_add_u32 s27, s27, 8192
    buffer_load_dwordx4 v[12:15], v3, s[20:23], s27 offen
    s_add_u32 s27, s27, 8192
    buffer_load_dwordx4 v[16:19], v3, s[20:23], s27 offen
    v_lshlrev_b32 v4, 5, v2
    buffer_load_dwordx4 v[20:23], v4, s[12:15], 0 offen
    buffer_load_dwordx4 v[24:27], v4, s[12:15], 0 offen offset:16
    s_mov_b32 s48, s44
    s_mov_b32 s49, s45
    s_mov_b32 s50, 0x400000
    s_mov_b32 s51, 0x20000
    s_lshl_b32 s27, s2, 14
    s_add_u32 s27, s27, 0x3000000
    buffer_load_dwordx4 v[100:103], v3, s[20:23], s27 offen
    s_add_u32 s27, s27, 8192
    buffer_load_dwordx4 v[104:107], v3, s[20:23], s27 offen
    s_cmp_lt_u32 s25, 28
    s_cselect_b32 s33, 0, 0x10000000
    v_lshrrev_b32 v5, 1, v2
    v_mul_u32_u24 v5, 7168, v5
    v_and_b32 v6, 1, v2
    v_lshl_add_u32 v5, v6, 4, v5
    v_add_u32 v5, s33, v5
    s_and_b32 s34, s3, 3
    s_mul_i32 s34, s34, 1835008
    s_lshl_b32 s35, s26, 5
    s_add_u32 s34, s34, s35
    buffer_load_dwordx4 v[32:35], v5, s[16:19], s34 offen
    s_add_u32 s34, s34, 229376
    buffer_load_dwordx4 v[36:39], v5, s[16:19], s34 offen
    s_add_u32 s34, s34, 229376
    buffer_load_dwordx4 v[40:43], v5, s[16:19], s34 offen
    s_add_u32 s34, s34, 229376
    buffer_load_dwordx4 v[44:47], v5, s[16:19], s34 offen
    s_add_u32 s34, s34, 229376
    buffer_load_dwordx4 v[48:51], v5, s[16:19], s34 offen
    s_add_u32 s34, s34, 229376
    buffer_load_dwordx4 v[52:55], v5, s[16:19], s34 offen
    s_add_u32 s34, s34, 229376
    buffer_load_dwordx4 v[56:59], v5, s[16:19], s34 offen
    s_add_u32 s34, s34, 229376
    buffer_load_dwordx4 v[60:63], v5, s[16:19], s34 offen
    v_lshrrev_b32 v6, 4, v2
    v_lshlrev_b32 v6, 11, v6
    v_and_b32 v7, 15, v2
    v_lshl_add_u32 v6, v7, 4, v6
    v_add_u32 v6, s33, v6
    s_lshl_b32 s34, s26, 15
    s_lshl_b32 s35, s3, 8
    s_add_u32 s34, s34, s35
    buffer_load_dwordx4 v[64:67], v6, s[28:31], s34 offen
    s_add_u32 s34, s34, 8192
    buffer_load_dwordx4 v[68:71], v6, s[28:31], s34 offen
    s_add_u32 s34, s34, 8192
    buffer_load_dwordx4 v[72:75], v6, s[28:31], s34 offen
    s_add_u32 s34, s34, 8192
    buffer_load_dwordx4 v[76:79], v6, s[28:31], s34 offen
    s_waitcnt vmcnt(14)
    v_mov_b32 v28, 0
    v_lshlrev_b32 v29, 16, v20
    v_and_b32 v30, 0xffff0000, v20
    v_add_f32 v28, v28, v29
    v_add_f32 v28, v28, v30
    v_lshlrev_b32 v29, 16, v21
    v_and_b32 v30, 0xffff0000, v21
    v_add_f32 v28, v28, v29
    v_add_f32 v28, v28, v30
    v_lshlrev_b32 v29, 16, v22
    v_and_b32 v30, 0xffff0000, v22
    v_add_f32 v28, v28, v29
    v_add_f32 v28, v28, v30
    v_lshlrev_b32 v29, 16, v23
    v_and_b32 v30, 0xffff0000, v23
    v_add_f32 v28, v28, v29
    v_add_f32 v28, v28, v30
    v_lshlrev_b32 v29, 16, v24
    v_and_b32 v30, 0xffff0000, v24
    v_add_f32 v28, v28, v29
    v_add_f32 v28, v28, v30
    v_lshlrev_b32 v29, 16, v25
    v_and_b32 v30, 0xffff0000, v25
    v_add_f32 v28, v28, v29
    v_add_f32 v28, v28, v30
    v_lshlrev_b32 v29, 16, v26
    v_and_b32 v30, 0xffff0000, v26
    v_add_f32 v28, v28, v29
    v_add_f32 v28, v28, v30
    v_lshlrev_b32 v29, 16, v27
    v_and_b32 v30, 0xffff0000, v27
    v_add_f32 v28, v28, v29
    v_add_f32 v28, v28, v30
    s_nop 1
    v_add_f32_dpp v28, v28, v28 quad_perm:[1,0,3,2] row_mask:0xf bank_mask:0xf
    s_nop 1
    v_add_f32_dpp v28, v28, v28 quad_perm:[2,3,0,1] row_mask:0xf bank_mask:0xf
    s_nop 1
    v_add_f32_dpp v28, v28, v28 row_half_mirror row_mask:0xf bank_mask:0xf
    s_nop 1
    v_add_f32_dpp v28, v28, v28 row_mirror row_mask:0xf bank_mask:0xf
    v_mov_b32 v29, v28
    s_nop 1
    v_permlane16_swap_b32 v28, v29
    v_add_f32 v28, v28, v29
    v_mov_b32 v29, v28
    s_nop 1
    v_permlane32_swap_b32 v28, v29
    v_add_f32 v28, v28, v29
    v_mul_f32 v8, 0x3a800000, v8
    v_mul_f32 v20, 0x3a800000, v12
    v_fma_f32 v20, -v8, v8, v20
    v_max_f32 v20, 0, v20
    v_add_f32 v12, 0x3727c5ac, v20
    v_rsq_f32 v12, v12
    v_fma_f32 v16, -v8, v28, v16
    v_mul_f32 v16, v16, v12
    v_mul_f32 v9, 0x3a800000, v9
    v_mul_f32 v21, 0x3a800000, v13
    v_fma_f32 v21, -v9, v9, v21
    v_max_f32 v21, 0, v21
    v_add_f32 v13, 0x3727c5ac, v21
    v_rsq_f32 v13, v13
    v_fma_f32 v17, -v9, v28, v17
    v_mul_f32 v17, v17, v13
    v_mul_f32 v10, 0x3a800000, v10
    v_mul_f32 v22, 0x3a800000, v14
    v_fma_f32 v22, -v10, v10, v22
    v_max_f32 v22, 0, v22
    v_add_f32 v14, 0x3727c5ac, v22
    v_rsq_f32 v14, v14
    v_fma_f32 v18, -v10, v28, v18
    v_mul_f32 v18, v18, v14
    v_mul_f32 v11, 0x3a800000, v11
    v_mul_f32 v23, 0x3a800000, v15
    v_fma_f32 v23, -v11, v11, v23
    v_max_f32 v23, 0, v23
    v_add_f32 v15, 0x3727c5ac, v23
    v_rsq_f32 v15, v15
    v_fma_f32 v19, -v11, v28, v19
    v_mul_f32 v19, v19, v15
    ds_write_b128 v3, v[8:11]
    ds_write_b128 v3, v[12:15] offset:8192
    ds_write_b128 v3, v[16:19] offset:16384
    v_max3_f32 v29, v16, v17, v18
    v_max_f32 v29, v29, v19
    s_nop 1
    v_max_f32_dpp v29, v29, v29 quad_perm:[1,0,3,2] row_mask:0xf bank_mask:0xf
    s_nop 1
    v_max_f32_dpp v29, v29, v29 quad_perm:[2,3,0,1] row_mask:0xf bank_mask:0xf
    s_nop 1
    v_max_f32_dpp v29, v29, v29 row_half_mirror row_mask:0xf bank_mask:0xf
    s_nop 1
    v_max_f32_dpp v29, v29, v29 row_mirror row_mask:0xf bank_mask:0xf
    v_mov_b32 v30, v29
    s_nop 1
    v_permlane16_swap_b32 v29, v30
    v_max_f32 v29, v29, v30
    v_mov_b32 v30, v29
    s_nop 1
    v_permlane32_swap_b32 v29, v30
    v_max_f32 v29, v29, v30
    v_lshlrev_b32 v30, 2, v1
    ds_write_b32 v30, v29 offset:24576
    v_mov_b32 v31, 0x7fffffff
    v_mov_b32 v30, 0
    ds_write_b32 v30, v31 offset:24640
    s_waitcnt lgkmcnt(0)
    s_barrier
    ds_read_b128 v[92:95], v30 offset:24576
    ds_read_b128 v[96:99], v30 offset:24592
    s_waitcnt lgkmcnt(0)
    v_max3_f32 v29, v92, v93, v94
    v_max3_f32 v29, v29, v95, v96
    v_max3_f32 v29, v29, v97, v98
    v_max_f32 v29, v29, v99
    v_lshlrev_b32 v92, 2, v0
    v_cmp_eq_f32 vcc, v29, v19
    v_add_u32 v93, 3, v92
    s_nop 0
    v_cndmask_b32 v31, v31, v93, vcc
    v_cmp_eq_f32 vcc, v29, v18
    v_add_u32 v93, 2, v92
    s_nop 0
    v_cndmask_b32 v31, v31, v93, vcc
    v_cmp_eq_f32 vcc, v29, v17
    v_add_u32 v93, 1, v92
    s_nop 0
    v_cndmask_b32 v31, v31, v93, vcc
    v_cmp_eq_f32 vcc, v29, v16
    v_add_u32 v93, 0, v92
    s_nop 0
    v_cndmask_b32 v31, v31, v93, vcc
    v_cmp_gt_u32 vcc, 0x7fffffff, v31
    s_and_saveexec_b64 s[36:37], vcc
    ds_min_u32 v30, v31 offset:24640
    s_mov_b64 exec, s[36:37]
    s_waitcnt lgkmcnt(0)
    s_barrier
    ds_read_b32 v31, v30 offset:24640
    s_waitcnt lgkmcnt(0)
    v_and_b32 v31, 2047, v31
    v_lshlrev_b32 v92, 2, v31
    ds_read_b32 v93, v92
    ds_read_b32 v94, v92 offset:8192
    v_lshrrev_b32 v95, 7, v31
    v_lshlrev_b32 v95, 18, v95
    v_bfe_u32 v96, v31, 5, 2
    v_lshl_add_u32 v95, v96, 12, v95
    v_and_b32 v96, 31, v31
    v_lshl_add_u32 v95, v96, 4, v95
    v_bfe_u32 v96, v0, 3, 4
    v_lshl_add_u32 v95, v96, 14, v95
    v_and_b32 v96, 7, v0
    v_lshl_add_u32 v95, v96, 9, v95
    s_mov_b32 s27, 0x3000000
    buffer_load_dwordx4 v[108:111], v95, s[20:23], s27 offen
    s_waitcnt lgkmcnt(0)
    v_mov_b32 v112, v31
    v_mov_b32 v113, v29
    v_mov_b32 v114, v93
    v_mov_b32 v115, v94
    v_or_b32 v96, s2, v0
    v_cmp_eq_u32 vcc, 0, v96
    s_and_saveexec_b64 s[36:37], vcc
    s_mov_b32 s27, 0x3450000
    buffer_store_dwordx4 v[112:115], v30, s[20:23], s27 offen
    s_mov_b64 exec, s[36:37]
    s_lshr_b32 s38, s2, 4
    s_and_b32 s39, s2, 15
    s_lshr_b32 s40, s3, 2
    s_lshl_b32 s41, s38, 7
    s_lshl_b32 s42, s40, 5
    s_add_u32 s41, s41, s42
    v_and_b32 v96, 31, v2
    v_add_u32 v96, s41, v96
    v_lshlrev_b32 v97, 2, v96
    ds_read_b32 v116, v97
    ds_read_b32 v117, v97 offset:8192
    ds_read_b32 v118, v97 offset:256
    ds_read_b32 v119, v97 offset:8448
    v_lshlrev_b32 v96, 11, v96
    v_lshrrev_b32 v97, 5, v2
    v_lshl_add_u32 v96, v97, 4, v96
    s_and_b32 s42, s3, 3
    s_lshl_b32 s42, s42, 5
    s_lshl_b32 s39, s39, 7
    s_add_u32 s42, s42, s39
    s_waitcnt lgkmcnt(0)
    v_mul_f32 v116, v116, v117
    v_add_f32 v117, 1.0, v117
    v_lshlrev_b32 v120, 16, v100
    v_and_b32 v121, 0xffff0000, v100
    v_fma_f32 v120, v120, v117, -v116
    v_fma_f32 v121, v121, v117, -v116
    v_cvt_pk_bf16_f32 v100, v120, v121
    v_lshlrev_b32 v120, 16, v101
    v_and_b32 v121, 0xffff0000, v101
    v_fma_f32 v120, v120, v117, -v116
    v_fma_f32 v121, v121, v117, -v116
    v_cvt_pk_bf16_f32 v101, v120, v121
    v_lshlrev_b32 v120, 16, v102
    v_and_b32 v121, 0xffff0000, v102
    v_fma_f32 v120, v120, v117, -v116
    v_fma_f32 v121, v121, v117, -v116
    v_cvt_pk_bf16_f32 v102, v120, v121
    v_lshlrev_b32 v120, 16, v103
    v_and_b32 v121, 0xffff0000, v103
    v_fma_f32 v120, v120, v117, -v116
    v_fma_f32 v121, v121, v117, -v116
    v_cvt_pk_bf16_f32 v103, v120, v121
    v_permlane32_swap_b32 v100, v102
    s_nop 0
    v_permlane32_swap_b32 v101, v103
    buffer_store_dwordx4 v[100:103], v96, s[48:51], s42 offen
    s_add_u32 s42, s42, 131072
    v_mul_f32 v118, v118, v119
    v_add_f32 v119, 1.0, v119
    v_lshlrev_b32 v120, 16, v104
    v_and_b32 v121, 0xffff0000, v104
    v_fma_f32 v120, v120, v119, -v118
    v_fma_f32 v121, v121, v119, -v118
    v_cvt_pk_bf16_f32 v104, v120, v121
    v_lshlrev_b32 v120, 16, v105
    v_and_b32 v121, 0xffff0000, v105
    v_fma_f32 v120, v120, v119, -v118
    v_fma_f32 v121, v121, v119, -v118
    v_cvt_pk_bf16_f32 v105, v120, v121
    v_lshlrev_b32 v120, 16, v106
    v_and_b32 v121, 0xffff0000, v106
    v_fma_f32 v120, v120, v119, -v118
    v_fma_f32 v121, v121, v119, -v118
    v_cvt_pk_bf16_f32 v106, v120, v121
    v_lshlrev_b32 v120, 16, v107
    v_and_b32 v121, 0xffff0000, v107
    v_fma_f32 v120, v120, v119, -v118
    v_fma_f32 v121, v121, v119, -v118
    v_cvt_pk_bf16_f32 v107, v120, v121
    v_permlane32_swap_b32 v104, v106
    s_nop 0
    v_permlane32_swap_b32 v105, v107
    buffer_store_dwordx4 v[104:107], v96, s[48:51], s42 offen
    s_add_u32 s42, s42, 131072
    s_waitcnt vmcnt(3)
    v_lshlrev_b32 v120, 16, v108
    v_and_b32 v121, 0xffff0000, v108
    v_lshlrev_b32 v122, 16, v109
    v_and_b32 v123, 0xffff0000, v109
    v_lshlrev_b32 v124, 16, v110
    v_and_b32 v125, 0xffff0000, v110
    v_lshlrev_b32 v126, 16, v111
    v_and_b32 v127, 0xffff0000, v111
    v_sub_f32 v120, v120, v93
    v_mul_f32 v120, v120, v94
    v_sub_f32 v121, v121, v93
    v_mul_f32 v121, v121, v94
    v_sub_f32 v122, v122, v93
    v_mul_f32 v122, v122, v94
    v_sub_f32 v123, v123, v93
    v_mul_f32 v123, v123, v94
    v_sub_f32 v124, v124, v93
    v_mul_f32 v124, v124, v94
    v_sub_f32 v125, v125, v93
    v_mul_f32 v125, v125, v94
    v_sub_f32 v126, v126, v93
    v_mul_f32 v126, v126, v94
    v_sub_f32 v127, v127, v93
    v_mul_f32 v127, v127, v94
    v_lshrrev_b32 v96, 1, v0
    v_lshlrev_b32 v96, 6, v96
    v_and_b32 v97, 1, v0
    v_lshl_add_u32 v96, v97, 4, v96
    v_cmp_gt_u32 vcc, 128, v0
    s_and_saveexec_b64 s[36:37], vcc
    ds_write_b128 v96, v[120:123] offset:32768
    ds_write_b128 v96, v[124:127] offset:32800
    s_mov_b64 exec, s[36:37]
    s_waitcnt lgkmcnt(0)
    s_barrier
    s_and_b32 s34, s3, 3
    s_lshl_b32 s34, s34, 10
    v_lshrrev_b32 v96, 1, v2
    v_lshl_add_u32 v96, v96, 2, s34
    ds_read_b32 v108, v96 offset:32768
    ds_read_b32 v109, v96 offset:32896
    ds_read_b32 v110, v96 offset:33024
    ds_read_b32 v111, v96 offset:33152
    ds_read_b32 v112, v96 offset:33280
    ds_read_b32 v113, v96 offset:33408
    ds_read_b32 v114, v96 offset:33536
    ds_read_b32 v115, v96 offset:33664
    s_waitcnt lgkmcnt(0)
    v_lshlrev_b32 v116, 16, v32
    v_and_b32 v117, 0xffff0000, v32
    v_mul_f32 v120, v116, v108
    v_mul_f32 v121, v117, v108
    v_lshlrev_b32 v116, 16, v33
    v_and_b32 v117, 0xffff0000, v33
    v_mul_f32 v122, v116, v108
    v_mul_f32 v123, v117, v108
    v_lshlrev_b32 v116, 16, v34
    v_and_b32 v117, 0xffff0000, v34
    v_mul_f32 v124, v116, v108
    v_mul_f32 v125, v117, v108
    v_lshlrev_b32 v116, 16, v35
    v_and_b32 v117, 0xffff0000, v35
    v_mul_f32 v126, v116, v108
    v_mul_f32 v127, v117, v108
    v_lshlrev_b32 v116, 16, v36
    v_and_b32 v117, 0xffff0000, v36
    v_fmac_f32 v120, v116, v109
    v_fmac_f32 v121, v117, v109
    v_lshlrev_b32 v116, 16, v37
    v_and_b32 v117, 0xffff0000, v37
    v_fmac_f32 v122, v116, v109
    v_fmac_f32 v123, v117, v109
    v_lshlrev_b32 v116, 16, v38
    v_and_b32 v117, 0xffff0000, v38
    v_fmac_f32 v124, v116, v109
    v_fmac_f32 v125, v117, v109
    v_lshlrev_b32 v116, 16, v39
    v_and_b32 v117, 0xffff0000, v39
    v_fmac_f32 v126, v116, v109
    v_fmac_f32 v127, v117, v109
    v_lshlrev_b32 v116, 16, v40
    v_and_b32 v117, 0xffff0000, v40
    v_fmac_f32 v120, v116, v110
    v_fmac_f32 v121, v117, v110
    v_lshlrev_b32 v116, 16, v41
    v_and_b32 v117, 0xffff0000, v41
    v_fmac_f32 v122, v116, v110
    v_fmac_f32 v123, v117, v110
    v_lshlrev_b32 v116, 16, v42
    v_and_b32 v117, 0xffff0000, v42
    v_fmac_f32 v124, v116, v110
    v_fmac_f32 v125, v117, v110
    v_lshlrev_b32 v116, 16, v43
    v_and_b32 v117, 0xffff0000, v43
    v_fmac_f32 v126, v116, v110
    v_fmac_f32 v127, v117, v110
    v_lshlrev_b32 v116, 16, v44
    v_and_b32 v117, 0xffff0000, v44
    v_fmac_f32 v120, v116, v111
    v_fmac_f32 v121, v117, v111
    v_lshlrev_b32 v116, 16, v45
    v_and_b32 v117, 0xffff0000, v45
    v_fmac_f32 v122, v116, v111
    v_fmac_f32 v123, v117, v111
    v_lshlrev_b32 v116, 16, v46
    v_and_b32 v117, 0xffff0000, v46
    v_fmac_f32 v124, v116, v111
    v_fmac_f32 v125, v117, v111
    v_lshlrev_b32 v116, 16, v47
    v_and_b32 v117, 0xffff0000, v47
    v_fmac_f32 v126, v116, v111
    v_fmac_f32 v127, v117, v111
    v_lshlrev_b32 v116, 16, v48
    v_and_b32 v117, 0xffff0000, v48
    v_fmac_f32 v120, v116, v112
    v_fmac_f32 v121, v117, v112
    v_lshlrev_b32 v116, 16, v49
    v_and_b32 v117, 0xffff0000, v49
    v_fmac_f32 v122, v116, v112
    v_fmac_f32 v123, v117, v112
    v_lshlrev_b32 v116, 16, v50
    v_and_b32 v117, 0xffff0000, v50
    v_fmac_f32 v124, v116, v112
    v_fmac_f32 v125, v117, v112
    v_lshlrev_b32 v116, 16, v51
    v_and_b32 v117, 0xffff0000, v51
    v_fmac_f32 v126, v116, v112
    v_fmac_f32 v127, v117, v112
    v_lshlrev_b32 v116, 16, v52
    v_and_b32 v117, 0xffff0000, v52
    v_fmac_f32 v120, v116, v113
    v_fmac_f32 v121, v117, v113
    v_lshlrev_b32 v116, 16, v53
    v_and_b32 v117, 0xffff0000, v53
    v_fmac_f32 v122, v116, v113
    v_fmac_f32 v123, v117, v113
    v_lshlrev_b32 v116, 16, v54
    v_and_b32 v117, 0xffff0000, v54
    v_fmac_f32 v124, v116, v113
    v_fmac_f32 v125, v117, v113
    v_lshlrev_b32 v116, 16, v55
    v_and_b32 v117, 0xffff0000, v55
    v_fmac_f32 v126, v116, v113
    v_fmac_f32 v127, v117, v113
    v_lshlrev_b32 v116, 16, v56
    v_and_b32 v117, 0xffff0000, v56
    v_fmac_f32 v120, v116, v114
    v_fmac_f32 v121, v117, v114
    v_lshlrev_b32 v116, 16, v57
    v_and_b32 v117, 0xffff0000, v57
    v_fmac_f32 v122, v116, v114
    v_fmac_f32 v123, v117, v114
    v_lshlrev_b32 v116, 16, v58
    v_and_b32 v117, 0xffff0000, v58
    v_fmac_f32 v124, v116, v114
    v_fmac_f32 v125, v117, v114
    v_lshlrev_b32 v116, 16, v59
    v_and_b32 v117, 0xffff0000, v59
    v_fmac_f32 v126, v116, v114
    v_fmac_f32 v127, v117, v114
    v_lshlrev_b32 v116, 16, v60
    v_and_b32 v117, 0xffff0000, v60
    v_fmac_f32 v120, v116, v115
    v_fmac_f32 v121, v117, v115
    v_lshlrev_b32 v116, 16, v61
    v_and_b32 v117, 0xffff0000, v61
    v_fmac_f32 v122, v116, v115
    v_fmac_f32 v123, v117, v115
    v_lshlrev_b32 v116, 16, v62
    v_and_b32 v117, 0xffff0000, v62
    v_fmac_f32 v124, v116, v115
    v_fmac_f32 v125, v117, v115
    v_lshlrev_b32 v116, 16, v63
    v_and_b32 v117, 0xffff0000, v63
    v_fmac_f32 v126, v116, v115
    v_fmac_f32 v127, v117, v115
    v_permlane32_swap_b32 v120, v124
    v_permlane32_swap_b32 v121, v125
    v_permlane32_swap_b32 v122, v126
    v_permlane32_swap_b32 v123, v127
    v_add_f32 v120, v120, v124
    v_add_f32 v121, v121, v125
    v_add_f32 v122, v122, v126
    v_add_f32 v123, v123, v127
    s_nop 0
    v_permlane16_swap_b32 v120, v122
    v_permlane16_swap_b32 v121, v123
    v_add_f32 v120, v120, v122
    v_add_f32 v121, v121, v123
    s_nop 0
    v_add_f32_dpp v120, v120, v120 quad_perm:[2,3,0,1] row_mask:0xf bank_mask:0xf
    v_add_f32_dpp v121, v121, v121 quad_perm:[2,3,0,1] row_mask:0xf bank_mask:0xf
    s_nop 0
    v_add_f32_dpp v120, v120, v120 row_ror:4 row_mask:0xf bank_mask:0xf
    v_add_f32_dpp v121, v121, v121 row_ror:4 row_mask:0xf bank_mask:0xf
    s_nop 0
    v_add_f32_dpp v120, v120, v120 row_ror:8 row_mask:0xf bank_mask:0xf
    v_add_f32_dpp v121, v121, v121 row_ror:8 row_mask:0xf bank_mask:0xf
    v_and_b32 v96, 1, v2
    v_lshrrev_b32 v97, 4, v2
    v_lshlrev_b32 v97, 3, v97
    v_lshl_add_u32 v96, v96, 5, v97
    s_lshl_b32 s34, s3, 6
    v_add_u32 v96, s34, v96
    ds_write_b64 v96, v[120:121] offset:40960
    s_waitcnt lgkmcnt(0)
    s_barrier
    v_and_b32 v96, 15, v2
    v_lshlrev_b32 v96, 2, v96
    ds_read_b32 v108, v96 offset:40960
    ds_read_b32 v109, v96 offset:41024
    ds_read_b32 v110, v96 offset:41088
    ds_read_b32 v111, v96 offset:41152
    ds_read_b32 v112, v96 offset:41216
    ds_read_b32 v113, v96 offset:41280
    ds_read_b32 v114, v96 offset:41344
    ds_read_b32 v115, v96 offset:41408
    s_waitcnt lgkmcnt(0)
    v_add_f32 v108, v108, v109
    v_add_f32 v110, v110, v111
    v_add_f32 v112, v112, v113
    v_add_f32 v114, v114, v115
    v_add_f32 v108, v108, v110
    v_add_f32 v112, v112, v114
    v_mul_f32 v109, 0xbfb8aa3b, v108
    v_exp_f32 v109, v109
    s_nop 0
    v_add_f32 v109, 1.0, v109
    v_rcp_f32 v109, v109
    s_nop 0
    v_mul_f32 v108, v108, v109
    v_mul_f32 v108, v108, v112
    v_lshrrev_b32 v96, 4, v2
    v_lshlrev_b32 v96, 2, v96
    ds_bpermute_b32 v112, v96, v108 offset:0
    ds_bpermute_b32 v113, v96, v108 offset:16
    ds_bpermute_b32 v114, v96, v108 offset:32
    ds_bpermute_b32 v115, v96, v108 offset:48
    s_waitcnt lgkmcnt(0)
    v_lshlrev_b32 v116, 16, v64
    v_and_b32 v117, 0xffff0000, v64
    v_mul_f32 v120, v116, v112
    v_mul_f32 v121, v117, v112
    v_lshlrev_b32 v116, 16, v65
    v_and_b32 v117, 0xffff0000, v65
    v_mul_f32 v122, v116, v112
    v_mul_f32 v123, v117, v112
    v_lshlrev_b32 v116, 16, v66
    v_and_b32 v117, 0xffff0000, v66
    v_mul_f32 v124, v116, v112
    v_mul_f32 v125, v117, v112
    v_lshlrev_b32 v116, 16, v67
    v_and_b32 v117, 0xffff0000, v67
    v_mul_f32 v126, v116, v112
    v_mul_f32 v127, v117, v112
    v_lshlrev_b32 v116, 16, v68
    v_and_b32 v117, 0xffff0000, v68
    v_fmac_f32 v120, v116, v113
    v_fmac_f32 v121, v117, v113
    v_lshlrev_b32 v116, 16, v69
    v_and_b32 v117, 0xffff0000, v69
    v_fmac_f32 v122, v116, v113
    v_fmac_f32 v123, v117, v113
    v_lshlrev_b32 v116, 16, v70
    v_and_b32 v117, 0xffff0000, v70
    v_fmac_f32 v124, v116, v113
    v_fmac_f32 v125, v117, v113
    v_lshlrev_b32 v116, 16, v71
    v_and_b32 v117, 0xffff0000, v71
    v_fmac_f32 v126, v116, v113
    v_fmac_f32 v127, v117, v113
    v_lshlrev_b32 v116, 16, v72
    v_and_b32 v117, 0xffff0000, v72
    v_fmac_f32 v120, v116, v114
    v_fmac_f32 v121, v117, v114
    v_lshlrev_b32 v116, 16, v73
    v_and_b32 v117, 0xffff0000, v73
    v_fmac_f32 v122, v116, v114
    v_fmac_f32 v123, v117, v114
    v_lshlrev_b32 v116, 16, v74
    v_and_b32 v117, 0xffff0000, v74
    v_fmac_f32 v124, v116, v114
    v_fmac_f32 v125, v117, v114
    v_lshlrev_b32 v116, 16, v75
    v_and_b32 v117, 0xffff0000, v75
    v_fmac_f32 v126, v116, v114
    v_fmac_f32 v127, v117, v114
    v_lshlrev_b32 v116, 16, v76
    v_and_b32 v117, 0xffff0000, v76
    v_fmac_f32 v120, v116, v115
    v_fmac_f32 v121, v117, v115
    v_lshlrev_b32 v116, 16, v77
    v_and_b32 v117, 0xffff0000, v77
    v_fmac_f32 v122, v116, v115
    v_fmac_f32 v123, v117, v115
    v_lshlrev_b32 v116, 16, v78
    v_and_b32 v117, 0xffff0000, v78
    v_fmac_f32 v124, v116, v115
    v_fmac_f32 v125, v117, v115
    v_lshlrev_b32 v116, 16, v79
    v_and_b32 v117, 0xffff0000, v79
    v_fmac_f32 v126, v116, v115
    v_fmac_f32 v127, v117, v115
    v_permlane32_swap_b32 v120, v124
    v_permlane32_swap_b32 v121, v125
    v_permlane32_swap_b32 v122, v126
    v_permlane32_swap_b32 v123, v127
    v_add_f32 v120, v120, v124
    v_add_f32 v121, v121, v125
    v_add_f32 v122, v122, v126
    v_add_f32 v123, v123, v127
    s_nop 0
    v_permlane16_swap_b32 v120, v122
    v_permlane16_swap_b32 v121, v123
    v_add_f32 v120, v120, v122
    v_add_f32 v121, v121, v123
    s_cmp_ge_u32 s25, 28
    s_cbranch_scc1 ffn1_kernel_end
    v_and_b32 v96, 15, v2
    v_lshlrev_b32 v96, 5, v96
    v_lshrrev_b32 v97, 4, v2
    v_lshl_add_u32 v96, v97, 3, v96
    s_and_b32 s34, s26, 15
    s_lshl_b32 s34, s34, 12
    s_lshl_b32 s35, s3, 9
    s_add_u32 s34, s34, s35
    s_add_u32 s34, s34, 0x3410000
    buffer_atomic_add_f32 v120, v96, s[20:23], s34 offen sc1
    buffer_atomic_add_f32 v121, v96, s[20:23], s34 offen offset:4 sc1
ffn1_kernel_end:
    s_endpgm
.globl fix1_kernel
.p2align 8
.type fix1_kernel,@function
fix1_kernel:
    s_cmp_ge_u32 s2, 1
    s_cbranch_scc1 fix1_kernel_end
    s_load_dwordx2 s[44:45], s[0:1], 64
    s_load_dwordx2 s[46:47], s[0:1], 80
    s_waitcnt lgkmcnt(0)
    s_mov_b32 s20, s46
    s_mov_b32 s21, s47
    s_mov_b32 s22, 0x8000000
    s_mov_b32 s23, 0x20000
    s_mov_b32 s48, s44
    s_mov_b32 s49, s45
    s_mov_b32 s50, 0x400000
    s_mov_b32 s51, 0x20000
    v_mov_b32 v1, 0
    s_mov_b32 s27, 0x3450000
    buffer_load_dwordx4 v[4:7], v1, s[20:23], s27 offen
    v_lshlrev_b32 v2, 4, v0
    s_mov_b32 s27, 0x3410000
    buffer_load_dwordx4 v[16:19], v2, s[20:23], s27 offen
    s_add_u32 s27, s27, 4096
    buffer_load_dwordx4 v[20:23], v2, s[20:23], s27 offen
    s_add_u32 s27, s27, 4096
    buffer_load_dwordx4 v[24:27], v2, s[20:23], s27 offen
    s_add_u32 s27, s27, 4096
    buffer_load_dwordx4 v[28:31], v2, s[20:23], s27 offen
    s_add_u32 s27, s27, 4096
    buffer_load_dwordx4 v[32:35], v2, s[20:23], s27 offen
    s_add_u32 s27, s27, 4096
    buffer_load_dwordx4 v[36:39], v2, s[20:23], s27 offen
    s_add_u32 s27, s27, 4096
    buffer_load_dwordx4 v[40:43], v2, s[20:23], s27 offen
    s_add_u32 s27, s27, 4096
    buffer_load_dwordx4 v[44:47], v2, s[20:23], s27 offen
    s_add_u32 s27, s27, 4096
    buffer_load_dwordx4 v[48:51], v2, s[20:23], s27 offen
    s_add_u32 s27, s27, 4096
    buffer_load_dwordx4 v[52:55], v2, s[20:23], s27 offen
    s_add_u32 s27, s27, 4096
    buffer_load_dwordx4 v[56:59], v2, s[20:23], s27 offen
    s_add_u32 s27, s27, 4096
    buffer_load_dwordx4 v[60:63], v2, s[20:23], s27 offen
    s_add_u32 s27, s27, 4096
    buffer_load_dwordx4 v[64:67], v2, s[20:23], s27 offen
    s_add_u32 s27, s27, 4096
    buffer_load_dwordx4 v[68:71], v2, s[20:23], s27 offen
    s_add_u32 s27, s27, 4096
    buffer_load_dwordx4 v[72:75], v2, s[20:23], s27 offen
    s_add_u32 s27, s27, 4096
    buffer_load_dwordx4 v[76:79], v2, s[20:23], s27 offen
    s_add_u32 s27, s27, 4096
    s_waitcnt vmcnt(16)
    v_and_b32 v4, 2047, v4
    v_lshrrev_b32 v8, 7, v4
    v_lshlrev_b32 v8, 18, v8
    v_bfe_u32 v9, v4, 5, 2
    v_lshl_add_u32 v8, v9, 12, v8
    v_and_b32 v9, 31, v4
    v_lshl_add_u32 v8, v9, 4, v8
    v_lshrrev_b32 v9, 4, v0
    v_lshl_add_u32 v8, v9, 14, v8
    v_bfe_u32 v9, v0, 2, 2
    v_lshl_add_u32 v8, v9, 10, v8
    v_and_b32 v9, 1, v0
    v_lshl_add_u32 v8, v9, 9, v8
    v_bfe_u32 v9, v0, 1, 1
    v_lshl_add_u32 v8, v9, 3, v8
    s_mov_b32 s28, 0x3000000
    buffer_load_dwordx2 v[10:11], v8, s[20:23], s28 offen
    v_mul_f32 v5, 0xbfb8aa3b, v5
    v_exp_f32 v5, v5
    s_nop 0
    v_add_f32 v5, 1.0, v5
    v_rcp_f32 v5, v5
    v_mul_f32 v6, v6, v7
    v_add_f32 v7, 1.0, v7
    s_waitcnt vmcnt(0)
    v_add_f32 v16, v16, v20
    v_add_f32 v17, v17, v21
    v_add_f32 v18, v18, v22
    v_add_f32 v19, v19, v23
    v_add_f32 v16, v16, v24
    v_add_f32 v17, v17, v25
    v_add_f32 v18, v18, v26
    v_add_f32 v19, v19, v27
    v_add_f32 v16, v16, v28
    v_add_f32 v17, v17, v29
    v_add_f32 v18, v18, v30
    v_add_f32 v19, v19, v31
    v_add_f32 v16, v16, v32
    v_add_f32 v17, v17, v33
    v_add_f32 v18, v18, v34
    v_add_f32 v19, v19, v35
    v_add_f32 v16, v16, v36
    v_add_f32 v17, v17, v37
    v_add_f32 v18, v18, v38
    v_add_f32 v19, v19, v39
    v_add_f32 v16, v16, v40
    v_add_f32 v17, v17, v41
    v_add_f32 v18, v18, v42
    v_add_f32 v19, v19, v43
    v_add_f32 v16, v16, v44
    v_add_f32 v17, v17, v45
    v_add_f32 v18, v18, v46
    v_add_f32 v19, v19, v47
    v_add_f32 v16, v16, v48
    v_add_f32 v17, v17, v49
    v_add_f32 v18, v18, v50
    v_add_f32 v19, v19, v51
    v_add_f32 v16, v16, v52
    v_add_f32 v17, v17, v53
    v_add_f32 v18, v18, v54
    v_add_f32 v19, v19, v55
    v_add_f32 v16, v16, v56
    v_add_f32 v17, v17, v57
    v_add_f32 v18, v18, v58
    v_add_f32 v19, v19, v59
    v_add_f32 v16, v16, v60
    v_add_f32 v17, v17, v61
    v_add_f32 v18, v18, v62
    v_add_f32 v19, v19, v63
    v_add_f32 v16, v16, v64
    v_add_f32 v17, v17, v65
    v_add_f32 v18, v18, v66
    v_add_f32 v19, v19, v67
    v_add_f32 v16, v16, v68
    v_add_f32 v17, v17, v69
    v_add_f32 v18, v18, v70
    v_add_f32 v19, v19, v71
    v_add_f32 v16, v16, v72
    v_add_f32 v17, v17, v73
    v_add_f32 v18, v18, v74
    v_add_f32 v19, v19, v75
    v_add_f32 v16, v16, v76
    v_add_f32 v17, v17, v77
    v_add_f32 v18, v18, v78
    v_add_f32 v19, v19, v79
    v_lshlrev_b32 v12, 16, v10
    v_and_b32 v13, 0xffff0000, v10
    v_lshlrev_b32 v14, 16, v11
    v_and_b32 v15, 0xffff0000, v11
    v_fma_f32 v12, v12, v7, -v6
    v_fmac_f32 v12, v16, v5
    v_fma_f32 v13, v13, v7, -v6
    v_fmac_f32 v13, v17, v5
    v_fma_f32 v14, v14, v7, -v6
    v_fmac_f32 v14, v18, v5
    v_fma_f32 v15, v15, v7, -v6
    v_fmac_f32 v15, v19, v5
    v_cvt_pk_bf16_f32 v10, v12, v13
    v_cvt_pk_bf16_f32 v11, v14, v15
    v_lshlrev_b32 v8, 11, v4
    v_lshl_add_u32 v8, v0, 3, v8
    buffer_store_dwordx2 v[10:11], v8, s[48:51], 0 offen
fix1_kernel_end:
    s_endpgm
.section .rodata,"a"
.p2align 6
.amdhsa_kernel prep_kernel
  .amdhsa_next_free_vgpr 64
  .amdhsa_next_free_sgpr 102
  .amdhsa_accum_offset 64
  .amdhsa_group_segment_fixed_size 0
  .amdhsa_kernarg_size 88
  .amdhsa_user_sgpr_count 2
  .amdhsa_user_sgpr_kernarg_segment_ptr 1
  .amdhsa_system_sgpr_workgroup_id_x 1
.end_amdhsa_kernel
.p2align 6
.amdhsa_kernel qkv0_kernel
  .amdhsa_next_free_vgpr 216
  .amdhsa_next_free_sgpr 102
  .amdhsa_accum_offset 216
  .amdhsa_group_segment_fixed_size 0
  .amdhsa_kernarg_size 88
  .amdhsa_user_sgpr_count 2
  .amdhsa_user_sgpr_kernarg_segment_ptr 1
  .amdhsa_system_sgpr_workgroup_id_x 1
.end_amdhsa_kernel
.p2align 6
.amdhsa_kernel attn0_kernel
  .amdhsa_next_free_vgpr 160
  .amdhsa_next_free_sgpr 102
  .amdhsa_accum_offset 160
  .amdhsa_group_segment_fixed_size 0
  .amdhsa_kernarg_size 88
  .amdhsa_user_sgpr_count 2
  .amdhsa_user_sgpr_kernarg_segment_ptr 1
  .amdhsa_system_sgpr_workgroup_id_x 1
.end_amdhsa_kernel
.p2align 6
.amdhsa_kernel wo0_kernel
  .amdhsa_next_free_vgpr 216
  .amdhsa_next_free_sgpr 102
  .amdhsa_accum_offset 216
  .amdhsa_group_segment_fixed_size 0
  .amdhsa_kernarg_size 88
  .amdhsa_user_sgpr_count 2
  .amdhsa_user_sgpr_kernarg_segment_ptr 1
  .amdhsa_system_sgpr_workgroup_id_x 1
.end_amdhsa_kernel
.p2align 6
.amdhsa_kernel ffn0_kernel
  .amdhsa_next_free_vgpr 128
  .amdhsa_next_free_sgpr 102
  .amdhsa_accum_offset 128
  .amdhsa_group_segment_fixed_size 0
  .amdhsa_kernarg_size 88
  .amdhsa_user_sgpr_count 2
  .amdhsa_user_sgpr_kernarg_segment_ptr 1
  .amdhsa_system_sgpr_workgroup_id_x 1
.end_amdhsa_kernel
.p2align 6
.amdhsa_kernel fix0_kernel
  .amdhsa_next_free_vgpr 96
  .amdhsa_next_free_sgpr 102
  .amdhsa_accum_offset 96
  .amdhsa_group_segment_fixed_size 0
  .amdhsa_kernarg_size 88
  .amdhsa_user_sgpr_count 2
  .amdhsa_user_sgpr_kernarg_segment_ptr 1
  .amdhsa_system_sgpr_workgroup_id_x 1
.end_amdhsa_kernel
.p2align 6
.amdhsa_kernel qkv1_kernel
  .amdhsa_next_free_vgpr 216
  .amdhsa_next_free_sgpr 102
  .amdhsa_accum_offset 216
  .amdhsa_group_segment_fixed_size 0
  .amdhsa_kernarg_size 88
  .amdhsa_user_sgpr_count 2
  .amdhsa_user_sgpr_kernarg_segment_ptr 1
  .amdhsa_system_sgpr_workgroup_id_x 1
.end_amdhsa_kernel
.p2align 6
.amdhsa_kernel attn1_kernel
  .amdhsa_next_free_vgpr 160
  .amdhsa_next_free_sgpr 102
  .amdhsa_accum_offset 160
  .amdhsa_group_segment_fixed_size 0
  .amdhsa_kernarg_size 88
  .amdhsa_user_sgpr_count 2
  .amdhsa_user_sgpr_kernarg_segment_ptr 1
  .amdhsa_system_sgpr_workgroup_id_x 1
.end_amdhsa_kernel
.p2align 6
.amdhsa_kernel wo1_kernel
  .amdhsa_next_free_vgpr 216
  .amdhsa_next_free_sgpr 102
  .amdhsa_accum_offset 216
  .amdhsa_group_segment_fixed_size 0
  .amdhsa_kernarg_size 88
  .amdhsa_user_sgpr_count 2
  .amdhsa_user_sgpr_kernarg_segment_ptr 1
  .amdhsa_system_sgpr_workgroup_id_x 1
.end_amdhsa_kernel
.p2align 6
.amdhsa_kernel ffn1_kernel
  .amdhsa_next_free_vgpr 128
  .amdhsa_next_free_sgpr 102
  .amdhsa_accum_offset 128
  .amdhsa_group_segment_fixed_size 0
  .amdhsa_kernarg_size 88
  .amdhsa_user_sgpr_count 2
  .amdhsa_user_sgpr_kernarg_segment_ptr 1
  .amdhsa_system_sgpr_workgroup_id_x 1
.end_amdhsa_kernel
.p2align 6
.amdhsa_kernel fix1_kernel
  .amdhsa_next_free_vgpr 96
  .amdhsa_next_free_sgpr 102
  .amdhsa_accum_offset 96
  .amdhsa_group_segment_fixed_size 0
  .amdhsa_kernarg_size 88
  .amdhsa_user_sgpr_count 2
  .amdhsa_user_sgpr_kernarg_segment_ptr 1
  .amdhsa_system_sgpr_workgroup_id_x 1
.end_amdhsa_kernel
```

```asm
; @launch kernel=prep_kernel grid=(256,1,1) block=(512,1,1) lds=16384
; @launch kernel=qkv0_kernel grid=(256,1,1) block=(512,1,1) lds=163840
; @launch kernel=attn0_kernel grid=(256,1,1) block=(512,1,1) lds=98304
; @launch kernel=wo0_kernel grid=(256,1,1) block=(512,1,1) lds=163840
; @launch kernel=ffn0_kernel grid=(256,1,1) block=(512,1,1) lds=49152
; @launch kernel=fix0_kernel grid=(1,1,1) block=(256,1,1) lds=1024
; @launch kernel=qkv1_kernel grid=(256,1,1) block=(512,1,1) lds=163840
; @launch kernel=attn1_kernel grid=(256,1,1) block=(512,1,1) lds=98304
; @launch kernel=wo1_kernel grid=(256,1,1) block=(512,1,1) lds=163840
; @launch kernel=ffn1_kernel grid=(256,1,1) block=(512,1,1) lds=49152
; @launch kernel=fix1_kernel grid=(1,1,1) block=(256,1,1) lds=1024
.amdgcn_target "amdgcn-amd-amdhsa--gfx950"
.text
.globl prep_kernel
.p2align 8
.type prep_kernel,@function
prep_kernel:
    s_cmp_ge_u32 s2, 256
    s_cbranch_scc1 prep_kernel_end
    s_load_dwordx4 s[4:7], s[0:1], 0
    s_load_dwordx2 s[8:9], s[0:1], 80
    v_lshrrev_b32 v1, 6, v0
    v_and_b32 v2, 63, v0
    v_readfirstlane_b32 s3, v1
    s_waitcnt lgkmcnt(0)
    s_mov_b32 s12, s4
    s_mov_b32 s13, s5
    s_mov_b32 s14, 0x400000
    s_mov_b32 s15, 0x20000
    s_mov_b32 s16, s6
    s_mov_b32 s17, s7
    s_mov_b32 s18, 0x600000
    s_mov_b32 s19, 0x20000
    s_mov_b32 s20, s8
    s_mov_b32 s21, s9
    s_mov_b32 s22, 0x8000000
    s_mov_b32 s23, 0x20000
    s_lshl_b32 s24, s2, 3
    s_add_u32 s24, s24, s3
    s_lshl_b32 s25, s24, 11
    v_lshlrev_b32 v3, 4, v2
    buffer_load_dwordx4 v[4:7], v3, s[12:15], s25 offen
    buffer_load_dwordx4 v[8:11], v3, s[12:15], s25 offen offset:1024
    s_mul_i32 s26, s2, 0x5556
    s_lshr_b32 s26, s26, 18
    s_mul_i32 s27, s26, 12
    s_sub_u32 s27, s2, s27
    s_lshl_b32 s28, s26, 6
    s_lshl_b32 s29, s3, 3
    s_add_u32 s28, s28, s29
    s_mul_i32 s28, s28, 6144
    s_lshl_b32 s29, s27, 9
    s_add_u32 s28, s28, s29
    v_lshrrev_b32 v12, 5, v2
    v_mul_u32_u24 v12, 6144, v12
    v_and_b32 v13, 31, v2
    v_lshl_add_u32 v12, v13, 4, v12
    buffer_load_dwordx4 v[16:19], v12, s[16:19], s28 offen
    s_add_u32 s28, s28, 12288
    buffer_load_dwordx4 v[20:23], v12, s[16:19], s28 offen
    s_add_u32 s28, s28, 12288
    buffer_load_dwordx4 v[24:27], v12, s[16:19], s28 offen
    s_add_u32 s28, s28, 12288
    buffer_load_dwordx4 v[28:31], v12, s[16:19], s28 offen
    s_add_u32 s28, s28, 12288
    v_mov_b32 v40, 0
    v_mov_b32 v41, 0
    s_lshr_b32 s30, s2, 7
    s_mul_i32 s30, s30, 33554432
    s_and_b32 s31, s2, 127
    s_lshl_b32 s31, s31, 10
    s_add_u32 s30, s30, s31
    s_add_u32 s30, s30, 0x1400000
    v_lshlrev_b32 v42, 1, v0
    v_and_b32 v42, 0x3fc, v42
    buffer_store_dword v40, v42, s[20:23], s30 offen
    s_waitcnt vmcnt(5)
    v_mov_b32 v32, 0
    v_mov_b32 v33, 0
    v_lshlrev_b32 v34, 16, v4
    v_and_b32 v35, 0xffff0000, v4
    v_add_f32 v32, v32, v34
    v_fmac_f32 v33, v34, v34
    v_add_f32 v32, v32, v35
    v_fmac_f32 v33, v35, v35
    v_lshlrev_b32 v34, 16, v5
    v_and_b32 v35, 0xffff0000, v5
    v_add_f32 v32, v32, v34
    v_fmac_f32 v33, v34, v34
    v_add_f32 v32, v32, v35
    v_fmac_f32 v33, v35, v35
    v_lshlrev_b32 v34, 16, v6
    v_and_b32 v35, 0xffff0000, v6
    v_add_f32 v32, v32, v34
    v_fmac_f32 v33, v34, v34
    v_add_f32 v32, v32, v35
    v_fmac_f32 v33, v35, v35
    v_lshlrev_b32 v34, 16, v7
    v_and_b32 v35, 0xffff0000, v7
    v_add_f32 v32, v32, v34
    v_fmac_f32 v33, v34, v34
    v_add_f32 v32, v32, v35
    v_fmac_f32 v33, v35, v35
    v_lshlrev_b32 v34, 16, v8
    v_and_b32 v35, 0xffff0000, v8
    v_add_f32 v32, v32, v34
    v_fmac_f32 v33, v34, v34
    v_add_f32 v32, v32, v35
    v_fmac_f32 v33, v35, v35
    v_lshlrev_b32 v34, 16, v9
    v_and_b32 v35, 0xffff0000, v9
    v_add_f32 v32, v32, v34
    v_fmac_f32 v33, v34, v34
    v_add_f32 v32, v32, v35
    v_fmac_f32 v33, v35, v35
    v_lshlrev_b32 v34, 16, v10
    v_and_b32 v35, 0xffff0000, v10
    v_add_f32 v32, v32, v34
    v_fmac_f32 v33, v34, v34
    v_add_f32 v32, v32, v35
    v_fmac_f32 v33, v35, v35
    v_lshlrev_b32 v34, 16, v11
    v_and_b32 v35, 0xffff0000, v11
    v_add_f32 v32, v32, v34
    v_fmac_f32 v33, v34, v34
    v_add_f32 v32, v32, v35
    v_fmac_f32 v33, v35, v35
    s_nop 0
    v_add_f32_dpp v32, v32, v32 quad_perm:[1,0,3,2] row_mask:0xf bank_mask:0xf
    s_nop 1
    v_add_f32_dpp v32, v32, v32 quad_perm:[2,3,0,1] row_mask:0xf bank_mask:0xf
    s_nop 1
    v_add_f32_dpp v32, v32, v32 row_half_mirror row_mask:0xf bank_mask:0xf
    s_nop 1
    v_add_f32_dpp v32, v32, v32 row_mirror row_mask:0xf bank_mask:0xf
    v_mov_b32 v36, v32
    s_nop 1
    v_permlane16_swap_b32 v32, v36
    v_add_f32 v32, v32, v36
    v_mov_b32 v36, v32
    s_nop 1
    v_permlane32_swap_b32 v32, v36
    v_add_f32 v32, v32, v36
    v_add_f32_dpp v33, v33, v33 quad_perm:[1,0,3,2] row_mask:0xf bank_mask:0xf
    s_nop 1
    v_add_f32_dpp v33, v33, v33 quad_perm:[2,3,0,1] row_mask:0xf bank_mask:0xf
    s_nop 1
    v_add_f32_dpp v33, v33, v33 row_half_mirror row_mask:0xf bank_mask:0xf
    s_nop 1
    v_add_f32_dpp v33, v33, v33 row_mirror row_mask:0xf bank_mask:0xf
    v_mov_b32 v36, v33
    s_nop 1
    v_permlane16_swap_b32 v33, v36
    v_add_f32 v33, v33, v36
    v_mov_b32 v36, v33
    s_nop 1
    v_permlane32_swap_b32 v33, v36
    v_add_f32 v33, v33, v36
    v_mul_f32 v32, 0x3a800000, v32
    v_mul_f32 v33, 0x3a800000, v33
    v_fma_f32 v33, -v32, v32, v33
    v_max_f32 v33, 0, v33
    v_add_f32 v33, 0x3727c5ac, v33
    v_rsq_f32 v33, v33
    s_lshl_b32 s24, s24, 2
    s_add_u32 s24, s24, 0x1440000
    v_lshlrev_b32 v37, 13, v2
    v_cmp_eq_u32 vcc, 0, v2
    s_nop 1
    v_cndmask_b32 v33, v32, v33, vcc
    s_mov_b64 exec, 3
    buffer_store_dword v33, v37, s[20:23], s24 offen
    s_mov_b64 exec, -1
    s_waitcnt vmcnt(2)
    v_lshlrev_b32 v44, 16, v16
    v_and_b32 v45, 0xffff0000, v16
    v_lshlrev_b32 v34, 16, v20
    v_and_b32 v35, 0xffff0000, v20
    v_add_f32 v44, v44, v34
    v_add_f32 v45, v45, v35
    v_lshlrev_b32 v34, 16, v24
    v_and_b32 v35, 0xffff0000, v24
    v_add_f32 v44, v44, v34
    v_add_f32 v45, v45, v35
    v_lshlrev_b32 v34, 16, v28
    v_and_b32 v35, 0xffff0000, v28
    v_add_f32 v44, v44, v34
    v_add_f32 v45, v45, v35
    v_lshlrev_b32 v46, 16, v17
    v_and_b32 v47, 0xffff0000, v17
    v_lshlrev_b32 v34, 16, v21
    v_and_b32 v35, 0xffff0000, v21
    v_add_f32 v46, v46, v34
    v_add_f32 v47, v47, v35
    v_lshlrev_b32 v34, 16, v25
    v_and_b32 v35, 0xffff0000, v25
    v_add_f32 v46, v46, v34
    v_add_f32 v47, v47, v35
    v_lshlrev_b32 v34, 16, v29
    v_and_b32 v35, 0xffff0000, v29
    v_add_f32 v46, v46, v34
    v_add_f32 v47, v47, v35
    v_lshlrev_b32 v48, 16, v18
    v_and_b32 v49, 0xffff0000, v18
    v_lshlrev_b32 v34, 16, v22
    v_and_b32 v35, 0xffff0000, v22
    v_add_f32 v48, v48, v34
    v_add_f32 v49, v49, v35
    v_lshlrev_b32 v34, 16, v26
    v_and_b32 v35, 0xffff0000, v26
    v_add_f32 v48, v48, v34
    v_add_f32 v49, v49, v35
    v_lshlrev_b32 v34, 16, v30
    v_and_b32 v35, 0xffff0000, v30
    v_add_f32 v48, v48, v34
    v_add_f32 v49, v49, v35
    v_lshlrev_b32 v50, 16, v19
    v_and_b32 v51, 0xffff0000, v19
    v_lshlrev_b32 v34, 16, v23
    v_and_b32 v35, 0xffff0000, v23
    v_add_f32 v50, v50, v34
    v_add_f32 v51, v51, v35
    v_lshlrev_b32 v34, 16, v27
    v_and_b32 v35, 0xffff0000, v27
    v_add_f32 v50, v50, v34
    v_add_f32 v51, v51, v35
    v_lshlrev_b32 v34, 16, v31
    v_and_b32 v35, 0xffff0000, v31
    v_add_f32 v50, v50, v34
    v_add_f32 v51, v51, v35
    v_lshlrev_b32 v52, 5, v0
    ds_write_b128 v52, v[44:47]
    ds_write_b128 v52, v[48:51] offset:16
    s_waitcnt lgkmcnt(0)
    s_barrier
    s_cmp_ge_u32 s3, 4
    s_cbranch_scc1 prep_kernel_end
    s_cmp_ge_u32 s2, 192
    s_cbranch_scc1 prep_kernel_end
    v_lshlrev_b32 v52, 2, v0
    ds_read_b32 v16, v52 offset:0
    ds_read_b32 v17, v52 offset:1024
    ds_read_b32 v18, v52 offset:2048
    ds_read_b32 v19, v52 offset:3072
    ds_read_b32 v20, v52 offset:4096
    ds_read_b32 v21, v52 offset:5120
    ds_read_b32 v22, v52 offset:6144
    ds_read_b32 v23, v52 offset:7168
    ds_read_b32 v24, v52 offset:8192
    ds_read_b32 v25, v52 offset:9216
    ds_read_b32 v26, v52 offset:10240
    ds_read_b32 v27, v52 offset:11264
    ds_read_b32 v28, v52 offset:12288
    ds_read_b32 v29, v52 offset:13312
    ds_read_b32 v30, v52 offset:14336
    ds_read_b32 v31, v52 offset:15360
    s_waitcnt lgkmcnt(0)
    v_add_f32 v16, v16, v17
    v_add_f32 v16, v16, v18
    v_add_f32 v16, v16, v19
    v_add_f32 v16, v16, v20
    v_add_f32 v16, v16, v21
    v_add_f32 v16, v16, v22
    v_add_f32 v16, v16, v23
    v_add_f32 v16, v16, v24
    v_add_f32 v16, v16, v25
    v_add_f32 v16, v16, v26
    v_add_f32 v16, v16, v27
    v_add_f32 v16, v16, v28
    v_add_f32 v16, v16, v29
    v_add_f32 v16, v16, v30
    v_add_f32 v16, v16, v31
    s_mul_i32 s26, s26, 12288
    s_lshl_b32 s27, s27, 10
    s_add_u32 s26, s26, s27
    s_add_u32 s26, s26, 0x4000000
    buffer_store_dword v16, v52, s[20:23], s26 offen
prep_kernel_end:
    s_endpgm
.globl qkv0_kernel
.p2align 8
.type qkv0_kernel,@function
qkv0_kernel:
    s_cmp_ge_u32 s2, 256
    s_cbranch_scc1 qkv0_kernel_end
    s_load_dwordx4 s[4:7], s[0:1], 0
    s_load_dwordx2 s[8:9], s[0:1], 80
    v_lshrrev_b32 v1, 6, v0
    v_and_b32 v2, 63, v0
    v_readfirstlane_b32 s3, v1
    s_and_b32 s24, s2, 7
    s_lshr_b32 s25, s2, 3
    s_lshr_b32 s26, s24, 2
    s_lshl_b32 s26, s26, 3
    s_and_b32 s27, s25, 7
    s_add_u32 s26, s26, s27
    s_and_b32 s27, s24, 3
    s_lshl_b32 s27, s27, 2
    s_lshr_b32 s25, s25, 3
    s_add_u32 s27, s27, s25
    s_waitcnt lgkmcnt(0)
    s_mov_b32 s20, s8
    s_mov_b32 s21, s9
    s_mov_b32 s22, 0x8000000
    s_mov_b32 s23, 0x20000
    s_cmp_lt_u32 s3, 4
    s_cbranch_scc1 qkv0_kernel_cons
    s_mov_b32 s12, s4
    s_mov_b32 s13, s5
    s_mov_b32 s14, 0x400000
    s_mov_b32 s15, 0x20000
    s_mov_b32 s16, s6
    s_mov_b32 s17, s7
    s_mov_b32 s18, 0x600000
    s_mov_b32 s19, 0x20000
    s_sub_u32 s3, s3, 4
    s_and_b32 s28, s3, 1
    s_lshl_b32 s28, s28, 2
    v_lshrrev_b32 v3, 4, v2
    v_add_u32 v3, s28, v3
    v_xor_b32 v3, v3, v2
    v_and_b32 v3, 7, v3
    v_lshlrev_b32 v3, 4, v3
    v_lshrrev_b32 v4, 3, v2
    v_lshl_add_u32 v3, v4, 11, v3
    s_lshl_b32 s28, s3, 14
    v_add_u32 v3, s28, v3
    s_lshl_b32 s30, s26, 18
    v_lshrrev_b32 v4, 3, v2
    s_lshl_b32 s28, s3, 3
    v_add_u32 v4, s28, v4
    v_mul_u32_u24 v4, 6144, v4
    v_lshrrev_b32 v5, 2, v2
    v_and_b32 v5, 4, v5
    v_xor_b32 v5, v5, v2
    v_and_b32 v5, 7, v5
    v_lshl_add_u32 v4, v5, 4, v4
    s_lshl_b32 s31, s27, 7
    s_lshl_b32 s32, s3, 10
    v_subrev_u32 v7, 256, v0
    v_lshrrev_b32 v8, 6, v7
    v_lshlrev_b32 v8, 12, v8
    v_lshl_add_u32 v8, v2, 2, v8
    s_lshl_b32 s33, s27, 8
    s_add_u32 s33, s33, 0x4000000
    buffer_load_dword v16, v8, s[20:23], s33 offen
    s_add_u32 s33, s33, 12288
    buffer_load_dword v17, v8, s[20:23], s33 offen
    s_add_u32 s33, s33, 12288
    buffer_load_dword v18, v8, s[20:23], s33 offen
    s_add_u32 s33, s33, 12288
    buffer_load_dword v19, v8, s[20:23], s33 offen
    s_add_u32 s33, s33, 12288
    buffer_load_dword v20, v8, s[20:23], s33 offen
    s_add_u32 s33, s33, 12288
    buffer_load_dword v21, v8, s[20:23], s33 offen
    s_add_u32 s33, s33, 12288
    buffer_load_dword v22, v8, s[20:23], s33 offen
    s_add_u32 s33, s33, 12288
    buffer_load_dword v23, v8, s[20:23], s33 offen
    s_add_u32 s33, s33, 12288
    buffer_load_dword v24, v8, s[20:23], s33 offen
    s_add_u32 s33, s33, 12288
    buffer_load_dword v25, v8, s[20:23], s33 offen
    s_add_u32 s33, s33, 12288
    buffer_load_dword v26, v8, s[20:23], s33 offen
    s_add_u32 s33, s33, 12288
    buffer_load_dword v27, v8, s[20:23], s33 offen
    s_add_u32 s33, s33, 12288
    buffer_load_dword v28, v8, s[20:23], s33 offen
    s_add_u32 s33, s33, 12288
    buffer_load_dword v29, v8, s[20:23], s33 offen
    s_add_u32 s33, s33, 12288
    buffer_load_dword v30, v8, s[20:23], s33 offen
    s_add_u32 s33, s33, 12288
    buffer_load_dword v31, v8, s[20:23], s33 offen
    s_add_u32 s33, s33, 12288
    v_lshrrev_b32 v9, 7, v7
    v_lshlrev_b32 v9, 13, v9
    v_and_b32 v10, 127, v7
    v_lshl_add_u32 v9, v10, 2, v9
    s_lshl_b32 s33, s26, 9
    s_add_u32 s33, s33, 0x1440000
    buffer_load_dword v32, v9, s[20:23], s33 offen
    s_mov_b32 s36, 4
qkv0_kernel_lpro:
    s_mov_b32 m0, s32
    s_mov_b32 s34, s30
    buffer_load_dwordx4 v3, s[12:15], s34 offen lds
    s_add_u32 m0, m0, 4096
    s_add_u32 s34, s34, 65536
    buffer_load_dwordx4 v3, s[12:15], s34 offen lds
    s_add_u32 m0, m0, 4096
    s_add_u32 s34, s34, 65536
    buffer_load_dwordx4 v3, s[12:15], s34 offen lds
    s_add_u32 m0, m0, 4096
    s_add_u32 s34, s34, 65536
    buffer_load_dwordx4 v3, s[12:15], s34 offen lds
    s_add_u32 m0, m0, 4096
    s_mov_b32 s34, s31
    buffer_load_dwordx4 v4, s[16:19], s34 offen lds
    s_add_u32 m0, m0, 4096
    s_add_u32 s34, s34, 196608
    buffer_load_dwordx4 v4, s[16:19], s34 offen lds
    s_add_u32 m0, m0, 4096
    s_sub_u32 s34, s34, 194560
    buffer_load_dwordx4 v4, s[16:19], s34 offen lds
    s_add_u32 m0, m0, 4096
    s_add_u32 s34, s34, 196608
    buffer_load_dwordx4 v4, s[16:19], s34 offen lds
    s_add_u32 m0, m0, 4096
    s_sub_u32 s34, s34, 194560
    buffer_load_dwordx4 v4, s[16:19], s34 offen lds
    s_add_u32 m0, m0, 4096
    s_add_u32 s34, s34, 196608
    buffer_load_dwordx4 v4, s[16:19], s34 offen lds
    s_add_u32 s30, s30, 128
    s_add_u32 s31, s31, 393216
    s_add_u32 s32, s32, 40960
    s_cmp_ge_u32 s32, 163840
    s_cselect_b32 s35, 163840, 0
    s_sub_u32 s32, s32, s35
    s_sub_u32 s36, s36, 1
    s_cmp_lg_u32 s36, 0
    s_cbranch_scc1 qkv0_kernel_lpro
    s_waitcnt vmcnt(30)
    v_add_f32 v16, v16, v17
    v_add_f32 v16, v16, v18
    v_add_f32 v16, v16, v19
    v_add_f32 v16, v16, v20
    v_add_f32 v16, v16, v21
    v_add_f32 v16, v16, v22
    v_add_f32 v16, v16, v23
    v_add_f32 v16, v16, v24
    v_add_f32 v16, v16, v25
    v_add_f32 v16, v16, v26
    v_add_f32 v16, v16, v27
    v_add_f32 v16, v16, v28
    v_add_f32 v16, v16, v29
    v_add_f32 v16, v16, v30
    v_add_f32 v16, v16, v31
    s_barrier
    s_mov_b32 s36, 12
qkv0_kernel_lloop:
    s_waitcnt vmcnt(20)
    s_barrier
    s_mov_b32 m0, s32
    s_mov_b32 s34, s30
    buffer_load_dwordx4 v3, s[12:15], s34 offen lds
    s_add_u32 m0, m0, 4096
    s_add_u32 s34, s34, 65536
    buffer_load_dwordx4 v3, s[12:15], s34 offen lds
    s_add_u32 m0, m0, 4096
    s_add_u32 s34, s34, 65536
    buffer_load_dwordx4 v3, s[12:15], s34 offen lds
    s_add_u32 m0, m0, 4096
    s_add_u32 s34, s34, 65536
    buffer_load_dwordx4 v3, s[12:15], s34 offen lds
    s_add_u32 m0, m0, 4096
    s_mov_b32 s34, s31
    buffer_load_dwordx4 v4, s[16:19], s34 offen lds
    s_add_u32 m0, m0, 4096
    s_add_u32 s34, s34, 196608
    buffer_load_dwordx4 v4, s[16:19], s34 offen lds
    s_add_u32 m0, m0, 4096
    s_sub_u32 s34, s34, 194560
    buffer_load_dwordx4 v4, s[16:19], s34 offen lds
    s_add_u32 m0, m0, 4096
    s_add_u32 s34, s34, 196608
    buffer_load_dwordx4 v4, s[16:19], s34 offen lds
    s_add_u32 m0, m0, 4096
    s_sub_u32 s34, s34, 194560
    buffer_load_dwordx4 v4, s[16:19], s34 offen lds
    s_add_u32 m0, m0, 4096
    s_add_u32 s34, s34, 196608
    buffer_load_dwordx4 v4, s[16:19], s34 offen lds
    s_add_u32 s30, s30, 128
    s_add_u32 s31, s31, 393216
    s_add_u32 s32, s32, 40960
    s_cmp_ge_u32 s32, 163840
    s_cselect_b32 s35, 163840, 0
    s_sub_u32 s32, s32, s35
    s_sub_u32 s36, s36, 1
    s_cmp_lg_u32 s36, 0
    s_cbranch_scc1 qkv0_kernel_lloop
    s_waitcnt vmcnt(20)
    s_barrier
    v_lshlrev_b32 v11, 2, v7
    ds_write_b32 v11, v32
    ds_write_b32 v11, v16 offset:1024
    s_waitcnt vmcnt(10)
    s_barrier
    s_waitcnt vmcnt(0)
    s_barrier
    s_waitcnt lgkmcnt(0)
    s_barrier
    s_endpgm
qkv0_kernel_cons:
    v_mov_b32 v212, v2
    s_and_b32 s28, s3, 1
    s_lshr_b32 s29, s3, 1
    v_and_b32 v3, 31, v2
    v_lshrrev_b32 v4, 5, v2
    v_lshrrev_b32 v5, 1, v3
    v_and_b32 v5, 7, v5
    v_xor_b32 v5, v5, v4
    v_lshlrev_b32 v5, 4, v5
    v_lshl_add_u32 v5, v3, 7, v5
    s_lshl_b32 s30, s28, 13
    v_add_u32 v136, s30, v5
    v_xor_b32 v137, 32, v136
    v_xor_b32 v138, 64, v136
    v_xor_b32 v139, 96, v136
    v_bfe_u32 v5, v2, 2, 2
    v_lshl_add_u32 v6, v4, 3, v5
    v_lshlrev_b32 v6, 7, v6
    v_lshrrev_b32 v5, 1, v5
    v_xor_b32 v5, s29, v5
    v_lshl_add_u32 v6, v5, 6, v6
    v_bfe_u32 v5, v2, 4, 1
    v_lshl_add_u32 v6, v5, 5, v6
    v_and_b32 v5, 3, v2
    v_lshl_add_u32 v6, v5, 3, v6
    v_add_u32 v140, 16384, v6
    v_mov_b32 v141, v136
    v_mov_b32 v142, v137
    v_mov_b32 v143, v138
    v_mov_b32 v144, v139
    v_mov_b32 v145, v140
    v_mov_b32 v0, 0
    v_mov_b32 v1, 0
    v_mov_b32 v2, 0
    v_mov_b32 v3, 0
    v_mov_b32 v4, 0
    v_mov_b32 v5, 0
    v_mov_b32 v6, 0
    v_mov_b32 v7, 0
    v_mov_b32 v8, 0
    v_mov_b32 v9, 0
    v_mov_b32 v10, 0
    v_mov_b32 v11, 0
    v_mov_b32 v12, 0
    v_mov_b32 v13, 0
    v_mov_b32 v14, 0
    v_mov_b32 v15, 0
    v_mov_b32 v16, 0
    v_mov_b32 v17, 0
    v_mov_b32 v18, 0
    v_mov_b32 v19, 0
    v_mov_b32 v20, 0
    v_mov_b32 v21, 0
    v_mov_b32 v22, 0
    v_mov_b32 v23, 0
    v_mov_b32 v24, 0
    v_mov_b32 v25, 0
    v_mov_b32 v26, 0
    v_mov_b32 v27, 0
    v_mov_b32 v28, 0
    v_mov_b32 v29, 0
    v_mov_b32 v30, 0
    v_mov_b32 v31, 0
    v_mov_b32 v32, 0
    v_mov_b32 v33, 0
    v_mov_b32 v34, 0
    v_mov_b32 v35, 0
    v_mov_b32 v36, 0
    v_mov_b32 v37, 0
    v_mov_b32 v38, 0
    v_mov_b32 v39, 0
    v_mov_b32 v40, 0
    v_mov_b32 v41, 0
    v_mov_b32 v42, 0
    v_mov_b32 v43, 0
    v_mov_b32 v44, 0
    v_mov_b32 v45, 0
    v_mov_b32 v46, 0
    v_mov_b32 v47, 0
    v_mov_b32 v48, 0
    v_mov_b32 v49, 0
    v_mov_b32 v50, 0
    v_mov_b32 v51, 0
    v_mov_b32 v52, 0
    v_mov_b32 v53, 0
    v_mov_b32 v54, 0
    v_mov_b32 v55, 0
    v_mov_b32 v56, 0
    v_mov_b32 v57, 0
    v_mov_b32 v58, 0
    v_mov_b32 v59, 0
    v_mov_b32 v60, 0
    v_mov_b32 v61, 0
    v_mov_b32 v62, 0
    v_mov_b32 v63, 0
    v_mov_b32 v64, 0
    v_mov_b32 v65, 0
    v_mov_b32 v66, 0
    v_mov_b32 v67, 0
    v_mov_b32 v68, 0
    v_mov_b32 v69, 0
    v_mov_b32 v70, 0
    v_mov_b32 v71, 0
    v_mov_b32 v72, 0
    v_mov_b32 v73, 0
    v_mov_b32 v74, 0
    v_mov_b32 v75, 0
    v_mov_b32 v76, 0
    v_mov_b32 v77, 0
    v_mov_b32 v78, 0
    v_mov_b32 v79, 0
    v_mov_b32 v80, 0
    v_mov_b32 v81, 0
    v_mov_b32 v82, 0
    v_mov_b32 v83, 0
    v_mov_b32 v84, 0
    v_mov_b32 v85, 0
    v_mov_b32 v86, 0
    v_mov_b32 v87, 0
    v_mov_b32 v88, 0
    v_mov_b32 v89, 0
    v_mov_b32 v90, 0
    v_mov_b32 v91, 0
    v_mov_b32 v92, 0
    v_mov_b32 v93, 0
    v_mov_b32 v94, 0
    v_mov_b32 v95, 0
    s_mov_b32 s31, 0
    s_mov_b32 s36, 16
    s_barrier
    ds_read_b128 v[96:99], v141
    ds_read_b128 v[100:103], v141 offset:4096
    ds_read_b64_tr_b16 v[104:105], v145 offset:0
    ds_read_b64_tr_b16 v[106:107], v145 offset:512
    ds_read_b64_tr_b16 v[108:109], v145 offset:8192
    ds_read_b64_tr_b16 v[110:111], v145 offset:8704
    ds_read_b64_tr_b16 v[112:113], v145 offset:16384
    ds_read_b64_tr_b16 v[114:115], v145 offset:16896
qkv0_kernel_cloop:
    s_waitcnt lgkmcnt(0)
    v_mfma_f32_32x32x16_bf16 v[0:15], v[104:107], v[96:99], v[0:15]
    ds_read_b128 v[116:119], v142
    ds_read_b64_tr_b16 v[124:125], v145 offset:2048
    ds_read_b64_tr_b16 v[126:127], v145 offset:2560
    v_mfma_f32_32x32x16_bf16 v[16:31], v[104:107], v[100:103], v[16:31]
    ds_read_b128 v[120:123], v142 offset:4096
    ds_read_b64_tr_b16 v[128:129], v145 offset:10240
    ds_read_b64_tr_b16 v[130:131], v145 offset:10752
    v_mfma_f32_32x32x16_bf16 v[32:47], v[108:111], v[96:99], v[32:47]
    ds_read_b64_tr_b16 v[132:133], v145 offset:18432
    ds_read_b64_tr_b16 v[134:135], v145 offset:18944
    v_mfma_f32_32x32x16_bf16 v[48:63], v[108:111], v[100:103], v[48:63]
    v_mfma_f32_32x32x16_bf16 v[64:79], v[96:99], v[112:115], v[64:79]
    v_mfma_f32_32x32x16_bf16 v[80:95], v[100:103], v[112:115], v[80:95]
    s_waitcnt lgkmcnt(0)
    v_mfma_f32_32x32x16_bf16 v[0:15], v[124:127], v[116:119], v[0:15]
    ds_read_b128 v[96:99], v143
    ds_read_b64_tr_b16 v[104:105], v145 offset:4096
    ds_read_b64_tr_b16 v[106:107], v145 offset:4608
    v_mfma_f32_32x32x16_bf16 v[16:31], v[124:127], v[120:123], v[16:31]
    ds_read_b128 v[100:103], v143 offset:4096
    ds_read_b64_tr_b16 v[108:109], v145 offset:12288
    ds_read_b64_tr_b16 v[110:111], v145 offset:12800
    v_mfma_f32_32x32x16_bf16 v[32:47], v[128:131], v[116:119], v[32:47]
    ds_read_b64_tr_b16 v[112:113], v145 offset:20480
    ds_read_b64_tr_b16 v[114:115], v145 offset:20992
    v_mfma_f32_32x32x16_bf16 v[48:63], v[128:131], v[120:123], v[48:63]
    v_mfma_f32_32x32x16_bf16 v[64:79], v[116:119], v[132:135], v[64:79]
    v_mfma_f32_32x32x16_bf16 v[80:95], v[120:123], v[132:135], v[80:95]
    s_waitcnt lgkmcnt(0)
    v_mfma_f32_32x32x16_bf16 v[0:15], v[104:107], v[96:99], v[0:15]
    ds_read_b128 v[116:119], v144
    ds_read_b64_tr_b16 v[124:125], v145 offset:6144
    ds_read_b64_tr_b16 v[126:127], v145 offset:6656
    v_mfma_f32_32x32x16_bf16 v[16:31], v[104:107], v[100:103], v[16:31]
    ds_read_b128 v[120:123], v144 offset:4096
    ds_read_b64_tr_b16 v[128:129], v145 offset:14336
    ds_read_b64_tr_b16 v[130:131], v145 offset:14848
    v_mfma_f32_32x32x16_bf16 v[32:47], v[108:111], v[96:99], v[32:47]
    ds_read_b64_tr_b16 v[132:133], v145 offset:22528
    ds_read_b64_tr_b16 v[134:135], v145 offset:23040
    v_mfma_f32_32x32x16_bf16 v[48:63], v[108:111], v[100:103], v[48:63]
    v_mfma_f32_32x32x16_bf16 v[64:79], v[96:99], v[112:115], v[64:79]
    v_mfma_f32_32x32x16_bf16 v[80:95], v[100:103], v[112:115], v[80:95]
    s_waitcnt lgkmcnt(0)
    v_mfma_f32_32x32x16_bf16 v[0:15], v[124:127], v[116:119], v[0:15]
    s_barrier
    s_add_u32 s31, s31, 40960
    s_cmp_ge_u32 s31, 163840
    s_cselect_b32 s31, 0, s31
    v_add_u32 v141, s31, v136
    v_add_u32 v145, s31, v140
    ds_read_b128 v[96:99], v141
    ds_read_b64_tr_b16 v[104:105], v145 offset:0
    ds_read_b64_tr_b16 v[106:107], v145 offset:512
    v_mfma_f32_32x32x16_bf16 v[16:31], v[124:127], v[120:123], v[16:31]
    ds_read_b128 v[100:103], v141 offset:4096
    ds_read_b64_tr_b16 v[108:109], v145 offset:8192
    ds_read_b64_tr_b16 v[110:111], v145 offset:8704
    v_mfma_f32_32x32x16_bf16 v[32:47], v[128:131], v[116:119], v[32:47]
    ds_read_b64_tr_b16 v[112:113], v145 offset:16384
    ds_read_b64_tr_b16 v[114:115], v145 offset:16896
    v_mfma_f32_32x32x16_bf16 v[48:63], v[128:131], v[120:123], v[48:63]
    v_add_u32 v142, s31, v137
    v_add_u32 v143, s31, v138
    v_add_u32 v144, s31, v139
    s_sub_u32 s36, s36, 1
    s_cmp_lg_u32 s36, 0
    v_mfma_f32_32x32x16_bf16 v[64:79], v[116:119], v[132:135], v[64:79]
    v_mfma_f32_32x32x16_bf16 v[80:95], v[120:123], v[132:135], v[80:95]
    s_cbranch_scc1 qkv0_kernel_cloop
    s_waitcnt lgkmcnt(0)
    v_and_b32 v96, 31, v212
    v_lshrrev_b32 v97, 5, v212
    s_lshl_b32 s30, s28, 8
    s_add_u32 s30, s30, 0
    v_lshl_add_u32 v98, v96, 2, s30
    v_lshl_add_u32 v99, v97, 4, s30
    s_lshl_b32 s30, s29, 7
    s_add_u32 s30, s30, 1024
    v_lshl_add_u32 v100, v97, 4, s30
    v_lshl_add_u32 v101, v96, 2, s30
    ds_read_b32 v104, v98
    ds_read_b32 v106, v98 offset:128
    ds_read_b32 v108, v98 offset:512
    ds_read_b32 v110, v98 offset:640
    ds_read_b32 v112, v101 offset:512
    ds_read_b128 v[116:119], v100 offset:0
    ds_read_b128 v[120:123], v100 offset:32
    ds_read_b128 v[124:127], v100 offset:64
    ds_read_b128 v[128:131], v100 offset:96
    ds_read_b128 v[132:135], v100 offset:256
    ds_read_b128 v[136:139], v100 offset:288
    ds_read_b128 v[140:143], v100 offset:320
    ds_read_b128 v[144:147], v100 offset:352
    ds_read_b128 v[148:151], v99 offset:0
    ds_read_b128 v[180:183], v99 offset:512
    ds_read_b128 v[152:155], v99 offset:32
    ds_read_b128 v[184:187], v99 offset:544
    ds_read_b128 v[156:159], v99 offset:64
    ds_read_b128 v[188:191], v99 offset:576
    ds_read_b128 v[160:163], v99 offset:96
    ds_read_b128 v[192:195], v99 offset:608
    ds_read_b128 v[164:167], v99 offset:128
    ds_read_b128 v[196:199], v99 offset:640
    ds_read_b128 v[168:171], v99 offset:160
    ds_read_b128 v[200:203], v99 offset:672
    ds_read_b128 v[172:175], v99 offset:192
    ds_read_b128 v[204:207], v99 offset:704
    ds_read_b128 v[176:179], v99 offset:224
    ds_read_b128 v[208:211], v99 offset:736
    s_lshl_b32 s30, s27, 1
    s_add_u32 s30, s30, s29
    s_lshl_b32 s30, s30, 6
    s_lshl_b32 s31, s26, 2
    s_add_u32 s30, s30, s31
    s_lshl_b32 s31, s28, 1
    s_add_u32 s30, s30, s31
    s_lshl_b32 s31, s30, 11
    s_add_u32 s31, s31, 0x0
    s_lshl_b32 s32, s30, 12
    s_add_u32 s32, s32, 0x400000
    s_add_u32 s33, s32, 4096
    v_lshlrev_b32 v96, 4, v212
    s_waitcnt lgkmcnt(15)
    v_mul_f32 v114, 0x3e8293ee, v104
    v_mul_f32 v102, 0x3e8293ee, v106
    v_pk_fma_f32 v[0:1], v[116:117], v[108:109], v[0:1] op_sel_hi:[1,0,1] neg_lo:[0,1,0] neg_hi:[0,1,0]
    v_pk_fma_f32 v[2:3], v[118:119], v[108:109], v[2:3] op_sel_hi:[1,0,1] neg_lo:[0,1,0] neg_hi:[0,1,0]
    v_pk_fma_f32 v[4:5], v[120:121], v[108:109], v[4:5] op_sel_hi:[1,0,1] neg_lo:[0,1,0] neg_hi:[0,1,0]
    v_pk_fma_f32 v[6:7], v[122:123], v[108:109], v[6:7] op_sel_hi:[1,0,1] neg_lo:[0,1,0] neg_hi:[0,1,0]
    v_pk_fma_f32 v[8:9], v[124:125], v[108:109], v[8:9] op_sel_hi:[1,0,1] neg_lo:[0,1,0] neg_hi:[0,1,0]
    v_pk_fma_f32 v[10:11], v[126:127], v[108:109], v[10:11] op_sel_hi:[1,0,1] neg_lo:[0,1,0] neg_hi:[0,1,0]
    v_pk_fma_f32 v[12:13], v[128:129], v[108:109], v[12:13] op_sel_hi:[1,0,1] neg_lo:[0,1,0] neg_hi:[0,1,0]
    v_pk_fma_f32 v[14:15], v[130:131], v[108:109], v[14:15] op_sel_hi:[1,0,1] neg_lo:[0,1,0] neg_hi:[0,1,0]
    v_pk_mul_f32 v[0:1], v[0:1], v[114:115] op_sel_hi:[1,0]
    v_pk_mul_f32 v[2:3], v[2:3], v[114:115] op_sel_hi:[1,0]
    v_pk_mul_f32 v[4:5], v[4:5], v[114:115] op_sel_hi:[1,0]
    v_pk_mul_f32 v[6:7], v[6:7], v[114:115] op_sel_hi:[1,0]
    v_pk_mul_f32 v[8:9], v[8:9], v[114:115] op_sel_hi:[1,0]
    v_pk_mul_f32 v[10:11], v[10:11], v[114:115] op_sel_hi:[1,0]
    v_pk_mul_f32 v[12:13], v[12:13], v[114:115] op_sel_hi:[1,0]
    v_pk_mul_f32 v[14:15], v[14:15], v[114:115] op_sel_hi:[1,0]
    v_cvt_pk_bf16_f32 v0, v0, v1
    v_cvt_pk_bf16_f32 v1, v2, v3
    v_cvt_pk_bf16_f32 v2, v4, v5
    v_cvt_pk_bf16_f32 v3, v6, v7
    v_cvt_pk_bf16_f32 v4, v8, v9
    v_cvt_pk_bf16_f32 v5, v10, v11
    v_cvt_pk_bf16_f32 v6, v12, v13
    v_cvt_pk_bf16_f32 v7, v14, v15
    buffer_store_dwordx4 v[0:3], v96, s[20:23], s31 offen offset:0
    buffer_store_dwordx4 v[4:7], v96, s[20:23], s31 offen offset:1024
    v_pk_fma_f32 v[16:17], v[116:117], v[110:111], v[16:17] op_sel_hi:[1,0,1] neg_lo:[0,1,0] neg_hi:[0,1,0]
    v_pk_fma_f32 v[18:19], v[118:119], v[110:111], v[18:19] op_sel_hi:[1,0,1] neg_lo:[0,1,0] neg_hi:[0,1,0]
    v_pk_fma_f32 v[20:21], v[120:121], v[110:111], v[20:21] op_sel_hi:[1,0,1] neg_lo:[0,1,0] neg_hi:[0,1,0]
    v_pk_fma_f32 v[22:23], v[122:123], v[110:111], v[22:23] op_sel_hi:[1,0,1] neg_lo:[0,1,0] neg_hi:[0,1,0]
    v_pk_fma_f32 v[24:25], v[124:125], v[110:111], v[24:25] op_sel_hi:[1,0,1] neg_lo:[0,1,0] neg_hi:[0,1,0]
    v_pk_fma_f32 v[26:27], v[126:127], v[110:111], v[26:27] op_sel_hi:[1,0,1] neg_lo:[0,1,0] neg_hi:[0,1,0]
    v_pk_fma_f32 v[28:29], v[128:129], v[110:111], v[28:29] op_sel_hi:[1,0,1] neg_lo:[0,1,0] neg_hi:[0,1,0]
    v_pk_fma_f32 v[30:31], v[130:131], v[110:111], v[30:31] op_sel_hi:[1,0,1] neg_lo:[0,1,0] neg_hi:[0,1,0]
    v_pk_mul_f32 v[16:17], v[16:17], v[102:103] op_sel_hi:[1,0]
    v_pk_mul_f32 v[18:19], v[18:19], v[102:103] op_sel_hi:[1,0]
    v_pk_mul_f32 v[20:21], v[20:21], v[102:103] op_sel_hi:[1,0]
    v_pk_mul_f32 v[22:23], v[22:23], v[102:103] op_sel_hi:[1,0]
    v_pk_mul_f32 v[24:25], v[24:25], v[102:103] op_sel_hi:[1,0]
    v_pk_mul_f32 v[26:27], v[26:27], v[102:103] op_sel_hi:[1,0]
    v_pk_mul_f32 v[28:29], v[28:29], v[102:103] op_sel_hi:[1,0]
    v_pk_mul_f32 v[30:31], v[30:31], v[102:103] op_sel_hi:[1,0]
    v_cvt_pk_bf16_f32 v16, v16, v17
    v_cvt_pk_bf16_f32 v17, v18, v19
    v_cvt_pk_bf16_f32 v18, v20, v21
    v_cvt_pk_bf16_f32 v19, v22, v23
    v_cvt_pk_bf16_f32 v20, v24, v25
    v_cvt_pk_bf16_f32 v21, v26, v27
    v_cvt_pk_bf16_f32 v22, v28, v29
    v_cvt_pk_bf16_f32 v23, v30, v31
    buffer_store_dwordx4 v[16:19], v96, s[20:23], s31 offen offset:2048
    buffer_store_dwordx4 v[20:23], v96, s[20:23], s31 offen offset:3072
    v_pk_fma_f32 v[32:33], v[132:133], v[108:109], v[32:33] op_sel_hi:[1,0,1] neg_lo:[0,1,0] neg_hi:[0,1,0]
    v_pk_fma_f32 v[34:35], v[134:135], v[108:109], v[34:35] op_sel_hi:[1,0,1] neg_lo:[0,1,0] neg_hi:[0,1,0]
    v_pk_fma_f32 v[36:37], v[136:137], v[108:109], v[36:37] op_sel_hi:[1,0,1] neg_lo:[0,1,0] neg_hi:[0,1,0]
    v_pk_fma_f32 v[38:39], v[138:139], v[108:109], v[38:39] op_sel_hi:[1,0,1] neg_lo:[0,1,0] neg_hi:[0,1,0]
    v_pk_fma_f32 v[40:41], v[140:141], v[108:109], v[40:41] op_sel_hi:[1,0,1] neg_lo:[0,1,0] neg_hi:[0,1,0]
    v_pk_fma_f32 v[42:43], v[142:143], v[108:109], v[42:43] op_sel_hi:[1,0,1] neg_lo:[0,1,0] neg_hi:[0,1,0]
    v_pk_fma_f32 v[44:45], v[144:145], v[108:109], v[44:45] op_sel_hi:[1,0,1] neg_lo:[0,1,0] neg_hi:[0,1,0]
    v_pk_fma_f32 v[46:47], v[146:147], v[108:109], v[46:47] op_sel_hi:[1,0,1] neg_lo:[0,1,0] neg_hi:[0,1,0]
    v_pk_mul_f32 v[32:33], v[32:33], v[104:105] op_sel_hi:[1,0]
    v_pk_mul_f32 v[34:35], v[34:35], v[104:105] op_sel_hi:[1,0]
    v_pk_mul_f32 v[36:37], v[36:37], v[104:105] op_sel_hi:[1,0]
    v_pk_mul_f32 v[38:39], v[38:39], v[104:105] op_sel_hi:[1,0]
    v_pk_mul_f32 v[40:41], v[40:41], v[104:105] op_sel_hi:[1,0]
    v_pk_mul_f32 v[42:43], v[42:43], v[104:105] op_sel_hi:[1,0]
    v_pk_mul_f32 v[44:45], v[44:45], v[104:105] op_sel_hi:[1,0]
    v_pk_mul_f32 v[46:47], v[46:47], v[104:105] op_sel_hi:[1,0]
    v_cvt_pk_bf16_f32 v32, v32, v33
    v_cvt_pk_bf16_f32 v33, v34, v35
    v_cvt_pk_bf16_f32 v34, v36, v37
    v_cvt_pk_bf16_f32 v35, v38, v39
    v_cvt_pk_bf16_f32 v36, v40, v41
    v_cvt_pk_bf16_f32 v37, v42, v43
    v_cvt_pk_bf16_f32 v38, v44, v45
    v_cvt_pk_bf16_f32 v39, v46, v47
    buffer_store_dwordx4 v[32:35], v96, s[20:23], s32 offen offset:0
    buffer_store_dwordx4 v[36:39], v96, s[20:23], s32 offen offset:1024
    v_pk_fma_f32 v[48:49], v[132:133], v[110:111], v[48:49] op_sel_hi:[1,0,1] neg_lo:[0,1,0] neg_hi:[0,1,0]
    v_pk_fma_f32 v[50:51], v[134:135], v[110:111], v[50:51] op_sel_hi:[1,0,1] neg_lo:[0,1,0] neg_hi:[0,1,0]
    v_pk_fma_f32 v[52:53], v[136:137], v[110:111], v[52:53] op_sel_hi:[1,0,1] neg_lo:[0,1,0] neg_hi:[0,1,0]
    v_pk_fma_f32 v[54:55], v[138:139], v[110:111], v[54:55] op_sel_hi:[1,0,1] neg_lo:[0,1,0] neg_hi:[0,1,0]
    v_pk_fma_f32 v[56:57], v[140:141], v[110:111], v[56:57] op_sel_hi:[1,0,1] neg_lo:[0,1,0] neg_hi:[0,1,0]
    v_pk_fma_f32 v[58:59], v[142:143], v[110:111], v[58:59] op_sel_hi:[1,0,1] neg_lo:[0,1,0] neg_hi:[0,1,0]
    v_pk_fma_f32 v[60:61], v[144:145], v[110:111], v[60:61] op_sel_hi:[1,0,1] neg_lo:[0,1,0] neg_hi:[0,1,0]
    v_pk_fma_f32 v[62:63], v[146:147], v[110:111], v[62:63] op_sel_hi:[1,0,1] neg_lo:[0,1,0] neg_hi:[0,1,0]
    v_pk_mul_f32 v[48:49], v[48:49], v[106:107] op_sel_hi:[1,0]
    v_pk_mul_f32 v[50:51], v[50:51], v[106:107] op_sel_hi:[1,0]
    v_pk_mul_f32 v[52:53], v[52:53], v[106:107] op_sel_hi:[1,0]
    v_pk_mul_f32 v[54:55], v[54:55], v[106:107] op_sel_hi:[1,0]
    v_pk_mul_f32 v[56:57], v[56:57], v[106:107] op_sel_hi:[1,0]
    v_pk_mul_f32 v[58:59], v[58:59], v[106:107] op_sel_hi:[1,0]
    v_pk_mul_f32 v[60:61], v[60:61], v[106:107] op_sel_hi:[1,0]
    v_pk_mul_f32 v[62:63], v[62:63], v[106:107] op_sel_hi:[1,0]
    v_cvt_pk_bf16_f32 v48, v48, v49
    v_cvt_pk_bf16_f32 v49, v50, v51
    v_cvt_pk_bf16_f32 v50, v52, v53
    v_cvt_pk_bf16_f32 v51, v54, v55
    v_cvt_pk_bf16_f32 v52, v56, v57
    v_cvt_pk_bf16_f32 v53, v58, v59
    v_cvt_pk_bf16_f32 v54, v60, v61
    v_cvt_pk_bf16_f32 v55, v62, v63
    buffer_store_dwordx4 v[48:51], v96, s[20:23], s33 offen offset:0
    buffer_store_dwordx4 v[52:55], v96, s[20:23], s33 offen offset:1024
    s_waitcnt lgkmcnt(0)
    v_pk_fma_f32 v[64:65], v[180:181], v[112:113], v[64:65] op_sel_hi:[1,0,1] neg_lo:[0,1,0] neg_hi:[0,1,0]
    v_pk_fma_f32 v[66:67], v[182:183], v[112:113], v[66:67] op_sel_hi:[1,0,1] neg_lo:[0,1,0] neg_hi:[0,1,0]
    v_pk_fma_f32 v[68:69], v[184:185], v[112:113], v[68:69] op_sel_hi:[1,0,1] neg_lo:[0,1,0] neg_hi:[0,1,0]
    v_pk_fma_f32 v[70:71], v[186:187], v[112:113], v[70:71] op_sel_hi:[1,0,1] neg_lo:[0,1,0] neg_hi:[0,1,0]
    v_pk_fma_f32 v[72:73], v[188:189], v[112:113], v[72:73] op_sel_hi:[1,0,1] neg_lo:[0,1,0] neg_hi:[0,1,0]
    v_pk_fma_f32 v[74:75], v[190:191], v[112:113], v[74:75] op_sel_hi:[1,0,1] neg_lo:[0,1,0] neg_hi:[0,1,0]
    v_pk_fma_f32 v[76:77], v[192:193], v[112:113], v[76:77] op_sel_hi:[1,0,1] neg_lo:[0,1,0] neg_hi:[0,1,0]
    v_pk_fma_f32 v[78:79], v[194:195], v[112:113], v[78:79] op_sel_hi:[1,0,1] neg_lo:[0,1,0] neg_hi:[0,1,0]
    v_pk_mul_f32 v[64:65], v[64:65], v[148:149]
    v_pk_mul_f32 v[66:67], v[66:67], v[150:151]
    v_pk_mul_f32 v[68:69], v[68:69], v[152:153]
    v_pk_mul_f32 v[70:71], v[70:71], v[154:155]
    v_pk_mul_f32 v[72:73], v[72:73], v[156:157]
    v_pk_mul_f32 v[74:75], v[74:75], v[158:159]
    v_pk_mul_f32 v[76:77], v[76:77], v[160:161]
    v_pk_mul_f32 v[78:79], v[78:79], v[162:163]
    v_cvt_pk_bf16_f32 v64, v64, v65
    v_cvt_pk_bf16_f32 v65, v66, v67
    v_cvt_pk_bf16_f32 v66, v68, v69
    v_cvt_pk_bf16_f32 v67, v70, v71
    v_cvt_pk_bf16_f32 v68, v72, v73
    v_cvt_pk_bf16_f32 v69, v74, v75
    v_cvt_pk_bf16_f32 v70, v76, v77
    v_cvt_pk_bf16_f32 v71, v78, v79
    buffer_store_dwordx4 v[64:67], v96, s[20:23], s32 offen offset:2048
    buffer_store_dwordx4 v[68:71], v96, s[20:23], s32 offen offset:3072
    v_pk_fma_f32 v[80:81], v[196:197], v[112:113], v[80:81] op_sel_hi:[1,0,1] neg_lo:[0,1,0] neg_hi:[0,1,0]
    v_pk_fma_f32 v[82:83], v[198:199], v[112:113], v[82:83] op_sel_hi:[1,0,1] neg_lo:[0,1,0] neg_hi:[0,1,0]
    v_pk_fma_f32 v[84:85], v[200:201], v[112:113], v[84:85] op_sel_hi:[1,0,1] neg_lo:[0,1,0] neg_hi:[0,1,0]
    v_pk_fma_f32 v[86:87], v[202:203], v[112:113], v[86:87] op_sel_hi:[1,0,1] neg_lo:[0,1,0] neg_hi:[0,1,0]
    v_pk_fma_f32 v[88:89], v[204:205], v[112:113], v[88:89] op_sel_hi:[1,0,1] neg_lo:[0,1,0] neg_hi:[0,1,0]
    v_pk_fma_f32 v[90:91], v[206:207], v[112:113], v[90:91] op_sel_hi:[1,0,1] neg_lo:[0,1,0] neg_hi:[0,1,0]
    v_pk_fma_f32 v[92:93], v[208:209], v[112:113], v[92:93] op_sel_hi:[1,0,1] neg_lo:[0,1,0] neg_hi:[0,1,0]
    v_pk_fma_f32 v[94:95], v[210:211], v[112:113], v[94:95] op_sel_hi:[1,0,1] neg_lo:[0,1,0] neg_hi:[0,1,0]
    v_pk_mul_f32 v[80:81], v[80:81], v[164:165]
    v_pk_mul_f32 v[82:83], v[82:83], v[166:167]
    v_pk_mul_f32 v[84:85], v[84:85], v[168:169]
    v_pk_mul_f32 v[86:87], v[86:87], v[170:171]
    v_pk_mul_f32 v[88:89], v[88:89], v[172:173]
    v_pk_mul_f32 v[90:91], v[90:91], v[174:175]
    v_pk_mul_f32 v[92:93], v[92:93], v[176:177]
    v_pk_mul_f32 v[94:95], v[94:95], v[178:179]
    v_cvt_pk_bf16_f32 v80, v80, v81
    v_cvt_pk_bf16_f32 v81, v82, v83
    v_cvt_pk_bf16_f32 v82, v84, v85
    v_cvt_pk_bf16_f32 v83, v86, v87
    v_cvt_pk_bf16_f32 v84, v88, v89
    v_cvt_pk_bf16_f32 v85, v90, v91
    v_cvt_pk_bf16_f32 v86, v92, v93
    v_cvt_pk_bf16_f32 v87, v94, v95
    buffer_store_dwordx4 v[80:83], v96, s[20:23], s33 offen offset:2048
    buffer_store_dwordx4 v[84:87], v96, s[20:23], s33 offen offset:3072
qkv0_kernel_end:
    s_endpgm
.globl attn0_kernel
.p2align 8
.type attn0_kernel,@function
attn0_kernel:
    s_cmp_ge_u32 s2, 256
    s_cbranch_scc1 attn0_kernel_end
    s_load_dwordx2 s[8:9], s[0:1], 80
    v_lshrrev_b32 v1, 6, v0
    v_and_b32 v2, 63, v0
    v_readfirstlane_b32 s3, v1
    s_and_b32 s24, s2, 7
    s_lshr_b32 s25, s2, 3
    s_lshr_b32 s26, s24, 2
    s_lshl_b32 s26, s26, 3
    s_and_b32 s27, s25, 7
    s_add_u32 s26, s26, s27
    s_and_b32 s27, s24, 3
    s_lshl_b32 s27, s27, 2
    s_lshr_b32 s25, s25, 3
    s_add_u32 s27, s27, s25
    s_lshr_b32 s28, s3, 2
    s_and_b32 s29, s3, 3
    s_lshl_b32 s30, s27, 1
    s_add_u32 s30, s30, s28
    s_lshl_b32 s31, s26, 2
    s_add_u32 s37, s31, s29
    v_lshlrev_b32 v3, 4, v2
    s_waitcnt lgkmcnt(0)
    s_mov_b32 s20, s8
    s_mov_b32 s21, s9
    s_mov_b32 s22, 0x8000000
    s_mov_b32 s23, 0x20000
    s_lshl_b32 s32, s30, 6
    s_add_u32 s33, s32, s37
    s_lshl_b32 s33, s33, 11
    s_add_u32 s33, s33, 0x0
    buffer_load_dwordx4 v[4:7], v3, s[20:23], s33 offen
    buffer_load_dwordx4 v[8:11], v3, s[20:23], s33 offen offset:1024
    s_mul_i32 s34, s29, 3
    s_mul_i32 s35, s28, 12
    s_add_u32 s35, s35, s34
    s_lshl_b32 s35, s35, 12
    s_add_u32 s34, s34, s31
    s_sub_u32 s34, s34, 8
    s_max_i32 s36, s34, 0
    s_add_u32 s36, s36, s32
    s_lshl_b32 s36, s36, 12
    s_add_u32 s36, s36, 0x400000
    s_mov_b32 m0, s35
    s_add_u32 s34, s34, 1
    buffer_load_dwordx4 v3, s[20:23], s36 offen offset:0 lds
    buffer_load_dwordx4 v3, s[20:23], s36 offen offset:1024 lds
    buffer_load_dwordx4 v3, s[20:23], s36 offen offset:2048 lds
    buffer_load_dwordx4 v3, s[20:23], s36 offen offset:3072 lds
    s_add_u32 s35, s35, 4096
    s_max_i32 s36, s34, 0
    s_add_u32 s36, s36, s32
    s_lshl_b32 s36, s36, 12
    s_add_u32 s36, s36, 0x400000
    s_mov_b32 m0, s35
    s_add_u32 s34, s34, 1
    buffer_load_dwordx4 v3, s[20:23], s36 offen offset:0 lds
    buffer_load_dwordx4 v3, s[20:23], s36 offen offset:1024 lds
    buffer_load_dwordx4 v3, s[20:23], s36 offen offset:2048 lds
    buffer_load_dwordx4 v3, s[20:23], s36 offen offset:3072 lds
    s_add_u32 s35, s35, 4096
    s_max_i32 s36, s34, 0
    s_add_u32 s36, s36, s32
    s_lshl_b32 s36, s36, 12
    s_add_u32 s36, s36, 0x400000
    s_mov_b32 m0, s35
    s_add_u32 s34, s34, 1
    buffer_load_dwordx4 v3, s[20:23], s36 offen offset:0 lds
    buffer_load_dwordx4 v3, s[20:23], s36 offen offset:1024 lds
    buffer_load_dwordx4 v3, s[20:23], s36 offen offset:2048 lds
    buffer_load_dwordx4 v3, s[20:23], s36 offen offset:3072 lds
    s_add_u32 s35, s35, 4096
    s_mov_b32 s40, 0xffffffff
    s_mov_b32 s41, 0xfffffff0
    s_mov_b32 s42, 0xfffffffe
    s_mov_b32 s43, 0xffffffe0
    s_mov_b32 s44, 0xfffffffc
    s_mov_b32 s45, 0xffffffc0
    s_mov_b32 s46, 0xfffffff8
    s_mov_b32 s47, 0xffffff80
    s_mov_b32 s48, 0xffffff00
    s_mov_b32 s49, 0xfffff000
    s_mov_b32 s50, 0xfffffe00
    s_mov_b32 s51, 0xffffe000
    s_mov_b32 s52, 0xfffffc00
    s_mov_b32 s53, 0xffffc000
    s_mov_b32 s54, 0xfffff800
    s_mov_b32 s55, 0xffff8000
    s_mov_b32 s56, 0xffff0000
    s_mov_b32 s57, 0xfff00000
    s_mov_b32 s58, 0xfffe0000
    s_mov_b32 s59, 0xffe00000
    s_mov_b32 s60, 0xfffc0000
    s_mov_b32 s61, 0xffc00000
    s_mov_b32 s62, 0xfff80000
    s_mov_b32 s63, 0xff800000
    s_mov_b32 s64, 0xff000000
    s_mov_b32 s65, 0xf0000000
    s_mov_b32 s66, 0xfe000000
    s_mov_b32 s67, 0xe0000000
    s_mov_b32 s68, 0xfc000000
    s_mov_b32 s69, 0xc0000000
    s_mov_b32 s70, 0xf8000000
    s_mov_b32 s71, 0x80000000
    v_mov_b32 v20, 0xffff
    v_mov_b32 v21, 0xffff0000
    v_cndmask_b32 v22, 0, v20, s[40:41]
    v_cndmask_b32 v23, 0, v21, s[42:43]
    v_or_b32 v12, v22, v23
    v_cndmask_b32 v22, 0, v20, s[44:45]
    v_cndmask_b32 v23, 0, v21, s[46:47]
    v_or_b32 v13, v22, v23
    v_cndmask_b32 v22, 0, v20, s[48:49]
    v_cndmask_b32 v23, 0, v21, s[50:51]
    v_or_b32 v14, v22, v23
    v_cndmask_b32 v22, 0, v20, s[52:53]
    v_cndmask_b32 v23, 0, v21, s[54:55]
    v_or_b32 v15, v22, v23
    v_cndmask_b32 v22, 0, v20, s[56:57]
    v_cndmask_b32 v23, 0, v21, s[58:59]
    v_or_b32 v16, v22, v23
    v_cndmask_b32 v22, 0, v20, s[60:61]
    v_cndmask_b32 v23, 0, v21, s[62:63]
    v_or_b32 v17, v22, v23
    v_cndmask_b32 v22, 0, v20, s[64:65]
    v_cndmask_b32 v23, 0, v21, s[66:67]
    v_or_b32 v18, v22, v23
    v_cndmask_b32 v22, 0, v20, s[68:69]
    v_cndmask_b32 v23, 0, v21, s[70:71]
    v_or_b32 v19, v22, v23
    s_mul_i32 s34, s28, 12
    s_add_u32 s34, s34, s29
    s_lshl_b32 s34, s34, 12
    v_add_u32 v20, s34, v3
    v_mov_b32 v24, 0
    v_mov_b32 v25, 0
    v_mov_b32 v26, 0
    v_mov_b32 v27, 0
    v_mov_b32 v28, 0
    v_mov_b32 v29, 0
    v_mov_b32 v30, 0
    v_mov_b32 v31, 0
    v_mov_b32 v32, 0
    v_mov_b32 v33, 0
    v_mov_b32 v34, 0
    v_mov_b32 v35, 0
    v_mov_b32 v36, 0
    v_mov_b32 v37, 0
    v_mov_b32 v38, 0
    v_mov_b32 v39, 0
    s_waitcnt vmcnt(0)
    s_barrier
    ds_read_b128 v[104:107], v20 offset:32768
    ds_read_b128 v[108:111], v20 offset:33792
    ds_read_b128 v[112:115], v20 offset:28672
    ds_read_b128 v[116:119], v20 offset:29696
    s_waitcnt lgkmcnt(2)
    v_mfma_f32_32x32x16_bf16 v[40:55], v[104:107], v[4:7], 0
    v_mfma_f32_32x32x16_bf16 v[40:55], v[108:111], v[8:11], v[40:55]
    ds_read_b128 v[104:107], v20 offset:24576
    ds_read_b128 v[108:111], v20 offset:25600
    s_cmp_eq_u32 s37, 0
    s_cbranch_scc0 attn0_kernel_a1
    v_mov_b32 v24, 0xf149f2ca
    v_mov_b32 v25, 0xf149f2ca
    v_mov_b32 v26, 0xf149f2ca
    v_mov_b32 v27, 0xf149f2ca
    v_mov_b32 v28, 0xf149f2ca
    v_mov_b32 v29, 0xf149f2ca
    v_mov_b32 v30, 0xf149f2ca
    v_mov_b32 v31, 0xf149f2ca
    v_mov_b32 v32, 0xf149f2ca
    v_mov_b32 v33, 0xf149f2ca
    v_mov_b32 v34, 0xf149f2ca
    v_mov_b32 v35, 0xf149f2ca
    v_mov_b32 v36, 0xf149f2ca
    v_mov_b32 v37, 0xf149f2ca
    v_mov_b32 v38, 0xf149f2ca
    v_mov_b32 v39, 0xf149f2ca
attn0_kernel_a1:
    s_waitcnt lgkmcnt(2)
    s_nop 0
    v_mfma_f32_32x32x16_bf16 v[72:87], v[112:115], v[4:7], v[24:39]
    v_mfma_f32_32x32x16_bf16 v[72:87], v[116:119], v[8:11], v[72:87]
    ds_read_b128 v[112:115], v20 offset:20480
    ds_read_b128 v[116:119], v20 offset:21504
    s_cmp_eq_u32 s37, 1
    s_cbranch_scc0 attn0_kernel_a2
    s_nop 1
    v_mov_b32 v24, 0xf149f2ca
    v_mov_b32 v25, 0xf149f2ca
    v_mov_b32 v26, 0xf149f2ca
    v_mov_b32 v27, 0xf149f2ca
    v_mov_b32 v28, 0xf149f2ca
    v_mov_b32 v29, 0xf149f2ca
    v_mov_b32 v30, 0xf149f2ca
    v_mov_b32 v31, 0xf149f2ca
    v_mov_b32 v32, 0xf149f2ca
    v_mov_b32 v33, 0xf149f2ca
    v_mov_b32 v34, 0xf149f2ca
    v_mov_b32 v35, 0xf149f2ca
    v_mov_b32 v36, 0xf149f2ca
    v_mov_b32 v37, 0xf149f2ca
    v_mov_b32 v38, 0xf149f2ca
    v_mov_b32 v39, 0xf149f2ca
attn0_kernel_a2:
    s_waitcnt lgkmcnt(2)
    s_nop 0
    v_mfma_f32_32x32x16_bf16 v[56:71], v[104:107], v[4:7], v[24:39]
    v_mfma_f32_32x32x16_bf16 v[56:71], v[108:111], v[8:11], v[56:71]
    s_nop 3
    v_max_f32 v21, v72, v73
    v_max3_f32 v21, v21, v74, v75
    v_max3_f32 v21, v21, v76, v77
    v_max3_f32 v21, v21, v78, v79
    v_max3_f32 v21, v21, v80, v81
    v_max3_f32 v21, v21, v82, v83
    v_max3_f32 v21, v21, v84, v85
    v_max3_f32 v21, v21, v86, v87
    ds_read_b128 v[104:107], v20 offset:16384
    ds_read_b128 v[108:111], v20 offset:17408
    s_cmp_eq_u32 s37, 2
    s_cbranch_scc0 attn0_kernel_a3
    v_mov_b32 v24, 0xf149f2ca
    v_mov_b32 v25, 0xf149f2ca
    v_mov_b32 v26, 0xf149f2ca
    v_mov_b32 v27, 0xf149f2ca
    v_mov_b32 v28, 0xf149f2ca
    v_mov_b32 v29, 0xf149f2ca
    v_mov_b32 v30, 0xf149f2ca
    v_mov_b32 v31, 0xf149f2ca
    v_mov_b32 v32, 0xf149f2ca
    v_mov_b32 v33, 0xf149f2ca
    v_mov_b32 v34, 0xf149f2ca
    v_mov_b32 v35, 0xf149f2ca
    v_mov_b32 v36, 0xf149f2ca
    v_mov_b32 v37, 0xf149f2ca
    v_mov_b32 v38, 0xf149f2ca
    v_mov_b32 v39, 0xf149f2ca
attn0_kernel_a3:
    s_waitcnt lgkmcnt(2)
    s_nop 0
    v_mfma_f32_32x32x16_bf16 v[72:87], v[112:115], v[4:7], v[24:39]
    v_mfma_f32_32x32x16_bf16 v[72:87], v[116:119], v[8:11], v[72:87]
    v_max3_f32 v21, v21, v56, v57
    v_max3_f32 v21, v21, v58, v59
    v_max3_f32 v21, v21, v60, v61
    v_max3_f32 v21, v21, v62, v63
    v_max3_f32 v21, v21, v64, v65
    v_max3_f32 v21, v21, v66, v67
    v_max3_f32 v21, v21, v68, v69
    v_max3_f32 v21, v21, v70, v71
    ds_read_b128 v[112:115], v20 offset:12288
    ds_read_b128 v[116:119], v20 offset:13312
    s_cmp_eq_u32 s37, 3
    s_cbranch_scc0 attn0_kernel_a4
    v_mov_b32 v24, 0xf149f2ca
    v_mov_b32 v25, 0xf149f2ca
    v_mov_b32 v26, 0xf149f2ca
    v_mov_b32 v27, 0xf149f2ca
    v_mov_b32 v28, 0xf149f2ca
    v_mov_b32 v29, 0xf149f2ca
    v_mov_b32 v30, 0xf149f2ca
    v_mov_b32 v31, 0xf149f2ca
    v_mov_b32 v32, 0xf149f2ca
    v_mov_b32 v33, 0xf149f2ca
    v_mov_b32 v34, 0xf149f2ca
    v_mov_b32 v35, 0xf149f2ca
    v_mov_b32 v36, 0xf149f2ca
    v_mov_b32 v37, 0xf149f2ca
    v_mov_b32 v38, 0xf149f2ca
    v_mov_b32 v39, 0xf149f2ca
attn0_kernel_a4:
    s_waitcnt lgkmcnt(2)
    s_nop 0
    v_mfma_f32_32x32x16_bf16 v[56:71], v[104:107], v[4:7], v[24:39]
    v_mfma_f32_32x32x16_bf16 v[56:71], v[108:111], v[8:11], v[56:71]
    v_max3_f32 v21, v21, v72, v73
    v_max3_f32 v21, v21, v74, v75
    v_max3_f32 v21, v21, v76, v77
    v_max3_f32 v21, v21, v78, v79
    v_max3_f32 v21, v21, v80, v81
    v_max3_f32 v21, v21, v82, v83
    v_max3_f32 v21, v21, v84, v85
    v_max3_f32 v21, v21, v86, v87
    ds_read_b128 v[104:107], v20 offset:8192
    ds_read_b128 v[108:111], v20 offset:9216
    s_cmp_eq_u32 s37, 4
    s_cbranch_scc0 attn0_kernel_a5
    v_mov_b32 v24, 0xf149f2ca
    v_mov_b32 v25, 0xf149f2ca
    v_mov_b32 v26, 0xf149f2ca
    v_mov_b32 v27, 0xf149f2ca
    v_mov_b32 v28, 0xf149f2ca
    v_mov_b32 v29, 0xf149f2ca
    v_mov_b32 v30, 0xf149f2ca
    v_mov_b32 v31, 0xf149f2ca
    v_mov_b32 v32, 0xf149f2ca
    v_mov_b32 v33, 0xf149f2ca
    v_mov_b32 v34, 0xf149f2ca
    v_mov_b32 v35, 0xf149f2ca
    v_mov_b32 v36, 0xf149f2ca
    v_mov_b32 v37, 0xf149f2ca
    v_mov_b32 v38, 0xf149f2ca
    v_mov_b32 v39, 0xf149f2ca
attn0_kernel_a5:
    s_waitcnt lgkmcnt(2)
    s_nop 0
    v_mfma_f32_32x32x16_bf16 v[72:87], v[112:115], v[4:7], v[24:39]
    v_mfma_f32_32x32x16_bf16 v[72:87], v[116:119], v[8:11], v[72:87]
    v_max3_f32 v21, v21, v56, v57
    v_max3_f32 v21, v21, v58, v59
    v_max3_f32 v21, v21, v60, v61
    v_max3_f32 v21, v21, v62, v63
    v_max3_f32 v21, v21, v64, v65
    v_max3_f32 v21, v21, v66, v67
    v_max3_f32 v21, v21, v68, v69
    v_max3_f32 v21, v21, v70, v71
    ds_read_b128 v[112:115], v20 offset:4096
    ds_read_b128 v[116:119], v20 offset:5120
    s_cmp_eq_u32 s37, 5
    s_cbranch_scc0 attn0_kernel_a6
    v_mov_b32 v24, 0xf149f2ca
    v_mov_b32 v25, 0xf149f2ca
    v_mov_b32 v26, 0xf149f2ca
    v_mov_b32 v27, 0xf149f2ca
    v_mov_b32 v28, 0xf149f2ca
    v_mov_b32 v29, 0xf149f2ca
    v_mov_b32 v30, 0xf149f2ca
    v_mov_b32 v31, 0xf149f2ca
    v_mov_b32 v32, 0xf149f2ca
    v_mov_b32 v33, 0xf149f2ca
    v_mov_b32 v34, 0xf149f2ca
    v_mov_b32 v35, 0xf149f2ca
    v_mov_b32 v36, 0xf149f2ca
    v_mov_b32 v37, 0xf149f2ca
    v_mov_b32 v38, 0xf149f2ca
    v_mov_b32 v39, 0xf149f2ca
attn0_kernel_a6:
    s_waitcnt lgkmcnt(2)
    s_nop 0
    v_mfma_f32_32x32x16_bf16 v[56:71], v[104:107], v[4:7], v[24:39]
    v_mfma_f32_32x32x16_bf16 v[56:71], v[108:111], v[8:11], v[56:71]
    v_max3_f32 v21, v21, v72, v73
    v_max3_f32 v21, v21, v74, v75
    v_max3_f32 v21, v21, v76, v77
    v_max3_f32 v21, v21, v78, v79
    v_max3_f32 v21, v21, v80, v81
    v_max3_f32 v21, v21, v82, v83
    v_max3_f32 v21, v21, v84, v85
    v_max3_f32 v21, v21, v86, v87
    ds_read_b128 v[104:107], v20 offset:0
    ds_read_b128 v[108:111], v20 offset:1024
    s_cmp_eq_u32 s37, 6
    s_cbranch_scc0 attn0_kernel_a7
    v_mov_b32 v24, 0xf149f2ca
    v_mov_b32 v25, 0xf149f2ca
    v_mov_b32 v26, 0xf149f2ca
    v_mov_b32 v27, 0xf149f2ca
    v_mov_b32 v28, 0xf149f2ca
    v_mov_b32 v29, 0xf149f2ca
    v_mov_b32 v30, 0xf149f2ca
    v_mov_b32 v31, 0xf149f2ca
    v_mov_b32 v32, 0xf149f2ca
    v_mov_b32 v33, 0xf149f2ca
    v_mov_b32 v34, 0xf149f2ca
    v_mov_b32 v35, 0xf149f2ca
    v_mov_b32 v36, 0xf149f2ca
    v_mov_b32 v37, 0xf149f2ca
    v_mov_b32 v38, 0xf149f2ca
    v_mov_b32 v39, 0xf149f2ca
attn0_kernel_a7:
    s_waitcnt lgkmcnt(2)
    s_nop 0
    v_mfma_f32_32x32x16_bf16 v[72:87], v[112:115], v[4:7], v[24:39]
    v_mfma_f32_32x32x16_bf16 v[72:87], v[116:119], v[8:11], v[72:87]
    v_max3_f32 v21, v21, v56, v57
    v_max3_f32 v21, v21, v58, v59
    v_max3_f32 v21, v21, v60, v61
    v_max3_f32 v21, v21, v62, v63
    v_max3_f32 v21, v21, v64, v65
    v_max3_f32 v21, v21, v66, v67
    v_max3_f32 v21, v21, v68, v69
    v_max3_f32 v21, v21, v70, v71
    s_cmp_eq_u32 s37, 7
    s_cbranch_scc0 attn0_kernel_a8
    v_mov_b32 v24, 0xf149f2ca
    v_mov_b32 v25, 0xf149f2ca
    v_mov_b32 v26, 0xf149f2ca
    v_mov_b32 v27, 0xf149f2ca
    v_mov_b32 v28, 0xf149f2ca
    v_mov_b32 v29, 0xf149f2ca
    v_mov_b32 v30, 0xf149f2ca
    v_mov_b32 v31, 0xf149f2ca
    v_mov_b32 v32, 0xf149f2ca
    v_mov_b32 v33, 0xf149f2ca
    v_mov_b32 v34, 0xf149f2ca
    v_mov_b32 v35, 0xf149f2ca
    v_mov_b32 v36, 0xf149f2ca
    v_mov_b32 v37, 0xf149f2ca
    v_mov_b32 v38, 0xf149f2ca
    v_mov_b32 v39, 0xf149f2ca
attn0_kernel_a8:
    s_waitcnt lgkmcnt(0)
    s_nop 0
    v_mfma_f32_32x32x16_bf16 v[56:71], v[104:107], v[4:7], v[24:39]
    v_mfma_f32_32x32x16_bf16 v[56:71], v[108:111], v[8:11], v[56:71]
    v_max3_f32 v21, v21, v72, v73
    v_max3_f32 v21, v21, v74, v75
    v_max3_f32 v21, v21, v76, v77
    v_max3_f32 v21, v21, v78, v79
    v_max3_f32 v21, v21, v80, v81
    v_max3_f32 v21, v21, v82, v83
    v_max3_f32 v21, v21, v84, v85
    v_max3_f32 v21, v21, v86, v87
    ds_read_b128 v[112:115], v20 offset:28672
    ds_read_b128 v[116:119], v20 offset:29696
    ds_read_b128 v[120:123], v20 offset:34816
    ds_read_b128 v[124:127], v20 offset:35840
    ds_read_b128 v[128:131], v20 offset:2048
    ds_read_b128 v[132:135], v20 offset:3072
    v_cndmask_b32 v40, v56, v40, s[40:41]
    v_cndmask_b32 v41, v57, v41, s[42:43]
    v_cndmask_b32 v42, v58, v42, s[44:45]
    v_cndmask_b32 v43, v59, v43, s[46:47]
    v_cndmask_b32 v44, v60, v44, s[48:49]
    v_cndmask_b32 v45, v61, v45, s[50:51]
    v_cndmask_b32 v46, v62, v46, s[52:53]
    v_cndmask_b32 v47, v63, v47, s[54:55]
    v_cndmask_b32 v48, v64, v48, s[56:57]
    v_cndmask_b32 v49, v65, v49, s[58:59]
    v_cndmask_b32 v50, v66, v50, s[60:61]
    v_cndmask_b32 v51, v67, v51, s[62:63]
    v_cndmask_b32 v52, v68, v52, s[64:65]
    v_cndmask_b32 v53, v69, v53, s[66:67]
    v_cndmask_b32 v54, v70, v54, s[68:69]
    v_cndmask_b32 v55, v71, v55, s[70:71]
    v_max3_f32 v21, v21, v40, v41
    v_max3_f32 v21, v21, v42, v43
    v_max3_f32 v21, v21, v44, v45
    v_max3_f32 v21, v21, v46, v47
    v_max3_f32 v21, v21, v48, v49
    v_max3_f32 v21, v21, v50, v51
    v_max3_f32 v21, v21, v52, v53
    v_max3_f32 v21, v21, v54, v55
    v_mov_b32 v152, v21
    s_nop 1
    v_permlane32_swap_b32 v21, v152
    v_max_f32 v21, v21, v152
    v_sub_f32 v24, 0, v21
    v_sub_f32 v25, 0, v21
    v_sub_f32 v26, 0, v21
    v_sub_f32 v27, 0, v21
    v_sub_f32 v28, 0, v21
    v_sub_f32 v29, 0, v21
    v_sub_f32 v30, 0, v21
    v_sub_f32 v31, 0, v21
    v_sub_f32 v32, 0, v21
    v_sub_f32 v33, 0, v21
    v_sub_f32 v34, 0, v21
    v_sub_f32 v35, 0, v21
    v_sub_f32 v36, 0, v21
    v_sub_f32 v37, 0, v21
    v_sub_f32 v38, 0, v21
    v_sub_f32 v39, 0, v21
    s_cmp_eq_u32 s37, 0
    s_cbranch_scc0 attn0_kernel_b1
    v_mov_b32 v24, 0xf149f2ca
    v_mov_b32 v25, 0xf149f2ca
    v_mov_b32 v26, 0xf149f2ca
    v_mov_b32 v27, 0xf149f2ca
    v_mov_b32 v28, 0xf149f2ca
    v_mov_b32 v29, 0xf149f2ca
    v_mov_b32 v30, 0xf149f2ca
    v_mov_b32 v31, 0xf149f2ca
    v_mov_b32 v32, 0xf149f2ca
    v_mov_b32 v33, 0xf149f2ca
    v_mov_b32 v34, 0xf149f2ca
    v_mov_b32 v35, 0xf149f2ca
    v_mov_b32 v36, 0xf149f2ca
    v_mov_b32 v37, 0xf149f2ca
    v_mov_b32 v38, 0xf149f2ca
    v_mov_b32 v39, 0xf149f2ca
attn0_kernel_b1:
    s_waitcnt lgkmcnt(4)
    s_nop 0
    v_mfma_f32_32x32x16_bf16 v[72:87], v[112:115], v[4:7], v[24:39]
    v_mfma_f32_32x32x16_bf16 v[72:87], v[116:119], v[8:11], v[72:87]
    ds_read_b128 v[104:107], v20 offset:24576
    ds_read_b128 v[108:111], v20 offset:25600
    v_sub_f32 v40, v40, v21
    v_sub_f32 v41, v41, v21
    v_sub_f32 v42, v42, v21
    v_sub_f32 v43, v43, v21
    v_sub_f32 v44, v44, v21
    v_sub_f32 v45, v45, v21
    v_sub_f32 v46, v46, v21
    v_sub_f32 v47, v47, v21
    v_sub_f32 v48, v48, v21
    v_sub_f32 v49, v49, v21
    v_sub_f32 v50, v50, v21
    v_sub_f32 v51, v51, v21
    v_sub_f32 v52, v52, v21
    v_sub_f32 v53, v53, v21
    v_sub_f32 v54, v54, v21
    v_sub_f32 v55, v55, v21
    v_exp_f32 v40, v40
    v_exp_f32 v41, v41
    v_exp_f32 v42, v42
    v_exp_f32 v43, v43
    v_exp_f32 v44, v44
    v_exp_f32 v45, v45
    v_exp_f32 v46, v46
    v_exp_f32 v47, v47
    v_exp_f32 v48, v48
    v_exp_f32 v49, v49
    v_exp_f32 v50, v50
    v_exp_f32 v51, v51
    v_exp_f32 v52, v52
    v_exp_f32 v53, v53
    v_exp_f32 v54, v54
    v_exp_f32 v55, v55
    v_add_f32 v22, v40, v41
    v_add_f32 v23, v42, v43
    v_add_f32 v22, v22, v44
    v_add_f32 v23, v23, v45
    v_add_f32 v22, v22, v46
    v_add_f32 v23, v23, v47
    v_add_f32 v22, v22, v48
    v_add_f32 v23, v23, v49
    v_add_f32 v22, v22, v50
    v_add_f32 v23, v23, v51
    v_add_f32 v22, v22, v52
    v_add_f32 v23, v23, v53
    v_add_f32 v22, v22, v54
    v_add_f32 v23, v23, v55
    v_cvt_pk_bf16_f32 v144, v40, v41
    v_cvt_pk_bf16_f32 v145, v42, v43
    v_cvt_pk_bf16_f32 v146, v44, v45
    v_cvt_pk_bf16_f32 v147, v46, v47
    v_cvt_pk_bf16_f32 v148, v48, v49
    v_cvt_pk_bf16_f32 v149, v50, v51
    v_cvt_pk_bf16_f32 v150, v52, v53
    v_cvt_pk_bf16_f32 v151, v54, v55
    v_and_b32 v136, v144, v12
    v_and_b32 v137, v145, v13
    v_and_b32 v138, v146, v14
    v_and_b32 v139, v147, v15
    v_and_b32 v140, v148, v16
    v_and_b32 v141, v149, v17
    v_and_b32 v142, v150, v18
    v_and_b32 v143, v151, v19
    v_xor_b32 v144, v144, v136
    v_xor_b32 v145, v145, v137
    v_xor_b32 v146, v146, v138
    v_xor_b32 v147, v147, v139
    v_xor_b32 v148, v148, v140
    v_xor_b32 v149, v149, v141
    v_xor_b32 v150, v150, v142
    v_xor_b32 v151, v151, v143
    s_waitcnt lgkmcnt(2)
    v_mfma_f32_32x32x16_bf16 v[88:103], v[120:123], v[136:139], 0
    v_mfma_f32_32x32x16_bf16 v[88:103], v[124:127], v[140:143], v[88:103]
    v_mfma_f32_32x32x16_bf16 v[88:103], v[128:131], v[144:147], v[88:103]
    v_mfma_f32_32x32x16_bf16 v[88:103], v[132:135], v[148:151], v[88:103]
    ds_read_b128 v[128:131], v20 offset:30720
    ds_read_b128 v[132:135], v20 offset:31744
    s_cmp_eq_u32 s37, 1
    s_cbranch_scc0 attn0_kernel_b2
    v_mov_b32 v24, 0xf149f2ca
    v_mov_b32 v25, 0xf149f2ca
    v_mov_b32 v26, 0xf149f2ca
    v_mov_b32 v27, 0xf149f2ca
    v_mov_b32 v28, 0xf149f2ca
    v_mov_b32 v29, 0xf149f2ca
    v_mov_b32 v30, 0xf149f2ca
    v_mov_b32 v31, 0xf149f2ca
    v_mov_b32 v32, 0xf149f2ca
    v_mov_b32 v33, 0xf149f2ca
    v_mov_b32 v34, 0xf149f2ca
    v_mov_b32 v35, 0xf149f2ca
    v_mov_b32 v36, 0xf149f2ca
    v_mov_b32 v37, 0xf149f2ca
    v_mov_b32 v38, 0xf149f2ca
    v_mov_b32 v39, 0xf149f2ca
attn0_kernel_b2:
    s_waitcnt lgkmcnt(2)
    s_nop 0
    v_mfma_f32_32x32x16_bf16 v[56:71], v[104:107], v[4:7], v[24:39]
    v_mfma_f32_32x32x16_bf16 v[56:71], v[108:111], v[8:11], v[56:71]
    ds_read_b128 v[112:115], v20 offset:20480
    ds_read_b128 v[116:119], v20 offset:21504
    v_exp_f32 v72, v72
    v_exp_f32 v73, v73
    v_exp_f32 v74, v74
    v_exp_f32 v75, v75
    v_exp_f32 v76, v76
    v_exp_f32 v77, v77
    v_exp_f32 v78, v78
    v_exp_f32 v79, v79
    v_exp_f32 v80, v80
    v_exp_f32 v81, v81
    v_exp_f32 v82, v82
    v_exp_f32 v83, v83
    v_exp_f32 v84, v84
    v_exp_f32 v85, v85
    v_exp_f32 v86, v86
    v_exp_f32 v87, v87
    v_add_f32 v22, v22, v72
    v_add_f32 v23, v23, v73
    v_add_f32 v22, v22, v74
    v_add_f32 v23, v23, v75
    v_add_f32 v22, v22, v76
    v_add_f32 v23, v23, v77
    v_add_f32 v22, v22, v78
    v_add_f32 v23, v23, v79
    v_add_f32 v22, v22, v80
    v_add_f32 v23, v23, v81
    v_add_f32 v22, v22, v82
    v_add_f32 v23, v23, v83
    v_add_f32 v22, v22, v84
    v_add_f32 v23, v23, v85
    v_add_f32 v22, v22, v86
    v_add_f32 v23, v23, v87
    v_cvt_pk_bf16_f32 v144, v72, v73
    v_cvt_pk_bf16_f32 v145, v74, v75
    v_cvt_pk_bf16_f32 v146, v76, v77
    v_cvt_pk_bf16_f32 v147, v78, v79
    v_cvt_pk_bf16_f32 v148, v80, v81
    v_cvt_pk_bf16_f32 v149, v82, v83
    v_cvt_pk_bf16_f32 v150, v84, v85
    v_cvt_pk_bf16_f32 v151, v86, v87
    s_waitcnt lgkmcnt(2)
    v_mfma_f32_32x32x16_bf16 v[88:103], v[128:131], v[144:147], v[88:103]
    v_mfma_f32_32x32x16_bf16 v[88:103], v[132:135], v[148:151], v[88:103]
    ds_read_b128 v[120:123], v20 offset:26624
    ds_read_b128 v[124:127], v20 offset:27648
    s_cmp_eq_u32 s37, 2
    s_cbranch_scc0 attn0_kernel_b3
    v_mov_b32 v24, 0xf149f2ca
    v_mov_b32 v25, 0xf149f2ca
    v_mov_b32 v26, 0xf149f2ca
    v_mov_b32 v27, 0xf149f2ca
    v_mov_b32 v28, 0xf149f2ca
    v_mov_b32 v29, 0xf149f2ca
    v_mov_b32 v30, 0xf149f2ca
    v_mov_b32 v31, 0xf149f2ca
    v_mov_b32 v32, 0xf149f2ca
    v_mov_b32 v33, 0xf149f2ca
    v_mov_b32 v34, 0xf149f2ca
    v_mov_b32 v35, 0xf149f2ca
    v_mov_b32 v36, 0xf149f2ca
    v_mov_b32 v37, 0xf149f2ca
    v_mov_b32 v38, 0xf149f2ca
    v_mov_b32 v39, 0xf149f2ca
attn0_kernel_b3:
    s_waitcnt lgkmcnt(2)
    s_nop 0
    v_mfma_f32_32x32x16_bf16 v[72:87], v[112:115], v[4:7], v[24:39]
    v_mfma_f32_32x32x16_bf16 v[72:87], v[116:119], v[8:11], v[72:87]
    ds_read_b128 v[104:107], v20 offset:16384
    ds_read_b128 v[108:111], v20 offset:17408
    v_exp_f32 v56, v56
    v_exp_f32 v57, v57
    v_exp_f32 v58, v58
    v_exp_f32 v59, v59
    v_exp_f32 v60, v60
    v_exp_f32 v61, v61
    v_exp_f32 v62, v62
    v_exp_f32 v63, v63
    v_exp_f32 v64, v64
    v_exp_f32 v65, v65
    v_exp_f32 v66, v66
    v_exp_f32 v67, v67
    v_exp_f32 v68, v68
    v_exp_f32 v69, v69
    v_exp_f32 v70, v70
    v_exp_f32 v71, v71
    v_add_f32 v22, v22, v56
    v_add_f32 v23, v23, v57
    v_add_f32 v22, v22, v58
    v_add_f32 v23, v23, v59
    v_add_f32 v22, v22, v60
    v_add_f32 v23, v23, v61
    v_add_f32 v22, v22, v62
    v_add_f32 v23, v23, v63
    v_add_f32 v22, v22, v64
    v_add_f32 v23, v23, v65
    v_add_f32 v22, v22, v66
    v_add_f32 v23, v23, v67
    v_add_f32 v22, v22, v68
    v_add_f32 v23, v23, v69
    v_add_f32 v22, v22, v70
    v_add_f32 v23, v23, v71
    v_cvt_pk_bf16_f32 v136, v56, v57
    v_cvt_pk_bf16_f32 v137, v58, v59
    v_cvt_pk_bf16_f32 v138, v60, v61
    v_cvt_pk_bf16_f32 v139, v62, v63
    v_cvt_pk_bf16_f32 v140, v64, v65
    v_cvt_pk_bf16_f32 v141, v66, v67
    v_cvt_pk_bf16_f32 v142, v68, v69
    v_cvt_pk_bf16_f32 v143, v70, v71
    s_waitcnt lgkmcnt(2)
    v_mfma_f32_32x32x16_bf16 v[88:103], v[120:123], v[136:139], v[88:103]
    v_mfma_f32_32x32x16_bf16 v[88:103], v[124:127], v[140:143], v[88:103]
    ds_read_b128 v[128:131], v20 offset:22528
    ds_read_b128 v[132:135], v20 offset:23552
    s_cmp_eq_u32 s37, 3
    s_cbranch_scc0 attn0_kernel_b4
    v_mov_b32 v24, 0xf149f2ca
    v_mov_b32 v25, 0xf149f2ca
    v_mov_b32 v26, 0xf149f2ca
    v_mov_b32 v27, 0xf149f2ca
    v_mov_b32 v28, 0xf149f2ca
    v_mov_b32 v29, 0xf149f2ca
    v_mov_b32 v30, 0xf149f2ca
    v_mov_b32 v31, 0xf149f2ca
    v_mov_b32 v32, 0xf149f2ca
    v_mov_b32 v33, 0xf149f2ca
    v_mov_b32 v34, 0xf149f2ca
    v_mov_b32 v35, 0xf149f2ca
    v_mov_b32 v36, 0xf149f2ca
    v_mov_b32 v37, 0xf149f2ca
    v_mov_b32 v38, 0xf149f2ca
    v_mov_b32 v39, 0xf149f2ca
attn0_kernel_b4:
    s_waitcnt lgkmcnt(2)
    s_nop 0
    v_mfma_f32_32x32x16_bf16 v[56:71], v[104:107], v[4:7], v[24:39]
    v_mfma_f32_32x32x16_bf16 v[56:71], v[108:111], v[8:11], v[56:71]
    ds_read_b128 v[112:115], v20 offset:12288
    ds_read_b128 v[116:119], v20 offset:13312
    v_exp_f32 v72, v72
    v_exp_f32 v73, v73
    v_exp_f32 v74, v74
    v_exp_f32 v75, v75
    v_exp_f32 v76, v76
    v_exp_f32 v77, v77
    v_exp_f32 v78, v78
    v_exp_f32 v79, v79
    v_exp_f32 v80, v80
    v_exp_f32 v81, v81
    v_exp_f32 v82, v82
    v_exp_f32 v83, v83
    v_exp_f32 v84, v84
    v_exp_f32 v85, v85
    v_exp_f32 v86, v86
    v_exp_f32 v87, v87
    v_add_f32 v22, v22, v72
    v_add_f32 v23, v23, v73
    v_add_f32 v22, v22, v74
    v_add_f32 v23, v23, v75
    v_add_f32 v22, v22, v76
    v_add_f32 v23, v23, v77
    v_add_f32 v22, v22, v78
    v_add_f32 v23, v23, v79
    v_add_f32 v22, v22, v80
    v_add_f32 v23, v23, v81
    v_add_f32 v22, v22, v82
    v_add_f32 v23, v23, v83
    v_add_f32 v22, v22, v84
    v_add_f32 v23, v23, v85
    v_add_f32 v22, v22, v86
    v_add_f32 v23, v23, v87
    v_cvt_pk_bf16_f32 v144, v72, v73
    v_cvt_pk_bf16_f32 v145, v74, v75
    v_cvt_pk_bf16_f32 v146, v76, v77
    v_cvt_pk_bf16_f32 v147, v78, v79
    v_cvt_pk_bf16_f32 v148, v80, v81
    v_cvt_pk_bf16_f32 v149, v82, v83
    v_cvt_pk_bf16_f32 v150, v84, v85
    v_cvt_pk_bf16_f32 v151, v86, v87
    s_waitcnt lgkmcnt(2)
    v_mfma_f32_32x32x16_bf16 v[88:103], v[128:131], v[144:147], v[88:103]
    v_mfma_f32_32x32x16_bf16 v[88:103], v[132:135], v[148:151], v[88:103]
    ds_read_b128 v[120:123], v20 offset:18432
    ds_read_b128 v[124:127], v20 offset:19456
    s_cmp_eq_u32 s37, 4
    s_cbranch_scc0 attn0_kernel_b5
    v_mov_b32 v24, 0xf149f2ca
    v_mov_b32 v25, 0xf149f2ca
    v_mov_b32 v26, 0xf149f2ca
    v_mov_b32 v27, 0xf149f2ca
    v_mov_b32 v28, 0xf149f2ca
    v_mov_b32 v29, 0xf149f2ca
    v_mov_b32 v30, 0xf149f2ca
    v_mov_b32 v31, 0xf149f2ca
    v_mov_b32 v32, 0xf149f2ca
    v_mov_b32 v33, 0xf149f2ca
    v_mov_b32 v34, 0xf149f2ca
    v_mov_b32 v35, 0xf149f2ca
    v_mov_b32 v36, 0xf149f2ca
    v_mov_b32 v37, 0xf149f2ca
    v_mov_b32 v38, 0xf149f2ca
    v_mov_b32 v39, 0xf149f2ca
attn0_kernel_b5:
    s_waitcnt lgkmcnt(2)
    s_nop 0
    v_mfma_f32_32x32x16_bf16 v[72:87], v[112:115], v[4:7], v[24:39]
    v_mfma_f32_32x32x16_bf16 v[72:87], v[116:119], v[8:11], v[72:87]
    ds_read_b128 v[104:107], v20 offset:8192
    ds_read_b128 v[108:111], v20 offset:9216
    v_exp_f32 v56, v56
    v_exp_f32 v57, v57
    v_exp_f32 v58, v58
    v_exp_f32 v59, v59
    v_exp_f32 v60, v60
    v_exp_f32 v61, v61
    v_exp_f32 v62, v62
    v_exp_f32 v63, v63
    v_exp_f32 v64, v64
    v_exp_f32 v65, v65
    v_exp_f32 v66, v66
    v_exp_f32 v67, v67
    v_exp_f32 v68, v68
    v_exp_f32 v69, v69
    v_exp_f32 v70, v70
    v_exp_f32 v71, v71
    v_add_f32 v22, v22, v56
    v_add_f32 v23, v23, v57
    v_add_f32 v22, v22, v58
    v_add_f32 v23, v23, v59
    v_add_f32 v22, v22, v60
    v_add_f32 v23, v23, v61
    v_add_f32 v22, v22, v62
    v_add_f32 v23, v23, v63
    v_add_f32 v22, v22, v64
    v_add_f32 v23, v23, v65
    v_add_f32 v22, v22, v66
    v_add_f32 v23, v23, v67
    v_add_f32 v22, v22, v68
    v_add_f32 v23, v23, v69
    v_add_f32 v22, v22, v70
    v_add_f32 v23, v23, v71
    v_cvt_pk_bf16_f32 v136, v56, v57
    v_cvt_pk_bf16_f32 v137, v58, v59
    v_cvt_pk_bf16_f32 v138, v60, v61
    v_cvt_pk_bf16_f32 v139, v62, v63
    v_cvt_pk_bf16_f32 v140, v64, v65
    v_cvt_pk_bf16_f32 v141, v66, v67
    v_cvt_pk_bf16_f32 v142, v68, v69
    v_cvt_pk_bf16_f32 v143, v70, v71
    s_waitcnt lgkmcnt(2)
    v_mfma_f32_32x32x16_bf16 v[88:103], v[120:123], v[136:139], v[88:103]
    v_mfma_f32_32x32x16_bf16 v[88:103], v[124:127], v[140:143], v[88:103]
    ds_read_b128 v[128:131], v20 offset:14336
    ds_read_b128 v[132:135], v20 offset:15360
    s_cmp_eq_u32 s37, 5
    s_cbranch_scc0 attn0_kernel_b6
    v_mov_b32 v24, 0xf149f2ca
    v_mov_b32 v25, 0xf149f2ca
    v_mov_b32 v26, 0xf149f2ca
    v_mov_b32 v27, 0xf149f2ca
    v_mov_b32 v28, 0xf149f2ca
    v_mov_b32 v29, 0xf149f2ca
    v_mov_b32 v30, 0xf149f2ca
    v_mov_b32 v31, 0xf149f2ca
    v_mov_b32 v32, 0xf149f2ca
    v_mov_b32 v33, 0xf149f2ca
    v_mov_b32 v34, 0xf149f2ca
    v_mov_b32 v35, 0xf149f2ca
    v_mov_b32 v36, 0xf149f2ca
    v_mov_b32 v37, 0xf149f2ca
    v_mov_b32 v38, 0xf149f2ca
    v_mov_b32 v39, 0xf149f2ca
attn0_kernel_b6:
    s_waitcnt lgkmcnt(2)
    s_nop 0
    v_mfma_f32_32x32x16_bf16 v[56:71], v[104:107], v[4:7], v[24:39]
    v_mfma_f32_32x32x16_bf16 v[56:71], v[108:111], v[8:11], v[56:71]
    ds_read_b128 v[112:115], v20 offset:4096
    ds_read_b128 v[116:119], v20 offset:5120
    v_exp_f32 v72, v72
    v_exp_f32 v73, v73
    v_exp_f32 v74, v74
    v_exp_f32 v75, v75
    v_exp_f32 v76, v76
    v_exp_f32 v77, v77
    v_exp_f32 v78, v78
    v_exp_f32 v79, v79
    v_exp_f32 v80, v80
    v_exp_f32 v81, v81
    v_exp_f32 v82, v82
    v_exp_f32 v83, v83
    v_exp_f32 v84, v84
    v_exp_f32 v85, v85
    v_exp_f32 v86, v86
    v_exp_f32 v87, v87
    v_add_f32 v22, v22, v72
    v_add_f32 v23, v23, v73
    v_add_f32 v22, v22, v74
    v_add_f32 v23, v23, v75
    v_add_f32 v22, v22, v76
    v_add_f32 v23, v23, v77
    v_add_f32 v22, v22, v78
    v_add_f32 v23, v23, v79
    v_add_f32 v22, v22, v80
    v_add_f32 v23, v23, v81
    v_add_f32 v22, v22, v82
    v_add_f32 v23, v23, v83
    v_add_f32 v22, v22, v84
    v_add_f32 v23, v23, v85
    v_add_f32 v22, v22, v86
    v_add_f32 v23, v23, v87
    v_cvt_pk_bf16_f32 v144, v72, v73
    v_cvt_pk_bf16_f32 v145, v74, v75
    v_cvt_pk_bf16_f32 v146, v76, v77
    v_cvt_pk_bf16_f32 v147, v78, v79
    v_cvt_pk_bf16_f32 v148, v80, v81
    v_cvt_pk_bf16_f32 v149, v82, v83
    v_cvt_pk_bf16_f32 v150, v84, v85
    v_cvt_pk_bf16_f32 v151, v86, v87
    s_waitcnt lgkmcnt(2)
    v_mfma_f32_32x32x16_bf16 v[88:103], v[128:131], v[144:147], v[88:103]
    v_mfma_f32_32x32x16_bf16 v[88:103], v[132:135], v[148:151], v[88:103]
    ds_read_b128 v[120:123], v20 offset:10240
    ds_read_b128 v[124:127], v20 offset:11264
    s_cmp_eq_u32 s37, 6
    s_cbranch_scc0 attn0_kernel_b7
    v_mov_b32 v24, 0xf149f2ca
    v_mov_b32 v25, 0xf149f2ca
    v_mov_b32 v26, 0xf149f2ca
    v_mov_b32 v27, 0xf149f2ca
    v_mov_b32 v28, 0xf149f2ca
    v_mov_b32 v29, 0xf149f2ca
    v_mov_b32 v30, 0xf149f2ca
    v_mov_b32 v31, 0xf149f2ca
    v_mov_b32 v32, 0xf149f2ca
    v_mov_b32 v33, 0xf149f2ca
    v_mov_b32 v34, 0xf149f2ca
    v_mov_b32 v35, 0xf149f2ca
    v_mov_b32 v36, 0xf149f2ca
    v_mov_b32 v37, 0xf149f2ca
    v_mov_b32 v38, 0xf149f2ca
    v_mov_b32 v39, 0xf149f2ca
attn0_kernel_b7:
    s_waitcnt lgkmcnt(2)
    s_nop 0
    v_mfma_f32_32x32x16_bf16 v[72:87], v[112:115], v[4:7], v[24:39]
    v_mfma_f32_32x32x16_bf16 v[72:87], v[116:119], v[8:11], v[72:87]
    v_exp_f32 v56, v56
    v_exp_f32 v57, v57
    v_exp_f32 v58, v58
    v_exp_f32 v59, v59
    v_exp_f32 v60, v60
    v_exp_f32 v61, v61
    v_exp_f32 v62, v62
    v_exp_f32 v63, v63
    v_exp_f32 v64, v64
    v_exp_f32 v65, v65
    v_exp_f32 v66, v66
    v_exp_f32 v67, v67
    v_exp_f32 v68, v68
    v_exp_f32 v69, v69
    v_exp_f32 v70, v70
    v_exp_f32 v71, v71
    v_add_f32 v22, v22, v56
    v_add_f32 v23, v23, v57
    v_add_f32 v22, v22, v58
    v_add_f32 v23, v23, v59
    v_add_f32 v22, v22, v60
    v_add_f32 v23, v23, v61
    v_add_f32 v22, v22, v62
    v_add_f32 v23, v23, v63
    v_add_f32 v22, v22, v64
    v_add_f32 v23, v23, v65
    v_add_f32 v22, v22, v66
    v_add_f32 v23, v23, v67
    v_add_f32 v22, v22, v68
    v_add_f32 v23, v23, v69
    v_add_f32 v22, v22, v70
    v_add_f32 v23, v23, v71
    v_cvt_pk_bf16_f32 v136, v56, v57
    v_cvt_pk_bf16_f32 v137, v58, v59
    v_cvt_pk_bf16_f32 v138, v60, v61
    v_cvt_pk_bf16_f32 v139, v62, v63
    v_cvt_pk_bf16_f32 v140, v64, v65
    v_cvt_pk_bf16_f32 v141, v66, v67
    v_cvt_pk_bf16_f32 v142, v68, v69
    v_cvt_pk_bf16_f32 v143, v70, v71
    s_waitcnt lgkmcnt(0)
    v_mfma_f32_32x32x16_bf16 v[88:103], v[120:123], v[136:139], v[88:103]
    v_mfma_f32_32x32x16_bf16 v[88:103], v[124:127], v[140:143], v[88:103]
    ds_read_b128 v[128:131], v20 offset:6144
    ds_read_b128 v[132:135], v20 offset:7168
    v_exp_f32 v72, v72
    v_exp_f32 v73, v73
    v_exp_f32 v74, v74
    v_exp_f32 v75, v75
    v_exp_f32 v76, v76
    v_exp_f32 v77, v77
    v_exp_f32 v78, v78
    v_exp_f32 v79, v79
    v_exp_f32 v80, v80
    v_exp_f32 v81, v81
    v_exp_f32 v82, v82
    v_exp_f32 v83, v83
    v_exp_f32 v84, v84
    v_exp_f32 v85, v85
    v_exp_f32 v86, v86
    v_exp_f32 v87, v87
    v_add_f32 v22, v22, v72
    v_add_f32 v23, v23, v73
    v_add_f32 v22, v22, v74
    v_add_f32 v23, v23, v75
    v_add_f32 v22, v22, v76
    v_add_f32 v23, v23, v77
    v_add_f32 v22, v22, v78
    v_add_f32 v23, v23, v79
    v_add_f32 v22, v22, v80
    v_add_f32 v23, v23, v81
    v_add_f32 v22, v22, v82
    v_add_f32 v23, v23, v83
    v_add_f32 v22, v22, v84
    v_add_f32 v23, v23, v85
    v_add_f32 v22, v22, v86
    v_add_f32 v23, v23, v87
    v_cvt_pk_bf16_f32 v144, v72, v73
    v_cvt_pk_bf16_f32 v145, v74, v75
    v_cvt_pk_bf16_f32 v146, v76, v77
    v_cvt_pk_bf16_f32 v147, v78, v79
    v_cvt_pk_bf16_f32 v148, v80, v81
    v_cvt_pk_bf16_f32 v149, v82, v83
    v_cvt_pk_bf16_f32 v150, v84, v85
    v_cvt_pk_bf16_f32 v151, v86, v87
    s_waitcnt lgkmcnt(0)
    v_mfma_f32_32x32x16_bf16 v[88:103], v[128:131], v[144:147], v[88:103]
    v_mfma_f32_32x32x16_bf16 v[88:103], v[132:135], v[148:151], v[88:103]
    v_add_f32 v22, v22, v23
    v_mov_b32 v152, v22
    s_nop 1
    v_permlane32_swap_b32 v22, v152
    v_add_f32 v22, v22, v152
    v_rcp_f32 v22, v22
    s_lshl_b32 s33, s37, 16
    s_lshl_b32 s34, s30, 11
    s_add_u32 s33, s33, s34
    s_add_u32 s33, s33, 0xc00000
    s_nop 0
    v_mul_f32 v88, v88, v22
    v_mul_f32 v89, v89, v22
    v_mul_f32 v90, v90, v22
    v_mul_f32 v91, v91, v22
    v_mul_f32 v92, v92, v22
    v_mul_f32 v93, v93, v22
    v_mul_f32 v94, v94, v22
    v_mul_f32 v95, v95, v22
    v_mul_f32 v96, v96, v22
    v_mul_f32 v97, v97, v22
    v_mul_f32 v98, v98, v22
    v_mul_f32 v99, v99, v22
    v_mul_f32 v100, v100, v22
    v_mul_f32 v101, v101, v22
    v_mul_f32 v102, v102, v22
    v_mul_f32 v103, v103, v22
    v_cvt_pk_bf16_f32 v88, v88, v89
    v_cvt_pk_bf16_f32 v89, v90, v91
    v_cvt_pk_bf16_f32 v90, v92, v93
    v_cvt_pk_bf16_f32 v91, v94, v95
    v_cvt_pk_bf16_f32 v92, v96, v97
    v_cvt_pk_bf16_f32 v93, v98, v99
    v_cvt_pk_bf16_f32 v94, v100, v101
    v_cvt_pk_bf16_f32 v95, v102, v103
    buffer_store_dwordx4 v[88:91], v3, s[20:23], s33 offen
    buffer_store_dwordx4 v[92:95], v3, s[20:23], s33 offen offset:1024
attn0_kernel_end:
    s_endpgm
.globl wo0_kernel
.p2align 8
.type wo0_kernel,@function
wo0_kernel:
    s_cmp_ge_u32 s2, 256
    s_cbranch_scc1 wo0_kernel_end
    s_load_dwordx2 s[4:5], s[0:1], 0
    s_load_dwordx2 s[6:7], s[0:1], 16
    s_load_dwordx2 s[8:9], s[0:1], 80
    s_load_dwordx2 s[10:11], s[0:1], 32
    v_lshrrev_b32 v1, 6, v0
    v_and_b32 v2, 63, v0
    v_readfirstlane_b32 s3, v1
    s_and_b32 s24, s2, 7
    s_lshr_b32 s25, s2, 3
    s_lshl_b32 s26, s24, 1
    s_and_b32 s27, s25, 1
    s_add_u32 s26, s26, s27
    s_lshr_b32 s27, s25, 1
    s_and_b32 s28, s3, 3
    s_lshr_b32 s29, s3, 2
    v_bfe_u32 v4, v2, 3, 2
    v_lshrrev_b32 v5, 5, v2
    v_lshl_add_u32 v4, v5, 3, v4
    s_lshr_b32 s30, s3, 1
    s_lshl_b32 s30, s30, 4
    s_and_b32 s31, s3, 1
    s_lshl_b32 s31, s31, 2
    s_add_u32 s30, s30, s31
    v_add_u32 v4, s30, v4
    v_lshlrev_b32 v4, 11, v4
    v_lshrrev_b32 v6, 2, v2
    v_and_b32 v6, 4, v6
    v_xor_b32 v6, v6, v2
    v_and_b32 v6, 7, v6
    v_lshl_add_u32 v4, v6, 4, v4
    v_lshlrev_b32 v3, 4, v2
    s_waitcnt lgkmcnt(0)
    s_mov_b32 s12, s4
    s_mov_b32 s13, s5
    s_mov_b32 s14, 0x400000
    s_mov_b32 s15, 0x20000
    s_mov_b32 s16, s6
    s_mov_b32 s17, s7
    s_mov_b32 s18, 0x200000
    s_mov_b32 s19, 0x20000
    s_mov_b32 s20, s8
    s_mov_b32 s21, s9
    s_mov_b32 s22, 0x8000000
    s_mov_b32 s23, 0x20000
    s_mov_b32 s40, s10
    s_mov_b32 s41, s11
    s_mov_b32 s42, 0x800
    s_mov_b32 s43, 0x20000
    s_lshl_b32 s30, s27, 7
    s_lshl_b32 s31, s3, 10
    s_mov_b32 m0, s31
    s_nop 0
    buffer_load_dwordx4 v4, s[16:19], s30 offen lds
    s_add_u32 m0, m0, 8192
    s_add_u32 s30, s30, 131072
    buffer_load_dwordx4 v4, s[16:19], s30 offen lds
    s_add_u32 m0, m0, 8192
    s_add_u32 s30, s30, 131072
    buffer_load_dwordx4 v4, s[16:19], s30 offen lds
    s_add_u32 m0, m0, 8192
    s_add_u32 s30, s30, 131072
    buffer_load_dwordx4 v4, s[16:19], s30 offen lds
    s_add_u32 m0, m0, 8192
    s_add_u32 s30, s30, 131072
    buffer_load_dwordx4 v4, s[16:19], s30 offen lds
    s_add_u32 m0, m0, 8192
    s_add_u32 s30, s30, 131072
    buffer_load_dwordx4 v4, s[16:19], s30 offen lds
    s_add_u32 m0, m0, 8192
    s_add_u32 s30, s30, 131072
    buffer_load_dwordx4 v4, s[16:19], s30 offen lds
    s_add_u32 m0, m0, 8192
    s_add_u32 s30, s30, 131072
    buffer_load_dwordx4 v4, s[16:19], s30 offen lds
    s_add_u32 m0, m0, 8192
    s_add_u32 s30, s30, 131072
    buffer_load_dwordx4 v4, s[16:19], s30 offen lds
    s_add_u32 m0, m0, 8192
    s_add_u32 s30, s30, 131072
    buffer_load_dwordx4 v4, s[16:19], s30 offen lds
    s_add_u32 m0, m0, 8192
    s_add_u32 s30, s30, 131072
    buffer_load_dwordx4 v4, s[16:19], s30 offen lds
    s_add_u32 m0, m0, 8192
    s_add_u32 s30, s30, 131072
    buffer_load_dwordx4 v4, s[16:19], s30 offen lds
    s_add_u32 m0, m0, 8192
    s_add_u32 s30, s30, 131072
    buffer_load_dwordx4 v4, s[16:19], s30 offen lds
    s_add_u32 m0, m0, 8192
    s_add_u32 s30, s30, 131072
    buffer_load_dwordx4 v4, s[16:19], s30 offen lds
    s_add_u32 m0, m0, 8192
    s_add_u32 s30, s30, 131072
    buffer_load_dwordx4 v4, s[16:19], s30 offen lds
    s_add_u32 m0, m0, 8192
    s_add_u32 s30, s30, 131072
    buffer_load_dwordx4 v4, s[16:19], s30 offen lds
    v_and_b32 v7, 31, v2
    s_lshl_b32 s32, s26, 2
    s_add_u32 s32, s32, s28
    s_lshl_b32 s33, s27, 7
    s_lshl_b32 s34, s29, 6
    s_add_u32 s33, s33, s34
    v_lshlrev_b32 v8, 3, v5
    buffer_load_dwordx2 v[48:49], v8, s[40:43], s33 offen offset:0
    buffer_load_dwordx2 v[50:51], v8, s[40:43], s33 offen offset:16
    buffer_load_dwordx2 v[52:53], v8, s[40:43], s33 offen offset:32
    buffer_load_dwordx2 v[54:55], v8, s[40:43], s33 offen offset:48
    s_lshl_b32 s35, s26, 4
    s_add_u32 s35, s35, s27
    s_lshl_b32 s35, s35, 14
    s_lshl_b32 s34, s28, 12
    s_add_u32 s35, s35, s34
    s_lshl_b32 s34, s29, 11
    s_add_u32 s35, s35, s34
    v_lshl_add_u32 v9, v7, 11, v8
    s_lshl_b32 s34, s32, 16
    s_add_u32 s34, s34, s33
    buffer_load_dwordx2 v[40:41], v9, s[12:15], s34 offen offset:0
    buffer_load_dwordx2 v[42:43], v9, s[12:15], s34 offen offset:16
    buffer_load_dwordx2 v[44:45], v9, s[12:15], s34 offen offset:32
    buffer_load_dwordx2 v[46:47], v9, s[12:15], s34 offen offset:48
    s_lshl_b32 s36, s32, 16
    s_lshl_b32 s34, s29, 15
    s_add_u32 s36, s36, s34
    s_add_u32 s36, s36, 0xc00000
    buffer_load_dwordx4 v[64:67], v3, s[20:23], s36 offen offset:0
    buffer_load_dwordx4 v[68:71], v3, s[20:23], s36 offen offset:1024
    buffer_load_dwordx4 v[72:75], v3, s[20:23], s36 offen offset:2048
    buffer_load_dwordx4 v[76:79], v3, s[20:23], s36 offen offset:3072
    s_add_u32 s36, s36, 4096
    buffer_load_dwordx4 v[80:83], v3, s[20:23], s36 offen offset:0
    buffer_load_dwordx4 v[84:87], v3, s[20:23], s36 offen offset:1024
    buffer_load_dwordx4 v[88:91], v3, s[20:23], s36 offen offset:2048
    buffer_load_dwordx4 v[92:95], v3, s[20:23], s36 offen offset:3072
    s_add_u32 s36, s36, 4096
    buffer_load_dwordx4 v[96:99], v3, s[20:23], s36 offen offset:0
    buffer_load_dwordx4 v[100:103], v3, s[20:23], s36 offen offset:1024
    buffer_load_dwordx4 v[104:107], v3, s[20:23], s36 offen offset:2048
    buffer_load_dwordx4 v[108:111], v3, s[20:23], s36 offen offset:3072
    s_add_u32 s36, s36, 4096
    buffer_load_dwordx4 v[112:115], v3, s[20:23], s36 offen offset:0
    buffer_load_dwordx4 v[116:119], v3, s[20:23], s36 offen offset:1024
    buffer_load_dwordx4 v[120:123], v3, s[20:23], s36 offen offset:2048
    buffer_load_dwordx4 v[124:127], v3, s[20:23], s36 offen offset:3072
    s_add_u32 s36, s36, 4096
    buffer_load_dwordx4 v[128:131], v3, s[20:23], s36 offen offset:0
    buffer_load_dwordx4 v[132:135], v3, s[20:23], s36 offen offset:1024
    buffer_load_dwordx4 v[136:139], v3, s[20:23], s36 offen offset:2048
    buffer_load_dwordx4 v[140:143], v3, s[20:23], s36 offen offset:3072
    s_add_u32 s36, s36, 4096
    buffer_load_dwordx4 v[144:147], v3, s[20:23], s36 offen offset:0
    buffer_load_dwordx4 v[148:151], v3, s[20:23], s36 offen offset:1024
    buffer_load_dwordx4 v[152:155], v3, s[20:23], s36 offen offset:2048
    buffer_load_dwordx4 v[156:159], v3, s[20:23], s36 offen offset:3072
    s_add_u32 s36, s36, 4096
    buffer_load_dwordx4 v[160:163], v3, s[20:23], s36 offen offset:0
    buffer_load_dwordx4 v[164:167], v3, s[20:23], s36 offen offset:1024
    buffer_load_dwordx4 v[168:171], v3, s[20:23], s36 offen offset:2048
    buffer_load_dwordx4 v[172:175], v3, s[20:23], s36 offen offset:3072
    s_add_u32 s36, s36, 4096
    buffer_load_dwordx4 v[176:179], v3, s[20:23], s36 offen offset:0
    buffer_load_dwordx4 v[180:183], v3, s[20:23], s36 offen offset:1024
    buffer_load_dwordx4 v[184:187], v3, s[20:23], s36 offen offset:2048
    buffer_load_dwordx4 v[188:191], v3, s[20:23], s36 offen offset:3072
    v_bfe_u32 v10, v2, 2, 2
    v_lshl_add_u32 v11, v5, 3, v10
    v_lshlrev_b32 v11, 7, v11
    v_lshrrev_b32 v10, 1, v10
    v_xor_b32 v10, s29, v10
    v_lshl_add_u32 v11, v10, 6, v11
    v_bfe_u32 v10, v2, 4, 1
    v_lshl_add_u32 v11, v10, 5, v11
    v_and_b32 v10, 3, v2
    v_lshl_add_u32 v11, v10, 3, v11
    s_lshl_b32 s34, s29, 16
    v_add_u32 v58, s34, v11
    v_xor_b32 v59, 64, v58
    v_mov_b32 v60, v7
    v_mov_b32 v61, v5
    v_mov_b32 v62, v3
    s_waitcnt vmcnt(40)
    s_barrier
    ds_read_b64_tr_b16 v[192:193], v58 offset:0
    ds_read_b64_tr_b16 v[194:195], v58 offset:512
    ds_read_b64_tr_b16 v[196:197], v59 offset:0
    ds_read_b64_tr_b16 v[198:199], v59 offset:512
    ds_read_b64_tr_b16 v[200:201], v58 offset:2048
    ds_read_b64_tr_b16 v[202:203], v58 offset:2560
    ds_read_b64_tr_b16 v[204:205], v59 offset:2048
    ds_read_b64_tr_b16 v[206:207], v59 offset:2560
    ds_read_b64_tr_b16 v[208:209], v58 offset:4096
    ds_read_b64_tr_b16 v[210:211], v58 offset:4608
    ds_read_b64_tr_b16 v[212:213], v59 offset:4096
    ds_read_b64_tr_b16 v[214:215], v59 offset:4608
    s_waitcnt vmcnt(31) lgkmcnt(8)
    v_mfma_f32_32x32x16_bf16 v[0:15], v[192:195], v[64:67], 0
    v_mfma_f32_32x32x16_bf16 v[16:31], v[196:199], v[64:67], 0
    ds_read_b64_tr_b16 v[192:193], v58 offset:6144
    ds_read_b64_tr_b16 v[194:195], v58 offset:6656
    ds_read_b64_tr_b16 v[196:197], v59 offset:6144
    ds_read_b64_tr_b16 v[198:199], v59 offset:6656
    s_waitcnt vmcnt(30) lgkmcnt(8)
    v_mfma_f32_32x32x16_bf16 v[0:15], v[200:203], v[68:71], v[0:15]
    v_mfma_f32_32x32x16_bf16 v[16:31], v[204:207], v[68:71], v[16:31]
    ds_read_b64_tr_b16 v[200:201], v58 offset:8192
    ds_read_b64_tr_b16 v[202:203], v58 offset:8704
    ds_read_b64_tr_b16 v[204:205], v59 offset:8192
    ds_read_b64_tr_b16 v[206:207], v59 offset:8704
    s_waitcnt vmcnt(29) lgkmcnt(8)
    v_mfma_f32_32x32x16_bf16 v[0:15], v[208:211], v[72:75], v[0:15]
    v_mfma_f32_32x32x16_bf16 v[16:31], v[212:215], v[72:75], v[16:31]
    ds_read_b64_tr_b16 v[208:209], v58 offset:10240
    ds_read_b64_tr_b16 v[210:211], v58 offset:10752
    ds_read_b64_tr_b16 v[212:213], v59 offset:10240
    ds_read_b64_tr_b16 v[214:215], v59 offset:10752
    s_waitcnt vmcnt(28) lgkmcnt(8)
    v_mfma_f32_32x32x16_bf16 v[0:15], v[192:195], v[76:79], v[0:15]
    v_mfma_f32_32x32x16_bf16 v[16:31], v[196:199], v[76:79], v[16:31]
    ds_read_b64_tr_b16 v[192:193], v58 offset:12288
    ds_read_b64_tr_b16 v[194:195], v58 offset:12800
    ds_read_b64_tr_b16 v[196:197], v59 offset:12288
    ds_read_b64_tr_b16 v[198:199], v59 offset:12800
    s_waitcnt vmcnt(27) lgkmcnt(8)
    v_mfma_f32_32x32x16_bf16 v[0:15], v[200:203], v[80:83], v[0:15]
    v_mfma_f32_32x32x16_bf16 v[16:31], v[204:207], v[80:83], v[16:31]
    ds_read_b64_tr_b16 v[200:201], v58 offset:14336
    ds_read_b64_tr_b16 v[202:203], v58 offset:14848
    ds_read_b64_tr_b16 v[204:205], v59 offset:14336
    ds_read_b64_tr_b16 v[206:207], v59 offset:14848
    s_waitcnt vmcnt(26) lgkmcnt(8)
    v_mfma_f32_32x32x16_bf16 v[0:15], v[208:211], v[84:87], v[0:15]
    v_mfma_f32_32x32x16_bf16 v[16:31], v[212:215], v[84:87], v[16:31]
    ds_read_b64_tr_b16 v[208:209], v58 offset:16384
    ds_read_b64_tr_b16 v[210:211], v58 offset:16896
    ds_read_b64_tr_b16 v[212:213], v59 offset:16384
    ds_read_b64_tr_b16 v[214:215], v59 offset:16896
    s_waitcnt vmcnt(25) lgkmcnt(8)
    v_mfma_f32_32x32x16_bf16 v[0:15], v[192:195], v[88:91], v[0:15]
    v_mfma_f32_32x32x16_bf16 v[16:31], v[196:199], v[88:91], v[16:31]
    ds_read_b64_tr_b16 v[192:193], v58 offset:18432
    ds_read_b64_tr_b16 v[194:195], v58 offset:18944
    ds_read_b64_tr_b16 v[196:197], v59 offset:18432
    ds_read_b64_tr_b16 v[198:199], v59 offset:18944
    s_waitcnt vmcnt(24) lgkmcnt(8)
    v_mfma_f32_32x32x16_bf16 v[0:15], v[200:203], v[92:95], v[0:15]
    v_mfma_f32_32x32x16_bf16 v[16:31], v[204:207], v[92:95], v[16:31]
    ds_read_b64_tr_b16 v[200:201], v58 offset:20480
    ds_read_b64_tr_b16 v[202:203], v58 offset:20992
    ds_read_b64_tr_b16 v[204:205], v59 offset:20480
    ds_read_b64_tr_b16 v[206:207], v59 offset:20992
    s_waitcnt vmcnt(23) lgkmcnt(8)
    v_mfma_f32_32x32x16_bf16 v[0:15], v[208:211], v[96:99], v[0:15]
    v_mfma_f32_32x32x16_bf16 v[16:31], v[212:215], v[96:99], v[16:31]
    ds_read_b64_tr_b16 v[208:209], v58 offset:22528
    ds_read_b64_tr_b16 v[210:211], v58 offset:23040
    ds_read_b64_tr_b16 v[212:213], v59 offset:22528
    ds_read_b64_tr_b16 v[214:215], v59 offset:23040
    s_waitcnt vmcnt(22) lgkmcnt(8)
    v_mfma_f32_32x32x16_bf16 v[0:15], v[192:195], v[100:103], v[0:15]
    v_mfma_f32_32x32x16_bf16 v[16:31], v[196:199], v[100:103], v[16:31]
    ds_read_b64_tr_b16 v[192:193], v58 offset:24576
    ds_read_b64_tr_b16 v[194:195], v58 offset:25088
    ds_read_b64_tr_b16 v[196:197], v59 offset:24576
    ds_read_b64_tr_b16 v[198:199], v59 offset:25088
    s_waitcnt vmcnt(21) lgkmcnt(8)
    v_mfma_f32_32x32x16_bf16 v[0:15], v[200:203], v[104:107], v[0:15]
    v_mfma_f32_32x32x16_bf16 v[16:31], v[204:207], v[104:107], v[16:31]
    ds_read_b64_tr_b16 v[200:201], v58 offset:26624
    ds_read_b64_tr_b16 v[202:203], v58 offset:27136
    ds_read_b64_tr_b16 v[204:205], v59 offset:26624
    ds_read_b64_tr_b16 v[206:207], v59 offset:27136
    s_waitcnt vmcnt(20) lgkmcnt(8)
    v_mfma_f32_32x32x16_bf16 v[0:15], v[208:211], v[108:111], v[0:15]
    v_mfma_f32_32x32x16_bf16 v[16:31], v[212:215], v[108:111], v[16:31]
    ds_read_b64_tr_b16 v[208:209], v58 offset:28672
    ds_read_b64_tr_b16 v[210:211], v58 offset:29184
    ds_read_b64_tr_b16 v[212:213], v59 offset:28672
    ds_read_b64_tr_b16 v[214:215], v59 offset:29184
    s_waitcnt vmcnt(19) lgkmcnt(8)
    v_mfma_f32_32x32x16_bf16 v[0:15], v[192:195], v[112:115], v[0:15]
    v_mfma_f32_32x32x16_bf16 v[16:31], v[196:199], v[112:115], v[16:31]
    ds_read_b64_tr_b16 v[192:193], v58 offset:30720
    ds_read_b64_tr_b16 v[194:195], v58 offset:31232
    ds_read_b64_tr_b16 v[196:197], v59 offset:30720
    ds_read_b64_tr_b16 v[198:199], v59 offset:31232
    s_waitcnt vmcnt(18) lgkmcnt(8)
    v_mfma_f32_32x32x16_bf16 v[0:15], v[200:203], v[116:119], v[0:15]
    v_mfma_f32_32x32x16_bf16 v[16:31], v[204:207], v[116:119], v[16:31]
    ds_read_b64_tr_b16 v[200:201], v58 offset:32768
    ds_read_b64_tr_b16 v[202:203], v58 offset:33280
    ds_read_b64_tr_b16 v[204:205], v59 offset:32768
    ds_read_b64_tr_b16 v[206:207], v59 offset:33280
    s_waitcnt vmcnt(17) lgkmcnt(8)
    v_mfma_f32_32x32x16_bf16 v[0:15], v[208:211], v[120:123], v[0:15]
    v_mfma_f32_32x32x16_bf16 v[16:31], v[212:215], v[120:123], v[16:31]
    ds_read_b64_tr_b16 v[208:209], v58 offset:34816
    ds_read_b64_tr_b16 v[210:211], v58 offset:35328
    ds_read_b64_tr_b16 v[212:213], v59 offset:34816
    ds_read_b64_tr_b16 v[214:215], v59 offset:35328
    s_waitcnt vmcnt(16) lgkmcnt(8)
    v_mfma_f32_32x32x16_bf16 v[0:15], v[192:195], v[124:127], v[0:15]
    v_mfma_f32_32x32x16_bf16 v[16:31], v[196:199], v[124:127], v[16:31]
    ds_read_b64_tr_b16 v[192:193], v58 offset:36864
    ds_read_b64_tr_b16 v[194:195], v58 offset:37376
    ds_read_b64_tr_b16 v[196:197], v59 offset:36864
    ds_read_b64_tr_b16 v[198:199], v59 offset:37376
    s_waitcnt vmcnt(15) lgkmcnt(8)
    v_mfma_f32_32x32x16_bf16 v[0:15], v[200:203], v[128:131], v[0:15]
    v_mfma_f32_32x32x16_bf16 v[16:31], v[204:207], v[128:131], v[16:31]
    ds_read_b64_tr_b16 v[200:201], v58 offset:38912
    ds_read_b64_tr_b16 v[202:203], v58 offset:39424
    ds_read_b64_tr_b16 v[204:205], v59 offset:38912
    ds_read_b64_tr_b16 v[206:207], v59 offset:39424
    s_waitcnt vmcnt(14) lgkmcnt(8)
    v_mfma_f32_32x32x16_bf16 v[0:15], v[208:211], v[132:135], v[0:15]
    v_mfma_f32_32x32x16_bf16 v[16:31], v[212:215], v[132:135], v[16:31]
    ds_read_b64_tr_b16 v[208:209], v58 offset:40960
    ds_read_b64_tr_b16 v[210:211], v58 offset:41472
    ds_read_b64_tr_b16 v[212:213], v59 offset:40960
    ds_read_b64_tr_b16 v[214:215], v59 offset:41472
    s_waitcnt vmcnt(13) lgkmcnt(8)
    v_mfma_f32_32x32x16_bf16 v[0:15], v[192:195], v[136:139], v[0:15]
    v_mfma_f32_32x32x16_bf16 v[16:31], v[196:199], v[136:139], v[16:31]
    ds_read_b64_tr_b16 v[192:193], v58 offset:43008
    ds_read_b64_tr_b16 v[194:195], v58 offset:43520
    ds_read_b64_tr_b16 v[196:197], v59 offset:43008
    ds_read_b64_tr_b16 v[198:199], v59 offset:43520
    s_waitcnt vmcnt(12) lgkmcnt(8)
    v_mfma_f32_32x32x16_bf16 v[0:15], v[200:203], v[140:143], v[0:15]
    v_mfma_f32_32x32x16_bf16 v[16:31], v[204:207], v[140:143], v[16:31]
    ds_read_b64_tr_b16 v[200:201], v58 offset:45056
    ds_read_b64_tr_b16 v[202:203], v58 offset:45568
    ds_read_b64_tr_b16 v[204:205], v59 offset:45056
    ds_read_b64_tr_b16 v[206:207], v59 offset:45568
    s_waitcnt vmcnt(11) lgkmcnt(8)
    v_mfma_f32_32x32x16_bf16 v[0:15], v[208:211], v[144:147], v[0:15]
    v_mfma_f32_32x32x16_bf16 v[16:31], v[212:215], v[144:147], v[16:31]
    ds_read_b64_tr_b16 v[208:209], v58 offset:47104
    ds_read_b64_tr_b16 v[210:211], v58 offset:47616
    ds_read_b64_tr_b16 v[212:213], v59 offset:47104
    ds_read_b64_tr_b16 v[214:215], v59 offset:47616
    s_waitcnt vmcnt(10) lgkmcnt(8)
    v_mfma_f32_32x32x16_bf16 v[0:15], v[192:195], v[148:151], v[0:15]
    v_mfma_f32_32x32x16_bf16 v[16:31], v[196:199], v[148:151], v[16:31]
    ds_read_b64_tr_b16 v[192:193], v58 offset:49152
    ds_read_b64_tr_b16 v[194:195], v58 offset:49664
    ds_read_b64_tr_b16 v[196:197], v59 offset:49152
    ds_read_b64_tr_b16 v[198:199], v59 offset:49664
    s_waitcnt vmcnt(9) lgkmcnt(8)
    v_mfma_f32_32x32x16_bf16 v[0:15], v[200:203], v[152:155], v[0:15]
    v_mfma_f32_32x32x16_bf16 v[16:31], v[204:207], v[152:155], v[16:31]
    ds_read_b64_tr_b16 v[200:201], v58 offset:51200
    ds_read_b64_tr_b16 v[202:203], v58 offset:51712
    ds_read_b64_tr_b16 v[204:205], v59 offset:51200
    ds_read_b64_tr_b16 v[206:207], v59 offset:51712
    s_waitcnt vmcnt(8) lgkmcnt(8)
    v_mfma_f32_32x32x16_bf16 v[0:15], v[208:211], v[156:159], v[0:15]
    v_mfma_f32_32x32x16_bf16 v[16:31], v[212:215], v[156:159], v[16:31]
    ds_read_b64_tr_b16 v[208:209], v58 offset:53248
    ds_read_b64_tr_b16 v[210:211], v58 offset:53760
    ds_read_b64_tr_b16 v[212:213], v59 offset:53248
    ds_read_b64_tr_b16 v[214:215], v59 offset:53760
    s_waitcnt vmcnt(7) lgkmcnt(8)
    v_mfma_f32_32x32x16_bf16 v[0:15], v[192:195], v[160:163], v[0:15]
    v_mfma_f32_32x32x16_bf16 v[16:31], v[196:199], v[160:163], v[16:31]
    ds_read_b64_tr_b16 v[192:193], v58 offset:55296
    ds_read_b64_tr_b16 v[194:195], v58 offset:55808
    ds_read_b64_tr_b16 v[196:197], v59 offset:55296
    ds_read_b64_tr_b16 v[198:199], v59 offset:55808
    s_waitcnt vmcnt(6) lgkmcnt(8)
    v_mfma_f32_32x32x16_bf16 v[0:15], v[200:203], v[164:167], v[0:15]
    v_mfma_f32_32x32x16_bf16 v[16:31], v[204:207], v[164:167], v[16:31]
    ds_read_b64_tr_b16 v[200:201], v58 offset:57344
    ds_read_b64_tr_b16 v[202:203], v58 offset:57856
    ds_read_b64_tr_b16 v[204:205], v59 offset:57344
    ds_read_b64_tr_b16 v[206:207], v59 offset:57856
    s_waitcnt vmcnt(5) lgkmcnt(8)
    v_mfma_f32_32x32x16_bf16 v[0:15], v[208:211], v[168:171], v[0:15]
    v_mfma_f32_32x32x16_bf16 v[16:31], v[212:215], v[168:171], v[16:31]
    ds_read_b64_tr_b16 v[208:209], v58 offset:59392
    ds_read_b64_tr_b16 v[210:211], v58 offset:59904
    ds_read_b64_tr_b16 v[212:213], v59 offset:59392
    ds_read_b64_tr_b16 v[214:215], v59 offset:59904
    s_waitcnt vmcnt(4) lgkmcnt(8)
    v_mfma_f32_32x32x16_bf16 v[0:15], v[192:195], v[172:175], v[0:15]
    v_mfma_f32_32x32x16_bf16 v[16:31], v[196:199], v[172:175], v[16:31]
    ds_read_b64_tr_b16 v[192:193], v58 offset:61440
    ds_read_b64_tr_b16 v[194:195], v58 offset:61952
    ds_read_b64_tr_b16 v[196:197], v59 offset:61440
    ds_read_b64_tr_b16 v[198:199], v59 offset:61952
    s_waitcnt vmcnt(3) lgkmcnt(8)
    v_mfma_f32_32x32x16_bf16 v[0:15], v[200:203], v[176:179], v[0:15]
    v_mfma_f32_32x32x16_bf16 v[16:31], v[204:207], v[176:179], v[16:31]
    ds_read_b64_tr_b16 v[200:201], v58 offset:63488
    ds_read_b64_tr_b16 v[202:203], v58 offset:64000
    ds_read_b64_tr_b16 v[204:205], v59 offset:63488
    ds_read_b64_tr_b16 v[206:207], v59 offset:64000
    s_waitcnt vmcnt(2) lgkmcnt(8)
    v_mfma_f32_32x32x16_bf16 v[0:15], v[208:211], v[180:183], v[0:15]
    v_mfma_f32_32x32x16_bf16 v[16:31], v[212:215], v[180:183], v[16:31]
    s_waitcnt vmcnt(1) lgkmcnt(4)
    v_mfma_f32_32x32x16_bf16 v[0:15], v[192:195], v[184:187], v[0:15]
    v_mfma_f32_32x32x16_bf16 v[16:31], v[196:199], v[184:187], v[16:31]
    s_waitcnt vmcnt(0) lgkmcnt(0)
    v_mfma_f32_32x32x16_bf16 v[0:15], v[200:203], v[188:191], v[0:15]
    v_mfma_f32_32x32x16_bf16 v[16:31], v[204:207], v[188:191], v[16:31]
    s_lshl_b32 s34, s3, 12
    s_add_u32 s34, s34, 131072
    v_add_u32 v63, s34, v62
    s_nop 8
    ds_write_b128 v63, v[16:19] offset:0
    ds_write_b128 v63, v[20:23] offset:1024
    ds_write_b128 v63, v[24:27] offset:2048
    ds_write_b128 v63, v[28:31] offset:3072
    v_xor_b32 v63, 16384, v63
    v_lshlrev_b32 v64, 16, v40
    v_and_b32 v65, 0xffff0000, v40
    v_lshlrev_b32 v80, 16, v48
    v_and_b32 v81, 0xffff0000, v48
    v_lshlrev_b32 v66, 16, v41
    v_and_b32 v67, 0xffff0000, v41
    v_lshlrev_b32 v82, 16, v49
    v_and_b32 v83, 0xffff0000, v49
    v_lshlrev_b32 v68, 16, v42
    v_and_b32 v69, 0xffff0000, v42
    v_lshlrev_b32 v84, 16, v50
    v_and_b32 v85, 0xffff0000, v50
    v_lshlrev_b32 v70, 16, v43
    v_and_b32 v71, 0xffff0000, v43
    v_lshlrev_b32 v86, 16, v51
    v_and_b32 v87, 0xffff0000, v51
    v_lshlrev_b32 v72, 16, v44
    v_and_b32 v73, 0xffff0000, v44
    v_lshlrev_b32 v88, 16, v52
    v_and_b32 v89, 0xffff0000, v52
    v_lshlrev_b32 v74, 16, v45
    v_and_b32 v75, 0xffff0000, v45
    v_lshlrev_b32 v90, 16, v53
    v_and_b32 v91, 0xffff0000, v53
    v_lshlrev_b32 v76, 16, v46
    v_and_b32 v77, 0xffff0000, v46
    v_lshlrev_b32 v92, 16, v54
    v_and_b32 v93, 0xffff0000, v54
    v_lshlrev_b32 v78, 16, v47
    v_and_b32 v79, 0xffff0000, v47
    v_lshlrev_b32 v94, 16, v55
    v_and_b32 v95, 0xffff0000, v55
    v_add_f32 v0, v0, v64
    v_add_f32 v1, v1, v65
    v_add_f32 v2, v2, v66
    v_add_f32 v3, v3, v67
    v_add_f32 v4, v4, v68
    v_add_f32 v5, v5, v69
    v_add_f32 v6, v6, v70
    v_add_f32 v7, v7, v71
    v_add_f32 v8, v8, v72
    v_add_f32 v9, v9, v73
    v_add_f32 v10, v10, v74
    v_add_f32 v11, v11, v75
    v_add_f32 v12, v12, v76
    v_add_f32 v13, v13, v77
    v_add_f32 v14, v14, v78
    v_add_f32 v15, v15, v79
    s_waitcnt lgkmcnt(0)
    s_barrier
    ds_read_b128 v[16:19], v63 offset:0
    ds_read_b128 v[20:23], v63 offset:1024
    ds_read_b128 v[24:27], v63 offset:2048
    ds_read_b128 v[28:31], v63 offset:3072
    s_waitcnt lgkmcnt(0)
    v_add_f32 v0, v0, v16
    v_add_f32 v1, v1, v17
    v_add_f32 v2, v2, v18
    v_add_f32 v3, v3, v19
    v_add_f32 v4, v4, v20
    v_add_f32 v5, v5, v21
    v_add_f32 v6, v6, v22
    v_add_f32 v7, v7, v23
    v_add_f32 v8, v8, v24
    v_add_f32 v9, v9, v25
    v_add_f32 v10, v10, v26
    v_add_f32 v11, v11, v27
    v_add_f32 v12, v12, v28
    v_add_f32 v13, v13, v29
    v_add_f32 v14, v14, v30
    v_add_f32 v15, v15, v31
    v_cvt_pk_bf16_f32 v32, v0, v1
    v_cvt_pk_bf16_f32 v33, v2, v3
    v_cvt_pk_bf16_f32 v34, v4, v5
    v_cvt_pk_bf16_f32 v35, v6, v7
    v_cvt_pk_bf16_f32 v36, v8, v9
    v_cvt_pk_bf16_f32 v37, v10, v11
    v_cvt_pk_bf16_f32 v38, v12, v13
    v_cvt_pk_bf16_f32 v39, v14, v15
    s_add_u32 s34, s35, 0x1000000
    buffer_store_dwordx4 v[32:35], v62, s[20:23], s34 offen
    buffer_store_dwordx4 v[36:39], v62, s[20:23], s34 offen offset:1024
    v_add_f32 v40, v0, v1
    v_mul_f32 v41, v0, v0
    v_mul_f32 v42, v0, v80
    v_fmac_f32 v41, v1, v1
    v_fmac_f32 v42, v1, v81
    v_add_f32 v40, v40, v2
    v_fmac_f32 v41, v2, v2
    v_fmac_f32 v42, v2, v82
    v_add_f32 v40, v40, v3
    v_fmac_f32 v41, v3, v3
    v_fmac_f32 v42, v3, v83
    v_add_f32 v40, v40, v4
    v_fmac_f32 v41, v4, v4
    v_fmac_f32 v42, v4, v84
    v_add_f32 v40, v40, v5
    v_fmac_f32 v41, v5, v5
    v_fmac_f32 v42, v5, v85
    v_add_f32 v40, v40, v6
    v_fmac_f32 v41, v6, v6
    v_fmac_f32 v42, v6, v86
    v_add_f32 v40, v40, v7
    v_fmac_f32 v41, v7, v7
    v_fmac_f32 v42, v7, v87
    v_add_f32 v40, v40, v8
    v_fmac_f32 v41, v8, v8
    v_fmac_f32 v42, v8, v88
    v_add_f32 v40, v40, v9
    v_fmac_f32 v41, v9, v9
    v_fmac_f32 v42, v9, v89
    v_add_f32 v40, v40, v10
    v_fmac_f32 v41, v10, v10
    v_fmac_f32 v42, v10, v90
    v_add_f32 v40, v40, v11
    v_fmac_f32 v41, v11, v11
    v_fmac_f32 v42, v11, v91
    v_add_f32 v40, v40, v12
    v_fmac_f32 v41, v12, v12
    v_fmac_f32 v42, v12, v92
    v_add_f32 v40, v40, v13
    v_fmac_f32 v41, v13, v13
    v_fmac_f32 v42, v13, v93
    v_add_f32 v40, v40, v14
    v_fmac_f32 v41, v14, v14
    v_fmac_f32 v42, v14, v94
    v_add_f32 v40, v40, v15
    v_fmac_f32 v41, v15, v15
    v_fmac_f32 v42, v15, v95
    v_mov_b32 v43, v42
    v_permlane32_swap_b32 v40, v41
    s_nop 0
    v_permlane32_swap_b32 v42, v43
    v_add_f32 v40, v40, v41
    v_add_f32 v42, v42, v43
    v_lshlrev_b32 v44, 2, v60
    v_lshl_add_u32 v45, v61, 13, v44
    s_lshl_b32 s34, s32, 7
    s_add_u32 s34, s34, 0x1400000
    buffer_atomic_add_f32 v40, v45, s[20:23], s34 offen sc1
    s_add_u32 s34, s34, 16384
    s_mov_b64 exec, 0xffffffff
    buffer_atomic_add_f32 v42, v44, s[20:23], s34 offen sc1
wo0_kernel_end:
    s_endpgm
.globl ffn0_kernel
.p2align 8
.type ffn0_kernel,@function
ffn0_kernel:
    s_cmp_ge_u32 s2, 256
    s_cbranch_scc1 ffn0_kernel_end
    s_load_dwordx4 s[4:7], s[0:1], 32
    s_load_dwordx4 s[8:11], s[0:1], 48
    s_load_dwordx2 s[44:45], s[0:1], 64
    s_load_dwordx2 s[46:47], s[0:1], 80
    v_lshrrev_b32 v1, 6, v0
    v_and_b32 v2, 63, v0
    v_readfirstlane_b32 s3, v1
    s_and_b32 s24, s2, 7
    s_lshr_b32 s25, s2, 3
    s_mul_i32 s26, s24, 28
    s_add_u32 s26, s26, s25
    s_waitcnt lgkmcnt(0)
    s_mov_b32 s12, s4
    s_mov_b32 s13, s5
    s_mov_b32 s14, 0x800
    s_mov_b32 s15, 0x20000
    s_mov_b32 s20, s46
    s_mov_b32 s21, s47
    s_mov_b32 s22, 0x8000000
    s_mov_b32 s23, 0x20000
    s_mov_b32 s28, s10
    s_mov_b32 s29, s11
    s_mov_b32 s30, 0x700000
    s_mov_b32 s31, 0x20000
    s_cmp_lt_u32 s3, 4
    s_cselect_b32 s16, s6, s8
    s_cselect_b32 s17, s7, s9
    s_mov_b32 s18, 7340032
    s_mov_b32 s19, 0x20000
    v_lshlrev_b32 v3, 4, v0
    s_mov_b32 s27, 0x1400000
    buffer_load_dwordx4 v[8:11], v3, s[20:23], s27 offen
    s_add_u32 s27, s27, 8192
    buffer_load_dwordx4 v[12:15], v3, s[20:23], s27 offen
    s_add_u32 s27, s27, 8192
    buffer_load_dwordx4 v[16:19], v3, s[20:23], s27 offen
    v_lshlrev_b32 v4, 5, v2
    buffer_load_dwordx4 v[20:23], v4, s[12:15], 0 offen
    buffer_load_dwordx4 v[24:27], v4, s[12:15], 0 offen offset:16
    s_cmp_lt_u32 s25, 28
    s_cselect_b32 s33, 0, 0x10000000
    v_lshrrev_b32 v5, 1, v2
    v_mul_u32_u24 v5, 7168, v5
    v_and_b32 v6, 1, v2
    v_lshl_add_u32 v5, v6, 4, v5
    v_add_u32 v5, s33, v5
    s_and_b32 s34, s3, 3
    s_mul_i32 s34, s34, 1835008
    s_lshl_b32 s35, s26, 5
    s_add_u32 s34, s34, s35
    buffer_load_dwordx4 v[32:35], v5, s[16:19], s34 offen
    s_add_u32 s34, s34, 229376
    buffer_load_dwordx4 v[36:39], v5, s[16:19], s34 offen
    s_add_u32 s34, s34, 229376
    buffer_load_dwordx4 v[40:43], v5, s[16:19], s34 offen
    s_add_u32 s34, s34, 229376
    buffer_load_dwordx4 v[44:47], v5, s[16:19], s34 offen
    s_add_u32 s34, s34, 229376
    buffer_load_dwordx4 v[48:51], v5, s[16:19], s34 offen
    s_add_u32 s34, s34, 229376
    buffer_load_dwordx4 v[52:55], v5, s[16:19], s34 offen
    s_add_u32 s34, s34, 229376
    buffer_load_dwordx4 v[56:59], v5, s[16:19], s34 offen
    s_add_u32 s34, s34, 229376
    buffer_load_dwordx4 v[60:63], v5, s[16:19], s34 offen
    v_lshrrev_b32 v6, 4, v2
    v_lshlrev_b32 v6, 11, v6
    v_and_b32 v7, 15, v2
    v_lshl_add_u32 v6, v7, 4, v6
    v_add_u32 v6, s33, v6
    s_lshl_b32 s34, s26, 15
    s_lshl_b32 s35, s3, 8
    s_add_u32 s34, s34, s35
    buffer_load_dwordx4 v[64:67], v6, s[28:31], s34 offen
    s_add_u32 s34, s34, 8192
    buffer_load_dwordx4 v[68:71], v6, s[28:31], s34 offen
    s_add_u32 s34, s34, 8192
    buffer_load_dwordx4 v[72:75], v6, s[28:31], s34 offen
    s_add_u32 s34, s34, 8192
    buffer_load_dwordx4 v[76:79], v6, s[28:31], s34 offen
    s_waitcnt vmcnt(12)
    v_mov_b32 v28, 0
    v_lshlrev_b32 v29, 16, v20
    v_and_b32 v30, 0xffff0000, v20
    v_add_f32 v28, v28, v29
    v_add_f32 v28, v28, v30
    v_lshlrev_b32 v29, 16, v21
    v_and_b32 v30, 0xffff0000, v21
    v_add_f32 v28, v28, v29
    v_add_f32 v28, v28, v30
    v_lshlrev_b32 v29, 16, v22
    v_and_b32 v30, 0xffff0000, v22
    v_add_f32 v28, v28, v29
    v_add_f32 v28, v28, v30
    v_lshlrev_b32 v29, 16, v23
    v_and_b32 v30, 0xffff0000, v23
    v_add_f32 v28, v28, v29
    v_add_f32 v28, v28, v30
    v_lshlrev_b32 v29, 16, v24
    v_and_b32 v30, 0xffff0000, v24
    v_add_f32 v28, v28, v29
    v_add_f32 v28, v28, v30
    v_lshlrev_b32 v29, 16, v25
    v_and_b32 v30, 0xffff0000, v25
    v_add_f32 v28, v28, v29
    v_add_f32 v28, v28, v30
    v_lshlrev_b32 v29, 16, v26
    v_and_b32 v30, 0xffff0000, v26
    v_add_f32 v28, v28, v29
    v_add_f32 v28, v28, v30
    v_lshlrev_b32 v29, 16, v27
    v_and_b32 v30, 0xffff0000, v27
    v_add_f32 v28, v28, v29
    v_add_f32 v28, v28, v30
    s_nop 1
    v_add_f32_dpp v28, v28, v28 quad_perm:[1,0,3,2] row_mask:0xf bank_mask:0xf
    s_nop 1
    v_add_f32_dpp v28, v28, v28 quad_perm:[2,3,0,1] row_mask:0xf bank_mask:0xf
    s_nop 1
    v_add_f32_dpp v28, v28, v28 row_half_mirror row_mask:0xf bank_mask:0xf
    s_nop 1
    v_add_f32_dpp v28, v28, v28 row_mirror row_mask:0xf bank_mask:0xf
    v_mov_b32 v29, v28
    s_nop 1
    v_permlane16_swap_b32 v28, v29
    v_add_f32 v28, v28, v29
    v_mov_b32 v29, v28
    s_nop 1
    v_permlane32_swap_b32 v28, v29
    v_add_f32 v28, v28, v29
    v_mul_f32 v8, 0x3a800000, v8
    v_mul_f32 v20, 0x3a800000, v12
    v_fma_f32 v20, -v8, v8, v20
    v_max_f32 v20, 0, v20
    v_add_f32 v12, 0x3727c5ac, v20
    v_rsq_f32 v12, v12
    v_fma_f32 v16, -v8, v28, v16
    v_mul_f32 v16, v16, v12
    v_mul_f32 v9, 0x3a800000, v9
    v_mul_f32 v21, 0x3a800000, v13
    v_fma_f32 v21, -v9, v9, v21
    v_max_f32 v21, 0, v21
    v_add_f32 v13, 0x3727c5ac, v21
    v_rsq_f32 v13, v13
    v_fma_f32 v17, -v9, v28, v17
    v_mul_f32 v17, v17, v13
    v_mul_f32 v10, 0x3a800000, v10
    v_mul_f32 v22, 0x3a800000, v14
    v_fma_f32 v22, -v10, v10, v22
    v_max_f32 v22, 0, v22
    v_add_f32 v14, 0x3727c5ac, v22
    v_rsq_f32 v14, v14
    v_fma_f32 v18, -v10, v28, v18
    v_mul_f32 v18, v18, v14
    v_mul_f32 v11, 0x3a800000, v11
    v_mul_f32 v23, 0x3a800000, v15
    v_fma_f32 v23, -v11, v11, v23
    v_max_f32 v23, 0, v23
    v_add_f32 v15, 0x3727c5ac, v23
    v_rsq_f32 v15, v15
    v_fma_f32 v19, -v11, v28, v19
    v_mul_f32 v19, v19, v15
    ds_write_b128 v3, v[8:11]
    ds_write_b128 v3, v[12:15] offset:8192
    ds_write_b128 v3, v[16:19] offset:16384
    v_add_f32 v84, 1.0, v12
    v_mul_f32 v88, v8, v12
    v_sub_f32 v88, 0, v88
    v_mul_f32 v80, v84, v84
    v_mul_f32 v80, v80, v20
    v_add_f32 v80, 0x3727c5ac, v80
    v_rsq_f32 v80, v80
    s_nop 0
    v_mul_f32 v80, v80, v84
    v_add_f32 v85, 1.0, v13
    v_mul_f32 v89, v9, v13
    v_sub_f32 v89, 0, v89
    v_mul_f32 v81, v85, v85
    v_mul_f32 v81, v81, v21
    v_add_f32 v81, 0x3727c5ac, v81
    v_rsq_f32 v81, v81
    s_nop 0
    v_mul_f32 v81, v81, v85
    v_add_f32 v86, 1.0, v14
    v_mul_f32 v90, v10, v14
    v_sub_f32 v90, 0, v90
    v_mul_f32 v82, v86, v86
    v_mul_f32 v82, v82, v22
    v_add_f32 v82, 0x3727c5ac, v82
    v_rsq_f32 v82, v82
    s_nop 0
    v_mul_f32 v82, v82, v86
    v_add_f32 v87, 1.0, v15
    v_mul_f32 v91, v11, v15
    v_sub_f32 v91, 0, v91
    v_mul_f32 v83, v87, v87
    v_mul_f32 v83, v83, v23
    v_add_f32 v83, 0x3727c5ac, v83
    v_rsq_f32 v83, v83
    s_nop 0
    v_mul_f32 v83, v83, v87
    v_lshrrev_b32 v29, 1, v0
    v_cmp_eq_u32 vcc, s2, v29
    s_and_saveexec_b64 s[36:37], vcc
    s_mov_b32 s27, 0x3440000
    buffer_store_dwordx4 v[80:83], v3, s[20:23], s27 offen
    s_add_u32 s27, s27, 8192
    buffer_store_dwordx4 v[8:11], v3, s[20:23], s27 offen
    s_add_u32 s27, s27, 8192
    buffer_store_dwordx4 v[84:87], v3, s[20:23], s27 offen
    s_add_u32 s27, s27, 8192
    buffer_store_dwordx4 v[88:91], v3, s[20:23], s27 offen
    s_mov_b64 exec, s[36:37]
    v_max3_f32 v29, v16, v17, v18
    v_max_f32 v29, v29, v19
    s_nop 1
    v_max_f32_dpp v29, v29, v29 quad_perm:[1,0,3,2] row_mask:0xf bank_mask:0xf
    s_nop 1
    v_max_f32_dpp v29, v29, v29 quad_perm:[2,3,0,1] row_mask:0xf bank_mask:0xf
    s_nop 1
    v_max_f32_dpp v29, v29, v29 row_half_mirror row_mask:0xf bank_mask:0xf
    s_nop 1
    v_max_f32_dpp v29, v29, v29 row_mirror row_mask:0xf bank_mask:0xf
    v_mov_b32 v30, v29
    s_nop 1
    v_permlane16_swap_b32 v29, v30
    v_max_f32 v29, v29, v30
    v_mov_b32 v30, v29
    s_nop 1
    v_permlane32_swap_b32 v29, v30
    v_max_f32 v29, v29, v30
    v_lshlrev_b32 v30, 2, v1
    ds_write_b32 v30, v29 offset:24576
    v_mov_b32 v31, 0x7fffffff
    v_mov_b32 v30, 0
    ds_write_b32 v30, v31 offset:24640
    s_waitcnt lgkmcnt(0)
    s_barrier
    ds_read_b128 v[92:95], v30 offset:24576
    ds_read_b128 v[96:99], v30 offset:24592
    s_waitcnt lgkmcnt(0)
    v_max3_f32 v29, v92, v93, v94
    v_max3_f32 v29, v29, v95, v96
    v_max3_f32 v29, v29, v97, v98
    v_max_f32 v29, v29, v99
    v_lshlrev_b32 v92, 2, v0
    v_cmp_eq_f32 vcc, v29, v19
    v_add_u32 v93, 3, v92
    s_nop 0
    v_cndmask_b32 v31, v31, v93, vcc
    v_cmp_eq_f32 vcc, v29, v18
    v_add_u32 v93, 2, v92
    s_nop 0
    v_cndmask_b32 v31, v31, v93, vcc
    v_cmp_eq_f32 vcc, v29, v17
    v_add_u32 v93, 1, v92
    s_nop 0
    v_cndmask_b32 v31, v31, v93, vcc
    v_cmp_eq_f32 vcc, v29, v16
    v_add_u32 v93, 0, v92
    s_nop 0
    v_cndmask_b32 v31, v31, v93, vcc
    v_cmp_gt_u32 vcc, 0x7fffffff, v31
    s_and_saveexec_b64 s[36:37], vcc
    ds_min_u32 v30, v31 offset:24640
    s_mov_b64 exec, s[36:37]
    s_waitcnt lgkmcnt(0)
    s_barrier
    ds_read_b32 v31, v30 offset:24640
    s_waitcnt lgkmcnt(0)
    v_and_b32 v31, 2047, v31
    v_lshlrev_b32 v92, 2, v31
    ds_read_b32 v93, v92
    ds_read_b32 v94, v92 offset:8192
    v_lshrrev_b32 v95, 7, v31
    v_lshlrev_b32 v95, 18, v95
    v_bfe_u32 v96, v31, 5, 2
    v_lshl_add_u32 v95, v96, 12, v95
    v_and_b32 v96, 31, v31
    v_lshl_add_u32 v95, v96, 4, v95
    v_bfe_u32 v96, v0, 3, 4
    v_lshl_add_u32 v95, v96, 14, v95
    v_and_b32 v96, 7, v0
    v_lshl_add_u32 v95, v96, 9, v95
    s_mov_b32 s27, 0x1000000
    buffer_load_dwordx4 v[108:111], v95, s[20:23], s27 offen
    s_waitcnt lgkmcnt(0)
    v_mov_b32 v112, v31
    v_mov_b32 v113, v29
    v_mov_b32 v114, v93
    v_mov_b32 v115, v94
    v_or_b32 v96, s2, v0
    v_cmp_eq_u32 vcc, 0, v96
    s_and_saveexec_b64 s[36:37], vcc
    s_mov_b32 s27, 0x1450000
    buffer_store_dwordx4 v[112:115], v30, s[20:23], s27 offen
    s_mov_b64 exec, s[36:37]
    s_waitcnt vmcnt(1)
    v_lshlrev_b32 v120, 16, v108
    v_and_b32 v121, 0xffff0000, v108
    v_lshlrev_b32 v122, 16, v109
    v_and_b32 v123, 0xffff0000, v109
    v_lshlrev_b32 v124, 16, v110
    v_and_b32 v125, 0xffff0000, v110
    v_lshlrev_b32 v126, 16, v111
    v_and_b32 v127, 0xffff0000, v111
    v_sub_f32 v120, v120, v93
    v_mul_f32 v120, v120, v94
    v_sub_f32 v121, v121, v93
    v_mul_f32 v121, v121, v94
    v_sub_f32 v122, v122, v93
    v_mul_f32 v122, v122, v94
    v_sub_f32 v123, v123, v93
    v_mul_f32 v123, v123, v94
    v_sub_f32 v124, v124, v93
    v_mul_f32 v124, v124, v94
    v_sub_f32 v125, v125, v93
    v_mul_f32 v125, v125, v94
    v_sub_f32 v126, v126, v93
    v_mul_f32 v126, v126, v94
    v_sub_f32 v127, v127, v93
    v_mul_f32 v127, v127, v94
    v_lshrrev_b32 v96, 1, v0
    v_lshlrev_b32 v96, 6, v96
    v_and_b32 v97, 1, v0
    v_lshl_add_u32 v96, v97, 4, v96
    v_cmp_gt_u32 vcc, 128, v0
    s_and_saveexec_b64 s[36:37], vcc
    ds_write_b128 v96, v[120:123] offset:32768
    ds_write_b128 v96, v[124:127] offset:32800
    s_mov_b64 exec, s[36:37]
    s_waitcnt lgkmcnt(0)
    s_barrier
    s_and_b32 s34, s3, 3
    s_lshl_b32 s34, s34, 10
    v_lshrrev_b32 v96, 1, v2
    v_lshl_add_u32 v96, v96, 2, s34
    ds_read_b32 v108, v96 offset:32768
    ds_read_b32 v109, v96 offset:32896
    ds_read_b32 v110, v96 offset:33024
    ds_read_b32 v111, v96 offset:33152
    ds_read_b32 v112, v96 offset:33280
    ds_read_b32 v113, v96 offset:33408
    ds_read_b32 v114, v96 offset:33536
    ds_read_b32 v115, v96 offset:33664
    s_waitcnt lgkmcnt(0)
    v_lshlrev_b32 v116, 16, v32
    v_and_b32 v117, 0xffff0000, v32
    v_mul_f32 v120, v116, v108
    v_mul_f32 v121, v117, v108
    v_lshlrev_b32 v116, 16, v33
    v_and_b32 v117, 0xffff0000, v33
    v_mul_f32 v122, v116, v108
    v_mul_f32 v123, v117, v108
    v_lshlrev_b32 v116, 16, v34
    v_and_b32 v117, 0xffff0000, v34
    v_mul_f32 v124, v116, v108
    v_mul_f32 v125, v117, v108
    v_lshlrev_b32 v116, 16, v35
    v_and_b32 v117, 0xffff0000, v35
    v_mul_f32 v126, v116, v108
    v_mul_f32 v127, v117, v108
    v_lshlrev_b32 v116, 16, v36
    v_and_b32 v117, 0xffff0000, v36
    v_fmac_f32 v120, v116, v109
    v_fmac_f32 v121, v117, v109
    v_lshlrev_b32 v116, 16, v37
    v_and_b32 v117, 0xffff0000, v37
    v_fmac_f32 v122, v116, v109
    v_fmac_f32 v123, v117, v109
    v_lshlrev_b32 v116, 16, v38
    v_and_b32 v117, 0xffff0000, v38
    v_fmac_f32 v124, v116, v109
    v_fmac_f32 v125, v117, v109
    v_lshlrev_b32 v116, 16, v39
    v_and_b32 v117, 0xffff0000, v39
    v_fmac_f32 v126, v116, v109
    v_fmac_f32 v127, v117, v109
    v_lshlrev_b32 v116, 16, v40
    v_and_b32 v117, 0xffff0000, v40
    v_fmac_f32 v120, v116, v110
    v_fmac_f32 v121, v117, v110
    v_lshlrev_b32 v116, 16, v41
    v_and_b32 v117, 0xffff0000, v41
    v_fmac_f32 v122, v116, v110
    v_fmac_f32 v123, v117, v110
    v_lshlrev_b32 v116, 16, v42
    v_and_b32 v117, 0xffff0000, v42
    v_fmac_f32 v124, v116, v110
    v_fmac_f32 v125, v117, v110
    v_lshlrev_b32 v116, 16, v43
    v_and_b32 v117, 0xffff0000, v43
    v_fmac_f32 v126, v116, v110
    v_fmac_f32 v127, v117, v110
    v_lshlrev_b32 v116, 16, v44
    v_and_b32 v117, 0xffff0000, v44
    v_fmac_f32 v120, v116, v111
    v_fmac_f32 v121, v117, v111
    v_lshlrev_b32 v116, 16, v45
    v_and_b32 v117, 0xffff0000, v45
    v_fmac_f32 v122, v116, v111
    v_fmac_f32 v123, v117, v111
    v_lshlrev_b32 v116, 16, v46
    v_and_b32 v117, 0xffff0000, v46
    v_fmac_f32 v124, v116, v111
    v_fmac_f32 v125, v117, v111
    v_lshlrev_b32 v116, 16, v47
    v_and_b32 v117, 0xffff0000, v47
    v_fmac_f32 v126, v116, v111
    v_fmac_f32 v127, v117, v111
    v_lshlrev_b32 v116, 16, v48
    v_and_b32 v117, 0xffff0000, v48
    v_fmac_f32 v120, v116, v112
    v_fmac_f32 v121, v117, v112
    v_lshlrev_b32 v116, 16, v49
    v_and_b32 v117, 0xffff0000, v49
    v_fmac_f32 v122, v116, v112
    v_fmac_f32 v123, v117, v112
    v_lshlrev_b32 v116, 16, v50
    v_and_b32 v117, 0xffff0000, v50
    v_fmac_f32 v124, v116, v112
    v_fmac_f32 v125, v117, v112
    v_lshlrev_b32 v116, 16, v51
    v_and_b32 v117, 0xffff0000, v51
    v_fmac_f32 v126, v116, v112
    v_fmac_f32 v127, v117, v112
    v_lshlrev_b32 v116, 16, v52
    v_and_b32 v117, 0xffff0000, v52
    v_fmac_f32 v120, v116, v113
    v_fmac_f32 v121, v117, v113
    v_lshlrev_b32 v116, 16, v53
    v_and_b32 v117, 0xffff0000, v53
    v_fmac_f32 v122, v116, v113
    v_fmac_f32 v123, v117, v113
    v_lshlrev_b32 v116, 16, v54
    v_and_b32 v117, 0xffff0000, v54
    v_fmac_f32 v124, v116, v113
    v_fmac_f32 v125, v117, v113
    v_lshlrev_b32 v116, 16, v55
    v_and_b32 v117, 0xffff0000, v55
    v_fmac_f32 v126, v116, v113
    v_fmac_f32 v127, v117, v113
    v_lshlrev_b32 v116, 16, v56
    v_and_b32 v117, 0xffff0000, v56
    v_fmac_f32 v120, v116, v114
    v_fmac_f32 v121, v117, v114
    v_lshlrev_b32 v116, 16, v57
    v_and_b32 v117, 0xffff0000, v57
    v_fmac_f32 v122, v116, v114
    v_fmac_f32 v123, v117, v114
    v_lshlrev_b32 v116, 16, v58
    v_and_b32 v117, 0xffff0000, v58
    v_fmac_f32 v124, v116, v114
    v_fmac_f32 v125, v117, v114
    v_lshlrev_b32 v116, 16, v59
    v_and_b32 v117, 0xffff0000, v59
    v_fmac_f32 v126, v116, v114
    v_fmac_f32 v127, v117, v114
    v_lshlrev_b32 v116, 16, v60
    v_and_b32 v117, 0xffff0000, v60
    v_fmac_f32 v120, v116, v115
    v_fmac_f32 v121, v117, v115
    v_lshlrev_b32 v116, 16, v61
    v_and_b32 v117, 0xffff0000, v61
    v_fmac_f32 v122, v116, v115
    v_fmac_f32 v123, v117, v115
    v_lshlrev_b32 v116, 16, v62
    v_and_b32 v117, 0xffff0000, v62
    v_fmac_f32 v124, v116, v115
    v_fmac_f32 v125, v117, v115
    v_lshlrev_b32 v116, 16, v63
    v_and_b32 v117, 0xffff0000, v63
    v_fmac_f32 v126, v116, v115
    v_fmac_f32 v127, v117, v115
    v_permlane32_swap_b32 v120, v124
    v_permlane32_swap_b32 v121, v125
    v_permlane32_swap_b32 v122, v126
    v_permlane32_swap_b32 v123, v127
    v_add_f32 v120, v120, v124
    v_add_f32 v121, v121, v125
    v_add_f32 v122, v122, v126
    v_add_f32 v123, v123, v127
    s_nop 0
    v_permlane16_swap_b32 v120, v122
    v_permlane16_swap_b32 v121, v123
    v_add_f32 v120, v120, v122
    v_add_f32 v121, v121, v123
    s_nop 0
    v_add_f32_dpp v120, v120, v120 quad_perm:[2,3,0,1] row_mask:0xf bank_mask:0xf
    v_add_f32_dpp v121, v121, v121 quad_perm:[2,3,0,1] row_mask:0xf bank_mask:0xf
    s_nop 0
    v_add_f32_dpp v120, v120, v120 row_ror:4 row_mask:0xf bank_mask:0xf
    v_add_f32_dpp v121, v121, v121 row_ror:4 row_mask:0xf bank_mask:0xf
    s_nop 0
    v_add_f32_dpp v120, v120, v120 row_ror:8 row_mask:0xf bank_mask:0xf
    v_add_f32_dpp v121, v121, v121 row_ror:8 row_mask:0xf bank_mask:0xf
    v_and_b32 v96, 1, v2
    v_lshrrev_b32 v97, 4, v2
    v_lshlrev_b32 v97, 3, v97
    v_lshl_add_u32 v96, v96, 5, v97
    s_lshl_b32 s34, s3, 6
    v_add_u32 v96, s34, v96
    ds_write_b64 v96, v[120:121] offset:40960
    s_waitcnt lgkmcnt(0)
    s_barrier
    v_and_b32 v96, 15, v2
    v_lshlrev_b32 v96, 2, v96
    ds_read_b32 v108, v96 offset:40960
    ds_read_b32 v109, v96 offset:41024
    ds_read_b32 v110, v96 offset:41088
    ds_read_b32 v111, v96 offset:41152
    ds_read_b32 v112, v96 offset:41216
    ds_read_b32 v113, v96 offset:41280
    ds_read_b32 v114, v96 offset:41344
    ds_read_b32 v115, v96 offset:41408
    s_waitcnt lgkmcnt(0)
    v_add_f32 v108, v108, v109
    v_add_f32 v110, v110, v111
    v_add_f32 v112, v112, v113
    v_add_f32 v114, v114, v115
    v_add_f32 v108, v108, v110
    v_add_f32 v112, v112, v114
    v_mul_f32 v109, 0xbfb8aa3b, v108
    v_exp_f32 v109, v109
    s_nop 0
    v_add_f32 v109, 1.0, v109
    v_rcp_f32 v109, v109
    s_nop 0
    v_mul_f32 v108, v108, v109
    v_mul_f32 v108, v108, v112
    v_lshrrev_b32 v96, 4, v2
    v_lshlrev_b32 v96, 2, v96
    ds_bpermute_b32 v112, v96, v108 offset:0
    ds_bpermute_b32 v113, v96, v108 offset:16
    ds_bpermute_b32 v114, v96, v108 offset:32
    ds_bpermute_b32 v115, v96, v108 offset:48
    s_waitcnt lgkmcnt(0)
    v_lshlrev_b32 v116, 16, v64
    v_and_b32 v117, 0xffff0000, v64
    v_mul_f32 v120, v116, v112
    v_mul_f32 v121, v117, v112
    v_lshlrev_b32 v116, 16, v65
    v_and_b32 v117, 0xffff0000, v65
    v_mul_f32 v122, v116, v112
    v_mul_f32 v123, v117, v112
    v_lshlrev_b32 v116, 16, v66
    v_and_b32 v117, 0xffff0000, v66
    v_mul_f32 v124, v116, v112
    v_mul_f32 v125, v117, v112
    v_lshlrev_b32 v116, 16, v67
    v_and_b32 v117, 0xffff0000, v67
    v_mul_f32 v126, v116, v112
    v_mul_f32 v127, v117, v112
    v_lshlrev_b32 v116, 16, v68
    v_and_b32 v117, 0xffff0000, v68
    v_fmac_f32 v120, v116, v113
    v_fmac_f32 v121, v117, v113
    v_lshlrev_b32 v116, 16, v69
    v_and_b32 v117, 0xffff0000, v69
    v_fmac_f32 v122, v116, v113
    v_fmac_f32 v123, v117, v113
    v_lshlrev_b32 v116, 16, v70
    v_and_b32 v117, 0xffff0000, v70
    v_fmac_f32 v124, v116, v113
    v_fmac_f32 v125, v117, v113
    v_lshlrev_b32 v116, 16, v71
    v_and_b32 v117, 0xffff0000, v71
    v_fmac_f32 v126, v116, v113
    v_fmac_f32 v127, v117, v113
    v_lshlrev_b32 v116, 16, v72
    v_and_b32 v117, 0xffff0000, v72
    v_fmac_f32 v120, v116, v114
    v_fmac_f32 v121, v117, v114
    v_lshlrev_b32 v116, 16, v73
    v_and_b32 v117, 0xffff0000, v73
    v_fmac_f32 v122, v116, v114
    v_fmac_f32 v123, v117, v114
    v_lshlrev_b32 v116, 16, v74
    v_and_b32 v117, 0xffff0000, v74
    v_fmac_f32 v124, v116, v114
    v_fmac_f32 v125, v117, v114
    v_lshlrev_b32 v116, 16, v75
    v_and_b32 v117, 0xffff0000, v75
    v_fmac_f32 v126, v116, v114
    v_fmac_f32 v127, v117, v114
    v_lshlrev_b32 v116, 16, v76
    v_and_b32 v117, 0xffff0000, v76
    v_fmac_f32 v120, v116, v115
    v_fmac_f32 v121, v117, v115
    v_lshlrev_b32 v116, 16, v77
    v_and_b32 v117, 0xffff0000, v77
    v_fmac_f32 v122, v116, v115
    v_fmac_f32 v123, v117, v115
    v_lshlrev_b32 v116, 16, v78
    v_and_b32 v117, 0xffff0000, v78
    v_fmac_f32 v124, v116, v115
    v_fmac_f32 v125, v117, v115
    v_lshlrev_b32 v116, 16, v79
    v_and_b32 v117, 0xffff0000, v79
    v_fmac_f32 v126, v116, v115
    v_fmac_f32 v127, v117, v115
    v_permlane32_swap_b32 v120, v124
    v_permlane32_swap_b32 v121, v125
    v_permlane32_swap_b32 v122, v126
    v_permlane32_swap_b32 v123, v127
    v_add_f32 v120, v120, v124
    v_add_f32 v121, v121, v125
    v_add_f32 v122, v122, v126
    v_add_f32 v123, v123, v127
    s_nop 0
    v_permlane16_swap_b32 v120, v122
    v_permlane16_swap_b32 v121, v123
    v_add_f32 v120, v120, v122
    v_add_f32 v121, v121, v123
    s_cmp_ge_u32 s25, 28
    s_cbranch_scc1 ffn0_kernel_end
    v_and_b32 v96, 15, v2
    v_lshlrev_b32 v96, 5, v96
    v_lshrrev_b32 v97, 4, v2
    v_lshl_add_u32 v96, v97, 3, v96
    s_and_b32 s34, s26, 15
    s_lshl_b32 s34, s34, 12
    s_lshl_b32 s35, s3, 9
    s_add_u32 s34, s34, s35
    s_add_u32 s34, s34, 0x1410000
    buffer_atomic_add_f32 v120, v96, s[20:23], s34 offen sc1
    buffer_atomic_add_f32 v121, v96, s[20:23], s34 offen offset:4 sc1
ffn0_kernel_end:
    s_endpgm
.globl fix0_kernel
.p2align 8
.type fix0_kernel,@function
fix0_kernel:
    s_cmp_ge_u32 s2, 1
    s_cbranch_scc1 fix0_kernel_end
    s_load_dwordx2 s[44:45], s[0:1], 64
    s_load_dwordx2 s[46:47], s[0:1], 80
    s_waitcnt lgkmcnt(0)
    s_mov_b32 s20, s46
    s_mov_b32 s21, s47
    s_mov_b32 s22, 0x8000000
    s_mov_b32 s23, 0x20000
    s_mov_b32 s48, s44
    s_mov_b32 s49, s45
    s_mov_b32 s50, 0x400000
    s_mov_b32 s51, 0x20000
    v_mov_b32 v1, 0
    s_mov_b32 s27, 0x1450000
    buffer_load_dwordx4 v[4:7], v1, s[20:23], s27 offen
    v_lshlrev_b32 v2, 4, v0
    s_mov_b32 s27, 0x1410000
    buffer_load_dwordx4 v[16:19], v2, s[20:23], s27 offen
    s_add_u32 s27, s27, 4096
    buffer_load_dwordx4 v[20:23], v2, s[20:23], s27 offen
    s_add_u32 s27, s27, 4096
    buffer_load_dwordx4 v[24:27], v2, s[20:23], s27 offen
    s_add_u32 s27, s27, 4096
    buffer_load_dwordx4 v[28:31], v2, s[20:23], s27 offen
    s_add_u32 s27, s27, 4096
    buffer_load_dwordx4 v[32:35], v2, s[20:23], s27 offen
    s_add_u32 s27, s27, 4096
    buffer_load_dwordx4 v[36:39], v2, s[20:23], s27 offen
    s_add_u32 s27, s27, 4096
    buffer_load_dwordx4 v[40:43], v2, s[20:23], s27 offen
    s_add_u32 s27, s27, 4096
    buffer_load_dwordx4 v[44:47], v2, s[20:23], s27 offen
    s_add_u32 s27, s27, 4096
    buffer_load_dwordx4 v[48:51], v2, s[20:23], s27 offen
    s_add_u32 s27, s27, 4096
    buffer_load_dwordx4 v[52:55], v2, s[20:23], s27 offen
    s_add_u32 s27, s27, 4096
    buffer_load_dwordx4 v[56:59], v2, s[20:23], s27 offen
    s_add_u32 s27, s27, 4096
    buffer_load_dwordx4 v[60:63], v2, s[20:23], s27 offen
    s_add_u32 s27, s27, 4096
    buffer_load_dwordx4 v[64:67], v2, s[20:23], s27 offen
    s_add_u32 s27, s27, 4096
    buffer_load_dwordx4 v[68:71], v2, s[20:23], s27 offen
    s_add_u32 s27, s27, 4096
    buffer_load_dwordx4 v[72:75], v2, s[20:23], s27 offen
    s_add_u32 s27, s27, 4096
    buffer_load_dwordx4 v[76:79], v2, s[20:23], s27 offen
    s_add_u32 s27, s27, 4096
    s_waitcnt vmcnt(16)
    v_and_b32 v4, 2047, v4
    v_lshrrev_b32 v8, 7, v4
    v_lshlrev_b32 v8, 18, v8
    v_bfe_u32 v9, v4, 5, 2
    v_lshl_add_u32 v8, v9, 12, v8
    v_and_b32 v9, 31, v4
    v_lshl_add_u32 v8, v9, 4, v8
    v_lshrrev_b32 v9, 4, v0
    v_lshl_add_u32 v8, v9, 14, v8
    v_bfe_u32 v9, v0, 2, 2
    v_lshl_add_u32 v8, v9, 10, v8
    v_and_b32 v9, 1, v0
    v_lshl_add_u32 v8, v9, 9, v8
    v_bfe_u32 v9, v0, 1, 1
    v_lshl_add_u32 v8, v9, 3, v8
    s_mov_b32 s28, 0x1000000
    buffer_load_dwordx2 v[10:11], v8, s[20:23], s28 offen
    v_mul_f32 v5, 0xbfb8aa3b, v5
    v_exp_f32 v5, v5
    s_nop 0
    v_add_f32 v5, 1.0, v5
    v_rcp_f32 v5, v5
    v_mul_f32 v6, v6, v7
    v_add_f32 v7, 1.0, v7
    s_waitcnt vmcnt(0)
    v_add_f32 v16, v16, v20
    v_add_f32 v17, v17, v21
    v_add_f32 v18, v18, v22
    v_add_f32 v19, v19, v23
    v_add_f32 v16, v16, v24
    v_add_f32 v17, v17, v25
    v_add_f32 v18, v18, v26
    v_add_f32 v19, v19, v27
    v_add_f32 v16, v16, v28
    v_add_f32 v17, v17, v29
    v_add_f32 v18, v18, v30
    v_add_f32 v19, v19, v31
    v_add_f32 v16, v16, v32
    v_add_f32 v17, v17, v33
    v_add_f32 v18, v18, v34
    v_add_f32 v19, v19, v35
    v_add_f32 v16, v16, v36
    v_add_f32 v17, v17, v37
    v_add_f32 v18, v18, v38
    v_add_f32 v19, v19, v39
    v_add_f32 v16, v16, v40
    v_add_f32 v17, v17, v41
    v_add_f32 v18, v18, v42
    v_add_f32 v19, v19, v43
    v_add_f32 v16, v16, v44
    v_add_f32 v17, v17, v45
    v_add_f32 v18, v18, v46
    v_add_f32 v19, v19, v47
    v_add_f32 v16, v16, v48
    v_add_f32 v17, v17, v49
    v_add_f32 v18, v18, v50
    v_add_f32 v19, v19, v51
    v_add_f32 v16, v16, v52
    v_add_f32 v17, v17, v53
    v_add_f32 v18, v18, v54
    v_add_f32 v19, v19, v55
    v_add_f32 v16, v16, v56
    v_add_f32 v17, v17, v57
    v_add_f32 v18, v18, v58
    v_add_f32 v19, v19, v59
    v_add_f32 v16, v16, v60
    v_add_f32 v17, v17, v61
    v_add_f32 v18, v18, v62
    v_add_f32 v19, v19, v63
    v_add_f32 v16, v16, v64
    v_add_f32 v17, v17, v65
    v_add_f32 v18, v18, v66
    v_add_f32 v19, v19, v67
    v_add_f32 v16, v16, v68
    v_add_f32 v17, v17, v69
    v_add_f32 v18, v18, v70
    v_add_f32 v19, v19, v71
    v_add_f32 v16, v16, v72
    v_add_f32 v17, v17, v73
    v_add_f32 v18, v18, v74
    v_add_f32 v19, v19, v75
    v_add_f32 v16, v16, v76
    v_add_f32 v17, v17, v77
    v_add_f32 v18, v18, v78
    v_add_f32 v19, v19, v79
    v_lshlrev_b32 v12, 16, v10
    v_and_b32 v13, 0xffff0000, v10
    v_lshlrev_b32 v14, 16, v11
    v_and_b32 v15, 0xffff0000, v11
    v_fma_f32 v12, v12, v7, -v6
    v_fmac_f32 v12, v16, v5
    v_fma_f32 v13, v13, v7, -v6
    v_fmac_f32 v13, v17, v5
    v_fma_f32 v14, v14, v7, -v6
    v_fmac_f32 v14, v18, v5
    v_fma_f32 v15, v15, v7, -v6
    v_fmac_f32 v15, v19, v5
    v_cvt_pk_bf16_f32 v10, v12, v13
    v_cvt_pk_bf16_f32 v11, v14, v15
    buffer_store_dwordx2 v[10:11], v8, s[20:23], s28 offen
    v_add_f32 v20, v12, v13
    v_add_f32 v20, v20, v14
    v_add_f32 v20, v20, v15
    v_mul_f32 v21, v12, v12
    v_fmac_f32 v21, v13, v13
    v_fmac_f32 v21, v14, v14
    v_fmac_f32 v21, v15, v15
    v_add_f32_dpp v20, v20, v20 quad_perm:[1,0,3,2] row_mask:0xf bank_mask:0xf
    s_nop 1
    v_add_f32_dpp v20, v20, v20 quad_perm:[2,3,0,1] row_mask:0xf bank_mask:0xf
    s_nop 1
    v_add_f32_dpp v20, v20, v20 row_half_mirror row_mask:0xf bank_mask:0xf
    s_nop 1
    v_add_f32_dpp v20, v20, v20 row_mirror row_mask:0xf bank_mask:0xf
    v_mov_b32 v22, v20
    s_nop 1
    v_permlane16_swap_b32 v20, v22
    v_add_f32 v20, v20, v22
    v_mov_b32 v22, v20
    s_nop 1
    v_permlane32_swap_b32 v20, v22
    v_add_f32 v20, v20, v22
    v_add_f32_dpp v21, v21, v21 quad_perm:[1,0,3,2] row_mask:0xf bank_mask:0xf
    s_nop 1
    v_add_f32_dpp v21, v21, v21 quad_perm:[2,3,0,1] row_mask:0xf bank_mask:0xf
    s_nop 1
    v_add_f32_dpp v21, v21, v21 row_half_mirror row_mask:0xf bank_mask:0xf
    s_nop 1
    v_add_f32_dpp v21, v21, v21 row_mirror row_mask:0xf bank_mask:0xf
    v_mov_b32 v22, v21
    s_nop 1
    v_permlane16_swap_b32 v21, v22
    v_add_f32 v21, v21, v22
    v_mov_b32 v22, v21
    s_nop 1
    v_permlane32_swap_b32 v21, v22
    v_add_f32 v21, v21, v22
    v_lshrrev_b32 v22, 6, v0
    v_lshlrev_b32 v22, 3, v22
    ds_write_b64 v22, v[20:21]
    s_waitcnt lgkmcnt(0)
    s_barrier
    ds_read_b128 v[24:27], v1
    ds_read_b128 v[28:31], v1 offset:16
    s_waitcnt lgkmcnt(0)
    v_add_f32 v20, v24, v26
    v_add_f32 v21, v25, v27
    v_add_f32 v20, v20, v28
    v_add_f32 v21, v21, v29
    v_add_f32 v20, v20, v30
    v_add_f32 v21, v21, v31
    v_mul_f32 v20, 0x3a800000, v20
    v_mul_f32 v21, 0x3a800000, v21
    v_fma_f32 v21, -v20, v20, v21
    v_max_f32 v21, 0, v21
    v_add_f32 v21, 0x3727c5ac, v21
    v_rsq_f32 v21, v21
    v_cmp_eq_u32 vcc, 1, v0
    s_nop 1
    v_cndmask_b32 v21, v21, v20, vcc
    v_cmp_eq_u32 vcc, 2, v0
    s_nop 1
    v_cndmask_b32 v21, v21, 1.0, vcc
    v_cmp_eq_u32 vcc, 3, v0
    s_nop 1
    v_cndmask_b32 v21, v21, 0, vcc
    v_lshlrev_b32 v22, 13, v0
    v_lshl_add_u32 v22, v4, 2, v22
    v_cmp_gt_u32 vcc, 4, v0
    s_and_saveexec_b64 s[36:37], vcc
    s_mov_b32 s27, 0x3440000
    buffer_store_dword v21, v22, s[20:23], s27 offen
fix0_kernel_end:
    s_endpgm
.globl qkv1_kernel
.p2align 8
.type qkv1_kernel,@function
qkv1_kernel:
    s_cmp_ge_u32 s2, 256
    s_cbranch_scc1 qkv1_kernel_end
    s_load_dwordx4 s[4:7], s[0:1], 0
    s_load_dwordx2 s[8:9], s[0:1], 80
    v_lshrrev_b32 v1, 6, v0
    v_and_b32 v2, 63, v0
    v_readfirstlane_b32 s3, v1
    s_and_b32 s24, s2, 7
    s_lshr_b32 s25, s2, 3
    s_lshr_b32 s26, s24, 2
    s_lshl_b32 s26, s26, 3
    s_and_b32 s27, s25, 7
    s_add_u32 s26, s26, s27
    s_and_b32 s27, s24, 3
    s_lshl_b32 s27, s27, 2
    s_lshr_b32 s25, s25, 3
    s_add_u32 s27, s27, s25
    s_waitcnt lgkmcnt(0)
    s_mov_b32 s20, s8
    s_mov_b32 s21, s9
    s_mov_b32 s22, 0x8000000
    s_mov_b32 s23, 0x20000
    s_cmp_lt_u32 s3, 4
    s_cbranch_scc1 qkv1_kernel_cons
    s_add_u32 s12, s8, 0x1000000
    s_addc_u32 s13, s9, 0
    s_mov_b32 s14, 0x400000
    s_mov_b32 s15, 0x20000
    s_mov_b32 s16, s6
    s_mov_b32 s17, s7
    s_mov_b32 s18, 0x600000
    s_mov_b32 s19, 0x20000
    s_sub_u32 s3, s3, 4
    s_lshl_b32 s28, s3, 10
    v_lshlrev_b32 v3, 4, v2
    v_add_u32 v3, s28, v3
    s_lshl_b32 s30, s26, 18
    v_lshrrev_b32 v4, 3, v2
    v_and_b32 v5, 3, v4
    v_lshrrev_b32 v6, 5, v2
    v_lshl_add_u32 v4, v6, 3, v5
    s_lshr_b32 s28, s3, 1
    s_lshl_b32 s28, s28, 4
    s_and_b32 s29, s3, 1
    s_lshl_b32 s29, s29, 2
    s_add_u32 s28, s28, s29
    v_add_u32 v4, s28, v4
    v_mul_u32_u24 v4, 6144, v4
    v_lshrrev_b32 v5, 2, v2
    v_and_b32 v5, 4, v5
    v_xor_b32 v5, v5, v2
    v_and_b32 v5, 7, v5
    v_lshl_add_u32 v4, v5, 4, v4
    s_lshl_b32 s31, s27, 7
    s_lshl_b32 s32, s3, 10
    v_subrev_u32 v7, 256, v0
    v_lshrrev_b32 v8, 6, v7
    v_lshlrev_b32 v8, 12, v8
    v_lshl_add_u32 v8, v2, 2, v8
    s_lshl_b32 s33, s27, 8
    s_add_u32 s33, s33, 0x4000000
    buffer_load_dword v16, v8, s[20:23], s33 offen
    s_add_u32 s33, s33, 12288
    buffer_load_dword v17, v8, s[20:23], s33 offen
    s_add_u32 s33, s33, 12288
    buffer_load_dword v18, v8, s[20:23], s33 offen
    s_add_u32 s33, s33, 12288
    buffer_load_dword v19, v8, s[20:23], s33 offen
    s_add_u32 s33, s33, 12288
    buffer_load_dword v20, v8, s[20:23], s33 offen
    s_add_u32 s33, s33, 12288
    buffer_load_dword v21, v8, s[20:23], s33 offen
    s_add_u32 s33, s33, 12288
    buffer_load_dword v22, v8, s[20:23], s33 offen
    s_add_u32 s33, s33, 12288
    buffer_load_dword v23, v8, s[20:23], s33 offen
    s_add_u32 s33, s33, 12288
    buffer_load_dword v24, v8, s[20:23], s33 offen
    s_add_u32 s33, s33, 12288
    buffer_load_dword v25, v8, s[20:23], s33 offen
    s_add_u32 s33, s33, 12288
    buffer_load_dword v26, v8, s[20:23], s33 offen
    s_add_u32 s33, s33, 12288
    buffer_load_dword v27, v8, s[20:23], s33 offen
    s_add_u32 s33, s33, 12288
    buffer_load_dword v28, v8, s[20:23], s33 offen
    s_add_u32 s33, s33, 12288
    buffer_load_dword v29, v8, s[20:23], s33 offen
    s_add_u32 s33, s33, 12288
    buffer_load_dword v30, v8, s[20:23], s33 offen
    s_add_u32 s33, s33, 12288
    buffer_load_dword v31, v8, s[20:23], s33 offen
    s_add_u32 s33, s33, 12288
    v_lshrrev_b32 v9, 7, v7
    v_lshlrev_b32 v9, 13, v9
    v_and_b32 v10, 127, v7
    v_lshl_add_u32 v9, v10, 2, v9
    s_lshl_b32 s33, s26, 9
    s_add_u32 s33, s33, 0x3440000
    buffer_load_dword v32, v9, s[20:23], s33 offen
    s_mov_b32 s36, 4
qkv1_kernel_lpro:
    s_mov_b32 m0, s32
    s_mov_b32 s34, s30
    buffer_load_dwordx4 v3, s[12:15], s34 offen lds
    s_add_u32 m0, m0, 4096
    s_add_u32 s34, s34, 4096
    buffer_load_dwordx4 v3, s[12:15], s34 offen lds
    s_add_u32 m0, m0, 4096
    s_add_u32 s34, s34, 4096
    buffer_load_dwordx4 v3, s[12:15], s34 offen lds
    s_add_u32 m0, m0, 4096
    s_add_u32 s34, s34, 4096
    buffer_load_dwordx4 v3, s[12:15], s34 offen lds
    s_add_u32 m0, m0, 4096
    s_mov_b32 s34, s31
    buffer_load_dwordx4 v4, s[16:19], s34 offen lds
    s_add_u32 m0, m0, 4096
    s_add_u32 s34, s34, 196608
    buffer_load_dwordx4 v4, s[16:19], s34 offen lds
    s_add_u32 m0, m0, 4096
    s_sub_u32 s34, s34, 194560
    buffer_load_dwordx4 v4, s[16:19], s34 offen lds
    s_add_u32 m0, m0, 4096
    s_add_u32 s34, s34, 196608
    buffer_load_dwordx4 v4, s[16:19], s34 offen lds
    s_add_u32 m0, m0, 4096
    s_sub_u32 s34, s34, 194560
    buffer_load_dwordx4 v4, s[16:19], s34 offen lds
    s_add_u32 m0, m0, 4096
    s_add_u32 s34, s34, 196608
    buffer_load_dwordx4 v4, s[16:19], s34 offen lds
    s_add_u32 s30, s30, 16384
    s_add_u32 s31, s31, 393216
    s_add_u32 s32, s32, 40960
    s_cmp_ge_u32 s32, 163840
    s_cselect_b32 s35, 163840, 0
    s_sub_u32 s32, s32, s35
    s_sub_u32 s36, s36, 1
    s_cmp_lg_u32 s36, 0
    s_cbranch_scc1 qkv1_kernel_lpro
    s_waitcnt vmcnt(30)
    v_add_f32 v16, v16, v17
    v_add_f32 v16, v16, v18
    v_add_f32 v16, v16, v19
    v_add_f32 v16, v16, v20
    v_add_f32 v16, v16, v21
    v_add_f32 v16, v16, v22
    v_add_f32 v16, v16, v23
    v_add_f32 v16, v16, v24
    v_add_f32 v16, v16, v25
    v_add_f32 v16, v16, v26
    v_add_f32 v16, v16, v27
    v_add_f32 v16, v16, v28
    v_add_f32 v16, v16, v29
    v_add_f32 v16, v16, v30
    v_add_f32 v16, v16, v31
    s_barrier
    s_mov_b32 s36, 12
qkv1_kernel_lloop:
    s_waitcnt vmcnt(20)
    s_barrier
    s_mov_b32 m0, s32
    s_mov_b32 s34, s30
    buffer_load_dwordx4 v3, s[12:15], s34 offen lds
    s_add_u32 m0, m0, 4096
    s_add_u32 s34, s34, 4096
    buffer_load_dwordx4 v3, s[12:15], s34 offen lds
    s_add_u32 m0, m0, 4096
    s_add_u32 s34, s34, 4096
    buffer_load_dwordx4 v3, s[12:15], s34 offen lds
    s_add_u32 m0, m0, 4096
    s_add_u32 s34, s34, 4096
    buffer_load_dwordx4 v3, s[12:15], s34 offen lds
    s_add_u32 m0, m0, 4096
    s_mov_b32 s34, s31
    buffer_load_dwordx4 v4, s[16:19], s34 offen lds
    s_add_u32 m0, m0, 4096
    s_add_u32 s34, s34, 196608
    buffer_load_dwordx4 v4, s[16:19], s34 offen lds
    s_add_u32 m0, m0, 4096
    s_sub_u32 s34, s34, 194560
    buffer_load_dwordx4 v4, s[16:19], s34 offen lds
    s_add_u32 m0, m0, 4096
    s_add_u32 s34, s34, 196608
    buffer_load_dwordx4 v4, s[16:19], s34 offen lds
    s_add_u32 m0, m0, 4096
    s_sub_u32 s34, s34, 194560
    buffer_load_dwordx4 v4, s[16:19], s34 offen lds
    s_add_u32 m0, m0, 4096
    s_add_u32 s34, s34, 196608
    buffer_load_dwordx4 v4, s[16:19], s34 offen lds
    s_add_u32 s30, s30, 16384
    s_add_u32 s31, s31, 393216
    s_add_u32 s32, s32, 40960
    s_cmp_ge_u32 s32, 163840
    s_cselect_b32 s35, 163840, 0
    s_sub_u32 s32, s32, s35
    s_sub_u32 s36, s36, 1
    s_cmp_lg_u32 s36, 0
    s_cbranch_scc1 qkv1_kernel_lloop
    s_waitcnt vmcnt(20)
    s_barrier
    v_lshlrev_b32 v11, 2, v7
    ds_write_b32 v11, v32
    ds_write_b32 v11, v16 offset:1024
    s_waitcnt vmcnt(10)
    s_barrier
    s_waitcnt vmcnt(0)
    s_barrier
    s_waitcnt lgkmcnt(0)
    s_barrier
    s_endpgm
qkv1_kernel_cons:
    v_mov_b32 v212, v2
    s_and_b32 s28, s3, 1
    s_lshr_b32 s29, s3, 1
    v_and_b32 v3, 31, v2
    v_lshrrev_b32 v4, 5, v2
    s_lshl_b32 s30, s28, 13
    v_lshlrev_b32 v5, 4, v2
    v_add_u32 v136, s30, v5
    v_add_u32 v137, 1024, v136
    v_add_u32 v138, 2048, v136
    v_add_u32 v139, 3072, v136
    v_bfe_u32 v5, v2, 2, 2
    v_lshl_add_u32 v6, v4, 3, v5
    v_lshlrev_b32 v6, 7, v6
    v_lshrrev_b32 v5, 1, v5
    v_xor_b32 v5, s29, v5
    v_lshl_add_u32 v6, v5, 6, v6
    v_bfe_u32 v5, v2, 4, 1
    v_lshl_add_u32 v6, v5, 5, v6
    v_and_b32 v5, 3, v2
    v_lshl_add_u32 v6, v5, 3, v6
    v_add_u32 v140, 16384, v6
    v_mov_b32 v141, v136
    v_mov_b32 v142, v137
    v_mov_b32 v143, v138
    v_mov_b32 v144, v139
    v_mov_b32 v145, v140
    v_mov_b32 v0, 0
    v_mov_b32 v1, 0
    v_mov_b32 v2, 0
    v_mov_b32 v3, 0
    v_mov_b32 v4, 0
    v_mov_b32 v5, 0
    v_mov_b32 v6, 0
    v_mov_b32 v7, 0
    v_mov_b32 v8, 0
    v_mov_b32 v9, 0
    v_mov_b32 v10, 0
    v_mov_b32 v11, 0
    v_mov_b32 v12, 0
    v_mov_b32 v13, 0
    v_mov_b32 v14, 0
    v_mov_b32 v15, 0
    v_mov_b32 v16, 0
    v_mov_b32 v17, 0
    v_mov_b32 v18, 0
    v_mov_b32 v19, 0
    v_mov_b32 v20, 0
    v_mov_b32 v21, 0
    v_mov_b32 v22, 0
    v_mov_b32 v23, 0
    v_mov_b32 v24, 0
    v_mov_b32 v25, 0
    v_mov_b32 v26, 0
    v_mov_b32 v27, 0
    v_mov_b32 v28, 0
    v_mov_b32 v29, 0
    v_mov_b32 v30, 0
    v_mov_b32 v31, 0
    v_mov_b32 v32, 0
    v_mov_b32 v33, 0
    v_mov_b32 v34, 0
    v_mov_b32 v35, 0
    v_mov_b32 v36, 0
    v_mov_b32 v37, 0
    v_mov_b32 v38, 0
    v_mov_b32 v39, 0
    v_mov_b32 v40, 0
    v_mov_b32 v41, 0
    v_mov_b32 v42, 0
    v_mov_b32 v43, 0
    v_mov_b32 v44, 0
    v_mov_b32 v45, 0
    v_mov_b32 v46, 0
    v_mov_b32 v47, 0
    v_mov_b32 v48, 0
    v_mov_b32 v49, 0
    v_mov_b32 v50, 0
    v_mov_b32 v51, 0
    v_mov_b32 v52, 0
    v_mov_b32 v53, 0
    v_mov_b32 v54, 0
    v_mov_b32 v55, 0
    v_mov_b32 v56, 0
    v_mov_b32 v57, 0
    v_mov_b32 v58, 0
    v_mov_b32 v59, 0
    v_mov_b32 v60, 0
    v_mov_b32 v61, 0
    v_mov_b32 v62, 0
    v_mov_b32 v63, 0
    v_mov_b32 v64, 0
    v_mov_b32 v65, 0
    v_mov_b32 v66, 0
    v_mov_b32 v67, 0
    v_mov_b32 v68, 0
    v_mov_b32 v69, 0
    v_mov_b32 v70, 0
    v_mov_b32 v71, 0
    v_mov_b32 v72, 0
    v_mov_b32 v73, 0
    v_mov_b32 v74, 0
    v_mov_b32 v75, 0
    v_mov_b32 v76, 0
    v_mov_b32 v77, 0
    v_mov_b32 v78, 0
    v_mov_b32 v79, 0
    v_mov_b32 v80, 0
    v_mov_b32 v81, 0
    v_mov_b32 v82, 0
    v_mov_b32 v83, 0
    v_mov_b32 v84, 0
    v_mov_b32 v85, 0
    v_mov_b32 v86, 0
    v_mov_b32 v87, 0
    v_mov_b32 v88, 0
    v_mov_b32 v89, 0
    v_mov_b32 v90, 0
    v_mov_b32 v91, 0
    v_mov_b32 v92, 0
    v_mov_b32 v93, 0
    v_mov_b32 v94, 0
    v_mov_b32 v95, 0
    s_mov_b32 s31, 0
    s_mov_b32 s36, 16
    s_barrier
    ds_read_b128 v[96:99], v141
    ds_read_b128 v[100:103], v141 offset:4096
    ds_read_b64_tr_b16 v[104:105], v145 offset:0
    ds_read_b64_tr_b16 v[106:107], v145 offset:512
    ds_read_b64_tr_b16 v[108:109], v145 offset:8192
    ds_read_b64_tr_b16 v[110:111], v145 offset:8704
    ds_read_b64_tr_b16 v[112:113], v145 offset:16384
    ds_read_b64_tr_b16 v[114:115], v145 offset:16896
qkv1_kernel_cloop:
    s_waitcnt lgkmcnt(0)
    v_mfma_f32_32x32x16_bf16 v[0:15], v[104:107], v[96:99], v[0:15]
    ds_read_b128 v[116:119], v142
    ds_read_b64_tr_b16 v[124:125], v145 offset:2048
    ds_read_b64_tr_b16 v[126:127], v145 offset:2560
    v_mfma_f32_32x32x16_bf16 v[16:31], v[104:107], v[100:103], v[16:31]
    ds_read_b128 v[120:123], v142 offset:4096
    ds_read_b64_tr_b16 v[128:129], v145 offset:10240
    ds_read_b64_tr_b16 v[130:131], v145 offset:10752
    v_mfma_f32_32x32x16_bf16 v[32:47], v[108:111], v[96:99], v[32:47]
    ds_read_b64_tr_b16 v[132:133], v145 offset:18432
    ds_read_b64_tr_b16 v[134:135], v145 offset:18944
    v_mfma_f32_32x32x16_bf16 v[48:63], v[108:111], v[100:103], v[48:63]
    v_mfma_f32_32x32x16_bf16 v[64:79], v[96:99], v[112:115], v[64:79]
    v_mfma_f32_32x32x16_bf16 v[80:95], v[100:103], v[112:115], v[80:95]
    s_waitcnt lgkmcnt(0)
    v_mfma_f32_32x32x16_bf16 v[0:15], v[124:127], v[116:119], v[0:15]
    ds_read_b128 v[96:99], v143
    ds_read_b64_tr_b16 v[104:105], v145 offset:4096
    ds_read_b64_tr_b16 v[106:107], v145 offset:4608
    v_mfma_f32_32x32x16_bf16 v[16:31], v[124:127], v[120:123], v[16:31]
    ds_read_b128 v[100:103], v143 offset:4096
    ds_read_b64_tr_b16 v[108:109], v145 offset:12288
    ds_read_b64_tr_b16 v[110:111], v145 offset:12800
    v_mfma_f32_32x32x16_bf16 v[32:47], v[128:131], v[116:119], v[32:47]
    ds_read_b64_tr_b16 v[112:113], v145 offset:20480
    ds_read_b64_tr_b16 v[114:115], v145 offset:20992
    v_mfma_f32_32x32x16_bf16 v[48:63], v[128:131], v[120:123], v[48:63]
    v_mfma_f32_32x32x16_bf16 v[64:79], v[116:119], v[132:135], v[64:79]
    v_mfma_f32_32x32x16_bf16 v[80:95], v[120:123], v[132:135], v[80:95]
    s_waitcnt lgkmcnt(0)
    v_mfma_f32_32x32x16_bf16 v[0:15], v[104:107], v[96:99], v[0:15]
    ds_read_b128 v[116:119], v144
    ds_read_b64_tr_b16 v[124:125], v145 offset:6144
    ds_read_b64_tr_b16 v[126:127], v145 offset:6656
    v_mfma_f32_32x32x16_bf16 v[16:31], v[104:107], v[100:103], v[16:31]
    ds_read_b128 v[120:123], v144 offset:4096
    ds_read_b64_tr_b16 v[128:129], v145 offset:14336
    ds_read_b64_tr_b16 v[130:131], v145 offset:14848
    v_mfma_f32_32x32x16_bf16 v[32:47], v[108:111], v[96:99], v[32:47]
    ds_read_b64_tr_b16 v[132:133], v145 offset:22528
    ds_read_b64_tr_b16 v[134:135], v145 offset:23040
    v_mfma_f32_32x32x16_bf16 v[48:63], v[108:111], v[100:103], v[48:63]
    v_mfma_f32_32x32x16_bf16 v[64:79], v[96:99], v[112:115], v[64:79]
    v_mfma_f32_32x32x16_bf16 v[80:95], v[100:103], v[112:115], v[80:95]
    s_waitcnt lgkmcnt(0)
    v_mfma_f32_32x32x16_bf16 v[0:15], v[124:127], v[116:119], v[0:15]
    s_barrier
    s_add_u32 s31, s31, 40960
    s_cmp_ge_u32 s31, 163840
    s_cselect_b32 s31, 0, s31
    v_add_u32 v141, s31, v136
    v_add_u32 v145, s31, v140
    ds_read_b128 v[96:99], v141
    ds_read_b64_tr_b16 v[104:105], v145 offset:0
    ds_read_b64_tr_b16 v[106:107], v145 offset:512
    v_mfma_f32_32x32x16_bf16 v[16:31], v[124:127], v[120:123], v[16:31]
    ds_read_b128 v[100:103], v141 offset:4096
    ds_read_b64_tr_b16 v[108:109], v145 offset:8192
    ds_read_b64_tr_b16 v[110:111], v145 offset:8704
    v_mfma_f32_32x32x16_bf16 v[32:47], v[128:131], v[116:119], v[32:47]
    ds_read_b64_tr_b16 v[112:113], v145 offset:16384
    ds_read_b64_tr_b16 v[114:115], v145 offset:16896
    v_mfma_f32_32x32x16_bf16 v[48:63], v[128:131], v[120:123], v[48:63]
    v_add_u32 v142, s31, v137
    v_add_u32 v143, s31, v138
    v_add_u32 v144, s31, v139
    s_sub_u32 s36, s36, 1
    s_cmp_lg_u32 s36, 0
    v_mfma_f32_32x32x16_bf16 v[64:79], v[116:119], v[132:135], v[64:79]
    v_mfma_f32_32x32x16_bf16 v[80:95], v[120:123], v[132:135], v[80:95]
    s_cbranch_scc1 qkv1_kernel_cloop
    s_waitcnt lgkmcnt(0)
    v_and_b32 v96, 31, v212
    v_lshrrev_b32 v97, 5, v212
    s_lshl_b32 s30, s28, 8
    s_add_u32 s30, s30, 0
    v_lshl_add_u32 v98, v96, 2, s30
    v_lshl_add_u32 v99, v97, 4, s30
    s_lshl_b32 s30, s29, 7
    s_add_u32 s30, s30, 1024
    v_lshl_add_u32 v100, v97, 4, s30
    v_lshl_add_u32 v101, v96, 2, s30
    ds_read_b32 v104, v98
    ds_read_b32 v106, v98 offset:128
    ds_read_b32 v108, v98 offset:512
    ds_read_b32 v110, v98 offset:640
    ds_read_b32 v112, v101 offset:512
    ds_read_b128 v[116:119], v100 offset:0
    ds_read_b128 v[120:123], v100 offset:32
    ds_read_b128 v[124:127], v100 offset:64
    ds_read_b128 v[128:131], v100 offset:96
    ds_read_b128 v[132:135], v100 offset:256
    ds_read_b128 v[136:139], v100 offset:288
    ds_read_b128 v[140:143], v100 offset:320
    ds_read_b128 v[144:147], v100 offset:352
    ds_read_b128 v[148:151], v99 offset:0
    ds_read_b128 v[180:183], v99 offset:512
    ds_read_b128 v[152:155], v99 offset:32
    ds_read_b128 v[184:187], v99 offset:544
    ds_read_b128 v[156:159], v99 offset:64
    ds_read_b128 v[188:191], v99 offset:576
    ds_read_b128 v[160:163], v99 offset:96
    ds_read_b128 v[192:195], v99 offset:608
    ds_read_b128 v[164:167], v99 offset:128
    ds_read_b128 v[196:199], v99 offset:640
    ds_read_b128 v[168:171], v99 offset:160
    ds_read_b128 v[200:203], v99 offset:672
    ds_read_b128 v[172:175], v99 offset:192
    ds_read_b128 v[204:207], v99 offset:704
    ds_read_b128 v[176:179], v99 offset:224
    ds_read_b128 v[208:211], v99 offset:736
    s_lshl_b32 s30, s27, 1
    s_add_u32 s30, s30, s29
    s_lshl_b32 s30, s30, 6
    s_lshl_b32 s31, s26, 2
    s_add_u32 s30, s30, s31
    s_lshl_b32 s31, s28, 1
    s_add_u32 s30, s30, s31
    s_lshl_b32 s31, s30, 11
    s_add_u32 s31, s31, 0x2000000
    s_lshl_b32 s32, s30, 12
    s_add_u32 s32, s32, 0x2400000
    s_add_u32 s33, s32, 4096
    v_lshlrev_b32 v96, 4, v212
    s_waitcnt lgkmcnt(15)
    v_mul_f32 v114, 0x3e8293ee, v104
    v_mul_f32 v102, 0x3e8293ee, v106
    v_pk_fma_f32 v[0:1], v[116:117], v[108:109], v[0:1] op_sel_hi:[1,0,1] neg_lo:[0,1,0] neg_hi:[0,1,0]
    v_pk_fma_f32 v[2:3], v[118:119], v[108:109], v[2:3] op_sel_hi:[1,0,1] neg_lo:[0,1,0] neg_hi:[0,1,0]
    v_pk_fma_f32 v[4:5], v[120:121], v[108:109], v[4:5] op_sel_hi:[1,0,1] neg_lo:[0,1,0] neg_hi:[0,1,0]
    v_pk_fma_f32 v[6:7], v[122:123], v[108:109], v[6:7] op_sel_hi:[1,0,1] neg_lo:[0,1,0] neg_hi:[0,1,0]
    v_pk_fma_f32 v[8:9], v[124:125], v[108:109], v[8:9] op_sel_hi:[1,0,1] neg_lo:[0,1,0] neg_hi:[0,1,0]
    v_pk_fma_f32 v[10:11], v[126:127], v[108:109], v[10:11] op_sel_hi:[1,0,1] neg_lo:[0,1,0] neg_hi:[0,1,0]
    v_pk_fma_f32 v[12:13], v[128:129], v[108:109], v[12:13] op_sel_hi:[1,0,1] neg_lo:[0,1,0] neg_hi:[0,1,0]
    v_pk_fma_f32 v[14:15], v[130:131], v[108:109], v[14:15] op_sel_hi:[1,0,1] neg_lo:[0,1,0] neg_hi:[0,1,0]
    v_pk_mul_f32 v[0:1], v[0:1], v[114:115] op_sel_hi:[1,0]
    v_pk_mul_f32 v[2:3], v[2:3], v[114:115] op_sel_hi:[1,0]
    v_pk_mul_f32 v[4:5], v[4:5], v[114:115] op_sel_hi:[1,0]
    v_pk_mul_f32 v[6:7], v[6:7], v[114:115] op_sel_hi:[1,0]
    v_pk_mul_f32 v[8:9], v[8:9], v[114:115] op_sel_hi:[1,0]
    v_pk_mul_f32 v[10:11], v[10:11], v[114:115] op_sel_hi:[1,0]
    v_pk_mul_f32 v[12:13], v[12:13], v[114:115] op_sel_hi:[1,0]
    v_pk_mul_f32 v[14:15], v[14:15], v[114:115] op_sel_hi:[1,0]
    v_cvt_pk_bf16_f32 v0, v0, v1
    v_cvt_pk_bf16_f32 v1, v2, v3
    v_cvt_pk_bf16_f32 v2, v4, v5
    v_cvt_pk_bf16_f32 v3, v6, v7
    v_cvt_pk_bf16_f32 v4, v8, v9
    v_cvt_pk_bf16_f32 v5, v10, v11
    v_cvt_pk_bf16_f32 v6, v12, v13
    v_cvt_pk_bf16_f32 v7, v14, v15
    buffer_store_dwordx4 v[0:3], v96, s[20:23], s31 offen offset:0
    buffer_store_dwordx4 v[4:7], v96, s[20:23], s31 offen offset:1024
    v_pk_fma_f32 v[16:17], v[116:117], v[110:111], v[16:17] op_sel_hi:[1,0,1] neg_lo:[0,1,0] neg_hi:[0,1,0]
    v_pk_fma_f32 v[18:19], v[118:119], v[110:111], v[18:19] op_sel_hi:[1,0,1] neg_lo:[0,1,0] neg_hi:[0,1,0]
    v_pk_fma_f32 v[20:21], v[120:121], v[110:111], v[20:21] op_sel_hi:[1,0,1] neg_lo:[0,1,0] neg_hi:[0,1,0]
    v_pk_fma_f32 v[22:23], v[122:123], v[110:111], v[22:23] op_sel_hi:[1,0,1] neg_lo:[0,1,0] neg_hi:[0,1,0]
    v_pk_fma_f32 v[24:25], v[124:125], v[110:111], v[24:25] op_sel_hi:[1,0,1] neg_lo:[0,1,0] neg_hi:[0,1,0]
    v_pk_fma_f32 v[26:27], v[126:127], v[110:111], v[26:27] op_sel_hi:[1,0,1] neg_lo:[0,1,0] neg_hi:[0,1,0]
    v_pk_fma_f32 v[28:29], v[128:129], v[110:111], v[28:29] op_sel_hi:[1,0,1] neg_lo:[0,1,0] neg_hi:[0,1,0]
    v_pk_fma_f32 v[30:31], v[130:131], v[110:111], v[30:31] op_sel_hi:[1,0,1] neg_lo:[0,1,0] neg_hi:[0,1,0]
    v_pk_mul_f32 v[16:17], v[16:17], v[102:103] op_sel_hi:[1,0]
    v_pk_mul_f32 v[18:19], v[18:19], v[102:103] op_sel_hi:[1,0]
    v_pk_mul_f32 v[20:21], v[20:21], v[102:103] op_sel_hi:[1,0]
    v_pk_mul_f32 v[22:23], v[22:23], v[102:103] op_sel_hi:[1,0]
    v_pk_mul_f32 v[24:25], v[24:25], v[102:103] op_sel_hi:[1,0]
    v_pk_mul_f32 v[26:27], v[26:27], v[102:103] op_sel_hi:[1,0]
    v_pk_mul_f32 v[28:29], v[28:29], v[102:103] op_sel_hi:[1,0]
    v_pk_mul_f32 v[30:31], v[30:31], v[102:103] op_sel_hi:[1,0]
    v_cvt_pk_bf16_f32 v16, v16, v17
    v_cvt_pk_bf16_f32 v17, v18, v19
    v_cvt_pk_bf16_f32 v18, v20, v21
    v_cvt_pk_bf16_f32 v19, v22, v23
    v_cvt_pk_bf16_f32 v20, v24, v25
    v_cvt_pk_bf16_f32 v21, v26, v27
    v_cvt_pk_bf16_f32 v22, v28, v29
    v_cvt_pk_bf16_f32 v23, v30, v31
    buffer_store_dwordx4 v[16:19], v96, s[20:23], s31 offen offset:2048
    buffer_store_dwordx4 v[20:23], v96, s[20:23], s31 offen offset:3072
    v_pk_fma_f32 v[32:33], v[132:133], v[108:109], v[32:33] op_sel_hi:[1,0,1] neg_lo:[0,1,0] neg_hi:[0,1,0]
    v_pk_fma_f32 v[34:35], v[134:135], v[108:109], v[34:35] op_sel_hi:[1,0,1] neg_lo:[0,1,0] neg_hi:[0,1,0]
    v_pk_fma_f32 v[36:37], v[136:137], v[108:109], v[36:37] op_sel_hi:[1,0,1] neg_lo:[0,1,0] neg_hi:[0,1,0]
    v_pk_fma_f32 v[38:39], v[138:139], v[108:109], v[38:39] op_sel_hi:[1,0,1] neg_lo:[0,1,0] neg_hi:[0,1,0]
    v_pk_fma_f32 v[40:41], v[140:141], v[108:109], v[40:41] op_sel_hi:[1,0,1] neg_lo:[0,1,0] neg_hi:[0,1,0]
    v_pk_fma_f32 v[42:43], v[142:143], v[108:109], v[42:43] op_sel_hi:[1,0,1] neg_lo:[0,1,0] neg_hi:[0,1,0]
    v_pk_fma_f32 v[44:45], v[144:145], v[108:109], v[44:45] op_sel_hi:[1,0,1] neg_lo:[0,1,0] neg_hi:[0,1,0]
    v_pk_fma_f32 v[46:47], v[146:147], v[108:109], v[46:47] op_sel_hi:[1,0,1] neg_lo:[0,1,0] neg_hi:[0,1,0]
    v_pk_mul_f32 v[32:33], v[32:33], v[104:105] op_sel_hi:[1,0]
    v_pk_mul_f32 v[34:35], v[34:35], v[104:105] op_sel_hi:[1,0]
    v_pk_mul_f32 v[36:37], v[36:37], v[104:105] op_sel_hi:[1,0]
    v_pk_mul_f32 v[38:39], v[38:39], v[104:105] op_sel_hi:[1,0]
    v_pk_mul_f32 v[40:41], v[40:41], v[104:105] op_sel_hi:[1,0]
    v_pk_mul_f32 v[42:43], v[42:43], v[104:105] op_sel_hi:[1,0]
    v_pk_mul_f32 v[44:45], v[44:45], v[104:105] op_sel_hi:[1,0]
    v_pk_mul_f32 v[46:47], v[46:47], v[104:105] op_sel_hi:[1,0]
    v_cvt_pk_bf16_f32 v32, v32, v33
    v_cvt_pk_bf16_f32 v33, v34, v35
    v_cvt_pk_bf16_f32 v34, v36, v37
    v_cvt_pk_bf16_f32 v35, v38, v39
    v_cvt_pk_bf16_f32 v36, v40, v41
    v_cvt_pk_bf16_f32 v37, v42, v43
    v_cvt_pk_bf16_f32 v38, v44, v45
    v_cvt_pk_bf16_f32 v39, v46, v47
    buffer_store_dwordx4 v[32:35], v96, s[20:23], s32 offen offset:0
    buffer_store_dwordx4 v[36:39], v96, s[20:23], s32 offen offset:1024
    v_pk_fma_f32 v[48:49], v[132:133], v[110:111], v[48:49] op_sel_hi:[1,0,1] neg_lo:[0,1,0] neg_hi:[0,1,0]
    v_pk_fma_f32 v[50:51], v[134:135], v[110:111], v[50:51] op_sel_hi:[1,0,1] neg_lo:[0,1,0] neg_hi:[0,1,0]
    v_pk_fma_f32 v[52:53], v[136:137], v[110:111], v[52:53] op_sel_hi:[1,0,1] neg_lo:[0,1,0] neg_hi:[0,1,0]
    v_pk_fma_f32 v[54:55], v[138:139], v[110:111], v[54:55] op_sel_hi:[1,0,1] neg_lo:[0,1,0] neg_hi:[0,1,0]
    v_pk_fma_f32 v[56:57], v[140:141], v[110:111], v[56:57] op_sel_hi:[1,0,1] neg_lo:[0,1,0] neg_hi:[0,1,0]
    v_pk_fma_f32 v[58:59], v[142:143], v[110:111], v[58:59] op_sel_hi:[1,0,1] neg_lo:[0,1,0] neg_hi:[0,1,0]
    v_pk_fma_f32 v[60:61], v[144:145], v[110:111], v[60:61] op_sel_hi:[1,0,1] neg_lo:[0,1,0] neg_hi:[0,1,0]
    v_pk_fma_f32 v[62:63], v[146:147], v[110:111], v[62:63] op_sel_hi:[1,0,1] neg_lo:[0,1,0] neg_hi:[0,1,0]
    v_pk_mul_f32 v[48:49], v[48:49], v[106:107] op_sel_hi:[1,0]
    v_pk_mul_f32 v[50:51], v[50:51], v[106:107] op_sel_hi:[1,0]
    v_pk_mul_f32 v[52:53], v[52:53], v[106:107] op_sel_hi:[1,0]
    v_pk_mul_f32 v[54:55], v[54:55], v[106:107] op_sel_hi:[1,0]
    v_pk_mul_f32 v[56:57], v[56:57], v[106:107] op_sel_hi:[1,0]
    v_pk_mul_f32 v[58:59], v[58:59], v[106:107] op_sel_hi:[1,0]
    v_pk_mul_f32 v[60:61], v[60:61], v[106:107] op_sel_hi:[1,0]
    v_pk_mul_f32 v[62:63], v[62:63], v[106:107] op_sel_hi:[1,0]
    v_cvt_pk_bf16_f32 v48, v48, v49
    v_cvt_pk_bf16_f32 v49, v50, v51
    v_cvt_pk_bf16_f32 v50, v52, v53
    v_cvt_pk_bf16_f32 v51, v54, v55
    v_cvt_pk_bf16_f32 v52, v56, v57
    v_cvt_pk_bf16_f32 v53, v58, v59
    v_cvt_pk_bf16_f32 v54, v60, v61
    v_cvt_pk_bf16_f32 v55, v62, v63
    buffer_store_dwordx4 v[48:51], v96, s[20:23], s33 offen offset:0
    buffer_store_dwordx4 v[52:55], v96, s[20:23], s33 offen offset:1024
    s_waitcnt lgkmcnt(0)
    v_pk_fma_f32 v[64:65], v[180:181], v[112:113], v[64:65] op_sel_hi:[1,0,1] neg_lo:[0,1,0] neg_hi:[0,1,0]
    v_pk_fma_f32 v[66:67], v[182:183], v[112:113], v[66:67] op_sel_hi:[1,0,1] neg_lo:[0,1,0] neg_hi:[0,1,0]
    v_pk_fma_f32 v[68:69], v[184:185], v[112:113], v[68:69] op_sel_hi:[1,0,1] neg_lo:[0,1,0] neg_hi:[0,1,0]
    v_pk_fma_f32 v[70:71], v[186:187], v[112:113], v[70:71] op_sel_hi:[1,0,1] neg_lo:[0,1,0] neg_hi:[0,1,0]
    v_pk_fma_f32 v[72:73], v[188:189], v[112:113], v[72:73] op_sel_hi:[1,0,1] neg_lo:[0,1,0] neg_hi:[0,1,0]
    v_pk_fma_f32 v[74:75], v[190:191], v[112:113], v[74:75] op_sel_hi:[1,0,1] neg_lo:[0,1,0] neg_hi:[0,1,0]
    v_pk_fma_f32 v[76:77], v[192:193], v[112:113], v[76:77] op_sel_hi:[1,0,1] neg_lo:[0,1,0] neg_hi:[0,1,0]
    v_pk_fma_f32 v[78:79], v[194:195], v[112:113], v[78:79] op_sel_hi:[1,0,1] neg_lo:[0,1,0] neg_hi:[0,1,0]
    v_pk_mul_f32 v[64:65], v[64:65], v[148:149]
    v_pk_mul_f32 v[66:67], v[66:67], v[150:151]
    v_pk_mul_f32 v[68:69], v[68:69], v[152:153]
    v_pk_mul_f32 v[70:71], v[70:71], v[154:155]
    v_pk_mul_f32 v[72:73], v[72:73], v[156:157]
    v_pk_mul_f32 v[74:75], v[74:75], v[158:159]
    v_pk_mul_f32 v[76:77], v[76:77], v[160:161]
    v_pk_mul_f32 v[78:79], v[78:79], v[162:163]
    v_cvt_pk_bf16_f32 v64, v64, v65
    v_cvt_pk_bf16_f32 v65, v66, v67
    v_cvt_pk_bf16_f32 v66, v68, v69
    v_cvt_pk_bf16_f32 v67, v70, v71
    v_cvt_pk_bf16_f32 v68, v72, v73
    v_cvt_pk_bf16_f32 v69, v74, v75
    v_cvt_pk_bf16_f32 v70, v76, v77
    v_cvt_pk_bf16_f32 v71, v78, v79
    buffer_store_dwordx4 v[64:67], v96, s[20:23], s32 offen offset:2048
    buffer_store_dwordx4 v[68:71], v96, s[20:23], s32 offen offset:3072
    v_pk_fma_f32 v[80:81], v[196:197], v[112:113], v[80:81] op_sel_hi:[1,0,1] neg_lo:[0,1,0] neg_hi:[0,1,0]
    v_pk_fma_f32 v[82:83], v[198:199], v[112:113], v[82:83] op_sel_hi:[1,0,1] neg_lo:[0,1,0] neg_hi:[0,1,0]
    v_pk_fma_f32 v[84:85], v[200:201], v[112:113], v[84:85] op_sel_hi:[1,0,1] neg_lo:[0,1,0] neg_hi:[0,1,0]
    v_pk_fma_f32 v[86:87], v[202:203], v[112:113], v[86:87] op_sel_hi:[1,0,1] neg_lo:[0,1,0] neg_hi:[0,1,0]
    v_pk_fma_f32 v[88:89], v[204:205], v[112:113], v[88:89] op_sel_hi:[1,0,1] neg_lo:[0,1,0] neg_hi:[0,1,0]
    v_pk_fma_f32 v[90:91], v[206:207], v[112:113], v[90:91] op_sel_hi:[1,0,1] neg_lo:[0,1,0] neg_hi:[0,1,0]
    v_pk_fma_f32 v[92:93], v[208:209], v[112:113], v[92:93] op_sel_hi:[1,0,1] neg_lo:[0,1,0] neg_hi:[0,1,0]
    v_pk_fma_f32 v[94:95], v[210:211], v[112:113], v[94:95] op_sel_hi:[1,0,1] neg_lo:[0,1,0] neg_hi:[0,1,0]
    v_pk_mul_f32 v[80:81], v[80:81], v[164:165]
    v_pk_mul_f32 v[82:83], v[82:83], v[166:167]
    v_pk_mul_f32 v[84:85], v[84:85], v[168:169]
    v_pk_mul_f32 v[86:87], v[86:87], v[170:171]
    v_pk_mul_f32 v[88:89], v[88:89], v[172:173]
    v_pk_mul_f32 v[90:91], v[90:91], v[174:175]
    v_pk_mul_f32 v[92:93], v[92:93], v[176:177]
    v_pk_mul_f32 v[94:95], v[94:95], v[178:179]
    v_cvt_pk_bf16_f32 v80, v80, v81
    v_cvt_pk_bf16_f32 v81, v82, v83
    v_cvt_pk_bf16_f32 v82, v84, v85
    v_cvt_pk_bf16_f32 v83, v86, v87
    v_cvt_pk_bf16_f32 v84, v88, v89
    v_cvt_pk_bf16_f32 v85, v90, v91
    v_cvt_pk_bf16_f32 v86, v92, v93
    v_cvt_pk_bf16_f32 v87, v94, v95
    buffer_store_dwordx4 v[80:83], v96, s[20:23], s33 offen offset:2048
    buffer_store_dwordx4 v[84:87], v96, s[20:23], s33 offen offset:3072
qkv1_kernel_end:
    s_endpgm
.globl attn1_kernel
.p2align 8
.type attn1_kernel,@function
attn1_kernel:
    s_cmp_ge_u32 s2, 256
    s_cbranch_scc1 attn1_kernel_end
    s_load_dwordx2 s[8:9], s[0:1], 80
    v_lshrrev_b32 v1, 6, v0
    v_and_b32 v2, 63, v0
    v_readfirstlane_b32 s3, v1
    s_and_b32 s24, s2, 7
    s_lshr_b32 s25, s2, 3
    s_lshr_b32 s26, s24, 2
    s_lshl_b32 s26, s26, 3
    s_and_b32 s27, s25, 7
    s_add_u32 s26, s26, s27
    s_and_b32 s27, s24, 3
    s_lshl_b32 s27, s27, 2
    s_lshr_b32 s25, s25, 3
    s_add_u32 s27, s27, s25
    s_lshr_b32 s28, s3, 2
    s_and_b32 s29, s3, 3
    s_lshl_b32 s30, s27, 1
    s_add_u32 s30, s30, s28
    s_lshl_b32 s31, s26, 2
    s_add_u32 s37, s31, s29
    v_lshlrev_b32 v3, 4, v2
    s_waitcnt lgkmcnt(0)
    s_mov_b32 s20, s8
    s_mov_b32 s21, s9
    s_mov_b32 s22, 0x8000000
    s_mov_b32 s23, 0x20000
    s_lshl_b32 s32, s30, 6
    s_add_u32 s33, s32, s37
    s_lshl_b32 s33, s33, 11
    s_add_u32 s33, s33, 0x2000000
    buffer_load_dwordx4 v[4:7], v3, s[20:23], s33 offen
    buffer_load_dwordx4 v[8:11], v3, s[20:23], s33 offen offset:1024
    s_mul_i32 s34, s29, 3
    s_mul_i32 s35, s28, 12
    s_add_u32 s35, s35, s34
    s_lshl_b32 s35, s35, 12
    s_add_u32 s34, s34, s31
    s_sub_u32 s34, s34, 8
    s_max_i32 s36, s34, 0
    s_add_u32 s36, s36, s32
    s_lshl_b32 s36, s36, 12
    s_add_u32 s36, s36, 0x2400000
    s_mov_b32 m0, s35
    s_add_u32 s34, s34, 1
    buffer_load_dwordx4 v3, s[20:23], s36 offen offset:0 lds
    buffer_load_dwordx4 v3, s[20:23], s36 offen offset:1024 lds
    buffer_load_dwordx4 v3, s[20:23], s36 offen offset:2048 lds
    buffer_load_dwordx4 v3, s[20:23], s36 offen offset:3072 lds
    s_add_u32 s35, s35, 4096
    s_max_i32 s36, s34, 0
    s_add_u32 s36, s36, s32
    s_lshl_b32 s36, s36, 12
    s_add_u32 s36, s36, 0x2400000
    s_mov_b32 m0, s35
    s_add_u32 s34, s34, 1
    buffer_load_dwordx4 v3, s[20:23], s36 offen offset:0 lds
    buffer_load_dwordx4 v3, s[20:23], s36 offen offset:1024 lds
    buffer_load_dwordx4 v3, s[20:23], s36 offen offset:2048 lds
    buffer_load_dwordx4 v3, s[20:23], s36 offen offset:3072 lds
    s_add_u32 s35, s35, 4096
    s_max_i32 s36, s34, 0
    s_add_u32 s36, s36, s32
    s_lshl_b32 s36, s36, 12
    s_add_u32 s36, s36, 0x2400000
    s_mov_b32 m0, s35
    s_add_u32 s34, s34, 1
    buffer_load_dwordx4 v3, s[20:23], s36 offen offset:0 lds
    buffer_load_dwordx4 v3, s[20:23], s36 offen offset:1024 lds
    buffer_load_dwordx4 v3, s[20:23], s36 offen offset:2048 lds
    buffer_load_dwordx4 v3, s[20:23], s36 offen offset:3072 lds
    s_add_u32 s35, s35, 4096
    s_mov_b32 s40, 0xffffffff
    s_mov_b32 s41, 0xfffffff0
    s_mov_b32 s42, 0xfffffffe
    s_mov_b32 s43, 0xffffffe0
    s_mov_b32 s44, 0xfffffffc
    s_mov_b32 s45, 0xffffffc0
    s_mov_b32 s46, 0xfffffff8
    s_mov_b32 s47, 0xffffff80
    s_mov_b32 s48, 0xffffff00
    s_mov_b32 s49, 0xfffff000
    s_mov_b32 s50, 0xfffffe00
    s_mov_b32 s51, 0xffffe000
    s_mov_b32 s52, 0xfffffc00
    s_mov_b32 s53, 0xffffc000
    s_mov_b32 s54, 0xfffff800
    s_mov_b32 s55, 0xffff8000
    s_mov_b32 s56, 0xffff0000
    s_mov_b32 s57, 0xfff00000
    s_mov_b32 s58, 0xfffe0000
    s_mov_b32 s59, 0xffe00000
    s_mov_b32 s60, 0xfffc0000
    s_mov_b32 s61, 0xffc00000
    s_mov_b32 s62, 0xfff80000
    s_mov_b32 s63, 0xff800000
    s_mov_b32 s64, 0xff000000
    s_mov_b32 s65, 0xf0000000
    s_mov_b32 s66, 0xfe000000
    s_mov_b32 s67, 0xe0000000
    s_mov_b32 s68, 0xfc000000
    s_mov_b32 s69, 0xc0000000
    s_mov_b32 s70, 0xf8000000
    s_mov_b32 s71, 0x80000000
    v_mov_b32 v20, 0xffff
    v_mov_b32 v21, 0xffff0000
    v_cndmask_b32 v22, 0, v20, s[40:41]
    v_cndmask_b32 v23, 0, v21, s[42:43]
    v_or_b32 v12, v22, v23
    v_cndmask_b32 v22, 0, v20, s[44:45]
    v_cndmask_b32 v23, 0, v21, s[46:47]
    v_or_b32 v13, v22, v23
    v_cndmask_b32 v22, 0, v20, s[48:49]
    v_cndmask_b32 v23, 0, v21, s[50:51]
    v_or_b32 v14, v22, v23
    v_cndmask_b32 v22, 0, v20, s[52:53]
    v_cndmask_b32 v23, 0, v21, s[54:55]
    v_or_b32 v15, v22, v23
    v_cndmask_b32 v22, 0, v20, s[56:57]
    v_cndmask_b32 v23, 0, v21, s[58:59]
    v_or_b32 v16, v22, v23
    v_cndmask_b32 v22, 0, v20, s[60:61]
    v_cndmask_b32 v23, 0, v21, s[62:63]
    v_or_b32 v17, v22, v23
    v_cndmask_b32 v22, 0, v20, s[64:65]
    v_cndmask_b32 v23, 0, v21, s[66:67]
    v_or_b32 v18, v22, v23
    v_cndmask_b32 v22, 0, v20, s[68:69]
    v_cndmask_b32 v23, 0, v21, s[70:71]
    v_or_b32 v19, v22, v23
    s_mul_i32 s34, s28, 12
    s_add_u32 s34, s34, s29
    s_lshl_b32 s34, s34, 12
    v_add_u32 v20, s34, v3
    v_mov_b32 v24, 0
    v_mov_b32 v25, 0
    v_mov_b32 v26, 0
    v_mov_b32 v27, 0
    v_mov_b32 v28, 0
    v_mov_b32 v29, 0
    v_mov_b32 v30, 0
    v_mov_b32 v31, 0
    v_mov_b32 v32, 0
    v_mov_b32 v33, 0
    v_mov_b32 v34, 0
    v_mov_b32 v35, 0
    v_mov_b32 v36, 0
    v_mov_b32 v37, 0
    v_mov_b32 v38, 0
    v_mov_b32 v39, 0
    s_waitcnt vmcnt(0)
    s_barrier
    ds_read_b128 v[104:107], v20 offset:32768
    ds_read_b128 v[108:111], v20 offset:33792
    ds_read_b128 v[112:115], v20 offset:28672
    ds_read_b128 v[116:119], v20 offset:29696
    s_waitcnt lgkmcnt(2)
    v_mfma_f32_32x32x16_bf16 v[40:55], v[104:107], v[4:7], 0
    v_mfma_f32_32x32x16_bf16 v[40:55], v[108:111], v[8:11], v[40:55]
    ds_read_b128 v[104:107], v20 offset:24576
    ds_read_b128 v[108:111], v20 offset:25600
    s_cmp_eq_u32 s37, 0
    s_cbranch_scc0 attn1_kernel_a1
    v_mov_b32 v24, 0xf149f2ca
    v_mov_b32 v25, 0xf149f2ca
    v_mov_b32 v26, 0xf149f2ca
    v_mov_b32 v27, 0xf149f2ca
    v_mov_b32 v28, 0xf149f2ca
    v_mov_b32 v29, 0xf149f2ca
    v_mov_b32 v30, 0xf149f2ca
    v_mov_b32 v31, 0xf149f2ca
    v_mov_b32 v32, 0xf149f2ca
    v_mov_b32 v33, 0xf149f2ca
    v_mov_b32 v34, 0xf149f2ca
    v_mov_b32 v35, 0xf149f2ca
    v_mov_b32 v36, 0xf149f2ca
    v_mov_b32 v37, 0xf149f2ca
    v_mov_b32 v38, 0xf149f2ca
    v_mov_b32 v39, 0xf149f2ca
attn1_kernel_a1:
    s_waitcnt lgkmcnt(2)
    s_nop 0
    v_mfma_f32_32x32x16_bf16 v[72:87], v[112:115], v[4:7], v[24:39]
    v_mfma_f32_32x32x16_bf16 v[72:87], v[116:119], v[8:11], v[72:87]
    ds_read_b128 v[112:115], v20 offset:20480
    ds_read_b128 v[116:119], v20 offset:21504
    s_cmp_eq_u32 s37, 1
    s_cbranch_scc0 attn1_kernel_a2
    s_nop 1
    v_mov_b32 v24, 0xf149f2ca
    v_mov_b32 v25, 0xf149f2ca
    v_mov_b32 v26, 0xf149f2ca
    v_mov_b32 v27, 0xf149f2ca
    v_mov_b32 v28, 0xf149f2ca
    v_mov_b32 v29, 0xf149f2ca
    v_mov_b32 v30, 0xf149f2ca
    v_mov_b32 v31, 0xf149f2ca
    v_mov_b32 v32, 0xf149f2ca
    v_mov_b32 v33, 0xf149f2ca
    v_mov_b32 v34, 0xf149f2ca
    v_mov_b32 v35, 0xf149f2ca
    v_mov_b32 v36, 0xf149f2ca
    v_mov_b32 v37, 0xf149f2ca
    v_mov_b32 v38, 0xf149f2ca
    v_mov_b32 v39, 0xf149f2ca
attn1_kernel_a2:
    s_waitcnt lgkmcnt(2)
    s_nop 0
    v_mfma_f32_32x32x16_bf16 v[56:71], v[104:107], v[4:7], v[24:39]
    v_mfma_f32_32x32x16_bf16 v[56:71], v[108:111], v[8:11], v[56:71]
    s_nop 3
    v_max_f32 v21, v72, v73
    v_max3_f32 v21, v21, v74, v75
    v_max3_f32 v21, v21, v76, v77
    v_max3_f32 v21, v21, v78, v79
    v_max3_f32 v21, v21, v80, v81
    v_max3_f32 v21, v21, v82, v83
    v_max3_f32 v21, v21, v84, v85
    v_max3_f32 v21, v21, v86, v87
    ds_read_b128 v[104:107], v20 offset:16384
    ds_read_b128 v[108:111], v20 offset:17408
    s_cmp_eq_u32 s37, 2
    s_cbranch_scc0 attn1_kernel_a3
    v_mov_b32 v24, 0xf149f2ca
    v_mov_b32 v25, 0xf149f2ca
    v_mov_b32 v26, 0xf149f2ca
    v_mov_b32 v27, 0xf149f2ca
    v_mov_b32 v28, 0xf149f2ca
    v_mov_b32 v29, 0xf149f2ca
    v_mov_b32 v30, 0xf149f2ca
    v_mov_b32 v31, 0xf149f2ca
    v_mov_b32 v32, 0xf149f2ca
    v_mov_b32 v33, 0xf149f2ca
    v_mov_b32 v34, 0xf149f2ca
    v_mov_b32 v35, 0xf149f2ca
    v_mov_b32 v36, 0xf149f2ca
    v_mov_b32 v37, 0xf149f2ca
    v_mov_b32 v38, 0xf149f2ca
    v_mov_b32 v39, 0xf149f2ca
attn1_kernel_a3:
    s_waitcnt lgkmcnt(2)
    s_nop 0
    v_mfma_f32_32x32x16_bf16 v[72:87], v[112:115], v[4:7], v[24:39]
    v_mfma_f32_32x32x16_bf16 v[72:87], v[116:119], v[8:11], v[72:87]
    v_max3_f32 v21, v21, v56, v57
    v_max3_f32 v21, v21, v58, v59
    v_max3_f32 v21, v21, v60, v61
    v_max3_f32 v21, v21, v62, v63
    v_max3_f32 v21, v21, v64, v65
    v_max3_f32 v21, v21, v66, v67
    v_max3_f32 v21, v21, v68, v69
    v_max3_f32 v21, v21, v70, v71
    ds_read_b128 v[112:115], v20 offset:12288
    ds_read_b128 v[116:119], v20 offset:13312
    s_cmp_eq_u32 s37, 3
    s_cbranch_scc0 attn1_kernel_a4
    v_mov_b32 v24, 0xf149f2ca
    v_mov_b32 v25, 0xf149f2ca
    v_mov_b32 v26, 0xf149f2ca
    v_mov_b32 v27, 0xf149f2ca
    v_mov_b32 v28, 0xf149f2ca
    v_mov_b32 v29, 0xf149f2ca
    v_mov_b32 v30, 0xf149f2ca
    v_mov_b32 v31, 0xf149f2ca
    v_mov_b32 v32, 0xf149f2ca
    v_mov_b32 v33, 0xf149f2ca
    v_mov_b32 v34, 0xf149f2ca
    v_mov_b32 v35, 0xf149f2ca
    v_mov_b32 v36, 0xf149f2ca
    v_mov_b32 v37, 0xf149f2ca
    v_mov_b32 v38, 0xf149f2ca
    v_mov_b32 v39, 0xf149f2ca
attn1_kernel_a4:
    s_waitcnt lgkmcnt(2)
    s_nop 0
    v_mfma_f32_32x32x16_bf16 v[56:71], v[104:107], v[4:7], v[24:39]
    v_mfma_f32_32x32x16_bf16 v[56:71], v[108:111], v[8:11], v[56:71]
    v_max3_f32 v21, v21, v72, v73
    v_max3_f32 v21, v21, v74, v75
    v_max3_f32 v21, v21, v76, v77
    v_max3_f32 v21, v21, v78, v79
    v_max3_f32 v21, v21, v80, v81
    v_max3_f32 v21, v21, v82, v83
    v_max3_f32 v21, v21, v84, v85
    v_max3_f32 v21, v21, v86, v87
    ds_read_b128 v[104:107], v20 offset:8192
    ds_read_b128 v[108:111], v20 offset:9216
    s_cmp_eq_u32 s37, 4
    s_cbranch_scc0 attn1_kernel_a5
    v_mov_b32 v24, 0xf149f2ca
    v_mov_b32 v25, 0xf149f2ca
    v_mov_b32 v26, 0xf149f2ca
    v_mov_b32 v27, 0xf149f2ca
    v_mov_b32 v28, 0xf149f2ca
    v_mov_b32 v29, 0xf149f2ca
    v_mov_b32 v30, 0xf149f2ca
    v_mov_b32 v31, 0xf149f2ca
    v_mov_b32 v32, 0xf149f2ca
    v_mov_b32 v33, 0xf149f2ca
    v_mov_b32 v34, 0xf149f2ca
    v_mov_b32 v35, 0xf149f2ca
    v_mov_b32 v36, 0xf149f2ca
    v_mov_b32 v37, 0xf149f2ca
    v_mov_b32 v38, 0xf149f2ca
    v_mov_b32 v39, 0xf149f2ca
attn1_kernel_a5:
    s_waitcnt lgkmcnt(2)
    s_nop 0
    v_mfma_f32_32x32x16_bf16 v[72:87], v[112:115], v[4:7], v[24:39]
    v_mfma_f32_32x32x16_bf16 v[72:87], v[116:119], v[8:11], v[72:87]
    v_max3_f32 v21, v21, v56, v57
    v_max3_f32 v21, v21, v58, v59
    v_max3_f32 v21, v21, v60, v61
    v_max3_f32 v21, v21, v62, v63
    v_max3_f32 v21, v21, v64, v65
    v_max3_f32 v21, v21, v66, v67
    v_max3_f32 v21, v21, v68, v69
    v_max3_f32 v21, v21, v70, v71
    ds_read_b128 v[112:115], v20 offset:4096
    ds_read_b128 v[116:119], v20 offset:5120
    s_cmp_eq_u32 s37, 5
    s_cbranch_scc0 attn1_kernel_a6
    v_mov_b32 v24, 0xf149f2ca
    v_mov_b32 v25, 0xf149f2ca
    v_mov_b32 v26, 0xf149f2ca
    v_mov_b32 v27, 0xf149f2ca
    v_mov_b32 v28, 0xf149f2ca
    v_mov_b32 v29, 0xf149f2ca
    v_mov_b32 v30, 0xf149f2ca
    v_mov_b32 v31, 0xf149f2ca
    v_mov_b32 v32, 0xf149f2ca
    v_mov_b32 v33, 0xf149f2ca
    v_mov_b32 v34, 0xf149f2ca
    v_mov_b32 v35, 0xf149f2ca
    v_mov_b32 v36, 0xf149f2ca
    v_mov_b32 v37, 0xf149f2ca
    v_mov_b32 v38, 0xf149f2ca
    v_mov_b32 v39, 0xf149f2ca
attn1_kernel_a6:
    s_waitcnt lgkmcnt(2)
    s_nop 0
    v_mfma_f32_32x32x16_bf16 v[56:71], v[104:107], v[4:7], v[24:39]
    v_mfma_f32_32x32x16_bf16 v[56:71], v[108:111], v[8:11], v[56:71]
    v_max3_f32 v21, v21, v72, v73
    v_max3_f32 v21, v21, v74, v75
    v_max3_f32 v21, v21, v76, v77
    v_max3_f32 v21, v21, v78, v79
    v_max3_f32 v21, v21, v80, v81
    v_max3_f32 v21, v21, v82, v83
    v_max3_f32 v21, v21, v84, v85
    v_max3_f32 v21, v21, v86, v87
    ds_read_b128 v[104:107], v20 offset:0
    ds_read_b128 v[108:111], v20 offset:1024
    s_cmp_eq_u32 s37, 6
    s_cbranch_scc0 attn1_kernel_a7
    v_mov_b32 v24, 0xf149f2ca
    v_mov_b32 v25, 0xf149f2ca
    v_mov_b32 v26, 0xf149f2ca
    v_mov_b32 v27, 0xf149f2ca
    v_mov_b32 v28, 0xf149f2ca
    v_mov_b32 v29, 0xf149f2ca
    v_mov_b32 v30, 0xf149f2ca
    v_mov_b32 v31, 0xf149f2ca
    v_mov_b32 v32, 0xf149f2ca
    v_mov_b32 v33, 0xf149f2ca
    v_mov_b32 v34, 0xf149f2ca
    v_mov_b32 v35, 0xf149f2ca
    v_mov_b32 v36, 0xf149f2ca
    v_mov_b32 v37, 0xf149f2ca
    v_mov_b32 v38, 0xf149f2ca
    v_mov_b32 v39, 0xf149f2ca
attn1_kernel_a7:
    s_waitcnt lgkmcnt(2)
    s_nop 0
    v_mfma_f32_32x32x16_bf16 v[72:87], v[112:115], v[4:7], v[24:39]
    v_mfma_f32_32x32x16_bf16 v[72:87], v[116:119], v[8:11], v[72:87]
    v_max3_f32 v21, v21, v56, v57
    v_max3_f32 v21, v21, v58, v59
    v_max3_f32 v21, v21, v60, v61
    v_max3_f32 v21, v21, v62, v63
    v_max3_f32 v21, v21, v64, v65
    v_max3_f32 v21, v21, v66, v67
    v_max3_f32 v21, v21, v68, v69
    v_max3_f32 v21, v21, v70, v71
    s_cmp_eq_u32 s37, 7
    s_cbranch_scc0 attn1_kernel_a8
    v_mov_b32 v24, 0xf149f2ca
    v_mov_b32 v25, 0xf149f2ca
    v_mov_b32 v26, 0xf149f2ca
    v_mov_b32 v27, 0xf149f2ca
    v_mov_b32 v28, 0xf149f2ca
    v_mov_b32 v29, 0xf149f2ca
    v_mov_b32 v30, 0xf149f2ca
    v_mov_b32 v31, 0xf149f2ca
    v_mov_b32 v32, 0xf149f2ca
    v_mov_b32 v33, 0xf149f2ca
    v_mov_b32 v34, 0xf149f2ca
    v_mov_b32 v35, 0xf149f2ca
    v_mov_b32 v36, 0xf149f2ca
    v_mov_b32 v37, 0xf149f2ca
    v_mov_b32 v38, 0xf149f2ca
    v_mov_b32 v39, 0xf149f2ca
attn1_kernel_a8:
    s_waitcnt lgkmcnt(0)
    s_nop 0
    v_mfma_f32_32x32x16_bf16 v[56:71], v[104:107], v[4:7], v[24:39]
    v_mfma_f32_32x32x16_bf16 v[56:71], v[108:111], v[8:11], v[56:71]
    v_max3_f32 v21, v21, v72, v73
    v_max3_f32 v21, v21, v74, v75
    v_max3_f32 v21, v21, v76, v77
    v_max3_f32 v21, v21, v78, v79
    v_max3_f32 v21, v21, v80, v81
    v_max3_f32 v21, v21, v82, v83
    v_max3_f32 v21, v21, v84, v85
    v_max3_f32 v21, v21, v86, v87
    ds_read_b128 v[112:115], v20 offset:28672
    ds_read_b128 v[116:119], v20 offset:29696
    ds_read_b128 v[120:123], v20 offset:34816
    ds_read_b128 v[124:127], v20 offset:35840
    ds_read_b128 v[128:131], v20 offset:2048
    ds_read_b128 v[132:135], v20 offset:3072
    v_cndmask_b32 v40, v56, v40, s[40:41]
    v_cndmask_b32 v41, v57, v41, s[42:43]
    v_cndmask_b32 v42, v58, v42, s[44:45]
    v_cndmask_b32 v43, v59, v43, s[46:47]
    v_cndmask_b32 v44, v60, v44, s[48:49]
    v_cndmask_b32 v45, v61, v45, s[50:51]
    v_cndmask_b32 v46, v62, v46, s[52:53]
    v_cndmask_b32 v47, v63, v47, s[54:55]
    v_cndmask_b32 v48, v64, v48, s[56:57]
    v_cndmask_b32 v49, v65, v49, s[58:59]
    v_cndmask_b32 v50, v66, v50, s[60:61]
    v_cndmask_b32 v51, v67, v51, s[62:63]
    v_cndmask_b32 v52, v68, v52, s[64:65]
    v_cndmask_b32 v53, v69, v53, s[66:67]
    v_cndmask_b32 v54, v70, v54, s[68:69]
    v_cndmask_b32 v55, v71, v55, s[70:71]
    v_max3_f32 v21, v21, v40, v41
    v_max3_f32 v21, v21, v42, v43
    v_max3_f32 v21, v21, v44, v45
    v_max3_f32 v21, v21, v46, v47
    v_max3_f32 v21, v21, v48, v49
    v_max3_f32 v21, v21, v50, v51
    v_max3_f32 v21, v21, v52, v53
    v_max3_f32 v21, v21, v54, v55
    v_mov_b32 v152, v21
    s_nop 1
    v_permlane32_swap_b32 v21, v152
    v_max_f32 v21, v21, v152
    v_sub_f32 v24, 0, v21
    v_sub_f32 v25, 0, v21
    v_sub_f32 v26, 0, v21
    v_sub_f32 v27, 0, v21
    v_sub_f32 v28, 0, v21
    v_sub_f32 v29, 0, v21
    v_sub_f32 v30, 0, v21
    v_sub_f32 v31, 0, v21
    v_sub_f32 v32, 0, v21
    v_sub_f32 v33, 0, v21
    v_sub_f32 v34, 0, v21
    v_sub_f32 v35, 0, v21
    v_sub_f32 v36, 0, v21
    v_sub_f32 v37, 0, v21
    v_sub_f32 v38, 0, v21
    v_sub_f32 v39, 0, v21
    s_cmp_eq_u32 s37, 0
    s_cbranch_scc0 attn1_kernel_b1
    v_mov_b32 v24, 0xf149f2ca
    v_mov_b32 v25, 0xf149f2ca
    v_mov_b32 v26, 0xf149f2ca
    v_mov_b32 v27, 0xf149f2ca
    v_mov_b32 v28, 0xf149f2ca
    v_mov_b32 v29, 0xf149f2ca
    v_mov_b32 v30, 0xf149f2ca
    v_mov_b32 v31, 0xf149f2ca
    v_mov_b32 v32, 0xf149f2ca
    v_mov_b32 v33, 0xf149f2ca
    v_mov_b32 v34, 0xf149f2ca
    v_mov_b32 v35, 0xf149f2ca
    v_mov_b32 v36, 0xf149f2ca
    v_mov_b32 v37, 0xf149f2ca
    v_mov_b32 v38, 0xf149f2ca
    v_mov_b32 v39, 0xf149f2ca
attn1_kernel_b1:
    s_waitcnt lgkmcnt(4)
    s_nop 0
    v_mfma_f32_32x32x16_bf16 v[72:87], v[112:115], v[4:7], v[24:39]
    v_mfma_f32_32x32x16_bf16 v[72:87], v[116:119], v[8:11], v[72:87]
    ds_read_b128 v[104:107], v20 offset:24576
    ds_read_b128 v[108:111], v20 offset:25600
    v_sub_f32 v40, v40, v21
    v_sub_f32 v41, v41, v21
    v_sub_f32 v42, v42, v21
    v_sub_f32 v43, v43, v21
    v_sub_f32 v44, v44, v21
    v_sub_f32 v45, v45, v21
    v_sub_f32 v46, v46, v21
    v_sub_f32 v47, v47, v21
    v_sub_f32 v48, v48, v21
    v_sub_f32 v49, v49, v21
    v_sub_f32 v50, v50, v21
    v_sub_f32 v51, v51, v21
    v_sub_f32 v52, v52, v21
    v_sub_f32 v53, v53, v21
    v_sub_f32 v54, v54, v21
    v_sub_f32 v55, v55, v21
    v_exp_f32 v40, v40
    v_exp_f32 v41, v41
    v_exp_f32 v42, v42
    v_exp_f32 v43, v43
    v_exp_f32 v44, v44
    v_exp_f32 v45, v45
    v_exp_f32 v46, v46
    v_exp_f32 v47, v47
    v_exp_f32 v48, v48
    v_exp_f32 v49, v49
    v_exp_f32 v50, v50
    v_exp_f32 v51, v51
    v_exp_f32 v52, v52
    v_exp_f32 v53, v53
    v_exp_f32 v54, v54
    v_exp_f32 v55, v55
    v_add_f32 v22, v40, v41
    v_add_f32 v23, v42, v43
    v_add_f32 v22, v22, v44
    v_add_f32 v23, v23, v45
    v_add_f32 v22, v22, v46
    v_add_f32 v23, v23, v47
    v_add_f32 v22, v22, v48
    v_add_f32 v23, v23, v49
    v_add_f32 v22, v22, v50
    v_add_f32 v23, v23, v51
    v_add_f32 v22, v22, v52
    v_add_f32 v23, v23, v53
    v_add_f32 v22, v22, v54
    v_add_f32 v23, v23, v55
    v_cvt_pk_bf16_f32 v144, v40, v41
    v_cvt_pk_bf16_f32 v145, v42, v43
    v_cvt_pk_bf16_f32 v146, v44, v45
    v_cvt_pk_bf16_f32 v147, v46, v47
    v_cvt_pk_bf16_f32 v148, v48, v49
    v_cvt_pk_bf16_f32 v149, v50, v51
    v_cvt_pk_bf16_f32 v150, v52, v53
    v_cvt_pk_bf16_f32 v151, v54, v55
    v_and_b32 v136, v144, v12
    v_and_b32 v137, v145, v13
    v_and_b32 v138, v146, v14
    v_and_b32 v139, v147, v15
    v_and_b32 v140, v148, v16
    v_and_b32 v141, v149, v17
    v_and_b32 v142, v150, v18
    v_and_b32 v143, v151, v19
    v_xor_b32 v144, v144, v136
    v_xor_b32 v145, v145, v137
    v_xor_b32 v146, v146, v138
    v_xor_b32 v147, v147, v139
    v_xor_b32 v148, v148, v140
    v_xor_b32 v149, v149, v141
    v_xor_b32 v150, v150, v142
    v_xor_b32 v151, v151, v143
    s_waitcnt lgkmcnt(2)
    v_mfma_f32_32x32x16_bf16 v[88:103], v[120:123], v[136:139], 0
    v_mfma_f32_32x32x16_bf16 v[88:103], v[124:127], v[140:143], v[88:103]
    v_mfma_f32_32x32x16_bf16 v[88:103], v[128:131], v[144:147], v[88:103]
    v_mfma_f32_32x32x16_bf16 v[88:103], v[132:135], v[148:151], v[88:103]
    ds_read_b128 v[128:131], v20 offset:30720
    ds_read_b128 v[132:135], v20 offset:31744
    s_cmp_eq_u32 s37, 1
    s_cbranch_scc0 attn1_kernel_b2
    v_mov_b32 v24, 0xf149f2ca
    v_mov_b32 v25, 0xf149f2ca
    v_mov_b32 v26, 0xf149f2ca
    v_mov_b32 v27, 0xf149f2ca
    v_mov_b32 v28, 0xf149f2ca
    v_mov_b32 v29, 0xf149f2ca
    v_mov_b32 v30, 0xf149f2ca
    v_mov_b32 v31, 0xf149f2ca
    v_mov_b32 v32, 0xf149f2ca
    v_mov_b32 v33, 0xf149f2ca
    v_mov_b32 v34, 0xf149f2ca
    v_mov_b32 v35, 0xf149f2ca
    v_mov_b32 v36, 0xf149f2ca
    v_mov_b32 v37, 0xf149f2ca
    v_mov_b32 v38, 0xf149f2ca
    v_mov_b32 v39, 0xf149f2ca
attn1_kernel_b2:
    s_waitcnt lgkmcnt(2)
    s_nop 0
    v_mfma_f32_32x32x16_bf16 v[56:71], v[104:107], v[4:7], v[24:39]
    v_mfma_f32_32x32x16_bf16 v[56:71], v[108:111], v[8:11], v[56:71]
    ds_read_b128 v[112:115], v20 offset:20480
    ds_read_b128 v[116:119], v20 offset:21504
    v_exp_f32 v72, v72
    v_exp_f32 v73, v73
    v_exp_f32 v74, v74
    v_exp_f32 v75, v75
    v_exp_f32 v76, v76
    v_exp_f32 v77, v77
    v_exp_f32 v78, v78
    v_exp_f32 v79, v79
    v_exp_f32 v80, v80
    v_exp_f32 v81, v81
    v_exp_f32 v82, v82
    v_exp_f32 v83, v83
    v_exp_f32 v84, v84
    v_exp_f32 v85, v85
    v_exp_f32 v86, v86
    v_exp_f32 v87, v87
    v_add_f32 v22, v22, v72
    v_add_f32 v23, v23, v73
    v_add_f32 v22, v22, v74
    v_add_f32 v23, v23, v75
    v_add_f32 v22, v22, v76
    v_add_f32 v23, v23, v77
    v_add_f32 v22, v22, v78
    v_add_f32 v23, v23, v79
    v_add_f32 v22, v22, v80
    v_add_f32 v23, v23, v81
    v_add_f32 v22, v22, v82
    v_add_f32 v23, v23, v83
    v_add_f32 v22, v22, v84
    v_add_f32 v23, v23, v85
    v_add_f32 v22, v22, v86
    v_add_f32 v23, v23, v87
    v_cvt_pk_bf16_f32 v144, v72, v73
    v_cvt_pk_bf16_f32 v145, v74, v75
    v_cvt_pk_bf16_f32 v146, v76, v77
    v_cvt_pk_bf16_f32 v147, v78, v79
    v_cvt_pk_bf16_f32 v148, v80, v81
    v_cvt_pk_bf16_f32 v149, v82, v83
    v_cvt_pk_bf16_f32 v150, v84, v85
    v_cvt_pk_bf16_f32 v151, v86, v87
    s_waitcnt lgkmcnt(2)
    v_mfma_f32_32x32x16_bf16 v[88:103], v[128:131], v[144:147], v[88:103]
    v_mfma_f32_32x32x16_bf16 v[88:103], v[132:135], v[148:151], v[88:103]
    ds_read_b128 v[120:123], v20 offset:26624
    ds_read_b128 v[124:127], v20 offset:27648
    s_cmp_eq_u32 s37, 2
    s_cbranch_scc0 attn1_kernel_b3
    v_mov_b32 v24, 0xf149f2ca
    v_mov_b32 v25, 0xf149f2ca
    v_mov_b32 v26, 0xf149f2ca
    v_mov_b32 v27, 0xf149f2ca
    v_mov_b32 v28, 0xf149f2ca
    v_mov_b32 v29, 0xf149f2ca
    v_mov_b32 v30, 0xf149f2ca
    v_mov_b32 v31, 0xf149f2ca
    v_mov_b32 v32, 0xf149f2ca
    v_mov_b32 v33, 0xf149f2ca
    v_mov_b32 v34, 0xf149f2ca
    v_mov_b32 v35, 0xf149f2ca
    v_mov_b32 v36, 0xf149f2ca
    v_mov_b32 v37, 0xf149f2ca
    v_mov_b32 v38, 0xf149f2ca
    v_mov_b32 v39, 0xf149f2ca
attn1_kernel_b3:
    s_waitcnt lgkmcnt(2)
    s_nop 0
    v_mfma_f32_32x32x16_bf16 v[72:87], v[112:115], v[4:7], v[24:39]
    v_mfma_f32_32x32x16_bf16 v[72:87], v[116:119], v[8:11], v[72:87]
    ds_read_b128 v[104:107], v20 offset:16384
    ds_read_b128 v[108:111], v20 offset:17408
    v_exp_f32 v56, v56
    v_exp_f32 v57, v57
    v_exp_f32 v58, v58
    v_exp_f32 v59, v59
    v_exp_f32 v60, v60
    v_exp_f32 v61, v61
    v_exp_f32 v62, v62
    v_exp_f32 v63, v63
    v_exp_f32 v64, v64
    v_exp_f32 v65, v65
    v_exp_f32 v66, v66
    v_exp_f32 v67, v67
    v_exp_f32 v68, v68
    v_exp_f32 v69, v69
    v_exp_f32 v70, v70
    v_exp_f32 v71, v71
    v_add_f32 v22, v22, v56
    v_add_f32 v23, v23, v57
    v_add_f32 v22, v22, v58
    v_add_f32 v23, v23, v59
    v_add_f32 v22, v22, v60
    v_add_f32 v23, v23, v61
    v_add_f32 v22, v22, v62
    v_add_f32 v23, v23, v63
    v_add_f32 v22, v22, v64
    v_add_f32 v23, v23, v65
    v_add_f32 v22, v22, v66
    v_add_f32 v23, v23, v67
    v_add_f32 v22, v22, v68
    v_add_f32 v23, v23, v69
    v_add_f32 v22, v22, v70
    v_add_f32 v23, v23, v71
    v_cvt_pk_bf16_f32 v136, v56, v57
    v_cvt_pk_bf16_f32 v137, v58, v59
    v_cvt_pk_bf16_f32 v138, v60, v61
    v_cvt_pk_bf16_f32 v139, v62, v63
    v_cvt_pk_bf16_f32 v140, v64, v65
    v_cvt_pk_bf16_f32 v141, v66, v67
    v_cvt_pk_bf16_f32 v142, v68, v69
    v_cvt_pk_bf16_f32 v143, v70, v71
    s_waitcnt lgkmcnt(2)
    v_mfma_f32_32x32x16_bf16 v[88:103], v[120:123], v[136:139], v[88:103]
    v_mfma_f32_32x32x16_bf16 v[88:103], v[124:127], v[140:143], v[88:103]
    ds_read_b128 v[128:131], v20 offset:22528
    ds_read_b128 v[132:135], v20 offset:23552
    s_cmp_eq_u32 s37, 3
    s_cbranch_scc0 attn1_kernel_b4
    v_mov_b32 v24, 0xf149f2ca
    v_mov_b32 v25, 0xf149f2ca
    v_mov_b32 v26, 0xf149f2ca
    v_mov_b32 v27, 0xf149f2ca
    v_mov_b32 v28, 0xf149f2ca
    v_mov_b32 v29, 0xf149f2ca
    v_mov_b32 v30, 0xf149f2ca
    v_mov_b32 v31, 0xf149f2ca
    v_mov_b32 v32, 0xf149f2ca
    v_mov_b32 v33, 0xf149f2ca
    v_mov_b32 v34, 0xf149f2ca
    v_mov_b32 v35, 0xf149f2ca
    v_mov_b32 v36, 0xf149f2ca
    v_mov_b32 v37, 0xf149f2ca
    v_mov_b32 v38, 0xf149f2ca
    v_mov_b32 v39, 0xf149f2ca
attn1_kernel_b4:
    s_waitcnt lgkmcnt(2)
    s_nop 0
    v_mfma_f32_32x32x16_bf16 v[56:71], v[104:107], v[4:7], v[24:39]
    v_mfma_f32_32x32x16_bf16 v[56:71], v[108:111], v[8:11], v[56:71]
    ds_read_b128 v[112:115], v20 offset:12288
    ds_read_b128 v[116:119], v20 offset:13312
    v_exp_f32 v72, v72
    v_exp_f32 v73, v73
    v_exp_f32 v74, v74
    v_exp_f32 v75, v75
    v_exp_f32 v76, v76
    v_exp_f32 v77, v77
    v_exp_f32 v78, v78
    v_exp_f32 v79, v79
    v_exp_f32 v80, v80
    v_exp_f32 v81, v81
    v_exp_f32 v82, v82
    v_exp_f32 v83, v83
    v_exp_f32 v84, v84
    v_exp_f32 v85, v85
    v_exp_f32 v86, v86
    v_exp_f32 v87, v87
    v_add_f32 v22, v22, v72
    v_add_f32 v23, v23, v73
    v_add_f32 v22, v22, v74
    v_add_f32 v23, v23, v75
    v_add_f32 v22, v22, v76
    v_add_f32 v23, v23, v77
    v_add_f32 v22, v22, v78
    v_add_f32 v23, v23, v79
    v_add_f32 v22, v22, v80
    v_add_f32 v23, v23, v81
    v_add_f32 v22, v22, v82
    v_add_f32 v23, v23, v83
    v_add_f32 v22, v22, v84
    v_add_f32 v23, v23, v85
    v_add_f32 v22, v22, v86
    v_add_f32 v23, v23, v87
    v_cvt_pk_bf16_f32 v144, v72, v73
    v_cvt_pk_bf16_f32 v145, v74, v75
    v_cvt_pk_bf16_f32 v146, v76, v77
    v_cvt_pk_bf16_f32 v147, v78, v79
    v_cvt_pk_bf16_f32 v148, v80, v81
    v_cvt_pk_bf16_f32 v149, v82, v83
    v_cvt_pk_bf16_f32 v150, v84, v85
    v_cvt_pk_bf16_f32 v151, v86, v87
    s_waitcnt lgkmcnt(2)
    v_mfma_f32_32x32x16_bf16 v[88:103], v[128:131], v[144:147], v[88:103]
    v_mfma_f32_32x32x16_bf16 v[88:103], v[132:135], v[148:151], v[88:103]
    ds_read_b128 v[120:123], v20 offset:18432
    ds_read_b128 v[124:127], v20 offset:19456
    s_cmp_eq_u32 s37, 4
    s_cbranch_scc0 attn1_kernel_b5
    v_mov_b32 v24, 0xf149f2ca
    v_mov_b32 v25, 0xf149f2ca
    v_mov_b32 v26, 0xf149f2ca
    v_mov_b32 v27, 0xf149f2ca
    v_mov_b32 v28, 0xf149f2ca
    v_mov_b32 v29, 0xf149f2ca
    v_mov_b32 v30, 0xf149f2ca
    v_mov_b32 v31, 0xf149f2ca
    v_mov_b32 v32, 0xf149f2ca
    v_mov_b32 v33, 0xf149f2ca
    v_mov_b32 v34, 0xf149f2ca
    v_mov_b32 v35, 0xf149f2ca
    v_mov_b32 v36, 0xf149f2ca
    v_mov_b32 v37, 0xf149f2ca
    v_mov_b32 v38, 0xf149f2ca
    v_mov_b32 v39, 0xf149f2ca
attn1_kernel_b5:
    s_waitcnt lgkmcnt(2)
    s_nop 0
    v_mfma_f32_32x32x16_bf16 v[72:87], v[112:115], v[4:7], v[24:39]
    v_mfma_f32_32x32x16_bf16 v[72:87], v[116:119], v[8:11], v[72:87]
    ds_read_b128 v[104:107], v20 offset:8192
    ds_read_b128 v[108:111], v20 offset:9216
    v_exp_f32 v56, v56
    v_exp_f32 v57, v57
    v_exp_f32 v58, v58
    v_exp_f32 v59, v59
    v_exp_f32 v60, v60
    v_exp_f32 v61, v61
    v_exp_f32 v62, v62
    v_exp_f32 v63, v63
    v_exp_f32 v64, v64
    v_exp_f32 v65, v65
    v_exp_f32 v66, v66
    v_exp_f32 v67, v67
    v_exp_f32 v68, v68
    v_exp_f32 v69, v69
    v_exp_f32 v70, v70
    v_exp_f32 v71, v71
    v_add_f32 v22, v22, v56
    v_add_f32 v23, v23, v57
    v_add_f32 v22, v22, v58
    v_add_f32 v23, v23, v59
    v_add_f32 v22, v22, v60
    v_add_f32 v23, v23, v61
    v_add_f32 v22, v22, v62
    v_add_f32 v23, v23, v63
    v_add_f32 v22, v22, v64
    v_add_f32 v23, v23, v65
    v_add_f32 v22, v22, v66
    v_add_f32 v23, v23, v67
    v_add_f32 v22, v22, v68
    v_add_f32 v23, v23, v69
    v_add_f32 v22, v22, v70
    v_add_f32 v23, v23, v71
    v_cvt_pk_bf16_f32 v136, v56, v57
    v_cvt_pk_bf16_f32 v137, v58, v59
    v_cvt_pk_bf16_f32 v138, v60, v61
    v_cvt_pk_bf16_f32 v139, v62, v63
    v_cvt_pk_bf16_f32 v140, v64, v65
    v_cvt_pk_bf16_f32 v141, v66, v67
    v_cvt_pk_bf16_f32 v142, v68, v69
    v_cvt_pk_bf16_f32 v143, v70, v71
    s_waitcnt lgkmcnt(2)
    v_mfma_f32_32x32x16_bf16 v[88:103], v[120:123], v[136:139], v[88:103]
    v_mfma_f32_32x32x16_bf16 v[88:103], v[124:127], v[140:143], v[88:103]
    ds_read_b128 v[128:131], v20 offset:14336
    ds_read_b128 v[132:135], v20 offset:15360
    s_cmp_eq_u32 s37, 5
    s_cbranch_scc0 attn1_kernel_b6
    v_mov_b32 v24, 0xf149f2ca
    v_mov_b32 v25, 0xf149f2ca
    v_mov_b32 v26, 0xf149f2ca
    v_mov_b32 v27, 0xf149f2ca
    v_mov_b32 v28, 0xf149f2ca
    v_mov_b32 v29, 0xf149f2ca
    v_mov_b32 v30, 0xf149f2ca
    v_mov_b32 v31, 0xf149f2ca
    v_mov_b32 v32, 0xf149f2ca
    v_mov_b32 v33, 0xf149f2ca
    v_mov_b32 v34, 0xf149f2ca
    v_mov_b32 v35, 0xf149f2ca
    v_mov_b32 v36, 0xf149f2ca
    v_mov_b32 v37, 0xf149f2ca
    v_mov_b32 v38, 0xf149f2ca
    v_mov_b32 v39, 0xf149f2ca
attn1_kernel_b6:
    s_waitcnt lgkmcnt(2)
    s_nop 0
    v_mfma_f32_32x32x16_bf16 v[56:71], v[104:107], v[4:7], v[24:39]
    v_mfma_f32_32x32x16_bf16 v[56:71], v[108:111], v[8:11], v[56:71]
    ds_read_b128 v[112:115], v20 offset:4096
    ds_read_b128 v[116:119], v20 offset:5120
    v_exp_f32 v72, v72
    v_exp_f32 v73, v73
    v_exp_f32 v74, v74
    v_exp_f32 v75, v75
    v_exp_f32 v76, v76
    v_exp_f32 v77, v77
    v_exp_f32 v78, v78
    v_exp_f32 v79, v79
    v_exp_f32 v80, v80
    v_exp_f32 v81, v81
    v_exp_f32 v82, v82
    v_exp_f32 v83, v83
    v_exp_f32 v84, v84
    v_exp_f32 v85, v85
    v_exp_f32 v86, v86
    v_exp_f32 v87, v87
    v_add_f32 v22, v22, v72
    v_add_f32 v23, v23, v73
    v_add_f32 v22, v22, v74
    v_add_f32 v23, v23, v75
    v_add_f32 v22, v22, v76
    v_add_f32 v23, v23, v77
    v_add_f32 v22, v22, v78
    v_add_f32 v23, v23, v79
    v_add_f32 v22, v22, v80
    v_add_f32 v23, v23, v81
    v_add_f32 v22, v22, v82
    v_add_f32 v23, v23, v83
    v_add_f32 v22, v22, v84
    v_add_f32 v23, v23, v85
    v_add_f32 v22, v22, v86
    v_add_f32 v23, v23, v87
    v_cvt_pk_bf16_f32 v144, v72, v73
    v_cvt_pk_bf16_f32 v145, v74, v75
    v_cvt_pk_bf16_f32 v146, v76, v77
    v_cvt_pk_bf16_f32 v147, v78, v79
    v_cvt_pk_bf16_f32 v148, v80, v81
    v_cvt_pk_bf16_f32 v149, v82, v83
    v_cvt_pk_bf16_f32 v150, v84, v85
    v_cvt_pk_bf16_f32 v151, v86, v87
    s_waitcnt lgkmcnt(2)
    v_mfma_f32_32x32x16_bf16 v[88:103], v[128:131], v[144:147], v[88:103]
    v_mfma_f32_32x32x16_bf16 v[88:103], v[132:135], v[148:151], v[88:103]
    ds_read_b128 v[120:123], v20 offset:10240
    ds_read_b128 v[124:127], v20 offset:11264
    s_cmp_eq_u32 s37, 6
    s_cbranch_scc0 attn1_kernel_b7
    v_mov_b32 v24, 0xf149f2ca
    v_mov_b32 v25, 0xf149f2ca
    v_mov_b32 v26, 0xf149f2ca
    v_mov_b32 v27, 0xf149f2ca
    v_mov_b32 v28, 0xf149f2ca
    v_mov_b32 v29, 0xf149f2ca
    v_mov_b32 v30, 0xf149f2ca
    v_mov_b32 v31, 0xf149f2ca
    v_mov_b32 v32, 0xf149f2ca
    v_mov_b32 v33, 0xf149f2ca
    v_mov_b32 v34, 0xf149f2ca
    v_mov_b32 v35, 0xf149f2ca
    v_mov_b32 v36, 0xf149f2ca
    v_mov_b32 v37, 0xf149f2ca
    v_mov_b32 v38, 0xf149f2ca
    v_mov_b32 v39, 0xf149f2ca
attn1_kernel_b7:
    s_waitcnt lgkmcnt(2)
    s_nop 0
    v_mfma_f32_32x32x16_bf16 v[72:87], v[112:115], v[4:7], v[24:39]
    v_mfma_f32_32x32x16_bf16 v[72:87], v[116:119], v[8:11], v[72:87]
    v_exp_f32 v56, v56
    v_exp_f32 v57, v57
    v_exp_f32 v58, v58
    v_exp_f32 v59, v59
    v_exp_f32 v60, v60
    v_exp_f32 v61, v61
    v_exp_f32 v62, v62
    v_exp_f32 v63, v63
    v_exp_f32 v64, v64
    v_exp_f32 v65, v65
    v_exp_f32 v66, v66
    v_exp_f32 v67, v67
    v_exp_f32 v68, v68
    v_exp_f32 v69, v69
    v_exp_f32 v70, v70
    v_exp_f32 v71, v71
    v_add_f32 v22, v22, v56
    v_add_f32 v23, v23, v57
    v_add_f32 v22, v22, v58
    v_add_f32 v23, v23, v59
    v_add_f32 v22, v22, v60
    v_add_f32 v23, v23, v61
    v_add_f32 v22, v22, v62
    v_add_f32 v23, v23, v63
    v_add_f32 v22, v22, v64
    v_add_f32 v23, v23, v65
    v_add_f32 v22, v22, v66
    v_add_f32 v23, v23, v67
    v_add_f32 v22, v22, v68
    v_add_f32 v23, v23, v69
    v_add_f32 v22, v22, v70
    v_add_f32 v23, v23, v71
    v_cvt_pk_bf16_f32 v136, v56, v57
    v_cvt_pk_bf16_f32 v137, v58, v59
    v_cvt_pk_bf16_f32 v138, v60, v61
    v_cvt_pk_bf16_f32 v139, v62, v63
    v_cvt_pk_bf16_f32 v140, v64, v65
    v_cvt_pk_bf16_f32 v141, v66, v67
    v_cvt_pk_bf16_f32 v142, v68, v69
    v_cvt_pk_bf16_f32 v143, v70, v71
    s_waitcnt lgkmcnt(0)
    v_mfma_f32_32x32x16_bf16 v[88:103], v[120:123], v[136:139], v[88:103]
    v_mfma_f32_32x32x16_bf16 v[88:103], v[124:127], v[140:143], v[88:103]
    ds_read_b128 v[128:131], v20 offset:6144
    ds_read_b128 v[132:135], v20 offset:7168
    v_exp_f32 v72, v72
    v_exp_f32 v73, v73
    v_exp_f32 v74, v74
    v_exp_f32 v75, v75
    v_exp_f32 v76, v76
    v_exp_f32 v77, v77
    v_exp_f32 v78, v78
    v_exp_f32 v79, v79
    v_exp_f32 v80, v80
    v_exp_f32 v81, v81
    v_exp_f32 v82, v82
    v_exp_f32 v83, v83
    v_exp_f32 v84, v84
    v_exp_f32 v85, v85
    v_exp_f32 v86, v86
    v_exp_f32 v87, v87
    v_add_f32 v22, v22, v72
    v_add_f32 v23, v23, v73
    v_add_f32 v22, v22, v74
    v_add_f32 v23, v23, v75
    v_add_f32 v22, v22, v76
    v_add_f32 v23, v23, v77
    v_add_f32 v22, v22, v78
    v_add_f32 v23, v23, v79
    v_add_f32 v22, v22, v80
    v_add_f32 v23, v23, v81
    v_add_f32 v22, v22, v82
    v_add_f32 v23, v23, v83
    v_add_f32 v22, v22, v84
    v_add_f32 v23, v23, v85
    v_add_f32 v22, v22, v86
    v_add_f32 v23, v23, v87
    v_cvt_pk_bf16_f32 v144, v72, v73
    v_cvt_pk_bf16_f32 v145, v74, v75
    v_cvt_pk_bf16_f32 v146, v76, v77
    v_cvt_pk_bf16_f32 v147, v78, v79
    v_cvt_pk_bf16_f32 v148, v80, v81
    v_cvt_pk_bf16_f32 v149, v82, v83
    v_cvt_pk_bf16_f32 v150, v84, v85
    v_cvt_pk_bf16_f32 v151, v86, v87
    s_waitcnt lgkmcnt(0)
    v_mfma_f32_32x32x16_bf16 v[88:103], v[128:131], v[144:147], v[88:103]
    v_mfma_f32_32x32x16_bf16 v[88:103], v[132:135], v[148:151], v[88:103]
    v_add_f32 v22, v22, v23
    v_mov_b32 v152, v22
    s_nop 1
    v_permlane32_swap_b32 v22, v152
    v_add_f32 v22, v22, v152
    v_rcp_f32 v22, v22
    s_lshl_b32 s33, s37, 16
    s_lshl_b32 s34, s30, 11
    s_add_u32 s33, s33, s34
    s_add_u32 s33, s33, 0x2c00000
    s_nop 0
    v_mul_f32 v88, v88, v22
    v_mul_f32 v89, v89, v22
    v_mul_f32 v90, v90, v22
    v_mul_f32 v91, v91, v22
    v_mul_f32 v92, v92, v22
    v_mul_f32 v93, v93, v22
    v_mul_f32 v94, v94, v22
    v_mul_f32 v95, v95, v22
    v_mul_f32 v96, v96, v22
    v_mul_f32 v97, v97, v22
    v_mul_f32 v98, v98, v22
    v_mul_f32 v99, v99, v22
    v_mul_f32 v100, v100, v22
    v_mul_f32 v101, v101, v22
    v_mul_f32 v102, v102, v22
    v_mul_f32 v103, v103, v22
    v_cvt_pk_bf16_f32 v88, v88, v89
    v_cvt_pk_bf16_f32 v89, v90, v91
    v_cvt_pk_bf16_f32 v90, v92, v93
    v_cvt_pk_bf16_f32 v91, v94, v95
    v_cvt_pk_bf16_f32 v92, v96, v97
    v_cvt_pk_bf16_f32 v93, v98, v99
    v_cvt_pk_bf16_f32 v94, v100, v101
    v_cvt_pk_bf16_f32 v95, v102, v103
    buffer_store_dwordx4 v[88:91], v3, s[20:23], s33 offen
    buffer_store_dwordx4 v[92:95], v3, s[20:23], s33 offen offset:1024
attn1_kernel_end:
    s_endpgm
.globl wo1_kernel
.p2align 8
.type wo1_kernel,@function
wo1_kernel:
    s_cmp_ge_u32 s2, 256
    s_cbranch_scc1 wo1_kernel_end
    s_load_dwordx2 s[4:5], s[0:1], 0
    s_load_dwordx2 s[6:7], s[0:1], 16
    s_load_dwordx2 s[8:9], s[0:1], 80
    s_load_dwordx2 s[10:11], s[0:1], 32
    v_lshrrev_b32 v1, 6, v0
    v_and_b32 v2, 63, v0
    v_readfirstlane_b32 s3, v1
    s_and_b32 s24, s2, 7
    s_lshr_b32 s25, s2, 3
    s_lshl_b32 s26, s24, 1
    s_and_b32 s27, s25, 1
    s_add_u32 s26, s26, s27
    s_lshr_b32 s27, s25, 1
    s_and_b32 s28, s3, 3
    s_lshr_b32 s29, s3, 2
    v_bfe_u32 v4, v2, 3, 2
    v_lshrrev_b32 v5, 5, v2
    v_lshl_add_u32 v4, v5, 3, v4
    s_lshr_b32 s30, s3, 1
    s_lshl_b32 s30, s30, 4
    s_and_b32 s31, s3, 1
    s_lshl_b32 s31, s31, 2
    s_add_u32 s30, s30, s31
    v_add_u32 v4, s30, v4
    v_lshlrev_b32 v4, 11, v4
    v_lshrrev_b32 v6, 2, v2
    v_and_b32 v6, 4, v6
    v_xor_b32 v6, v6, v2
    v_and_b32 v6, 7, v6
    v_lshl_add_u32 v4, v6, 4, v4
    v_lshlrev_b32 v3, 4, v2
    s_waitcnt lgkmcnt(0)
    s_mov_b32 s12, s4
    s_mov_b32 s13, s5
    s_mov_b32 s14, 0x400000
    s_mov_b32 s15, 0x20000
    s_mov_b32 s16, s6
    s_mov_b32 s17, s7
    s_mov_b32 s18, 0x200000
    s_mov_b32 s19, 0x20000
    s_mov_b32 s20, s8
    s_mov_b32 s21, s9
    s_mov_b32 s22, 0x8000000
    s_mov_b32 s23, 0x20000
    s_mov_b32 s40, s10
    s_mov_b32 s41, s11
    s_mov_b32 s42, 0x800
    s_mov_b32 s43, 0x20000
    s_lshl_b32 s30, s27, 7
    s_lshl_b32 s31, s3, 10
    s_mov_b32 m0, s31
    s_nop 0
    buffer_load_dwordx4 v4, s[16:19], s30 offen lds
    s_add_u32 m0, m0, 8192
    s_add_u32 s30, s30, 131072
    buffer_load_dwordx4 v4, s[16:19], s30 offen lds
    s_add_u32 m0, m0, 8192
    s_add_u32 s30, s30, 131072
    buffer_load_dwordx4 v4, s[16:19], s30 offen lds
    s_add_u32 m0, m0, 8192
    s_add_u32 s30, s30, 131072
    buffer_load_dwordx4 v4, s[16:19], s30 offen lds
    s_add_u32 m0, m0, 8192
    s_add_u32 s30, s30, 131072
    buffer_load_dwordx4 v4, s[16:19], s30 offen lds
    s_add_u32 m0, m0, 8192
    s_add_u32 s30, s30, 131072
    buffer_load_dwordx4 v4, s[16:19], s30 offen lds
    s_add_u32 m0, m0, 8192
    s_add_u32 s30, s30, 131072
    buffer_load_dwordx4 v4, s[16:19], s30 offen lds
    s_add_u32 m0, m0, 8192
    s_add_u32 s30, s30, 131072
    buffer_load_dwordx4 v4, s[16:19], s30 offen lds
    s_add_u32 m0, m0, 8192
    s_add_u32 s30, s30, 131072
    buffer_load_dwordx4 v4, s[16:19], s30 offen lds
    s_add_u32 m0, m0, 8192
    s_add_u32 s30, s30, 131072
    buffer_load_dwordx4 v4, s[16:19], s30 offen lds
    s_add_u32 m0, m0, 8192
    s_add_u32 s30, s30, 131072
    buffer_load_dwordx4 v4, s[16:19], s30 offen lds
    s_add_u32 m0, m0, 8192
    s_add_u32 s30, s30, 131072
    buffer_load_dwordx4 v4, s[16:19], s30 offen lds
    s_add_u32 m0, m0, 8192
    s_add_u32 s30, s30, 131072
    buffer_load_dwordx4 v4, s[16:19], s30 offen lds
    s_add_u32 m0, m0, 8192
    s_add_u32 s30, s30, 131072
    buffer_load_dwordx4 v4, s[16:19], s30 offen lds
    s_add_u32 m0, m0, 8192
    s_add_u32 s30, s30, 131072
    buffer_load_dwordx4 v4, s[16:19], s30 offen lds
    s_add_u32 m0, m0, 8192
    s_add_u32 s30, s30, 131072
    buffer_load_dwordx4 v4, s[16:19], s30 offen lds
    v_and_b32 v7, 31, v2
    s_lshl_b32 s32, s26, 2
    s_add_u32 s32, s32, s28
    s_lshl_b32 s33, s27, 7
    s_lshl_b32 s34, s29, 6
    s_add_u32 s33, s33, s34
    v_lshlrev_b32 v8, 3, v5
    buffer_load_dwordx2 v[48:49], v8, s[40:43], s33 offen offset:0
    buffer_load_dwordx2 v[50:51], v8, s[40:43], s33 offen offset:16
    buffer_load_dwordx2 v[52:53], v8, s[40:43], s33 offen offset:32
    buffer_load_dwordx2 v[54:55], v8, s[40:43], s33 offen offset:48
    s_lshl_b32 s35, s26, 4
    s_add_u32 s35, s35, s27
    s_lshl_b32 s35, s35, 14
    s_lshl_b32 s34, s28, 12
    s_add_u32 s35, s35, s34
    s_lshl_b32 s34, s29, 11
    s_add_u32 s35, s35, s34
    s_add_u32 s34, s35, 0x1000000
    buffer_load_dwordx4 v[40:43], v3, s[20:23], s34 offen
    buffer_load_dwordx4 v[44:47], v3, s[20:23], s34 offen offset:1024
    v_lshlrev_b32 v9, 2, v7
    s_lshl_b32 s34, s32, 7
    s_add_u32 s34, s34, 0x3444000
    buffer_load_dword v56, v9, s[20:23], s34 offen
    s_add_u32 s34, s34, 8192
    buffer_load_dword v57, v9, s[20:23], s34 offen
    s_lshl_b32 s36, s32, 16
    s_lshl_b32 s34, s29, 15
    s_add_u32 s36, s36, s34
    s_add_u32 s36, s36, 0x2c00000
    buffer_load_dwordx4 v[64:67], v3, s[20:23], s36 offen offset:0
    buffer_load_dwordx4 v[68:71], v3, s[20:23], s36 offen offset:1024
    buffer_load_dwordx4 v[72:75], v3, s[20:23], s36 offen offset:2048
    buffer_load_dwordx4 v[76:79], v3, s[20:23], s36 offen offset:3072
    s_add_u32 s36, s36, 4096
    buffer_load_dwordx4 v[80:83], v3, s[20:23], s36 offen offset:0
    buffer_load_dwordx4 v[84:87], v3, s[20:23], s36 offen offset:1024
    buffer_load_dwordx4 v[88:91], v3, s[20:23], s36 offen offset:2048
    buffer_load_dwordx4 v[92:95], v3, s[20:23], s36 offen offset:3072
    s_add_u32 s36, s36, 4096
    buffer_load_dwordx4 v[96:99], v3, s[20:23], s36 offen offset:0
    buffer_load_dwordx4 v[100:103], v3, s[20:23], s36 offen offset:1024
    buffer_load_dwordx4 v[104:107], v3, s[20:23], s36 offen offset:2048
    buffer_load_dwordx4 v[108:111], v3, s[20:23], s36 offen offset:3072
    s_add_u32 s36, s36, 4096
    buffer_load_dwordx4 v[112:115], v3, s[20:23], s36 offen offset:0
    buffer_load_dwordx4 v[116:119], v3, s[20:23], s36 offen offset:1024
    buffer_load_dwordx4 v[120:123], v3, s[20:23], s36 offen offset:2048
    buffer_load_dwordx4 v[124:127], v3, s[20:23], s36 offen offset:3072
    s_add_u32 s36, s36, 4096
    buffer_load_dwordx4 v[128:131], v3, s[20:23], s36 offen offset:0
    buffer_load_dwordx4 v[132:135], v3, s[20:23], s36 offen offset:1024
    buffer_load_dwordx4 v[136:139], v3, s[20:23], s36 offen offset:2048
    buffer_load_dwordx4 v[140:143], v3, s[20:23], s36 offen offset:3072
    s_add_u32 s36, s36, 4096
    buffer_load_dwordx4 v[144:147], v3, s[20:23], s36 offen offset:0
    buffer_load_dwordx4 v[148:151], v3, s[20:23], s36 offen offset:1024
    buffer_load_dwordx4 v[152:155], v3, s[20:23], s36 offen offset:2048
    buffer_load_dwordx4 v[156:159], v3, s[20:23], s36 offen offset:3072
    s_add_u32 s36, s36, 4096
    buffer_load_dwordx4 v[160:163], v3, s[20:23], s36 offen offset:0
    buffer_load_dwordx4 v[164:167], v3, s[20:23], s36 offen offset:1024
    buffer_load_dwordx4 v[168:171], v3, s[20:23], s36 offen offset:2048
    buffer_load_dwordx4 v[172:175], v3, s[20:23], s36 offen offset:3072
    s_add_u32 s36, s36, 4096
    buffer_load_dwordx4 v[176:179], v3, s[20:23], s36 offen offset:0
    buffer_load_dwordx4 v[180:183], v3, s[20:23], s36 offen offset:1024
    buffer_load_dwordx4 v[184:187], v3, s[20:23], s36 offen offset:2048
    buffer_load_dwordx4 v[188:191], v3, s[20:23], s36 offen offset:3072
    v_bfe_u32 v10, v2, 2, 2
    v_lshl_add_u32 v11, v5, 3, v10
    v_lshlrev_b32 v11, 7, v11
    v_lshrrev_b32 v10, 1, v10
    v_xor_b32 v10, s29, v10
    v_lshl_add_u32 v11, v10, 6, v11
    v_bfe_u32 v10, v2, 4, 1
    v_lshl_add_u32 v11, v10, 5, v11
    v_and_b32 v10, 3, v2
    v_lshl_add_u32 v11, v10, 3, v11
    s_lshl_b32 s34, s29, 16
    v_add_u32 v58, s34, v11
    v_xor_b32 v59, 64, v58
    v_mov_b32 v60, v7
    v_mov_b32 v61, v5
    v_mov_b32 v62, v3
    s_waitcnt vmcnt(40)
    s_barrier
    ds_read_b64_tr_b16 v[192:193], v58 offset:0
    ds_read_b64_tr_b16 v[194:195], v58 offset:512
    ds_read_b64_tr_b16 v[196:197], v59 offset:0
    ds_read_b64_tr_b16 v[198:199], v59 offset:512
    ds_read_b64_tr_b16 v[200:201], v58 offset:2048
    ds_read_b64_tr_b16 v[202:203], v58 offset:2560
    ds_read_b64_tr_b16 v[204:205], v59 offset:2048
    ds_read_b64_tr_b16 v[206:207], v59 offset:2560
    ds_read_b64_tr_b16 v[208:209], v58 offset:4096
    ds_read_b64_tr_b16 v[210:211], v58 offset:4608
    ds_read_b64_tr_b16 v[212:213], v59 offset:4096
    ds_read_b64_tr_b16 v[214:215], v59 offset:4608
    s_waitcnt vmcnt(31) lgkmcnt(8)
    v_mfma_f32_32x32x16_bf16 v[0:15], v[192:195], v[64:67], 0
    v_mfma_f32_32x32x16_bf16 v[16:31], v[196:199], v[64:67], 0
    ds_read_b64_tr_b16 v[192:193], v58 offset:6144
    ds_read_b64_tr_b16 v[194:195], v58 offset:6656
    ds_read_b64_tr_b16 v[196:197], v59 offset:6144
    ds_read_b64_tr_b16 v[198:199], v59 offset:6656
    s_waitcnt vmcnt(30) lgkmcnt(8)
    v_mfma_f32_32x32x16_bf16 v[0:15], v[200:203], v[68:71], v[0:15]
    v_mfma_f32_32x32x16_bf16 v[16:31], v[204:207], v[68:71], v[16:31]
    ds_read_b64_tr_b16 v[200:201], v58 offset:8192
    ds_read_b64_tr_b16 v[202:203], v58 offset:8704
    ds_read_b64_tr_b16 v[204:205], v59 offset:8192
    ds_read_b64_tr_b16 v[206:207], v59 offset:8704
    s_waitcnt vmcnt(29) lgkmcnt(8)
    v_mfma_f32_32x32x16_bf16 v[0:15], v[208:211], v[72:75], v[0:15]
    v_mfma_f32_32x32x16_bf16 v[16:31], v[212:215], v[72:75], v[16:31]
    ds_read_b64_tr_b16 v[208:209], v58 offset:10240
    ds_read_b64_tr_b16 v[210:211], v58 offset:10752
    ds_read_b64_tr_b16 v[212:213], v59 offset:10240
    ds_read_b64_tr_b16 v[214:215], v59 offset:10752
    s_waitcnt vmcnt(28) lgkmcnt(8)
    v_mfma_f32_32x32x16_bf16 v[0:15], v[192:195], v[76:79], v[0:15]
    v_mfma_f32_32x32x16_bf16 v[16:31], v[196:199], v[76:79], v[16:31]
    ds_read_b64_tr_b16 v[192:193], v58 offset:12288
    ds_read_b64_tr_b16 v[194:195], v58 offset:12800
    ds_read_b64_tr_b16 v[196:197], v59 offset:12288
    ds_read_b64_tr_b16 v[198:199], v59 offset:12800
    s_waitcnt vmcnt(27) lgkmcnt(8)
    v_mfma_f32_32x32x16_bf16 v[0:15], v[200:203], v[80:83], v[0:15]
    v_mfma_f32_32x32x16_bf16 v[16:31], v[204:207], v[80:83], v[16:31]
    ds_read_b64_tr_b16 v[200:201], v58 offset:14336
    ds_read_b64_tr_b16 v[202:203], v58 offset:14848
    ds_read_b64_tr_b16 v[204:205], v59 offset:14336
    ds_read_b64_tr_b16 v[206:207], v59 offset:14848
    s_waitcnt vmcnt(26) lgkmcnt(8)
    v_mfma_f32_32x32x16_bf16 v[0:15], v[208:211], v[84:87], v[0:15]
    v_mfma_f32_32x32x16_bf16 v[16:31], v[212:215], v[84:87], v[16:31]
    ds_read_b64_tr_b16 v[208:209], v58 offset:16384
    ds_read_b64_tr_b16 v[210:211], v58 offset:16896
    ds_read_b64_tr_b16 v[212:213], v59 offset:16384
    ds_read_b64_tr_b16 v[214:215], v59 offset:16896
    s_waitcnt vmcnt(25) lgkmcnt(8)
    v_mfma_f32_32x32x16_bf16 v[0:15], v[192:195], v[88:91], v[0:15]
    v_mfma_f32_32x32x16_bf16 v[16:31], v[196:199], v[88:91], v[16:31]
    ds_read_b64_tr_b16 v[192:193], v58 offset:18432
    ds_read_b64_tr_b16 v[194:195], v58 offset:18944
    ds_read_b64_tr_b16 v[196:197], v59 offset:18432
    ds_read_b64_tr_b16 v[198:199], v59 offset:18944
    s_waitcnt vmcnt(24) lgkmcnt(8)
    v_mfma_f32_32x32x16_bf16 v[0:15], v[200:203], v[92:95], v[0:15]
    v_mfma_f32_32x32x16_bf16 v[16:31], v[204:207], v[92:95], v[16:31]
    ds_read_b64_tr_b16 v[200:201], v58 offset:20480
    ds_read_b64_tr_b16 v[202:203], v58 offset:20992
    ds_read_b64_tr_b16 v[204:205], v59 offset:20480
    ds_read_b64_tr_b16 v[206:207], v59 offset:20992
    s_waitcnt vmcnt(23) lgkmcnt(8)
    v_mfma_f32_32x32x16_bf16 v[0:15], v[208:211], v[96:99], v[0:15]
    v_mfma_f32_32x32x16_bf16 v[16:31], v[212:215], v[96:99], v[16:31]
    ds_read_b64_tr_b16 v[208:209], v58 offset:22528
    ds_read_b64_tr_b16 v[210:211], v58 offset:23040
    ds_read_b64_tr_b16 v[212:213], v59 offset:22528
    ds_read_b64_tr_b16 v[214:215], v59 offset:23040
    s_waitcnt vmcnt(22) lgkmcnt(8)
    v_mfma_f32_32x32x16_bf16 v[0:15], v[192:195], v[100:103], v[0:15]
    v_mfma_f32_32x32x16_bf16 v[16:31], v[196:199], v[100:103], v[16:31]
    ds_read_b64_tr_b16 v[192:193], v58 offset:24576
    ds_read_b64_tr_b16 v[194:195], v58 offset:25088
    ds_read_b64_tr_b16 v[196:197], v59 offset:24576
    ds_read_b64_tr_b16 v[198:199], v59 offset:25088
    s_waitcnt vmcnt(21) lgkmcnt(8)
    v_mfma_f32_32x32x16_bf16 v[0:15], v[200:203], v[104:107], v[0:15]
    v_mfma_f32_32x32x16_bf16 v[16:31], v[204:207], v[104:107], v[16:31]
    ds_read_b64_tr_b16 v[200:201], v58 offset:26624
    ds_read_b64_tr_b16 v[202:203], v58 offset:27136
    ds_read_b64_tr_b16 v[204:205], v59 offset:26624
    ds_read_b64_tr_b16 v[206:207], v59 offset:27136
    s_waitcnt vmcnt(20) lgkmcnt(8)
    v_mfma_f32_32x32x16_bf16 v[0:15], v[208:211], v[108:111], v[0:15]
    v_mfma_f32_32x32x16_bf16 v[16:31], v[212:215], v[108:111], v[16:31]
    ds_read_b64_tr_b16 v[208:209], v58 offset:28672
    ds_read_b64_tr_b16 v[210:211], v58 offset:29184
    ds_read_b64_tr_b16 v[212:213], v59 offset:28672
    ds_read_b64_tr_b16 v[214:215], v59 offset:29184
    s_waitcnt vmcnt(19) lgkmcnt(8)
    v_mfma_f32_32x32x16_bf16 v[0:15], v[192:195], v[112:115], v[0:15]
    v_mfma_f32_32x32x16_bf16 v[16:31], v[196:199], v[112:115], v[16:31]
    ds_read_b64_tr_b16 v[192:193], v58 offset:30720
    ds_read_b64_tr_b16 v[194:195], v58 offset:31232
    ds_read_b64_tr_b16 v[196:197], v59 offset:30720
    ds_read_b64_tr_b16 v[198:199], v59 offset:31232
    s_waitcnt vmcnt(18) lgkmcnt(8)
    v_mfma_f32_32x32x16_bf16 v[0:15], v[200:203], v[116:119], v[0:15]
    v_mfma_f32_32x32x16_bf16 v[16:31], v[204:207], v[116:119], v[16:31]
    ds_read_b64_tr_b16 v[200:201], v58 offset:32768
    ds_read_b64_tr_b16 v[202:203], v58 offset:33280
    ds_read_b64_tr_b16 v[204:205], v59 offset:32768
    ds_read_b64_tr_b16 v[206:207], v59 offset:33280
    s_waitcnt vmcnt(17) lgkmcnt(8)
    v_mfma_f32_32x32x16_bf16 v[0:15], v[208:211], v[120:123], v[0:15]
    v_mfma_f32_32x32x16_bf16 v[16:31], v[212:215], v[120:123], v[16:31]
    ds_read_b64_tr_b16 v[208:209], v58 offset:34816
    ds_read_b64_tr_b16 v[210:211], v58 offset:35328
    ds_read_b64_tr_b16 v[212:213], v59 offset:34816
    ds_read_b64_tr_b16 v[214:215], v59 offset:35328
    s_waitcnt vmcnt(16) lgkmcnt(8)
    v_mfma_f32_32x32x16_bf16 v[0:15], v[192:195], v[124:127], v[0:15]
    v_mfma_f32_32x32x16_bf16 v[16:31], v[196:199], v[124:127], v[16:31]
    ds_read_b64_tr_b16 v[192:193], v58 offset:36864
    ds_read_b64_tr_b16 v[194:195], v58 offset:37376
    ds_read_b64_tr_b16 v[196:197], v59 offset:36864
    ds_read_b64_tr_b16 v[198:199], v59 offset:37376
    s_waitcnt vmcnt(15) lgkmcnt(8)
    v_mfma_f32_32x32x16_bf16 v[0:15], v[200:203], v[128:131], v[0:15]
    v_mfma_f32_32x32x16_bf16 v[16:31], v[204:207], v[128:131], v[16:31]
    ds_read_b64_tr_b16 v[200:201], v58 offset:38912
    ds_read_b64_tr_b16 v[202:203], v58 offset:39424
    ds_read_b64_tr_b16 v[204:205], v59 offset:38912
    ds_read_b64_tr_b16 v[206:207], v59 offset:39424
    s_waitcnt vmcnt(14) lgkmcnt(8)
    v_mfma_f32_32x32x16_bf16 v[0:15], v[208:211], v[132:135], v[0:15]
    v_mfma_f32_32x32x16_bf16 v[16:31], v[212:215], v[132:135], v[16:31]
    ds_read_b64_tr_b16 v[208:209], v58 offset:40960
    ds_read_b64_tr_b16 v[210:211], v58 offset:41472
    ds_read_b64_tr_b16 v[212:213], v59 offset:40960
    ds_read_b64_tr_b16 v[214:215], v59 offset:41472
    s_waitcnt vmcnt(13) lgkmcnt(8)
    v_mfma_f32_32x32x16_bf16 v[0:15], v[192:195], v[136:139], v[0:15]
    v_mfma_f32_32x32x16_bf16 v[16:31], v[196:199], v[136:139], v[16:31]
    ds_read_b64_tr_b16 v[192:193], v58 offset:43008
    ds_read_b64_tr_b16 v[194:195], v58 offset:43520
    ds_read_b64_tr_b16 v[196:197], v59 offset:43008
    ds_read_b64_tr_b16 v[198:199], v59 offset:43520
    s_waitcnt vmcnt(12) lgkmcnt(8)
    v_mfma_f32_32x32x16_bf16 v[0:15], v[200:203], v[140:143], v[0:15]
    v_mfma_f32_32x32x16_bf16 v[16:31], v[204:207], v[140:143], v[16:31]
    ds_read_b64_tr_b16 v[200:201], v58 offset:45056
    ds_read_b64_tr_b16 v[202:203], v58 offset:45568
    ds_read_b64_tr_b16 v[204:205], v59 offset:45056
    ds_read_b64_tr_b16 v[206:207], v59 offset:45568
    s_waitcnt vmcnt(11) lgkmcnt(8)
    v_mfma_f32_32x32x16_bf16 v[0:15], v[208:211], v[144:147], v[0:15]
    v_mfma_f32_32x32x16_bf16 v[16:31], v[212:215], v[144:147], v[16:31]
    ds_read_b64_tr_b16 v[208:209], v58 offset:47104
    ds_read_b64_tr_b16 v[210:211], v58 offset:47616
    ds_read_b64_tr_b16 v[212:213], v59 offset:47104
    ds_read_b64_tr_b16 v[214:215], v59 offset:47616
    s_waitcnt vmcnt(10) lgkmcnt(8)
    v_mfma_f32_32x32x16_bf16 v[0:15], v[192:195], v[148:151], v[0:15]
    v_mfma_f32_32x32x16_bf16 v[16:31], v[196:199], v[148:151], v[16:31]
    ds_read_b64_tr_b16 v[192:193], v58 offset:49152
    ds_read_b64_tr_b16 v[194:195], v58 offset:49664
    ds_read_b64_tr_b16 v[196:197], v59 offset:49152
    ds_read_b64_tr_b16 v[198:199], v59 offset:49664
    s_waitcnt vmcnt(9) lgkmcnt(8)
    v_mfma_f32_32x32x16_bf16 v[0:15], v[200:203], v[152:155], v[0:15]
    v_mfma_f32_32x32x16_bf16 v[16:31], v[204:207], v[152:155], v[16:31]
    ds_read_b64_tr_b16 v[200:201], v58 offset:51200
    ds_read_b64_tr_b16 v[202:203], v58 offset:51712
    ds_read_b64_tr_b16 v[204:205], v59 offset:51200
    ds_read_b64_tr_b16 v[206:207], v59 offset:51712
    s_waitcnt vmcnt(8) lgkmcnt(8)
    v_mfma_f32_32x32x16_bf16 v[0:15], v[208:211], v[156:159], v[0:15]
    v_mfma_f32_32x32x16_bf16 v[16:31], v[212:215], v[156:159], v[16:31]
    ds_read_b64_tr_b16 v[208:209], v58 offset:53248
    ds_read_b64_tr_b16 v[210:211], v58 offset:53760
    ds_read_b64_tr_b16 v[212:213], v59 offset:53248
    ds_read_b64_tr_b16 v[214:215], v59 offset:53760
    s_waitcnt vmcnt(7) lgkmcnt(8)
    v_mfma_f32_32x32x16_bf16 v[0:15], v[192:195], v[160:163], v[0:15]
    v_mfma_f32_32x32x16_bf16 v[16:31], v[196:199], v[160:163], v[16:31]
    ds_read_b64_tr_b16 v[192:193], v58 offset:55296
    ds_read_b64_tr_b16 v[194:195], v58 offset:55808
    ds_read_b64_tr_b16 v[196:197], v59 offset:55296
    ds_read_b64_tr_b16 v[198:199], v59 offset:55808
    s_waitcnt vmcnt(6) lgkmcnt(8)
    v_mfma_f32_32x32x16_bf16 v[0:15], v[200:203], v[164:167], v[0:15]
    v_mfma_f32_32x32x16_bf16 v[16:31], v[204:207], v[164:167], v[16:31]
    ds_read_b64_tr_b16 v[200:201], v58 offset:57344
    ds_read_b64_tr_b16 v[202:203], v58 offset:57856
    ds_read_b64_tr_b16 v[204:205], v59 offset:57344
    ds_read_b64_tr_b16 v[206:207], v59 offset:57856
    s_waitcnt vmcnt(5) lgkmcnt(8)
    v_mfma_f32_32x32x16_bf16 v[0:15], v[208:211], v[168:171], v[0:15]
    v_mfma_f32_32x32x16_bf16 v[16:31], v[212:215], v[168:171], v[16:31]
    ds_read_b64_tr_b16 v[208:209], v58 offset:59392
    ds_read_b64_tr_b16 v[210:211], v58 offset:59904
    ds_read_b64_tr_b16 v[212:213], v59 offset:59392
    ds_read_b64_tr_b16 v[214:215], v59 offset:59904
    s_waitcnt vmcnt(4) lgkmcnt(8)
    v_mfma_f32_32x32x16_bf16 v[0:15], v[192:195], v[172:175], v[0:15]
    v_mfma_f32_32x32x16_bf16 v[16:31], v[196:199], v[172:175], v[16:31]
    ds_read_b64_tr_b16 v[192:193], v58 offset:61440
    ds_read_b64_tr_b16 v[194:195], v58 offset:61952
    ds_read_b64_tr_b16 v[196:197], v59 offset:61440
    ds_read_b64_tr_b16 v[198:199], v59 offset:61952
    s_waitcnt vmcnt(3) lgkmcnt(8)
    v_mfma_f32_32x32x16_bf16 v[0:15], v[200:203], v[176:179], v[0:15]
    v_mfma_f32_32x32x16_bf16 v[16:31], v[204:207], v[176:179], v[16:31]
    ds_read_b64_tr_b16 v[200:201], v58 offset:63488
    ds_read_b64_tr_b16 v[202:203], v58 offset:64000
    ds_read_b64_tr_b16 v[204:205], v59 offset:63488
    ds_read_b64_tr_b16 v[206:207], v59 offset:64000
    s_waitcnt vmcnt(2) lgkmcnt(8)
    v_mfma_f32_32x32x16_bf16 v[0:15], v[208:211], v[180:183], v[0:15]
    v_mfma_f32_32x32x16_bf16 v[16:31], v[212:215], v[180:183], v[16:31]
    s_waitcnt vmcnt(1) lgkmcnt(4)
    v_mfma_f32_32x32x16_bf16 v[0:15], v[192:195], v[184:187], v[0:15]
    v_mfma_f32_32x32x16_bf16 v[16:31], v[196:199], v[184:187], v[16:31]
    s_waitcnt vmcnt(0) lgkmcnt(0)
    v_mfma_f32_32x32x16_bf16 v[0:15], v[200:203], v[188:191], v[0:15]
    v_mfma_f32_32x32x16_bf16 v[16:31], v[204:207], v[188:191], v[16:31]
    s_lshl_b32 s34, s3, 12
    s_add_u32 s34, s34, 131072
    v_add_u32 v63, s34, v62
    s_nop 8
    ds_write_b128 v63, v[16:19] offset:0
    ds_write_b128 v63, v[20:23] offset:1024
    ds_write_b128 v63, v[24:27] offset:2048
    ds_write_b128 v63, v[28:31] offset:3072
    v_xor_b32 v63, 16384, v63
    v_lshlrev_b32 v64, 16, v40
    v_and_b32 v65, 0xffff0000, v40
    v_lshlrev_b32 v80, 16, v48
    v_and_b32 v81, 0xffff0000, v48
    v_lshlrev_b32 v66, 16, v41
    v_and_b32 v67, 0xffff0000, v41
    v_lshlrev_b32 v82, 16, v49
    v_and_b32 v83, 0xffff0000, v49
    v_lshlrev_b32 v68, 16, v42
    v_and_b32 v69, 0xffff0000, v42
    v_lshlrev_b32 v84, 16, v50
    v_and_b32 v85, 0xffff0000, v50
    v_lshlrev_b32 v70, 16, v43
    v_and_b32 v71, 0xffff0000, v43
    v_lshlrev_b32 v86, 16, v51
    v_and_b32 v87, 0xffff0000, v51
    v_lshlrev_b32 v72, 16, v44
    v_and_b32 v73, 0xffff0000, v44
    v_lshlrev_b32 v88, 16, v52
    v_and_b32 v89, 0xffff0000, v52
    v_lshlrev_b32 v74, 16, v45
    v_and_b32 v75, 0xffff0000, v45
    v_lshlrev_b32 v90, 16, v53
    v_and_b32 v91, 0xffff0000, v53
    v_lshlrev_b32 v76, 16, v46
    v_and_b32 v77, 0xffff0000, v46
    v_lshlrev_b32 v92, 16, v54
    v_and_b32 v93, 0xffff0000, v54
    v_lshlrev_b32 v78, 16, v47
    v_and_b32 v79, 0xffff0000, v47
    v_lshlrev_b32 v94, 16, v55
    v_and_b32 v95, 0xffff0000, v55
    v_fma_f32 v64, v64, v56, v57
    v_fma_f32 v65, v65, v56, v57
    v_fma_f32 v66, v66, v56, v57
    v_fma_f32 v67, v67, v56, v57
    v_fma_f32 v68, v68, v56, v57
    v_fma_f32 v69, v69, v56, v57
    v_fma_f32 v70, v70, v56, v57
    v_fma_f32 v71, v71, v56, v57
    v_fma_f32 v72, v72, v56, v57
    v_fma_f32 v73, v73, v56, v57
    v_fma_f32 v74, v74, v56, v57
    v_fma_f32 v75, v75, v56, v57
    v_fma_f32 v76, v76, v56, v57
    v_fma_f32 v77, v77, v56, v57
    v_fma_f32 v78, v78, v56, v57
    v_fma_f32 v79, v79, v56, v57
    v_add_f32 v0, v0, v64
    v_add_f32 v1, v1, v65
    v_add_f32 v2, v2, v66
    v_add_f32 v3, v3, v67
    v_add_f32 v4, v4, v68
    v_add_f32 v5, v5, v69
    v_add_f32 v6, v6, v70
    v_add_f32 v7, v7, v71
    v_add_f32 v8, v8, v72
    v_add_f32 v9, v9, v73
    v_add_f32 v10, v10, v74
    v_add_f32 v11, v11, v75
    v_add_f32 v12, v12, v76
    v_add_f32 v13, v13, v77
    v_add_f32 v14, v14, v78
    v_add_f32 v15, v15, v79
    s_waitcnt lgkmcnt(0)
    s_barrier
    ds_read_b128 v[16:19], v63 offset:0
    ds_read_b128 v[20:23], v63 offset:1024
    ds_read_b128 v[24:27], v63 offset:2048
    ds_read_b128 v[28:31], v63 offset:3072
    s_waitcnt lgkmcnt(0)
    v_add_f32 v0, v0, v16
    v_add_f32 v1, v1, v17
    v_add_f32 v2, v2, v18
    v_add_f32 v3, v3, v19
    v_add_f32 v4, v4, v20
    v_add_f32 v5, v5, v21
    v_add_f32 v6, v6, v22
    v_add_f32 v7, v7, v23
    v_add_f32 v8, v8, v24
    v_add_f32 v9, v9, v25
    v_add_f32 v10, v10, v26
    v_add_f32 v11, v11, v27
    v_add_f32 v12, v12, v28
    v_add_f32 v13, v13, v29
    v_add_f32 v14, v14, v30
    v_add_f32 v15, v15, v31
    v_cvt_pk_bf16_f32 v32, v0, v1
    v_cvt_pk_bf16_f32 v33, v2, v3
    v_cvt_pk_bf16_f32 v34, v4, v5
    v_cvt_pk_bf16_f32 v35, v6, v7
    v_cvt_pk_bf16_f32 v36, v8, v9
    v_cvt_pk_bf16_f32 v37, v10, v11
    v_cvt_pk_bf16_f32 v38, v12, v13
    v_cvt_pk_bf16_f32 v39, v14, v15
    s_add_u32 s34, s35, 0x3000000
    buffer_store_dwordx4 v[32:35], v62, s[20:23], s34 offen
    buffer_store_dwordx4 v[36:39], v62, s[20:23], s34 offen offset:1024
    v_add_f32 v40, v0, v1
    v_mul_f32 v41, v0, v0
    v_mul_f32 v42, v0, v80
    v_fmac_f32 v41, v1, v1
    v_fmac_f32 v42, v1, v81
    v_add_f32 v40, v40, v2
    v_fmac_f32 v41, v2, v2
    v_fmac_f32 v42, v2, v82
    v_add_f32 v40, v40, v3
    v_fmac_f32 v41, v3, v3
    v_fmac_f32 v42, v3, v83
    v_add_f32 v40, v40, v4
    v_fmac_f32 v41, v4, v4
    v_fmac_f32 v42, v4, v84
    v_add_f32 v40, v40, v5
    v_fmac_f32 v41, v5, v5
    v_fmac_f32 v42, v5, v85
    v_add_f32 v40, v40, v6
    v_fmac_f32 v41, v6, v6
    v_fmac_f32 v42, v6, v86
    v_add_f32 v40, v40, v7
    v_fmac_f32 v41, v7, v7
    v_fmac_f32 v42, v7, v87
    v_add_f32 v40, v40, v8
    v_fmac_f32 v41, v8, v8
    v_fmac_f32 v42, v8, v88
    v_add_f32 v40, v40, v9
    v_fmac_f32 v41, v9, v9
    v_fmac_f32 v42, v9, v89
    v_add_f32 v40, v40, v10
    v_fmac_f32 v41, v10, v10
    v_fmac_f32 v42, v10, v90
    v_add_f32 v40, v40, v11
    v_fmac_f32 v41, v11, v11
    v_fmac_f32 v42, v11, v91
    v_add_f32 v40, v40, v12
    v_fmac_f32 v41, v12, v12
    v_fmac_f32 v42, v12, v92
    v_add_f32 v40, v40, v13
    v_fmac_f32 v41, v13, v13
    v_fmac_f32 v42, v13, v93
    v_add_f32 v40, v40, v14
    v_fmac_f32 v41, v14, v14
    v_fmac_f32 v42, v14, v94
    v_add_f32 v40, v40, v15
    v_fmac_f32 v41, v15, v15
    v_fmac_f32 v42, v15, v95
    v_mov_b32 v43, v42
    v_permlane32_swap_b32 v40, v41
    s_nop 0
    v_permlane32_swap_b32 v42, v43
    v_add_f32 v40, v40, v41
    v_add_f32 v42, v42, v43
    v_lshlrev_b32 v44, 2, v60
    v_lshl_add_u32 v45, v61, 13, v44
    s_lshl_b32 s34, s32, 7
    s_add_u32 s34, s34, 0x3400000
    buffer_atomic_add_f32 v40, v45, s[20:23], s34 offen sc1
    s_add_u32 s34, s34, 16384
    s_mov_b64 exec, 0xffffffff
    buffer_atomic_add_f32 v42, v44, s[20:23], s34 offen sc1
wo1_kernel_end:
    s_endpgm
.globl ffn1_kernel
.p2align 8
.type ffn1_kernel,@function
ffn1_kernel:
    s_cmp_ge_u32 s2, 256
    s_cbranch_scc1 ffn1_kernel_end
    s_load_dwordx4 s[4:7], s[0:1], 32
    s_load_dwordx4 s[8:11], s[0:1], 48
    s_load_dwordx2 s[44:45], s[0:1], 64
    s_load_dwordx2 s[46:47], s[0:1], 80
    v_lshrrev_b32 v1, 6, v0
    v_and_b32 v2, 63, v0
    v_readfirstlane_b32 s3, v1
    s_and_b32 s24, s2, 7
    s_lshr_b32 s25, s2, 3
    s_mul_i32 s26, s24, 28
    s_add_u32 s26, s26, s25
    s_waitcnt lgkmcnt(0)
    s_mov_b32 s12, s4
    s_mov_b32 s13, s5
    s_mov_b32 s14, 0x800
    s_mov_b32 s15, 0x20000
    s_mov_b32 s20, s46
    s_mov_b32 s21, s47
    s_mov_b32 s22, 0x8000000
    s_mov_b32 s23, 0x20000
    s_mov_b32 s28, s10
    s_mov_b32 s29, s11
    s_mov_b32 s30, 0x700000
    s_mov_b32 s31, 0x20000
    s_cmp_lt_u32 s3, 4
    s_cselect_b32 s16, s6, s8
    s_cselect_b32 s17, s7, s9
    s_mov_b32 s18, 7340032
    s_mov_b32 s19, 0x20000
    v_lshlrev_b32 v3, 4, v0
    s_mov_b32 s27, 0x3400000
    buffer_load_dwordx4 v[8:11], v3, s[20:23], s27 offen
    s_add_u32 s27, s27, 8192
    buffer_load_dwordx4 v[12:15], v3, s[20:23], s27 offen
    s_add_u32 s27, s27, 8192
    buffer_load_dwordx4 v[16:19], v3, s[20:23], s27 offen
    v_lshlrev_b32 v4, 5, v2
    buffer_load_dwordx4 v[20:23], v4, s[12:15], 0 offen
    buffer_load_dwordx4 v[24:27], v4, s[12:15], 0 offen offset:16
    s_mov_b32 s48, s44
    s_mov_b32 s49, s45
    s_mov_b32 s50, 0x400000
    s_mov_b32 s51, 0x20000
    s_lshl_b32 s27, s2, 14
    s_add_u32 s27, s27, 0x3000000
    buffer_load_dwordx4 v[100:103], v3, s[20:23], s27 offen
    s_add_u32 s27, s27, 8192
    buffer_load_dwordx4 v[104:107], v3, s[20:23], s27 offen
    s_cmp_lt_u32 s25, 28
    s_cselect_b32 s33, 0, 0x10000000
    v_lshrrev_b32 v5, 1, v2
    v_mul_u32_u24 v5, 7168, v5
    v_and_b32 v6, 1, v2
    v_lshl_add_u32 v5, v6, 4, v5
    v_add_u32 v5, s33, v5
    s_and_b32 s34, s3, 3
    s_mul_i32 s34, s34, 1835008
    s_lshl_b32 s35, s26, 5
    s_add_u32 s34, s34, s35
    buffer_load_dwordx4 v[32:35], v5, s[16:19], s34 offen
    s_add_u32 s34, s34, 229376
    buffer_load_dwordx4 v[36:39], v5, s[16:19], s34 offen
    s_add_u32 s34, s34, 229376
    buffer_load_dwordx4 v[40:43], v5, s[16:19], s34 offen
    s_add_u32 s34, s34, 229376
    buffer_load_dwordx4 v[44:47], v5, s[16:19], s34 offen
    s_add_u32 s34, s34, 229376
    buffer_load_dwordx4 v[48:51], v5, s[16:19], s34 offen
    s_add_u32 s34, s34, 229376
    buffer_load_dwordx4 v[52:55], v5, s[16:19], s34 offen
    s_add_u32 s34, s34, 229376
    buffer_load_dwordx4 v[56:59], v5, s[16:19], s34 offen
    s_add_u32 s34, s34, 229376
    buffer_load_dwordx4 v[60:63], v5, s[16:19], s34 offen
    v_lshrrev_b32 v6, 4, v2
    v_lshlrev_b32 v6, 11, v6
    v_and_b32 v7, 15, v2
    v_lshl_add_u32 v6, v7, 4, v6
    v_add_u32 v6, s33, v6
    s_lshl_b32 s34, s26, 15
    s_lshl_b32 s35, s3, 8
    s_add_u32 s34, s34, s35
    buffer_load_dwordx4 v[64:67], v6, s[28:31], s34 offen
    s_add_u32 s34, s34, 8192
    buffer_load_dwordx4 v[68:71], v6, s[28:31], s34 offen
    s_add_u32 s34, s34, 8192
    buffer_load_dwordx4 v[72:75], v6, s[28:31], s34 offen
    s_add_u32 s34, s34, 8192
    buffer_load_dwordx4 v[76:79], v6, s[28:31], s34 offen
    s_waitcnt vmcnt(14)
    v_mov_b32 v28, 0
    v_lshlrev_b32 v29, 16, v20
    v_and_b32 v30, 0xffff0000, v20
    v_add_f32 v28, v28, v29
    v_add_f32 v28, v28, v30
    v_lshlrev_b32 v29, 16, v21
    v_and_b32 v30, 0xffff0000, v21
    v_add_f32 v28, v28, v29
    v_add_f32 v28, v28, v30
    v_lshlrev_b32 v29, 16, v22
    v_and_b32 v30, 0xffff0000, v22
    v_add_f32 v28, v28, v29
    v_add_f32 v28, v28, v30
    v_lshlrev_b32 v29, 16, v23
    v_and_b32 v30, 0xffff0000, v23
    v_add_f32 v28, v28, v29
    v_add_f32 v28, v28, v30
    v_lshlrev_b32 v29, 16, v24
    v_and_b32 v30, 0xffff0000, v24
    v_add_f32 v28, v28, v29
    v_add_f32 v28, v28, v30
    v_lshlrev_b32 v29, 16, v25
    v_and_b32 v30, 0xffff0000, v25
    v_add_f32 v28, v28, v29
    v_add_f32 v28, v28, v30
    v_lshlrev_b32 v29, 16, v26
    v_and_b32 v30, 0xffff0000, v26
    v_add_f32 v28, v28, v29
    v_add_f32 v28, v28, v30
    v_lshlrev_b32 v29, 16, v27
    v_and_b32 v30, 0xffff0000, v27
    v_add_f32 v28, v28, v29
    v_add_f32 v28, v28, v30
    s_nop 1
    v_add_f32_dpp v28, v28, v28 quad_perm:[1,0,3,2] row_mask:0xf bank_mask:0xf
    s_nop 1
    v_add_f32_dpp v28, v28, v28 quad_perm:[2,3,0,1] row_mask:0xf bank_mask:0xf
    s_nop 1
    v_add_f32_dpp v28, v28, v28 row_half_mirror row_mask:0xf bank_mask:0xf
    s_nop 1
    v_add_f32_dpp v28, v28, v28 row_mirror row_mask:0xf bank_mask:0xf
    v_mov_b32 v29, v28
    s_nop 1
    v_permlane16_swap_b32 v28, v29
    v_add_f32 v28, v28, v29
    v_mov_b32 v29, v28
    s_nop 1
    v_permlane32_swap_b32 v28, v29
    v_add_f32 v28, v28, v29
    v_mul_f32 v8, 0x3a800000, v8
    v_mul_f32 v20, 0x3a800000, v12
    v_fma_f32 v20, -v8, v8, v20
    v_max_f32 v20, 0, v20
    v_add_f32 v12, 0x3727c5ac, v20
    v_rsq_f32 v12, v12
    v_fma_f32 v16, -v8, v28, v16
    v_mul_f32 v16, v16, v12
    v_mul_f32 v9, 0x3a800000, v9
    v_mul_f32 v21, 0x3a800000, v13
    v_fma_f32 v21, -v9, v9, v21
    v_max_f32 v21, 0, v21
    v_add_f32 v13, 0x3727c5ac, v21
    v_rsq_f32 v13, v13
    v_fma_f32 v17, -v9, v28, v17
    v_mul_f32 v17, v17, v13
    v_mul_f32 v10, 0x3a800000, v10
    v_mul_f32 v22, 0x3a800000, v14
    v_fma_f32 v22, -v10, v10, v22
    v_max_f32 v22, 0, v22
    v_add_f32 v14, 0x3727c5ac, v22
    v_rsq_f32 v14, v14
    v_fma_f32 v18, -v10, v28, v18
    v_mul_f32 v18, v18, v14
    v_mul_f32 v11, 0x3a800000, v11
    v_mul_f32 v23, 0x3a800000, v15
    v_fma_f32 v23, -v11, v11, v23
    v_max_f32 v23, 0, v23
    v_add_f32 v15, 0x3727c5ac, v23
    v_rsq_f32 v15, v15
    v_fma_f32 v19, -v11, v28, v19
    v_mul_f32 v19, v19, v15
    ds_write_b128 v3, v[8:11]
    ds_write_b128 v3, v[12:15] offset:8192
    ds_write_b128 v3, v[16:19] offset:16384
    v_max3_f32 v29, v16, v17, v18
    v_max_f32 v29, v29, v19
    s_nop 1
    v_max_f32_dpp v29, v29, v29 quad_perm:[1,0,3,2] row_mask:0xf bank_mask:0xf
    s_nop 1
    v_max_f32_dpp v29, v29, v29 quad_perm:[2,3,0,1] row_mask:0xf bank_mask:0xf
    s_nop 1
    v_max_f32_dpp v29, v29, v29 row_half_mirror row_mask:0xf bank_mask:0xf
    s_nop 1
    v_max_f32_dpp v29, v29, v29 row_mirror row_mask:0xf bank_mask:0xf
    v_mov_b32 v30, v29
    s_nop 1
    v_permlane16_swap_b32 v29, v30
    v_max_f32 v29, v29, v30
    v_mov_b32 v30, v29
    s_nop 1
    v_permlane32_swap_b32 v29, v30
    v_max_f32 v29, v29, v30
    v_lshlrev_b32 v30, 2, v1
    ds_write_b32 v30, v29 offset:24576
    v_mov_b32 v31, 0x7fffffff
    v_mov_b32 v30, 0
    ds_write_b32 v30, v31 offset:24640
    s_waitcnt lgkmcnt(0)
    s_barrier
    ds_read_b128 v[92:95], v30 offset:24576
    ds_read_b128 v[96:99], v30 offset:24592
    s_waitcnt lgkmcnt(0)
    v_max3_f32 v29, v92, v93, v94
    v_max3_f32 v29, v29, v95, v96
    v_max3_f32 v29, v29, v97, v98
    v_max_f32 v29, v29, v99
    v_lshlrev_b32 v92, 2, v0
    v_cmp_eq_f32 vcc, v29, v19
    v_add_u32 v93, 3, v92
    s_nop 0
    v_cndmask_b32 v31, v31, v93, vcc
    v_cmp_eq_f32 vcc, v29, v18
    v_add_u32 v93, 2, v92
    s_nop 0
    v_cndmask_b32 v31, v31, v93, vcc
    v_cmp_eq_f32 vcc, v29, v17
    v_add_u32 v93, 1, v92
    s_nop 0
    v_cndmask_b32 v31, v31, v93, vcc
    v_cmp_eq_f32 vcc, v29, v16
    v_add_u32 v93, 0, v92
    s_nop 0
    v_cndmask_b32 v31, v31, v93, vcc
    v_cmp_gt_u32 vcc, 0x7fffffff, v31
    s_and_saveexec_b64 s[36:37], vcc
    ds_min_u32 v30, v31 offset:24640
    s_mov_b64 exec, s[36:37]
    s_waitcnt lgkmcnt(0)
    s_barrier
    ds_read_b32 v31, v30 offset:24640
    s_waitcnt lgkmcnt(0)
    v_and_b32 v31, 2047, v31
    v_lshlrev_b32 v92, 2, v31
    ds_read_b32 v93, v92
    ds_read_b32 v94, v92 offset:8192
    v_lshrrev_b32 v95, 7, v31
    v_lshlrev_b32 v95, 18, v95
    v_bfe_u32 v96, v31, 5, 2
    v_lshl_add_u32 v95, v96, 12, v95
    v_and_b32 v96, 31, v31
    v_lshl_add_u32 v95, v96, 4, v95
    v_bfe_u32 v96, v0, 3, 4
    v_lshl_add_u32 v95, v96, 14, v95
    v_and_b32 v96, 7, v0
    v_lshl_add_u32 v95, v96, 9, v95
    s_mov_b32 s27, 0x3000000
    buffer_load_dwordx4 v[108:111], v95, s[20:23], s27 offen
    s_waitcnt lgkmcnt(0)
    v_mov_b32 v112, v31
    v_mov_b32 v113, v29
    v_mov_b32 v114, v93
    v_mov_b32 v115, v94
    v_or_b32 v96, s2, v0
    v_cmp_eq_u32 vcc, 0, v96
    s_and_saveexec_b64 s[36:37], vcc
    s_mov_b32 s27, 0x3450000
    buffer_store_dwordx4 v[112:115], v30, s[20:23], s27 offen
    s_mov_b64 exec, s[36:37]
    s_lshr_b32 s38, s2, 4
    s_and_b32 s39, s2, 15
    s_lshr_b32 s40, s3, 2
    s_lshl_b32 s41, s38, 7
    s_lshl_b32 s42, s40, 5
    s_add_u32 s41, s41, s42
    v_and_b32 v96, 31, v2
    v_add_u32 v96, s41, v96
    v_lshlrev_b32 v97, 2, v96
    ds_read_b32 v116, v97
    ds_read_b32 v117, v97 offset:8192
    ds_read_b32 v118, v97 offset:256
    ds_read_b32 v119, v97 offset:8448
    v_lshlrev_b32 v96, 11, v96
    v_lshrrev_b32 v97, 5, v2
    v_lshl_add_u32 v96, v97, 4, v96
    s_and_b32 s42, s3, 3
    s_lshl_b32 s42, s42, 5
    s_lshl_b32 s39, s39, 7
    s_add_u32 s42, s42, s39
    s_waitcnt lgkmcnt(0)
    v_mul_f32 v116, v116, v117
    v_add_f32 v117, 1.0, v117
    v_lshlrev_b32 v120, 16, v100
    v_and_b32 v121, 0xffff0000, v100
    v_fma_f32 v120, v120, v117, -v116
    v_fma_f32 v121, v121, v117, -v116
    v_cvt_pk_bf16_f32 v100, v120, v121
    v_lshlrev_b32 v120, 16, v101
    v_and_b32 v121, 0xffff0000, v101
    v_fma_f32 v120, v120, v117, -v116
    v_fma_f32 v121, v121, v117, -v116
    v_cvt_pk_bf16_f32 v101, v120, v121
    v_lshlrev_b32 v120, 16, v102
    v_and_b32 v121, 0xffff0000, v102
    v_fma_f32 v120, v120, v117, -v116
    v_fma_f32 v121, v121, v117, -v116
    v_cvt_pk_bf16_f32 v102, v120, v121
    v_lshlrev_b32 v120, 16, v103
    v_and_b32 v121, 0xffff0000, v103
    v_fma_f32 v120, v120, v117, -v116
    v_fma_f32 v121, v121, v117, -v116
    v_cvt_pk_bf16_f32 v103, v120, v121
    v_permlane32_swap_b32 v100, v102
    s_nop 0
    v_permlane32_swap_b32 v101, v103
    buffer_store_dwordx4 v[100:103], v96, s[48:51], s42 offen
    s_add_u32 s42, s42, 131072
    v_mul_f32 v118, v118, v119
    v_add_f32 v119, 1.0, v119
    v_lshlrev_b32 v120, 16, v104
    v_and_b32 v121, 0xffff0000, v104
    v_fma_f32 v120, v120, v119, -v118
    v_fma_f32 v121, v121, v119, -v118
    v_cvt_pk_bf16_f32 v104, v120, v121
    v_lshlrev_b32 v120, 16, v105
    v_and_b32 v121, 0xffff0000, v105
    v_fma_f32 v120, v120, v119, -v118
    v_fma_f32 v121, v121, v119, -v118
    v_cvt_pk_bf16_f32 v105, v120, v121
    v_lshlrev_b32 v120, 16, v106
    v_and_b32 v121, 0xffff0000, v106
    v_fma_f32 v120, v120, v119, -v118
    v_fma_f32 v121, v121, v119, -v118
    v_cvt_pk_bf16_f32 v106, v120, v121
    v_lshlrev_b32 v120, 16, v107
    v_and_b32 v121, 0xffff0000, v107
    v_fma_f32 v120, v120, v119, -v118
    v_fma_f32 v121, v121, v119, -v118
    v_cvt_pk_bf16_f32 v107, v120, v121
    v_permlane32_swap_b32 v104, v106
    s_nop 0
    v_permlane32_swap_b32 v105, v107
    buffer_store_dwordx4 v[104:107], v96, s[48:51], s42 offen
    s_add_u32 s42, s42, 131072
    s_waitcnt vmcnt(3)
    v_lshlrev_b32 v120, 16, v108
    v_and_b32 v121, 0xffff0000, v108
    v_lshlrev_b32 v122, 16, v109
    v_and_b32 v123, 0xffff0000, v109
    v_lshlrev_b32 v124, 16, v110
    v_and_b32 v125, 0xffff0000, v110
    v_lshlrev_b32 v126, 16, v111
    v_and_b32 v127, 0xffff0000, v111
    v_sub_f32 v120, v120, v93
    v_mul_f32 v120, v120, v94
    v_sub_f32 v121, v121, v93
    v_mul_f32 v121, v121, v94
    v_sub_f32 v122, v122, v93
    v_mul_f32 v122, v122, v94
    v_sub_f32 v123, v123, v93
    v_mul_f32 v123, v123, v94
    v_sub_f32 v124, v124, v93
    v_mul_f32 v124, v124, v94
    v_sub_f32 v125, v125, v93
    v_mul_f32 v125, v125, v94
    v_sub_f32 v126, v126, v93
    v_mul_f32 v126, v126, v94
    v_sub_f32 v127, v127, v93
    v_mul_f32 v127, v127, v94
    v_lshrrev_b32 v96, 1, v0
    v_lshlrev_b32 v96, 6, v96
    v_and_b32 v97, 1, v0
    v_lshl_add_u32 v96, v97, 4, v96
    v_cmp_gt_u32 vcc, 128, v0
    s_and_saveexec_b64 s[36:37], vcc
    ds_write_b128 v96, v[120:123] offset:32768
    ds_write_b128 v96, v[124:127] offset:32800
    s_mov_b64 exec, s[36:37]
    s_waitcnt lgkmcnt(0)
    s_barrier
    s_and_b32 s34, s3, 3
    s_lshl_b32 s34, s34, 10
    v_lshrrev_b32 v96, 1, v2
    v_lshl_add_u32 v96, v96, 2, s34
    ds_read_b32 v108, v96 offset:32768
    ds_read_b32 v109, v96 offset:32896
    ds_read_b32 v110, v96 offset:33024
    ds_read_b32 v111, v96 offset:33152
    ds_read_b32 v112, v96 offset:33280
    ds_read_b32 v113, v96 offset:33408
    ds_read_b32 v114, v96 offset:33536
    ds_read_b32 v115, v96 offset:33664
    s_waitcnt lgkmcnt(0)
    v_lshlrev_b32 v116, 16, v32
    v_and_b32 v117, 0xffff0000, v32
    v_mul_f32 v120, v116, v108
    v_mul_f32 v121, v117, v108
    v_lshlrev_b32 v116, 16, v33
    v_and_b32 v117, 0xffff0000, v33
    v_mul_f32 v122, v116, v108
    v_mul_f32 v123, v117, v108
    v_lshlrev_b32 v116, 16, v34
    v_and_b32 v117, 0xffff0000, v34
    v_mul_f32 v124, v116, v108
    v_mul_f32 v125, v117, v108
    v_lshlrev_b32 v116, 16, v35
    v_and_b32 v117, 0xffff0000, v35
    v_mul_f32 v126, v116, v108
    v_mul_f32 v127, v117, v108
    v_lshlrev_b32 v116, 16, v36
    v_and_b32 v117, 0xffff0000, v36
    v_fmac_f32 v120, v116, v109
    v_fmac_f32 v121, v117, v109
    v_lshlrev_b32 v116, 16, v37
    v_and_b32 v117, 0xffff0000, v37
    v_fmac_f32 v122, v116, v109
    v_fmac_f32 v123, v117, v109
    v_lshlrev_b32 v116, 16, v38
    v_and_b32 v117, 0xffff0000, v38
    v_fmac_f32 v124, v116, v109
    v_fmac_f32 v125, v117, v109
    v_lshlrev_b32 v116, 16, v39
    v_and_b32 v117, 0xffff0000, v39
    v_fmac_f32 v126, v116, v109
    v_fmac_f32 v127, v117, v109
    v_lshlrev_b32 v116, 16, v40
    v_and_b32 v117, 0xffff0000, v40
    v_fmac_f32 v120, v116, v110
    v_fmac_f32 v121, v117, v110
    v_lshlrev_b32 v116, 16, v41
    v_and_b32 v117, 0xffff0000, v41
    v_fmac_f32 v122, v116, v110
    v_fmac_f32 v123, v117, v110
    v_lshlrev_b32 v116, 16, v42
    v_and_b32 v117, 0xffff0000, v42
    v_fmac_f32 v124, v116, v110
    v_fmac_f32 v125, v117, v110
    v_lshlrev_b32 v116, 16, v43
    v_and_b32 v117, 0xffff0000, v43
    v_fmac_f32 v126, v116, v110
    v_fmac_f32 v127, v117, v110
    v_lshlrev_b32 v116, 16, v44
    v_and_b32 v117, 0xffff0000, v44
    v_fmac_f32 v120, v116, v111
    v_fmac_f32 v121, v117, v111
    v_lshlrev_b32 v116, 16, v45
    v_and_b32 v117, 0xffff0000, v45
    v_fmac_f32 v122, v116, v111
    v_fmac_f32 v123, v117, v111
    v_lshlrev_b32 v116, 16, v46
    v_and_b32 v117, 0xffff0000, v46
    v_fmac_f32 v124, v116, v111
    v_fmac_f32 v125, v117, v111
    v_lshlrev_b32 v116, 16, v47
    v_and_b32 v117, 0xffff0000, v47
    v_fmac_f32 v126, v116, v111
    v_fmac_f32 v127, v117, v111
    v_lshlrev_b32 v116, 16, v48
    v_and_b32 v117, 0xffff0000, v48
    v_fmac_f32 v120, v116, v112
    v_fmac_f32 v121, v117, v112
    v_lshlrev_b32 v116, 16, v49
    v_and_b32 v117, 0xffff0000, v49
    v_fmac_f32 v122, v116, v112
    v_fmac_f32 v123, v117, v112
    v_lshlrev_b32 v116, 16, v50
    v_and_b32 v117, 0xffff0000, v50
    v_fmac_f32 v124, v116, v112
    v_fmac_f32 v125, v117, v112
    v_lshlrev_b32 v116, 16, v51
    v_and_b32 v117, 0xffff0000, v51
    v_fmac_f32 v126, v116, v112
    v_fmac_f32 v127, v117, v112
    v_lshlrev_b32 v116, 16, v52
    v_and_b32 v117, 0xffff0000, v52
    v_fmac_f32 v120, v116, v113
    v_fmac_f32 v121, v117, v113
    v_lshlrev_b32 v116, 16, v53
    v_and_b32 v117, 0xffff0000, v53
    v_fmac_f32 v122, v116, v113
    v_fmac_f32 v123, v117, v113
    v_lshlrev_b32 v116, 16, v54
    v_and_b32 v117, 0xffff0000, v54
    v_fmac_f32 v124, v116, v113
    v_fmac_f32 v125, v117, v113
    v_lshlrev_b32 v116, 16, v55
    v_and_b32 v117, 0xffff0000, v55
    v_fmac_f32 v126, v116, v113
    v_fmac_f32 v127, v117, v113
    v_lshlrev_b32 v116, 16, v56
    v_and_b32 v117, 0xffff0000, v56
    v_fmac_f32 v120, v116, v114
    v_fmac_f32 v121, v117, v114
    v_lshlrev_b32 v116, 16, v57
    v_and_b32 v117, 0xffff0000, v57
    v_fmac_f32 v122, v116, v114
    v_fmac_f32 v123, v117, v114
    v_lshlrev_b32 v116, 16, v58
    v_and_b32 v117, 0xffff0000, v58
    v_fmac_f32 v124, v116, v114
    v_fmac_f32 v125, v117, v114
    v_lshlrev_b32 v116, 16, v59
    v_and_b32 v117, 0xffff0000, v59
    v_fmac_f32 v126, v116, v114
    v_fmac_f32 v127, v117, v114
    v_lshlrev_b32 v116, 16, v60
    v_and_b32 v117, 0xffff0000, v60
    v_fmac_f32 v120, v116, v115
    v_fmac_f32 v121, v117, v115
    v_lshlrev_b32 v116, 16, v61
    v_and_b32 v117, 0xffff0000, v61
    v_fmac_f32 v122, v116, v115
    v_fmac_f32 v123, v117, v115
    v_lshlrev_b32 v116, 16, v62
    v_and_b32 v117, 0xffff0000, v62
    v_fmac_f32 v124, v116, v115
    v_fmac_f32 v125, v117, v115
    v_lshlrev_b32 v116, 16, v63
    v_and_b32 v117, 0xffff0000, v63
    v_fmac_f32 v126, v116, v115
    v_fmac_f32 v127, v117, v115
    v_permlane32_swap_b32 v120, v124
    v_permlane32_swap_b32 v121, v125
    v_permlane32_swap_b32 v122, v126
    v_permlane32_swap_b32 v123, v127
    v_add_f32 v120, v120, v124
    v_add_f32 v121, v121, v125
    v_add_f32 v122, v122, v126
    v_add_f32 v123, v123, v127
    s_nop 0
    v_permlane16_swap_b32 v120, v122
    v_permlane16_swap_b32 v121, v123
    v_add_f32 v120, v120, v122
    v_add_f32 v121, v121, v123
    s_nop 0
    v_add_f32_dpp v120, v120, v120 quad_perm:[2,3,0,1] row_mask:0xf bank_mask:0xf
    v_add_f32_dpp v121, v121, v121 quad_perm:[2,3,0,1] row_mask:0xf bank_mask:0xf
    s_nop 0
    v_add_f32_dpp v120, v120, v120 row_ror:4 row_mask:0xf bank_mask:0xf
    v_add_f32_dpp v121, v121, v121 row_ror:4 row_mask:0xf bank_mask:0xf
    s_nop 0
    v_add_f32_dpp v120, v120, v120 row_ror:8 row_mask:0xf bank_mask:0xf
    v_add_f32_dpp v121, v121, v121 row_ror:8 row_mask:0xf bank_mask:0xf
    v_and_b32 v96, 1, v2
    v_lshrrev_b32 v97, 4, v2
    v_lshlrev_b32 v97, 3, v97
    v_lshl_add_u32 v96, v96, 5, v97
    s_lshl_b32 s34, s3, 6
    v_add_u32 v96, s34, v96
    ds_write_b64 v96, v[120:121] offset:40960
    s_waitcnt lgkmcnt(0)
    s_barrier
    v_and_b32 v96, 15, v2
    v_lshlrev_b32 v96, 2, v96
    ds_read_b32 v108, v96 offset:40960
    ds_read_b32 v109, v96 offset:41024
    ds_read_b32 v110, v96 offset:41088
    ds_read_b32 v111, v96 offset:41152
    ds_read_b32 v112, v96 offset:41216
    ds_read_b32 v113, v96 offset:41280
    ds_read_b32 v114, v96 offset:41344
    ds_read_b32 v115, v96 offset:41408
    s_waitcnt lgkmcnt(0)
    v_add_f32 v108, v108, v109
    v_add_f32 v110, v110, v111
    v_add_f32 v112, v112, v113
    v_add_f32 v114, v114, v115
    v_add_f32 v108, v108, v110
    v_add_f32 v112, v112, v114
    v_mul_f32 v109, 0xbfb8aa3b, v108
    v_exp_f32 v109, v109
    s_nop 0
    v_add_f32 v109, 1.0, v109
    v_rcp_f32 v109, v109
    s_nop 0
    v_mul_f32 v108, v108, v109
    v_mul_f32 v108, v108, v112
    v_lshrrev_b32 v96, 4, v2
    v_lshlrev_b32 v96, 2, v96
    ds_bpermute_b32 v112, v96, v108 offset:0
    ds_bpermute_b32 v113, v96, v108 offset:16
    ds_bpermute_b32 v114, v96, v108 offset:32
    ds_bpermute_b32 v115, v96, v108 offset:48
    s_waitcnt lgkmcnt(0)
    v_lshlrev_b32 v116, 16, v64
    v_and_b32 v117, 0xffff0000, v64
    v_mul_f32 v120, v116, v112
    v_mul_f32 v121, v117, v112
    v_lshlrev_b32 v116, 16, v65
    v_and_b32 v117, 0xffff0000, v65
    v_mul_f32 v122, v116, v112
    v_mul_f32 v123, v117, v112
    v_lshlrev_b32 v116, 16, v66
    v_and_b32 v117, 0xffff0000, v66
    v_mul_f32 v124, v116, v112
    v_mul_f32 v125, v117, v112
    v_lshlrev_b32 v116, 16, v67
    v_and_b32 v117, 0xffff0000, v67
    v_mul_f32 v126, v116, v112
    v_mul_f32 v127, v117, v112
    v_lshlrev_b32 v116, 16, v68
    v_and_b32 v117, 0xffff0000, v68
    v_fmac_f32 v120, v116, v113
    v_fmac_f32 v121, v117, v113
    v_lshlrev_b32 v116, 16, v69
    v_and_b32 v117, 0xffff0000, v69
    v_fmac_f32 v122, v116, v113
    v_fmac_f32 v123, v117, v113
    v_lshlrev_b32 v116, 16, v70
    v_and_b32 v117, 0xffff0000, v70
    v_fmac_f32 v124, v116, v113
    v_fmac_f32 v125, v117, v113
    v_lshlrev_b32 v116, 16, v71
    v_and_b32 v117, 0xffff0000, v71
    v_fmac_f32 v126, v116, v113
    v_fmac_f32 v127, v117, v113
    v_lshlrev_b32 v116, 16, v72
    v_and_b32 v117, 0xffff0000, v72
    v_fmac_f32 v120, v116, v114
    v_fmac_f32 v121, v117, v114
    v_lshlrev_b32 v116, 16, v73
    v_and_b32 v117, 0xffff0000, v73
    v_fmac_f32 v122, v116, v114
    v_fmac_f32 v123, v117, v114
    v_lshlrev_b32 v116, 16, v74
    v_and_b32 v117, 0xffff0000, v74
    v_fmac_f32 v124, v116, v114
    v_fmac_f32 v125, v117, v114
    v_lshlrev_b32 v116, 16, v75
    v_and_b32 v117, 0xffff0000, v75
    v_fmac_f32 v126, v116, v114
    v_fmac_f32 v127, v117, v114
    v_lshlrev_b32 v116, 16, v76
    v_and_b32 v117, 0xffff0000, v76
    v_fmac_f32 v120, v116, v115
    v_fmac_f32 v121, v117, v115
    v_lshlrev_b32 v116, 16, v77
    v_and_b32 v117, 0xffff0000, v77
    v_fmac_f32 v122, v116, v115
    v_fmac_f32 v123, v117, v115
    v_lshlrev_b32 v116, 16, v78
    v_and_b32 v117, 0xffff0000, v78
    v_fmac_f32 v124, v116, v115
    v_fmac_f32 v125, v117, v115
    v_lshlrev_b32 v116, 16, v79
    v_and_b32 v117, 0xffff0000, v79
    v_fmac_f32 v126, v116, v115
    v_fmac_f32 v127, v117, v115
    v_permlane32_swap_b32 v120, v124
    v_permlane32_swap_b32 v121, v125
    v_permlane32_swap_b32 v122, v126
    v_permlane32_swap_b32 v123, v127
    v_add_f32 v120, v120, v124
    v_add_f32 v121, v121, v125
    v_add_f32 v122, v122, v126
    v_add_f32 v123, v123, v127
    s_nop 0
    v_permlane16_swap_b32 v120, v122
    v_permlane16_swap_b32 v121, v123
    v_add_f32 v120, v120, v122
    v_add_f32 v121, v121, v123
    s_cmp_ge_u32 s25, 28
    s_cbranch_scc1 ffn1_kernel_end
    v_and_b32 v96, 15, v2
    v_lshlrev_b32 v96, 5, v96
    v_lshrrev_b32 v97, 4, v2
    v_lshl_add_u32 v96, v97, 3, v96
    s_and_b32 s34, s26, 15
    s_lshl_b32 s34, s34, 12
    s_lshl_b32 s35, s3, 9
    s_add_u32 s34, s34, s35
    s_add_u32 s34, s34, 0x3410000
    buffer_atomic_add_f32 v120, v96, s[20:23], s34 offen sc1
    buffer_atomic_add_f32 v121, v96, s[20:23], s34 offen offset:4 sc1
ffn1_kernel_end:
    s_endpgm
.globl fix1_kernel
.p2align 8
.type fix1_kernel,@function
fix1_kernel:
    s_cmp_ge_u32 s2, 1
    s_cbranch_scc1 fix1_kernel_end
    s_load_dwordx2 s[44:45], s[0:1], 64
    s_load_dwordx2 s[46:47], s[0:1], 80
    s_waitcnt lgkmcnt(0)
    s_mov_b32 s20, s46
    s_mov_b32 s21, s47
    s_mov_b32 s22, 0x8000000
    s_mov_b32 s23, 0x20000
    s_mov_b32 s48, s44
    s_mov_b32 s49, s45
    s_mov_b32 s50, 0x400000
    s_mov_b32 s51, 0x20000
    v_mov_b32 v1, 0
    s_mov_b32 s27, 0x3450000
    buffer_load_dwordx4 v[4:7], v1, s[20:23], s27 offen
    v_lshlrev_b32 v2, 4, v0
    s_mov_b32 s27, 0x3410000
    buffer_load_dwordx4 v[16:19], v2, s[20:23], s27 offen
    s_add_u32 s27, s27, 4096
    buffer_load_dwordx4 v[20:23], v2, s[20:23], s27 offen
    s_add_u32 s27, s27, 4096
    buffer_load_dwordx4 v[24:27], v2, s[20:23], s27 offen
    s_add_u32 s27, s27, 4096
    buffer_load_dwordx4 v[28:31], v2, s[20:23], s27 offen
    s_add_u32 s27, s27, 4096
    buffer_load_dwordx4 v[32:35], v2, s[20:23], s27 offen
    s_add_u32 s27, s27, 4096
    buffer_load_dwordx4 v[36:39], v2, s[20:23], s27 offen
    s_add_u32 s27, s27, 4096
    buffer_load_dwordx4 v[40:43], v2, s[20:23], s27 offen
    s_add_u32 s27, s27, 4096
    buffer_load_dwordx4 v[44:47], v2, s[20:23], s27 offen
    s_add_u32 s27, s27, 4096
    buffer_load_dwordx4 v[48:51], v2, s[20:23], s27 offen
    s_add_u32 s27, s27, 4096
    buffer_load_dwordx4 v[52:55], v2, s[20:23], s27 offen
    s_add_u32 s27, s27, 4096
    buffer_load_dwordx4 v[56:59], v2, s[20:23], s27 offen
    s_add_u32 s27, s27, 4096
    buffer_load_dwordx4 v[60:63], v2, s[20:23], s27 offen
    s_add_u32 s27, s27, 4096
    buffer_load_dwordx4 v[64:67], v2, s[20:23], s27 offen
    s_add_u32 s27, s27, 4096
    buffer_load_dwordx4 v[68:71], v2, s[20:23], s27 offen
    s_add_u32 s27, s27, 4096
    buffer_load_dwordx4 v[72:75], v2, s[20:23], s27 offen
    s_add_u32 s27, s27, 4096
    buffer_load_dwordx4 v[76:79], v2, s[20:23], s27 offen
    s_add_u32 s27, s27, 4096
    s_waitcnt vmcnt(16)
    v_and_b32 v4, 2047, v4
    v_lshrrev_b32 v8, 7, v4
    v_lshlrev_b32 v8, 18, v8
    v_bfe_u32 v9, v4, 5, 2
    v_lshl_add_u32 v8, v9, 12, v8
    v_and_b32 v9, 31, v4
    v_lshl_add_u32 v8, v9, 4, v8
    v_lshrrev_b32 v9, 4, v0
    v_lshl_add_u32 v8, v9, 14, v8
    v_bfe_u32 v9, v0, 2, 2
    v_lshl_add_u32 v8, v9, 10, v8
    v_and_b32 v9, 1, v0
    v_lshl_add_u32 v8, v9, 9, v8
    v_bfe_u32 v9, v0, 1, 1
    v_lshl_add_u32 v8, v9, 3, v8
    s_mov_b32 s28, 0x3000000
    buffer_load_dwordx2 v[10:11], v8, s[20:23], s28 offen
    v_mul_f32 v5, 0xbfb8aa3b, v5
    v_exp_f32 v5, v5
    s_nop 0
    v_add_f32 v5, 1.0, v5
    v_rcp_f32 v5, v5
    v_mul_f32 v6, v6, v7
    v_add_f32 v7, 1.0, v7
    s_waitcnt vmcnt(0)
    v_add_f32 v16, v16, v20
    v_add_f32 v17, v17, v21
    v_add_f32 v18, v18, v22
    v_add_f32 v19, v19, v23
    v_add_f32 v16, v16, v24
    v_add_f32 v17, v17, v25
    v_add_f32 v18, v18, v26
    v_add_f32 v19, v19, v27
    v_add_f32 v16, v16, v28
    v_add_f32 v17, v17, v29
    v_add_f32 v18, v18, v30
    v_add_f32 v19, v19, v31
    v_add_f32 v16, v16, v32
    v_add_f32 v17, v17, v33
    v_add_f32 v18, v18, v34
    v_add_f32 v19, v19, v35
    v_add_f32 v16, v16, v36
    v_add_f32 v17, v17, v37
    v_add_f32 v18, v18, v38
    v_add_f32 v19, v19, v39
    v_add_f32 v16, v16, v40
    v_add_f32 v17, v17, v41
    v_add_f32 v18, v18, v42
    v_add_f32 v19, v19, v43
    v_add_f32 v16, v16, v44
    v_add_f32 v17, v17, v45
    v_add_f32 v18, v18, v46
    v_add_f32 v19, v19, v47
    v_add_f32 v16, v16, v48
    v_add_f32 v17, v17, v49
    v_add_f32 v18, v18, v50
    v_add_f32 v19, v19, v51
    v_add_f32 v16, v16, v52
    v_add_f32 v17, v17, v53
    v_add_f32 v18, v18, v54
    v_add_f32 v19, v19, v55
    v_add_f32 v16, v16, v56
    v_add_f32 v17, v17, v57
    v_add_f32 v18, v18, v58
    v_add_f32 v19, v19, v59
    v_add_f32 v16, v16, v60
    v_add_f32 v17, v17, v61
    v_add_f32 v18, v18, v62
    v_add_f32 v19, v19, v63
    v_add_f32 v16, v16, v64
    v_add_f32 v17, v17, v65
    v_add_f32 v18, v18, v66
    v_add_f32 v19, v19, v67
    v_add_f32 v16, v16, v68
    v_add_f32 v17, v17, v69
    v_add_f32 v18, v18, v70
    v_add_f32 v19, v19, v71
    v_add_f32 v16, v16, v72
    v_add_f32 v17, v17, v73
    v_add_f32 v18, v18, v74
    v_add_f32 v19, v19, v75
    v_add_f32 v16, v16, v76
    v_add_f32 v17, v17, v77
    v_add_f32 v18, v18, v78
    v_add_f32 v19, v19, v79
    v_lshlrev_b32 v12, 16, v10
    v_and_b32 v13, 0xffff0000, v10
    v_lshlrev_b32 v14, 16, v11
    v_and_b32 v15, 0xffff0000, v11
    v_fma_f32 v12, v12, v7, -v6
    v_fmac_f32 v12, v16, v5
    v_fma_f32 v13, v13, v7, -v6
    v_fmac_f32 v13, v17, v5
    v_fma_f32 v14, v14, v7, -v6
    v_fmac_f32 v14, v18, v5
    v_fma_f32 v15, v15, v7, -v6
    v_fmac_f32 v15, v19, v5
    v_cvt_pk_bf16_f32 v10, v12, v13
    v_cvt_pk_bf16_f32 v11, v14, v15
    v_lshlrev_b32 v8, 11, v4
    v_lshl_add_u32 v8, v0, 3, v8
    buffer_store_dwordx2 v[10:11], v8, s[48:51], 0 offen
fix1_kernel_end:
    s_endpgm
.section .rodata,"a"
.p2align 6
.amdhsa_kernel prep_kernel
  .amdhsa_next_free_vgpr 64
  .amdhsa_next_free_sgpr 102
  .amdhsa_accum_offset 64
  .amdhsa_group_segment_fixed_size 0
  .amdhsa_kernarg_size 88
  .amdhsa_user_sgpr_count 2
  .amdhsa_user_sgpr_kernarg_segment_ptr 1
  .amdhsa_system_sgpr_workgroup_id_x 1
.end_amdhsa_kernel
.p2align 6
.amdhsa_kernel qkv0_kernel
  .amdhsa_next_free_vgpr 216
  .amdhsa_next_free_sgpr 102
  .amdhsa_accum_offset 216
  .amdhsa_group_segment_fixed_size 0
  .amdhsa_kernarg_size 88
  .amdhsa_user_sgpr_count 2
  .amdhsa_user_sgpr_kernarg_segment_ptr 1
  .amdhsa_system_sgpr_workgroup_id_x 1
.end_amdhsa_kernel
.p2align 6
.amdhsa_kernel attn0_kernel
  .amdhsa_next_free_vgpr 160
  .amdhsa_next_free_sgpr 102
  .amdhsa_accum_offset 160
  .amdhsa_group_segment_fixed_size 0
  .amdhsa_kernarg_size 88
  .amdhsa_user_sgpr_count 2
  .amdhsa_user_sgpr_kernarg_segment_ptr 1
  .amdhsa_system_sgpr_workgroup_id_x 1
.end_amdhsa_kernel
.p2align 6
.amdhsa_kernel wo0_kernel
  .amdhsa_next_free_vgpr 216
  .amdhsa_next_free_sgpr 102
  .amdhsa_accum_offset 216
  .amdhsa_group_segment_fixed_size 0
  .amdhsa_kernarg_size 88
  .amdhsa_user_sgpr_count 2
  .amdhsa_user_sgpr_kernarg_segment_ptr 1
  .amdhsa_system_sgpr_workgroup_id_x 1
.end_amdhsa_kernel
.p2align 6
.amdhsa_kernel ffn0_kernel
  .amdhsa_next_free_vgpr 128
  .amdhsa_next_free_sgpr 102
  .amdhsa_accum_offset 128
  .amdhsa_group_segment_fixed_size 0
  .amdhsa_kernarg_size 88
  .amdhsa_user_sgpr_count 2
  .amdhsa_user_sgpr_kernarg_segment_ptr 1
  .amdhsa_system_sgpr_workgroup_id_x 1
.end_amdhsa_kernel
.p2align 6
.amdhsa_kernel fix0_kernel
  .amdhsa_next_free_vgpr 96
  .amdhsa_next_free_sgpr 102
  .amdhsa_accum_offset 96
  .amdhsa_group_segment_fixed_size 0
  .amdhsa_kernarg_size 88
  .amdhsa_user_sgpr_count 2
  .amdhsa_user_sgpr_kernarg_segment_ptr 1
  .amdhsa_system_sgpr_workgroup_id_x 1
.end_amdhsa_kernel
.p2align 6
.amdhsa_kernel qkv1_kernel
  .amdhsa_next_free_vgpr 216
  .amdhsa_next_free_sgpr 102
  .amdhsa_accum_offset 216
  .amdhsa_group_segment_fixed_size 0
  .amdhsa_kernarg_size 88
  .amdhsa_user_sgpr_count 2
  .amdhsa_user_sgpr_kernarg_segment_ptr 1
  .amdhsa_system_sgpr_workgroup_id_x 1
.end_amdhsa_kernel
.p2align 6
.amdhsa_kernel attn1_kernel
  .amdhsa_next_free_vgpr 160
  .amdhsa_next_free_sgpr 102
  .amdhsa_accum_offset 160
  .amdhsa_group_segment_fixed_size 0
  .amdhsa_kernarg_size 88
  .amdhsa_user_sgpr_count 2
  .amdhsa_user_sgpr_kernarg_segment_ptr 1
  .amdhsa_system_sgpr_workgroup_id_x 1
.end_amdhsa_kernel
.p2align 6
.amdhsa_kernel wo1_kernel
  .amdhsa_next_free_vgpr 216
  .amdhsa_next_free_sgpr 102
  .amdhsa_accum_offset 216
  .amdhsa_group_segment_fixed_size 0
  .amdhsa_kernarg_size 88
  .amdhsa_user_sgpr_count 2
  .amdhsa_user_sgpr_kernarg_segment_ptr 1
  .amdhsa_system_sgpr_workgroup_id_x 1
.end_amdhsa_kernel
.p2align 6
.amdhsa_kernel ffn1_kernel
  .amdhsa_next_free_vgpr 128
  .amdhsa_next_free_sgpr 102
  .amdhsa_accum_offset 128
  .amdhsa_group_segment_fixed_size 0
  .amdhsa_kernarg_size 88
  .amdhsa_user_sgpr_count 2
  .amdhsa_user_sgpr_kernarg_segment_ptr 1
  .amdhsa_system_sgpr_workgroup_id_x 1
.end_amdhsa_kernel
.p2align 6
.amdhsa_kernel fix1_kernel
  .amdhsa_next_free_vgpr 96
  .amdhsa_next_free_sgpr 102
  .amdhsa_accum_offset 96
  .amdhsa_group_segment_fixed_size 0
  .amdhsa_kernarg_size 88
  .amdhsa_user_sgpr_count 2
  .amdhsa_user_sgpr_kernarg_segment_ptr 1
  .amdhsa_system_sgpr_workgroup_id_x 1
.end_amdhsa_kernel
```

```asm
; @launch kernel=prep_kernel grid=(256,1,1) block=(512,1,1) lds=16384
; @launch kernel=qkv0_kernel grid=(256,1,1) block=(512,1,1) lds=163840
; @launch kernel=attn0_kernel grid=(256,1,1) block=(512,1,1) lds=98304
; @launch kernel=wo0_kernel grid=(256,1,1) block=(512,1,1) lds=163840
; @launch kernel=ffn0_kernel grid=(256,1,1) block=(512,1,1) lds=49152
; @launch kernel=fix0_kernel grid=(1,1,1) block=(256,1,1) lds=1024
; @launch kernel=qkv1_kernel grid=(256,1,1) block=(512,1,1) lds=163840
; @launch kernel=attn1_kernel grid=(256,1,1) block=(512,1,1) lds=98304
; @launch kernel=wo1_kernel grid=(256,1,1) block=(512,1,1) lds=163840
; @launch kernel=ffn1_kernel grid=(256,1,1) block=(512,1,1) lds=49152
; @launch kernel=fix1_kernel grid=(1,1,1) block=(256,1,1) lds=1024
.amdgcn_target "amdgcn-amd-amdhsa--gfx950"
.text
.globl prep_kernel
.p2align 8
.type prep_kernel,@function
prep_kernel:
    s_cmp_ge_u32 s2, 256
    s_cbranch_scc1 prep_kernel_exit
    s_load_dwordx4 s[4:7], s[0:1], 0
    s_load_dwordx2 s[8:9], s[0:1], 80
    v_lshrrev_b32 v1, 6, v0
    v_and_b32 v2, 63, v0
    v_readfirstlane_b32 s3, v1
    s_waitcnt lgkmcnt(0)
    s_mov_b32 s12, s4
    s_mov_b32 s13, s5
    s_mov_b32 s14, 0x400000
    s_mov_b32 s15, 0x20000
    s_mov_b32 s16, s6
    s_mov_b32 s17, s7
    s_mov_b32 s18, 0x600000
    s_mov_b32 s19, 0x20000
    s_mov_b32 s20, s8
    s_mov_b32 s21, s9
    s_mov_b32 s22, 0x8000000
    s_mov_b32 s23, 0x20000
    s_lshl_b32 s24, s2, 3
    s_add_u32 s24, s24, s3
    s_lshl_b32 s25, s24, 11
    v_lshlrev_b32 v3, 4, v2
    buffer_load_dwordx4 v[4:7], v3, s[12:15], s25 offen
    buffer_load_dwordx4 v[8:11], v3, s[12:15], s25 offen offset:1024
    s_mul_i32 s26, s2, 0x5556
    s_lshr_b32 s26, s26, 18
    s_mul_i32 s27, s26, 12
    s_sub_u32 s27, s2, s27
    s_lshl_b32 s28, s26, 6
    s_lshl_b32 s29, s3, 3
    s_add_u32 s28, s28, s29
    s_mul_i32 s28, s28, 6144
    s_lshl_b32 s29, s27, 9
    s_add_u32 s28, s28, s29
    v_lshrrev_b32 v12, 5, v2
    v_mul_u32_u24 v12, 6144, v12
    v_and_b32 v13, 31, v2
    v_lshl_add_u32 v12, v13, 4, v12
    buffer_load_dwordx4 v[16:19], v12, s[16:19], s28 offen
    s_add_u32 s28, s28, 12288
    buffer_load_dwordx4 v[20:23], v12, s[16:19], s28 offen
    s_add_u32 s28, s28, 12288
    buffer_load_dwordx4 v[24:27], v12, s[16:19], s28 offen
    s_add_u32 s28, s28, 12288
    buffer_load_dwordx4 v[28:31], v12, s[16:19], s28 offen
    s_add_u32 s28, s28, 12288
    v_mov_b32 v40, 0
    v_mov_b32 v41, 0
    s_lshr_b32 s30, s2, 7
    s_mul_i32 s30, s30, 33554432
    s_and_b32 s31, s2, 127
    s_lshl_b32 s31, s31, 10
    s_add_u32 s30, s30, s31
    s_add_u32 s30, s30, 0x1400000
    v_lshlrev_b32 v42, 1, v0
    v_and_b32 v42, 0x3fc, v42
    buffer_store_dword v40, v42, s[20:23], s30 offen
    s_waitcnt vmcnt(5)
    v_mov_b32 v32, 0
    v_mov_b32 v33, 0
    v_lshlrev_b32 v34, 16, v4
    v_and_b32 v35, 0xffff0000, v4
    v_add_f32 v32, v32, v34
    v_fmac_f32 v33, v34, v34
    v_add_f32 v32, v32, v35
    v_fmac_f32 v33, v35, v35
    v_lshlrev_b32 v34, 16, v5
    v_and_b32 v35, 0xffff0000, v5
    v_add_f32 v32, v32, v34
    v_fmac_f32 v33, v34, v34
    v_add_f32 v32, v32, v35
    v_fmac_f32 v33, v35, v35
    v_lshlrev_b32 v34, 16, v6
    v_and_b32 v35, 0xffff0000, v6
    v_add_f32 v32, v32, v34
    v_fmac_f32 v33, v34, v34
    v_add_f32 v32, v32, v35
    v_fmac_f32 v33, v35, v35
    v_lshlrev_b32 v34, 16, v7
    v_and_b32 v35, 0xffff0000, v7
    v_add_f32 v32, v32, v34
    v_fmac_f32 v33, v34, v34
    v_add_f32 v32, v32, v35
    v_fmac_f32 v33, v35, v35
    v_lshlrev_b32 v34, 16, v8
    v_and_b32 v35, 0xffff0000, v8
    v_add_f32 v32, v32, v34
    v_fmac_f32 v33, v34, v34
    v_add_f32 v32, v32, v35
    v_fmac_f32 v33, v35, v35
    v_lshlrev_b32 v34, 16, v9
    v_and_b32 v35, 0xffff0000, v9
    v_add_f32 v32, v32, v34
    v_fmac_f32 v33, v34, v34
    v_add_f32 v32, v32, v35
    v_fmac_f32 v33, v35, v35
    v_lshlrev_b32 v34, 16, v10
    v_and_b32 v35, 0xffff0000, v10
    v_add_f32 v32, v32, v34
    v_fmac_f32 v33, v34, v34
    v_add_f32 v32, v32, v35
    v_fmac_f32 v33, v35, v35
    v_lshlrev_b32 v34, 16, v11
    v_and_b32 v35, 0xffff0000, v11
    v_add_f32 v32, v32, v34
    v_fmac_f32 v33, v34, v34
    v_add_f32 v32, v32, v35
    v_fmac_f32 v33, v35, v35
    s_nop 0
    v_add_f32_dpp v32, v32, v32 quad_perm:[1,0,3,2] row_mask:0xf bank_mask:0xf
    s_nop 1
    v_add_f32_dpp v32, v32, v32 quad_perm:[2,3,0,1] row_mask:0xf bank_mask:0xf
    s_nop 1
    v_add_f32_dpp v32, v32, v32 row_half_mirror row_mask:0xf bank_mask:0xf
    s_nop 1
    v_add_f32_dpp v32, v32, v32 row_mirror row_mask:0xf bank_mask:0xf
    v_mov_b32 v36, v32
    s_nop 1
    v_permlane16_swap_b32 v32, v36
    v_add_f32 v32, v32, v36
    v_mov_b32 v36, v32
    s_nop 1
    v_permlane32_swap_b32 v32, v36
    v_add_f32 v32, v32, v36
    v_add_f32_dpp v33, v33, v33 quad_perm:[1,0,3,2] row_mask:0xf bank_mask:0xf
    s_nop 1
    v_add_f32_dpp v33, v33, v33 quad_perm:[2,3,0,1] row_mask:0xf bank_mask:0xf
    s_nop 1
    v_add_f32_dpp v33, v33, v33 row_half_mirror row_mask:0xf bank_mask:0xf
    s_nop 1
    v_add_f32_dpp v33, v33, v33 row_mirror row_mask:0xf bank_mask:0xf
    v_mov_b32 v36, v33
    s_nop 1
    v_permlane16_swap_b32 v33, v36
    v_add_f32 v33, v33, v36
    v_mov_b32 v36, v33
    s_nop 1
    v_permlane32_swap_b32 v33, v36
    v_add_f32 v33, v33, v36
    v_mul_f32 v32, 0x3a800000, v32
    v_mul_f32 v33, 0x3a800000, v33
    v_fma_f32 v33, -v32, v32, v33
    v_max_f32 v33, 0, v33
    v_add_f32 v33, 0x3727c5ac, v33
    v_rsq_f32 v33, v33
    s_lshl_b32 s24, s24, 2
    s_add_u32 s24, s24, 0x1440000
    v_lshlrev_b32 v37, 13, v2
    v_cmp_eq_u32 vcc, 0, v2
    s_nop 1
    v_cndmask_b32 v33, v32, v33, vcc
    s_mov_b64 exec, 3
    buffer_store_dword v33, v37, s[20:23], s24 offen
    s_mov_b64 exec, -1
    s_waitcnt vmcnt(2)
    v_lshlrev_b32 v44, 16, v16
    v_and_b32 v45, 0xffff0000, v16
    v_lshlrev_b32 v34, 16, v20
    v_and_b32 v35, 0xffff0000, v20
    v_add_f32 v44, v44, v34
    v_add_f32 v45, v45, v35
    v_lshlrev_b32 v34, 16, v24
    v_and_b32 v35, 0xffff0000, v24
    v_add_f32 v44, v44, v34
    v_add_f32 v45, v45, v35
    v_lshlrev_b32 v34, 16, v28
    v_and_b32 v35, 0xffff0000, v28
    v_add_f32 v44, v44, v34
    v_add_f32 v45, v45, v35
    v_lshlrev_b32 v46, 16, v17
    v_and_b32 v47, 0xffff0000, v17
    v_lshlrev_b32 v34, 16, v21
    v_and_b32 v35, 0xffff0000, v21
    v_add_f32 v46, v46, v34
    v_add_f32 v47, v47, v35
    v_lshlrev_b32 v34, 16, v25
    v_and_b32 v35, 0xffff0000, v25
    v_add_f32 v46, v46, v34
    v_add_f32 v47, v47, v35
    v_lshlrev_b32 v34, 16, v29
    v_and_b32 v35, 0xffff0000, v29
    v_add_f32 v46, v46, v34
    v_add_f32 v47, v47, v35
    v_lshlrev_b32 v48, 16, v18
    v_and_b32 v49, 0xffff0000, v18
    v_lshlrev_b32 v34, 16, v22
    v_and_b32 v35, 0xffff0000, v22
    v_add_f32 v48, v48, v34
    v_add_f32 v49, v49, v35
    v_lshlrev_b32 v34, 16, v26
    v_and_b32 v35, 0xffff0000, v26
    v_add_f32 v48, v48, v34
    v_add_f32 v49, v49, v35
    v_lshlrev_b32 v34, 16, v30
    v_and_b32 v35, 0xffff0000, v30
    v_add_f32 v48, v48, v34
    v_add_f32 v49, v49, v35
    v_lshlrev_b32 v50, 16, v19
    v_and_b32 v51, 0xffff0000, v19
    v_lshlrev_b32 v34, 16, v23
    v_and_b32 v35, 0xffff0000, v23
    v_add_f32 v50, v50, v34
    v_add_f32 v51, v51, v35
    v_lshlrev_b32 v34, 16, v27
    v_and_b32 v35, 0xffff0000, v27
    v_add_f32 v50, v50, v34
    v_add_f32 v51, v51, v35
    v_lshlrev_b32 v34, 16, v31
    v_and_b32 v35, 0xffff0000, v31
    v_add_f32 v50, v50, v34
    v_add_f32 v51, v51, v35
    v_lshlrev_b32 v52, 5, v0
    ds_write_b128 v52, v[44:47]
    ds_write_b128 v52, v[48:51] offset:16
    s_waitcnt lgkmcnt(0)
    s_barrier
    s_cmp_ge_u32 s3, 4
    s_cbranch_scc1 prep_kernel_end
    s_cmp_ge_u32 s2, 192
    s_cbranch_scc1 prep_kernel_end
    v_lshlrev_b32 v52, 2, v0
    ds_read_b32 v16, v52 offset:0
    ds_read_b32 v17, v52 offset:1024
    ds_read_b32 v18, v52 offset:2048
    ds_read_b32 v19, v52 offset:3072
    ds_read_b32 v20, v52 offset:4096
    ds_read_b32 v21, v52 offset:5120
    ds_read_b32 v22, v52 offset:6144
    ds_read_b32 v23, v52 offset:7168
    ds_read_b32 v24, v52 offset:8192
    ds_read_b32 v25, v52 offset:9216
    ds_read_b32 v26, v52 offset:10240
    ds_read_b32 v27, v52 offset:11264
    ds_read_b32 v28, v52 offset:12288
    ds_read_b32 v29, v52 offset:13312
    ds_read_b32 v30, v52 offset:14336
    ds_read_b32 v31, v52 offset:15360
    s_waitcnt lgkmcnt(0)
    v_add_f32 v16, v16, v17
    v_add_f32 v16, v16, v18
    v_add_f32 v16, v16, v19
    v_add_f32 v16, v16, v20
    v_add_f32 v16, v16, v21
    v_add_f32 v16, v16, v22
    v_add_f32 v16, v16, v23
    v_add_f32 v16, v16, v24
    v_add_f32 v16, v16, v25
    v_add_f32 v16, v16, v26
    v_add_f32 v16, v16, v27
    v_add_f32 v16, v16, v28
    v_add_f32 v16, v16, v29
    v_add_f32 v16, v16, v30
    v_add_f32 v16, v16, v31
    s_mul_i32 s26, s26, 12288
    s_lshl_b32 s27, s27, 10
    s_add_u32 s26, s26, s27
    s_add_u32 s26, s26, 0x4000000
    buffer_store_dword v16, v52, s[20:23], s26 offen
prep_kernel_end:
prep_kernel_exit:
    s_endpgm
.globl qkv0_kernel
.p2align 8
.type qkv0_kernel,@function
qkv0_kernel:
    s_cmp_ge_u32 s2, 256
    s_cbranch_scc1 qkv0_kernel_exit
    s_load_dwordx4 s[4:7], s[0:1], 0
    s_load_dwordx2 s[8:9], s[0:1], 80
    v_lshrrev_b32 v1, 6, v0
    v_and_b32 v2, 63, v0
    v_readfirstlane_b32 s3, v1
    s_and_b32 s24, s2, 7
    s_lshr_b32 s25, s2, 3
    s_lshr_b32 s26, s24, 2
    s_lshl_b32 s26, s26, 3
    s_and_b32 s27, s25, 7
    s_add_u32 s26, s26, s27
    s_and_b32 s27, s24, 3
    s_lshl_b32 s27, s27, 2
    s_lshr_b32 s25, s25, 3
    s_add_u32 s27, s27, s25
    s_waitcnt lgkmcnt(0)
    s_mov_b32 s20, s8
    s_mov_b32 s21, s9
    s_mov_b32 s22, 0x8000000
    s_mov_b32 s23, 0x20000
    s_cmp_lt_u32 s3, 4
    s_cbranch_scc1 qkv0_kernel_cons
    s_mov_b32 s12, s4
    s_mov_b32 s13, s5
    s_mov_b32 s14, 0x400000
    s_mov_b32 s15, 0x20000
    s_mov_b32 s16, s6
    s_mov_b32 s17, s7
    s_mov_b32 s18, 0x600000
    s_mov_b32 s19, 0x20000
    s_sub_u32 s3, s3, 4
    s_and_b32 s28, s3, 1
    s_lshl_b32 s28, s28, 2
    v_lshrrev_b32 v3, 4, v2
    v_add_u32 v3, s28, v3
    v_xor_b32 v3, v3, v2
    v_and_b32 v3, 7, v3
    v_lshlrev_b32 v3, 4, v3
    v_lshrrev_b32 v4, 3, v2
    v_lshl_add_u32 v3, v4, 11, v3
    s_lshl_b32 s28, s3, 14
    v_add_u32 v3, s28, v3
    s_lshl_b32 s30, s26, 18
    v_lshrrev_b32 v4, 3, v2
    s_lshl_b32 s28, s3, 3
    v_add_u32 v4, s28, v4
    v_mul_u32_u24 v4, 6144, v4
    v_lshrrev_b32 v5, 2, v2
    v_and_b32 v5, 4, v5
    v_xor_b32 v5, v5, v2
    v_and_b32 v5, 7, v5
    v_lshl_add_u32 v4, v5, 4, v4
    s_lshl_b32 s31, s27, 7
    s_lshl_b32 s32, s3, 10
    v_subrev_u32 v7, 256, v0
    v_lshrrev_b32 v8, 6, v7
    v_lshlrev_b32 v8, 12, v8
    v_lshl_add_u32 v8, v2, 2, v8
    s_lshl_b32 s33, s27, 8
    s_add_u32 s33, s33, 0x4000000
    buffer_load_dword v16, v8, s[20:23], s33 offen
    s_add_u32 s33, s33, 12288
    buffer_load_dword v17, v8, s[20:23], s33 offen
    s_add_u32 s33, s33, 12288
    buffer_load_dword v18, v8, s[20:23], s33 offen
    s_add_u32 s33, s33, 12288
    buffer_load_dword v19, v8, s[20:23], s33 offen
    s_add_u32 s33, s33, 12288
    buffer_load_dword v20, v8, s[20:23], s33 offen
    s_add_u32 s33, s33, 12288
    buffer_load_dword v21, v8, s[20:23], s33 offen
    s_add_u32 s33, s33, 12288
    buffer_load_dword v22, v8, s[20:23], s33 offen
    s_add_u32 s33, s33, 12288
    buffer_load_dword v23, v8, s[20:23], s33 offen
    s_add_u32 s33, s33, 12288
    buffer_load_dword v24, v8, s[20:23], s33 offen
    s_add_u32 s33, s33, 12288
    buffer_load_dword v25, v8, s[20:23], s33 offen
    s_add_u32 s33, s33, 12288
    buffer_load_dword v26, v8, s[20:23], s33 offen
    s_add_u32 s33, s33, 12288
    buffer_load_dword v27, v8, s[20:23], s33 offen
    s_add_u32 s33, s33, 12288
    buffer_load_dword v28, v8, s[20:23], s33 offen
    s_add_u32 s33, s33, 12288
    buffer_load_dword v29, v8, s[20:23], s33 offen
    s_add_u32 s33, s33, 12288
    buffer_load_dword v30, v8, s[20:23], s33 offen
    s_add_u32 s33, s33, 12288
    buffer_load_dword v31, v8, s[20:23], s33 offen
    s_add_u32 s33, s33, 12288
    v_lshrrev_b32 v9, 7, v7
    v_lshlrev_b32 v9, 13, v9
    v_and_b32 v10, 127, v7
    v_lshl_add_u32 v9, v10, 2, v9
    s_lshl_b32 s33, s26, 9
    s_add_u32 s33, s33, 0x1440000
    buffer_load_dword v32, v9, s[20:23], s33 offen
    s_mov_b32 s36, 4
qkv0_kernel_lpro:
    s_mov_b32 m0, s32
    s_mov_b32 s34, s30
    buffer_load_dwordx4 v3, s[12:15], s34 offen lds
    s_add_u32 m0, m0, 4096
    s_add_u32 s34, s34, 65536
    buffer_load_dwordx4 v3, s[12:15], s34 offen lds
    s_add_u32 m0, m0, 4096
    s_add_u32 s34, s34, 65536
    buffer_load_dwordx4 v3, s[12:15], s34 offen lds
    s_add_u32 m0, m0, 4096
    s_add_u32 s34, s34, 65536
    buffer_load_dwordx4 v3, s[12:15], s34 offen lds
    s_add_u32 m0, m0, 4096
    s_mov_b32 s34, s31
    buffer_load_dwordx4 v4, s[16:19], s34 offen lds
    s_add_u32 m0, m0, 4096
    s_add_u32 s34, s34, 196608
    buffer_load_dwordx4 v4, s[16:19], s34 offen lds
    s_add_u32 m0, m0, 4096
    s_sub_u32 s34, s34, 194560
    buffer_load_dwordx4 v4, s[16:19], s34 offen lds
    s_add_u32 m0, m0, 4096
    s_add_u32 s34, s34, 196608
    buffer_load_dwordx4 v4, s[16:19], s34 offen lds
    s_add_u32 m0, m0, 4096
    s_sub_u32 s34, s34, 194560
    buffer_load_dwordx4 v4, s[16:19], s34 offen lds
    s_add_u32 m0, m0, 4096
    s_add_u32 s34, s34, 196608
    buffer_load_dwordx4 v4, s[16:19], s34 offen lds
    s_add_u32 s30, s30, 128
    s_add_u32 s31, s31, 393216
    s_add_u32 s32, s32, 40960
    s_cmp_ge_u32 s32, 163840
    s_cselect_b32 s35, 163840, 0
    s_sub_u32 s32, s32, s35
    s_sub_u32 s36, s36, 1
    s_cmp_lg_u32 s36, 0
    s_cbranch_scc1 qkv0_kernel_lpro
    s_waitcnt vmcnt(30)
    v_add_f32 v16, v16, v17
    v_add_f32 v16, v16, v18
    v_add_f32 v16, v16, v19
    v_add_f32 v16, v16, v20
    v_add_f32 v16, v16, v21
    v_add_f32 v16, v16, v22
    v_add_f32 v16, v16, v23
    v_add_f32 v16, v16, v24
    v_add_f32 v16, v16, v25
    v_add_f32 v16, v16, v26
    v_add_f32 v16, v16, v27
    v_add_f32 v16, v16, v28
    v_add_f32 v16, v16, v29
    v_add_f32 v16, v16, v30
    v_add_f32 v16, v16, v31
    s_barrier
    s_mov_b32 s36, 12
qkv0_kernel_lloop:
    s_waitcnt vmcnt(20)
    s_barrier
    s_mov_b32 m0, s32
    s_mov_b32 s34, s30
    buffer_load_dwordx4 v3, s[12:15], s34 offen lds
    s_add_u32 m0, m0, 4096
    s_add_u32 s34, s34, 65536
    buffer_load_dwordx4 v3, s[12:15], s34 offen lds
    s_add_u32 m0, m0, 4096
    s_add_u32 s34, s34, 65536
    buffer_load_dwordx4 v3, s[12:15], s34 offen lds
    s_add_u32 m0, m0, 4096
    s_add_u32 s34, s34, 65536
    buffer_load_dwordx4 v3, s[12:15], s34 offen lds
    s_add_u32 m0, m0, 4096
    s_mov_b32 s34, s31
    buffer_load_dwordx4 v4, s[16:19], s34 offen lds
    s_add_u32 m0, m0, 4096
    s_add_u32 s34, s34, 196608
    buffer_load_dwordx4 v4, s[16:19], s34 offen lds
    s_add_u32 m0, m0, 4096
    s_sub_u32 s34, s34, 194560
    buffer_load_dwordx4 v4, s[16:19], s34 offen lds
    s_add_u32 m0, m0, 4096
    s_add_u32 s34, s34, 196608
    buffer_load_dwordx4 v4, s[16:19], s34 offen lds
    s_add_u32 m0, m0, 4096
    s_sub_u32 s34, s34, 194560
    buffer_load_dwordx4 v4, s[16:19], s34 offen lds
    s_add_u32 m0, m0, 4096
    s_add_u32 s34, s34, 196608
    buffer_load_dwordx4 v4, s[16:19], s34 offen lds
    s_add_u32 s30, s30, 128
    s_add_u32 s31, s31, 393216
    s_add_u32 s32, s32, 40960
    s_cmp_ge_u32 s32, 163840
    s_cselect_b32 s35, 163840, 0
    s_sub_u32 s32, s32, s35
    s_sub_u32 s36, s36, 1
    s_cmp_lg_u32 s36, 0
    s_cbranch_scc1 qkv0_kernel_lloop
    s_waitcnt vmcnt(20)
    s_barrier
    v_lshlrev_b32 v11, 2, v7
    ds_write_b32 v11, v32
    ds_write_b32 v11, v16 offset:1024
    s_waitcnt vmcnt(10)
    s_barrier
    s_waitcnt vmcnt(0)
    s_barrier
    s_waitcnt lgkmcnt(0)
    s_barrier
    s_endpgm
qkv0_kernel_cons:
    v_mov_b32 v212, v2
    s_and_b32 s28, s3, 1
    s_lshr_b32 s29, s3, 1
    v_and_b32 v3, 31, v2
    v_lshrrev_b32 v4, 5, v2
    v_lshrrev_b32 v5, 1, v3
    v_and_b32 v5, 7, v5
    v_xor_b32 v5, v5, v4
    v_lshlrev_b32 v5, 4, v5
    v_lshl_add_u32 v5, v3, 7, v5
    s_lshl_b32 s30, s28, 13
    v_add_u32 v136, s30, v5
    v_xor_b32 v137, 32, v136
    v_xor_b32 v138, 64, v136
    v_xor_b32 v139, 96, v136
    v_bfe_u32 v5, v2, 2, 2
    v_lshl_add_u32 v6, v4, 3, v5
    v_lshlrev_b32 v6, 7, v6
    v_lshrrev_b32 v5, 1, v5
    v_xor_b32 v5, s29, v5
    v_lshl_add_u32 v6, v5, 6, v6
    v_bfe_u32 v5, v2, 4, 1
    v_lshl_add_u32 v6, v5, 5, v6
    v_and_b32 v5, 3, v2
    v_lshl_add_u32 v6, v5, 3, v6
    v_add_u32 v140, 16384, v6
    v_mov_b32 v141, v136
    v_mov_b32 v142, v137
    v_mov_b32 v143, v138
    v_mov_b32 v144, v139
    v_mov_b32 v145, v140
    v_mov_b32 v0, 0
    v_mov_b32 v1, 0
    v_mov_b32 v2, 0
    v_mov_b32 v3, 0
    v_mov_b32 v4, 0
    v_mov_b32 v5, 0
    v_mov_b32 v6, 0
    v_mov_b32 v7, 0
    v_mov_b32 v8, 0
    v_mov_b32 v9, 0
    v_mov_b32 v10, 0
    v_mov_b32 v11, 0
    v_mov_b32 v12, 0
    v_mov_b32 v13, 0
    v_mov_b32 v14, 0
    v_mov_b32 v15, 0
    v_mov_b32 v16, 0
    v_mov_b32 v17, 0
    v_mov_b32 v18, 0
    v_mov_b32 v19, 0
    v_mov_b32 v20, 0
    v_mov_b32 v21, 0
    v_mov_b32 v22, 0
    v_mov_b32 v23, 0
    v_mov_b32 v24, 0
    v_mov_b32 v25, 0
    v_mov_b32 v26, 0
    v_mov_b32 v27, 0
    v_mov_b32 v28, 0
    v_mov_b32 v29, 0
    v_mov_b32 v30, 0
    v_mov_b32 v31, 0
    v_mov_b32 v32, 0
    v_mov_b32 v33, 0
    v_mov_b32 v34, 0
    v_mov_b32 v35, 0
    v_mov_b32 v36, 0
    v_mov_b32 v37, 0
    v_mov_b32 v38, 0
    v_mov_b32 v39, 0
    v_mov_b32 v40, 0
    v_mov_b32 v41, 0
    v_mov_b32 v42, 0
    v_mov_b32 v43, 0
    v_mov_b32 v44, 0
    v_mov_b32 v45, 0
    v_mov_b32 v46, 0
    v_mov_b32 v47, 0
    v_mov_b32 v48, 0
    v_mov_b32 v49, 0
    v_mov_b32 v50, 0
    v_mov_b32 v51, 0
    v_mov_b32 v52, 0
    v_mov_b32 v53, 0
    v_mov_b32 v54, 0
    v_mov_b32 v55, 0
    v_mov_b32 v56, 0
    v_mov_b32 v57, 0
    v_mov_b32 v58, 0
    v_mov_b32 v59, 0
    v_mov_b32 v60, 0
    v_mov_b32 v61, 0
    v_mov_b32 v62, 0
    v_mov_b32 v63, 0
    v_mov_b32 v64, 0
    v_mov_b32 v65, 0
    v_mov_b32 v66, 0
    v_mov_b32 v67, 0
    v_mov_b32 v68, 0
    v_mov_b32 v69, 0
    v_mov_b32 v70, 0
    v_mov_b32 v71, 0
    v_mov_b32 v72, 0
    v_mov_b32 v73, 0
    v_mov_b32 v74, 0
    v_mov_b32 v75, 0
    v_mov_b32 v76, 0
    v_mov_b32 v77, 0
    v_mov_b32 v78, 0
    v_mov_b32 v79, 0
    v_mov_b32 v80, 0
    v_mov_b32 v81, 0
    v_mov_b32 v82, 0
    v_mov_b32 v83, 0
    v_mov_b32 v84, 0
    v_mov_b32 v85, 0
    v_mov_b32 v86, 0
    v_mov_b32 v87, 0
    v_mov_b32 v88, 0
    v_mov_b32 v89, 0
    v_mov_b32 v90, 0
    v_mov_b32 v91, 0
    v_mov_b32 v92, 0
    v_mov_b32 v93, 0
    v_mov_b32 v94, 0
    v_mov_b32 v95, 0
    s_mov_b32 s31, 0
    s_mov_b32 s36, 16
    s_barrier
    ds_read_b128 v[96:99], v141
    ds_read_b128 v[100:103], v141 offset:4096
    ds_read_b64_tr_b16 v[104:105], v145 offset:0
    ds_read_b64_tr_b16 v[106:107], v145 offset:512
    ds_read_b64_tr_b16 v[108:109], v145 offset:8192
    ds_read_b64_tr_b16 v[110:111], v145 offset:8704
    ds_read_b64_tr_b16 v[112:113], v145 offset:16384
    ds_read_b64_tr_b16 v[114:115], v145 offset:16896
qkv0_kernel_cloop:
    s_waitcnt lgkmcnt(0)
    v_mfma_f32_32x32x16_bf16 v[0:15], v[104:107], v[96:99], v[0:15]
    ds_read_b128 v[116:119], v142
    ds_read_b64_tr_b16 v[124:125], v145 offset:2048
    ds_read_b64_tr_b16 v[126:127], v145 offset:2560
    v_mfma_f32_32x32x16_bf16 v[16:31], v[104:107], v[100:103], v[16:31]
    ds_read_b128 v[120:123], v142 offset:4096
    ds_read_b64_tr_b16 v[128:129], v145 offset:10240
    ds_read_b64_tr_b16 v[130:131], v145 offset:10752
    v_mfma_f32_32x32x16_bf16 v[32:47], v[108:111], v[96:99], v[32:47]
    ds_read_b64_tr_b16 v[132:133], v145 offset:18432
    ds_read_b64_tr_b16 v[134:135], v145 offset:18944
    v_mfma_f32_32x32x16_bf16 v[48:63], v[108:111], v[100:103], v[48:63]
    v_mfma_f32_32x32x16_bf16 v[64:79], v[96:99], v[112:115], v[64:79]
    v_mfma_f32_32x32x16_bf16 v[80:95], v[100:103], v[112:115], v[80:95]
    s_waitcnt lgkmcnt(0)
    v_mfma_f32_32x32x16_bf16 v[0:15], v[124:127], v[116:119], v[0:15]
    ds_read_b128 v[96:99], v143
    ds_read_b64_tr_b16 v[104:105], v145 offset:4096
    ds_read_b64_tr_b16 v[106:107], v145 offset:4608
    v_mfma_f32_32x32x16_bf16 v[16:31], v[124:127], v[120:123], v[16:31]
    ds_read_b128 v[100:103], v143 offset:4096
    ds_read_b64_tr_b16 v[108:109], v145 offset:12288
    ds_read_b64_tr_b16 v[110:111], v145 offset:12800
    v_mfma_f32_32x32x16_bf16 v[32:47], v[128:131], v[116:119], v[32:47]
    ds_read_b64_tr_b16 v[112:113], v145 offset:20480
    ds_read_b64_tr_b16 v[114:115], v145 offset:20992
    v_mfma_f32_32x32x16_bf16 v[48:63], v[128:131], v[120:123], v[48:63]
    v_mfma_f32_32x32x16_bf16 v[64:79], v[116:119], v[132:135], v[64:79]
    v_mfma_f32_32x32x16_bf16 v[80:95], v[120:123], v[132:135], v[80:95]
    s_waitcnt lgkmcnt(0)
    v_mfma_f32_32x32x16_bf16 v[0:15], v[104:107], v[96:99], v[0:15]
    ds_read_b128 v[116:119], v144
    ds_read_b64_tr_b16 v[124:125], v145 offset:6144
    ds_read_b64_tr_b16 v[126:127], v145 offset:6656
    v_mfma_f32_32x32x16_bf16 v[16:31], v[104:107], v[100:103], v[16:31]
    ds_read_b128 v[120:123], v144 offset:4096
    ds_read_b64_tr_b16 v[128:129], v145 offset:14336
    ds_read_b64_tr_b16 v[130:131], v145 offset:14848
    v_mfma_f32_32x32x16_bf16 v[32:47], v[108:111], v[96:99], v[32:47]
    ds_read_b64_tr_b16 v[132:133], v145 offset:22528
    ds_read_b64_tr_b16 v[134:135], v145 offset:23040
    v_mfma_f32_32x32x16_bf16 v[48:63], v[108:111], v[100:103], v[48:63]
    v_mfma_f32_32x32x16_bf16 v[64:79], v[96:99], v[112:115], v[64:79]
    v_mfma_f32_32x32x16_bf16 v[80:95], v[100:103], v[112:115], v[80:95]
    s_waitcnt lgkmcnt(0)
    v_mfma_f32_32x32x16_bf16 v[0:15], v[124:127], v[116:119], v[0:15]
    s_barrier
    s_add_u32 s31, s31, 40960
    s_cmp_ge_u32 s31, 163840
    s_cselect_b32 s31, 0, s31
    v_add_u32 v141, s31, v136
    v_add_u32 v145, s31, v140
    ds_read_b128 v[96:99], v141
    ds_read_b64_tr_b16 v[104:105], v145 offset:0
    ds_read_b64_tr_b16 v[106:107], v145 offset:512
    v_mfma_f32_32x32x16_bf16 v[16:31], v[124:127], v[120:123], v[16:31]
    ds_read_b128 v[100:103], v141 offset:4096
    ds_read_b64_tr_b16 v[108:109], v145 offset:8192
    ds_read_b64_tr_b16 v[110:111], v145 offset:8704
    v_mfma_f32_32x32x16_bf16 v[32:47], v[128:131], v[116:119], v[32:47]
    ds_read_b64_tr_b16 v[112:113], v145 offset:16384
    ds_read_b64_tr_b16 v[114:115], v145 offset:16896
    v_mfma_f32_32x32x16_bf16 v[48:63], v[128:131], v[120:123], v[48:63]
    v_add_u32 v142, s31, v137
    v_add_u32 v143, s31, v138
    v_add_u32 v144, s31, v139
    s_sub_u32 s36, s36, 1
    s_cmp_lg_u32 s36, 0
    v_mfma_f32_32x32x16_bf16 v[64:79], v[116:119], v[132:135], v[64:79]
    v_mfma_f32_32x32x16_bf16 v[80:95], v[120:123], v[132:135], v[80:95]
    s_cbranch_scc1 qkv0_kernel_cloop
    s_waitcnt lgkmcnt(0)
    v_and_b32 v96, 31, v212
    v_lshrrev_b32 v97, 5, v212
    s_lshl_b32 s30, s28, 8
    s_add_u32 s30, s30, 0
    v_lshl_add_u32 v98, v96, 2, s30
    v_lshl_add_u32 v99, v97, 4, s30
    s_lshl_b32 s30, s29, 7
    s_add_u32 s30, s30, 1024
    v_lshl_add_u32 v100, v97, 4, s30
    v_lshl_add_u32 v101, v96, 2, s30
    ds_read_b32 v104, v98
    ds_read_b32 v106, v98 offset:128
    ds_read_b32 v108, v98 offset:512
    ds_read_b32 v110, v98 offset:640
    ds_read_b32 v112, v101 offset:512
    ds_read_b128 v[116:119], v100 offset:0
    ds_read_b128 v[120:123], v100 offset:32
    ds_read_b128 v[124:127], v100 offset:64
    ds_read_b128 v[128:131], v100 offset:96
    ds_read_b128 v[132:135], v100 offset:256
    ds_read_b128 v[136:139], v100 offset:288
    ds_read_b128 v[140:143], v100 offset:320
    ds_read_b128 v[144:147], v100 offset:352
    ds_read_b128 v[148:151], v99 offset:0
    ds_read_b128 v[180:183], v99 offset:512
    ds_read_b128 v[152:155], v99 offset:32
    ds_read_b128 v[184:187], v99 offset:544
    ds_read_b128 v[156:159], v99 offset:64
    ds_read_b128 v[188:191], v99 offset:576
    ds_read_b128 v[160:163], v99 offset:96
    ds_read_b128 v[192:195], v99 offset:608
    ds_read_b128 v[164:167], v99 offset:128
    ds_read_b128 v[196:199], v99 offset:640
    ds_read_b128 v[168:171], v99 offset:160
    ds_read_b128 v[200:203], v99 offset:672
    ds_read_b128 v[172:175], v99 offset:192
    ds_read_b128 v[204:207], v99 offset:704
    ds_read_b128 v[176:179], v99 offset:224
    ds_read_b128 v[208:211], v99 offset:736
    s_lshl_b32 s30, s27, 1
    s_add_u32 s30, s30, s29
    s_lshl_b32 s30, s30, 6
    s_lshl_b32 s31, s26, 2
    s_add_u32 s30, s30, s31
    s_lshl_b32 s31, s28, 1
    s_add_u32 s30, s30, s31
    s_lshl_b32 s31, s30, 11
    s_add_u32 s31, s31, 0x0
    s_lshl_b32 s32, s30, 12
    s_add_u32 s32, s32, 0x400000
    s_add_u32 s33, s32, 4096
    v_lshlrev_b32 v96, 4, v212
    s_waitcnt lgkmcnt(15)
    v_mul_f32 v114, 0x3e8293ee, v104
    v_mul_f32 v102, 0x3e8293ee, v106
    v_pk_fma_f32 v[0:1], v[116:117], v[108:109], v[0:1] op_sel_hi:[1,0,1] neg_lo:[0,1,0] neg_hi:[0,1,0]
    v_pk_fma_f32 v[2:3], v[118:119], v[108:109], v[2:3] op_sel_hi:[1,0,1] neg_lo:[0,1,0] neg_hi:[0,1,0]
    v_pk_fma_f32 v[4:5], v[120:121], v[108:109], v[4:5] op_sel_hi:[1,0,1] neg_lo:[0,1,0] neg_hi:[0,1,0]
    v_pk_fma_f32 v[6:7], v[122:123], v[108:109], v[6:7] op_sel_hi:[1,0,1] neg_lo:[0,1,0] neg_hi:[0,1,0]
    v_pk_fma_f32 v[8:9], v[124:125], v[108:109], v[8:9] op_sel_hi:[1,0,1] neg_lo:[0,1,0] neg_hi:[0,1,0]
    v_pk_fma_f32 v[10:11], v[126:127], v[108:109], v[10:11] op_sel_hi:[1,0,1] neg_lo:[0,1,0] neg_hi:[0,1,0]
    v_pk_fma_f32 v[12:13], v[128:129], v[108:109], v[12:13] op_sel_hi:[1,0,1] neg_lo:[0,1,0] neg_hi:[0,1,0]
    v_pk_fma_f32 v[14:15], v[130:131], v[108:109], v[14:15] op_sel_hi:[1,0,1] neg_lo:[0,1,0] neg_hi:[0,1,0]
    v_pk_mul_f32 v[0:1], v[0:1], v[114:115] op_sel_hi:[1,0]
    v_pk_mul_f32 v[2:3], v[2:3], v[114:115] op_sel_hi:[1,0]
    v_pk_mul_f32 v[4:5], v[4:5], v[114:115] op_sel_hi:[1,0]
    v_pk_mul_f32 v[6:7], v[6:7], v[114:115] op_sel_hi:[1,0]
    v_pk_mul_f32 v[8:9], v[8:9], v[114:115] op_sel_hi:[1,0]
    v_pk_mul_f32 v[10:11], v[10:11], v[114:115] op_sel_hi:[1,0]
    v_pk_mul_f32 v[12:13], v[12:13], v[114:115] op_sel_hi:[1,0]
    v_pk_mul_f32 v[14:15], v[14:15], v[114:115] op_sel_hi:[1,0]
    v_cvt_pk_bf16_f32 v0, v0, v1
    v_cvt_pk_bf16_f32 v1, v2, v3
    v_cvt_pk_bf16_f32 v2, v4, v5
    v_cvt_pk_bf16_f32 v3, v6, v7
    v_cvt_pk_bf16_f32 v4, v8, v9
    v_cvt_pk_bf16_f32 v5, v10, v11
    v_cvt_pk_bf16_f32 v6, v12, v13
    v_cvt_pk_bf16_f32 v7, v14, v15
    buffer_store_dwordx4 v[0:3], v96, s[20:23], s31 offen offset:0
    buffer_store_dwordx4 v[4:7], v96, s[20:23], s31 offen offset:1024
    v_pk_fma_f32 v[16:17], v[116:117], v[110:111], v[16:17] op_sel_hi:[1,0,1] neg_lo:[0,1,0] neg_hi:[0,1,0]
    v_pk_fma_f32 v[18:19], v[118:119], v[110:111], v[18:19] op_sel_hi:[1,0,1] neg_lo:[0,1,0] neg_hi:[0,1,0]
    v_pk_fma_f32 v[20:21], v[120:121], v[110:111], v[20:21] op_sel_hi:[1,0,1] neg_lo:[0,1,0] neg_hi:[0,1,0]
    v_pk_fma_f32 v[22:23], v[122:123], v[110:111], v[22:23] op_sel_hi:[1,0,1] neg_lo:[0,1,0] neg_hi:[0,1,0]
    v_pk_fma_f32 v[24:25], v[124:125], v[110:111], v[24:25] op_sel_hi:[1,0,1] neg_lo:[0,1,0] neg_hi:[0,1,0]
    v_pk_fma_f32 v[26:27], v[126:127], v[110:111], v[26:27] op_sel_hi:[1,0,1] neg_lo:[0,1,0] neg_hi:[0,1,0]
    v_pk_fma_f32 v[28:29], v[128:129], v[110:111], v[28:29] op_sel_hi:[1,0,1] neg_lo:[0,1,0] neg_hi:[0,1,0]
    v_pk_fma_f32 v[30:31], v[130:131], v[110:111], v[30:31] op_sel_hi:[1,0,1] neg_lo:[0,1,0] neg_hi:[0,1,0]
    v_pk_mul_f32 v[16:17], v[16:17], v[102:103] op_sel_hi:[1,0]
    v_pk_mul_f32 v[18:19], v[18:19], v[102:103] op_sel_hi:[1,0]
    v_pk_mul_f32 v[20:21], v[20:21], v[102:103] op_sel_hi:[1,0]
    v_pk_mul_f32 v[22:23], v[22:23], v[102:103] op_sel_hi:[1,0]
    v_pk_mul_f32 v[24:25], v[24:25], v[102:103] op_sel_hi:[1,0]
    v_pk_mul_f32 v[26:27], v[26:27], v[102:103] op_sel_hi:[1,0]
    v_pk_mul_f32 v[28:29], v[28:29], v[102:103] op_sel_hi:[1,0]
    v_pk_mul_f32 v[30:31], v[30:31], v[102:103] op_sel_hi:[1,0]
    v_cvt_pk_bf16_f32 v16, v16, v17
    v_cvt_pk_bf16_f32 v17, v18, v19
    v_cvt_pk_bf16_f32 v18, v20, v21
    v_cvt_pk_bf16_f32 v19, v22, v23
    v_cvt_pk_bf16_f32 v20, v24, v25
    v_cvt_pk_bf16_f32 v21, v26, v27
    v_cvt_pk_bf16_f32 v22, v28, v29
    v_cvt_pk_bf16_f32 v23, v30, v31
    buffer_store_dwordx4 v[16:19], v96, s[20:23], s31 offen offset:2048
    buffer_store_dwordx4 v[20:23], v96, s[20:23], s31 offen offset:3072
    v_pk_fma_f32 v[32:33], v[132:133], v[108:109], v[32:33] op_sel_hi:[1,0,1] neg_lo:[0,1,0] neg_hi:[0,1,0]
    v_pk_fma_f32 v[34:35], v[134:135], v[108:109], v[34:35] op_sel_hi:[1,0,1] neg_lo:[0,1,0] neg_hi:[0,1,0]
    v_pk_fma_f32 v[36:37], v[136:137], v[108:109], v[36:37] op_sel_hi:[1,0,1] neg_lo:[0,1,0] neg_hi:[0,1,0]
    v_pk_fma_f32 v[38:39], v[138:139], v[108:109], v[38:39] op_sel_hi:[1,0,1] neg_lo:[0,1,0] neg_hi:[0,1,0]
    v_pk_fma_f32 v[40:41], v[140:141], v[108:109], v[40:41] op_sel_hi:[1,0,1] neg_lo:[0,1,0] neg_hi:[0,1,0]
    v_pk_fma_f32 v[42:43], v[142:143], v[108:109], v[42:43] op_sel_hi:[1,0,1] neg_lo:[0,1,0] neg_hi:[0,1,0]
    v_pk_fma_f32 v[44:45], v[144:145], v[108:109], v[44:45] op_sel_hi:[1,0,1] neg_lo:[0,1,0] neg_hi:[0,1,0]
    v_pk_fma_f32 v[46:47], v[146:147], v[108:109], v[46:47] op_sel_hi:[1,0,1] neg_lo:[0,1,0] neg_hi:[0,1,0]
    v_pk_mul_f32 v[32:33], v[32:33], v[104:105] op_sel_hi:[1,0]
    v_pk_mul_f32 v[34:35], v[34:35], v[104:105] op_sel_hi:[1,0]
    v_pk_mul_f32 v[36:37], v[36:37], v[104:105] op_sel_hi:[1,0]
    v_pk_mul_f32 v[38:39], v[38:39], v[104:105] op_sel_hi:[1,0]
    v_pk_mul_f32 v[40:41], v[40:41], v[104:105] op_sel_hi:[1,0]
    v_pk_mul_f32 v[42:43], v[42:43], v[104:105] op_sel_hi:[1,0]
    v_pk_mul_f32 v[44:45], v[44:45], v[104:105] op_sel_hi:[1,0]
    v_pk_mul_f32 v[46:47], v[46:47], v[104:105] op_sel_hi:[1,0]
    v_cvt_pk_bf16_f32 v32, v32, v33
    v_cvt_pk_bf16_f32 v33, v34, v35
    v_cvt_pk_bf16_f32 v34, v36, v37
    v_cvt_pk_bf16_f32 v35, v38, v39
    v_cvt_pk_bf16_f32 v36, v40, v41
    v_cvt_pk_bf16_f32 v37, v42, v43
    v_cvt_pk_bf16_f32 v38, v44, v45
    v_cvt_pk_bf16_f32 v39, v46, v47
    buffer_store_dwordx4 v[32:35], v96, s[20:23], s32 offen offset:0
    buffer_store_dwordx4 v[36:39], v96, s[20:23], s32 offen offset:1024
    v_pk_fma_f32 v[48:49], v[132:133], v[110:111], v[48:49] op_sel_hi:[1,0,1] neg_lo:[0,1,0] neg_hi:[0,1,0]
    v_pk_fma_f32 v[50:51], v[134:135], v[110:111], v[50:51] op_sel_hi:[1,0,1] neg_lo:[0,1,0] neg_hi:[0,1,0]
    v_pk_fma_f32 v[52:53], v[136:137], v[110:111], v[52:53] op_sel_hi:[1,0,1] neg_lo:[0,1,0] neg_hi:[0,1,0]
    v_pk_fma_f32 v[54:55], v[138:139], v[110:111], v[54:55] op_sel_hi:[1,0,1] neg_lo:[0,1,0] neg_hi:[0,1,0]
    v_pk_fma_f32 v[56:57], v[140:141], v[110:111], v[56:57] op_sel_hi:[1,0,1] neg_lo:[0,1,0] neg_hi:[0,1,0]
    v_pk_fma_f32 v[58:59], v[142:143], v[110:111], v[58:59] op_sel_hi:[1,0,1] neg_lo:[0,1,0] neg_hi:[0,1,0]
    v_pk_fma_f32 v[60:61], v[144:145], v[110:111], v[60:61] op_sel_hi:[1,0,1] neg_lo:[0,1,0] neg_hi:[0,1,0]
    v_pk_fma_f32 v[62:63], v[146:147], v[110:111], v[62:63] op_sel_hi:[1,0,1] neg_lo:[0,1,0] neg_hi:[0,1,0]
    v_pk_mul_f32 v[48:49], v[48:49], v[106:107] op_sel_hi:[1,0]
    v_pk_mul_f32 v[50:51], v[50:51], v[106:107] op_sel_hi:[1,0]
    v_pk_mul_f32 v[52:53], v[52:53], v[106:107] op_sel_hi:[1,0]
    v_pk_mul_f32 v[54:55], v[54:55], v[106:107] op_sel_hi:[1,0]
    v_pk_mul_f32 v[56:57], v[56:57], v[106:107] op_sel_hi:[1,0]
    v_pk_mul_f32 v[58:59], v[58:59], v[106:107] op_sel_hi:[1,0]
    v_pk_mul_f32 v[60:61], v[60:61], v[106:107] op_sel_hi:[1,0]
    v_pk_mul_f32 v[62:63], v[62:63], v[106:107] op_sel_hi:[1,0]
    v_cvt_pk_bf16_f32 v48, v48, v49
    v_cvt_pk_bf16_f32 v49, v50, v51
    v_cvt_pk_bf16_f32 v50, v52, v53
    v_cvt_pk_bf16_f32 v51, v54, v55
    v_cvt_pk_bf16_f32 v52, v56, v57
    v_cvt_pk_bf16_f32 v53, v58, v59
    v_cvt_pk_bf16_f32 v54, v60, v61
    v_cvt_pk_bf16_f32 v55, v62, v63
    buffer_store_dwordx4 v[48:51], v96, s[20:23], s33 offen offset:0
    buffer_store_dwordx4 v[52:55], v96, s[20:23], s33 offen offset:1024
    s_waitcnt lgkmcnt(0)
    v_pk_fma_f32 v[64:65], v[180:181], v[112:113], v[64:65] op_sel_hi:[1,0,1] neg_lo:[0,1,0] neg_hi:[0,1,0]
    v_pk_fma_f32 v[66:67], v[182:183], v[112:113], v[66:67] op_sel_hi:[1,0,1] neg_lo:[0,1,0] neg_hi:[0,1,0]
    v_pk_fma_f32 v[68:69], v[184:185], v[112:113], v[68:69] op_sel_hi:[1,0,1] neg_lo:[0,1,0] neg_hi:[0,1,0]
    v_pk_fma_f32 v[70:71], v[186:187], v[112:113], v[70:71] op_sel_hi:[1,0,1] neg_lo:[0,1,0] neg_hi:[0,1,0]
    v_pk_fma_f32 v[72:73], v[188:189], v[112:113], v[72:73] op_sel_hi:[1,0,1] neg_lo:[0,1,0] neg_hi:[0,1,0]
    v_pk_fma_f32 v[74:75], v[190:191], v[112:113], v[74:75] op_sel_hi:[1,0,1] neg_lo:[0,1,0] neg_hi:[0,1,0]
    v_pk_fma_f32 v[76:77], v[192:193], v[112:113], v[76:77] op_sel_hi:[1,0,1] neg_lo:[0,1,0] neg_hi:[0,1,0]
    v_pk_fma_f32 v[78:79], v[194:195], v[112:113], v[78:79] op_sel_hi:[1,0,1] neg_lo:[0,1,0] neg_hi:[0,1,0]
    v_pk_mul_f32 v[64:65], v[64:65], v[148:149]
    v_pk_mul_f32 v[66:67], v[66:67], v[150:151]
    v_pk_mul_f32 v[68:69], v[68:69], v[152:153]
    v_pk_mul_f32 v[70:71], v[70:71], v[154:155]
    v_pk_mul_f32 v[72:73], v[72:73], v[156:157]
    v_pk_mul_f32 v[74:75], v[74:75], v[158:159]
    v_pk_mul_f32 v[76:77], v[76:77], v[160:161]
    v_pk_mul_f32 v[78:79], v[78:79], v[162:163]
    v_cvt_pk_bf16_f32 v64, v64, v65
    v_cvt_pk_bf16_f32 v65, v66, v67
    v_cvt_pk_bf16_f32 v66, v68, v69
    v_cvt_pk_bf16_f32 v67, v70, v71
    v_cvt_pk_bf16_f32 v68, v72, v73
    v_cvt_pk_bf16_f32 v69, v74, v75
    v_cvt_pk_bf16_f32 v70, v76, v77
    v_cvt_pk_bf16_f32 v71, v78, v79
    buffer_store_dwordx4 v[64:67], v96, s[20:23], s32 offen offset:2048
    buffer_store_dwordx4 v[68:71], v96, s[20:23], s32 offen offset:3072
    v_pk_fma_f32 v[80:81], v[196:197], v[112:113], v[80:81] op_sel_hi:[1,0,1] neg_lo:[0,1,0] neg_hi:[0,1,0]
    v_pk_fma_f32 v[82:83], v[198:199], v[112:113], v[82:83] op_sel_hi:[1,0,1] neg_lo:[0,1,0] neg_hi:[0,1,0]
    v_pk_fma_f32 v[84:85], v[200:201], v[112:113], v[84:85] op_sel_hi:[1,0,1] neg_lo:[0,1,0] neg_hi:[0,1,0]
    v_pk_fma_f32 v[86:87], v[202:203], v[112:113], v[86:87] op_sel_hi:[1,0,1] neg_lo:[0,1,0] neg_hi:[0,1,0]
    v_pk_fma_f32 v[88:89], v[204:205], v[112:113], v[88:89] op_sel_hi:[1,0,1] neg_lo:[0,1,0] neg_hi:[0,1,0]
    v_pk_fma_f32 v[90:91], v[206:207], v[112:113], v[90:91] op_sel_hi:[1,0,1] neg_lo:[0,1,0] neg_hi:[0,1,0]
    v_pk_fma_f32 v[92:93], v[208:209], v[112:113], v[92:93] op_sel_hi:[1,0,1] neg_lo:[0,1,0] neg_hi:[0,1,0]
    v_pk_fma_f32 v[94:95], v[210:211], v[112:113], v[94:95] op_sel_hi:[1,0,1] neg_lo:[0,1,0] neg_hi:[0,1,0]
    v_pk_mul_f32 v[80:81], v[80:81], v[164:165]
    v_pk_mul_f32 v[82:83], v[82:83], v[166:167]
    v_pk_mul_f32 v[84:85], v[84:85], v[168:169]
    v_pk_mul_f32 v[86:87], v[86:87], v[170:171]
    v_pk_mul_f32 v[88:89], v[88:89], v[172:173]
    v_pk_mul_f32 v[90:91], v[90:91], v[174:175]
    v_pk_mul_f32 v[92:93], v[92:93], v[176:177]
    v_pk_mul_f32 v[94:95], v[94:95], v[178:179]
    v_cvt_pk_bf16_f32 v80, v80, v81
    v_cvt_pk_bf16_f32 v81, v82, v83
    v_cvt_pk_bf16_f32 v82, v84, v85
    v_cvt_pk_bf16_f32 v83, v86, v87
    v_cvt_pk_bf16_f32 v84, v88, v89
    v_cvt_pk_bf16_f32 v85, v90, v91
    v_cvt_pk_bf16_f32 v86, v92, v93
    v_cvt_pk_bf16_f32 v87, v94, v95
    buffer_store_dwordx4 v[80:83], v96, s[20:23], s33 offen offset:2048
    buffer_store_dwordx4 v[84:87], v96, s[20:23], s33 offen offset:3072
qkv0_kernel_end:
qkv0_kernel_exit:
    s_endpgm
.globl attn0_kernel
.p2align 8
.type attn0_kernel,@function
attn0_kernel:
    s_cmp_ge_u32 s2, 256
    s_cbranch_scc1 attn0_kernel_exit
    s_load_dwordx2 s[8:9], s[0:1], 80
    v_lshrrev_b32 v1, 6, v0
    v_and_b32 v2, 63, v0
    v_readfirstlane_b32 s3, v1
    s_and_b32 s24, s2, 7
    s_lshr_b32 s25, s2, 3
    s_lshr_b32 s26, s24, 2
    s_lshl_b32 s26, s26, 3
    s_and_b32 s27, s25, 7
    s_add_u32 s26, s26, s27
    s_and_b32 s27, s24, 3
    s_lshl_b32 s27, s27, 2
    s_lshr_b32 s25, s25, 3
    s_add_u32 s27, s27, s25
    s_lshr_b32 s28, s3, 2
    s_and_b32 s29, s3, 3
    s_lshl_b32 s30, s27, 1
    s_add_u32 s30, s30, s28
    s_lshl_b32 s31, s26, 2
    s_add_u32 s37, s31, s29
    v_lshlrev_b32 v3, 4, v2
    s_waitcnt lgkmcnt(0)
    s_mov_b32 s20, s8
    s_mov_b32 s21, s9
    s_mov_b32 s22, 0x8000000
    s_mov_b32 s23, 0x20000
    s_lshl_b32 s32, s30, 6
    s_add_u32 s33, s32, s37
    s_lshl_b32 s33, s33, 11
    s_add_u32 s33, s33, 0x0
    buffer_load_dwordx4 v[4:7], v3, s[20:23], s33 offen
    buffer_load_dwordx4 v[8:11], v3, s[20:23], s33 offen offset:1024
    s_mul_i32 s34, s29, 3
    s_mul_i32 s35, s28, 12
    s_add_u32 s35, s35, s34
    s_lshl_b32 s35, s35, 12
    s_add_u32 s34, s34, s31
    s_sub_u32 s34, s34, 8
    s_max_i32 s36, s34, 0
    s_add_u32 s36, s36, s32
    s_lshl_b32 s36, s36, 12
    s_add_u32 s36, s36, 0x400000
    s_mov_b32 m0, s35
    s_add_u32 s34, s34, 1
    buffer_load_dwordx4 v3, s[20:23], s36 offen offset:0 lds
    buffer_load_dwordx4 v3, s[20:23], s36 offen offset:1024 lds
    buffer_load_dwordx4 v3, s[20:23], s36 offen offset:2048 lds
    buffer_load_dwordx4 v3, s[20:23], s36 offen offset:3072 lds
    s_add_u32 s35, s35, 4096
    s_max_i32 s36, s34, 0
    s_add_u32 s36, s36, s32
    s_lshl_b32 s36, s36, 12
    s_add_u32 s36, s36, 0x400000
    s_mov_b32 m0, s35
    s_add_u32 s34, s34, 1
    buffer_load_dwordx4 v3, s[20:23], s36 offen offset:0 lds
    buffer_load_dwordx4 v3, s[20:23], s36 offen offset:1024 lds
    buffer_load_dwordx4 v3, s[20:23], s36 offen offset:2048 lds
    buffer_load_dwordx4 v3, s[20:23], s36 offen offset:3072 lds
    s_add_u32 s35, s35, 4096
    s_max_i32 s36, s34, 0
    s_add_u32 s36, s36, s32
    s_lshl_b32 s36, s36, 12
    s_add_u32 s36, s36, 0x400000
    s_mov_b32 m0, s35
    s_add_u32 s34, s34, 1
    buffer_load_dwordx4 v3, s[20:23], s36 offen offset:0 lds
    buffer_load_dwordx4 v3, s[20:23], s36 offen offset:1024 lds
    buffer_load_dwordx4 v3, s[20:23], s36 offen offset:2048 lds
    buffer_load_dwordx4 v3, s[20:23], s36 offen offset:3072 lds
    s_add_u32 s35, s35, 4096
    s_mov_b32 s40, 0xffffffff
    s_mov_b32 s41, 0xfffffff0
    s_mov_b32 s42, 0xfffffffe
    s_mov_b32 s43, 0xffffffe0
    s_mov_b32 s44, 0xfffffffc
    s_mov_b32 s45, 0xffffffc0
    s_mov_b32 s46, 0xfffffff8
    s_mov_b32 s47, 0xffffff80
    s_mov_b32 s48, 0xffffff00
    s_mov_b32 s49, 0xfffff000
    s_mov_b32 s50, 0xfffffe00
    s_mov_b32 s51, 0xffffe000
    s_mov_b32 s52, 0xfffffc00
    s_mov_b32 s53, 0xffffc000
    s_mov_b32 s54, 0xfffff800
    s_mov_b32 s55, 0xffff8000
    s_mov_b32 s56, 0xffff0000
    s_mov_b32 s57, 0xfff00000
    s_mov_b32 s58, 0xfffe0000
    s_mov_b32 s59, 0xffe00000
    s_mov_b32 s60, 0xfffc0000
    s_mov_b32 s61, 0xffc00000
    s_mov_b32 s62, 0xfff80000
    s_mov_b32 s63, 0xff800000
    s_mov_b32 s64, 0xff000000
    s_mov_b32 s65, 0xf0000000
    s_mov_b32 s66, 0xfe000000
    s_mov_b32 s67, 0xe0000000
    s_mov_b32 s68, 0xfc000000
    s_mov_b32 s69, 0xc0000000
    s_mov_b32 s70, 0xf8000000
    s_mov_b32 s71, 0x80000000
    v_mov_b32 v20, 0xffff
    v_mov_b32 v21, 0xffff0000
    v_cndmask_b32 v22, 0, v20, s[40:41]
    v_cndmask_b32 v23, 0, v21, s[42:43]
    v_or_b32 v12, v22, v23
    v_cndmask_b32 v22, 0, v20, s[44:45]
    v_cndmask_b32 v23, 0, v21, s[46:47]
    v_or_b32 v13, v22, v23
    v_cndmask_b32 v22, 0, v20, s[48:49]
    v_cndmask_b32 v23, 0, v21, s[50:51]
    v_or_b32 v14, v22, v23
    v_cndmask_b32 v22, 0, v20, s[52:53]
    v_cndmask_b32 v23, 0, v21, s[54:55]
    v_or_b32 v15, v22, v23
    v_cndmask_b32 v22, 0, v20, s[56:57]
    v_cndmask_b32 v23, 0, v21, s[58:59]
    v_or_b32 v16, v22, v23
    v_cndmask_b32 v22, 0, v20, s[60:61]
    v_cndmask_b32 v23, 0, v21, s[62:63]
    v_or_b32 v17, v22, v23
    v_cndmask_b32 v22, 0, v20, s[64:65]
    v_cndmask_b32 v23, 0, v21, s[66:67]
    v_or_b32 v18, v22, v23
    v_cndmask_b32 v22, 0, v20, s[68:69]
    v_cndmask_b32 v23, 0, v21, s[70:71]
    v_or_b32 v19, v22, v23
    s_mul_i32 s34, s28, 12
    s_add_u32 s34, s34, s29
    s_lshl_b32 s34, s34, 12
    v_add_u32 v20, s34, v3
    v_mov_b32 v24, 0
    v_mov_b32 v25, 0
    v_mov_b32 v26, 0
    v_mov_b32 v27, 0
    v_mov_b32 v28, 0
    v_mov_b32 v29, 0
    v_mov_b32 v30, 0
    v_mov_b32 v31, 0
    v_mov_b32 v32, 0
    v_mov_b32 v33, 0
    v_mov_b32 v34, 0
    v_mov_b32 v35, 0
    v_mov_b32 v36, 0
    v_mov_b32 v37, 0
    v_mov_b32 v38, 0
    v_mov_b32 v39, 0
    s_waitcnt vmcnt(0)
    s_barrier
    ds_read_b128 v[104:107], v20 offset:32768
    ds_read_b128 v[108:111], v20 offset:33792
    ds_read_b128 v[112:115], v20 offset:28672
    ds_read_b128 v[116:119], v20 offset:29696
    s_waitcnt lgkmcnt(2)
    v_mfma_f32_32x32x16_bf16 v[40:55], v[104:107], v[4:7], 0
    v_mfma_f32_32x32x16_bf16 v[40:55], v[108:111], v[8:11], v[40:55]
    ds_read_b128 v[104:107], v20 offset:24576
    ds_read_b128 v[108:111], v20 offset:25600
    s_cmp_eq_u32 s37, 0
    s_cbranch_scc0 attn0_kernel_a1
    v_mov_b32 v24, 0xf149f2ca
    v_mov_b32 v25, 0xf149f2ca
    v_mov_b32 v26, 0xf149f2ca
    v_mov_b32 v27, 0xf149f2ca
    v_mov_b32 v28, 0xf149f2ca
    v_mov_b32 v29, 0xf149f2ca
    v_mov_b32 v30, 0xf149f2ca
    v_mov_b32 v31, 0xf149f2ca
    v_mov_b32 v32, 0xf149f2ca
    v_mov_b32 v33, 0xf149f2ca
    v_mov_b32 v34, 0xf149f2ca
    v_mov_b32 v35, 0xf149f2ca
    v_mov_b32 v36, 0xf149f2ca
    v_mov_b32 v37, 0xf149f2ca
    v_mov_b32 v38, 0xf149f2ca
    v_mov_b32 v39, 0xf149f2ca
attn0_kernel_a1:
    s_waitcnt lgkmcnt(2)
    s_nop 0
    v_mfma_f32_32x32x16_bf16 v[72:87], v[112:115], v[4:7], v[24:39]
    v_mfma_f32_32x32x16_bf16 v[72:87], v[116:119], v[8:11], v[72:87]
    ds_read_b128 v[112:115], v20 offset:20480
    ds_read_b128 v[116:119], v20 offset:21504
    s_cmp_eq_u32 s37, 1
    s_cbranch_scc0 attn0_kernel_a2
    s_nop 1
    v_mov_b32 v24, 0xf149f2ca
    v_mov_b32 v25, 0xf149f2ca
    v_mov_b32 v26, 0xf149f2ca
    v_mov_b32 v27, 0xf149f2ca
    v_mov_b32 v28, 0xf149f2ca
    v_mov_b32 v29, 0xf149f2ca
    v_mov_b32 v30, 0xf149f2ca
    v_mov_b32 v31, 0xf149f2ca
    v_mov_b32 v32, 0xf149f2ca
    v_mov_b32 v33, 0xf149f2ca
    v_mov_b32 v34, 0xf149f2ca
    v_mov_b32 v35, 0xf149f2ca
    v_mov_b32 v36, 0xf149f2ca
    v_mov_b32 v37, 0xf149f2ca
    v_mov_b32 v38, 0xf149f2ca
    v_mov_b32 v39, 0xf149f2ca
attn0_kernel_a2:
    s_waitcnt lgkmcnt(2)
    s_nop 0
    v_mfma_f32_32x32x16_bf16 v[56:71], v[104:107], v[4:7], v[24:39]
    v_mfma_f32_32x32x16_bf16 v[56:71], v[108:111], v[8:11], v[56:71]
    s_nop 3
    v_max_f32 v21, v72, v73
    v_max3_f32 v21, v21, v74, v75
    v_max3_f32 v21, v21, v76, v77
    v_max3_f32 v21, v21, v78, v79
    v_max3_f32 v21, v21, v80, v81
    v_max3_f32 v21, v21, v82, v83
    v_max3_f32 v21, v21, v84, v85
    v_max3_f32 v21, v21, v86, v87
    ds_read_b128 v[104:107], v20 offset:16384
    ds_read_b128 v[108:111], v20 offset:17408
    s_cmp_eq_u32 s37, 2
    s_cbranch_scc0 attn0_kernel_a3
    v_mov_b32 v24, 0xf149f2ca
    v_mov_b32 v25, 0xf149f2ca
    v_mov_b32 v26, 0xf149f2ca
    v_mov_b32 v27, 0xf149f2ca
    v_mov_b32 v28, 0xf149f2ca
    v_mov_b32 v29, 0xf149f2ca
    v_mov_b32 v30, 0xf149f2ca
    v_mov_b32 v31, 0xf149f2ca
    v_mov_b32 v32, 0xf149f2ca
    v_mov_b32 v33, 0xf149f2ca
    v_mov_b32 v34, 0xf149f2ca
    v_mov_b32 v35, 0xf149f2ca
    v_mov_b32 v36, 0xf149f2ca
    v_mov_b32 v37, 0xf149f2ca
    v_mov_b32 v38, 0xf149f2ca
    v_mov_b32 v39, 0xf149f2ca
attn0_kernel_a3:
    s_waitcnt lgkmcnt(2)
    s_nop 0
    v_mfma_f32_32x32x16_bf16 v[72:87], v[112:115], v[4:7], v[24:39]
    v_mfma_f32_32x32x16_bf16 v[72:87], v[116:119], v[8:11], v[72:87]
    v_max3_f32 v21, v21, v56, v57
    v_max3_f32 v21, v21, v58, v59
    v_max3_f32 v21, v21, v60, v61
    v_max3_f32 v21, v21, v62, v63
    v_max3_f32 v21, v21, v64, v65
    v_max3_f32 v21, v21, v66, v67
    v_max3_f32 v21, v21, v68, v69
    v_max3_f32 v21, v21, v70, v71
    ds_read_b128 v[112:115], v20 offset:12288
    ds_read_b128 v[116:119], v20 offset:13312
    s_cmp_eq_u32 s37, 3
    s_cbranch_scc0 attn0_kernel_a4
    v_mov_b32 v24, 0xf149f2ca
    v_mov_b32 v25, 0xf149f2ca
    v_mov_b32 v26, 0xf149f2ca
    v_mov_b32 v27, 0xf149f2ca
    v_mov_b32 v28, 0xf149f2ca
    v_mov_b32 v29, 0xf149f2ca
    v_mov_b32 v30, 0xf149f2ca
    v_mov_b32 v31, 0xf149f2ca
    v_mov_b32 v32, 0xf149f2ca
    v_mov_b32 v33, 0xf149f2ca
    v_mov_b32 v34, 0xf149f2ca
    v_mov_b32 v35, 0xf149f2ca
    v_mov_b32 v36, 0xf149f2ca
    v_mov_b32 v37, 0xf149f2ca
    v_mov_b32 v38, 0xf149f2ca
    v_mov_b32 v39, 0xf149f2ca
attn0_kernel_a4:
    s_waitcnt lgkmcnt(2)
    s_nop 0
    v_mfma_f32_32x32x16_bf16 v[56:71], v[104:107], v[4:7], v[24:39]
    v_mfma_f32_32x32x16_bf16 v[56:71], v[108:111], v[8:11], v[56:71]
    v_max3_f32 v21, v21, v72, v73
    v_max3_f32 v21, v21, v74, v75
    v_max3_f32 v21, v21, v76, v77
    v_max3_f32 v21, v21, v78, v79
    v_max3_f32 v21, v21, v80, v81
    v_max3_f32 v21, v21, v82, v83
    v_max3_f32 v21, v21, v84, v85
    v_max3_f32 v21, v21, v86, v87
    ds_read_b128 v[104:107], v20 offset:8192
    ds_read_b128 v[108:111], v20 offset:9216
    s_cmp_eq_u32 s37, 4
    s_cbranch_scc0 attn0_kernel_a5
    v_mov_b32 v24, 0xf149f2ca
    v_mov_b32 v25, 0xf149f2ca
    v_mov_b32 v26, 0xf149f2ca
    v_mov_b32 v27, 0xf149f2ca
    v_mov_b32 v28, 0xf149f2ca
    v_mov_b32 v29, 0xf149f2ca
    v_mov_b32 v30, 0xf149f2ca
    v_mov_b32 v31, 0xf149f2ca
    v_mov_b32 v32, 0xf149f2ca
    v_mov_b32 v33, 0xf149f2ca
    v_mov_b32 v34, 0xf149f2ca
    v_mov_b32 v35, 0xf149f2ca
    v_mov_b32 v36, 0xf149f2ca
    v_mov_b32 v37, 0xf149f2ca
    v_mov_b32 v38, 0xf149f2ca
    v_mov_b32 v39, 0xf149f2ca
attn0_kernel_a5:
    s_waitcnt lgkmcnt(2)
    s_nop 0
    v_mfma_f32_32x32x16_bf16 v[72:87], v[112:115], v[4:7], v[24:39]
    v_mfma_f32_32x32x16_bf16 v[72:87], v[116:119], v[8:11], v[72:87]
    v_max3_f32 v21, v21, v56, v57
    v_max3_f32 v21, v21, v58, v59
    v_max3_f32 v21, v21, v60, v61
    v_max3_f32 v21, v21, v62, v63
    v_max3_f32 v21, v21, v64, v65
    v_max3_f32 v21, v21, v66, v67
    v_max3_f32 v21, v21, v68, v69
    v_max3_f32 v21, v21, v70, v71
    ds_read_b128 v[112:115], v20 offset:4096
    ds_read_b128 v[116:119], v20 offset:5120
    s_cmp_eq_u32 s37, 5
    s_cbranch_scc0 attn0_kernel_a6
    v_mov_b32 v24, 0xf149f2ca
    v_mov_b32 v25, 0xf149f2ca
    v_mov_b32 v26, 0xf149f2ca
    v_mov_b32 v27, 0xf149f2ca
    v_mov_b32 v28, 0xf149f2ca
    v_mov_b32 v29, 0xf149f2ca
    v_mov_b32 v30, 0xf149f2ca
    v_mov_b32 v31, 0xf149f2ca
    v_mov_b32 v32, 0xf149f2ca
    v_mov_b32 v33, 0xf149f2ca
    v_mov_b32 v34, 0xf149f2ca
    v_mov_b32 v35, 0xf149f2ca
    v_mov_b32 v36, 0xf149f2ca
    v_mov_b32 v37, 0xf149f2ca
    v_mov_b32 v38, 0xf149f2ca
    v_mov_b32 v39, 0xf149f2ca
attn0_kernel_a6:
    s_waitcnt lgkmcnt(2)
    s_nop 0
    v_mfma_f32_32x32x16_bf16 v[56:71], v[104:107], v[4:7], v[24:39]
    v_mfma_f32_32x32x16_bf16 v[56:71], v[108:111], v[8:11], v[56:71]
    v_max3_f32 v21, v21, v72, v73
    v_max3_f32 v21, v21, v74, v75
    v_max3_f32 v21, v21, v76, v77
    v_max3_f32 v21, v21, v78, v79
    v_max3_f32 v21, v21, v80, v81
    v_max3_f32 v21, v21, v82, v83
    v_max3_f32 v21, v21, v84, v85
    v_max3_f32 v21, v21, v86, v87
    ds_read_b128 v[104:107], v20 offset:0
    ds_read_b128 v[108:111], v20 offset:1024
    s_cmp_eq_u32 s37, 6
    s_cbranch_scc0 attn0_kernel_a7
    v_mov_b32 v24, 0xf149f2ca
    v_mov_b32 v25, 0xf149f2ca
    v_mov_b32 v26, 0xf149f2ca
    v_mov_b32 v27, 0xf149f2ca
    v_mov_b32 v28, 0xf149f2ca
    v_mov_b32 v29, 0xf149f2ca
    v_mov_b32 v30, 0xf149f2ca
    v_mov_b32 v31, 0xf149f2ca
    v_mov_b32 v32, 0xf149f2ca
    v_mov_b32 v33, 0xf149f2ca
    v_mov_b32 v34, 0xf149f2ca
    v_mov_b32 v35, 0xf149f2ca
    v_mov_b32 v36, 0xf149f2ca
    v_mov_b32 v37, 0xf149f2ca
    v_mov_b32 v38, 0xf149f2ca
    v_mov_b32 v39, 0xf149f2ca
attn0_kernel_a7:
    s_waitcnt lgkmcnt(2)
    s_nop 0
    v_mfma_f32_32x32x16_bf16 v[72:87], v[112:115], v[4:7], v[24:39]
    v_mfma_f32_32x32x16_bf16 v[72:87], v[116:119], v[8:11], v[72:87]
    v_max3_f32 v21, v21, v56, v57
    v_max3_f32 v21, v21, v58, v59
    v_max3_f32 v21, v21, v60, v61
    v_max3_f32 v21, v21, v62, v63
    v_max3_f32 v21, v21, v64, v65
    v_max3_f32 v21, v21, v66, v67
    v_max3_f32 v21, v21, v68, v69
    v_max3_f32 v21, v21, v70, v71
    s_cmp_eq_u32 s37, 7
    s_cbranch_scc0 attn0_kernel_a8
    v_mov_b32 v24, 0xf149f2ca
    v_mov_b32 v25, 0xf149f2ca
    v_mov_b32 v26, 0xf149f2ca
    v_mov_b32 v27, 0xf149f2ca
    v_mov_b32 v28, 0xf149f2ca
    v_mov_b32 v29, 0xf149f2ca
    v_mov_b32 v30, 0xf149f2ca
    v_mov_b32 v31, 0xf149f2ca
    v_mov_b32 v32, 0xf149f2ca
    v_mov_b32 v33, 0xf149f2ca
    v_mov_b32 v34, 0xf149f2ca
    v_mov_b32 v35, 0xf149f2ca
    v_mov_b32 v36, 0xf149f2ca
    v_mov_b32 v37, 0xf149f2ca
    v_mov_b32 v38, 0xf149f2ca
    v_mov_b32 v39, 0xf149f2ca
attn0_kernel_a8:
    s_waitcnt lgkmcnt(0)
    s_nop 0
    v_mfma_f32_32x32x16_bf16 v[56:71], v[104:107], v[4:7], v[24:39]
    v_mfma_f32_32x32x16_bf16 v[56:71], v[108:111], v[8:11], v[56:71]
    v_max3_f32 v21, v21, v72, v73
    v_max3_f32 v21, v21, v74, v75
    v_max3_f32 v21, v21, v76, v77
    v_max3_f32 v21, v21, v78, v79
    v_max3_f32 v21, v21, v80, v81
    v_max3_f32 v21, v21, v82, v83
    v_max3_f32 v21, v21, v84, v85
    v_max3_f32 v21, v21, v86, v87
    ds_read_b128 v[112:115], v20 offset:28672
    ds_read_b128 v[116:119], v20 offset:29696
    ds_read_b128 v[120:123], v20 offset:34816
    ds_read_b128 v[124:127], v20 offset:35840
    ds_read_b128 v[128:131], v20 offset:2048
    ds_read_b128 v[132:135], v20 offset:3072
    v_cndmask_b32 v40, v56, v40, s[40:41]
    v_cndmask_b32 v41, v57, v41, s[42:43]
    v_cndmask_b32 v42, v58, v42, s[44:45]
    v_cndmask_b32 v43, v59, v43, s[46:47]
    v_cndmask_b32 v44, v60, v44, s[48:49]
    v_cndmask_b32 v45, v61, v45, s[50:51]
    v_cndmask_b32 v46, v62, v46, s[52:53]
    v_cndmask_b32 v47, v63, v47, s[54:55]
    v_cndmask_b32 v48, v64, v48, s[56:57]
    v_cndmask_b32 v49, v65, v49, s[58:59]
    v_cndmask_b32 v50, v66, v50, s[60:61]
    v_cndmask_b32 v51, v67, v51, s[62:63]
    v_cndmask_b32 v52, v68, v52, s[64:65]
    v_cndmask_b32 v53, v69, v53, s[66:67]
    v_cndmask_b32 v54, v70, v54, s[68:69]
    v_cndmask_b32 v55, v71, v55, s[70:71]
    v_max3_f32 v21, v21, v40, v41
    v_max3_f32 v21, v21, v42, v43
    v_max3_f32 v21, v21, v44, v45
    v_max3_f32 v21, v21, v46, v47
    v_max3_f32 v21, v21, v48, v49
    v_max3_f32 v21, v21, v50, v51
    v_max3_f32 v21, v21, v52, v53
    v_max3_f32 v21, v21, v54, v55
    v_mov_b32 v152, v21
    s_nop 1
    v_permlane32_swap_b32 v21, v152
    v_max_f32 v21, v21, v152
    v_sub_f32 v24, 0, v21
    v_sub_f32 v25, 0, v21
    v_sub_f32 v26, 0, v21
    v_sub_f32 v27, 0, v21
    v_sub_f32 v28, 0, v21
    v_sub_f32 v29, 0, v21
    v_sub_f32 v30, 0, v21
    v_sub_f32 v31, 0, v21
    v_sub_f32 v32, 0, v21
    v_sub_f32 v33, 0, v21
    v_sub_f32 v34, 0, v21
    v_sub_f32 v35, 0, v21
    v_sub_f32 v36, 0, v21
    v_sub_f32 v37, 0, v21
    v_sub_f32 v38, 0, v21
    v_sub_f32 v39, 0, v21
    s_cmp_eq_u32 s37, 0
    s_cbranch_scc0 attn0_kernel_b1
    v_mov_b32 v24, 0xf149f2ca
    v_mov_b32 v25, 0xf149f2ca
    v_mov_b32 v26, 0xf149f2ca
    v_mov_b32 v27, 0xf149f2ca
    v_mov_b32 v28, 0xf149f2ca
    v_mov_b32 v29, 0xf149f2ca
    v_mov_b32 v30, 0xf149f2ca
    v_mov_b32 v31, 0xf149f2ca
    v_mov_b32 v32, 0xf149f2ca
    v_mov_b32 v33, 0xf149f2ca
    v_mov_b32 v34, 0xf149f2ca
    v_mov_b32 v35, 0xf149f2ca
    v_mov_b32 v36, 0xf149f2ca
    v_mov_b32 v37, 0xf149f2ca
    v_mov_b32 v38, 0xf149f2ca
    v_mov_b32 v39, 0xf149f2ca
attn0_kernel_b1:
    s_waitcnt lgkmcnt(4)
    s_nop 0
    v_mfma_f32_32x32x16_bf16 v[72:87], v[112:115], v[4:7], v[24:39]
    v_mfma_f32_32x32x16_bf16 v[72:87], v[116:119], v[8:11], v[72:87]
    ds_read_b128 v[104:107], v20 offset:24576
    ds_read_b128 v[108:111], v20 offset:25600
    v_sub_f32 v40, v40, v21
    v_sub_f32 v41, v41, v21
    v_sub_f32 v42, v42, v21
    v_sub_f32 v43, v43, v21
    v_sub_f32 v44, v44, v21
    v_sub_f32 v45, v45, v21
    v_sub_f32 v46, v46, v21
    v_sub_f32 v47, v47, v21
    v_sub_f32 v48, v48, v21
    v_sub_f32 v49, v49, v21
    v_sub_f32 v50, v50, v21
    v_sub_f32 v51, v51, v21
    v_sub_f32 v52, v52, v21
    v_sub_f32 v53, v53, v21
    v_sub_f32 v54, v54, v21
    v_sub_f32 v55, v55, v21
    v_exp_f32 v40, v40
    v_exp_f32 v41, v41
    v_exp_f32 v42, v42
    v_exp_f32 v43, v43
    v_exp_f32 v44, v44
    v_exp_f32 v45, v45
    v_exp_f32 v46, v46
    v_exp_f32 v47, v47
    v_exp_f32 v48, v48
    v_exp_f32 v49, v49
    v_exp_f32 v50, v50
    v_exp_f32 v51, v51
    v_exp_f32 v52, v52
    v_exp_f32 v53, v53
    v_exp_f32 v54, v54
    v_exp_f32 v55, v55
    v_add_f32 v22, v40, v41
    v_add_f32 v23, v42, v43
    v_add_f32 v22, v22, v44
    v_add_f32 v23, v23, v45
    v_add_f32 v22, v22, v46
    v_add_f32 v23, v23, v47
    v_add_f32 v22, v22, v48
    v_add_f32 v23, v23, v49
    v_add_f32 v22, v22, v50
    v_add_f32 v23, v23, v51
    v_add_f32 v22, v22, v52
    v_add_f32 v23, v23, v53
    v_add_f32 v22, v22, v54
    v_add_f32 v23, v23, v55
    v_cvt_pk_bf16_f32 v144, v40, v41
    v_cvt_pk_bf16_f32 v145, v42, v43
    v_cvt_pk_bf16_f32 v146, v44, v45
    v_cvt_pk_bf16_f32 v147, v46, v47
    v_cvt_pk_bf16_f32 v148, v48, v49
    v_cvt_pk_bf16_f32 v149, v50, v51
    v_cvt_pk_bf16_f32 v150, v52, v53
    v_cvt_pk_bf16_f32 v151, v54, v55
    v_and_b32 v136, v144, v12
    v_and_b32 v137, v145, v13
    v_and_b32 v138, v146, v14
    v_and_b32 v139, v147, v15
    v_and_b32 v140, v148, v16
    v_and_b32 v141, v149, v17
    v_and_b32 v142, v150, v18
    v_and_b32 v143, v151, v19
    v_xor_b32 v144, v144, v136
    v_xor_b32 v145, v145, v137
    v_xor_b32 v146, v146, v138
    v_xor_b32 v147, v147, v139
    v_xor_b32 v148, v148, v140
    v_xor_b32 v149, v149, v141
    v_xor_b32 v150, v150, v142
    v_xor_b32 v151, v151, v143
    s_waitcnt lgkmcnt(2)
    v_mfma_f32_32x32x16_bf16 v[88:103], v[120:123], v[136:139], 0
    v_mfma_f32_32x32x16_bf16 v[88:103], v[124:127], v[140:143], v[88:103]
    v_mfma_f32_32x32x16_bf16 v[88:103], v[128:131], v[144:147], v[88:103]
    v_mfma_f32_32x32x16_bf16 v[88:103], v[132:135], v[148:151], v[88:103]
    ds_read_b128 v[128:131], v20 offset:30720
    ds_read_b128 v[132:135], v20 offset:31744
    s_cmp_eq_u32 s37, 1
    s_cbranch_scc0 attn0_kernel_b2
    v_mov_b32 v24, 0xf149f2ca
    v_mov_b32 v25, 0xf149f2ca
    v_mov_b32 v26, 0xf149f2ca
    v_mov_b32 v27, 0xf149f2ca
    v_mov_b32 v28, 0xf149f2ca
    v_mov_b32 v29, 0xf149f2ca
    v_mov_b32 v30, 0xf149f2ca
    v_mov_b32 v31, 0xf149f2ca
    v_mov_b32 v32, 0xf149f2ca
    v_mov_b32 v33, 0xf149f2ca
    v_mov_b32 v34, 0xf149f2ca
    v_mov_b32 v35, 0xf149f2ca
    v_mov_b32 v36, 0xf149f2ca
    v_mov_b32 v37, 0xf149f2ca
    v_mov_b32 v38, 0xf149f2ca
    v_mov_b32 v39, 0xf149f2ca
attn0_kernel_b2:
    s_waitcnt lgkmcnt(2)
    s_nop 0
    v_mfma_f32_32x32x16_bf16 v[56:71], v[104:107], v[4:7], v[24:39]
    v_mfma_f32_32x32x16_bf16 v[56:71], v[108:111], v[8:11], v[56:71]
    ds_read_b128 v[112:115], v20 offset:20480
    ds_read_b128 v[116:119], v20 offset:21504
    v_exp_f32 v72, v72
    v_exp_f32 v73, v73
    v_exp_f32 v74, v74
    v_exp_f32 v75, v75
    v_exp_f32 v76, v76
    v_exp_f32 v77, v77
    v_exp_f32 v78, v78
    v_exp_f32 v79, v79
    v_exp_f32 v80, v80
    v_exp_f32 v81, v81
    v_exp_f32 v82, v82
    v_exp_f32 v83, v83
    v_exp_f32 v84, v84
    v_exp_f32 v85, v85
    v_exp_f32 v86, v86
    v_exp_f32 v87, v87
    v_add_f32 v22, v22, v72
    v_add_f32 v23, v23, v73
    v_add_f32 v22, v22, v74
    v_add_f32 v23, v23, v75
    v_add_f32 v22, v22, v76
    v_add_f32 v23, v23, v77
    v_add_f32 v22, v22, v78
    v_add_f32 v23, v23, v79
    v_add_f32 v22, v22, v80
    v_add_f32 v23, v23, v81
    v_add_f32 v22, v22, v82
    v_add_f32 v23, v23, v83
    v_add_f32 v22, v22, v84
    v_add_f32 v23, v23, v85
    v_add_f32 v22, v22, v86
    v_add_f32 v23, v23, v87
    v_cvt_pk_bf16_f32 v144, v72, v73
    v_cvt_pk_bf16_f32 v145, v74, v75
    v_cvt_pk_bf16_f32 v146, v76, v77
    v_cvt_pk_bf16_f32 v147, v78, v79
    v_cvt_pk_bf16_f32 v148, v80, v81
    v_cvt_pk_bf16_f32 v149, v82, v83
    v_cvt_pk_bf16_f32 v150, v84, v85
    v_cvt_pk_bf16_f32 v151, v86, v87
    s_waitcnt lgkmcnt(2)
    v_mfma_f32_32x32x16_bf16 v[88:103], v[128:131], v[144:147], v[88:103]
    v_mfma_f32_32x32x16_bf16 v[88:103], v[132:135], v[148:151], v[88:103]
    ds_read_b128 v[120:123], v20 offset:26624
    ds_read_b128 v[124:127], v20 offset:27648
    s_cmp_eq_u32 s37, 2
    s_cbranch_scc0 attn0_kernel_b3
    v_mov_b32 v24, 0xf149f2ca
    v_mov_b32 v25, 0xf149f2ca
    v_mov_b32 v26, 0xf149f2ca
    v_mov_b32 v27, 0xf149f2ca
    v_mov_b32 v28, 0xf149f2ca
    v_mov_b32 v29, 0xf149f2ca
    v_mov_b32 v30, 0xf149f2ca
    v_mov_b32 v31, 0xf149f2ca
    v_mov_b32 v32, 0xf149f2ca
    v_mov_b32 v33, 0xf149f2ca
    v_mov_b32 v34, 0xf149f2ca
    v_mov_b32 v35, 0xf149f2ca
    v_mov_b32 v36, 0xf149f2ca
    v_mov_b32 v37, 0xf149f2ca
    v_mov_b32 v38, 0xf149f2ca
    v_mov_b32 v39, 0xf149f2ca
attn0_kernel_b3:
    s_waitcnt lgkmcnt(2)
    s_nop 0
    v_mfma_f32_32x32x16_bf16 v[72:87], v[112:115], v[4:7], v[24:39]
    v_mfma_f32_32x32x16_bf16 v[72:87], v[116:119], v[8:11], v[72:87]
    ds_read_b128 v[104:107], v20 offset:16384
    ds_read_b128 v[108:111], v20 offset:17408
    v_exp_f32 v56, v56
    v_exp_f32 v57, v57
    v_exp_f32 v58, v58
    v_exp_f32 v59, v59
    v_exp_f32 v60, v60
    v_exp_f32 v61, v61
    v_exp_f32 v62, v62
    v_exp_f32 v63, v63
    v_exp_f32 v64, v64
    v_exp_f32 v65, v65
    v_exp_f32 v66, v66
    v_exp_f32 v67, v67
    v_exp_f32 v68, v68
    v_exp_f32 v69, v69
    v_exp_f32 v70, v70
    v_exp_f32 v71, v71
    v_add_f32 v22, v22, v56
    v_add_f32 v23, v23, v57
    v_add_f32 v22, v22, v58
    v_add_f32 v23, v23, v59
    v_add_f32 v22, v22, v60
    v_add_f32 v23, v23, v61
    v_add_f32 v22, v22, v62
    v_add_f32 v23, v23, v63
    v_add_f32 v22, v22, v64
    v_add_f32 v23, v23, v65
    v_add_f32 v22, v22, v66
    v_add_f32 v23, v23, v67
    v_add_f32 v22, v22, v68
    v_add_f32 v23, v23, v69
    v_add_f32 v22, v22, v70
    v_add_f32 v23, v23, v71
    v_cvt_pk_bf16_f32 v136, v56, v57
    v_cvt_pk_bf16_f32 v137, v58, v59
    v_cvt_pk_bf16_f32 v138, v60, v61
    v_cvt_pk_bf16_f32 v139, v62, v63
    v_cvt_pk_bf16_f32 v140, v64, v65
    v_cvt_pk_bf16_f32 v141, v66, v67
    v_cvt_pk_bf16_f32 v142, v68, v69
    v_cvt_pk_bf16_f32 v143, v70, v71
    s_waitcnt lgkmcnt(2)
    v_mfma_f32_32x32x16_bf16 v[88:103], v[120:123], v[136:139], v[88:103]
    v_mfma_f32_32x32x16_bf16 v[88:103], v[124:127], v[140:143], v[88:103]
    ds_read_b128 v[128:131], v20 offset:22528
    ds_read_b128 v[132:135], v20 offset:23552
    s_cmp_eq_u32 s37, 3
    s_cbranch_scc0 attn0_kernel_b4
    v_mov_b32 v24, 0xf149f2ca
    v_mov_b32 v25, 0xf149f2ca
    v_mov_b32 v26, 0xf149f2ca
    v_mov_b32 v27, 0xf149f2ca
    v_mov_b32 v28, 0xf149f2ca
    v_mov_b32 v29, 0xf149f2ca
    v_mov_b32 v30, 0xf149f2ca
    v_mov_b32 v31, 0xf149f2ca
    v_mov_b32 v32, 0xf149f2ca
    v_mov_b32 v33, 0xf149f2ca
    v_mov_b32 v34, 0xf149f2ca
    v_mov_b32 v35, 0xf149f2ca
    v_mov_b32 v36, 0xf149f2ca
    v_mov_b32 v37, 0xf149f2ca
    v_mov_b32 v38, 0xf149f2ca
    v_mov_b32 v39, 0xf149f2ca
attn0_kernel_b4:
    s_waitcnt lgkmcnt(2)
    s_nop 0
    v_mfma_f32_32x32x16_bf16 v[56:71], v[104:107], v[4:7], v[24:39]
    v_mfma_f32_32x32x16_bf16 v[56:71], v[108:111], v[8:11], v[56:71]
    ds_read_b128 v[112:115], v20 offset:12288
    ds_read_b128 v[116:119], v20 offset:13312
    v_exp_f32 v72, v72
    v_exp_f32 v73, v73
    v_exp_f32 v74, v74
    v_exp_f32 v75, v75
    v_exp_f32 v76, v76
    v_exp_f32 v77, v77
    v_exp_f32 v78, v78
    v_exp_f32 v79, v79
    v_exp_f32 v80, v80
    v_exp_f32 v81, v81
    v_exp_f32 v82, v82
    v_exp_f32 v83, v83
    v_exp_f32 v84, v84
    v_exp_f32 v85, v85
    v_exp_f32 v86, v86
    v_exp_f32 v87, v87
    v_add_f32 v22, v22, v72
    v_add_f32 v23, v23, v73
    v_add_f32 v22, v22, v74
    v_add_f32 v23, v23, v75
    v_add_f32 v22, v22, v76
    v_add_f32 v23, v23, v77
    v_add_f32 v22, v22, v78
    v_add_f32 v23, v23, v79
    v_add_f32 v22, v22, v80
    v_add_f32 v23, v23, v81
    v_add_f32 v22, v22, v82
    v_add_f32 v23, v23, v83
    v_add_f32 v22, v22, v84
    v_add_f32 v23, v23, v85
    v_add_f32 v22, v22, v86
    v_add_f32 v23, v23, v87
    v_cvt_pk_bf16_f32 v144, v72, v73
    v_cvt_pk_bf16_f32 v145, v74, v75
    v_cvt_pk_bf16_f32 v146, v76, v77
    v_cvt_pk_bf16_f32 v147, v78, v79
    v_cvt_pk_bf16_f32 v148, v80, v81
    v_cvt_pk_bf16_f32 v149, v82, v83
    v_cvt_pk_bf16_f32 v150, v84, v85
    v_cvt_pk_bf16_f32 v151, v86, v87
    s_waitcnt lgkmcnt(2)
    v_mfma_f32_32x32x16_bf16 v[88:103], v[128:131], v[144:147], v[88:103]
    v_mfma_f32_32x32x16_bf16 v[88:103], v[132:135], v[148:151], v[88:103]
    ds_read_b128 v[120:123], v20 offset:18432
    ds_read_b128 v[124:127], v20 offset:19456
    s_cmp_eq_u32 s37, 4
    s_cbranch_scc0 attn0_kernel_b5
    v_mov_b32 v24, 0xf149f2ca
    v_mov_b32 v25, 0xf149f2ca
    v_mov_b32 v26, 0xf149f2ca
    v_mov_b32 v27, 0xf149f2ca
    v_mov_b32 v28, 0xf149f2ca
    v_mov_b32 v29, 0xf149f2ca
    v_mov_b32 v30, 0xf149f2ca
    v_mov_b32 v31, 0xf149f2ca
    v_mov_b32 v32, 0xf149f2ca
    v_mov_b32 v33, 0xf149f2ca
    v_mov_b32 v34, 0xf149f2ca
    v_mov_b32 v35, 0xf149f2ca
    v_mov_b32 v36, 0xf149f2ca
    v_mov_b32 v37, 0xf149f2ca
    v_mov_b32 v38, 0xf149f2ca
    v_mov_b32 v39, 0xf149f2ca
attn0_kernel_b5:
    s_waitcnt lgkmcnt(2)
    s_nop 0
    v_mfma_f32_32x32x16_bf16 v[72:87], v[112:115], v[4:7], v[24:39]
    v_mfma_f32_32x32x16_bf16 v[72:87], v[116:119], v[8:11], v[72:87]
    ds_read_b128 v[104:107], v20 offset:8192
    ds_read_b128 v[108:111], v20 offset:9216
    v_exp_f32 v56, v56
    v_exp_f32 v57, v57
    v_exp_f32 v58, v58
    v_exp_f32 v59, v59
    v_exp_f32 v60, v60
    v_exp_f32 v61, v61
    v_exp_f32 v62, v62
    v_exp_f32 v63, v63
    v_exp_f32 v64, v64
    v_exp_f32 v65, v65
    v_exp_f32 v66, v66
    v_exp_f32 v67, v67
    v_exp_f32 v68, v68
    v_exp_f32 v69, v69
    v_exp_f32 v70, v70
    v_exp_f32 v71, v71
    v_add_f32 v22, v22, v56
    v_add_f32 v23, v23, v57
    v_add_f32 v22, v22, v58
    v_add_f32 v23, v23, v59
    v_add_f32 v22, v22, v60
    v_add_f32 v23, v23, v61
    v_add_f32 v22, v22, v62
    v_add_f32 v23, v23, v63
    v_add_f32 v22, v22, v64
    v_add_f32 v23, v23, v65
    v_add_f32 v22, v22, v66
    v_add_f32 v23, v23, v67
    v_add_f32 v22, v22, v68
    v_add_f32 v23, v23, v69
    v_add_f32 v22, v22, v70
    v_add_f32 v23, v23, v71
    v_cvt_pk_bf16_f32 v136, v56, v57
    v_cvt_pk_bf16_f32 v137, v58, v59
    v_cvt_pk_bf16_f32 v138, v60, v61
    v_cvt_pk_bf16_f32 v139, v62, v63
    v_cvt_pk_bf16_f32 v140, v64, v65
    v_cvt_pk_bf16_f32 v141, v66, v67
    v_cvt_pk_bf16_f32 v142, v68, v69
    v_cvt_pk_bf16_f32 v143, v70, v71
    s_waitcnt lgkmcnt(2)
    v_mfma_f32_32x32x16_bf16 v[88:103], v[120:123], v[136:139], v[88:103]
    v_mfma_f32_32x32x16_bf16 v[88:103], v[124:127], v[140:143], v[88:103]
    ds_read_b128 v[128:131], v20 offset:14336
    ds_read_b128 v[132:135], v20 offset:15360
    s_cmp_eq_u32 s37, 5
    s_cbranch_scc0 attn0_kernel_b6
    v_mov_b32 v24, 0xf149f2ca
    v_mov_b32 v25, 0xf149f2ca
    v_mov_b32 v26, 0xf149f2ca
    v_mov_b32 v27, 0xf149f2ca
    v_mov_b32 v28, 0xf149f2ca
    v_mov_b32 v29, 0xf149f2ca
    v_mov_b32 v30, 0xf149f2ca
    v_mov_b32 v31, 0xf149f2ca
    v_mov_b32 v32, 0xf149f2ca
    v_mov_b32 v33, 0xf149f2ca
    v_mov_b32 v34, 0xf149f2ca
    v_mov_b32 v35, 0xf149f2ca
    v_mov_b32 v36, 0xf149f2ca
    v_mov_b32 v37, 0xf149f2ca
    v_mov_b32 v38, 0xf149f2ca
    v_mov_b32 v39, 0xf149f2ca
attn0_kernel_b6:
    s_waitcnt lgkmcnt(2)
    s_nop 0
    v_mfma_f32_32x32x16_bf16 v[56:71], v[104:107], v[4:7], v[24:39]
    v_mfma_f32_32x32x16_bf16 v[56:71], v[108:111], v[8:11], v[56:71]
    ds_read_b128 v[112:115], v20 offset:4096
    ds_read_b128 v[116:119], v20 offset:5120
    v_exp_f32 v72, v72
    v_exp_f32 v73, v73
    v_exp_f32 v74, v74
    v_exp_f32 v75, v75
    v_exp_f32 v76, v76
    v_exp_f32 v77, v77
    v_exp_f32 v78, v78
    v_exp_f32 v79, v79
    v_exp_f32 v80, v80
    v_exp_f32 v81, v81
    v_exp_f32 v82, v82
    v_exp_f32 v83, v83
    v_exp_f32 v84, v84
    v_exp_f32 v85, v85
    v_exp_f32 v86, v86
    v_exp_f32 v87, v87
    v_add_f32 v22, v22, v72
    v_add_f32 v23, v23, v73
    v_add_f32 v22, v22, v74
    v_add_f32 v23, v23, v75
    v_add_f32 v22, v22, v76
    v_add_f32 v23, v23, v77
    v_add_f32 v22, v22, v78
    v_add_f32 v23, v23, v79
    v_add_f32 v22, v22, v80
    v_add_f32 v23, v23, v81
    v_add_f32 v22, v22, v82
    v_add_f32 v23, v23, v83
    v_add_f32 v22, v22, v84
    v_add_f32 v23, v23, v85
    v_add_f32 v22, v22, v86
    v_add_f32 v23, v23, v87
    v_cvt_pk_bf16_f32 v144, v72, v73
    v_cvt_pk_bf16_f32 v145, v74, v75
    v_cvt_pk_bf16_f32 v146, v76, v77
    v_cvt_pk_bf16_f32 v147, v78, v79
    v_cvt_pk_bf16_f32 v148, v80, v81
    v_cvt_pk_bf16_f32 v149, v82, v83
    v_cvt_pk_bf16_f32 v150, v84, v85
    v_cvt_pk_bf16_f32 v151, v86, v87
    s_waitcnt lgkmcnt(2)
    v_mfma_f32_32x32x16_bf16 v[88:103], v[128:131], v[144:147], v[88:103]
    v_mfma_f32_32x32x16_bf16 v[88:103], v[132:135], v[148:151], v[88:103]
    ds_read_b128 v[120:123], v20 offset:10240
    ds_read_b128 v[124:127], v20 offset:11264
    s_cmp_eq_u32 s37, 6
    s_cbranch_scc0 attn0_kernel_b7
    v_mov_b32 v24, 0xf149f2ca
    v_mov_b32 v25, 0xf149f2ca
    v_mov_b32 v26, 0xf149f2ca
    v_mov_b32 v27, 0xf149f2ca
    v_mov_b32 v28, 0xf149f2ca
    v_mov_b32 v29, 0xf149f2ca
    v_mov_b32 v30, 0xf149f2ca
    v_mov_b32 v31, 0xf149f2ca
    v_mov_b32 v32, 0xf149f2ca
    v_mov_b32 v33, 0xf149f2ca
    v_mov_b32 v34, 0xf149f2ca
    v_mov_b32 v35, 0xf149f2ca
    v_mov_b32 v36, 0xf149f2ca
    v_mov_b32 v37, 0xf149f2ca
    v_mov_b32 v38, 0xf149f2ca
    v_mov_b32 v39, 0xf149f2ca
attn0_kernel_b7:
    s_waitcnt lgkmcnt(2)
    s_nop 0
    v_mfma_f32_32x32x16_bf16 v[72:87], v[112:115], v[4:7], v[24:39]
    v_mfma_f32_32x32x16_bf16 v[72:87], v[116:119], v[8:11], v[72:87]
    v_exp_f32 v56, v56
    v_exp_f32 v57, v57
    v_exp_f32 v58, v58
    v_exp_f32 v59, v59
    v_exp_f32 v60, v60
    v_exp_f32 v61, v61
    v_exp_f32 v62, v62
    v_exp_f32 v63, v63
    v_exp_f32 v64, v64
    v_exp_f32 v65, v65
    v_exp_f32 v66, v66
    v_exp_f32 v67, v67
    v_exp_f32 v68, v68
    v_exp_f32 v69, v69
    v_exp_f32 v70, v70
    v_exp_f32 v71, v71
    v_add_f32 v22, v22, v56
    v_add_f32 v23, v23, v57
    v_add_f32 v22, v22, v58
    v_add_f32 v23, v23, v59
    v_add_f32 v22, v22, v60
    v_add_f32 v23, v23, v61
    v_add_f32 v22, v22, v62
    v_add_f32 v23, v23, v63
    v_add_f32 v22, v22, v64
    v_add_f32 v23, v23, v65
    v_add_f32 v22, v22, v66
    v_add_f32 v23, v23, v67
    v_add_f32 v22, v22, v68
    v_add_f32 v23, v23, v69
    v_add_f32 v22, v22, v70
    v_add_f32 v23, v23, v71
    v_cvt_pk_bf16_f32 v136, v56, v57
    v_cvt_pk_bf16_f32 v137, v58, v59
    v_cvt_pk_bf16_f32 v138, v60, v61
    v_cvt_pk_bf16_f32 v139, v62, v63
    v_cvt_pk_bf16_f32 v140, v64, v65
    v_cvt_pk_bf16_f32 v141, v66, v67
    v_cvt_pk_bf16_f32 v142, v68, v69
    v_cvt_pk_bf16_f32 v143, v70, v71
    s_waitcnt lgkmcnt(0)
    v_mfma_f32_32x32x16_bf16 v[88:103], v[120:123], v[136:139], v[88:103]
    v_mfma_f32_32x32x16_bf16 v[88:103], v[124:127], v[140:143], v[88:103]
    ds_read_b128 v[128:131], v20 offset:6144
    ds_read_b128 v[132:135], v20 offset:7168
    v_exp_f32 v72, v72
    v_exp_f32 v73, v73
    v_exp_f32 v74, v74
    v_exp_f32 v75, v75
    v_exp_f32 v76, v76
    v_exp_f32 v77, v77
    v_exp_f32 v78, v78
    v_exp_f32 v79, v79
    v_exp_f32 v80, v80
    v_exp_f32 v81, v81
    v_exp_f32 v82, v82
    v_exp_f32 v83, v83
    v_exp_f32 v84, v84
    v_exp_f32 v85, v85
    v_exp_f32 v86, v86
    v_exp_f32 v87, v87
    v_add_f32 v22, v22, v72
    v_add_f32 v23, v23, v73
    v_add_f32 v22, v22, v74
    v_add_f32 v23, v23, v75
    v_add_f32 v22, v22, v76
    v_add_f32 v23, v23, v77
    v_add_f32 v22, v22, v78
    v_add_f32 v23, v23, v79
    v_add_f32 v22, v22, v80
    v_add_f32 v23, v23, v81
    v_add_f32 v22, v22, v82
    v_add_f32 v23, v23, v83
    v_add_f32 v22, v22, v84
    v_add_f32 v23, v23, v85
    v_add_f32 v22, v22, v86
    v_add_f32 v23, v23, v87
    v_cvt_pk_bf16_f32 v144, v72, v73
    v_cvt_pk_bf16_f32 v145, v74, v75
    v_cvt_pk_bf16_f32 v146, v76, v77
    v_cvt_pk_bf16_f32 v147, v78, v79
    v_cvt_pk_bf16_f32 v148, v80, v81
    v_cvt_pk_bf16_f32 v149, v82, v83
    v_cvt_pk_bf16_f32 v150, v84, v85
    v_cvt_pk_bf16_f32 v151, v86, v87
    s_waitcnt lgkmcnt(0)
    v_mfma_f32_32x32x16_bf16 v[88:103], v[128:131], v[144:147], v[88:103]
    v_mfma_f32_32x32x16_bf16 v[88:103], v[132:135], v[148:151], v[88:103]
    v_add_f32 v22, v22, v23
    v_mov_b32 v152, v22
    s_nop 1
    v_permlane32_swap_b32 v22, v152
    v_add_f32 v22, v22, v152
    v_rcp_f32 v22, v22
    s_lshl_b32 s33, s37, 16
    s_lshl_b32 s34, s30, 11
    s_add_u32 s33, s33, s34
    s_add_u32 s33, s33, 0xc00000
    s_nop 0
    v_mul_f32 v88, v88, v22
    v_mul_f32 v89, v89, v22
    v_mul_f32 v90, v90, v22
    v_mul_f32 v91, v91, v22
    v_mul_f32 v92, v92, v22
    v_mul_f32 v93, v93, v22
    v_mul_f32 v94, v94, v22
    v_mul_f32 v95, v95, v22
    v_mul_f32 v96, v96, v22
    v_mul_f32 v97, v97, v22
    v_mul_f32 v98, v98, v22
    v_mul_f32 v99, v99, v22
    v_mul_f32 v100, v100, v22
    v_mul_f32 v101, v101, v22
    v_mul_f32 v102, v102, v22
    v_mul_f32 v103, v103, v22
    v_cvt_pk_bf16_f32 v88, v88, v89
    v_cvt_pk_bf16_f32 v89, v90, v91
    v_cvt_pk_bf16_f32 v90, v92, v93
    v_cvt_pk_bf16_f32 v91, v94, v95
    v_cvt_pk_bf16_f32 v92, v96, v97
    v_cvt_pk_bf16_f32 v93, v98, v99
    v_cvt_pk_bf16_f32 v94, v100, v101
    v_cvt_pk_bf16_f32 v95, v102, v103
    buffer_store_dwordx4 v[88:91], v3, s[20:23], s33 offen
    buffer_store_dwordx4 v[92:95], v3, s[20:23], s33 offen offset:1024
attn0_kernel_end:
attn0_kernel_exit:
    s_endpgm
.globl wo0_kernel
.p2align 8
.type wo0_kernel,@function
wo0_kernel:
    s_cmp_ge_u32 s2, 256
    s_cbranch_scc1 wo0_kernel_exit
    s_load_dwordx2 s[4:5], s[0:1], 0
    s_load_dwordx2 s[6:7], s[0:1], 16
    s_load_dwordx2 s[8:9], s[0:1], 80
    s_load_dwordx2 s[10:11], s[0:1], 32
    v_lshrrev_b32 v1, 6, v0
    v_and_b32 v2, 63, v0
    v_readfirstlane_b32 s3, v1
    s_and_b32 s24, s2, 7
    s_lshr_b32 s25, s2, 3
    s_lshl_b32 s26, s24, 1
    s_and_b32 s27, s25, 1
    s_add_u32 s26, s26, s27
    s_lshr_b32 s27, s25, 1
    s_and_b32 s28, s3, 3
    s_lshr_b32 s29, s3, 2
    v_bfe_u32 v4, v2, 3, 2
    v_lshrrev_b32 v5, 5, v2
    v_lshl_add_u32 v4, v5, 3, v4
    s_lshr_b32 s30, s3, 1
    s_lshl_b32 s30, s30, 4
    s_and_b32 s31, s3, 1
    s_lshl_b32 s31, s31, 2
    s_add_u32 s30, s30, s31
    v_add_u32 v4, s30, v4
    v_lshlrev_b32 v4, 11, v4
    v_lshrrev_b32 v6, 2, v2
    v_and_b32 v6, 4, v6
    v_xor_b32 v6, v6, v2
    v_and_b32 v6, 7, v6
    v_lshl_add_u32 v4, v6, 4, v4
    v_lshlrev_b32 v3, 4, v2
    s_waitcnt lgkmcnt(0)
    s_mov_b32 s12, s4
    s_mov_b32 s13, s5
    s_mov_b32 s14, 0x400000
    s_mov_b32 s15, 0x20000
    s_mov_b32 s16, s6
    s_mov_b32 s17, s7
    s_mov_b32 s18, 0x200000
    s_mov_b32 s19, 0x20000
    s_mov_b32 s20, s8
    s_mov_b32 s21, s9
    s_mov_b32 s22, 0x8000000
    s_mov_b32 s23, 0x20000
    s_mov_b32 s40, s10
    s_mov_b32 s41, s11
    s_mov_b32 s42, 0x800
    s_mov_b32 s43, 0x20000
    s_lshl_b32 s30, s27, 7
    s_lshl_b32 s31, s3, 10
    s_mov_b32 m0, s31
    s_nop 0
    buffer_load_dwordx4 v4, s[16:19], s30 offen lds
    s_add_u32 m0, m0, 8192
    s_add_u32 s30, s30, 131072
    buffer_load_dwordx4 v4, s[16:19], s30 offen lds
    s_add_u32 m0, m0, 8192
    s_add_u32 s30, s30, 131072
    buffer_load_dwordx4 v4, s[16:19], s30 offen lds
    s_add_u32 m0, m0, 8192
    s_add_u32 s30, s30, 131072
    buffer_load_dwordx4 v4, s[16:19], s30 offen lds
    s_add_u32 m0, m0, 8192
    s_add_u32 s30, s30, 131072
    buffer_load_dwordx4 v4, s[16:19], s30 offen lds
    s_add_u32 m0, m0, 8192
    s_add_u32 s30, s30, 131072
    buffer_load_dwordx4 v4, s[16:19], s30 offen lds
    s_add_u32 m0, m0, 8192
    s_add_u32 s30, s30, 131072
    buffer_load_dwordx4 v4, s[16:19], s30 offen lds
    s_add_u32 m0, m0, 8192
    s_add_u32 s30, s30, 131072
    buffer_load_dwordx4 v4, s[16:19], s30 offen lds
    s_add_u32 m0, m0, 8192
    s_add_u32 s30, s30, 131072
    buffer_load_dwordx4 v4, s[16:19], s30 offen lds
    s_add_u32 m0, m0, 8192
    s_add_u32 s30, s30, 131072
    buffer_load_dwordx4 v4, s[16:19], s30 offen lds
    s_add_u32 m0, m0, 8192
    s_add_u32 s30, s30, 131072
    buffer_load_dwordx4 v4, s[16:19], s30 offen lds
    s_add_u32 m0, m0, 8192
    s_add_u32 s30, s30, 131072
    buffer_load_dwordx4 v4, s[16:19], s30 offen lds
    s_add_u32 m0, m0, 8192
    s_add_u32 s30, s30, 131072
    buffer_load_dwordx4 v4, s[16:19], s30 offen lds
    s_add_u32 m0, m0, 8192
    s_add_u32 s30, s30, 131072
    buffer_load_dwordx4 v4, s[16:19], s30 offen lds
    s_add_u32 m0, m0, 8192
    s_add_u32 s30, s30, 131072
    buffer_load_dwordx4 v4, s[16:19], s30 offen lds
    s_add_u32 m0, m0, 8192
    s_add_u32 s30, s30, 131072
    buffer_load_dwordx4 v4, s[16:19], s30 offen lds
    v_and_b32 v7, 31, v2
    s_lshl_b32 s32, s26, 2
    s_add_u32 s32, s32, s28
    s_lshl_b32 s33, s27, 7
    s_lshl_b32 s34, s29, 6
    s_add_u32 s33, s33, s34
    v_lshlrev_b32 v8, 3, v5
    buffer_load_dwordx2 v[48:49], v8, s[40:43], s33 offen offset:0
    buffer_load_dwordx2 v[50:51], v8, s[40:43], s33 offen offset:16
    buffer_load_dwordx2 v[52:53], v8, s[40:43], s33 offen offset:32
    buffer_load_dwordx2 v[54:55], v8, s[40:43], s33 offen offset:48
    s_lshl_b32 s35, s26, 4
    s_add_u32 s35, s35, s27
    s_lshl_b32 s35, s35, 14
    s_lshl_b32 s34, s28, 12
    s_add_u32 s35, s35, s34
    s_lshl_b32 s34, s29, 11
    s_add_u32 s35, s35, s34
    v_lshl_add_u32 v9, v7, 11, v8
    s_lshl_b32 s34, s32, 16
    s_add_u32 s34, s34, s33
    buffer_load_dwordx2 v[40:41], v9, s[12:15], s34 offen offset:0
    buffer_load_dwordx2 v[42:43], v9, s[12:15], s34 offen offset:16
    buffer_load_dwordx2 v[44:45], v9, s[12:15], s34 offen offset:32
    buffer_load_dwordx2 v[46:47], v9, s[12:15], s34 offen offset:48
    s_lshl_b32 s36, s32, 16
    s_lshl_b32 s34, s29, 15
    s_add_u32 s36, s36, s34
    s_add_u32 s36, s36, 0xc00000
    buffer_load_dwordx4 v[64:67], v3, s[20:23], s36 offen offset:0
    buffer_load_dwordx4 v[68:71], v3, s[20:23], s36 offen offset:1024
    buffer_load_dwordx4 v[72:75], v3, s[20:23], s36 offen offset:2048
    buffer_load_dwordx4 v[76:79], v3, s[20:23], s36 offen offset:3072
    s_add_u32 s36, s36, 4096
    buffer_load_dwordx4 v[80:83], v3, s[20:23], s36 offen offset:0
    buffer_load_dwordx4 v[84:87], v3, s[20:23], s36 offen offset:1024
    buffer_load_dwordx4 v[88:91], v3, s[20:23], s36 offen offset:2048
    buffer_load_dwordx4 v[92:95], v3, s[20:23], s36 offen offset:3072
    s_add_u32 s36, s36, 4096
    buffer_load_dwordx4 v[96:99], v3, s[20:23], s36 offen offset:0
    buffer_load_dwordx4 v[100:103], v3, s[20:23], s36 offen offset:1024
    buffer_load_dwordx4 v[104:107], v3, s[20:23], s36 offen offset:2048
    buffer_load_dwordx4 v[108:111], v3, s[20:23], s36 offen offset:3072
    s_add_u32 s36, s36, 4096
    buffer_load_dwordx4 v[112:115], v3, s[20:23], s36 offen offset:0
    buffer_load_dwordx4 v[116:119], v3, s[20:23], s36 offen offset:1024
    buffer_load_dwordx4 v[120:123], v3, s[20:23], s36 offen offset:2048
    buffer_load_dwordx4 v[124:127], v3, s[20:23], s36 offen offset:3072
    s_add_u32 s36, s36, 4096
    buffer_load_dwordx4 v[128:131], v3, s[20:23], s36 offen offset:0
    buffer_load_dwordx4 v[132:135], v3, s[20:23], s36 offen offset:1024
    buffer_load_dwordx4 v[136:139], v3, s[20:23], s36 offen offset:2048
    buffer_load_dwordx4 v[140:143], v3, s[20:23], s36 offen offset:3072
    s_add_u32 s36, s36, 4096
    buffer_load_dwordx4 v[144:147], v3, s[20:23], s36 offen offset:0
    buffer_load_dwordx4 v[148:151], v3, s[20:23], s36 offen offset:1024
    buffer_load_dwordx4 v[152:155], v3, s[20:23], s36 offen offset:2048
    buffer_load_dwordx4 v[156:159], v3, s[20:23], s36 offen offset:3072
    s_add_u32 s36, s36, 4096
    buffer_load_dwordx4 v[160:163], v3, s[20:23], s36 offen offset:0
    buffer_load_dwordx4 v[164:167], v3, s[20:23], s36 offen offset:1024
    buffer_load_dwordx4 v[168:171], v3, s[20:23], s36 offen offset:2048
    buffer_load_dwordx4 v[172:175], v3, s[20:23], s36 offen offset:3072
    s_add_u32 s36, s36, 4096
    buffer_load_dwordx4 v[176:179], v3, s[20:23], s36 offen offset:0
    buffer_load_dwordx4 v[180:183], v3, s[20:23], s36 offen offset:1024
    buffer_load_dwordx4 v[184:187], v3, s[20:23], s36 offen offset:2048
    buffer_load_dwordx4 v[188:191], v3, s[20:23], s36 offen offset:3072
    v_bfe_u32 v10, v2, 2, 2
    v_lshl_add_u32 v11, v5, 3, v10
    v_lshlrev_b32 v11, 7, v11
    v_lshrrev_b32 v10, 1, v10
    v_xor_b32 v10, s29, v10
    v_lshl_add_u32 v11, v10, 6, v11
    v_bfe_u32 v10, v2, 4, 1
    v_lshl_add_u32 v11, v10, 5, v11
    v_and_b32 v10, 3, v2
    v_lshl_add_u32 v11, v10, 3, v11
    s_lshl_b32 s34, s29, 16
    v_add_u32 v58, s34, v11
    v_xor_b32 v59, 64, v58
    v_mov_b32 v60, v7
    v_mov_b32 v61, v5
    v_mov_b32 v62, v3
    s_waitcnt vmcnt(40)
    s_barrier
    ds_read_b64_tr_b16 v[192:193], v58 offset:0
    ds_read_b64_tr_b16 v[194:195], v58 offset:512
    ds_read_b64_tr_b16 v[196:197], v59 offset:0
    ds_read_b64_tr_b16 v[198:199], v59 offset:512
    ds_read_b64_tr_b16 v[200:201], v58 offset:2048
    ds_read_b64_tr_b16 v[202:203], v58 offset:2560
    ds_read_b64_tr_b16 v[204:205], v59 offset:2048
    ds_read_b64_tr_b16 v[206:207], v59 offset:2560
    ds_read_b64_tr_b16 v[208:209], v58 offset:4096
    ds_read_b64_tr_b16 v[210:211], v58 offset:4608
    ds_read_b64_tr_b16 v[212:213], v59 offset:4096
    ds_read_b64_tr_b16 v[214:215], v59 offset:4608
    s_waitcnt vmcnt(31) lgkmcnt(8)
    v_mfma_f32_32x32x16_bf16 v[0:15], v[192:195], v[64:67], 0
    v_mfma_f32_32x32x16_bf16 v[16:31], v[196:199], v[64:67], 0
    ds_read_b64_tr_b16 v[192:193], v58 offset:6144
    ds_read_b64_tr_b16 v[194:195], v58 offset:6656
    ds_read_b64_tr_b16 v[196:197], v59 offset:6144
    ds_read_b64_tr_b16 v[198:199], v59 offset:6656
    s_waitcnt vmcnt(30) lgkmcnt(8)
    v_mfma_f32_32x32x16_bf16 v[0:15], v[200:203], v[68:71], v[0:15]
    v_mfma_f32_32x32x16_bf16 v[16:31], v[204:207], v[68:71], v[16:31]
    ds_read_b64_tr_b16 v[200:201], v58 offset:8192
    ds_read_b64_tr_b16 v[202:203], v58 offset:8704
    ds_read_b64_tr_b16 v[204:205], v59 offset:8192
    ds_read_b64_tr_b16 v[206:207], v59 offset:8704
    s_waitcnt vmcnt(29) lgkmcnt(8)
    v_mfma_f32_32x32x16_bf16 v[0:15], v[208:211], v[72:75], v[0:15]
    v_mfma_f32_32x32x16_bf16 v[16:31], v[212:215], v[72:75], v[16:31]
    ds_read_b64_tr_b16 v[208:209], v58 offset:10240
    ds_read_b64_tr_b16 v[210:211], v58 offset:10752
    ds_read_b64_tr_b16 v[212:213], v59 offset:10240
    ds_read_b64_tr_b16 v[214:215], v59 offset:10752
    s_waitcnt vmcnt(28) lgkmcnt(8)
    v_mfma_f32_32x32x16_bf16 v[0:15], v[192:195], v[76:79], v[0:15]
    v_mfma_f32_32x32x16_bf16 v[16:31], v[196:199], v[76:79], v[16:31]
    ds_read_b64_tr_b16 v[192:193], v58 offset:12288
    ds_read_b64_tr_b16 v[194:195], v58 offset:12800
    ds_read_b64_tr_b16 v[196:197], v59 offset:12288
    ds_read_b64_tr_b16 v[198:199], v59 offset:12800
    s_waitcnt vmcnt(27) lgkmcnt(8)
    v_mfma_f32_32x32x16_bf16 v[0:15], v[200:203], v[80:83], v[0:15]
    v_mfma_f32_32x32x16_bf16 v[16:31], v[204:207], v[80:83], v[16:31]
    ds_read_b64_tr_b16 v[200:201], v58 offset:14336
    ds_read_b64_tr_b16 v[202:203], v58 offset:14848
    ds_read_b64_tr_b16 v[204:205], v59 offset:14336
    ds_read_b64_tr_b16 v[206:207], v59 offset:14848
    s_waitcnt vmcnt(26) lgkmcnt(8)
    v_mfma_f32_32x32x16_bf16 v[0:15], v[208:211], v[84:87], v[0:15]
    v_mfma_f32_32x32x16_bf16 v[16:31], v[212:215], v[84:87], v[16:31]
    ds_read_b64_tr_b16 v[208:209], v58 offset:16384
    ds_read_b64_tr_b16 v[210:211], v58 offset:16896
    ds_read_b64_tr_b16 v[212:213], v59 offset:16384
    ds_read_b64_tr_b16 v[214:215], v59 offset:16896
    s_waitcnt vmcnt(25) lgkmcnt(8)
    v_mfma_f32_32x32x16_bf16 v[0:15], v[192:195], v[88:91], v[0:15]
    v_mfma_f32_32x32x16_bf16 v[16:31], v[196:199], v[88:91], v[16:31]
    ds_read_b64_tr_b16 v[192:193], v58 offset:18432
    ds_read_b64_tr_b16 v[194:195], v58 offset:18944
    ds_read_b64_tr_b16 v[196:197], v59 offset:18432
    ds_read_b64_tr_b16 v[198:199], v59 offset:18944
    s_waitcnt vmcnt(24) lgkmcnt(8)
    v_mfma_f32_32x32x16_bf16 v[0:15], v[200:203], v[92:95], v[0:15]
    v_mfma_f32_32x32x16_bf16 v[16:31], v[204:207], v[92:95], v[16:31]
    ds_read_b64_tr_b16 v[200:201], v58 offset:20480
    ds_read_b64_tr_b16 v[202:203], v58 offset:20992
    ds_read_b64_tr_b16 v[204:205], v59 offset:20480
    ds_read_b64_tr_b16 v[206:207], v59 offset:20992
    s_waitcnt vmcnt(23) lgkmcnt(8)
    v_mfma_f32_32x32x16_bf16 v[0:15], v[208:211], v[96:99], v[0:15]
    v_mfma_f32_32x32x16_bf16 v[16:31], v[212:215], v[96:99], v[16:31]
    ds_read_b64_tr_b16 v[208:209], v58 offset:22528
    ds_read_b64_tr_b16 v[210:211], v58 offset:23040
    ds_read_b64_tr_b16 v[212:213], v59 offset:22528
    ds_read_b64_tr_b16 v[214:215], v59 offset:23040
    s_waitcnt vmcnt(22) lgkmcnt(8)
    v_mfma_f32_32x32x16_bf16 v[0:15], v[192:195], v[100:103], v[0:15]
    v_mfma_f32_32x32x16_bf16 v[16:31], v[196:199], v[100:103], v[16:31]
    ds_read_b64_tr_b16 v[192:193], v58 offset:24576
    ds_read_b64_tr_b16 v[194:195], v58 offset:25088
    ds_read_b64_tr_b16 v[196:197], v59 offset:24576
    ds_read_b64_tr_b16 v[198:199], v59 offset:25088
    s_waitcnt vmcnt(21) lgkmcnt(8)
    v_mfma_f32_32x32x16_bf16 v[0:15], v[200:203], v[104:107], v[0:15]
    v_mfma_f32_32x32x16_bf16 v[16:31], v[204:207], v[104:107], v[16:31]
    ds_read_b64_tr_b16 v[200:201], v58 offset:26624
    ds_read_b64_tr_b16 v[202:203], v58 offset:27136
    ds_read_b64_tr_b16 v[204:205], v59 offset:26624
    ds_read_b64_tr_b16 v[206:207], v59 offset:27136
    s_waitcnt vmcnt(20) lgkmcnt(8)
    v_mfma_f32_32x32x16_bf16 v[0:15], v[208:211], v[108:111], v[0:15]
    v_mfma_f32_32x32x16_bf16 v[16:31], v[212:215], v[108:111], v[16:31]
    ds_read_b64_tr_b16 v[208:209], v58 offset:28672
    ds_read_b64_tr_b16 v[210:211], v58 offset:29184
    ds_read_b64_tr_b16 v[212:213], v59 offset:28672
    ds_read_b64_tr_b16 v[214:215], v59 offset:29184
    s_waitcnt vmcnt(19) lgkmcnt(8)
    v_mfma_f32_32x32x16_bf16 v[0:15], v[192:195], v[112:115], v[0:15]
    v_mfma_f32_32x32x16_bf16 v[16:31], v[196:199], v[112:115], v[16:31]
    ds_read_b64_tr_b16 v[192:193], v58 offset:30720
    ds_read_b64_tr_b16 v[194:195], v58 offset:31232
    ds_read_b64_tr_b16 v[196:197], v59 offset:30720
    ds_read_b64_tr_b16 v[198:199], v59 offset:31232
    s_waitcnt vmcnt(18) lgkmcnt(8)
    v_mfma_f32_32x32x16_bf16 v[0:15], v[200:203], v[116:119], v[0:15]
    v_mfma_f32_32x32x16_bf16 v[16:31], v[204:207], v[116:119], v[16:31]
    ds_read_b64_tr_b16 v[200:201], v58 offset:32768
    ds_read_b64_tr_b16 v[202:203], v58 offset:33280
    ds_read_b64_tr_b16 v[204:205], v59 offset:32768
    ds_read_b64_tr_b16 v[206:207], v59 offset:33280
    s_waitcnt vmcnt(17) lgkmcnt(8)
    v_mfma_f32_32x32x16_bf16 v[0:15], v[208:211], v[120:123], v[0:15]
    v_mfma_f32_32x32x16_bf16 v[16:31], v[212:215], v[120:123], v[16:31]
    ds_read_b64_tr_b16 v[208:209], v58 offset:34816
    ds_read_b64_tr_b16 v[210:211], v58 offset:35328
    ds_read_b64_tr_b16 v[212:213], v59 offset:34816
    ds_read_b64_tr_b16 v[214:215], v59 offset:35328
    s_waitcnt vmcnt(16) lgkmcnt(8)
    v_mfma_f32_32x32x16_bf16 v[0:15], v[192:195], v[124:127], v[0:15]
    v_mfma_f32_32x32x16_bf16 v[16:31], v[196:199], v[124:127], v[16:31]
    ds_read_b64_tr_b16 v[192:193], v58 offset:36864
    ds_read_b64_tr_b16 v[194:195], v58 offset:37376
    ds_read_b64_tr_b16 v[196:197], v59 offset:36864
    ds_read_b64_tr_b16 v[198:199], v59 offset:37376
    s_waitcnt vmcnt(15) lgkmcnt(8)
    v_mfma_f32_32x32x16_bf16 v[0:15], v[200:203], v[128:131], v[0:15]
    v_mfma_f32_32x32x16_bf16 v[16:31], v[204:207], v[128:131], v[16:31]
    ds_read_b64_tr_b16 v[200:201], v58 offset:38912
    ds_read_b64_tr_b16 v[202:203], v58 offset:39424
    ds_read_b64_tr_b16 v[204:205], v59 offset:38912
    ds_read_b64_tr_b16 v[206:207], v59 offset:39424
    s_waitcnt vmcnt(14) lgkmcnt(8)
    v_mfma_f32_32x32x16_bf16 v[0:15], v[208:211], v[132:135], v[0:15]
    v_mfma_f32_32x32x16_bf16 v[16:31], v[212:215], v[132:135], v[16:31]
    ds_read_b64_tr_b16 v[208:209], v58 offset:40960
    ds_read_b64_tr_b16 v[210:211], v58 offset:41472
    ds_read_b64_tr_b16 v[212:213], v59 offset:40960
    ds_read_b64_tr_b16 v[214:215], v59 offset:41472
    s_waitcnt vmcnt(13) lgkmcnt(8)
    v_mfma_f32_32x32x16_bf16 v[0:15], v[192:195], v[136:139], v[0:15]
    v_mfma_f32_32x32x16_bf16 v[16:31], v[196:199], v[136:139], v[16:31]
    ds_read_b64_tr_b16 v[192:193], v58 offset:43008
    ds_read_b64_tr_b16 v[194:195], v58 offset:43520
    ds_read_b64_tr_b16 v[196:197], v59 offset:43008
    ds_read_b64_tr_b16 v[198:199], v59 offset:43520
    s_waitcnt vmcnt(12) lgkmcnt(8)
    v_mfma_f32_32x32x16_bf16 v[0:15], v[200:203], v[140:143], v[0:15]
    v_mfma_f32_32x32x16_bf16 v[16:31], v[204:207], v[140:143], v[16:31]
    ds_read_b64_tr_b16 v[200:201], v58 offset:45056
    ds_read_b64_tr_b16 v[202:203], v58 offset:45568
    ds_read_b64_tr_b16 v[204:205], v59 offset:45056
    ds_read_b64_tr_b16 v[206:207], v59 offset:45568
    s_waitcnt vmcnt(11) lgkmcnt(8)
    v_mfma_f32_32x32x16_bf16 v[0:15], v[208:211], v[144:147], v[0:15]
    v_mfma_f32_32x32x16_bf16 v[16:31], v[212:215], v[144:147], v[16:31]
    ds_read_b64_tr_b16 v[208:209], v58 offset:47104
    ds_read_b64_tr_b16 v[210:211], v58 offset:47616
    ds_read_b64_tr_b16 v[212:213], v59 offset:47104
    ds_read_b64_tr_b16 v[214:215], v59 offset:47616
    s_waitcnt vmcnt(10) lgkmcnt(8)
    v_mfma_f32_32x32x16_bf16 v[0:15], v[192:195], v[148:151], v[0:15]
    v_mfma_f32_32x32x16_bf16 v[16:31], v[196:199], v[148:151], v[16:31]
    ds_read_b64_tr_b16 v[192:193], v58 offset:49152
    ds_read_b64_tr_b16 v[194:195], v58 offset:49664
    ds_read_b64_tr_b16 v[196:197], v59 offset:49152
    ds_read_b64_tr_b16 v[198:199], v59 offset:49664
    s_waitcnt vmcnt(9) lgkmcnt(8)
    v_mfma_f32_32x32x16_bf16 v[0:15], v[200:203], v[152:155], v[0:15]
    v_mfma_f32_32x32x16_bf16 v[16:31], v[204:207], v[152:155], v[16:31]
    ds_read_b64_tr_b16 v[200:201], v58 offset:51200
    ds_read_b64_tr_b16 v[202:203], v58 offset:51712
    ds_read_b64_tr_b16 v[204:205], v59 offset:51200
    ds_read_b64_tr_b16 v[206:207], v59 offset:51712
    s_waitcnt vmcnt(8) lgkmcnt(8)
    v_mfma_f32_32x32x16_bf16 v[0:15], v[208:211], v[156:159], v[0:15]
    v_mfma_f32_32x32x16_bf16 v[16:31], v[212:215], v[156:159], v[16:31]
    ds_read_b64_tr_b16 v[208:209], v58 offset:53248
    ds_read_b64_tr_b16 v[210:211], v58 offset:53760
    ds_read_b64_tr_b16 v[212:213], v59 offset:53248
    ds_read_b64_tr_b16 v[214:215], v59 offset:53760
    s_waitcnt vmcnt(7) lgkmcnt(8)
    v_mfma_f32_32x32x16_bf16 v[0:15], v[192:195], v[160:163], v[0:15]
    v_mfma_f32_32x32x16_bf16 v[16:31], v[196:199], v[160:163], v[16:31]
    ds_read_b64_tr_b16 v[192:193], v58 offset:55296
    ds_read_b64_tr_b16 v[194:195], v58 offset:55808
    ds_read_b64_tr_b16 v[196:197], v59 offset:55296
    ds_read_b64_tr_b16 v[198:199], v59 offset:55808
    s_waitcnt vmcnt(6) lgkmcnt(8)
    v_mfma_f32_32x32x16_bf16 v[0:15], v[200:203], v[164:167], v[0:15]
    v_mfma_f32_32x32x16_bf16 v[16:31], v[204:207], v[164:167], v[16:31]
    ds_read_b64_tr_b16 v[200:201], v58 offset:57344
    ds_read_b64_tr_b16 v[202:203], v58 offset:57856
    ds_read_b64_tr_b16 v[204:205], v59 offset:57344
    ds_read_b64_tr_b16 v[206:207], v59 offset:57856
    s_waitcnt vmcnt(5) lgkmcnt(8)
    v_mfma_f32_32x32x16_bf16 v[0:15], v[208:211], v[168:171], v[0:15]
    v_mfma_f32_32x32x16_bf16 v[16:31], v[212:215], v[168:171], v[16:31]
    ds_read_b64_tr_b16 v[208:209], v58 offset:59392
    ds_read_b64_tr_b16 v[210:211], v58 offset:59904
    ds_read_b64_tr_b16 v[212:213], v59 offset:59392
    ds_read_b64_tr_b16 v[214:215], v59 offset:59904
    s_waitcnt vmcnt(4) lgkmcnt(8)
    v_mfma_f32_32x32x16_bf16 v[0:15], v[192:195], v[172:175], v[0:15]
    v_mfma_f32_32x32x16_bf16 v[16:31], v[196:199], v[172:175], v[16:31]
    ds_read_b64_tr_b16 v[192:193], v58 offset:61440
    ds_read_b64_tr_b16 v[194:195], v58 offset:61952
    ds_read_b64_tr_b16 v[196:197], v59 offset:61440
    ds_read_b64_tr_b16 v[198:199], v59 offset:61952
    s_waitcnt vmcnt(3) lgkmcnt(8)
    v_mfma_f32_32x32x16_bf16 v[0:15], v[200:203], v[176:179], v[0:15]
    v_mfma_f32_32x32x16_bf16 v[16:31], v[204:207], v[176:179], v[16:31]
    ds_read_b64_tr_b16 v[200:201], v58 offset:63488
    ds_read_b64_tr_b16 v[202:203], v58 offset:64000
    ds_read_b64_tr_b16 v[204:205], v59 offset:63488
    ds_read_b64_tr_b16 v[206:207], v59 offset:64000
    s_waitcnt vmcnt(2) lgkmcnt(8)
    v_mfma_f32_32x32x16_bf16 v[0:15], v[208:211], v[180:183], v[0:15]
    v_mfma_f32_32x32x16_bf16 v[16:31], v[212:215], v[180:183], v[16:31]
    s_waitcnt vmcnt(1) lgkmcnt(4)
    v_mfma_f32_32x32x16_bf16 v[0:15], v[192:195], v[184:187], v[0:15]
    v_mfma_f32_32x32x16_bf16 v[16:31], v[196:199], v[184:187], v[16:31]
    s_waitcnt vmcnt(0) lgkmcnt(0)
    v_mfma_f32_32x32x16_bf16 v[0:15], v[200:203], v[188:191], v[0:15]
    v_mfma_f32_32x32x16_bf16 v[16:31], v[204:207], v[188:191], v[16:31]
    s_lshl_b32 s34, s3, 12
    s_add_u32 s34, s34, 131072
    v_add_u32 v63, s34, v62
    s_nop 8
    ds_write_b128 v63, v[16:19] offset:0
    ds_write_b128 v63, v[20:23] offset:1024
    ds_write_b128 v63, v[24:27] offset:2048
    ds_write_b128 v63, v[28:31] offset:3072
    v_xor_b32 v63, 16384, v63
    v_lshlrev_b32 v64, 16, v40
    v_and_b32 v65, 0xffff0000, v40
    v_lshlrev_b32 v80, 16, v48
    v_and_b32 v81, 0xffff0000, v48
    v_lshlrev_b32 v66, 16, v41
    v_and_b32 v67, 0xffff0000, v41
    v_lshlrev_b32 v82, 16, v49
    v_and_b32 v83, 0xffff0000, v49
    v_lshlrev_b32 v68, 16, v42
    v_and_b32 v69, 0xffff0000, v42
    v_lshlrev_b32 v84, 16, v50
    v_and_b32 v85, 0xffff0000, v50
    v_lshlrev_b32 v70, 16, v43
    v_and_b32 v71, 0xffff0000, v43
    v_lshlrev_b32 v86, 16, v51
    v_and_b32 v87, 0xffff0000, v51
    v_lshlrev_b32 v72, 16, v44
    v_and_b32 v73, 0xffff0000, v44
    v_lshlrev_b32 v88, 16, v52
    v_and_b32 v89, 0xffff0000, v52
    v_lshlrev_b32 v74, 16, v45
    v_and_b32 v75, 0xffff0000, v45
    v_lshlrev_b32 v90, 16, v53
    v_and_b32 v91, 0xffff0000, v53
    v_lshlrev_b32 v76, 16, v46
    v_and_b32 v77, 0xffff0000, v46
    v_lshlrev_b32 v92, 16, v54
    v_and_b32 v93, 0xffff0000, v54
    v_lshlrev_b32 v78, 16, v47
    v_and_b32 v79, 0xffff0000, v47
    v_lshlrev_b32 v94, 16, v55
    v_and_b32 v95, 0xffff0000, v55
    v_add_f32 v0, v0, v64
    v_add_f32 v1, v1, v65
    v_add_f32 v2, v2, v66
    v_add_f32 v3, v3, v67
    v_add_f32 v4, v4, v68
    v_add_f32 v5, v5, v69
    v_add_f32 v6, v6, v70
    v_add_f32 v7, v7, v71
    v_add_f32 v8, v8, v72
    v_add_f32 v9, v9, v73
    v_add_f32 v10, v10, v74
    v_add_f32 v11, v11, v75
    v_add_f32 v12, v12, v76
    v_add_f32 v13, v13, v77
    v_add_f32 v14, v14, v78
    v_add_f32 v15, v15, v79
    s_waitcnt lgkmcnt(0)
    s_barrier
    ds_read_b128 v[16:19], v63 offset:0
    ds_read_b128 v[20:23], v63 offset:1024
    ds_read_b128 v[24:27], v63 offset:2048
    ds_read_b128 v[28:31], v63 offset:3072
    s_waitcnt lgkmcnt(0)
    v_add_f32 v0, v0, v16
    v_add_f32 v1, v1, v17
    v_add_f32 v2, v2, v18
    v_add_f32 v3, v3, v19
    v_add_f32 v4, v4, v20
    v_add_f32 v5, v5, v21
    v_add_f32 v6, v6, v22
    v_add_f32 v7, v7, v23
    v_add_f32 v8, v8, v24
    v_add_f32 v9, v9, v25
    v_add_f32 v10, v10, v26
    v_add_f32 v11, v11, v27
    v_add_f32 v12, v12, v28
    v_add_f32 v13, v13, v29
    v_add_f32 v14, v14, v30
    v_add_f32 v15, v15, v31
    v_cvt_pk_bf16_f32 v32, v0, v1
    v_cvt_pk_bf16_f32 v33, v2, v3
    v_cvt_pk_bf16_f32 v34, v4, v5
    v_cvt_pk_bf16_f32 v35, v6, v7
    v_cvt_pk_bf16_f32 v36, v8, v9
    v_cvt_pk_bf16_f32 v37, v10, v11
    v_cvt_pk_bf16_f32 v38, v12, v13
    v_cvt_pk_bf16_f32 v39, v14, v15
    s_add_u32 s34, s35, 0x1000000
    buffer_store_dwordx4 v[32:35], v62, s[20:23], s34 offen
    buffer_store_dwordx4 v[36:39], v62, s[20:23], s34 offen offset:1024
    v_add_f32 v40, v0, v1
    v_mul_f32 v41, v0, v0
    v_mul_f32 v42, v0, v80
    v_fmac_f32 v41, v1, v1
    v_fmac_f32 v42, v1, v81
    v_add_f32 v40, v40, v2
    v_fmac_f32 v41, v2, v2
    v_fmac_f32 v42, v2, v82
    v_add_f32 v40, v40, v3
    v_fmac_f32 v41, v3, v3
    v_fmac_f32 v42, v3, v83
    v_add_f32 v40, v40, v4
    v_fmac_f32 v41, v4, v4
    v_fmac_f32 v42, v4, v84
    v_add_f32 v40, v40, v5
    v_fmac_f32 v41, v5, v5
    v_fmac_f32 v42, v5, v85
    v_add_f32 v40, v40, v6
    v_fmac_f32 v41, v6, v6
    v_fmac_f32 v42, v6, v86
    v_add_f32 v40, v40, v7
    v_fmac_f32 v41, v7, v7
    v_fmac_f32 v42, v7, v87
    v_add_f32 v40, v40, v8
    v_fmac_f32 v41, v8, v8
    v_fmac_f32 v42, v8, v88
    v_add_f32 v40, v40, v9
    v_fmac_f32 v41, v9, v9
    v_fmac_f32 v42, v9, v89
    v_add_f32 v40, v40, v10
    v_fmac_f32 v41, v10, v10
    v_fmac_f32 v42, v10, v90
    v_add_f32 v40, v40, v11
    v_fmac_f32 v41, v11, v11
    v_fmac_f32 v42, v11, v91
    v_add_f32 v40, v40, v12
    v_fmac_f32 v41, v12, v12
    v_fmac_f32 v42, v12, v92
    v_add_f32 v40, v40, v13
    v_fmac_f32 v41, v13, v13
    v_fmac_f32 v42, v13, v93
    v_add_f32 v40, v40, v14
    v_fmac_f32 v41, v14, v14
    v_fmac_f32 v42, v14, v94
    v_add_f32 v40, v40, v15
    v_fmac_f32 v41, v15, v15
    v_fmac_f32 v42, v15, v95
    v_mov_b32 v43, v42
    v_permlane32_swap_b32 v40, v41
    s_nop 0
    v_permlane32_swap_b32 v42, v43
    v_add_f32 v40, v40, v41
    v_add_f32 v42, v42, v43
    v_lshlrev_b32 v44, 2, v60
    v_lshl_add_u32 v45, v61, 13, v44
    s_lshl_b32 s34, s32, 7
    s_add_u32 s34, s34, 0x1400000
    buffer_atomic_add_f32 v40, v45, s[20:23], s34 offen sc1
    s_add_u32 s34, s34, 16384
    s_mov_b64 exec, 0xffffffff
    buffer_atomic_add_f32 v42, v44, s[20:23], s34 offen sc1
wo0_kernel_end:
wo0_kernel_exit:
    s_endpgm
.globl ffn0_kernel
.p2align 8
.type ffn0_kernel,@function
ffn0_kernel:
    s_cmp_ge_u32 s2, 256
    s_cbranch_scc1 ffn0_kernel_exit
    s_load_dwordx4 s[4:7], s[0:1], 32
    s_load_dwordx4 s[8:11], s[0:1], 48
    s_load_dwordx2 s[44:45], s[0:1], 64
    s_load_dwordx2 s[46:47], s[0:1], 80
    v_lshrrev_b32 v1, 6, v0
    v_and_b32 v2, 63, v0
    v_readfirstlane_b32 s3, v1
    s_and_b32 s24, s2, 7
    s_lshr_b32 s25, s2, 3
    s_mul_i32 s26, s24, 28
    s_add_u32 s26, s26, s25
    s_waitcnt lgkmcnt(0)
    s_mov_b32 s12, s4
    s_mov_b32 s13, s5
    s_mov_b32 s14, 0x800
    s_mov_b32 s15, 0x20000
    s_mov_b32 s20, s46
    s_mov_b32 s21, s47
    s_mov_b32 s22, 0x8000000
    s_mov_b32 s23, 0x20000
    s_mov_b32 s28, s10
    s_mov_b32 s29, s11
    s_mov_b32 s30, 0x700000
    s_mov_b32 s31, 0x20000
    s_cmp_lt_u32 s3, 4
    s_cselect_b32 s16, s6, s8
    s_cselect_b32 s17, s7, s9
    s_mov_b32 s18, 7340032
    s_mov_b32 s19, 0x20000
    v_lshlrev_b32 v3, 4, v0
    s_mov_b32 s27, 0x1400000
    buffer_load_dwordx4 v[8:11], v3, s[20:23], s27 offen
    s_add_u32 s27, s27, 8192
    buffer_load_dwordx4 v[12:15], v3, s[20:23], s27 offen
    s_add_u32 s27, s27, 8192
    buffer_load_dwordx4 v[16:19], v3, s[20:23], s27 offen
    v_lshlrev_b32 v4, 5, v2
    buffer_load_dwordx4 v[20:23], v4, s[12:15], 0 offen
    buffer_load_dwordx4 v[24:27], v4, s[12:15], 0 offen offset:16
    s_cmp_lt_u32 s25, 28
    s_cselect_b32 s33, 0, 0x10000000
    v_lshrrev_b32 v5, 1, v2
    v_mul_u32_u24 v5, 7168, v5
    v_and_b32 v6, 1, v2
    v_lshl_add_u32 v5, v6, 4, v5
    v_add_u32 v5, s33, v5
    s_and_b32 s34, s3, 3
    s_mul_i32 s34, s34, 1835008
    s_lshl_b32 s35, s26, 5
    s_add_u32 s34, s34, s35
    buffer_load_dwordx4 v[32:35], v5, s[16:19], s34 offen
    s_add_u32 s34, s34, 229376
    buffer_load_dwordx4 v[36:39], v5, s[16:19], s34 offen
    s_add_u32 s34, s34, 229376
    buffer_load_dwordx4 v[40:43], v5, s[16:19], s34 offen
    s_add_u32 s34, s34, 229376
    buffer_load_dwordx4 v[44:47], v5, s[16:19], s34 offen
    s_add_u32 s34, s34, 229376
    buffer_load_dwordx4 v[48:51], v5, s[16:19], s34 offen
    s_add_u32 s34, s34, 229376
    buffer_load_dwordx4 v[52:55], v5, s[16:19], s34 offen
    s_add_u32 s34, s34, 229376
    buffer_load_dwordx4 v[56:59], v5, s[16:19], s34 offen
    s_add_u32 s34, s34, 229376
    buffer_load_dwordx4 v[60:63], v5, s[16:19], s34 offen
    v_lshrrev_b32 v6, 4, v2
    v_lshlrev_b32 v6, 11, v6
    v_and_b32 v7, 15, v2
    v_lshl_add_u32 v6, v7, 4, v6
    v_add_u32 v6, s33, v6
    s_lshl_b32 s34, s26, 15
    s_lshl_b32 s35, s3, 8
    s_add_u32 s34, s34, s35
    buffer_load_dwordx4 v[64:67], v6, s[28:31], s34 offen
    s_add_u32 s34, s34, 8192
    buffer_load_dwordx4 v[68:71], v6, s[28:31], s34 offen
    s_add_u32 s34, s34, 8192
    buffer_load_dwordx4 v[72:75], v6, s[28:31], s34 offen
    s_add_u32 s34, s34, 8192
    buffer_load_dwordx4 v[76:79], v6, s[28:31], s34 offen
    s_waitcnt vmcnt(12)
    v_mov_b32 v28, 0
    v_lshlrev_b32 v29, 16, v20
    v_and_b32 v30, 0xffff0000, v20
    v_add_f32 v28, v28, v29
    v_add_f32 v28, v28, v30
    v_lshlrev_b32 v29, 16, v21
    v_and_b32 v30, 0xffff0000, v21
    v_add_f32 v28, v28, v29
    v_add_f32 v28, v28, v30
    v_lshlrev_b32 v29, 16, v22
    v_and_b32 v30, 0xffff0000, v22
    v_add_f32 v28, v28, v29
    v_add_f32 v28, v28, v30
    v_lshlrev_b32 v29, 16, v23
    v_and_b32 v30, 0xffff0000, v23
    v_add_f32 v28, v28, v29
    v_add_f32 v28, v28, v30
    v_lshlrev_b32 v29, 16, v24
    v_and_b32 v30, 0xffff0000, v24
    v_add_f32 v28, v28, v29
    v_add_f32 v28, v28, v30
    v_lshlrev_b32 v29, 16, v25
    v_and_b32 v30, 0xffff0000, v25
    v_add_f32 v28, v28, v29
    v_add_f32 v28, v28, v30
    v_lshlrev_b32 v29, 16, v26
    v_and_b32 v30, 0xffff0000, v26
    v_add_f32 v28, v28, v29
    v_add_f32 v28, v28, v30
    v_lshlrev_b32 v29, 16, v27
    v_and_b32 v30, 0xffff0000, v27
    v_add_f32 v28, v28, v29
    v_add_f32 v28, v28, v30
    s_nop 1
    v_add_f32_dpp v28, v28, v28 quad_perm:[1,0,3,2] row_mask:0xf bank_mask:0xf
    s_nop 1
    v_add_f32_dpp v28, v28, v28 quad_perm:[2,3,0,1] row_mask:0xf bank_mask:0xf
    s_nop 1
    v_add_f32_dpp v28, v28, v28 row_half_mirror row_mask:0xf bank_mask:0xf
    s_nop 1
    v_add_f32_dpp v28, v28, v28 row_mirror row_mask:0xf bank_mask:0xf
    v_mov_b32 v29, v28
    s_nop 1
    v_permlane16_swap_b32 v28, v29
    v_add_f32 v28, v28, v29
    v_mov_b32 v29, v28
    s_nop 1
    v_permlane32_swap_b32 v28, v29
    v_add_f32 v28, v28, v29
    v_mul_f32 v8, 0x3a800000, v8
    v_mul_f32 v20, 0x3a800000, v12
    v_fma_f32 v20, -v8, v8, v20
    v_max_f32 v20, 0, v20
    v_add_f32 v12, 0x3727c5ac, v20
    v_rsq_f32 v12, v12
    v_fma_f32 v16, -v8, v28, v16
    v_mul_f32 v16, v16, v12
    v_mul_f32 v9, 0x3a800000, v9
    v_mul_f32 v21, 0x3a800000, v13
    v_fma_f32 v21, -v9, v9, v21
    v_max_f32 v21, 0, v21
    v_add_f32 v13, 0x3727c5ac, v21
    v_rsq_f32 v13, v13
    v_fma_f32 v17, -v9, v28, v17
    v_mul_f32 v17, v17, v13
    v_mul_f32 v10, 0x3a800000, v10
    v_mul_f32 v22, 0x3a800000, v14
    v_fma_f32 v22, -v10, v10, v22
    v_max_f32 v22, 0, v22
    v_add_f32 v14, 0x3727c5ac, v22
    v_rsq_f32 v14, v14
    v_fma_f32 v18, -v10, v28, v18
    v_mul_f32 v18, v18, v14
    v_mul_f32 v11, 0x3a800000, v11
    v_mul_f32 v23, 0x3a800000, v15
    v_fma_f32 v23, -v11, v11, v23
    v_max_f32 v23, 0, v23
    v_add_f32 v15, 0x3727c5ac, v23
    v_rsq_f32 v15, v15
    v_fma_f32 v19, -v11, v28, v19
    v_mul_f32 v19, v19, v15
    ds_write_b128 v3, v[8:11]
    ds_write_b128 v3, v[12:15] offset:8192
    ds_write_b128 v3, v[16:19] offset:16384
    v_add_f32 v84, 1.0, v12
    v_mul_f32 v88, v8, v12
    v_sub_f32 v88, 0, v88
    v_mul_f32 v80, v84, v84
    v_mul_f32 v80, v80, v20
    v_add_f32 v80, 0x3727c5ac, v80
    v_rsq_f32 v80, v80
    s_nop 0
    v_mul_f32 v80, v80, v84
    v_add_f32 v85, 1.0, v13
    v_mul_f32 v89, v9, v13
    v_sub_f32 v89, 0, v89
    v_mul_f32 v81, v85, v85
    v_mul_f32 v81, v81, v21
    v_add_f32 v81, 0x3727c5ac, v81
    v_rsq_f32 v81, v81
    s_nop 0
    v_mul_f32 v81, v81, v85
    v_add_f32 v86, 1.0, v14
    v_mul_f32 v90, v10, v14
    v_sub_f32 v90, 0, v90
    v_mul_f32 v82, v86, v86
    v_mul_f32 v82, v82, v22
    v_add_f32 v82, 0x3727c5ac, v82
    v_rsq_f32 v82, v82
    s_nop 0
    v_mul_f32 v82, v82, v86
    v_add_f32 v87, 1.0, v15
    v_mul_f32 v91, v11, v15
    v_sub_f32 v91, 0, v91
    v_mul_f32 v83, v87, v87
    v_mul_f32 v83, v83, v23
    v_add_f32 v83, 0x3727c5ac, v83
    v_rsq_f32 v83, v83
    s_nop 0
    v_mul_f32 v83, v83, v87
    v_lshrrev_b32 v29, 1, v0
    v_cmp_eq_u32 vcc, s2, v29
    s_and_saveexec_b64 s[36:37], vcc
    s_mov_b32 s27, 0x3440000
    buffer_store_dwordx4 v[80:83], v3, s[20:23], s27 offen
    s_add_u32 s27, s27, 8192
    buffer_store_dwordx4 v[8:11], v3, s[20:23], s27 offen
    s_add_u32 s27, s27, 8192
    buffer_store_dwordx4 v[84:87], v3, s[20:23], s27 offen
    s_add_u32 s27, s27, 8192
    buffer_store_dwordx4 v[88:91], v3, s[20:23], s27 offen
    s_mov_b64 exec, s[36:37]
    v_max3_f32 v29, v16, v17, v18
    v_max_f32 v29, v29, v19
    s_nop 1
    v_max_f32_dpp v29, v29, v29 quad_perm:[1,0,3,2] row_mask:0xf bank_mask:0xf
    s_nop 1
    v_max_f32_dpp v29, v29, v29 quad_perm:[2,3,0,1] row_mask:0xf bank_mask:0xf
    s_nop 1
    v_max_f32_dpp v29, v29, v29 row_half_mirror row_mask:0xf bank_mask:0xf
    s_nop 1
    v_max_f32_dpp v29, v29, v29 row_mirror row_mask:0xf bank_mask:0xf
    v_mov_b32 v30, v29
    s_nop 1
    v_permlane16_swap_b32 v29, v30
    v_max_f32 v29, v29, v30
    v_mov_b32 v30, v29
    s_nop 1
    v_permlane32_swap_b32 v29, v30
    v_max_f32 v29, v29, v30
    v_lshlrev_b32 v30, 2, v1
    ds_write_b32 v30, v29 offset:24576
    v_mov_b32 v31, 0x7fffffff
    v_mov_b32 v30, 0
    ds_write_b32 v30, v31 offset:24640
    s_waitcnt lgkmcnt(0)
    s_barrier
    ds_read_b128 v[92:95], v30 offset:24576
    ds_read_b128 v[96:99], v30 offset:24592
    s_waitcnt lgkmcnt(0)
    v_max3_f32 v29, v92, v93, v94
    v_max3_f32 v29, v29, v95, v96
    v_max3_f32 v29, v29, v97, v98
    v_max_f32 v29, v29, v99
    v_lshlrev_b32 v92, 2, v0
    v_cmp_eq_f32 vcc, v29, v19
    v_add_u32 v93, 3, v92
    s_nop 0
    v_cndmask_b32 v31, v31, v93, vcc
    v_cmp_eq_f32 vcc, v29, v18
    v_add_u32 v93, 2, v92
    s_nop 0
    v_cndmask_b32 v31, v31, v93, vcc
    v_cmp_eq_f32 vcc, v29, v17
    v_add_u32 v93, 1, v92
    s_nop 0
    v_cndmask_b32 v31, v31, v93, vcc
    v_cmp_eq_f32 vcc, v29, v16
    v_add_u32 v93, 0, v92
    s_nop 0
    v_cndmask_b32 v31, v31, v93, vcc
    v_cmp_gt_u32 vcc, 0x7fffffff, v31
    s_and_saveexec_b64 s[36:37], vcc
    ds_min_u32 v30, v31 offset:24640
    s_mov_b64 exec, s[36:37]
    s_waitcnt lgkmcnt(0)
    s_barrier
    ds_read_b32 v31, v30 offset:24640
    s_waitcnt lgkmcnt(0)
    v_and_b32 v31, 2047, v31
    v_lshlrev_b32 v92, 2, v31
    ds_read_b32 v93, v92
    ds_read_b32 v94, v92 offset:8192
    v_lshrrev_b32 v95, 7, v31
    v_lshlrev_b32 v95, 18, v95
    v_bfe_u32 v96, v31, 5, 2
    v_lshl_add_u32 v95, v96, 12, v95
    v_and_b32 v96, 31, v31
    v_lshl_add_u32 v95, v96, 4, v95
    v_bfe_u32 v96, v0, 3, 4
    v_lshl_add_u32 v95, v96, 14, v95
    v_and_b32 v96, 7, v0
    v_lshl_add_u32 v95, v96, 9, v95
    s_mov_b32 s27, 0x1000000
    buffer_load_dwordx4 v[108:111], v95, s[20:23], s27 offen
    s_waitcnt lgkmcnt(0)
    v_mov_b32 v112, v31
    v_mov_b32 v113, v29
    v_mov_b32 v114, v93
    v_mov_b32 v115, v94
    v_or_b32 v96, s2, v0
    v_cmp_eq_u32 vcc, 0, v96
    s_and_saveexec_b64 s[36:37], vcc
    s_mov_b32 s27, 0x1450000
    buffer_store_dwordx4 v[112:115], v30, s[20:23], s27 offen
    s_mov_b64 exec, s[36:37]
    s_waitcnt vmcnt(0)
    v_lshlrev_b32 v120, 16, v108
    v_and_b32 v121, 0xffff0000, v108
    v_lshlrev_b32 v122, 16, v109
    v_and_b32 v123, 0xffff0000, v109
    v_lshlrev_b32 v124, 16, v110
    v_and_b32 v125, 0xffff0000, v110
    v_lshlrev_b32 v126, 16, v111
    v_and_b32 v127, 0xffff0000, v111
    v_sub_f32 v120, v120, v93
    v_mul_f32 v120, v120, v94
    v_sub_f32 v121, v121, v93
    v_mul_f32 v121, v121, v94
    v_sub_f32 v122, v122, v93
    v_mul_f32 v122, v122, v94
    v_sub_f32 v123, v123, v93
    v_mul_f32 v123, v123, v94
    v_sub_f32 v124, v124, v93
    v_mul_f32 v124, v124, v94
    v_sub_f32 v125, v125, v93
    v_mul_f32 v125, v125, v94
    v_sub_f32 v126, v126, v93
    v_mul_f32 v126, v126, v94
    v_sub_f32 v127, v127, v93
    v_mul_f32 v127, v127, v94
    v_lshrrev_b32 v96, 1, v0
    v_lshlrev_b32 v96, 6, v96
    v_and_b32 v97, 1, v0
    v_lshl_add_u32 v96, v97, 4, v96
    v_cmp_gt_u32 vcc, 128, v0
    s_and_saveexec_b64 s[36:37], vcc
    ds_write_b128 v96, v[120:123] offset:32768
    ds_write_b128 v96, v[124:127] offset:32800
    s_mov_b64 exec, s[36:37]
    s_waitcnt lgkmcnt(0)
    s_barrier
    s_and_b32 s34, s3, 3
    s_lshl_b32 s34, s34, 10
    v_lshrrev_b32 v96, 1, v2
    v_lshl_add_u32 v96, v96, 2, s34
    ds_read_b32 v108, v96 offset:32768
    ds_read_b32 v109, v96 offset:32896
    ds_read_b32 v110, v96 offset:33024
    ds_read_b32 v111, v96 offset:33152
    ds_read_b32 v112, v96 offset:33280
    ds_read_b32 v113, v96 offset:33408
    ds_read_b32 v114, v96 offset:33536
    ds_read_b32 v115, v96 offset:33664
    s_waitcnt lgkmcnt(0)
    v_lshlrev_b32 v116, 16, v32
    v_and_b32 v117, 0xffff0000, v32
    v_mul_f32 v120, v116, v108
    v_mul_f32 v121, v117, v108
    v_lshlrev_b32 v116, 16, v33
    v_and_b32 v117, 0xffff0000, v33
    v_mul_f32 v122, v116, v108
    v_mul_f32 v123, v117, v108
    v_lshlrev_b32 v116, 16, v34
    v_and_b32 v117, 0xffff0000, v34
    v_mul_f32 v124, v116, v108
    v_mul_f32 v125, v117, v108
    v_lshlrev_b32 v116, 16, v35
    v_and_b32 v117, 0xffff0000, v35
    v_mul_f32 v126, v116, v108
    v_mul_f32 v127, v117, v108
    v_lshlrev_b32 v116, 16, v36
    v_and_b32 v117, 0xffff0000, v36
    v_fmac_f32 v120, v116, v109
    v_fmac_f32 v121, v117, v109
    v_lshlrev_b32 v116, 16, v37
    v_and_b32 v117, 0xffff0000, v37
    v_fmac_f32 v122, v116, v109
    v_fmac_f32 v123, v117, v109
    v_lshlrev_b32 v116, 16, v38
    v_and_b32 v117, 0xffff0000, v38
    v_fmac_f32 v124, v116, v109
    v_fmac_f32 v125, v117, v109
    v_lshlrev_b32 v116, 16, v39
    v_and_b32 v117, 0xffff0000, v39
    v_fmac_f32 v126, v116, v109
    v_fmac_f32 v127, v117, v109
    v_lshlrev_b32 v116, 16, v40
    v_and_b32 v117, 0xffff0000, v40
    v_fmac_f32 v120, v116, v110
    v_fmac_f32 v121, v117, v110
    v_lshlrev_b32 v116, 16, v41
    v_and_b32 v117, 0xffff0000, v41
    v_fmac_f32 v122, v116, v110
    v_fmac_f32 v123, v117, v110
    v_lshlrev_b32 v116, 16, v42
    v_and_b32 v117, 0xffff0000, v42
    v_fmac_f32 v124, v116, v110
    v_fmac_f32 v125, v117, v110
    v_lshlrev_b32 v116, 16, v43
    v_and_b32 v117, 0xffff0000, v43
    v_fmac_f32 v126, v116, v110
    v_fmac_f32 v127, v117, v110
    v_lshlrev_b32 v116, 16, v44
    v_and_b32 v117, 0xffff0000, v44
    v_fmac_f32 v120, v116, v111
    v_fmac_f32 v121, v117, v111
    v_lshlrev_b32 v116, 16, v45
    v_and_b32 v117, 0xffff0000, v45
    v_fmac_f32 v122, v116, v111
    v_fmac_f32 v123, v117, v111
    v_lshlrev_b32 v116, 16, v46
    v_and_b32 v117, 0xffff0000, v46
    v_fmac_f32 v124, v116, v111
    v_fmac_f32 v125, v117, v111
    v_lshlrev_b32 v116, 16, v47
    v_and_b32 v117, 0xffff0000, v47
    v_fmac_f32 v126, v116, v111
    v_fmac_f32 v127, v117, v111
    v_lshlrev_b32 v116, 16, v48
    v_and_b32 v117, 0xffff0000, v48
    v_fmac_f32 v120, v116, v112
    v_fmac_f32 v121, v117, v112
    v_lshlrev_b32 v116, 16, v49
    v_and_b32 v117, 0xffff0000, v49
    v_fmac_f32 v122, v116, v112
    v_fmac_f32 v123, v117, v112
    v_lshlrev_b32 v116, 16, v50
    v_and_b32 v117, 0xffff0000, v50
    v_fmac_f32 v124, v116, v112
    v_fmac_f32 v125, v117, v112
    v_lshlrev_b32 v116, 16, v51
    v_and_b32 v117, 0xffff0000, v51
    v_fmac_f32 v126, v116, v112
    v_fmac_f32 v127, v117, v112
    v_lshlrev_b32 v116, 16, v52
    v_and_b32 v117, 0xffff0000, v52
    v_fmac_f32 v120, v116, v113
    v_fmac_f32 v121, v117, v113
    v_lshlrev_b32 v116, 16, v53
    v_and_b32 v117, 0xffff0000, v53
    v_fmac_f32 v122, v116, v113
    v_fmac_f32 v123, v117, v113
    v_lshlrev_b32 v116, 16, v54
    v_and_b32 v117, 0xffff0000, v54
    v_fmac_f32 v124, v116, v113
    v_fmac_f32 v125, v117, v113
    v_lshlrev_b32 v116, 16, v55
    v_and_b32 v117, 0xffff0000, v55
    v_fmac_f32 v126, v116, v113
    v_fmac_f32 v127, v117, v113
    v_lshlrev_b32 v116, 16, v56
    v_and_b32 v117, 0xffff0000, v56
    v_fmac_f32 v120, v116, v114
    v_fmac_f32 v121, v117, v114
    v_lshlrev_b32 v116, 16, v57
    v_and_b32 v117, 0xffff0000, v57
    v_fmac_f32 v122, v116, v114
    v_fmac_f32 v123, v117, v114
    v_lshlrev_b32 v116, 16, v58
    v_and_b32 v117, 0xffff0000, v58
    v_fmac_f32 v124, v116, v114
    v_fmac_f32 v125, v117, v114
    v_lshlrev_b32 v116, 16, v59
    v_and_b32 v117, 0xffff0000, v59
    v_fmac_f32 v126, v116, v114
    v_fmac_f32 v127, v117, v114
    v_lshlrev_b32 v116, 16, v60
    v_and_b32 v117, 0xffff0000, v60
    v_fmac_f32 v120, v116, v115
    v_fmac_f32 v121, v117, v115
    v_lshlrev_b32 v116, 16, v61
    v_and_b32 v117, 0xffff0000, v61
    v_fmac_f32 v122, v116, v115
    v_fmac_f32 v123, v117, v115
    v_lshlrev_b32 v116, 16, v62
    v_and_b32 v117, 0xffff0000, v62
    v_fmac_f32 v124, v116, v115
    v_fmac_f32 v125, v117, v115
    v_lshlrev_b32 v116, 16, v63
    v_and_b32 v117, 0xffff0000, v63
    v_fmac_f32 v126, v116, v115
    v_fmac_f32 v127, v117, v115
    v_permlane32_swap_b32 v120, v124
    v_permlane32_swap_b32 v121, v125
    v_permlane32_swap_b32 v122, v126
    v_permlane32_swap_b32 v123, v127
    v_add_f32 v120, v120, v124
    v_add_f32 v121, v121, v125
    v_add_f32 v122, v122, v126
    v_add_f32 v123, v123, v127
    s_nop 0
    v_permlane16_swap_b32 v120, v122
    v_permlane16_swap_b32 v121, v123
    v_add_f32 v120, v120, v122
    v_add_f32 v121, v121, v123
    s_nop 0
    v_add_f32_dpp v120, v120, v120 quad_perm:[2,3,0,1] row_mask:0xf bank_mask:0xf
    v_add_f32_dpp v121, v121, v121 quad_perm:[2,3,0,1] row_mask:0xf bank_mask:0xf
    s_nop 0
    v_add_f32_dpp v120, v120, v120 row_ror:4 row_mask:0xf bank_mask:0xf
    v_add_f32_dpp v121, v121, v121 row_ror:4 row_mask:0xf bank_mask:0xf
    s_nop 0
    v_add_f32_dpp v120, v120, v120 row_ror:8 row_mask:0xf bank_mask:0xf
    v_add_f32_dpp v121, v121, v121 row_ror:8 row_mask:0xf bank_mask:0xf
    v_and_b32 v96, 1, v2
    v_lshrrev_b32 v97, 4, v2
    v_lshlrev_b32 v97, 3, v97
    v_lshl_add_u32 v96, v96, 5, v97
    s_lshl_b32 s34, s3, 6
    v_add_u32 v96, s34, v96
    ds_write_b64 v96, v[120:121] offset:40960
    s_waitcnt lgkmcnt(0)
    s_barrier
    v_and_b32 v96, 15, v2
    v_lshlrev_b32 v96, 2, v96
    ds_read_b32 v108, v96 offset:40960
    ds_read_b32 v109, v96 offset:41024
    ds_read_b32 v110, v96 offset:41088
    ds_read_b32 v111, v96 offset:41152
    ds_read_b32 v112, v96 offset:41216
    ds_read_b32 v113, v96 offset:41280
    ds_read_b32 v114, v96 offset:41344
    ds_read_b32 v115, v96 offset:41408
    s_waitcnt lgkmcnt(0)
    v_add_f32 v108, v108, v109
    v_add_f32 v110, v110, v111
    v_add_f32 v112, v112, v113
    v_add_f32 v114, v114, v115
    v_add_f32 v108, v108, v110
    v_add_f32 v112, v112, v114
    v_mul_f32 v109, 0xbfb8aa3b, v108
    v_exp_f32 v109, v109
    s_nop 0
    v_add_f32 v109, 1.0, v109
    v_rcp_f32 v109, v109
    s_nop 0
    v_mul_f32 v108, v108, v109
    v_mul_f32 v108, v108, v112
    v_lshrrev_b32 v96, 4, v2
    v_lshlrev_b32 v96, 2, v96
    ds_bpermute_b32 v112, v96, v108 offset:0
    ds_bpermute_b32 v113, v96, v108 offset:16
    ds_bpermute_b32 v114, v96, v108 offset:32
    ds_bpermute_b32 v115, v96, v108 offset:48
    s_waitcnt lgkmcnt(0)
    v_lshlrev_b32 v116, 16, v64
    v_and_b32 v117, 0xffff0000, v64
    v_mul_f32 v120, v116, v112
    v_mul_f32 v121, v117, v112
    v_lshlrev_b32 v116, 16, v65
    v_and_b32 v117, 0xffff0000, v65
    v_mul_f32 v122, v116, v112
    v_mul_f32 v123, v117, v112
    v_lshlrev_b32 v116, 16, v66
    v_and_b32 v117, 0xffff0000, v66
    v_mul_f32 v124, v116, v112
    v_mul_f32 v125, v117, v112
    v_lshlrev_b32 v116, 16, v67
    v_and_b32 v117, 0xffff0000, v67
    v_mul_f32 v126, v116, v112
    v_mul_f32 v127, v117, v112
    v_lshlrev_b32 v116, 16, v68
    v_and_b32 v117, 0xffff0000, v68
    v_fmac_f32 v120, v116, v113
    v_fmac_f32 v121, v117, v113
    v_lshlrev_b32 v116, 16, v69
    v_and_b32 v117, 0xffff0000, v69
    v_fmac_f32 v122, v116, v113
    v_fmac_f32 v123, v117, v113
    v_lshlrev_b32 v116, 16, v70
    v_and_b32 v117, 0xffff0000, v70
    v_fmac_f32 v124, v116, v113
    v_fmac_f32 v125, v117, v113
    v_lshlrev_b32 v116, 16, v71
    v_and_b32 v117, 0xffff0000, v71
    v_fmac_f32 v126, v116, v113
    v_fmac_f32 v127, v117, v113
    v_lshlrev_b32 v116, 16, v72
    v_and_b32 v117, 0xffff0000, v72
    v_fmac_f32 v120, v116, v114
    v_fmac_f32 v121, v117, v114
    v_lshlrev_b32 v116, 16, v73
    v_and_b32 v117, 0xffff0000, v73
    v_fmac_f32 v122, v116, v114
    v_fmac_f32 v123, v117, v114
    v_lshlrev_b32 v116, 16, v74
    v_and_b32 v117, 0xffff0000, v74
    v_fmac_f32 v124, v116, v114
    v_fmac_f32 v125, v117, v114
    v_lshlrev_b32 v116, 16, v75
    v_and_b32 v117, 0xffff0000, v75
    v_fmac_f32 v126, v116, v114
    v_fmac_f32 v127, v117, v114
    v_lshlrev_b32 v116, 16, v76
    v_and_b32 v117, 0xffff0000, v76
    v_fmac_f32 v120, v116, v115
    v_fmac_f32 v121, v117, v115
    v_lshlrev_b32 v116, 16, v77
    v_and_b32 v117, 0xffff0000, v77
    v_fmac_f32 v122, v116, v115
    v_fmac_f32 v123, v117, v115
    v_lshlrev_b32 v116, 16, v78
    v_and_b32 v117, 0xffff0000, v78
    v_fmac_f32 v124, v116, v115
    v_fmac_f32 v125, v117, v115
    v_lshlrev_b32 v116, 16, v79
    v_and_b32 v117, 0xffff0000, v79
    v_fmac_f32 v126, v116, v115
    v_fmac_f32 v127, v117, v115
    v_permlane32_swap_b32 v120, v124
    v_permlane32_swap_b32 v121, v125
    v_permlane32_swap_b32 v122, v126
    v_permlane32_swap_b32 v123, v127
    v_add_f32 v120, v120, v124
    v_add_f32 v121, v121, v125
    v_add_f32 v122, v122, v126
    v_add_f32 v123, v123, v127
    s_nop 0
    v_permlane16_swap_b32 v120, v122
    v_permlane16_swap_b32 v121, v123
    v_add_f32 v120, v120, v122
    v_add_f32 v121, v121, v123
    s_cmp_ge_u32 s25, 28
    s_cbranch_scc1 ffn0_kernel_end
    v_and_b32 v96, 15, v2
    v_lshlrev_b32 v96, 5, v96
    v_lshrrev_b32 v97, 4, v2
    v_lshl_add_u32 v96, v97, 3, v96
    s_and_b32 s34, s26, 15
    s_lshl_b32 s34, s34, 12
    s_lshl_b32 s35, s3, 9
    s_add_u32 s34, s34, s35
    s_add_u32 s34, s34, 0x1410000
    buffer_atomic_add_f32 v120, v96, s[20:23], s34 offen sc1
    buffer_atomic_add_f32 v121, v96, s[20:23], s34 offen offset:4 sc1
ffn0_kernel_end:
ffn0_kernel_exit:
    s_endpgm
.globl fix0_kernel
.p2align 8
.type fix0_kernel,@function
fix0_kernel:
    s_cmp_ge_u32 s2, 1
    s_cbranch_scc1 fix0_kernel_exit
    s_load_dwordx2 s[44:45], s[0:1], 64
    s_load_dwordx2 s[46:47], s[0:1], 80
    s_waitcnt lgkmcnt(0)
    s_mov_b32 s20, s46
    s_mov_b32 s21, s47
    s_mov_b32 s22, 0x8000000
    s_mov_b32 s23, 0x20000
    s_mov_b32 s48, s44
    s_mov_b32 s49, s45
    s_mov_b32 s50, 0x400000
    s_mov_b32 s51, 0x20000
    v_mov_b32 v1, 0
    s_mov_b32 s27, 0x1450000
    buffer_load_dwordx4 v[4:7], v1, s[20:23], s27 offen
    v_lshlrev_b32 v2, 4, v0
    s_mov_b32 s27, 0x1410000
    buffer_load_dwordx4 v[16:19], v2, s[20:23], s27 offen
    s_add_u32 s27, s27, 4096
    buffer_load_dwordx4 v[20:23], v2, s[20:23], s27 offen
    s_add_u32 s27, s27, 4096
    buffer_load_dwordx4 v[24:27], v2, s[20:23], s27 offen
    s_add_u32 s27, s27, 4096
    buffer_load_dwordx4 v[28:31], v2, s[20:23], s27 offen
    s_add_u32 s27, s27, 4096
    buffer_load_dwordx4 v[32:35], v2, s[20:23], s27 offen
    s_add_u32 s27, s27, 4096
    buffer_load_dwordx4 v[36:39], v2, s[20:23], s27 offen
    s_add_u32 s27, s27, 4096
    buffer_load_dwordx4 v[40:43], v2, s[20:23], s27 offen
    s_add_u32 s27, s27, 4096
    buffer_load_dwordx4 v[44:47], v2, s[20:23], s27 offen
    s_add_u32 s27, s27, 4096
    buffer_load_dwordx4 v[48:51], v2, s[20:23], s27 offen
    s_add_u32 s27, s27, 4096
    buffer_load_dwordx4 v[52:55], v2, s[20:23], s27 offen
    s_add_u32 s27, s27, 4096
    buffer_load_dwordx4 v[56:59], v2, s[20:23], s27 offen
    s_add_u32 s27, s27, 4096
    buffer_load_dwordx4 v[60:63], v2, s[20:23], s27 offen
    s_add_u32 s27, s27, 4096
    buffer_load_dwordx4 v[64:67], v2, s[20:23], s27 offen
    s_add_u32 s27, s27, 4096
    buffer_load_dwordx4 v[68:71], v2, s[20:23], s27 offen
    s_add_u32 s27, s27, 4096
    buffer_load_dwordx4 v[72:75], v2, s[20:23], s27 offen
    s_add_u32 s27, s27, 4096
    buffer_load_dwordx4 v[76:79], v2, s[20:23], s27 offen
    s_add_u32 s27, s27, 4096
    s_waitcnt vmcnt(16)
    v_and_b32 v4, 2047, v4
    v_lshrrev_b32 v8, 7, v4
    v_lshlrev_b32 v8, 18, v8
    v_bfe_u32 v9, v4, 5, 2
    v_lshl_add_u32 v8, v9, 12, v8
    v_and_b32 v9, 31, v4
    v_lshl_add_u32 v8, v9, 4, v8
    v_lshrrev_b32 v9, 4, v0
    v_lshl_add_u32 v8, v9, 14, v8
    v_bfe_u32 v9, v0, 2, 2
    v_lshl_add_u32 v8, v9, 10, v8
    v_and_b32 v9, 1, v0
    v_lshl_add_u32 v8, v9, 9, v8
    v_bfe_u32 v9, v0, 1, 1
    v_lshl_add_u32 v8, v9, 3, v8
    s_mov_b32 s28, 0x1000000
    buffer_load_dwordx2 v[10:11], v8, s[20:23], s28 offen
    v_mul_f32 v5, 0xbfb8aa3b, v5
    v_exp_f32 v5, v5
    s_nop 0
    v_add_f32 v5, 1.0, v5
    v_rcp_f32 v5, v5
    v_mul_f32 v6, v6, v7
    v_add_f32 v7, 1.0, v7
    s_waitcnt vmcnt(0)
    v_add_f32 v16, v16, v20
    v_add_f32 v17, v17, v21
    v_add_f32 v18, v18, v22
    v_add_f32 v19, v19, v23
    v_add_f32 v16, v16, v24
    v_add_f32 v17, v17, v25
    v_add_f32 v18, v18, v26
    v_add_f32 v19, v19, v27
    v_add_f32 v16, v16, v28
    v_add_f32 v17, v17, v29
    v_add_f32 v18, v18, v30
    v_add_f32 v19, v19, v31
    v_add_f32 v16, v16, v32
    v_add_f32 v17, v17, v33
    v_add_f32 v18, v18, v34
    v_add_f32 v19, v19, v35
    v_add_f32 v16, v16, v36
    v_add_f32 v17, v17, v37
    v_add_f32 v18, v18, v38
    v_add_f32 v19, v19, v39
    v_add_f32 v16, v16, v40
    v_add_f32 v17, v17, v41
    v_add_f32 v18, v18, v42
    v_add_f32 v19, v19, v43
    v_add_f32 v16, v16, v44
    v_add_f32 v17, v17, v45
    v_add_f32 v18, v18, v46
    v_add_f32 v19, v19, v47
    v_add_f32 v16, v16, v48
    v_add_f32 v17, v17, v49
    v_add_f32 v18, v18, v50
    v_add_f32 v19, v19, v51
    v_add_f32 v16, v16, v52
    v_add_f32 v17, v17, v53
    v_add_f32 v18, v18, v54
    v_add_f32 v19, v19, v55
    v_add_f32 v16, v16, v56
    v_add_f32 v17, v17, v57
    v_add_f32 v18, v18, v58
    v_add_f32 v19, v19, v59
    v_add_f32 v16, v16, v60
    v_add_f32 v17, v17, v61
    v_add_f32 v18, v18, v62
    v_add_f32 v19, v19, v63
    v_add_f32 v16, v16, v64
    v_add_f32 v17, v17, v65
    v_add_f32 v18, v18, v66
    v_add_f32 v19, v19, v67
    v_add_f32 v16, v16, v68
    v_add_f32 v17, v17, v69
    v_add_f32 v18, v18, v70
    v_add_f32 v19, v19, v71
    v_add_f32 v16, v16, v72
    v_add_f32 v17, v17, v73
    v_add_f32 v18, v18, v74
    v_add_f32 v19, v19, v75
    v_add_f32 v16, v16, v76
    v_add_f32 v17, v17, v77
    v_add_f32 v18, v18, v78
    v_add_f32 v19, v19, v79
    v_lshlrev_b32 v12, 16, v10
    v_and_b32 v13, 0xffff0000, v10
    v_lshlrev_b32 v14, 16, v11
    v_and_b32 v15, 0xffff0000, v11
    v_fma_f32 v12, v12, v7, -v6
    v_fmac_f32 v12, v16, v5
    v_fma_f32 v13, v13, v7, -v6
    v_fmac_f32 v13, v17, v5
    v_fma_f32 v14, v14, v7, -v6
    v_fmac_f32 v14, v18, v5
    v_fma_f32 v15, v15, v7, -v6
    v_fmac_f32 v15, v19, v5
    v_cvt_pk_bf16_f32 v10, v12, v13
    v_cvt_pk_bf16_f32 v11, v14, v15
    buffer_store_dwordx2 v[10:11], v8, s[20:23], s28 offen
    v_add_f32 v20, v12, v13
    v_add_f32 v20, v20, v14
    v_add_f32 v20, v20, v15
    v_mul_f32 v21, v12, v12
    v_fmac_f32 v21, v13, v13
    v_fmac_f32 v21, v14, v14
    v_fmac_f32 v21, v15, v15
    v_add_f32_dpp v20, v20, v20 quad_perm:[1,0,3,2] row_mask:0xf bank_mask:0xf
    s_nop 1
    v_add_f32_dpp v20, v20, v20 quad_perm:[2,3,0,1] row_mask:0xf bank_mask:0xf
    s_nop 1
    v_add_f32_dpp v20, v20, v20 row_half_mirror row_mask:0xf bank_mask:0xf
    s_nop 1
    v_add_f32_dpp v20, v20, v20 row_mirror row_mask:0xf bank_mask:0xf
    v_mov_b32 v22, v20
    s_nop 1
    v_permlane16_swap_b32 v20, v22
    v_add_f32 v20, v20, v22
    v_mov_b32 v22, v20
    s_nop 1
    v_permlane32_swap_b32 v20, v22
    v_add_f32 v20, v20, v22
    v_add_f32_dpp v21, v21, v21 quad_perm:[1,0,3,2] row_mask:0xf bank_mask:0xf
    s_nop 1
    v_add_f32_dpp v21, v21, v21 quad_perm:[2,3,0,1] row_mask:0xf bank_mask:0xf
    s_nop 1
    v_add_f32_dpp v21, v21, v21 row_half_mirror row_mask:0xf bank_mask:0xf
    s_nop 1
    v_add_f32_dpp v21, v21, v21 row_mirror row_mask:0xf bank_mask:0xf
    v_mov_b32 v22, v21
    s_nop 1
    v_permlane16_swap_b32 v21, v22
    v_add_f32 v21, v21, v22
    v_mov_b32 v22, v21
    s_nop 1
    v_permlane32_swap_b32 v21, v22
    v_add_f32 v21, v21, v22
    v_lshrrev_b32 v22, 6, v0
    v_lshlrev_b32 v22, 3, v22
    ds_write_b64 v22, v[20:21]
    s_waitcnt lgkmcnt(0)
    s_barrier
    ds_read_b128 v[24:27], v1
    ds_read_b128 v[28:31], v1 offset:16
    s_waitcnt lgkmcnt(0)
    v_add_f32 v20, v24, v26
    v_add_f32 v21, v25, v27
    v_add_f32 v20, v20, v28
    v_add_f32 v21, v21, v29
    v_add_f32 v20, v20, v30
    v_add_f32 v21, v21, v31
    v_mul_f32 v20, 0x3a800000, v20
    v_mul_f32 v21, 0x3a800000, v21
    v_fma_f32 v21, -v20, v20, v21
    v_max_f32 v21, 0, v21
    v_add_f32 v21, 0x3727c5ac, v21
    v_rsq_f32 v21, v21
    v_cmp_eq_u32 vcc, 1, v0
    s_nop 1
    v_cndmask_b32 v21, v21, v20, vcc
    v_cmp_eq_u32 vcc, 2, v0
    s_nop 1
    v_cndmask_b32 v21, v21, 1.0, vcc
    v_cmp_eq_u32 vcc, 3, v0
    s_nop 1
    v_cndmask_b32 v21, v21, 0, vcc
    v_lshlrev_b32 v22, 13, v0
    v_lshl_add_u32 v22, v4, 2, v22
    v_cmp_gt_u32 vcc, 4, v0
    s_and_saveexec_b64 s[36:37], vcc
    s_mov_b32 s27, 0x3440000
    buffer_store_dword v21, v22, s[20:23], s27 offen
fix0_kernel_end:
fix0_kernel_exit:
    s_endpgm
.globl qkv1_kernel
.p2align 8
.type qkv1_kernel,@function
qkv1_kernel:
    s_cmp_ge_u32 s2, 256
    s_cbranch_scc1 qkv1_kernel_exit
    s_load_dwordx4 s[4:7], s[0:1], 0
    s_load_dwordx2 s[8:9], s[0:1], 80
    v_lshrrev_b32 v1, 6, v0
    v_and_b32 v2, 63, v0
    v_readfirstlane_b32 s3, v1
    s_and_b32 s24, s2, 7
    s_lshr_b32 s25, s2, 3
    s_lshr_b32 s26, s24, 2
    s_lshl_b32 s26, s26, 3
    s_and_b32 s27, s25, 7
    s_add_u32 s26, s26, s27
    s_and_b32 s27, s24, 3
    s_lshl_b32 s27, s27, 2
    s_lshr_b32 s25, s25, 3
    s_add_u32 s27, s27, s25
    s_waitcnt lgkmcnt(0)
    s_mov_b32 s20, s8
    s_mov_b32 s21, s9
    s_mov_b32 s22, 0x8000000
    s_mov_b32 s23, 0x20000
    s_cmp_lt_u32 s3, 4
    s_cbranch_scc1 qkv1_kernel_cons
    s_add_u32 s12, s8, 0x1000000
    s_addc_u32 s13, s9, 0
    s_mov_b32 s14, 0x400000
    s_mov_b32 s15, 0x20000
    s_mov_b32 s16, s6
    s_mov_b32 s17, s7
    s_mov_b32 s18, 0x600000
    s_mov_b32 s19, 0x20000
    s_sub_u32 s3, s3, 4
    s_lshl_b32 s28, s3, 10
    v_lshlrev_b32 v3, 4, v2
    v_add_u32 v3, s28, v3
    s_lshl_b32 s30, s26, 18
    v_lshrrev_b32 v4, 3, v2
    v_and_b32 v5, 3, v4
    v_lshrrev_b32 v6, 5, v2
    v_lshl_add_u32 v4, v6, 3, v5
    s_lshr_b32 s28, s3, 1
    s_lshl_b32 s28, s28, 4
    s_and_b32 s29, s3, 1
    s_lshl_b32 s29, s29, 2
    s_add_u32 s28, s28, s29
    v_add_u32 v4, s28, v4
    v_mul_u32_u24 v4, 6144, v4
    v_lshrrev_b32 v5, 2, v2
    v_and_b32 v5, 4, v5
    v_xor_b32 v5, v5, v2
    v_and_b32 v5, 7, v5
    v_lshl_add_u32 v4, v5, 4, v4
    s_lshl_b32 s31, s27, 7
    s_lshl_b32 s32, s3, 10
    v_subrev_u32 v7, 256, v0
    v_lshrrev_b32 v8, 6, v7
    v_lshlrev_b32 v8, 12, v8
    v_lshl_add_u32 v8, v2, 2, v8
    s_lshl_b32 s33, s27, 8
    s_add_u32 s33, s33, 0x4000000
    buffer_load_dword v16, v8, s[20:23], s33 offen
    s_add_u32 s33, s33, 12288
    buffer_load_dword v17, v8, s[20:23], s33 offen
    s_add_u32 s33, s33, 12288
    buffer_load_dword v18, v8, s[20:23], s33 offen
    s_add_u32 s33, s33, 12288
    buffer_load_dword v19, v8, s[20:23], s33 offen
    s_add_u32 s33, s33, 12288
    buffer_load_dword v20, v8, s[20:23], s33 offen
    s_add_u32 s33, s33, 12288
    buffer_load_dword v21, v8, s[20:23], s33 offen
    s_add_u32 s33, s33, 12288
    buffer_load_dword v22, v8, s[20:23], s33 offen
    s_add_u32 s33, s33, 12288
    buffer_load_dword v23, v8, s[20:23], s33 offen
    s_add_u32 s33, s33, 12288
    buffer_load_dword v24, v8, s[20:23], s33 offen
    s_add_u32 s33, s33, 12288
    buffer_load_dword v25, v8, s[20:23], s33 offen
    s_add_u32 s33, s33, 12288
    buffer_load_dword v26, v8, s[20:23], s33 offen
    s_add_u32 s33, s33, 12288
    buffer_load_dword v27, v8, s[20:23], s33 offen
    s_add_u32 s33, s33, 12288
    buffer_load_dword v28, v8, s[20:23], s33 offen
    s_add_u32 s33, s33, 12288
    buffer_load_dword v29, v8, s[20:23], s33 offen
    s_add_u32 s33, s33, 12288
    buffer_load_dword v30, v8, s[20:23], s33 offen
    s_add_u32 s33, s33, 12288
    buffer_load_dword v31, v8, s[20:23], s33 offen
    s_add_u32 s33, s33, 12288
    v_lshrrev_b32 v9, 7, v7
    v_lshlrev_b32 v9, 13, v9
    v_and_b32 v10, 127, v7
    v_lshl_add_u32 v9, v10, 2, v9
    s_lshl_b32 s33, s26, 9
    s_add_u32 s33, s33, 0x3440000
    buffer_load_dword v32, v9, s[20:23], s33 offen
    s_mov_b32 s36, 4
qkv1_kernel_lpro:
    s_mov_b32 m0, s32
    s_mov_b32 s34, s30
    buffer_load_dwordx4 v3, s[12:15], s34 offen lds
    s_add_u32 m0, m0, 4096
    s_add_u32 s34, s34, 4096
    buffer_load_dwordx4 v3, s[12:15], s34 offen lds
    s_add_u32 m0, m0, 4096
    s_add_u32 s34, s34, 4096
    buffer_load_dwordx4 v3, s[12:15], s34 offen lds
    s_add_u32 m0, m0, 4096
    s_add_u32 s34, s34, 4096
    buffer_load_dwordx4 v3, s[12:15], s34 offen lds
    s_add_u32 m0, m0, 4096
    s_mov_b32 s34, s31
    buffer_load_dwordx4 v4, s[16:19], s34 offen lds
    s_add_u32 m0, m0, 4096
    s_add_u32 s34, s34, 196608
    buffer_load_dwordx4 v4, s[16:19], s34 offen lds
    s_add_u32 m0, m0, 4096
    s_sub_u32 s34, s34, 194560
    buffer_load_dwordx4 v4, s[16:19], s34 offen lds
    s_add_u32 m0, m0, 4096
    s_add_u32 s34, s34, 196608
    buffer_load_dwordx4 v4, s[16:19], s34 offen lds
    s_add_u32 m0, m0, 4096
    s_sub_u32 s34, s34, 194560
    buffer_load_dwordx4 v4, s[16:19], s34 offen lds
    s_add_u32 m0, m0, 4096
    s_add_u32 s34, s34, 196608
    buffer_load_dwordx4 v4, s[16:19], s34 offen lds
    s_add_u32 s30, s30, 16384
    s_add_u32 s31, s31, 393216
    s_add_u32 s32, s32, 40960
    s_cmp_ge_u32 s32, 163840
    s_cselect_b32 s35, 163840, 0
    s_sub_u32 s32, s32, s35
    s_sub_u32 s36, s36, 1
    s_cmp_lg_u32 s36, 0
    s_cbranch_scc1 qkv1_kernel_lpro
    s_waitcnt vmcnt(30)
    v_add_f32 v16, v16, v17
    v_add_f32 v16, v16, v18
    v_add_f32 v16, v16, v19
    v_add_f32 v16, v16, v20
    v_add_f32 v16, v16, v21
    v_add_f32 v16, v16, v22
    v_add_f32 v16, v16, v23
    v_add_f32 v16, v16, v24
    v_add_f32 v16, v16, v25
    v_add_f32 v16, v16, v26
    v_add_f32 v16, v16, v27
    v_add_f32 v16, v16, v28
    v_add_f32 v16, v16, v29
    v_add_f32 v16, v16, v30
    v_add_f32 v16, v16, v31
    s_barrier
    s_mov_b32 s36, 12
qkv1_kernel_lloop:
    s_waitcnt vmcnt(20)
    s_barrier
    s_mov_b32 m0, s32
    s_mov_b32 s34, s30
    buffer_load_dwordx4 v3, s[12:15], s34 offen lds
    s_add_u32 m0, m0, 4096
    s_add_u32 s34, s34, 4096
    buffer_load_dwordx4 v3, s[12:15], s34 offen lds
    s_add_u32 m0, m0, 4096
    s_add_u32 s34, s34, 4096
    buffer_load_dwordx4 v3, s[12:15], s34 offen lds
    s_add_u32 m0, m0, 4096
    s_add_u32 s34, s34, 4096
    buffer_load_dwordx4 v3, s[12:15], s34 offen lds
    s_add_u32 m0, m0, 4096
    s_mov_b32 s34, s31
    buffer_load_dwordx4 v4, s[16:19], s34 offen lds
    s_add_u32 m0, m0, 4096
    s_add_u32 s34, s34, 196608
    buffer_load_dwordx4 v4, s[16:19], s34 offen lds
    s_add_u32 m0, m0, 4096
    s_sub_u32 s34, s34, 194560
    buffer_load_dwordx4 v4, s[16:19], s34 offen lds
    s_add_u32 m0, m0, 4096
    s_add_u32 s34, s34, 196608
    buffer_load_dwordx4 v4, s[16:19], s34 offen lds
    s_add_u32 m0, m0, 4096
    s_sub_u32 s34, s34, 194560
    buffer_load_dwordx4 v4, s[16:19], s34 offen lds
    s_add_u32 m0, m0, 4096
    s_add_u32 s34, s34, 196608
    buffer_load_dwordx4 v4, s[16:19], s34 offen lds
    s_add_u32 s30, s30, 16384
    s_add_u32 s31, s31, 393216
    s_add_u32 s32, s32, 40960
    s_cmp_ge_u32 s32, 163840
    s_cselect_b32 s35, 163840, 0
    s_sub_u32 s32, s32, s35
    s_sub_u32 s36, s36, 1
    s_cmp_lg_u32 s36, 0
    s_cbranch_scc1 qkv1_kernel_lloop
    s_waitcnt vmcnt(20)
    s_barrier
    v_lshlrev_b32 v11, 2, v7
    ds_write_b32 v11, v32
    ds_write_b32 v11, v16 offset:1024
    s_waitcnt vmcnt(10)
    s_barrier
    s_waitcnt vmcnt(0)
    s_barrier
    s_waitcnt lgkmcnt(0)
    s_barrier
    s_endpgm
qkv1_kernel_cons:
    v_mov_b32 v212, v2
    s_and_b32 s28, s3, 1
    s_lshr_b32 s29, s3, 1
    v_and_b32 v3, 31, v2
    v_lshrrev_b32 v4, 5, v2
    s_lshl_b32 s30, s28, 13
    v_lshlrev_b32 v5, 4, v2
    v_add_u32 v136, s30, v5
    v_add_u32 v137, 1024, v136
    v_add_u32 v138, 2048, v136
    v_add_u32 v139, 3072, v136
    v_bfe_u32 v5, v2, 2, 2
    v_lshl_add_u32 v6, v4, 3, v5
    v_lshlrev_b32 v6, 7, v6
    v_lshrrev_b32 v5, 1, v5
    v_xor_b32 v5, s29, v5
    v_lshl_add_u32 v6, v5, 6, v6
    v_bfe_u32 v5, v2, 4, 1
    v_lshl_add_u32 v6, v5, 5, v6
    v_and_b32 v5, 3, v2
    v_lshl_add_u32 v6, v5, 3, v6
    v_add_u32 v140, 16384, v6
    v_mov_b32 v141, v136
    v_mov_b32 v142, v137
    v_mov_b32 v143, v138
    v_mov_b32 v144, v139
    v_mov_b32 v145, v140
    v_mov_b32 v0, 0
    v_mov_b32 v1, 0
    v_mov_b32 v2, 0
    v_mov_b32 v3, 0
    v_mov_b32 v4, 0
    v_mov_b32 v5, 0
    v_mov_b32 v6, 0
    v_mov_b32 v7, 0
    v_mov_b32 v8, 0
    v_mov_b32 v9, 0
    v_mov_b32 v10, 0
    v_mov_b32 v11, 0
    v_mov_b32 v12, 0
    v_mov_b32 v13, 0
    v_mov_b32 v14, 0
    v_mov_b32 v15, 0
    v_mov_b32 v16, 0
    v_mov_b32 v17, 0
    v_mov_b32 v18, 0
    v_mov_b32 v19, 0
    v_mov_b32 v20, 0
    v_mov_b32 v21, 0
    v_mov_b32 v22, 0
    v_mov_b32 v23, 0
    v_mov_b32 v24, 0
    v_mov_b32 v25, 0
    v_mov_b32 v26, 0
    v_mov_b32 v27, 0
    v_mov_b32 v28, 0
    v_mov_b32 v29, 0
    v_mov_b32 v30, 0
    v_mov_b32 v31, 0
    v_mov_b32 v32, 0
    v_mov_b32 v33, 0
    v_mov_b32 v34, 0
    v_mov_b32 v35, 0
    v_mov_b32 v36, 0
    v_mov_b32 v37, 0
    v_mov_b32 v38, 0
    v_mov_b32 v39, 0
    v_mov_b32 v40, 0
    v_mov_b32 v41, 0
    v_mov_b32 v42, 0
    v_mov_b32 v43, 0
    v_mov_b32 v44, 0
    v_mov_b32 v45, 0
    v_mov_b32 v46, 0
    v_mov_b32 v47, 0
    v_mov_b32 v48, 0
    v_mov_b32 v49, 0
    v_mov_b32 v50, 0
    v_mov_b32 v51, 0
    v_mov_b32 v52, 0
    v_mov_b32 v53, 0
    v_mov_b32 v54, 0
    v_mov_b32 v55, 0
    v_mov_b32 v56, 0
    v_mov_b32 v57, 0
    v_mov_b32 v58, 0
    v_mov_b32 v59, 0
    v_mov_b32 v60, 0
    v_mov_b32 v61, 0
    v_mov_b32 v62, 0
    v_mov_b32 v63, 0
    v_mov_b32 v64, 0
    v_mov_b32 v65, 0
    v_mov_b32 v66, 0
    v_mov_b32 v67, 0
    v_mov_b32 v68, 0
    v_mov_b32 v69, 0
    v_mov_b32 v70, 0
    v_mov_b32 v71, 0
    v_mov_b32 v72, 0
    v_mov_b32 v73, 0
    v_mov_b32 v74, 0
    v_mov_b32 v75, 0
    v_mov_b32 v76, 0
    v_mov_b32 v77, 0
    v_mov_b32 v78, 0
    v_mov_b32 v79, 0
    v_mov_b32 v80, 0
    v_mov_b32 v81, 0
    v_mov_b32 v82, 0
    v_mov_b32 v83, 0
    v_mov_b32 v84, 0
    v_mov_b32 v85, 0
    v_mov_b32 v86, 0
    v_mov_b32 v87, 0
    v_mov_b32 v88, 0
    v_mov_b32 v89, 0
    v_mov_b32 v90, 0
    v_mov_b32 v91, 0
    v_mov_b32 v92, 0
    v_mov_b32 v93, 0
    v_mov_b32 v94, 0
    v_mov_b32 v95, 0
    s_mov_b32 s31, 0
    s_mov_b32 s36, 16
    s_barrier
    ds_read_b128 v[96:99], v141
    ds_read_b128 v[100:103], v141 offset:4096
    ds_read_b64_tr_b16 v[104:105], v145 offset:0
    ds_read_b64_tr_b16 v[106:107], v145 offset:512
    ds_read_b64_tr_b16 v[108:109], v145 offset:8192
    ds_read_b64_tr_b16 v[110:111], v145 offset:8704
    ds_read_b64_tr_b16 v[112:113], v145 offset:16384
    ds_read_b64_tr_b16 v[114:115], v145 offset:16896
qkv1_kernel_cloop:
    s_waitcnt lgkmcnt(0)
    v_mfma_f32_32x32x16_bf16 v[0:15], v[104:107], v[96:99], v[0:15]
    ds_read_b128 v[116:119], v142
    ds_read_b64_tr_b16 v[124:125], v145 offset:2048
    ds_read_b64_tr_b16 v[126:127], v145 offset:2560
    v_mfma_f32_32x32x16_bf16 v[16:31], v[104:107], v[100:103], v[16:31]
    ds_read_b128 v[120:123], v142 offset:4096
    ds_read_b64_tr_b16 v[128:129], v145 offset:10240
    ds_read_b64_tr_b16 v[130:131], v145 offset:10752
    v_mfma_f32_32x32x16_bf16 v[32:47], v[108:111], v[96:99], v[32:47]
    ds_read_b64_tr_b16 v[132:133], v145 offset:18432
    ds_read_b64_tr_b16 v[134:135], v145 offset:18944
    v_mfma_f32_32x32x16_bf16 v[48:63], v[108:111], v[100:103], v[48:63]
    v_mfma_f32_32x32x16_bf16 v[64:79], v[96:99], v[112:115], v[64:79]
    v_mfma_f32_32x32x16_bf16 v[80:95], v[100:103], v[112:115], v[80:95]
    s_waitcnt lgkmcnt(0)
    v_mfma_f32_32x32x16_bf16 v[0:15], v[124:127], v[116:119], v[0:15]
    ds_read_b128 v[96:99], v143
    ds_read_b64_tr_b16 v[104:105], v145 offset:4096
    ds_read_b64_tr_b16 v[106:107], v145 offset:4608
    v_mfma_f32_32x32x16_bf16 v[16:31], v[124:127], v[120:123], v[16:31]
    ds_read_b128 v[100:103], v143 offset:4096
    ds_read_b64_tr_b16 v[108:109], v145 offset:12288
    ds_read_b64_tr_b16 v[110:111], v145 offset:12800
    v_mfma_f32_32x32x16_bf16 v[32:47], v[128:131], v[116:119], v[32:47]
    ds_read_b64_tr_b16 v[112:113], v145 offset:20480
    ds_read_b64_tr_b16 v[114:115], v145 offset:20992
    v_mfma_f32_32x32x16_bf16 v[48:63], v[128:131], v[120:123], v[48:63]
    v_mfma_f32_32x32x16_bf16 v[64:79], v[116:119], v[132:135], v[64:79]
    v_mfma_f32_32x32x16_bf16 v[80:95], v[120:123], v[132:135], v[80:95]
    s_waitcnt lgkmcnt(0)
    v_mfma_f32_32x32x16_bf16 v[0:15], v[104:107], v[96:99], v[0:15]
    ds_read_b128 v[116:119], v144
    ds_read_b64_tr_b16 v[124:125], v145 offset:6144
    ds_read_b64_tr_b16 v[126:127], v145 offset:6656
    v_mfma_f32_32x32x16_bf16 v[16:31], v[104:107], v[100:103], v[16:31]
    ds_read_b128 v[120:123], v144 offset:4096
    ds_read_b64_tr_b16 v[128:129], v145 offset:14336
    ds_read_b64_tr_b16 v[130:131], v145 offset:14848
    v_mfma_f32_32x32x16_bf16 v[32:47], v[108:111], v[96:99], v[32:47]
    ds_read_b64_tr_b16 v[132:133], v145 offset:22528
    ds_read_b64_tr_b16 v[134:135], v145 offset:23040
    v_mfma_f32_32x32x16_bf16 v[48:63], v[108:111], v[100:103], v[48:63]
    v_mfma_f32_32x32x16_bf16 v[64:79], v[96:99], v[112:115], v[64:79]
    v_mfma_f32_32x32x16_bf16 v[80:95], v[100:103], v[112:115], v[80:95]
    s_waitcnt lgkmcnt(0)
    v_mfma_f32_32x32x16_bf16 v[0:15], v[124:127], v[116:119], v[0:15]
    s_barrier
    s_add_u32 s31, s31, 40960
    s_cmp_ge_u32 s31, 163840
    s_cselect_b32 s31, 0, s31
    v_add_u32 v141, s31, v136
    v_add_u32 v145, s31, v140
    ds_read_b128 v[96:99], v141
    ds_read_b64_tr_b16 v[104:105], v145 offset:0
    ds_read_b64_tr_b16 v[106:107], v145 offset:512
    v_mfma_f32_32x32x16_bf16 v[16:31], v[124:127], v[120:123], v[16:31]
    ds_read_b128 v[100:103], v141 offset:4096
    ds_read_b64_tr_b16 v[108:109], v145 offset:8192
    ds_read_b64_tr_b16 v[110:111], v145 offset:8704
    v_mfma_f32_32x32x16_bf16 v[32:47], v[128:131], v[116:119], v[32:47]
    ds_read_b64_tr_b16 v[112:113], v145 offset:16384
    ds_read_b64_tr_b16 v[114:115], v145 offset:16896
    v_mfma_f32_32x32x16_bf16 v[48:63], v[128:131], v[120:123], v[48:63]
    v_add_u32 v142, s31, v137
    v_add_u32 v143, s31, v138
    v_add_u32 v144, s31, v139
    s_sub_u32 s36, s36, 1
    s_cmp_lg_u32 s36, 0
    v_mfma_f32_32x32x16_bf16 v[64:79], v[116:119], v[132:135], v[64:79]
    v_mfma_f32_32x32x16_bf16 v[80:95], v[120:123], v[132:135], v[80:95]
    s_cbranch_scc1 qkv1_kernel_cloop
    s_waitcnt lgkmcnt(0)
    v_and_b32 v96, 31, v212
    v_lshrrev_b32 v97, 5, v212
    s_lshl_b32 s30, s28, 8
    s_add_u32 s30, s30, 0
    v_lshl_add_u32 v98, v96, 2, s30
    v_lshl_add_u32 v99, v97, 4, s30
    s_lshl_b32 s30, s29, 7
    s_add_u32 s30, s30, 1024
    v_lshl_add_u32 v100, v97, 4, s30
    v_lshl_add_u32 v101, v96, 2, s30
    ds_read_b32 v104, v98
    ds_read_b32 v106, v98 offset:128
    ds_read_b32 v108, v98 offset:512
    ds_read_b32 v110, v98 offset:640
    ds_read_b32 v112, v101 offset:512
    ds_read_b128 v[116:119], v100 offset:0
    ds_read_b128 v[120:123], v100 offset:32
    ds_read_b128 v[124:127], v100 offset:64
    ds_read_b128 v[128:131], v100 offset:96
    ds_read_b128 v[132:135], v100 offset:256
    ds_read_b128 v[136:139], v100 offset:288
    ds_read_b128 v[140:143], v100 offset:320
    ds_read_b128 v[144:147], v100 offset:352
    ds_read_b128 v[148:151], v99 offset:0
    ds_read_b128 v[180:183], v99 offset:512
    ds_read_b128 v[152:155], v99 offset:32
    ds_read_b128 v[184:187], v99 offset:544
    ds_read_b128 v[156:159], v99 offset:64
    ds_read_b128 v[188:191], v99 offset:576
    ds_read_b128 v[160:163], v99 offset:96
    ds_read_b128 v[192:195], v99 offset:608
    ds_read_b128 v[164:167], v99 offset:128
    ds_read_b128 v[196:199], v99 offset:640
    ds_read_b128 v[168:171], v99 offset:160
    ds_read_b128 v[200:203], v99 offset:672
    ds_read_b128 v[172:175], v99 offset:192
    ds_read_b128 v[204:207], v99 offset:704
    ds_read_b128 v[176:179], v99 offset:224
    ds_read_b128 v[208:211], v99 offset:736
    s_lshl_b32 s30, s27, 1
    s_add_u32 s30, s30, s29
    s_lshl_b32 s30, s30, 6
    s_lshl_b32 s31, s26, 2
    s_add_u32 s30, s30, s31
    s_lshl_b32 s31, s28, 1
    s_add_u32 s30, s30, s31
    s_lshl_b32 s31, s30, 11
    s_add_u32 s31, s31, 0x2000000
    s_lshl_b32 s32, s30, 12
    s_add_u32 s32, s32, 0x2400000
    s_add_u32 s33, s32, 4096
    v_lshlrev_b32 v96, 4, v212
    s_waitcnt lgkmcnt(15)
    v_mul_f32 v114, 0x3e8293ee, v104
    v_mul_f32 v102, 0x3e8293ee, v106
    v_pk_fma_f32 v[0:1], v[116:117], v[108:109], v[0:1] op_sel_hi:[1,0,1] neg_lo:[0,1,0] neg_hi:[0,1,0]
    v_pk_fma_f32 v[2:3], v[118:119], v[108:109], v[2:3] op_sel_hi:[1,0,1] neg_lo:[0,1,0] neg_hi:[0,1,0]
    v_pk_fma_f32 v[4:5], v[120:121], v[108:109], v[4:5] op_sel_hi:[1,0,1] neg_lo:[0,1,0] neg_hi:[0,1,0]
    v_pk_fma_f32 v[6:7], v[122:123], v[108:109], v[6:7] op_sel_hi:[1,0,1] neg_lo:[0,1,0] neg_hi:[0,1,0]
    v_pk_fma_f32 v[8:9], v[124:125], v[108:109], v[8:9] op_sel_hi:[1,0,1] neg_lo:[0,1,0] neg_hi:[0,1,0]
    v_pk_fma_f32 v[10:11], v[126:127], v[108:109], v[10:11] op_sel_hi:[1,0,1] neg_lo:[0,1,0] neg_hi:[0,1,0]
    v_pk_fma_f32 v[12:13], v[128:129], v[108:109], v[12:13] op_sel_hi:[1,0,1] neg_lo:[0,1,0] neg_hi:[0,1,0]
    v_pk_fma_f32 v[14:15], v[130:131], v[108:109], v[14:15] op_sel_hi:[1,0,1] neg_lo:[0,1,0] neg_hi:[0,1,0]
    v_pk_mul_f32 v[0:1], v[0:1], v[114:115] op_sel_hi:[1,0]
    v_pk_mul_f32 v[2:3], v[2:3], v[114:115] op_sel_hi:[1,0]
    v_pk_mul_f32 v[4:5], v[4:5], v[114:115] op_sel_hi:[1,0]
    v_pk_mul_f32 v[6:7], v[6:7], v[114:115] op_sel_hi:[1,0]
    v_pk_mul_f32 v[8:9], v[8:9], v[114:115] op_sel_hi:[1,0]
    v_pk_mul_f32 v[10:11], v[10:11], v[114:115] op_sel_hi:[1,0]
    v_pk_mul_f32 v[12:13], v[12:13], v[114:115] op_sel_hi:[1,0]
    v_pk_mul_f32 v[14:15], v[14:15], v[114:115] op_sel_hi:[1,0]
    v_cvt_pk_bf16_f32 v0, v0, v1
    v_cvt_pk_bf16_f32 v1, v2, v3
    v_cvt_pk_bf16_f32 v2, v4, v5
    v_cvt_pk_bf16_f32 v3, v6, v7
    v_cvt_pk_bf16_f32 v4, v8, v9
    v_cvt_pk_bf16_f32 v5, v10, v11
    v_cvt_pk_bf16_f32 v6, v12, v13
    v_cvt_pk_bf16_f32 v7, v14, v15
    buffer_store_dwordx4 v[0:3], v96, s[20:23], s31 offen offset:0
    buffer_store_dwordx4 v[4:7], v96, s[20:23], s31 offen offset:1024
    v_pk_fma_f32 v[16:17], v[116:117], v[110:111], v[16:17] op_sel_hi:[1,0,1] neg_lo:[0,1,0] neg_hi:[0,1,0]
    v_pk_fma_f32 v[18:19], v[118:119], v[110:111], v[18:19] op_sel_hi:[1,0,1] neg_lo:[0,1,0] neg_hi:[0,1,0]
    v_pk_fma_f32 v[20:21], v[120:121], v[110:111], v[20:21] op_sel_hi:[1,0,1] neg_lo:[0,1,0] neg_hi:[0,1,0]
    v_pk_fma_f32 v[22:23], v[122:123], v[110:111], v[22:23] op_sel_hi:[1,0,1] neg_lo:[0,1,0] neg_hi:[0,1,0]
    v_pk_fma_f32 v[24:25], v[124:125], v[110:111], v[24:25] op_sel_hi:[1,0,1] neg_lo:[0,1,0] neg_hi:[0,1,0]
    v_pk_fma_f32 v[26:27], v[126:127], v[110:111], v[26:27] op_sel_hi:[1,0,1] neg_lo:[0,1,0] neg_hi:[0,1,0]
    v_pk_fma_f32 v[28:29], v[128:129], v[110:111], v[28:29] op_sel_hi:[1,0,1] neg_lo:[0,1,0] neg_hi:[0,1,0]
    v_pk_fma_f32 v[30:31], v[130:131], v[110:111], v[30:31] op_sel_hi:[1,0,1] neg_lo:[0,1,0] neg_hi:[0,1,0]
    v_pk_mul_f32 v[16:17], v[16:17], v[102:103] op_sel_hi:[1,0]
    v_pk_mul_f32 v[18:19], v[18:19], v[102:103] op_sel_hi:[1,0]
    v_pk_mul_f32 v[20:21], v[20:21], v[102:103] op_sel_hi:[1,0]
    v_pk_mul_f32 v[22:23], v[22:23], v[102:103] op_sel_hi:[1,0]
    v_pk_mul_f32 v[24:25], v[24:25], v[102:103] op_sel_hi:[1,0]
    v_pk_mul_f32 v[26:27], v[26:27], v[102:103] op_sel_hi:[1,0]
    v_pk_mul_f32 v[28:29], v[28:29], v[102:103] op_sel_hi:[1,0]
    v_pk_mul_f32 v[30:31], v[30:31], v[102:103] op_sel_hi:[1,0]
    v_cvt_pk_bf16_f32 v16, v16, v17
    v_cvt_pk_bf16_f32 v17, v18, v19
    v_cvt_pk_bf16_f32 v18, v20, v21
    v_cvt_pk_bf16_f32 v19, v22, v23
    v_cvt_pk_bf16_f32 v20, v24, v25
    v_cvt_pk_bf16_f32 v21, v26, v27
    v_cvt_pk_bf16_f32 v22, v28, v29
    v_cvt_pk_bf16_f32 v23, v30, v31
    buffer_store_dwordx4 v[16:19], v96, s[20:23], s31 offen offset:2048
    buffer_store_dwordx4 v[20:23], v96, s[20:23], s31 offen offset:3072
    v_pk_fma_f32 v[32:33], v[132:133], v[108:109], v[32:33] op_sel_hi:[1,0,1] neg_lo:[0,1,0] neg_hi:[0,1,0]
    v_pk_fma_f32 v[34:35], v[134:135], v[108:109], v[34:35] op_sel_hi:[1,0,1] neg_lo:[0,1,0] neg_hi:[0,1,0]
    v_pk_fma_f32 v[36:37], v[136:137], v[108:109], v[36:37] op_sel_hi:[1,0,1] neg_lo:[0,1,0] neg_hi:[0,1,0]
    v_pk_fma_f32 v[38:39], v[138:139], v[108:109], v[38:39] op_sel_hi:[1,0,1] neg_lo:[0,1,0] neg_hi:[0,1,0]
    v_pk_fma_f32 v[40:41], v[140:141], v[108:109], v[40:41] op_sel_hi:[1,0,1] neg_lo:[0,1,0] neg_hi:[0,1,0]
    v_pk_fma_f32 v[42:43], v[142:143], v[108:109], v[42:43] op_sel_hi:[1,0,1] neg_lo:[0,1,0] neg_hi:[0,1,0]
    v_pk_fma_f32 v[44:45], v[144:145], v[108:109], v[44:45] op_sel_hi:[1,0,1] neg_lo:[0,1,0] neg_hi:[0,1,0]
    v_pk_fma_f32 v[46:47], v[146:147], v[108:109], v[46:47] op_sel_hi:[1,0,1] neg_lo:[0,1,0] neg_hi:[0,1,0]
    v_pk_mul_f32 v[32:33], v[32:33], v[104:105] op_sel_hi:[1,0]
    v_pk_mul_f32 v[34:35], v[34:35], v[104:105] op_sel_hi:[1,0]
    v_pk_mul_f32 v[36:37], v[36:37], v[104:105] op_sel_hi:[1,0]
    v_pk_mul_f32 v[38:39], v[38:39], v[104:105] op_sel_hi:[1,0]
    v_pk_mul_f32 v[40:41], v[40:41], v[104:105] op_sel_hi:[1,0]
    v_pk_mul_f32 v[42:43], v[42:43], v[104:105] op_sel_hi:[1,0]
    v_pk_mul_f32 v[44:45], v[44:45], v[104:105] op_sel_hi:[1,0]
    v_pk_mul_f32 v[46:47], v[46:47], v[104:105] op_sel_hi:[1,0]
    v_cvt_pk_bf16_f32 v32, v32, v33
    v_cvt_pk_bf16_f32 v33, v34, v35
    v_cvt_pk_bf16_f32 v34, v36, v37
    v_cvt_pk_bf16_f32 v35, v38, v39
    v_cvt_pk_bf16_f32 v36, v40, v41
    v_cvt_pk_bf16_f32 v37, v42, v43
    v_cvt_pk_bf16_f32 v38, v44, v45
    v_cvt_pk_bf16_f32 v39, v46, v47
    buffer_store_dwordx4 v[32:35], v96, s[20:23], s32 offen offset:0
    buffer_store_dwordx4 v[36:39], v96, s[20:23], s32 offen offset:1024
    v_pk_fma_f32 v[48:49], v[132:133], v[110:111], v[48:49] op_sel_hi:[1,0,1] neg_lo:[0,1,0] neg_hi:[0,1,0]
    v_pk_fma_f32 v[50:51], v[134:135], v[110:111], v[50:51] op_sel_hi:[1,0,1] neg_lo:[0,1,0] neg_hi:[0,1,0]
    v_pk_fma_f32 v[52:53], v[136:137], v[110:111], v[52:53] op_sel_hi:[1,0,1] neg_lo:[0,1,0] neg_hi:[0,1,0]
    v_pk_fma_f32 v[54:55], v[138:139], v[110:111], v[54:55] op_sel_hi:[1,0,1] neg_lo:[0,1,0] neg_hi:[0,1,0]
    v_pk_fma_f32 v[56:57], v[140:141], v[110:111], v[56:57] op_sel_hi:[1,0,1] neg_lo:[0,1,0] neg_hi:[0,1,0]
    v_pk_fma_f32 v[58:59], v[142:143], v[110:111], v[58:59] op_sel_hi:[1,0,1] neg_lo:[0,1,0] neg_hi:[0,1,0]
    v_pk_fma_f32 v[60:61], v[144:145], v[110:111], v[60:61] op_sel_hi:[1,0,1] neg_lo:[0,1,0] neg_hi:[0,1,0]
    v_pk_fma_f32 v[62:63], v[146:147], v[110:111], v[62:63] op_sel_hi:[1,0,1] neg_lo:[0,1,0] neg_hi:[0,1,0]
    v_pk_mul_f32 v[48:49], v[48:49], v[106:107] op_sel_hi:[1,0]
    v_pk_mul_f32 v[50:51], v[50:51], v[106:107] op_sel_hi:[1,0]
    v_pk_mul_f32 v[52:53], v[52:53], v[106:107] op_sel_hi:[1,0]
    v_pk_mul_f32 v[54:55], v[54:55], v[106:107] op_sel_hi:[1,0]
    v_pk_mul_f32 v[56:57], v[56:57], v[106:107] op_sel_hi:[1,0]
    v_pk_mul_f32 v[58:59], v[58:59], v[106:107] op_sel_hi:[1,0]
    v_pk_mul_f32 v[60:61], v[60:61], v[106:107] op_sel_hi:[1,0]
    v_pk_mul_f32 v[62:63], v[62:63], v[106:107] op_sel_hi:[1,0]
    v_cvt_pk_bf16_f32 v48, v48, v49
    v_cvt_pk_bf16_f32 v49, v50, v51
    v_cvt_pk_bf16_f32 v50, v52, v53
    v_cvt_pk_bf16_f32 v51, v54, v55
    v_cvt_pk_bf16_f32 v52, v56, v57
    v_cvt_pk_bf16_f32 v53, v58, v59
    v_cvt_pk_bf16_f32 v54, v60, v61
    v_cvt_pk_bf16_f32 v55, v62, v63
    buffer_store_dwordx4 v[48:51], v96, s[20:23], s33 offen offset:0
    buffer_store_dwordx4 v[52:55], v96, s[20:23], s33 offen offset:1024
    s_waitcnt lgkmcnt(0)
    v_pk_fma_f32 v[64:65], v[180:181], v[112:113], v[64:65] op_sel_hi:[1,0,1] neg_lo:[0,1,0] neg_hi:[0,1,0]
    v_pk_fma_f32 v[66:67], v[182:183], v[112:113], v[66:67] op_sel_hi:[1,0,1] neg_lo:[0,1,0] neg_hi:[0,1,0]
    v_pk_fma_f32 v[68:69], v[184:185], v[112:113], v[68:69] op_sel_hi:[1,0,1] neg_lo:[0,1,0] neg_hi:[0,1,0]
    v_pk_fma_f32 v[70:71], v[186:187], v[112:113], v[70:71] op_sel_hi:[1,0,1] neg_lo:[0,1,0] neg_hi:[0,1,0]
    v_pk_fma_f32 v[72:73], v[188:189], v[112:113], v[72:73] op_sel_hi:[1,0,1] neg_lo:[0,1,0] neg_hi:[0,1,0]
    v_pk_fma_f32 v[74:75], v[190:191], v[112:113], v[74:75] op_sel_hi:[1,0,1] neg_lo:[0,1,0] neg_hi:[0,1,0]
    v_pk_fma_f32 v[76:77], v[192:193], v[112:113], v[76:77] op_sel_hi:[1,0,1] neg_lo:[0,1,0] neg_hi:[0,1,0]
    v_pk_fma_f32 v[78:79], v[194:195], v[112:113], v[78:79] op_sel_hi:[1,0,1] neg_lo:[0,1,0] neg_hi:[0,1,0]
    v_pk_mul_f32 v[64:65], v[64:65], v[148:149]
    v_pk_mul_f32 v[66:67], v[66:67], v[150:151]
    v_pk_mul_f32 v[68:69], v[68:69], v[152:153]
    v_pk_mul_f32 v[70:71], v[70:71], v[154:155]
    v_pk_mul_f32 v[72:73], v[72:73], v[156:157]
    v_pk_mul_f32 v[74:75], v[74:75], v[158:159]
    v_pk_mul_f32 v[76:77], v[76:77], v[160:161]
    v_pk_mul_f32 v[78:79], v[78:79], v[162:163]
    v_cvt_pk_bf16_f32 v64, v64, v65
    v_cvt_pk_bf16_f32 v65, v66, v67
    v_cvt_pk_bf16_f32 v66, v68, v69
    v_cvt_pk_bf16_f32 v67, v70, v71
    v_cvt_pk_bf16_f32 v68, v72, v73
    v_cvt_pk_bf16_f32 v69, v74, v75
    v_cvt_pk_bf16_f32 v70, v76, v77
    v_cvt_pk_bf16_f32 v71, v78, v79
    buffer_store_dwordx4 v[64:67], v96, s[20:23], s32 offen offset:2048
    buffer_store_dwordx4 v[68:71], v96, s[20:23], s32 offen offset:3072
    v_pk_fma_f32 v[80:81], v[196:197], v[112:113], v[80:81] op_sel_hi:[1,0,1] neg_lo:[0,1,0] neg_hi:[0,1,0]
    v_pk_fma_f32 v[82:83], v[198:199], v[112:113], v[82:83] op_sel_hi:[1,0,1] neg_lo:[0,1,0] neg_hi:[0,1,0]
    v_pk_fma_f32 v[84:85], v[200:201], v[112:113], v[84:85] op_sel_hi:[1,0,1] neg_lo:[0,1,0] neg_hi:[0,1,0]
    v_pk_fma_f32 v[86:87], v[202:203], v[112:113], v[86:87] op_sel_hi:[1,0,1] neg_lo:[0,1,0] neg_hi:[0,1,0]
    v_pk_fma_f32 v[88:89], v[204:205], v[112:113], v[88:89] op_sel_hi:[1,0,1] neg_lo:[0,1,0] neg_hi:[0,1,0]
    v_pk_fma_f32 v[90:91], v[206:207], v[112:113], v[90:91] op_sel_hi:[1,0,1] neg_lo:[0,1,0] neg_hi:[0,1,0]
    v_pk_fma_f32 v[92:93], v[208:209], v[112:113], v[92:93] op_sel_hi:[1,0,1] neg_lo:[0,1,0] neg_hi:[0,1,0]
    v_pk_fma_f32 v[94:95], v[210:211], v[112:113], v[94:95] op_sel_hi:[1,0,1] neg_lo:[0,1,0] neg_hi:[0,1,0]
    v_pk_mul_f32 v[80:81], v[80:81], v[164:165]
    v_pk_mul_f32 v[82:83], v[82:83], v[166:167]
    v_pk_mul_f32 v[84:85], v[84:85], v[168:169]
    v_pk_mul_f32 v[86:87], v[86:87], v[170:171]
    v_pk_mul_f32 v[88:89], v[88:89], v[172:173]
    v_pk_mul_f32 v[90:91], v[90:91], v[174:175]
    v_pk_mul_f32 v[92:93], v[92:93], v[176:177]
    v_pk_mul_f32 v[94:95], v[94:95], v[178:179]
    v_cvt_pk_bf16_f32 v80, v80, v81
    v_cvt_pk_bf16_f32 v81, v82, v83
    v_cvt_pk_bf16_f32 v82, v84, v85
    v_cvt_pk_bf16_f32 v83, v86, v87
    v_cvt_pk_bf16_f32 v84, v88, v89
    v_cvt_pk_bf16_f32 v85, v90, v91
    v_cvt_pk_bf16_f32 v86, v92, v93
    v_cvt_pk_bf16_f32 v87, v94, v95
    buffer_store_dwordx4 v[80:83], v96, s[20:23], s33 offen offset:2048
    buffer_store_dwordx4 v[84:87], v96, s[20:23], s33 offen offset:3072
qkv1_kernel_end:
qkv1_kernel_exit:
    s_endpgm
.globl attn1_kernel
.p2align 8
.type attn1_kernel,@function
attn1_kernel:
    s_cmp_ge_u32 s2, 256
    s_cbranch_scc1 attn1_kernel_exit
    s_load_dwordx2 s[8:9], s[0:1], 80
    v_lshrrev_b32 v1, 6, v0
    v_and_b32 v2, 63, v0
    v_readfirstlane_b32 s3, v1
    s_and_b32 s24, s2, 7
    s_lshr_b32 s25, s2, 3
    s_lshr_b32 s26, s24, 2
    s_lshl_b32 s26, s26, 3
    s_and_b32 s27, s25, 7
    s_add_u32 s26, s26, s27
    s_and_b32 s27, s24, 3
    s_lshl_b32 s27, s27, 2
    s_lshr_b32 s25, s25, 3
    s_add_u32 s27, s27, s25
    s_lshr_b32 s28, s3, 2
    s_and_b32 s29, s3, 3
    s_lshl_b32 s30, s27, 1
    s_add_u32 s30, s30, s28
    s_lshl_b32 s31, s26, 2
    s_add_u32 s37, s31, s29
    v_lshlrev_b32 v3, 4, v2
    s_waitcnt lgkmcnt(0)
    s_mov_b32 s20, s8
    s_mov_b32 s21, s9
    s_mov_b32 s22, 0x8000000
    s_mov_b32 s23, 0x20000
    s_lshl_b32 s32, s30, 6
    s_add_u32 s33, s32, s37
    s_lshl_b32 s33, s33, 11
    s_add_u32 s33, s33, 0x2000000
    buffer_load_dwordx4 v[4:7], v3, s[20:23], s33 offen
    buffer_load_dwordx4 v[8:11], v3, s[20:23], s33 offen offset:1024
    s_mul_i32 s34, s29, 3
    s_mul_i32 s35, s28, 12
    s_add_u32 s35, s35, s34
    s_lshl_b32 s35, s35, 12
    s_add_u32 s34, s34, s31
    s_sub_u32 s34, s34, 8
    s_max_i32 s36, s34, 0
    s_add_u32 s36, s36, s32
    s_lshl_b32 s36, s36, 12
    s_add_u32 s36, s36, 0x2400000
    s_mov_b32 m0, s35
    s_add_u32 s34, s34, 1
    buffer_load_dwordx4 v3, s[20:23], s36 offen offset:0 lds
    buffer_load_dwordx4 v3, s[20:23], s36 offen offset:1024 lds
    buffer_load_dwordx4 v3, s[20:23], s36 offen offset:2048 lds
    buffer_load_dwordx4 v3, s[20:23], s36 offen offset:3072 lds
    s_add_u32 s35, s35, 4096
    s_max_i32 s36, s34, 0
    s_add_u32 s36, s36, s32
    s_lshl_b32 s36, s36, 12
    s_add_u32 s36, s36, 0x2400000
    s_mov_b32 m0, s35
    s_add_u32 s34, s34, 1
    buffer_load_dwordx4 v3, s[20:23], s36 offen offset:0 lds
    buffer_load_dwordx4 v3, s[20:23], s36 offen offset:1024 lds
    buffer_load_dwordx4 v3, s[20:23], s36 offen offset:2048 lds
    buffer_load_dwordx4 v3, s[20:23], s36 offen offset:3072 lds
    s_add_u32 s35, s35, 4096
    s_max_i32 s36, s34, 0
    s_add_u32 s36, s36, s32
    s_lshl_b32 s36, s36, 12
    s_add_u32 s36, s36, 0x2400000
    s_mov_b32 m0, s35
    s_add_u32 s34, s34, 1
    buffer_load_dwordx4 v3, s[20:23], s36 offen offset:0 lds
    buffer_load_dwordx4 v3, s[20:23], s36 offen offset:1024 lds
    buffer_load_dwordx4 v3, s[20:23], s36 offen offset:2048 lds
    buffer_load_dwordx4 v3, s[20:23], s36 offen offset:3072 lds
    s_add_u32 s35, s35, 4096
    s_mov_b32 s40, 0xffffffff
    s_mov_b32 s41, 0xfffffff0
    s_mov_b32 s42, 0xfffffffe
    s_mov_b32 s43, 0xffffffe0
    s_mov_b32 s44, 0xfffffffc
    s_mov_b32 s45, 0xffffffc0
    s_mov_b32 s46, 0xfffffff8
    s_mov_b32 s47, 0xffffff80
    s_mov_b32 s48, 0xffffff00
    s_mov_b32 s49, 0xfffff000
    s_mov_b32 s50, 0xfffffe00
    s_mov_b32 s51, 0xffffe000
    s_mov_b32 s52, 0xfffffc00
    s_mov_b32 s53, 0xffffc000
    s_mov_b32 s54, 0xfffff800
    s_mov_b32 s55, 0xffff8000
    s_mov_b32 s56, 0xffff0000
    s_mov_b32 s57, 0xfff00000
    s_mov_b32 s58, 0xfffe0000
    s_mov_b32 s59, 0xffe00000
    s_mov_b32 s60, 0xfffc0000
    s_mov_b32 s61, 0xffc00000
    s_mov_b32 s62, 0xfff80000
    s_mov_b32 s63, 0xff800000
    s_mov_b32 s64, 0xff000000
    s_mov_b32 s65, 0xf0000000
    s_mov_b32 s66, 0xfe000000
    s_mov_b32 s67, 0xe0000000
    s_mov_b32 s68, 0xfc000000
    s_mov_b32 s69, 0xc0000000
    s_mov_b32 s70, 0xf8000000
    s_mov_b32 s71, 0x80000000
    v_mov_b32 v20, 0xffff
    v_mov_b32 v21, 0xffff0000
    v_cndmask_b32 v22, 0, v20, s[40:41]
    v_cndmask_b32 v23, 0, v21, s[42:43]
    v_or_b32 v12, v22, v23
    v_cndmask_b32 v22, 0, v20, s[44:45]
    v_cndmask_b32 v23, 0, v21, s[46:47]
    v_or_b32 v13, v22, v23
    v_cndmask_b32 v22, 0, v20, s[48:49]
    v_cndmask_b32 v23, 0, v21, s[50:51]
    v_or_b32 v14, v22, v23
    v_cndmask_b32 v22, 0, v20, s[52:53]
    v_cndmask_b32 v23, 0, v21, s[54:55]
    v_or_b32 v15, v22, v23
    v_cndmask_b32 v22, 0, v20, s[56:57]
    v_cndmask_b32 v23, 0, v21, s[58:59]
    v_or_b32 v16, v22, v23
    v_cndmask_b32 v22, 0, v20, s[60:61]
    v_cndmask_b32 v23, 0, v21, s[62:63]
    v_or_b32 v17, v22, v23
    v_cndmask_b32 v22, 0, v20, s[64:65]
    v_cndmask_b32 v23, 0, v21, s[66:67]
    v_or_b32 v18, v22, v23
    v_cndmask_b32 v22, 0, v20, s[68:69]
    v_cndmask_b32 v23, 0, v21, s[70:71]
    v_or_b32 v19, v22, v23
    s_mul_i32 s34, s28, 12
    s_add_u32 s34, s34, s29
    s_lshl_b32 s34, s34, 12
    v_add_u32 v20, s34, v3
    v_mov_b32 v24, 0
    v_mov_b32 v25, 0
    v_mov_b32 v26, 0
    v_mov_b32 v27, 0
    v_mov_b32 v28, 0
    v_mov_b32 v29, 0
    v_mov_b32 v30, 0
    v_mov_b32 v31, 0
    v_mov_b32 v32, 0
    v_mov_b32 v33, 0
    v_mov_b32 v34, 0
    v_mov_b32 v35, 0
    v_mov_b32 v36, 0
    v_mov_b32 v37, 0
    v_mov_b32 v38, 0
    v_mov_b32 v39, 0
    s_waitcnt vmcnt(0)
    s_barrier
    ds_read_b128 v[104:107], v20 offset:32768
    ds_read_b128 v[108:111], v20 offset:33792
    ds_read_b128 v[112:115], v20 offset:28672
    ds_read_b128 v[116:119], v20 offset:29696
    s_waitcnt lgkmcnt(2)
    v_mfma_f32_32x32x16_bf16 v[40:55], v[104:107], v[4:7], 0
    v_mfma_f32_32x32x16_bf16 v[40:55], v[108:111], v[8:11], v[40:55]
    ds_read_b128 v[104:107], v20 offset:24576
    ds_read_b128 v[108:111], v20 offset:25600
    s_cmp_eq_u32 s37, 0
    s_cbranch_scc0 attn1_kernel_a1
    v_mov_b32 v24, 0xf149f2ca
    v_mov_b32 v25, 0xf149f2ca
    v_mov_b32 v26, 0xf149f2ca
    v_mov_b32 v27, 0xf149f2ca
    v_mov_b32 v28, 0xf149f2ca
    v_mov_b32 v29, 0xf149f2ca
    v_mov_b32 v30, 0xf149f2ca
    v_mov_b32 v31, 0xf149f2ca
    v_mov_b32 v32, 0xf149f2ca
    v_mov_b32 v33, 0xf149f2ca
    v_mov_b32 v34, 0xf149f2ca
    v_mov_b32 v35, 0xf149f2ca
    v_mov_b32 v36, 0xf149f2ca
    v_mov_b32 v37, 0xf149f2ca
    v_mov_b32 v38, 0xf149f2ca
    v_mov_b32 v39, 0xf149f2ca
attn1_kernel_a1:
    s_waitcnt lgkmcnt(2)
    s_nop 0
    v_mfma_f32_32x32x16_bf16 v[72:87], v[112:115], v[4:7], v[24:39]
    v_mfma_f32_32x32x16_bf16 v[72:87], v[116:119], v[8:11], v[72:87]
    ds_read_b128 v[112:115], v20 offset:20480
    ds_read_b128 v[116:119], v20 offset:21504
    s_cmp_eq_u32 s37, 1
    s_cbranch_scc0 attn1_kernel_a2
    s_nop 1
    v_mov_b32 v24, 0xf149f2ca
    v_mov_b32 v25, 0xf149f2ca
    v_mov_b32 v26, 0xf149f2ca
    v_mov_b32 v27, 0xf149f2ca
    v_mov_b32 v28, 0xf149f2ca
    v_mov_b32 v29, 0xf149f2ca
    v_mov_b32 v30, 0xf149f2ca
    v_mov_b32 v31, 0xf149f2ca
    v_mov_b32 v32, 0xf149f2ca
    v_mov_b32 v33, 0xf149f2ca
    v_mov_b32 v34, 0xf149f2ca
    v_mov_b32 v35, 0xf149f2ca
    v_mov_b32 v36, 0xf149f2ca
    v_mov_b32 v37, 0xf149f2ca
    v_mov_b32 v38, 0xf149f2ca
    v_mov_b32 v39, 0xf149f2ca
attn1_kernel_a2:
    s_waitcnt lgkmcnt(2)
    s_nop 0
    v_mfma_f32_32x32x16_bf16 v[56:71], v[104:107], v[4:7], v[24:39]
    v_mfma_f32_32x32x16_bf16 v[56:71], v[108:111], v[8:11], v[56:71]
    s_nop 3
    v_max_f32 v21, v72, v73
    v_max3_f32 v21, v21, v74, v75
    v_max3_f32 v21, v21, v76, v77
    v_max3_f32 v21, v21, v78, v79
    v_max3_f32 v21, v21, v80, v81
    v_max3_f32 v21, v21, v82, v83
    v_max3_f32 v21, v21, v84, v85
    v_max3_f32 v21, v21, v86, v87
    ds_read_b128 v[104:107], v20 offset:16384
    ds_read_b128 v[108:111], v20 offset:17408
    s_cmp_eq_u32 s37, 2
    s_cbranch_scc0 attn1_kernel_a3
    v_mov_b32 v24, 0xf149f2ca
    v_mov_b32 v25, 0xf149f2ca
    v_mov_b32 v26, 0xf149f2ca
    v_mov_b32 v27, 0xf149f2ca
    v_mov_b32 v28, 0xf149f2ca
    v_mov_b32 v29, 0xf149f2ca
    v_mov_b32 v30, 0xf149f2ca
    v_mov_b32 v31, 0xf149f2ca
    v_mov_b32 v32, 0xf149f2ca
    v_mov_b32 v33, 0xf149f2ca
    v_mov_b32 v34, 0xf149f2ca
    v_mov_b32 v35, 0xf149f2ca
    v_mov_b32 v36, 0xf149f2ca
    v_mov_b32 v37, 0xf149f2ca
    v_mov_b32 v38, 0xf149f2ca
    v_mov_b32 v39, 0xf149f2ca
attn1_kernel_a3:
    s_waitcnt lgkmcnt(2)
    s_nop 0
    v_mfma_f32_32x32x16_bf16 v[72:87], v[112:115], v[4:7], v[24:39]
    v_mfma_f32_32x32x16_bf16 v[72:87], v[116:119], v[8:11], v[72:87]
    v_max3_f32 v21, v21, v56, v57
    v_max3_f32 v21, v21, v58, v59
    v_max3_f32 v21, v21, v60, v61
    v_max3_f32 v21, v21, v62, v63
    v_max3_f32 v21, v21, v64, v65
    v_max3_f32 v21, v21, v66, v67
    v_max3_f32 v21, v21, v68, v69
    v_max3_f32 v21, v21, v70, v71
    ds_read_b128 v[112:115], v20 offset:12288
    ds_read_b128 v[116:119], v20 offset:13312
    s_cmp_eq_u32 s37, 3
    s_cbranch_scc0 attn1_kernel_a4
    v_mov_b32 v24, 0xf149f2ca
    v_mov_b32 v25, 0xf149f2ca
    v_mov_b32 v26, 0xf149f2ca
    v_mov_b32 v27, 0xf149f2ca
    v_mov_b32 v28, 0xf149f2ca
    v_mov_b32 v29, 0xf149f2ca
    v_mov_b32 v30, 0xf149f2ca
    v_mov_b32 v31, 0xf149f2ca
    v_mov_b32 v32, 0xf149f2ca
    v_mov_b32 v33, 0xf149f2ca
    v_mov_b32 v34, 0xf149f2ca
    v_mov_b32 v35, 0xf149f2ca
    v_mov_b32 v36, 0xf149f2ca
    v_mov_b32 v37, 0xf149f2ca
    v_mov_b32 v38, 0xf149f2ca
    v_mov_b32 v39, 0xf149f2ca
attn1_kernel_a4:
    s_waitcnt lgkmcnt(2)
    s_nop 0
    v_mfma_f32_32x32x16_bf16 v[56:71], v[104:107], v[4:7], v[24:39]
    v_mfma_f32_32x32x16_bf16 v[56:71], v[108:111], v[8:11], v[56:71]
    v_max3_f32 v21, v21, v72, v73
    v_max3_f32 v21, v21, v74, v75
    v_max3_f32 v21, v21, v76, v77
    v_max3_f32 v21, v21, v78, v79
    v_max3_f32 v21, v21, v80, v81
    v_max3_f32 v21, v21, v82, v83
    v_max3_f32 v21, v21, v84, v85
    v_max3_f32 v21, v21, v86, v87
    ds_read_b128 v[104:107], v20 offset:8192
    ds_read_b128 v[108:111], v20 offset:9216
    s_cmp_eq_u32 s37, 4
    s_cbranch_scc0 attn1_kernel_a5
    v_mov_b32 v24, 0xf149f2ca
    v_mov_b32 v25, 0xf149f2ca
    v_mov_b32 v26, 0xf149f2ca
    v_mov_b32 v27, 0xf149f2ca
    v_mov_b32 v28, 0xf149f2ca
    v_mov_b32 v29, 0xf149f2ca
    v_mov_b32 v30, 0xf149f2ca
    v_mov_b32 v31, 0xf149f2ca
    v_mov_b32 v32, 0xf149f2ca
    v_mov_b32 v33, 0xf149f2ca
    v_mov_b32 v34, 0xf149f2ca
    v_mov_b32 v35, 0xf149f2ca
    v_mov_b32 v36, 0xf149f2ca
    v_mov_b32 v37, 0xf149f2ca
    v_mov_b32 v38, 0xf149f2ca
    v_mov_b32 v39, 0xf149f2ca
attn1_kernel_a5:
    s_waitcnt lgkmcnt(2)
    s_nop 0
    v_mfma_f32_32x32x16_bf16 v[72:87], v[112:115], v[4:7], v[24:39]
    v_mfma_f32_32x32x16_bf16 v[72:87], v[116:119], v[8:11], v[72:87]
    v_max3_f32 v21, v21, v56, v57
    v_max3_f32 v21, v21, v58, v59
    v_max3_f32 v21, v21, v60, v61
    v_max3_f32 v21, v21, v62, v63
    v_max3_f32 v21, v21, v64, v65
    v_max3_f32 v21, v21, v66, v67
    v_max3_f32 v21, v21, v68, v69
    v_max3_f32 v21, v21, v70, v71
    ds_read_b128 v[112:115], v20 offset:4096
    ds_read_b128 v[116:119], v20 offset:5120
    s_cmp_eq_u32 s37, 5
    s_cbranch_scc0 attn1_kernel_a6
    v_mov_b32 v24, 0xf149f2ca
    v_mov_b32 v25, 0xf149f2ca
    v_mov_b32 v26, 0xf149f2ca
    v_mov_b32 v27, 0xf149f2ca
    v_mov_b32 v28, 0xf149f2ca
    v_mov_b32 v29, 0xf149f2ca
    v_mov_b32 v30, 0xf149f2ca
    v_mov_b32 v31, 0xf149f2ca
    v_mov_b32 v32, 0xf149f2ca
    v_mov_b32 v33, 0xf149f2ca
    v_mov_b32 v34, 0xf149f2ca
    v_mov_b32 v35, 0xf149f2ca
    v_mov_b32 v36, 0xf149f2ca
    v_mov_b32 v37, 0xf149f2ca
    v_mov_b32 v38, 0xf149f2ca
    v_mov_b32 v39, 0xf149f2ca
attn1_kernel_a6:
    s_waitcnt lgkmcnt(2)
    s_nop 0
    v_mfma_f32_32x32x16_bf16 v[56:71], v[104:107], v[4:7], v[24:39]
    v_mfma_f32_32x32x16_bf16 v[56:71], v[108:111], v[8:11], v[56:71]
    v_max3_f32 v21, v21, v72, v73
    v_max3_f32 v21, v21, v74, v75
    v_max3_f32 v21, v21, v76, v77
    v_max3_f32 v21, v21, v78, v79
    v_max3_f32 v21, v21, v80, v81
    v_max3_f32 v21, v21, v82, v83
    v_max3_f32 v21, v21, v84, v85
    v_max3_f32 v21, v21, v86, v87
    ds_read_b128 v[104:107], v20 offset:0
    ds_read_b128 v[108:111], v20 offset:1024
    s_cmp_eq_u32 s37, 6
    s_cbranch_scc0 attn1_kernel_a7
    v_mov_b32 v24, 0xf149f2ca
    v_mov_b32 v25, 0xf149f2ca
    v_mov_b32 v26, 0xf149f2ca
    v_mov_b32 v27, 0xf149f2ca
    v_mov_b32 v28, 0xf149f2ca
    v_mov_b32 v29, 0xf149f2ca
    v_mov_b32 v30, 0xf149f2ca
    v_mov_b32 v31, 0xf149f2ca
    v_mov_b32 v32, 0xf149f2ca
    v_mov_b32 v33, 0xf149f2ca
    v_mov_b32 v34, 0xf149f2ca
    v_mov_b32 v35, 0xf149f2ca
    v_mov_b32 v36, 0xf149f2ca
    v_mov_b32 v37, 0xf149f2ca
    v_mov_b32 v38, 0xf149f2ca
    v_mov_b32 v39, 0xf149f2ca
attn1_kernel_a7:
    s_waitcnt lgkmcnt(2)
    s_nop 0
    v_mfma_f32_32x32x16_bf16 v[72:87], v[112:115], v[4:7], v[24:39]
    v_mfma_f32_32x32x16_bf16 v[72:87], v[116:119], v[8:11], v[72:87]
    v_max3_f32 v21, v21, v56, v57
    v_max3_f32 v21, v21, v58, v59
    v_max3_f32 v21, v21, v60, v61
    v_max3_f32 v21, v21, v62, v63
    v_max3_f32 v21, v21, v64, v65
    v_max3_f32 v21, v21, v66, v67
    v_max3_f32 v21, v21, v68, v69
    v_max3_f32 v21, v21, v70, v71
    s_cmp_eq_u32 s37, 7
    s_cbranch_scc0 attn1_kernel_a8
    v_mov_b32 v24, 0xf149f2ca
    v_mov_b32 v25, 0xf149f2ca
    v_mov_b32 v26, 0xf149f2ca
    v_mov_b32 v27, 0xf149f2ca
    v_mov_b32 v28, 0xf149f2ca
    v_mov_b32 v29, 0xf149f2ca
    v_mov_b32 v30, 0xf149f2ca
    v_mov_b32 v31, 0xf149f2ca
    v_mov_b32 v32, 0xf149f2ca
    v_mov_b32 v33, 0xf149f2ca
    v_mov_b32 v34, 0xf149f2ca
    v_mov_b32 v35, 0xf149f2ca
    v_mov_b32 v36, 0xf149f2ca
    v_mov_b32 v37, 0xf149f2ca
    v_mov_b32 v38, 0xf149f2ca
    v_mov_b32 v39, 0xf149f2ca
attn1_kernel_a8:
    s_waitcnt lgkmcnt(0)
    s_nop 0
    v_mfma_f32_32x32x16_bf16 v[56:71], v[104:107], v[4:7], v[24:39]
    v_mfma_f32_32x32x16_bf16 v[56:71], v[108:111], v[8:11], v[56:71]
    v_max3_f32 v21, v21, v72, v73
    v_max3_f32 v21, v21, v74, v75
    v_max3_f32 v21, v21, v76, v77
    v_max3_f32 v21, v21, v78, v79
    v_max3_f32 v21, v21, v80, v81
    v_max3_f32 v21, v21, v82, v83
    v_max3_f32 v21, v21, v84, v85
    v_max3_f32 v21, v21, v86, v87
    ds_read_b128 v[112:115], v20 offset:28672
    ds_read_b128 v[116:119], v20 offset:29696
    ds_read_b128 v[120:123], v20 offset:34816
    ds_read_b128 v[124:127], v20 offset:35840
    ds_read_b128 v[128:131], v20 offset:2048
    ds_read_b128 v[132:135], v20 offset:3072
    v_cndmask_b32 v40, v56, v40, s[40:41]
    v_cndmask_b32 v41, v57, v41, s[42:43]
    v_cndmask_b32 v42, v58, v42, s[44:45]
    v_cndmask_b32 v43, v59, v43, s[46:47]
    v_cndmask_b32 v44, v60, v44, s[48:49]
    v_cndmask_b32 v45, v61, v45, s[50:51]
    v_cndmask_b32 v46, v62, v46, s[52:53]
    v_cndmask_b32 v47, v63, v47, s[54:55]
    v_cndmask_b32 v48, v64, v48, s[56:57]
    v_cndmask_b32 v49, v65, v49, s[58:59]
    v_cndmask_b32 v50, v66, v50, s[60:61]
    v_cndmask_b32 v51, v67, v51, s[62:63]
    v_cndmask_b32 v52, v68, v52, s[64:65]
    v_cndmask_b32 v53, v69, v53, s[66:67]
    v_cndmask_b32 v54, v70, v54, s[68:69]
    v_cndmask_b32 v55, v71, v55, s[70:71]
    v_max3_f32 v21, v21, v40, v41
    v_max3_f32 v21, v21, v42, v43
    v_max3_f32 v21, v21, v44, v45
    v_max3_f32 v21, v21, v46, v47
    v_max3_f32 v21, v21, v48, v49
    v_max3_f32 v21, v21, v50, v51
    v_max3_f32 v21, v21, v52, v53
    v_max3_f32 v21, v21, v54, v55
    v_mov_b32 v152, v21
    s_nop 1
    v_permlane32_swap_b32 v21, v152
    v_max_f32 v21, v21, v152
    v_sub_f32 v24, 0, v21
    v_sub_f32 v25, 0, v21
    v_sub_f32 v26, 0, v21
    v_sub_f32 v27, 0, v21
    v_sub_f32 v28, 0, v21
    v_sub_f32 v29, 0, v21
    v_sub_f32 v30, 0, v21
    v_sub_f32 v31, 0, v21
    v_sub_f32 v32, 0, v21
    v_sub_f32 v33, 0, v21
    v_sub_f32 v34, 0, v21
    v_sub_f32 v35, 0, v21
    v_sub_f32 v36, 0, v21
    v_sub_f32 v37, 0, v21
    v_sub_f32 v38, 0, v21
    v_sub_f32 v39, 0, v21
    s_cmp_eq_u32 s37, 0
    s_cbranch_scc0 attn1_kernel_b1
    v_mov_b32 v24, 0xf149f2ca
    v_mov_b32 v25, 0xf149f2ca
    v_mov_b32 v26, 0xf149f2ca
    v_mov_b32 v27, 0xf149f2ca
    v_mov_b32 v28, 0xf149f2ca
    v_mov_b32 v29, 0xf149f2ca
    v_mov_b32 v30, 0xf149f2ca
    v_mov_b32 v31, 0xf149f2ca
    v_mov_b32 v32, 0xf149f2ca
    v_mov_b32 v33, 0xf149f2ca
    v_mov_b32 v34, 0xf149f2ca
    v_mov_b32 v35, 0xf149f2ca
    v_mov_b32 v36, 0xf149f2ca
    v_mov_b32 v37, 0xf149f2ca
    v_mov_b32 v38, 0xf149f2ca
    v_mov_b32 v39, 0xf149f2ca
attn1_kernel_b1:
    s_waitcnt lgkmcnt(4)
    s_nop 0
    v_mfma_f32_32x32x16_bf16 v[72:87], v[112:115], v[4:7], v[24:39]
    v_mfma_f32_32x32x16_bf16 v[72:87], v[116:119], v[8:11], v[72:87]
    ds_read_b128 v[104:107], v20 offset:24576
    ds_read_b128 v[108:111], v20 offset:25600
    v_sub_f32 v40, v40, v21
    v_sub_f32 v41, v41, v21
    v_sub_f32 v42, v42, v21
    v_sub_f32 v43, v43, v21
    v_sub_f32 v44, v44, v21
    v_sub_f32 v45, v45, v21
    v_sub_f32 v46, v46, v21
    v_sub_f32 v47, v47, v21
    v_sub_f32 v48, v48, v21
    v_sub_f32 v49, v49, v21
    v_sub_f32 v50, v50, v21
    v_sub_f32 v51, v51, v21
    v_sub_f32 v52, v52, v21
    v_sub_f32 v53, v53, v21
    v_sub_f32 v54, v54, v21
    v_sub_f32 v55, v55, v21
    v_exp_f32 v40, v40
    v_exp_f32 v41, v41
    v_exp_f32 v42, v42
    v_exp_f32 v43, v43
    v_exp_f32 v44, v44
    v_exp_f32 v45, v45
    v_exp_f32 v46, v46
    v_exp_f32 v47, v47
    v_exp_f32 v48, v48
    v_exp_f32 v49, v49
    v_exp_f32 v50, v50
    v_exp_f32 v51, v51
    v_exp_f32 v52, v52
    v_exp_f32 v53, v53
    v_exp_f32 v54, v54
    v_exp_f32 v55, v55
    v_add_f32 v22, v40, v41
    v_add_f32 v23, v42, v43
    v_add_f32 v22, v22, v44
    v_add_f32 v23, v23, v45
    v_add_f32 v22, v22, v46
    v_add_f32 v23, v23, v47
    v_add_f32 v22, v22, v48
    v_add_f32 v23, v23, v49
    v_add_f32 v22, v22, v50
    v_add_f32 v23, v23, v51
    v_add_f32 v22, v22, v52
    v_add_f32 v23, v23, v53
    v_add_f32 v22, v22, v54
    v_add_f32 v23, v23, v55
    v_cvt_pk_bf16_f32 v144, v40, v41
    v_cvt_pk_bf16_f32 v145, v42, v43
    v_cvt_pk_bf16_f32 v146, v44, v45
    v_cvt_pk_bf16_f32 v147, v46, v47
    v_cvt_pk_bf16_f32 v148, v48, v49
    v_cvt_pk_bf16_f32 v149, v50, v51
    v_cvt_pk_bf16_f32 v150, v52, v53
    v_cvt_pk_bf16_f32 v151, v54, v55
    v_and_b32 v136, v144, v12
    v_and_b32 v137, v145, v13
    v_and_b32 v138, v146, v14
    v_and_b32 v139, v147, v15
    v_and_b32 v140, v148, v16
    v_and_b32 v141, v149, v17
    v_and_b32 v142, v150, v18
    v_and_b32 v143, v151, v19
    v_xor_b32 v144, v144, v136
    v_xor_b32 v145, v145, v137
    v_xor_b32 v146, v146, v138
    v_xor_b32 v147, v147, v139
    v_xor_b32 v148, v148, v140
    v_xor_b32 v149, v149, v141
    v_xor_b32 v150, v150, v142
    v_xor_b32 v151, v151, v143
    s_waitcnt lgkmcnt(2)
    v_mfma_f32_32x32x16_bf16 v[88:103], v[120:123], v[136:139], 0
    v_mfma_f32_32x32x16_bf16 v[88:103], v[124:127], v[140:143], v[88:103]
    v_mfma_f32_32x32x16_bf16 v[88:103], v[128:131], v[144:147], v[88:103]
    v_mfma_f32_32x32x16_bf16 v[88:103], v[132:135], v[148:151], v[88:103]
    ds_read_b128 v[128:131], v20 offset:30720
    ds_read_b128 v[132:135], v20 offset:31744
    s_cmp_eq_u32 s37, 1
    s_cbranch_scc0 attn1_kernel_b2
    v_mov_b32 v24, 0xf149f2ca
    v_mov_b32 v25, 0xf149f2ca
    v_mov_b32 v26, 0xf149f2ca
    v_mov_b32 v27, 0xf149f2ca
    v_mov_b32 v28, 0xf149f2ca
    v_mov_b32 v29, 0xf149f2ca
    v_mov_b32 v30, 0xf149f2ca
    v_mov_b32 v31, 0xf149f2ca
    v_mov_b32 v32, 0xf149f2ca
    v_mov_b32 v33, 0xf149f2ca
    v_mov_b32 v34, 0xf149f2ca
    v_mov_b32 v35, 0xf149f2ca
    v_mov_b32 v36, 0xf149f2ca
    v_mov_b32 v37, 0xf149f2ca
    v_mov_b32 v38, 0xf149f2ca
    v_mov_b32 v39, 0xf149f2ca
attn1_kernel_b2:
    s_waitcnt lgkmcnt(2)
    s_nop 0
    v_mfma_f32_32x32x16_bf16 v[56:71], v[104:107], v[4:7], v[24:39]
    v_mfma_f32_32x32x16_bf16 v[56:71], v[108:111], v[8:11], v[56:71]
    ds_read_b128 v[112:115], v20 offset:20480
    ds_read_b128 v[116:119], v20 offset:21504
    v_exp_f32 v72, v72
    v_exp_f32 v73, v73
    v_exp_f32 v74, v74
    v_exp_f32 v75, v75
    v_exp_f32 v76, v76
    v_exp_f32 v77, v77
    v_exp_f32 v78, v78
    v_exp_f32 v79, v79
    v_exp_f32 v80, v80
    v_exp_f32 v81, v81
    v_exp_f32 v82, v82
    v_exp_f32 v83, v83
    v_exp_f32 v84, v84
    v_exp_f32 v85, v85
    v_exp_f32 v86, v86
    v_exp_f32 v87, v87
    v_add_f32 v22, v22, v72
    v_add_f32 v23, v23, v73
    v_add_f32 v22, v22, v74
    v_add_f32 v23, v23, v75
    v_add_f32 v22, v22, v76
    v_add_f32 v23, v23, v77
    v_add_f32 v22, v22, v78
    v_add_f32 v23, v23, v79
    v_add_f32 v22, v22, v80
    v_add_f32 v23, v23, v81
    v_add_f32 v22, v22, v82
    v_add_f32 v23, v23, v83
    v_add_f32 v22, v22, v84
    v_add_f32 v23, v23, v85
    v_add_f32 v22, v22, v86
    v_add_f32 v23, v23, v87
    v_cvt_pk_bf16_f32 v144, v72, v73
    v_cvt_pk_bf16_f32 v145, v74, v75
    v_cvt_pk_bf16_f32 v146, v76, v77
    v_cvt_pk_bf16_f32 v147, v78, v79
    v_cvt_pk_bf16_f32 v148, v80, v81
    v_cvt_pk_bf16_f32 v149, v82, v83
    v_cvt_pk_bf16_f32 v150, v84, v85
    v_cvt_pk_bf16_f32 v151, v86, v87
    s_waitcnt lgkmcnt(2)
    v_mfma_f32_32x32x16_bf16 v[88:103], v[128:131], v[144:147], v[88:103]
    v_mfma_f32_32x32x16_bf16 v[88:103], v[132:135], v[148:151], v[88:103]
    ds_read_b128 v[120:123], v20 offset:26624
    ds_read_b128 v[124:127], v20 offset:27648
    s_cmp_eq_u32 s37, 2
    s_cbranch_scc0 attn1_kernel_b3
    v_mov_b32 v24, 0xf149f2ca
    v_mov_b32 v25, 0xf149f2ca
    v_mov_b32 v26, 0xf149f2ca
    v_mov_b32 v27, 0xf149f2ca
    v_mov_b32 v28, 0xf149f2ca
    v_mov_b32 v29, 0xf149f2ca
    v_mov_b32 v30, 0xf149f2ca
    v_mov_b32 v31, 0xf149f2ca
    v_mov_b32 v32, 0xf149f2ca
    v_mov_b32 v33, 0xf149f2ca
    v_mov_b32 v34, 0xf149f2ca
    v_mov_b32 v35, 0xf149f2ca
    v_mov_b32 v36, 0xf149f2ca
    v_mov_b32 v37, 0xf149f2ca
    v_mov_b32 v38, 0xf149f2ca
    v_mov_b32 v39, 0xf149f2ca
attn1_kernel_b3:
    s_waitcnt lgkmcnt(2)
    s_nop 0
    v_mfma_f32_32x32x16_bf16 v[72:87], v[112:115], v[4:7], v[24:39]
    v_mfma_f32_32x32x16_bf16 v[72:87], v[116:119], v[8:11], v[72:87]
    ds_read_b128 v[104:107], v20 offset:16384
    ds_read_b128 v[108:111], v20 offset:17408
    v_exp_f32 v56, v56
    v_exp_f32 v57, v57
    v_exp_f32 v58, v58
    v_exp_f32 v59, v59
    v_exp_f32 v60, v60
    v_exp_f32 v61, v61
    v_exp_f32 v62, v62
    v_exp_f32 v63, v63
    v_exp_f32 v64, v64
    v_exp_f32 v65, v65
    v_exp_f32 v66, v66
    v_exp_f32 v67, v67
    v_exp_f32 v68, v68
    v_exp_f32 v69, v69
    v_exp_f32 v70, v70
    v_exp_f32 v71, v71
    v_add_f32 v22, v22, v56
    v_add_f32 v23, v23, v57
    v_add_f32 v22, v22, v58
    v_add_f32 v23, v23, v59
    v_add_f32 v22, v22, v60
    v_add_f32 v23, v23, v61
    v_add_f32 v22, v22, v62
    v_add_f32 v23, v23, v63
    v_add_f32 v22, v22, v64
    v_add_f32 v23, v23, v65
    v_add_f32 v22, v22, v66
    v_add_f32 v23, v23, v67
    v_add_f32 v22, v22, v68
    v_add_f32 v23, v23, v69
    v_add_f32 v22, v22, v70
    v_add_f32 v23, v23, v71
    v_cvt_pk_bf16_f32 v136, v56, v57
    v_cvt_pk_bf16_f32 v137, v58, v59
    v_cvt_pk_bf16_f32 v138, v60, v61
    v_cvt_pk_bf16_f32 v139, v62, v63
    v_cvt_pk_bf16_f32 v140, v64, v65
    v_cvt_pk_bf16_f32 v141, v66, v67
    v_cvt_pk_bf16_f32 v142, v68, v69
    v_cvt_pk_bf16_f32 v143, v70, v71
    s_waitcnt lgkmcnt(2)
    v_mfma_f32_32x32x16_bf16 v[88:103], v[120:123], v[136:139], v[88:103]
    v_mfma_f32_32x32x16_bf16 v[88:103], v[124:127], v[140:143], v[88:103]
    ds_read_b128 v[128:131], v20 offset:22528
    ds_read_b128 v[132:135], v20 offset:23552
    s_cmp_eq_u32 s37, 3
    s_cbranch_scc0 attn1_kernel_b4
    v_mov_b32 v24, 0xf149f2ca
    v_mov_b32 v25, 0xf149f2ca
    v_mov_b32 v26, 0xf149f2ca
    v_mov_b32 v27, 0xf149f2ca
    v_mov_b32 v28, 0xf149f2ca
    v_mov_b32 v29, 0xf149f2ca
    v_mov_b32 v30, 0xf149f2ca
    v_mov_b32 v31, 0xf149f2ca
    v_mov_b32 v32, 0xf149f2ca
    v_mov_b32 v33, 0xf149f2ca
    v_mov_b32 v34, 0xf149f2ca
    v_mov_b32 v35, 0xf149f2ca
    v_mov_b32 v36, 0xf149f2ca
    v_mov_b32 v37, 0xf149f2ca
    v_mov_b32 v38, 0xf149f2ca
    v_mov_b32 v39, 0xf149f2ca
attn1_kernel_b4:
    s_waitcnt lgkmcnt(2)
    s_nop 0
    v_mfma_f32_32x32x16_bf16 v[56:71], v[104:107], v[4:7], v[24:39]
    v_mfma_f32_32x32x16_bf16 v[56:71], v[108:111], v[8:11], v[56:71]
    ds_read_b128 v[112:115], v20 offset:12288
    ds_read_b128 v[116:119], v20 offset:13312
    v_exp_f32 v72, v72
    v_exp_f32 v73, v73
    v_exp_f32 v74, v74
    v_exp_f32 v75, v75
    v_exp_f32 v76, v76
    v_exp_f32 v77, v77
    v_exp_f32 v78, v78
    v_exp_f32 v79, v79
    v_exp_f32 v80, v80
    v_exp_f32 v81, v81
    v_exp_f32 v82, v82
    v_exp_f32 v83, v83
    v_exp_f32 v84, v84
    v_exp_f32 v85, v85
    v_exp_f32 v86, v86
    v_exp_f32 v87, v87
    v_add_f32 v22, v22, v72
    v_add_f32 v23, v23, v73
    v_add_f32 v22, v22, v74
    v_add_f32 v23, v23, v75
    v_add_f32 v22, v22, v76
    v_add_f32 v23, v23, v77
    v_add_f32 v22, v22, v78
    v_add_f32 v23, v23, v79
    v_add_f32 v22, v22, v80
    v_add_f32 v23, v23, v81
    v_add_f32 v22, v22, v82
    v_add_f32 v23, v23, v83
    v_add_f32 v22, v22, v84
    v_add_f32 v23, v23, v85
    v_add_f32 v22, v22, v86
    v_add_f32 v23, v23, v87
    v_cvt_pk_bf16_f32 v144, v72, v73
    v_cvt_pk_bf16_f32 v145, v74, v75
    v_cvt_pk_bf16_f32 v146, v76, v77
    v_cvt_pk_bf16_f32 v147, v78, v79
    v_cvt_pk_bf16_f32 v148, v80, v81
    v_cvt_pk_bf16_f32 v149, v82, v83
    v_cvt_pk_bf16_f32 v150, v84, v85
    v_cvt_pk_bf16_f32 v151, v86, v87
    s_waitcnt lgkmcnt(2)
    v_mfma_f32_32x32x16_bf16 v[88:103], v[128:131], v[144:147], v[88:103]
    v_mfma_f32_32x32x16_bf16 v[88:103], v[132:135], v[148:151], v[88:103]
    ds_read_b128 v[120:123], v20 offset:18432
    ds_read_b128 v[124:127], v20 offset:19456
    s_cmp_eq_u32 s37, 4
    s_cbranch_scc0 attn1_kernel_b5
    v_mov_b32 v24, 0xf149f2ca
    v_mov_b32 v25, 0xf149f2ca
    v_mov_b32 v26, 0xf149f2ca
    v_mov_b32 v27, 0xf149f2ca
    v_mov_b32 v28, 0xf149f2ca
    v_mov_b32 v29, 0xf149f2ca
    v_mov_b32 v30, 0xf149f2ca
    v_mov_b32 v31, 0xf149f2ca
    v_mov_b32 v32, 0xf149f2ca
    v_mov_b32 v33, 0xf149f2ca
    v_mov_b32 v34, 0xf149f2ca
    v_mov_b32 v35, 0xf149f2ca
    v_mov_b32 v36, 0xf149f2ca
    v_mov_b32 v37, 0xf149f2ca
    v_mov_b32 v38, 0xf149f2ca
    v_mov_b32 v39, 0xf149f2ca
attn1_kernel_b5:
    s_waitcnt lgkmcnt(2)
    s_nop 0
    v_mfma_f32_32x32x16_bf16 v[72:87], v[112:115], v[4:7], v[24:39]
    v_mfma_f32_32x32x16_bf16 v[72:87], v[116:119], v[8:11], v[72:87]
    ds_read_b128 v[104:107], v20 offset:8192
    ds_read_b128 v[108:111], v20 offset:9216
    v_exp_f32 v56, v56
    v_exp_f32 v57, v57
    v_exp_f32 v58, v58
    v_exp_f32 v59, v59
    v_exp_f32 v60, v60
    v_exp_f32 v61, v61
    v_exp_f32 v62, v62
    v_exp_f32 v63, v63
    v_exp_f32 v64, v64
    v_exp_f32 v65, v65
    v_exp_f32 v66, v66
    v_exp_f32 v67, v67
    v_exp_f32 v68, v68
    v_exp_f32 v69, v69
    v_exp_f32 v70, v70
    v_exp_f32 v71, v71
    v_add_f32 v22, v22, v56
    v_add_f32 v23, v23, v57
    v_add_f32 v22, v22, v58
    v_add_f32 v23, v23, v59
    v_add_f32 v22, v22, v60
    v_add_f32 v23, v23, v61
    v_add_f32 v22, v22, v62
    v_add_f32 v23, v23, v63
    v_add_f32 v22, v22, v64
    v_add_f32 v23, v23, v65
    v_add_f32 v22, v22, v66
    v_add_f32 v23, v23, v67
    v_add_f32 v22, v22, v68
    v_add_f32 v23, v23, v69
    v_add_f32 v22, v22, v70
    v_add_f32 v23, v23, v71
    v_cvt_pk_bf16_f32 v136, v56, v57
    v_cvt_pk_bf16_f32 v137, v58, v59
    v_cvt_pk_bf16_f32 v138, v60, v61
    v_cvt_pk_bf16_f32 v139, v62, v63
    v_cvt_pk_bf16_f32 v140, v64, v65
    v_cvt_pk_bf16_f32 v141, v66, v67
    v_cvt_pk_bf16_f32 v142, v68, v69
    v_cvt_pk_bf16_f32 v143, v70, v71
    s_waitcnt lgkmcnt(2)
    v_mfma_f32_32x32x16_bf16 v[88:103], v[120:123], v[136:139], v[88:103]
    v_mfma_f32_32x32x16_bf16 v[88:103], v[124:127], v[140:143], v[88:103]
    ds_read_b128 v[128:131], v20 offset:14336
    ds_read_b128 v[132:135], v20 offset:15360
    s_cmp_eq_u32 s37, 5
    s_cbranch_scc0 attn1_kernel_b6
    v_mov_b32 v24, 0xf149f2ca
    v_mov_b32 v25, 0xf149f2ca
    v_mov_b32 v26, 0xf149f2ca
    v_mov_b32 v27, 0xf149f2ca
    v_mov_b32 v28, 0xf149f2ca
    v_mov_b32 v29, 0xf149f2ca
    v_mov_b32 v30, 0xf149f2ca
    v_mov_b32 v31, 0xf149f2ca
    v_mov_b32 v32, 0xf149f2ca
    v_mov_b32 v33, 0xf149f2ca
    v_mov_b32 v34, 0xf149f2ca
    v_mov_b32 v35, 0xf149f2ca
    v_mov_b32 v36, 0xf149f2ca
    v_mov_b32 v37, 0xf149f2ca
    v_mov_b32 v38, 0xf149f2ca
    v_mov_b32 v39, 0xf149f2ca
attn1_kernel_b6:
    s_waitcnt lgkmcnt(2)
    s_nop 0
    v_mfma_f32_32x32x16_bf16 v[56:71], v[104:107], v[4:7], v[24:39]
    v_mfma_f32_32x32x16_bf16 v[56:71], v[108:111], v[8:11], v[56:71]
    ds_read_b128 v[112:115], v20 offset:4096
    ds_read_b128 v[116:119], v20 offset:5120
    v_exp_f32 v72, v72
    v_exp_f32 v73, v73
    v_exp_f32 v74, v74
    v_exp_f32 v75, v75
    v_exp_f32 v76, v76
    v_exp_f32 v77, v77
    v_exp_f32 v78, v78
    v_exp_f32 v79, v79
    v_exp_f32 v80, v80
    v_exp_f32 v81, v81
    v_exp_f32 v82, v82
    v_exp_f32 v83, v83
    v_exp_f32 v84, v84
    v_exp_f32 v85, v85
    v_exp_f32 v86, v86
    v_exp_f32 v87, v87
    v_add_f32 v22, v22, v72
    v_add_f32 v23, v23, v73
    v_add_f32 v22, v22, v74
    v_add_f32 v23, v23, v75
    v_add_f32 v22, v22, v76
    v_add_f32 v23, v23, v77
    v_add_f32 v22, v22, v78
    v_add_f32 v23, v23, v79
    v_add_f32 v22, v22, v80
    v_add_f32 v23, v23, v81
    v_add_f32 v22, v22, v82
    v_add_f32 v23, v23, v83
    v_add_f32 v22, v22, v84
    v_add_f32 v23, v23, v85
    v_add_f32 v22, v22, v86
    v_add_f32 v23, v23, v87
    v_cvt_pk_bf16_f32 v144, v72, v73
    v_cvt_pk_bf16_f32 v145, v74, v75
    v_cvt_pk_bf16_f32 v146, v76, v77
    v_cvt_pk_bf16_f32 v147, v78, v79
    v_cvt_pk_bf16_f32 v148, v80, v81
    v_cvt_pk_bf16_f32 v149, v82, v83
    v_cvt_pk_bf16_f32 v150, v84, v85
    v_cvt_pk_bf16_f32 v151, v86, v87
    s_waitcnt lgkmcnt(2)
    v_mfma_f32_32x32x16_bf16 v[88:103], v[128:131], v[144:147], v[88:103]
    v_mfma_f32_32x32x16_bf16 v[88:103], v[132:135], v[148:151], v[88:103]
    ds_read_b128 v[120:123], v20 offset:10240
    ds_read_b128 v[124:127], v20 offset:11264
    s_cmp_eq_u32 s37, 6
    s_cbranch_scc0 attn1_kernel_b7
    v_mov_b32 v24, 0xf149f2ca
    v_mov_b32 v25, 0xf149f2ca
    v_mov_b32 v26, 0xf149f2ca
    v_mov_b32 v27, 0xf149f2ca
    v_mov_b32 v28, 0xf149f2ca
    v_mov_b32 v29, 0xf149f2ca
    v_mov_b32 v30, 0xf149f2ca
    v_mov_b32 v31, 0xf149f2ca
    v_mov_b32 v32, 0xf149f2ca
    v_mov_b32 v33, 0xf149f2ca
    v_mov_b32 v34, 0xf149f2ca
    v_mov_b32 v35, 0xf149f2ca
    v_mov_b32 v36, 0xf149f2ca
    v_mov_b32 v37, 0xf149f2ca
    v_mov_b32 v38, 0xf149f2ca
    v_mov_b32 v39, 0xf149f2ca
attn1_kernel_b7:
    s_waitcnt lgkmcnt(2)
    s_nop 0
    v_mfma_f32_32x32x16_bf16 v[72:87], v[112:115], v[4:7], v[24:39]
    v_mfma_f32_32x32x16_bf16 v[72:87], v[116:119], v[8:11], v[72:87]
    v_exp_f32 v56, v56
    v_exp_f32 v57, v57
    v_exp_f32 v58, v58
    v_exp_f32 v59, v59
    v_exp_f32 v60, v60
    v_exp_f32 v61, v61
    v_exp_f32 v62, v62
    v_exp_f32 v63, v63
    v_exp_f32 v64, v64
    v_exp_f32 v65, v65
    v_exp_f32 v66, v66
    v_exp_f32 v67, v67
    v_exp_f32 v68, v68
    v_exp_f32 v69, v69
    v_exp_f32 v70, v70
    v_exp_f32 v71, v71
    v_add_f32 v22, v22, v56
    v_add_f32 v23, v23, v57
    v_add_f32 v22, v22, v58
    v_add_f32 v23, v23, v59
    v_add_f32 v22, v22, v60
    v_add_f32 v23, v23, v61
    v_add_f32 v22, v22, v62
    v_add_f32 v23, v23, v63
    v_add_f32 v22, v22, v64
    v_add_f32 v23, v23, v65
    v_add_f32 v22, v22, v66
    v_add_f32 v23, v23, v67
    v_add_f32 v22, v22, v68
    v_add_f32 v23, v23, v69
    v_add_f32 v22, v22, v70
    v_add_f32 v23, v23, v71
    v_cvt_pk_bf16_f32 v136, v56, v57
    v_cvt_pk_bf16_f32 v137, v58, v59
    v_cvt_pk_bf16_f32 v138, v60, v61
    v_cvt_pk_bf16_f32 v139, v62, v63
    v_cvt_pk_bf16_f32 v140, v64, v65
    v_cvt_pk_bf16_f32 v141, v66, v67
    v_cvt_pk_bf16_f32 v142, v68, v69
    v_cvt_pk_bf16_f32 v143, v70, v71
    s_waitcnt lgkmcnt(0)
    v_mfma_f32_32x32x16_bf16 v[88:103], v[120:123], v[136:139], v[88:103]
    v_mfma_f32_32x32x16_bf16 v[88:103], v[124:127], v[140:143], v[88:103]
    ds_read_b128 v[128:131], v20 offset:6144
    ds_read_b128 v[132:135], v20 offset:7168
    v_exp_f32 v72, v72
    v_exp_f32 v73, v73
    v_exp_f32 v74, v74
    v_exp_f32 v75, v75
    v_exp_f32 v76, v76
    v_exp_f32 v77, v77
    v_exp_f32 v78, v78
    v_exp_f32 v79, v79
    v_exp_f32 v80, v80
    v_exp_f32 v81, v81
    v_exp_f32 v82, v82
    v_exp_f32 v83, v83
    v_exp_f32 v84, v84
    v_exp_f32 v85, v85
    v_exp_f32 v86, v86
    v_exp_f32 v87, v87
    v_add_f32 v22, v22, v72
    v_add_f32 v23, v23, v73
    v_add_f32 v22, v22, v74
    v_add_f32 v23, v23, v75
    v_add_f32 v22, v22, v76
    v_add_f32 v23, v23, v77
    v_add_f32 v22, v22, v78
    v_add_f32 v23, v23, v79
    v_add_f32 v22, v22, v80
    v_add_f32 v23, v23, v81
    v_add_f32 v22, v22, v82
    v_add_f32 v23, v23, v83
    v_add_f32 v22, v22, v84
    v_add_f32 v23, v23, v85
    v_add_f32 v22, v22, v86
    v_add_f32 v23, v23, v87
    v_cvt_pk_bf16_f32 v144, v72, v73
    v_cvt_pk_bf16_f32 v145, v74, v75
    v_cvt_pk_bf16_f32 v146, v76, v77
    v_cvt_pk_bf16_f32 v147, v78, v79
    v_cvt_pk_bf16_f32 v148, v80, v81
    v_cvt_pk_bf16_f32 v149, v82, v83
    v_cvt_pk_bf16_f32 v150, v84, v85
    v_cvt_pk_bf16_f32 v151, v86, v87
    s_waitcnt lgkmcnt(0)
    v_mfma_f32_32x32x16_bf16 v[88:103], v[128:131], v[144:147], v[88:103]
    v_mfma_f32_32x32x16_bf16 v[88:103], v[132:135], v[148:151], v[88:103]
    v_add_f32 v22, v22, v23
    v_mov_b32 v152, v22
    s_nop 1
    v_permlane32_swap_b32 v22, v152
    v_add_f32 v22, v22, v152
    v_rcp_f32 v22, v22
    s_lshl_b32 s33, s37, 16
    s_lshl_b32 s34, s30, 11
    s_add_u32 s33, s33, s34
    s_add_u32 s33, s33, 0x2c00000
    s_nop 0
    v_mul_f32 v88, v88, v22
    v_mul_f32 v89, v89, v22
    v_mul_f32 v90, v90, v22
    v_mul_f32 v91, v91, v22
    v_mul_f32 v92, v92, v22
    v_mul_f32 v93, v93, v22
    v_mul_f32 v94, v94, v22
    v_mul_f32 v95, v95, v22
    v_mul_f32 v96, v96, v22
    v_mul_f32 v97, v97, v22
    v_mul_f32 v98, v98, v22
    v_mul_f32 v99, v99, v22
    v_mul_f32 v100, v100, v22
    v_mul_f32 v101, v101, v22
    v_mul_f32 v102, v102, v22
    v_mul_f32 v103, v103, v22
    v_cvt_pk_bf16_f32 v88, v88, v89
    v_cvt_pk_bf16_f32 v89, v90, v91
    v_cvt_pk_bf16_f32 v90, v92, v93
    v_cvt_pk_bf16_f32 v91, v94, v95
    v_cvt_pk_bf16_f32 v92, v96, v97
    v_cvt_pk_bf16_f32 v93, v98, v99
    v_cvt_pk_bf16_f32 v94, v100, v101
    v_cvt_pk_bf16_f32 v95, v102, v103
    buffer_store_dwordx4 v[88:91], v3, s[20:23], s33 offen
    buffer_store_dwordx4 v[92:95], v3, s[20:23], s33 offen offset:1024
attn1_kernel_end:
attn1_kernel_exit:
    s_endpgm
.globl wo1_kernel
.p2align 8
.type wo1_kernel,@function
wo1_kernel:
    s_cmp_ge_u32 s2, 256
    s_cbranch_scc1 wo1_kernel_exit
    s_load_dwordx2 s[4:5], s[0:1], 0
    s_load_dwordx2 s[6:7], s[0:1], 16
    s_load_dwordx2 s[8:9], s[0:1], 80
    s_load_dwordx2 s[10:11], s[0:1], 32
    v_lshrrev_b32 v1, 6, v0
    v_and_b32 v2, 63, v0
    v_readfirstlane_b32 s3, v1
    s_and_b32 s24, s2, 7
    s_lshr_b32 s25, s2, 3
    s_lshl_b32 s26, s24, 1
    s_and_b32 s27, s25, 1
    s_add_u32 s26, s26, s27
    s_lshr_b32 s27, s25, 1
    s_and_b32 s28, s3, 3
    s_lshr_b32 s29, s3, 2
    v_bfe_u32 v4, v2, 3, 2
    v_lshrrev_b32 v5, 5, v2
    v_lshl_add_u32 v4, v5, 3, v4
    s_lshr_b32 s30, s3, 1
    s_lshl_b32 s30, s30, 4
    s_and_b32 s31, s3, 1
    s_lshl_b32 s31, s31, 2
    s_add_u32 s30, s30, s31
    v_add_u32 v4, s30, v4
    v_lshlrev_b32 v4, 11, v4
    v_lshrrev_b32 v6, 2, v2
    v_and_b32 v6, 4, v6
    v_xor_b32 v6, v6, v2
    v_and_b32 v6, 7, v6
    v_lshl_add_u32 v4, v6, 4, v4
    v_lshlrev_b32 v3, 4, v2
    s_waitcnt lgkmcnt(0)
    s_mov_b32 s12, s4
    s_mov_b32 s13, s5
    s_mov_b32 s14, 0x400000
    s_mov_b32 s15, 0x20000
    s_mov_b32 s16, s6
    s_mov_b32 s17, s7
    s_mov_b32 s18, 0x200000
    s_mov_b32 s19, 0x20000
    s_mov_b32 s20, s8
    s_mov_b32 s21, s9
    s_mov_b32 s22, 0x8000000
    s_mov_b32 s23, 0x20000
    s_mov_b32 s40, s10
    s_mov_b32 s41, s11
    s_mov_b32 s42, 0x800
    s_mov_b32 s43, 0x20000
    s_lshl_b32 s30, s27, 7
    s_lshl_b32 s31, s3, 10
    s_mov_b32 m0, s31
    s_nop 0
    buffer_load_dwordx4 v4, s[16:19], s30 offen lds
    s_add_u32 m0, m0, 8192
    s_add_u32 s30, s30, 131072
    buffer_load_dwordx4 v4, s[16:19], s30 offen lds
    s_add_u32 m0, m0, 8192
    s_add_u32 s30, s30, 131072
    buffer_load_dwordx4 v4, s[16:19], s30 offen lds
    s_add_u32 m0, m0, 8192
    s_add_u32 s30, s30, 131072
    buffer_load_dwordx4 v4, s[16:19], s30 offen lds
    s_add_u32 m0, m0, 8192
    s_add_u32 s30, s30, 131072
    buffer_load_dwordx4 v4, s[16:19], s30 offen lds
    s_add_u32 m0, m0, 8192
    s_add_u32 s30, s30, 131072
    buffer_load_dwordx4 v4, s[16:19], s30 offen lds
    s_add_u32 m0, m0, 8192
    s_add_u32 s30, s30, 131072
    buffer_load_dwordx4 v4, s[16:19], s30 offen lds
    s_add_u32 m0, m0, 8192
    s_add_u32 s30, s30, 131072
    buffer_load_dwordx4 v4, s[16:19], s30 offen lds
    s_add_u32 m0, m0, 8192
    s_add_u32 s30, s30, 131072
    buffer_load_dwordx4 v4, s[16:19], s30 offen lds
    s_add_u32 m0, m0, 8192
    s_add_u32 s30, s30, 131072
    buffer_load_dwordx4 v4, s[16:19], s30 offen lds
    s_add_u32 m0, m0, 8192
    s_add_u32 s30, s30, 131072
    buffer_load_dwordx4 v4, s[16:19], s30 offen lds
    s_add_u32 m0, m0, 8192
    s_add_u32 s30, s30, 131072
    buffer_load_dwordx4 v4, s[16:19], s30 offen lds
    s_add_u32 m0, m0, 8192
    s_add_u32 s30, s30, 131072
    buffer_load_dwordx4 v4, s[16:19], s30 offen lds
    s_add_u32 m0, m0, 8192
    s_add_u32 s30, s30, 131072
    buffer_load_dwordx4 v4, s[16:19], s30 offen lds
    s_add_u32 m0, m0, 8192
    s_add_u32 s30, s30, 131072
    buffer_load_dwordx4 v4, s[16:19], s30 offen lds
    s_add_u32 m0, m0, 8192
    s_add_u32 s30, s30, 131072
    buffer_load_dwordx4 v4, s[16:19], s30 offen lds
    v_and_b32 v7, 31, v2
    s_lshl_b32 s32, s26, 2
    s_add_u32 s32, s32, s28
    s_lshl_b32 s33, s27, 7
    s_lshl_b32 s34, s29, 6
    s_add_u32 s33, s33, s34
    v_lshlrev_b32 v8, 3, v5
    buffer_load_dwordx2 v[48:49], v8, s[40:43], s33 offen offset:0
    buffer_load_dwordx2 v[50:51], v8, s[40:43], s33 offen offset:16
    buffer_load_dwordx2 v[52:53], v8, s[40:43], s33 offen offset:32
    buffer_load_dwordx2 v[54:55], v8, s[40:43], s33 offen offset:48
    s_lshl_b32 s35, s26, 4
    s_add_u32 s35, s35, s27
    s_lshl_b32 s35, s35, 14
    s_lshl_b32 s34, s28, 12
    s_add_u32 s35, s35, s34
    s_lshl_b32 s34, s29, 11
    s_add_u32 s35, s35, s34
    s_add_u32 s34, s35, 0x1000000
    buffer_load_dwordx4 v[40:43], v3, s[20:23], s34 offen
    buffer_load_dwordx4 v[44:47], v3, s[20:23], s34 offen offset:1024
    v_lshlrev_b32 v9, 2, v7
    s_lshl_b32 s34, s32, 7
    s_add_u32 s34, s34, 0x3444000
    buffer_load_dword v56, v9, s[20:23], s34 offen
    s_add_u32 s34, s34, 8192
    buffer_load_dword v57, v9, s[20:23], s34 offen
    s_lshl_b32 s36, s32, 16
    s_lshl_b32 s34, s29, 15
    s_add_u32 s36, s36, s34
    s_add_u32 s36, s36, 0x2c00000
    buffer_load_dwordx4 v[64:67], v3, s[20:23], s36 offen offset:0
    buffer_load_dwordx4 v[68:71], v3, s[20:23], s36 offen offset:1024
    buffer_load_dwordx4 v[72:75], v3, s[20:23], s36 offen offset:2048
    buffer_load_dwordx4 v[76:79], v3, s[20:23], s36 offen offset:3072
    s_add_u32 s36, s36, 4096
    buffer_load_dwordx4 v[80:83], v3, s[20:23], s36 offen offset:0
    buffer_load_dwordx4 v[84:87], v3, s[20:23], s36 offen offset:1024
    buffer_load_dwordx4 v[88:91], v3, s[20:23], s36 offen offset:2048
    buffer_load_dwordx4 v[92:95], v3, s[20:23], s36 offen offset:3072
    s_add_u32 s36, s36, 4096
    buffer_load_dwordx4 v[96:99], v3, s[20:23], s36 offen offset:0
    buffer_load_dwordx4 v[100:103], v3, s[20:23], s36 offen offset:1024
    buffer_load_dwordx4 v[104:107], v3, s[20:23], s36 offen offset:2048
    buffer_load_dwordx4 v[108:111], v3, s[20:23], s36 offen offset:3072
    s_add_u32 s36, s36, 4096
    buffer_load_dwordx4 v[112:115], v3, s[20:23], s36 offen offset:0
    buffer_load_dwordx4 v[116:119], v3, s[20:23], s36 offen offset:1024
    buffer_load_dwordx4 v[120:123], v3, s[20:23], s36 offen offset:2048
    buffer_load_dwordx4 v[124:127], v3, s[20:23], s36 offen offset:3072
    s_add_u32 s36, s36, 4096
    buffer_load_dwordx4 v[128:131], v3, s[20:23], s36 offen offset:0
    buffer_load_dwordx4 v[132:135], v3, s[20:23], s36 offen offset:1024
    buffer_load_dwordx4 v[136:139], v3, s[20:23], s36 offen offset:2048
    buffer_load_dwordx4 v[140:143], v3, s[20:23], s36 offen offset:3072
    s_add_u32 s36, s36, 4096
    buffer_load_dwordx4 v[144:147], v3, s[20:23], s36 offen offset:0
    buffer_load_dwordx4 v[148:151], v3, s[20:23], s36 offen offset:1024
    buffer_load_dwordx4 v[152:155], v3, s[20:23], s36 offen offset:2048
    buffer_load_dwordx4 v[156:159], v3, s[20:23], s36 offen offset:3072
    s_add_u32 s36, s36, 4096
    buffer_load_dwordx4 v[160:163], v3, s[20:23], s36 offen offset:0
    buffer_load_dwordx4 v[164:167], v3, s[20:23], s36 offen offset:1024
    buffer_load_dwordx4 v[168:171], v3, s[20:23], s36 offen offset:2048
    buffer_load_dwordx4 v[172:175], v3, s[20:23], s36 offen offset:3072
    s_add_u32 s36, s36, 4096
    buffer_load_dwordx4 v[176:179], v3, s[20:23], s36 offen offset:0
    buffer_load_dwordx4 v[180:183], v3, s[20:23], s36 offen offset:1024
    buffer_load_dwordx4 v[184:187], v3, s[20:23], s36 offen offset:2048
    buffer_load_dwordx4 v[188:191], v3, s[20:23], s36 offen offset:3072
    v_bfe_u32 v10, v2, 2, 2
    v_lshl_add_u32 v11, v5, 3, v10
    v_lshlrev_b32 v11, 7, v11
    v_lshrrev_b32 v10, 1, v10
    v_xor_b32 v10, s29, v10
    v_lshl_add_u32 v11, v10, 6, v11
    v_bfe_u32 v10, v2, 4, 1
    v_lshl_add_u32 v11, v10, 5, v11
    v_and_b32 v10, 3, v2
    v_lshl_add_u32 v11, v10, 3, v11
    s_lshl_b32 s34, s29, 16
    v_add_u32 v58, s34, v11
    v_xor_b32 v59, 64, v58
    v_mov_b32 v60, v7
    v_mov_b32 v61, v5
    v_mov_b32 v62, v3
    s_waitcnt vmcnt(40)
    s_barrier
    ds_read_b64_tr_b16 v[192:193], v58 offset:0
    ds_read_b64_tr_b16 v[194:195], v58 offset:512
    ds_read_b64_tr_b16 v[196:197], v59 offset:0
    ds_read_b64_tr_b16 v[198:199], v59 offset:512
    ds_read_b64_tr_b16 v[200:201], v58 offset:2048
    ds_read_b64_tr_b16 v[202:203], v58 offset:2560
    ds_read_b64_tr_b16 v[204:205], v59 offset:2048
    ds_read_b64_tr_b16 v[206:207], v59 offset:2560
    ds_read_b64_tr_b16 v[208:209], v58 offset:4096
    ds_read_b64_tr_b16 v[210:211], v58 offset:4608
    ds_read_b64_tr_b16 v[212:213], v59 offset:4096
    ds_read_b64_tr_b16 v[214:215], v59 offset:4608
    s_waitcnt vmcnt(31) lgkmcnt(8)
    v_mfma_f32_32x32x16_bf16 v[0:15], v[192:195], v[64:67], 0
    v_mfma_f32_32x32x16_bf16 v[16:31], v[196:199], v[64:67], 0
    ds_read_b64_tr_b16 v[192:193], v58 offset:6144
    ds_read_b64_tr_b16 v[194:195], v58 offset:6656
    ds_read_b64_tr_b16 v[196:197], v59 offset:6144
    ds_read_b64_tr_b16 v[198:199], v59 offset:6656
    s_waitcnt vmcnt(30) lgkmcnt(8)
    v_mfma_f32_32x32x16_bf16 v[0:15], v[200:203], v[68:71], v[0:15]
    v_mfma_f32_32x32x16_bf16 v[16:31], v[204:207], v[68:71], v[16:31]
    ds_read_b64_tr_b16 v[200:201], v58 offset:8192
    ds_read_b64_tr_b16 v[202:203], v58 offset:8704
    ds_read_b64_tr_b16 v[204:205], v59 offset:8192
    ds_read_b64_tr_b16 v[206:207], v59 offset:8704
    s_waitcnt vmcnt(29) lgkmcnt(8)
    v_mfma_f32_32x32x16_bf16 v[0:15], v[208:211], v[72:75], v[0:15]
    v_mfma_f32_32x32x16_bf16 v[16:31], v[212:215], v[72:75], v[16:31]
    ds_read_b64_tr_b16 v[208:209], v58 offset:10240
    ds_read_b64_tr_b16 v[210:211], v58 offset:10752
    ds_read_b64_tr_b16 v[212:213], v59 offset:10240
    ds_read_b64_tr_b16 v[214:215], v59 offset:10752
    s_waitcnt vmcnt(28) lgkmcnt(8)
    v_mfma_f32_32x32x16_bf16 v[0:15], v[192:195], v[76:79], v[0:15]
    v_mfma_f32_32x32x16_bf16 v[16:31], v[196:199], v[76:79], v[16:31]
    ds_read_b64_tr_b16 v[192:193], v58 offset:12288
    ds_read_b64_tr_b16 v[194:195], v58 offset:12800
    ds_read_b64_tr_b16 v[196:197], v59 offset:12288
    ds_read_b64_tr_b16 v[198:199], v59 offset:12800
    s_waitcnt vmcnt(27) lgkmcnt(8)
    v_mfma_f32_32x32x16_bf16 v[0:15], v[200:203], v[80:83], v[0:15]
    v_mfma_f32_32x32x16_bf16 v[16:31], v[204:207], v[80:83], v[16:31]
    ds_read_b64_tr_b16 v[200:201], v58 offset:14336
    ds_read_b64_tr_b16 v[202:203], v58 offset:14848
    ds_read_b64_tr_b16 v[204:205], v59 offset:14336
    ds_read_b64_tr_b16 v[206:207], v59 offset:14848
    s_waitcnt vmcnt(26) lgkmcnt(8)
    v_mfma_f32_32x32x16_bf16 v[0:15], v[208:211], v[84:87], v[0:15]
    v_mfma_f32_32x32x16_bf16 v[16:31], v[212:215], v[84:87], v[16:31]
    ds_read_b64_tr_b16 v[208:209], v58 offset:16384
    ds_read_b64_tr_b16 v[210:211], v58 offset:16896
    ds_read_b64_tr_b16 v[212:213], v59 offset:16384
    ds_read_b64_tr_b16 v[214:215], v59 offset:16896
    s_waitcnt vmcnt(25) lgkmcnt(8)
    v_mfma_f32_32x32x16_bf16 v[0:15], v[192:195], v[88:91], v[0:15]
    v_mfma_f32_32x32x16_bf16 v[16:31], v[196:199], v[88:91], v[16:31]
    ds_read_b64_tr_b16 v[192:193], v58 offset:18432
    ds_read_b64_tr_b16 v[194:195], v58 offset:18944
    ds_read_b64_tr_b16 v[196:197], v59 offset:18432
    ds_read_b64_tr_b16 v[198:199], v59 offset:18944
    s_waitcnt vmcnt(24) lgkmcnt(8)
    v_mfma_f32_32x32x16_bf16 v[0:15], v[200:203], v[92:95], v[0:15]
    v_mfma_f32_32x32x16_bf16 v[16:31], v[204:207], v[92:95], v[16:31]
    ds_read_b64_tr_b16 v[200:201], v58 offset:20480
    ds_read_b64_tr_b16 v[202:203], v58 offset:20992
    ds_read_b64_tr_b16 v[204:205], v59 offset:20480
    ds_read_b64_tr_b16 v[206:207], v59 offset:20992
    s_waitcnt vmcnt(23) lgkmcnt(8)
    v_mfma_f32_32x32x16_bf16 v[0:15], v[208:211], v[96:99], v[0:15]
    v_mfma_f32_32x32x16_bf16 v[16:31], v[212:215], v[96:99], v[16:31]
    ds_read_b64_tr_b16 v[208:209], v58 offset:22528
    ds_read_b64_tr_b16 v[210:211], v58 offset:23040
    ds_read_b64_tr_b16 v[212:213], v59 offset:22528
    ds_read_b64_tr_b16 v[214:215], v59 offset:23040
    s_waitcnt vmcnt(22) lgkmcnt(8)
    v_mfma_f32_32x32x16_bf16 v[0:15], v[192:195], v[100:103], v[0:15]
    v_mfma_f32_32x32x16_bf16 v[16:31], v[196:199], v[100:103], v[16:31]
    ds_read_b64_tr_b16 v[192:193], v58 offset:24576
    ds_read_b64_tr_b16 v[194:195], v58 offset:25088
    ds_read_b64_tr_b16 v[196:197], v59 offset:24576
    ds_read_b64_tr_b16 v[198:199], v59 offset:25088
    s_waitcnt vmcnt(21) lgkmcnt(8)
    v_mfma_f32_32x32x16_bf16 v[0:15], v[200:203], v[104:107], v[0:15]
    v_mfma_f32_32x32x16_bf16 v[16:31], v[204:207], v[104:107], v[16:31]
    ds_read_b64_tr_b16 v[200:201], v58 offset:26624
    ds_read_b64_tr_b16 v[202:203], v58 offset:27136
    ds_read_b64_tr_b16 v[204:205], v59 offset:26624
    ds_read_b64_tr_b16 v[206:207], v59 offset:27136
    s_waitcnt vmcnt(20) lgkmcnt(8)
    v_mfma_f32_32x32x16_bf16 v[0:15], v[208:211], v[108:111], v[0:15]
    v_mfma_f32_32x32x16_bf16 v[16:31], v[212:215], v[108:111], v[16:31]
    ds_read_b64_tr_b16 v[208:209], v58 offset:28672
    ds_read_b64_tr_b16 v[210:211], v58 offset:29184
    ds_read_b64_tr_b16 v[212:213], v59 offset:28672
    ds_read_b64_tr_b16 v[214:215], v59 offset:29184
    s_waitcnt vmcnt(19) lgkmcnt(8)
    v_mfma_f32_32x32x16_bf16 v[0:15], v[192:195], v[112:115], v[0:15]
    v_mfma_f32_32x32x16_bf16 v[16:31], v[196:199], v[112:115], v[16:31]
    ds_read_b64_tr_b16 v[192:193], v58 offset:30720
    ds_read_b64_tr_b16 v[194:195], v58 offset:31232
    ds_read_b64_tr_b16 v[196:197], v59 offset:30720
    ds_read_b64_tr_b16 v[198:199], v59 offset:31232
    s_waitcnt vmcnt(18) lgkmcnt(8)
    v_mfma_f32_32x32x16_bf16 v[0:15], v[200:203], v[116:119], v[0:15]
    v_mfma_f32_32x32x16_bf16 v[16:31], v[204:207], v[116:119], v[16:31]
    ds_read_b64_tr_b16 v[200:201], v58 offset:32768
    ds_read_b64_tr_b16 v[202:203], v58 offset:33280
    ds_read_b64_tr_b16 v[204:205], v59 offset:32768
    ds_read_b64_tr_b16 v[206:207], v59 offset:33280
    s_waitcnt vmcnt(17) lgkmcnt(8)
    v_mfma_f32_32x32x16_bf16 v[0:15], v[208:211], v[120:123], v[0:15]
    v_mfma_f32_32x32x16_bf16 v[16:31], v[212:215], v[120:123], v[16:31]
    ds_read_b64_tr_b16 v[208:209], v58 offset:34816
    ds_read_b64_tr_b16 v[210:211], v58 offset:35328
    ds_read_b64_tr_b16 v[212:213], v59 offset:34816
    ds_read_b64_tr_b16 v[214:215], v59 offset:35328
    s_waitcnt vmcnt(16) lgkmcnt(8)
    v_mfma_f32_32x32x16_bf16 v[0:15], v[192:195], v[124:127], v[0:15]
    v_mfma_f32_32x32x16_bf16 v[16:31], v[196:199], v[124:127], v[16:31]
    ds_read_b64_tr_b16 v[192:193], v58 offset:36864
    ds_read_b64_tr_b16 v[194:195], v58 offset:37376
    ds_read_b64_tr_b16 v[196:197], v59 offset:36864
    ds_read_b64_tr_b16 v[198:199], v59 offset:37376
    s_waitcnt vmcnt(15) lgkmcnt(8)
    v_mfma_f32_32x32x16_bf16 v[0:15], v[200:203], v[128:131], v[0:15]
    v_mfma_f32_32x32x16_bf16 v[16:31], v[204:207], v[128:131], v[16:31]
    ds_read_b64_tr_b16 v[200:201], v58 offset:38912
    ds_read_b64_tr_b16 v[202:203], v58 offset:39424
    ds_read_b64_tr_b16 v[204:205], v59 offset:38912
    ds_read_b64_tr_b16 v[206:207], v59 offset:39424
    s_waitcnt vmcnt(14) lgkmcnt(8)
    v_mfma_f32_32x32x16_bf16 v[0:15], v[208:211], v[132:135], v[0:15]
    v_mfma_f32_32x32x16_bf16 v[16:31], v[212:215], v[132:135], v[16:31]
    ds_read_b64_tr_b16 v[208:209], v58 offset:40960
    ds_read_b64_tr_b16 v[210:211], v58 offset:41472
    ds_read_b64_tr_b16 v[212:213], v59 offset:40960
    ds_read_b64_tr_b16 v[214:215], v59 offset:41472
    s_waitcnt vmcnt(13) lgkmcnt(8)
    v_mfma_f32_32x32x16_bf16 v[0:15], v[192:195], v[136:139], v[0:15]
    v_mfma_f32_32x32x16_bf16 v[16:31], v[196:199], v[136:139], v[16:31]
    ds_read_b64_tr_b16 v[192:193], v58 offset:43008
    ds_read_b64_tr_b16 v[194:195], v58 offset:43520
    ds_read_b64_tr_b16 v[196:197], v59 offset:43008
    ds_read_b64_tr_b16 v[198:199], v59 offset:43520
    s_waitcnt vmcnt(12) lgkmcnt(8)
    v_mfma_f32_32x32x16_bf16 v[0:15], v[200:203], v[140:143], v[0:15]
    v_mfma_f32_32x32x16_bf16 v[16:31], v[204:207], v[140:143], v[16:31]
    ds_read_b64_tr_b16 v[200:201], v58 offset:45056
    ds_read_b64_tr_b16 v[202:203], v58 offset:45568
    ds_read_b64_tr_b16 v[204:205], v59 offset:45056
    ds_read_b64_tr_b16 v[206:207], v59 offset:45568
    s_waitcnt vmcnt(11) lgkmcnt(8)
    v_mfma_f32_32x32x16_bf16 v[0:15], v[208:211], v[144:147], v[0:15]
    v_mfma_f32_32x32x16_bf16 v[16:31], v[212:215], v[144:147], v[16:31]
    ds_read_b64_tr_b16 v[208:209], v58 offset:47104
    ds_read_b64_tr_b16 v[210:211], v58 offset:47616
    ds_read_b64_tr_b16 v[212:213], v59 offset:47104
    ds_read_b64_tr_b16 v[214:215], v59 offset:47616
    s_waitcnt vmcnt(10) lgkmcnt(8)
    v_mfma_f32_32x32x16_bf16 v[0:15], v[192:195], v[148:151], v[0:15]
    v_mfma_f32_32x32x16_bf16 v[16:31], v[196:199], v[148:151], v[16:31]
    ds_read_b64_tr_b16 v[192:193], v58 offset:49152
    ds_read_b64_tr_b16 v[194:195], v58 offset:49664
    ds_read_b64_tr_b16 v[196:197], v59 offset:49152
    ds_read_b64_tr_b16 v[198:199], v59 offset:49664
    s_waitcnt vmcnt(9) lgkmcnt(8)
    v_mfma_f32_32x32x16_bf16 v[0:15], v[200:203], v[152:155], v[0:15]
    v_mfma_f32_32x32x16_bf16 v[16:31], v[204:207], v[152:155], v[16:31]
    ds_read_b64_tr_b16 v[200:201], v58 offset:51200
    ds_read_b64_tr_b16 v[202:203], v58 offset:51712
    ds_read_b64_tr_b16 v[204:205], v59 offset:51200
    ds_read_b64_tr_b16 v[206:207], v59 offset:51712
    s_waitcnt vmcnt(8) lgkmcnt(8)
    v_mfma_f32_32x32x16_bf16 v[0:15], v[208:211], v[156:159], v[0:15]
    v_mfma_f32_32x32x16_bf16 v[16:31], v[212:215], v[156:159], v[16:31]
    ds_read_b64_tr_b16 v[208:209], v58 offset:53248
    ds_read_b64_tr_b16 v[210:211], v58 offset:53760
    ds_read_b64_tr_b16 v[212:213], v59 offset:53248
    ds_read_b64_tr_b16 v[214:215], v59 offset:53760
    s_waitcnt vmcnt(7) lgkmcnt(8)
    v_mfma_f32_32x32x16_bf16 v[0:15], v[192:195], v[160:163], v[0:15]
    v_mfma_f32_32x32x16_bf16 v[16:31], v[196:199], v[160:163], v[16:31]
    ds_read_b64_tr_b16 v[192:193], v58 offset:55296
    ds_read_b64_tr_b16 v[194:195], v58 offset:55808
    ds_read_b64_tr_b16 v[196:197], v59 offset:55296
    ds_read_b64_tr_b16 v[198:199], v59 offset:55808
    s_waitcnt vmcnt(6) lgkmcnt(8)
    v_mfma_f32_32x32x16_bf16 v[0:15], v[200:203], v[164:167], v[0:15]
    v_mfma_f32_32x32x16_bf16 v[16:31], v[204:207], v[164:167], v[16:31]
    ds_read_b64_tr_b16 v[200:201], v58 offset:57344
    ds_read_b64_tr_b16 v[202:203], v58 offset:57856
    ds_read_b64_tr_b16 v[204:205], v59 offset:57344
    ds_read_b64_tr_b16 v[206:207], v59 offset:57856
    s_waitcnt vmcnt(5) lgkmcnt(8)
    v_mfma_f32_32x32x16_bf16 v[0:15], v[208:211], v[168:171], v[0:15]
    v_mfma_f32_32x32x16_bf16 v[16:31], v[212:215], v[168:171], v[16:31]
    ds_read_b64_tr_b16 v[208:209], v58 offset:59392
    ds_read_b64_tr_b16 v[210:211], v58 offset:59904
    ds_read_b64_tr_b16 v[212:213], v59 offset:59392
    ds_read_b64_tr_b16 v[214:215], v59 offset:59904
    s_waitcnt vmcnt(4) lgkmcnt(8)
    v_mfma_f32_32x32x16_bf16 v[0:15], v[192:195], v[172:175], v[0:15]
    v_mfma_f32_32x32x16_bf16 v[16:31], v[196:199], v[172:175], v[16:31]
    ds_read_b64_tr_b16 v[192:193], v58 offset:61440
    ds_read_b64_tr_b16 v[194:195], v58 offset:61952
    ds_read_b64_tr_b16 v[196:197], v59 offset:61440
    ds_read_b64_tr_b16 v[198:199], v59 offset:61952
    s_waitcnt vmcnt(3) lgkmcnt(8)
    v_mfma_f32_32x32x16_bf16 v[0:15], v[200:203], v[176:179], v[0:15]
    v_mfma_f32_32x32x16_bf16 v[16:31], v[204:207], v[176:179], v[16:31]
    ds_read_b64_tr_b16 v[200:201], v58 offset:63488
    ds_read_b64_tr_b16 v[202:203], v58 offset:64000
    ds_read_b64_tr_b16 v[204:205], v59 offset:63488
    ds_read_b64_tr_b16 v[206:207], v59 offset:64000
    s_waitcnt vmcnt(2) lgkmcnt(8)
    v_mfma_f32_32x32x16_bf16 v[0:15], v[208:211], v[180:183], v[0:15]
    v_mfma_f32_32x32x16_bf16 v[16:31], v[212:215], v[180:183], v[16:31]
    s_waitcnt vmcnt(1) lgkmcnt(4)
    v_mfma_f32_32x32x16_bf16 v[0:15], v[192:195], v[184:187], v[0:15]
    v_mfma_f32_32x32x16_bf16 v[16:31], v[196:199], v[184:187], v[16:31]
    s_waitcnt vmcnt(0) lgkmcnt(0)
    v_mfma_f32_32x32x16_bf16 v[0:15], v[200:203], v[188:191], v[0:15]
    v_mfma_f32_32x32x16_bf16 v[16:31], v[204:207], v[188:191], v[16:31]
    s_lshl_b32 s34, s3, 12
    s_add_u32 s34, s34, 131072
    v_add_u32 v63, s34, v62
    s_nop 8
    ds_write_b128 v63, v[16:19] offset:0
    ds_write_b128 v63, v[20:23] offset:1024
    ds_write_b128 v63, v[24:27] offset:2048
    ds_write_b128 v63, v[28:31] offset:3072
    v_xor_b32 v63, 16384, v63
    v_lshlrev_b32 v64, 16, v40
    v_and_b32 v65, 0xffff0000, v40
    v_lshlrev_b32 v80, 16, v48
    v_and_b32 v81, 0xffff0000, v48
    v_lshlrev_b32 v66, 16, v41
    v_and_b32 v67, 0xffff0000, v41
    v_lshlrev_b32 v82, 16, v49
    v_and_b32 v83, 0xffff0000, v49
    v_lshlrev_b32 v68, 16, v42
    v_and_b32 v69, 0xffff0000, v42
    v_lshlrev_b32 v84, 16, v50
    v_and_b32 v85, 0xffff0000, v50
    v_lshlrev_b32 v70, 16, v43
    v_and_b32 v71, 0xffff0000, v43
    v_lshlrev_b32 v86, 16, v51
    v_and_b32 v87, 0xffff0000, v51
    v_lshlrev_b32 v72, 16, v44
    v_and_b32 v73, 0xffff0000, v44
    v_lshlrev_b32 v88, 16, v52
    v_and_b32 v89, 0xffff0000, v52
    v_lshlrev_b32 v74, 16, v45
    v_and_b32 v75, 0xffff0000, v45
    v_lshlrev_b32 v90, 16, v53
    v_and_b32 v91, 0xffff0000, v53
    v_lshlrev_b32 v76, 16, v46
    v_and_b32 v77, 0xffff0000, v46
    v_lshlrev_b32 v92, 16, v54
    v_and_b32 v93, 0xffff0000, v54
    v_lshlrev_b32 v78, 16, v47
    v_and_b32 v79, 0xffff0000, v47
    v_lshlrev_b32 v94, 16, v55
    v_and_b32 v95, 0xffff0000, v55
    v_fma_f32 v64, v64, v56, v57
    v_fma_f32 v65, v65, v56, v57
    v_fma_f32 v66, v66, v56, v57
    v_fma_f32 v67, v67, v56, v57
    v_fma_f32 v68, v68, v56, v57
    v_fma_f32 v69, v69, v56, v57
    v_fma_f32 v70, v70, v56, v57
    v_fma_f32 v71, v71, v56, v57
    v_fma_f32 v72, v72, v56, v57
    v_fma_f32 v73, v73, v56, v57
    v_fma_f32 v74, v74, v56, v57
    v_fma_f32 v75, v75, v56, v57
    v_fma_f32 v76, v76, v56, v57
    v_fma_f32 v77, v77, v56, v57
    v_fma_f32 v78, v78, v56, v57
    v_fma_f32 v79, v79, v56, v57
    v_add_f32 v0, v0, v64
    v_add_f32 v1, v1, v65
    v_add_f32 v2, v2, v66
    v_add_f32 v3, v3, v67
    v_add_f32 v4, v4, v68
    v_add_f32 v5, v5, v69
    v_add_f32 v6, v6, v70
    v_add_f32 v7, v7, v71
    v_add_f32 v8, v8, v72
    v_add_f32 v9, v9, v73
    v_add_f32 v10, v10, v74
    v_add_f32 v11, v11, v75
    v_add_f32 v12, v12, v76
    v_add_f32 v13, v13, v77
    v_add_f32 v14, v14, v78
    v_add_f32 v15, v15, v79
    s_waitcnt lgkmcnt(0)
    s_barrier
    ds_read_b128 v[16:19], v63 offset:0
    ds_read_b128 v[20:23], v63 offset:1024
    ds_read_b128 v[24:27], v63 offset:2048
    ds_read_b128 v[28:31], v63 offset:3072
    s_waitcnt lgkmcnt(0)
    v_add_f32 v0, v0, v16
    v_add_f32 v1, v1, v17
    v_add_f32 v2, v2, v18
    v_add_f32 v3, v3, v19
    v_add_f32 v4, v4, v20
    v_add_f32 v5, v5, v21
    v_add_f32 v6, v6, v22
    v_add_f32 v7, v7, v23
    v_add_f32 v8, v8, v24
    v_add_f32 v9, v9, v25
    v_add_f32 v10, v10, v26
    v_add_f32 v11, v11, v27
    v_add_f32 v12, v12, v28
    v_add_f32 v13, v13, v29
    v_add_f32 v14, v14, v30
    v_add_f32 v15, v15, v31
    v_cvt_pk_bf16_f32 v32, v0, v1
    v_cvt_pk_bf16_f32 v33, v2, v3
    v_cvt_pk_bf16_f32 v34, v4, v5
    v_cvt_pk_bf16_f32 v35, v6, v7
    v_cvt_pk_bf16_f32 v36, v8, v9
    v_cvt_pk_bf16_f32 v37, v10, v11
    v_cvt_pk_bf16_f32 v38, v12, v13
    v_cvt_pk_bf16_f32 v39, v14, v15
    s_add_u32 s34, s35, 0x3000000
    buffer_store_dwordx4 v[32:35], v62, s[20:23], s34 offen
    buffer_store_dwordx4 v[36:39], v62, s[20:23], s34 offen offset:1024
    v_add_f32 v40, v0, v1
    v_mul_f32 v41, v0, v0
    v_mul_f32 v42, v0, v80
    v_fmac_f32 v41, v1, v1
    v_fmac_f32 v42, v1, v81
    v_add_f32 v40, v40, v2
    v_fmac_f32 v41, v2, v2
    v_fmac_f32 v42, v2, v82
    v_add_f32 v40, v40, v3
    v_fmac_f32 v41, v3, v3
    v_fmac_f32 v42, v3, v83
    v_add_f32 v40, v40, v4
    v_fmac_f32 v41, v4, v4
    v_fmac_f32 v42, v4, v84
    v_add_f32 v40, v40, v5
    v_fmac_f32 v41, v5, v5
    v_fmac_f32 v42, v5, v85
    v_add_f32 v40, v40, v6
    v_fmac_f32 v41, v6, v6
    v_fmac_f32 v42, v6, v86
    v_add_f32 v40, v40, v7
    v_fmac_f32 v41, v7, v7
    v_fmac_f32 v42, v7, v87
    v_add_f32 v40, v40, v8
    v_fmac_f32 v41, v8, v8
    v_fmac_f32 v42, v8, v88
    v_add_f32 v40, v40, v9
    v_fmac_f32 v41, v9, v9
    v_fmac_f32 v42, v9, v89
    v_add_f32 v40, v40, v10
    v_fmac_f32 v41, v10, v10
    v_fmac_f32 v42, v10, v90
    v_add_f32 v40, v40, v11
    v_fmac_f32 v41, v11, v11
    v_fmac_f32 v42, v11, v91
    v_add_f32 v40, v40, v12
    v_fmac_f32 v41, v12, v12
    v_fmac_f32 v42, v12, v92
    v_add_f32 v40, v40, v13
    v_fmac_f32 v41, v13, v13
    v_fmac_f32 v42, v13, v93
    v_add_f32 v40, v40, v14
    v_fmac_f32 v41, v14, v14
    v_fmac_f32 v42, v14, v94
    v_add_f32 v40, v40, v15
    v_fmac_f32 v41, v15, v15
    v_fmac_f32 v42, v15, v95
    v_mov_b32 v43, v42
    v_permlane32_swap_b32 v40, v41
    s_nop 0
    v_permlane32_swap_b32 v42, v43
    v_add_f32 v40, v40, v41
    v_add_f32 v42, v42, v43
    v_lshlrev_b32 v44, 2, v60
    v_lshl_add_u32 v45, v61, 13, v44
    s_lshl_b32 s34, s32, 7
    s_add_u32 s34, s34, 0x3400000
    buffer_atomic_add_f32 v40, v45, s[20:23], s34 offen sc1
    s_add_u32 s34, s34, 16384
    s_mov_b64 exec, 0xffffffff
    buffer_atomic_add_f32 v42, v44, s[20:23], s34 offen sc1
wo1_kernel_end:
wo1_kernel_exit:
    s_endpgm
.globl ffn1_kernel
.p2align 8
.type ffn1_kernel,@function
ffn1_kernel:
    s_cmp_ge_u32 s2, 256
    s_cbranch_scc1 ffn1_kernel_exit
    s_load_dwordx4 s[4:7], s[0:1], 32
    s_load_dwordx4 s[8:11], s[0:1], 48
    s_load_dwordx2 s[44:45], s[0:1], 64
    s_load_dwordx2 s[46:47], s[0:1], 80
    v_lshrrev_b32 v1, 6, v0
    v_and_b32 v2, 63, v0
    v_readfirstlane_b32 s3, v1
    s_and_b32 s24, s2, 7
    s_lshr_b32 s25, s2, 3
    s_mul_i32 s26, s24, 28
    s_add_u32 s26, s26, s25
    s_waitcnt lgkmcnt(0)
    s_mov_b32 s12, s4
    s_mov_b32 s13, s5
    s_mov_b32 s14, 0x800
    s_mov_b32 s15, 0x20000
    s_mov_b32 s20, s46
    s_mov_b32 s21, s47
    s_mov_b32 s22, 0x8000000
    s_mov_b32 s23, 0x20000
    s_mov_b32 s28, s10
    s_mov_b32 s29, s11
    s_mov_b32 s30, 0x700000
    s_mov_b32 s31, 0x20000
    s_cmp_lt_u32 s3, 4
    s_cselect_b32 s16, s6, s8
    s_cselect_b32 s17, s7, s9
    s_mov_b32 s18, 7340032
    s_mov_b32 s19, 0x20000
    v_lshlrev_b32 v3, 4, v0
    s_mov_b32 s27, 0x3400000
    buffer_load_dwordx4 v[8:11], v3, s[20:23], s27 offen
    s_add_u32 s27, s27, 8192
    buffer_load_dwordx4 v[12:15], v3, s[20:23], s27 offen
    s_add_u32 s27, s27, 8192
    buffer_load_dwordx4 v[16:19], v3, s[20:23], s27 offen
    v_lshlrev_b32 v4, 5, v2
    buffer_load_dwordx4 v[20:23], v4, s[12:15], 0 offen
    buffer_load_dwordx4 v[24:27], v4, s[12:15], 0 offen offset:16
    s_mov_b32 s48, s44
    s_mov_b32 s49, s45
    s_mov_b32 s50, 0x400000
    s_mov_b32 s51, 0x20000
    s_lshl_b32 s27, s2, 14
    s_add_u32 s27, s27, 0x3000000
    buffer_load_dwordx4 v[100:103], v3, s[20:23], s27 offen
    s_add_u32 s27, s27, 8192
    buffer_load_dwordx4 v[104:107], v3, s[20:23], s27 offen
    s_cmp_lt_u32 s25, 28
    s_cselect_b32 s33, 0, 0x10000000
    v_lshrrev_b32 v5, 1, v2
    v_mul_u32_u24 v5, 7168, v5
    v_and_b32 v6, 1, v2
    v_lshl_add_u32 v5, v6, 4, v5
    v_add_u32 v5, s33, v5
    s_and_b32 s34, s3, 3
    s_mul_i32 s34, s34, 1835008
    s_lshl_b32 s35, s26, 5
    s_add_u32 s34, s34, s35
    buffer_load_dwordx4 v[32:35], v5, s[16:19], s34 offen
    s_add_u32 s34, s34, 229376
    buffer_load_dwordx4 v[36:39], v5, s[16:19], s34 offen
    s_add_u32 s34, s34, 229376
    buffer_load_dwordx4 v[40:43], v5, s[16:19], s34 offen
    s_add_u32 s34, s34, 229376
    buffer_load_dwordx4 v[44:47], v5, s[16:19], s34 offen
    s_add_u32 s34, s34, 229376
    buffer_load_dwordx4 v[48:51], v5, s[16:19], s34 offen
    s_add_u32 s34, s34, 229376
    buffer_load_dwordx4 v[52:55], v5, s[16:19], s34 offen
    s_add_u32 s34, s34, 229376
    buffer_load_dwordx4 v[56:59], v5, s[16:19], s34 offen
    s_add_u32 s34, s34, 229376
    buffer_load_dwordx4 v[60:63], v5, s[16:19], s34 offen
    v_lshrrev_b32 v6, 4, v2
    v_lshlrev_b32 v6, 11, v6
    v_and_b32 v7, 15, v2
    v_lshl_add_u32 v6, v7, 4, v6
    v_add_u32 v6, s33, v6
    s_lshl_b32 s34, s26, 15
    s_lshl_b32 s35, s3, 8
    s_add_u32 s34, s34, s35
    buffer_load_dwordx4 v[64:67], v6, s[28:31], s34 offen
    s_add_u32 s34, s34, 8192
    buffer_load_dwordx4 v[68:71], v6, s[28:31], s34 offen
    s_add_u32 s34, s34, 8192
    buffer_load_dwordx4 v[72:75], v6, s[28:31], s34 offen
    s_add_u32 s34, s34, 8192
    buffer_load_dwordx4 v[76:79], v6, s[28:31], s34 offen
    s_waitcnt vmcnt(14)
    v_mov_b32 v28, 0
    v_lshlrev_b32 v29, 16, v20
    v_and_b32 v30, 0xffff0000, v20
    v_add_f32 v28, v28, v29
    v_add_f32 v28, v28, v30
    v_lshlrev_b32 v29, 16, v21
    v_and_b32 v30, 0xffff0000, v21
    v_add_f32 v28, v28, v29
    v_add_f32 v28, v28, v30
    v_lshlrev_b32 v29, 16, v22
    v_and_b32 v30, 0xffff0000, v22
    v_add_f32 v28, v28, v29
    v_add_f32 v28, v28, v30
    v_lshlrev_b32 v29, 16, v23
    v_and_b32 v30, 0xffff0000, v23
    v_add_f32 v28, v28, v29
    v_add_f32 v28, v28, v30
    v_lshlrev_b32 v29, 16, v24
    v_and_b32 v30, 0xffff0000, v24
    v_add_f32 v28, v28, v29
    v_add_f32 v28, v28, v30
    v_lshlrev_b32 v29, 16, v25
    v_and_b32 v30, 0xffff0000, v25
    v_add_f32 v28, v28, v29
    v_add_f32 v28, v28, v30
    v_lshlrev_b32 v29, 16, v26
    v_and_b32 v30, 0xffff0000, v26
    v_add_f32 v28, v28, v29
    v_add_f32 v28, v28, v30
    v_lshlrev_b32 v29, 16, v27
    v_and_b32 v30, 0xffff0000, v27
    v_add_f32 v28, v28, v29
    v_add_f32 v28, v28, v30
    s_nop 1
    v_add_f32_dpp v28, v28, v28 quad_perm:[1,0,3,2] row_mask:0xf bank_mask:0xf
    s_nop 1
    v_add_f32_dpp v28, v28, v28 quad_perm:[2,3,0,1] row_mask:0xf bank_mask:0xf
    s_nop 1
    v_add_f32_dpp v28, v28, v28 row_half_mirror row_mask:0xf bank_mask:0xf
    s_nop 1
    v_add_f32_dpp v28, v28, v28 row_mirror row_mask:0xf bank_mask:0xf
    v_mov_b32 v29, v28
    s_nop 1
    v_permlane16_swap_b32 v28, v29
    v_add_f32 v28, v28, v29
    v_mov_b32 v29, v28
    s_nop 1
    v_permlane32_swap_b32 v28, v29
    v_add_f32 v28, v28, v29
    v_mul_f32 v8, 0x3a800000, v8
    v_mul_f32 v20, 0x3a800000, v12
    v_fma_f32 v20, -v8, v8, v20
    v_max_f32 v20, 0, v20
    v_add_f32 v12, 0x3727c5ac, v20
    v_rsq_f32 v12, v12
    v_fma_f32 v16, -v8, v28, v16
    v_mul_f32 v16, v16, v12
    v_mul_f32 v9, 0x3a800000, v9
    v_mul_f32 v21, 0x3a800000, v13
    v_fma_f32 v21, -v9, v9, v21
    v_max_f32 v21, 0, v21
    v_add_f32 v13, 0x3727c5ac, v21
    v_rsq_f32 v13, v13
    v_fma_f32 v17, -v9, v28, v17
    v_mul_f32 v17, v17, v13
    v_mul_f32 v10, 0x3a800000, v10
    v_mul_f32 v22, 0x3a800000, v14
    v_fma_f32 v22, -v10, v10, v22
    v_max_f32 v22, 0, v22
    v_add_f32 v14, 0x3727c5ac, v22
    v_rsq_f32 v14, v14
    v_fma_f32 v18, -v10, v28, v18
    v_mul_f32 v18, v18, v14
    v_mul_f32 v11, 0x3a800000, v11
    v_mul_f32 v23, 0x3a800000, v15
    v_fma_f32 v23, -v11, v11, v23
    v_max_f32 v23, 0, v23
    v_add_f32 v15, 0x3727c5ac, v23
    v_rsq_f32 v15, v15
    v_fma_f32 v19, -v11, v28, v19
    v_mul_f32 v19, v19, v15
    ds_write_b128 v3, v[8:11]
    ds_write_b128 v3, v[12:15] offset:8192
    ds_write_b128 v3, v[16:19] offset:16384
    v_max3_f32 v29, v16, v17, v18
    v_max_f32 v29, v29, v19
    s_nop 1
    v_max_f32_dpp v29, v29, v29 quad_perm:[1,0,3,2] row_mask:0xf bank_mask:0xf
    s_nop 1
    v_max_f32_dpp v29, v29, v29 quad_perm:[2,3,0,1] row_mask:0xf bank_mask:0xf
    s_nop 1
    v_max_f32_dpp v29, v29, v29 row_half_mirror row_mask:0xf bank_mask:0xf
    s_nop 1
    v_max_f32_dpp v29, v29, v29 row_mirror row_mask:0xf bank_mask:0xf
    v_mov_b32 v30, v29
    s_nop 1
    v_permlane16_swap_b32 v29, v30
    v_max_f32 v29, v29, v30
    v_mov_b32 v30, v29
    s_nop 1
    v_permlane32_swap_b32 v29, v30
    v_max_f32 v29, v29, v30
    v_lshlrev_b32 v30, 2, v1
    ds_write_b32 v30, v29 offset:24576
    v_mov_b32 v31, 0x7fffffff
    v_mov_b32 v30, 0
    ds_write_b32 v30, v31 offset:24640
    s_waitcnt lgkmcnt(0)
    s_barrier
    ds_read_b128 v[92:95], v30 offset:24576
    ds_read_b128 v[96:99], v30 offset:24592
    s_waitcnt lgkmcnt(0)
    v_max3_f32 v29, v92, v93, v94
    v_max3_f32 v29, v29, v95, v96
    v_max3_f32 v29, v29, v97, v98
    v_max_f32 v29, v29, v99
    v_lshlrev_b32 v92, 2, v0
    v_cmp_eq_f32 vcc, v29, v19
    v_add_u32 v93, 3, v92
    s_nop 0
    v_cndmask_b32 v31, v31, v93, vcc
    v_cmp_eq_f32 vcc, v29, v18
    v_add_u32 v93, 2, v92
    s_nop 0
    v_cndmask_b32 v31, v31, v93, vcc
    v_cmp_eq_f32 vcc, v29, v17
    v_add_u32 v93, 1, v92
    s_nop 0
    v_cndmask_b32 v31, v31, v93, vcc
    v_cmp_eq_f32 vcc, v29, v16
    v_add_u32 v93, 0, v92
    s_nop 0
    v_cndmask_b32 v31, v31, v93, vcc
    v_cmp_gt_u32 vcc, 0x7fffffff, v31
    s_and_saveexec_b64 s[36:37], vcc
    ds_min_u32 v30, v31 offset:24640
    s_mov_b64 exec, s[36:37]
    s_waitcnt lgkmcnt(0)
    s_barrier
    ds_read_b32 v31, v30 offset:24640
    s_waitcnt lgkmcnt(0)
    v_and_b32 v31, 2047, v31
    v_lshlrev_b32 v92, 2, v31
    ds_read_b32 v93, v92
    ds_read_b32 v94, v92 offset:8192
    v_lshrrev_b32 v95, 7, v31
    v_lshlrev_b32 v95, 18, v95
    v_bfe_u32 v96, v31, 5, 2
    v_lshl_add_u32 v95, v96, 12, v95
    v_and_b32 v96, 31, v31
    v_lshl_add_u32 v95, v96, 4, v95
    v_bfe_u32 v96, v0, 3, 4
    v_lshl_add_u32 v95, v96, 14, v95
    v_and_b32 v96, 7, v0
    v_lshl_add_u32 v95, v96, 9, v95
    s_mov_b32 s27, 0x3000000
    buffer_load_dwordx4 v[108:111], v95, s[20:23], s27 offen
    s_waitcnt lgkmcnt(0)
    v_mov_b32 v112, v31
    v_mov_b32 v113, v29
    v_mov_b32 v114, v93
    v_mov_b32 v115, v94
    v_or_b32 v96, s2, v0
    v_cmp_eq_u32 vcc, 0, v96
    s_and_saveexec_b64 s[36:37], vcc
    s_mov_b32 s27, 0x3450000
    buffer_store_dwordx4 v[112:115], v30, s[20:23], s27 offen
    s_mov_b64 exec, s[36:37]
    s_lshr_b32 s38, s2, 4
    s_and_b32 s39, s2, 15
    s_lshr_b32 s40, s3, 2
    s_lshl_b32 s41, s38, 7
    s_lshl_b32 s42, s40, 5
    s_add_u32 s41, s41, s42
    v_and_b32 v96, 31, v2
    v_add_u32 v96, s41, v96
    v_lshlrev_b32 v97, 2, v96
    ds_read_b32 v116, v97
    ds_read_b32 v117, v97 offset:8192
    ds_read_b32 v118, v97 offset:256
    ds_read_b32 v119, v97 offset:8448
    v_lshlrev_b32 v96, 11, v96
    v_lshrrev_b32 v97, 5, v2
    v_lshl_add_u32 v96, v97, 4, v96
    s_and_b32 s42, s3, 3
    s_lshl_b32 s42, s42, 5
    s_lshl_b32 s39, s39, 7
    s_add_u32 s42, s42, s39
    s_waitcnt vmcnt(13) lgkmcnt(0)
    v_mul_f32 v116, v116, v117
    v_add_f32 v117, 1.0, v117
    v_lshlrev_b32 v120, 16, v100
    v_and_b32 v121, 0xffff0000, v100
    v_fma_f32 v120, v120, v117, -v116
    v_fma_f32 v121, v121, v117, -v116
    v_cvt_pk_bf16_f32 v100, v120, v121
    v_lshlrev_b32 v120, 16, v101
    v_and_b32 v121, 0xffff0000, v101
    v_fma_f32 v120, v120, v117, -v116
    v_fma_f32 v121, v121, v117, -v116
    v_cvt_pk_bf16_f32 v101, v120, v121
    v_lshlrev_b32 v120, 16, v102
    v_and_b32 v121, 0xffff0000, v102
    v_fma_f32 v120, v120, v117, -v116
    v_fma_f32 v121, v121, v117, -v116
    v_cvt_pk_bf16_f32 v102, v120, v121
    v_lshlrev_b32 v120, 16, v103
    v_and_b32 v121, 0xffff0000, v103
    v_fma_f32 v120, v120, v117, -v116
    v_fma_f32 v121, v121, v117, -v116
    v_cvt_pk_bf16_f32 v103, v120, v121
    v_permlane32_swap_b32 v100, v102
    s_nop 0
    v_permlane32_swap_b32 v101, v103
    buffer_store_dwordx4 v[100:103], v96, s[48:51], s42 offen
    s_add_u32 s42, s42, 131072
    v_mul_f32 v118, v118, v119
    v_add_f32 v119, 1.0, v119
    v_lshlrev_b32 v120, 16, v104
    v_and_b32 v121, 0xffff0000, v104
    v_fma_f32 v120, v120, v119, -v118
    v_fma_f32 v121, v121, v119, -v118
    v_cvt_pk_bf16_f32 v104, v120, v121
    v_lshlrev_b32 v120, 16, v105
    v_and_b32 v121, 0xffff0000, v105
    v_fma_f32 v120, v120, v119, -v118
    v_fma_f32 v121, v121, v119, -v118
    v_cvt_pk_bf16_f32 v105, v120, v121
    v_lshlrev_b32 v120, 16, v106
    v_and_b32 v121, 0xffff0000, v106
    v_fma_f32 v120, v120, v119, -v118
    v_fma_f32 v121, v121, v119, -v118
    v_cvt_pk_bf16_f32 v106, v120, v121
    v_lshlrev_b32 v120, 16, v107
    v_and_b32 v121, 0xffff0000, v107
    v_fma_f32 v120, v120, v119, -v118
    v_fma_f32 v121, v121, v119, -v118
    v_cvt_pk_bf16_f32 v107, v120, v121
    v_permlane32_swap_b32 v104, v106
    s_nop 0
    v_permlane32_swap_b32 v105, v107
    buffer_store_dwordx4 v[104:107], v96, s[48:51], s42 offen
    s_add_u32 s42, s42, 131072
    s_waitcnt vmcnt(2)
    v_lshlrev_b32 v120, 16, v108
    v_and_b32 v121, 0xffff0000, v108
    v_lshlrev_b32 v122, 16, v109
    v_and_b32 v123, 0xffff0000, v109
    v_lshlrev_b32 v124, 16, v110
    v_and_b32 v125, 0xffff0000, v110
    v_lshlrev_b32 v126, 16, v111
    v_and_b32 v127, 0xffff0000, v111
    v_sub_f32 v120, v120, v93
    v_mul_f32 v120, v120, v94
    v_sub_f32 v121, v121, v93
    v_mul_f32 v121, v121, v94
    v_sub_f32 v122, v122, v93
    v_mul_f32 v122, v122, v94
    v_sub_f32 v123, v123, v93
    v_mul_f32 v123, v123, v94
    v_sub_f32 v124, v124, v93
    v_mul_f32 v124, v124, v94
    v_sub_f32 v125, v125, v93
    v_mul_f32 v125, v125, v94
    v_sub_f32 v126, v126, v93
    v_mul_f32 v126, v126, v94
    v_sub_f32 v127, v127, v93
    v_mul_f32 v127, v127, v94
    v_lshrrev_b32 v96, 1, v0
    v_lshlrev_b32 v96, 6, v96
    v_and_b32 v97, 1, v0
    v_lshl_add_u32 v96, v97, 4, v96
    v_cmp_gt_u32 vcc, 128, v0
    s_and_saveexec_b64 s[36:37], vcc
    ds_write_b128 v96, v[120:123] offset:32768
    ds_write_b128 v96, v[124:127] offset:32800
    s_mov_b64 exec, s[36:37]
    s_waitcnt lgkmcnt(0)
    s_barrier
    s_and_b32 s34, s3, 3
    s_lshl_b32 s34, s34, 10
    v_lshrrev_b32 v96, 1, v2
    v_lshl_add_u32 v96, v96, 2, s34
    ds_read_b32 v108, v96 offset:32768
    ds_read_b32 v109, v96 offset:32896
    ds_read_b32 v110, v96 offset:33024
    ds_read_b32 v111, v96 offset:33152
    ds_read_b32 v112, v96 offset:33280
    ds_read_b32 v113, v96 offset:33408
    ds_read_b32 v114, v96 offset:33536
    ds_read_b32 v115, v96 offset:33664
    s_waitcnt lgkmcnt(0)
    v_lshlrev_b32 v116, 16, v32
    v_and_b32 v117, 0xffff0000, v32
    v_mul_f32 v120, v116, v108
    v_mul_f32 v121, v117, v108
    v_lshlrev_b32 v116, 16, v33
    v_and_b32 v117, 0xffff0000, v33
    v_mul_f32 v122, v116, v108
    v_mul_f32 v123, v117, v108
    v_lshlrev_b32 v116, 16, v34
    v_and_b32 v117, 0xffff0000, v34
    v_mul_f32 v124, v116, v108
    v_mul_f32 v125, v117, v108
    v_lshlrev_b32 v116, 16, v35
    v_and_b32 v117, 0xffff0000, v35
    v_mul_f32 v126, v116, v108
    v_mul_f32 v127, v117, v108
    v_lshlrev_b32 v116, 16, v36
    v_and_b32 v117, 0xffff0000, v36
    v_fmac_f32 v120, v116, v109
    v_fmac_f32 v121, v117, v109
    v_lshlrev_b32 v116, 16, v37
    v_and_b32 v117, 0xffff0000, v37
    v_fmac_f32 v122, v116, v109
    v_fmac_f32 v123, v117, v109
    v_lshlrev_b32 v116, 16, v38
    v_and_b32 v117, 0xffff0000, v38
    v_fmac_f32 v124, v116, v109
    v_fmac_f32 v125, v117, v109
    v_lshlrev_b32 v116, 16, v39
    v_and_b32 v117, 0xffff0000, v39
    v_fmac_f32 v126, v116, v109
    v_fmac_f32 v127, v117, v109
    v_lshlrev_b32 v116, 16, v40
    v_and_b32 v117, 0xffff0000, v40
    v_fmac_f32 v120, v116, v110
    v_fmac_f32 v121, v117, v110
    v_lshlrev_b32 v116, 16, v41
    v_and_b32 v117, 0xffff0000, v41
    v_fmac_f32 v122, v116, v110
    v_fmac_f32 v123, v117, v110
    v_lshlrev_b32 v116, 16, v42
    v_and_b32 v117, 0xffff0000, v42
    v_fmac_f32 v124, v116, v110
    v_fmac_f32 v125, v117, v110
    v_lshlrev_b32 v116, 16, v43
    v_and_b32 v117, 0xffff0000, v43
    v_fmac_f32 v126, v116, v110
    v_fmac_f32 v127, v117, v110
    v_lshlrev_b32 v116, 16, v44
    v_and_b32 v117, 0xffff0000, v44
    v_fmac_f32 v120, v116, v111
    v_fmac_f32 v121, v117, v111
    v_lshlrev_b32 v116, 16, v45
    v_and_b32 v117, 0xffff0000, v45
    v_fmac_f32 v122, v116, v111
    v_fmac_f32 v123, v117, v111
    v_lshlrev_b32 v116, 16, v46
    v_and_b32 v117, 0xffff0000, v46
    v_fmac_f32 v124, v116, v111
    v_fmac_f32 v125, v117, v111
    v_lshlrev_b32 v116, 16, v47
    v_and_b32 v117, 0xffff0000, v47
    v_fmac_f32 v126, v116, v111
    v_fmac_f32 v127, v117, v111
    v_lshlrev_b32 v116, 16, v48
    v_and_b32 v117, 0xffff0000, v48
    v_fmac_f32 v120, v116, v112
    v_fmac_f32 v121, v117, v112
    v_lshlrev_b32 v116, 16, v49
    v_and_b32 v117, 0xffff0000, v49
    v_fmac_f32 v122, v116, v112
    v_fmac_f32 v123, v117, v112
    v_lshlrev_b32 v116, 16, v50
    v_and_b32 v117, 0xffff0000, v50
    v_fmac_f32 v124, v116, v112
    v_fmac_f32 v125, v117, v112
    v_lshlrev_b32 v116, 16, v51
    v_and_b32 v117, 0xffff0000, v51
    v_fmac_f32 v126, v116, v112
    v_fmac_f32 v127, v117, v112
    v_lshlrev_b32 v116, 16, v52
    v_and_b32 v117, 0xffff0000, v52
    v_fmac_f32 v120, v116, v113
    v_fmac_f32 v121, v117, v113
    v_lshlrev_b32 v116, 16, v53
    v_and_b32 v117, 0xffff0000, v53
    v_fmac_f32 v122, v116, v113
    v_fmac_f32 v123, v117, v113
    v_lshlrev_b32 v116, 16, v54
    v_and_b32 v117, 0xffff0000, v54
    v_fmac_f32 v124, v116, v113
    v_fmac_f32 v125, v117, v113
    v_lshlrev_b32 v116, 16, v55
    v_and_b32 v117, 0xffff0000, v55
    v_fmac_f32 v126, v116, v113
    v_fmac_f32 v127, v117, v113
    v_lshlrev_b32 v116, 16, v56
    v_and_b32 v117, 0xffff0000, v56
    v_fmac_f32 v120, v116, v114
    v_fmac_f32 v121, v117, v114
    v_lshlrev_b32 v116, 16, v57
    v_and_b32 v117, 0xffff0000, v57
    v_fmac_f32 v122, v116, v114
    v_fmac_f32 v123, v117, v114
    v_lshlrev_b32 v116, 16, v58
    v_and_b32 v117, 0xffff0000, v58
    v_fmac_f32 v124, v116, v114
    v_fmac_f32 v125, v117, v114
    v_lshlrev_b32 v116, 16, v59
    v_and_b32 v117, 0xffff0000, v59
    v_fmac_f32 v126, v116, v114
    v_fmac_f32 v127, v117, v114
    v_lshlrev_b32 v116, 16, v60
    v_and_b32 v117, 0xffff0000, v60
    v_fmac_f32 v120, v116, v115
    v_fmac_f32 v121, v117, v115
    v_lshlrev_b32 v116, 16, v61
    v_and_b32 v117, 0xffff0000, v61
    v_fmac_f32 v122, v116, v115
    v_fmac_f32 v123, v117, v115
    v_lshlrev_b32 v116, 16, v62
    v_and_b32 v117, 0xffff0000, v62
    v_fmac_f32 v124, v116, v115
    v_fmac_f32 v125, v117, v115
    v_lshlrev_b32 v116, 16, v63
    v_and_b32 v117, 0xffff0000, v63
    v_fmac_f32 v126, v116, v115
    v_fmac_f32 v127, v117, v115
    v_permlane32_swap_b32 v120, v124
    v_permlane32_swap_b32 v121, v125
    v_permlane32_swap_b32 v122, v126
    v_permlane32_swap_b32 v123, v127
    v_add_f32 v120, v120, v124
    v_add_f32 v121, v121, v125
    v_add_f32 v122, v122, v126
    v_add_f32 v123, v123, v127
    s_nop 0
    v_permlane16_swap_b32 v120, v122
    v_permlane16_swap_b32 v121, v123
    v_add_f32 v120, v120, v122
    v_add_f32 v121, v121, v123
    s_nop 0
    v_add_f32_dpp v120, v120, v120 quad_perm:[2,3,0,1] row_mask:0xf bank_mask:0xf
    v_add_f32_dpp v121, v121, v121 quad_perm:[2,3,0,1] row_mask:0xf bank_mask:0xf
    s_nop 0
    v_add_f32_dpp v120, v120, v120 row_ror:4 row_mask:0xf bank_mask:0xf
    v_add_f32_dpp v121, v121, v121 row_ror:4 row_mask:0xf bank_mask:0xf
    s_nop 0
    v_add_f32_dpp v120, v120, v120 row_ror:8 row_mask:0xf bank_mask:0xf
    v_add_f32_dpp v121, v121, v121 row_ror:8 row_mask:0xf bank_mask:0xf
    v_and_b32 v96, 1, v2
    v_lshrrev_b32 v97, 4, v2
    v_lshlrev_b32 v97, 3, v97
    v_lshl_add_u32 v96, v96, 5, v97
    s_lshl_b32 s34, s3, 6
    v_add_u32 v96, s34, v96
    ds_write_b64 v96, v[120:121] offset:40960
    s_waitcnt lgkmcnt(0)
    s_barrier
    v_and_b32 v96, 15, v2
    v_lshlrev_b32 v96, 2, v96
    ds_read_b32 v108, v96 offset:40960
    ds_read_b32 v109, v96 offset:41024
    ds_read_b32 v110, v96 offset:41088
    ds_read_b32 v111, v96 offset:41152
    ds_read_b32 v112, v96 offset:41216
    ds_read_b32 v113, v96 offset:41280
    ds_read_b32 v114, v96 offset:41344
    ds_read_b32 v115, v96 offset:41408
    s_waitcnt lgkmcnt(0)
    v_add_f32 v108, v108, v109
    v_add_f32 v110, v110, v111
    v_add_f32 v112, v112, v113
    v_add_f32 v114, v114, v115
    v_add_f32 v108, v108, v110
    v_add_f32 v112, v112, v114
    v_mul_f32 v109, 0xbfb8aa3b, v108
    v_exp_f32 v109, v109
    s_nop 0
    v_add_f32 v109, 1.0, v109
    v_rcp_f32 v109, v109
    s_nop 0
    v_mul_f32 v108, v108, v109
    v_mul_f32 v108, v108, v112
    v_lshrrev_b32 v96, 4, v2
    v_lshlrev_b32 v96, 2, v96
    ds_bpermute_b32 v112, v96, v108 offset:0
    ds_bpermute_b32 v113, v96, v108 offset:16
    ds_bpermute_b32 v114, v96, v108 offset:32
    ds_bpermute_b32 v115, v96, v108 offset:48
    s_waitcnt lgkmcnt(0)
    v_lshlrev_b32 v116, 16, v64
    v_and_b32 v117, 0xffff0000, v64
    v_mul_f32 v120, v116, v112
    v_mul_f32 v121, v117, v112
    v_lshlrev_b32 v116, 16, v65
    v_and_b32 v117, 0xffff0000, v65
    v_mul_f32 v122, v116, v112
    v_mul_f32 v123, v117, v112
    v_lshlrev_b32 v116, 16, v66
    v_and_b32 v117, 0xffff0000, v66
    v_mul_f32 v124, v116, v112
    v_mul_f32 v125, v117, v112
    v_lshlrev_b32 v116, 16, v67
    v_and_b32 v117, 0xffff0000, v67
    v_mul_f32 v126, v116, v112
    v_mul_f32 v127, v117, v112
    v_lshlrev_b32 v116, 16, v68
    v_and_b32 v117, 0xffff0000, v68
    v_fmac_f32 v120, v116, v113
    v_fmac_f32 v121, v117, v113
    v_lshlrev_b32 v116, 16, v69
    v_and_b32 v117, 0xffff0000, v69
    v_fmac_f32 v122, v116, v113
    v_fmac_f32 v123, v117, v113
    v_lshlrev_b32 v116, 16, v70
    v_and_b32 v117, 0xffff0000, v70
    v_fmac_f32 v124, v116, v113
    v_fmac_f32 v125, v117, v113
    v_lshlrev_b32 v116, 16, v71
    v_and_b32 v117, 0xffff0000, v71
    v_fmac_f32 v126, v116, v113
    v_fmac_f32 v127, v117, v113
    v_lshlrev_b32 v116, 16, v72
    v_and_b32 v117, 0xffff0000, v72
    v_fmac_f32 v120, v116, v114
    v_fmac_f32 v121, v117, v114
    v_lshlrev_b32 v116, 16, v73
    v_and_b32 v117, 0xffff0000, v73
    v_fmac_f32 v122, v116, v114
    v_fmac_f32 v123, v117, v114
    v_lshlrev_b32 v116, 16, v74
    v_and_b32 v117, 0xffff0000, v74
    v_fmac_f32 v124, v116, v114
    v_fmac_f32 v125, v117, v114
    v_lshlrev_b32 v116, 16, v75
    v_and_b32 v117, 0xffff0000, v75
    v_fmac_f32 v126, v116, v114
    v_fmac_f32 v127, v117, v114
    v_lshlrev_b32 v116, 16, v76
    v_and_b32 v117, 0xffff0000, v76
    v_fmac_f32 v120, v116, v115
    v_fmac_f32 v121, v117, v115
    v_lshlrev_b32 v116, 16, v77
    v_and_b32 v117, 0xffff0000, v77
    v_fmac_f32 v122, v116, v115
    v_fmac_f32 v123, v117, v115
    v_lshlrev_b32 v116, 16, v78
    v_and_b32 v117, 0xffff0000, v78
    v_fmac_f32 v124, v116, v115
    v_fmac_f32 v125, v117, v115
    v_lshlrev_b32 v116, 16, v79
    v_and_b32 v117, 0xffff0000, v79
    v_fmac_f32 v126, v116, v115
    v_fmac_f32 v127, v117, v115
    v_permlane32_swap_b32 v120, v124
    v_permlane32_swap_b32 v121, v125
    v_permlane32_swap_b32 v122, v126
    v_permlane32_swap_b32 v123, v127
    v_add_f32 v120, v120, v124
    v_add_f32 v121, v121, v125
    v_add_f32 v122, v122, v126
    v_add_f32 v123, v123, v127
    s_nop 0
    v_permlane16_swap_b32 v120, v122
    v_permlane16_swap_b32 v121, v123
    v_add_f32 v120, v120, v122
    v_add_f32 v121, v121, v123
    s_cmp_ge_u32 s25, 28
    s_cbranch_scc1 ffn1_kernel_end
    v_and_b32 v96, 15, v2
    v_lshlrev_b32 v96, 5, v96
    v_lshrrev_b32 v97, 4, v2
    v_lshl_add_u32 v96, v97, 3, v96
    s_and_b32 s34, s26, 15
    s_lshl_b32 s34, s34, 12
    s_lshl_b32 s35, s3, 9
    s_add_u32 s34, s34, s35
    s_add_u32 s34, s34, 0x3410000
    buffer_atomic_add_f32 v120, v96, s[20:23], s34 offen sc1
    buffer_atomic_add_f32 v121, v96, s[20:23], s34 offen offset:4 sc1
ffn1_kernel_end:
ffn1_kernel_exit:
    s_endpgm
.globl fix1_kernel
.p2align 8
.type fix1_kernel,@function
fix1_kernel:
    s_cmp_ge_u32 s2, 1
    s_cbranch_scc1 fix1_kernel_exit
    s_load_dwordx2 s[44:45], s[0:1], 64
    s_load_dwordx2 s[46:47], s[0:1], 80
    s_waitcnt lgkmcnt(0)
    s_mov_b32 s20, s46
    s_mov_b32 s21, s47
    s_mov_b32 s22, 0x8000000
    s_mov_b32 s23, 0x20000
    s_mov_b32 s48, s44
    s_mov_b32 s49, s45
    s_mov_b32 s50, 0x400000
    s_mov_b32 s51, 0x20000
    v_mov_b32 v1, 0
    s_mov_b32 s27, 0x3450000
    buffer_load_dwordx4 v[4:7], v1, s[20:23], s27 offen
    v_lshlrev_b32 v2, 4, v0
    s_mov_b32 s27, 0x3410000
    buffer_load_dwordx4 v[16:19], v2, s[20:23], s27 offen
    s_add_u32 s27, s27, 4096
    buffer_load_dwordx4 v[20:23], v2, s[20:23], s27 offen
    s_add_u32 s27, s27, 4096
    buffer_load_dwordx4 v[24:27], v2, s[20:23], s27 offen
    s_add_u32 s27, s27, 4096
    buffer_load_dwordx4 v[28:31], v2, s[20:23], s27 offen
    s_add_u32 s27, s27, 4096
    buffer_load_dwordx4 v[32:35], v2, s[20:23], s27 offen
    s_add_u32 s27, s27, 4096
    buffer_load_dwordx4 v[36:39], v2, s[20:23], s27 offen
    s_add_u32 s27, s27, 4096
    buffer_load_dwordx4 v[40:43], v2, s[20:23], s27 offen
    s_add_u32 s27, s27, 4096
    buffer_load_dwordx4 v[44:47], v2, s[20:23], s27 offen
    s_add_u32 s27, s27, 4096
    buffer_load_dwordx4 v[48:51], v2, s[20:23], s27 offen
    s_add_u32 s27, s27, 4096
    buffer_load_dwordx4 v[52:55], v2, s[20:23], s27 offen
    s_add_u32 s27, s27, 4096
    buffer_load_dwordx4 v[56:59], v2, s[20:23], s27 offen
    s_add_u32 s27, s27, 4096
    buffer_load_dwordx4 v[60:63], v2, s[20:23], s27 offen
    s_add_u32 s27, s27, 4096
    buffer_load_dwordx4 v[64:67], v2, s[20:23], s27 offen
    s_add_u32 s27, s27, 4096
    buffer_load_dwordx4 v[68:71], v2, s[20:23], s27 offen
    s_add_u32 s27, s27, 4096
    buffer_load_dwordx4 v[72:75], v2, s[20:23], s27 offen
    s_add_u32 s27, s27, 4096
    buffer_load_dwordx4 v[76:79], v2, s[20:23], s27 offen
    s_add_u32 s27, s27, 4096
    s_waitcnt vmcnt(16)
    v_and_b32 v4, 2047, v4
    v_lshrrev_b32 v8, 7, v4
    v_lshlrev_b32 v8, 18, v8
    v_bfe_u32 v9, v4, 5, 2
    v_lshl_add_u32 v8, v9, 12, v8
    v_and_b32 v9, 31, v4
    v_lshl_add_u32 v8, v9, 4, v8
    v_lshrrev_b32 v9, 4, v0
    v_lshl_add_u32 v8, v9, 14, v8
    v_bfe_u32 v9, v0, 2, 2
    v_lshl_add_u32 v8, v9, 10, v8
    v_and_b32 v9, 1, v0
    v_lshl_add_u32 v8, v9, 9, v8
    v_bfe_u32 v9, v0, 1, 1
    v_lshl_add_u32 v8, v9, 3, v8
    s_mov_b32 s28, 0x3000000
    buffer_load_dwordx2 v[10:11], v8, s[20:23], s28 offen
    v_mul_f32 v5, 0xbfb8aa3b, v5
    v_exp_f32 v5, v5
    s_nop 0
    v_add_f32 v5, 1.0, v5
    v_rcp_f32 v5, v5
    v_mul_f32 v6, v6, v7
    v_add_f32 v7, 1.0, v7
    s_waitcnt vmcnt(0)
    v_add_f32 v16, v16, v20
    v_add_f32 v17, v17, v21
    v_add_f32 v18, v18, v22
    v_add_f32 v19, v19, v23
    v_add_f32 v16, v16, v24
    v_add_f32 v17, v17, v25
    v_add_f32 v18, v18, v26
    v_add_f32 v19, v19, v27
    v_add_f32 v16, v16, v28
    v_add_f32 v17, v17, v29
    v_add_f32 v18, v18, v30
    v_add_f32 v19, v19, v31
    v_add_f32 v16, v16, v32
    v_add_f32 v17, v17, v33
    v_add_f32 v18, v18, v34
    v_add_f32 v19, v19, v35
    v_add_f32 v16, v16, v36
    v_add_f32 v17, v17, v37
    v_add_f32 v18, v18, v38
    v_add_f32 v19, v19, v39
    v_add_f32 v16, v16, v40
    v_add_f32 v17, v17, v41
    v_add_f32 v18, v18, v42
    v_add_f32 v19, v19, v43
    v_add_f32 v16, v16, v44
    v_add_f32 v17, v17, v45
    v_add_f32 v18, v18, v46
    v_add_f32 v19, v19, v47
    v_add_f32 v16, v16, v48
    v_add_f32 v17, v17, v49
    v_add_f32 v18, v18, v50
    v_add_f32 v19, v19, v51
    v_add_f32 v16, v16, v52
    v_add_f32 v17, v17, v53
    v_add_f32 v18, v18, v54
    v_add_f32 v19, v19, v55
    v_add_f32 v16, v16, v56
    v_add_f32 v17, v17, v57
    v_add_f32 v18, v18, v58
    v_add_f32 v19, v19, v59
    v_add_f32 v16, v16, v60
    v_add_f32 v17, v17, v61
    v_add_f32 v18, v18, v62
    v_add_f32 v19, v19, v63
    v_add_f32 v16, v16, v64
    v_add_f32 v17, v17, v65
    v_add_f32 v18, v18, v66
    v_add_f32 v19, v19, v67
    v_add_f32 v16, v16, v68
    v_add_f32 v17, v17, v69
    v_add_f32 v18, v18, v70
    v_add_f32 v19, v19, v71
    v_add_f32 v16, v16, v72
    v_add_f32 v17, v17, v73
    v_add_f32 v18, v18, v74
    v_add_f32 v19, v19, v75
    v_add_f32 v16, v16, v76
    v_add_f32 v17, v17, v77
    v_add_f32 v18, v18, v78
    v_add_f32 v19, v19, v79
    v_lshlrev_b32 v12, 16, v10
    v_and_b32 v13, 0xffff0000, v10
    v_lshlrev_b32 v14, 16, v11
    v_and_b32 v15, 0xffff0000, v11
    v_fma_f32 v12, v12, v7, -v6
    v_fmac_f32 v12, v16, v5
    v_fma_f32 v13, v13, v7, -v6
    v_fmac_f32 v13, v17, v5
    v_fma_f32 v14, v14, v7, -v6
    v_fmac_f32 v14, v18, v5
    v_fma_f32 v15, v15, v7, -v6
    v_fmac_f32 v15, v19, v5
    v_cvt_pk_bf16_f32 v10, v12, v13
    v_cvt_pk_bf16_f32 v11, v14, v15
    v_lshlrev_b32 v8, 11, v4
    v_lshl_add_u32 v8, v0, 3, v8
    buffer_store_dwordx2 v[10:11], v8, s[48:51], 0 offen
fix1_kernel_end:
fix1_kernel_exit:
    s_endpgm
.section .rodata,"a"
.p2align 6
.amdhsa_kernel prep_kernel
  .amdhsa_next_free_vgpr 64
  .amdhsa_next_free_sgpr 102
  .amdhsa_accum_offset 64
  .amdhsa_group_segment_fixed_size 0
  .amdhsa_kernarg_size 88
  .amdhsa_user_sgpr_count 2
  .amdhsa_user_sgpr_kernarg_segment_ptr 1
  .amdhsa_system_sgpr_workgroup_id_x 1
.end_amdhsa_kernel
.p2align 6
.amdhsa_kernel qkv0_kernel
  .amdhsa_next_free_vgpr 216
  .amdhsa_next_free_sgpr 102
  .amdhsa_accum_offset 216
  .amdhsa_group_segment_fixed_size 0
  .amdhsa_kernarg_size 88
  .amdhsa_user_sgpr_count 2
  .amdhsa_user_sgpr_kernarg_segment_ptr 1
  .amdhsa_system_sgpr_workgroup_id_x 1
.end_amdhsa_kernel
.p2align 6
.amdhsa_kernel attn0_kernel
  .amdhsa_next_free_vgpr 160
  .amdhsa_next_free_sgpr 102
  .amdhsa_accum_offset 160
  .amdhsa_group_segment_fixed_size 0
  .amdhsa_kernarg_size 88
  .amdhsa_user_sgpr_count 2
  .amdhsa_user_sgpr_kernarg_segment_ptr 1
  .amdhsa_system_sgpr_workgroup_id_x 1
.end_amdhsa_kernel
.p2align 6
.amdhsa_kernel wo0_kernel
  .amdhsa_next_free_vgpr 216
  .amdhsa_next_free_sgpr 102
  .amdhsa_accum_offset 216
  .amdhsa_group_segment_fixed_size 0
  .amdhsa_kernarg_size 88
  .amdhsa_user_sgpr_count 2
  .amdhsa_user_sgpr_kernarg_segment_ptr 1
  .amdhsa_system_sgpr_workgroup_id_x 1
.end_amdhsa_kernel
.p2align 6
.amdhsa_kernel ffn0_kernel
  .amdhsa_next_free_vgpr 128
  .amdhsa_next_free_sgpr 102
  .amdhsa_accum_offset 128
  .amdhsa_group_segment_fixed_size 0
  .amdhsa_kernarg_size 88
  .amdhsa_user_sgpr_count 2
  .amdhsa_user_sgpr_kernarg_segment_ptr 1
  .amdhsa_system_sgpr_workgroup_id_x 1
.end_amdhsa_kernel
.p2align 6
.amdhsa_kernel fix0_kernel
  .amdhsa_next_free_vgpr 96
  .amdhsa_next_free_sgpr 102
  .amdhsa_accum_offset 96
  .amdhsa_group_segment_fixed_size 0
  .amdhsa_kernarg_size 88
  .amdhsa_user_sgpr_count 2
  .amdhsa_user_sgpr_kernarg_segment_ptr 1
  .amdhsa_system_sgpr_workgroup_id_x 1
.end_amdhsa_kernel
.p2align 6
.amdhsa_kernel qkv1_kernel
  .amdhsa_next_free_vgpr 216
  .amdhsa_next_free_sgpr 102
  .amdhsa_accum_offset 216
  .amdhsa_group_segment_fixed_size 0
  .amdhsa_kernarg_size 88
  .amdhsa_user_sgpr_count 2
  .amdhsa_user_sgpr_kernarg_segment_ptr 1
  .amdhsa_system_sgpr_workgroup_id_x 1
.end_amdhsa_kernel
.p2align 6
.amdhsa_kernel attn1_kernel
  .amdhsa_next_free_vgpr 160
  .amdhsa_next_free_sgpr 102
  .amdhsa_accum_offset 160
  .amdhsa_group_segment_fixed_size 0
  .amdhsa_kernarg_size 88
  .amdhsa_user_sgpr_count 2
  .amdhsa_user_sgpr_kernarg_segment_ptr 1
  .amdhsa_system_sgpr_workgroup_id_x 1
.end_amdhsa_kernel
.p2align 6
.amdhsa_kernel wo1_kernel
  .amdhsa_next_free_vgpr 216
  .amdhsa_next_free_sgpr 102
  .amdhsa_accum_offset 216
  .amdhsa_group_segment_fixed_size 0
  .amdhsa_kernarg_size 88
  .amdhsa_user_sgpr_count 2
  .amdhsa_user_sgpr_kernarg_segment_ptr 1
  .amdhsa_system_sgpr_workgroup_id_x 1
.end_amdhsa_kernel
.p2align 6
.amdhsa_kernel ffn1_kernel
  .amdhsa_next_free_vgpr 128
  .amdhsa_next_free_sgpr 102
  .amdhsa_accum_offset 128
  .amdhsa_group_segment_fixed_size 0
  .amdhsa_kernarg_size 88
  .amdhsa_user_sgpr_count 2
  .amdhsa_user_sgpr_kernarg_segment_ptr 1
  .amdhsa_system_sgpr_workgroup_id_x 1
.end_amdhsa_kernel
.p2align 6
.amdhsa_kernel fix1_kernel
  .amdhsa_next_free_vgpr 96
  .amdhsa_next_free_sgpr 102
  .amdhsa_accum_offset 96
  .amdhsa_group_segment_fixed_size 0
  .amdhsa_kernarg_size 88
  .amdhsa_user_sgpr_count 2
  .amdhsa_user_sgpr_kernarg_segment_ptr 1
  .amdhsa_system_sgpr_workgroup_id_x 1
.end_amdhsa_kernel
```

```asm
; @launch grid=(256,1,1) block=(512,1,1) lds=163840
.amdgcn_target "amdgcn-amd-amdhsa--gfx950"
.text
.globl interleave_layers__sliding_block__moe_arch_mod__prompt_kernel
.p2align 8
.type interleave_layers__sliding_block__moe_arch_mod__prompt_kernel,@function
interleave_layers__sliding_block__moe_arch_mod__prompt_kernel:
    s_cmp_ge_u32 s2, 256
    s_cbranch_scc1 k_exit
    s_load_dwordx2 s[4:5], s[0:1], 0
    s_load_dwordx2 s[16:17], s[0:1], 8
    s_load_dwordx2 s[8:9], s[0:1], 16
    s_load_dwordx2 s[20:21], s[0:1], 80
    s_load_dwordx2 s[12:13], s[0:1], 72
    v_lshrrev_b32 v1, 6, v0
    v_and_b32 v252, 63, v0
    v_readfirstlane_b32 s3, v1
    v_lshlrev_b32 v253, 4, v252
    s_and_b32 s30, s2, 7
    s_lshr_b32 s31, s2, 3
    s_lshr_b32 s24, s30, 0
    s_lshl_b32 s24, s24, 1
    s_and_b32 s32, s31, 1
    s_add_u32 s24, s24, s32
    s_and_b32 s25, s30, 0
    s_mul_i32 s25, s25, 16
    s_lshr_b32 s32, s31, 1
    s_add_u32 s25, s25, s32
    s_mul_i32 s29, s30, 28
    s_lshl_b32 s32, s30, 2
    s_add_u32 s32, s32, 196
    s_cmp_lt_u32 s31, 28
    s_cselect_b32 s29, s29, s32
    s_add_u32 s29, s29, s31
    s_lshl_b32 s72, s24, 4
    s_add_u32 s72, s72, s25
    s_mov_b32 s26, 0
    s_mov_b32 s27, 20000
    s_and_b32 s28, s3, 3
    s_mov_b32 s6, 0x400000
    s_mov_b32 s7, 0x20000
    s_mov_b32 s18, 0x600000
    s_mov_b32 s19, 0x20000
    s_mov_b32 s10, 0x200000
    s_mov_b32 s11, 0x20000
    s_mov_b32 s22, 0x8000000
    s_mov_b32 s23, 0x20000
    s_mov_b32 s14, 0x100
    s_mov_b32 s15, 0x20000
    s_waitcnt lgkmcnt(0)
    s_cmp_ge_u32 s3, 4
    s_cbranch_scc1 l_start
    v_mov_b32 v0, -1
    v_mov_b32 v1, -1
    v_mov_b32 v2, -1
    v_mov_b32 v3, -1
    s_lshr_b32 s30, s3, 1
    s_mul_i32 s30, s30, 16777216
    s_and_b32 s31, s3, 1
    s_lshl_b32 s32, s31, 20
    s_lshl_b32 s33, s72, 10
    s_add_u32 s32, s32, s33
    s_add_u32 s32, s32, s30
    s_add_u32 s32, s32, 0xc00000
    buffer_store_dwordx4 v[0:3], v253, s[20:23], s32 offen sc1
    s_add_u32 s32, s32, 262144
    buffer_store_dwordx4 v[0:3], v253, s[20:23], s32 offen sc1
    s_add_u32 s32, s32, 262144
    buffer_store_dwordx4 v[0:3], v253, s[20:23], s32 offen sc1
    s_add_u32 s32, s32, 262144
    s_lshl_b32 s33, s72, 7
    s_add_u32 s33, s33, s30
    s_add_u32 s33, s33, 0xdc0000
    s_cmp_eq_u32 s31, 0
    s_cselect_b32 s32, s32, s33
    s_cselect_b64 exec, -1, 0xff
    buffer_store_dwordx4 v[0:3], v253, s[20:23], s32 offen sc1
    s_mov_b64 exec, -1
    v_mov_b32 v246, 1.0
    v_mov_b32 v247, 0
    s_mov_b32 s77, 329
    v_lshlrev_b32 v151, 2, v252
    v_bfe_u32 v152, v252, 3, 2
    v_lshlrev_b32 v152, 10, v152
    v_and_b32 v153, 7, v252
    v_lshl_add_u32 v152, v153, 3, v152
    v_lshrrev_b32 v153, 5, v252
    v_lshl_add_u32 v152, v153, 2, v152
    s_and_b32 s30, s3, 1
    s_lshl_b32 s30, s30, 13
    v_and_b32 v4, 31, v252
    v_lshrrev_b32 v5, 5, v252
    v_bfe_u32 v6, v4, 1, 3
    v_xor_b32 v6, v6, v5
    v_lshlrev_b32 v6, 4, v6
    v_lshl_add_u32 v6, v4, 7, v6
    v_add_u32 v136, s30, v6
    v_xor_b32 v137, 32, v136
    v_xor_b32 v138, 64, v136
    v_xor_b32 v139, 96, v136
e_q:
    s_lshr_b32 s30, s3, 1
    v_bfe_u32 v5, v252, 2, 2
    v_lshrrev_b32 v4, 5, v252
    v_lshl_add_u32 v6, v4, 3, v5
    v_lshlrev_b32 v6, 7, v6
    v_lshrrev_b32 v5, 1, v5
    v_xor_b32 v5, s30, v5
    v_lshl_add_u32 v6, v5, 6, v6
    v_bfe_u32 v5, v252, 4, 1
    v_lshl_add_u32 v6, v5, 5, v6
    v_and_b32 v5, 3, v252
    v_lshl_add_u32 v140, v5, 3, v6
    v_add_u32 v140, 16384, v140
    v_mov_b32 v141, v136
    v_mov_b32 v142, v137
    v_mov_b32 v143, v138
    v_mov_b32 v144, v139
    v_mov_b32 v145, v140
    v_mov_b32 v0, 0
    v_mov_b32 v1, 0
    v_mov_b32 v2, 0
    v_mov_b32 v3, 0
    v_mov_b32 v4, 0
    v_mov_b32 v5, 0
    v_mov_b32 v6, 0
    v_mov_b32 v7, 0
    v_mov_b32 v8, 0
    v_mov_b32 v9, 0
    v_mov_b32 v10, 0
    v_mov_b32 v11, 0
    v_mov_b32 v12, 0
    v_mov_b32 v13, 0
    v_mov_b32 v14, 0
    v_mov_b32 v15, 0
    v_mov_b32 v16, 0
    v_mov_b32 v17, 0
    v_mov_b32 v18, 0
    v_mov_b32 v19, 0
    v_mov_b32 v20, 0
    v_mov_b32 v21, 0
    v_mov_b32 v22, 0
    v_mov_b32 v23, 0
    v_mov_b32 v24, 0
    v_mov_b32 v25, 0
    v_mov_b32 v26, 0
    v_mov_b32 v27, 0
    v_mov_b32 v28, 0
    v_mov_b32 v29, 0
    v_mov_b32 v30, 0
    v_mov_b32 v31, 0
    v_mov_b32 v32, 0
    v_mov_b32 v33, 0
    v_mov_b32 v34, 0
    v_mov_b32 v35, 0
    v_mov_b32 v36, 0
    v_mov_b32 v37, 0
    v_mov_b32 v38, 0
    v_mov_b32 v39, 0
    v_mov_b32 v40, 0
    v_mov_b32 v41, 0
    v_mov_b32 v42, 0
    v_mov_b32 v43, 0
    v_mov_b32 v44, 0
    v_mov_b32 v45, 0
    v_mov_b32 v46, 0
    v_mov_b32 v47, 0
    v_mov_b32 v48, 0
    v_mov_b32 v49, 0
    v_mov_b32 v50, 0
    v_mov_b32 v51, 0
    v_mov_b32 v52, 0
    v_mov_b32 v53, 0
    v_mov_b32 v54, 0
    v_mov_b32 v55, 0
    v_mov_b32 v56, 0
    v_mov_b32 v57, 0
    v_mov_b32 v58, 0
    v_mov_b32 v59, 0
    v_mov_b32 v60, 0
    v_mov_b32 v61, 0
    v_mov_b32 v62, 0
    v_mov_b32 v63, 0
    v_mov_b32 v64, 0
    v_mov_b32 v65, 0
    v_mov_b32 v66, 0
    v_mov_b32 v67, 0
    v_mov_b32 v68, 0
    v_mov_b32 v69, 0
    v_mov_b32 v70, 0
    v_mov_b32 v71, 0
    v_mov_b32 v72, 0
    v_mov_b32 v73, 0
    v_mov_b32 v74, 0
    v_mov_b32 v75, 0
    v_mov_b32 v76, 0
    v_mov_b32 v77, 0
    v_mov_b32 v78, 0
    v_mov_b32 v79, 0
    v_mov_b32 v80, 0
    v_mov_b32 v81, 0
    v_mov_b32 v82, 0
    v_mov_b32 v83, 0
    v_mov_b32 v84, 0
    v_mov_b32 v85, 0
    v_mov_b32 v86, 0
    v_mov_b32 v87, 0
    v_mov_b32 v88, 0
    v_mov_b32 v89, 0
    v_mov_b32 v90, 0
    v_mov_b32 v91, 0
    v_mov_b32 v92, 0
    v_mov_b32 v93, 0
    v_mov_b32 v94, 0
    v_mov_b32 v95, 0
    s_mov_b32 s31, 0
    s_mov_b32 s36, 16
    s_waitcnt vmcnt(0)
    s_setprio 1
    s_barrier
    ds_read_b128 v[96:99], v141
    ds_read_b128 v[100:103], v141 offset:4096
    ds_read_b64_tr_b16 v[104:105], v145 offset:0
    ds_read_b64_tr_b16 v[106:107], v145 offset:512
    ds_read_b64_tr_b16 v[108:109], v145 offset:8192
    ds_read_b64_tr_b16 v[110:111], v145 offset:8704
    ds_read_b64_tr_b16 v[112:113], v145 offset:16384
    ds_read_b64_tr_b16 v[114:115], v145 offset:16896
e_loop:
    s_waitcnt lgkmcnt(0)
    v_mfma_f32_32x32x16_bf16 v[0:15], v[104:107], v[96:99], v[0:15]
    ds_read_b128 v[116:119], v142
    ds_read_b64_tr_b16 v[124:125], v145 offset:2048
    ds_read_b64_tr_b16 v[126:127], v145 offset:2560
    v_mfma_f32_32x32x16_bf16 v[16:31], v[104:107], v[100:103], v[16:31]
    ds_read_b128 v[120:123], v142 offset:4096
    ds_read_b64_tr_b16 v[128:129], v145 offset:10240
    ds_read_b64_tr_b16 v[130:131], v145 offset:10752
    v_mfma_f32_32x32x16_bf16 v[32:47], v[108:111], v[96:99], v[32:47]
    ds_read_b64_tr_b16 v[132:133], v145 offset:18432
    ds_read_b64_tr_b16 v[134:135], v145 offset:18944
    v_mfma_f32_32x32x16_bf16 v[48:63], v[108:111], v[100:103], v[48:63]
    v_mfma_f32_32x32x16_bf16 v[64:79], v[96:99], v[112:115], v[64:79]
    v_mfma_f32_32x32x16_bf16 v[80:95], v[100:103], v[112:115], v[80:95]
    s_waitcnt lgkmcnt(0)
    v_mfma_f32_32x32x16_bf16 v[0:15], v[124:127], v[116:119], v[0:15]
    ds_read_b128 v[96:99], v143
    ds_read_b64_tr_b16 v[104:105], v145 offset:4096
    ds_read_b64_tr_b16 v[106:107], v145 offset:4608
    v_mfma_f32_32x32x16_bf16 v[16:31], v[124:127], v[120:123], v[16:31]
    ds_read_b128 v[100:103], v143 offset:4096
    ds_read_b64_tr_b16 v[108:109], v145 offset:12288
    ds_read_b64_tr_b16 v[110:111], v145 offset:12800
    v_mfma_f32_32x32x16_bf16 v[32:47], v[128:131], v[116:119], v[32:47]
    ds_read_b64_tr_b16 v[112:113], v145 offset:20480
    ds_read_b64_tr_b16 v[114:115], v145 offset:20992
    v_mfma_f32_32x32x16_bf16 v[48:63], v[128:131], v[120:123], v[48:63]
    v_mfma_f32_32x32x16_bf16 v[64:79], v[116:119], v[132:135], v[64:79]
    v_mfma_f32_32x32x16_bf16 v[80:95], v[120:123], v[132:135], v[80:95]
    s_waitcnt lgkmcnt(0)
    v_mfma_f32_32x32x16_bf16 v[0:15], v[104:107], v[96:99], v[0:15]
    ds_read_b128 v[116:119], v144
    ds_read_b64_tr_b16 v[124:125], v145 offset:6144
    ds_read_b64_tr_b16 v[126:127], v145 offset:6656
    v_mfma_f32_32x32x16_bf16 v[16:31], v[104:107], v[100:103], v[16:31]
    ds_read_b128 v[120:123], v144 offset:4096
    ds_read_b64_tr_b16 v[128:129], v145 offset:14336
    ds_read_b64_tr_b16 v[130:131], v145 offset:14848
    v_mfma_f32_32x32x16_bf16 v[32:47], v[108:111], v[96:99], v[32:47]
    ds_read_b64_tr_b16 v[132:133], v145 offset:22528
    ds_read_b64_tr_b16 v[134:135], v145 offset:23040
    v_mfma_f32_32x32x16_bf16 v[48:63], v[108:111], v[100:103], v[48:63]
    v_mfma_f32_32x32x16_bf16 v[64:79], v[96:99], v[112:115], v[64:79]
    v_mfma_f32_32x32x16_bf16 v[80:95], v[100:103], v[112:115], v[80:95]
    s_waitcnt lgkmcnt(0)
    v_mfma_f32_32x32x16_bf16 v[0:15], v[124:127], v[116:119], v[0:15]
    s_barrier
    s_add_u32 s31, s31, 40960
    s_cmp_ge_u32 s31, 163840
    s_cselect_b32 s31, 0, s31
    v_add_u32 v141, s31, v136
    v_add_u32 v145, s31, v140
    ds_read_b128 v[96:99], v141
    ds_read_b64_tr_b16 v[104:105], v145 offset:0
    ds_read_b64_tr_b16 v[106:107], v145 offset:512
    v_mfma_f32_32x32x16_bf16 v[16:31], v[124:127], v[120:123], v[16:31]
    ds_read_b128 v[100:103], v141 offset:4096
    ds_read_b64_tr_b16 v[108:109], v145 offset:8192
    ds_read_b64_tr_b16 v[110:111], v145 offset:8704
    v_mfma_f32_32x32x16_bf16 v[32:47], v[128:131], v[116:119], v[32:47]
    ds_read_b64_tr_b16 v[112:113], v145 offset:16384
    ds_read_b64_tr_b16 v[114:115], v145 offset:16896
    v_mfma_f32_32x32x16_bf16 v[48:63], v[128:131], v[120:123], v[48:63]
    v_add_u32 v142, s31, v137
    v_add_u32 v143, s31, v138
    v_add_u32 v144, s31, v139
    s_sub_u32 s36, s36, 1
    s_bitcmp1_b32 s77, s36
    v_mfma_f32_32x32x16_bf16 v[64:79], v[116:119], v[132:135], v[64:79]
    v_mfma_f32_32x32x16_bf16 v[80:95], v[120:123], v[132:135], v[80:95]
    s_cbranch_scc0 e_loop
    s_cmp_eq_u32 s36, 0
    s_cbranch_scc1 e_qdone
    s_cmp_eq_u32 s36, 3
    s_cbranch_scc1 e_evtab
    s_cmp_eq_u32 s36, 6
    s_cbranch_scc1 e_evload
    buffer_load_dword v150, v151, s[12:15], 0 offen sc1
    s_branch e_loop
e_evload:
    s_mov_b32 s78, s27
    s_waitcnt vmcnt(0)
    s_branch pc_2
pl_1:
    buffer_load_dword v150, v151, s[12:15], 0 offen sc1
    s_waitcnt vmcnt(0)
pc_2:
    v_cmp_ne_u32 vcc, 0x01010101, v150
    s_cbranch_vccz pd_3
    s_sub_u32 s78, s78, 1
    s_cmp_lg_u32 s78, 0
    s_cbranch_scc1 pl_1
    s_mov_b32 s27, 1
pd_3:
    s_lshl_b32 s32, s24, 14
    s_lshl_b32 s33, s3, 12
    s_add_u32 s32, s32, s33
    s_add_u32 s32, s32, 0xd80000
    buffer_load_dword v244, v152, s[20:23], s32 offen offset:768 sc1
    s_min_u32 s33, s3, 2
    s_lshl_b32 s33, s33, 8
    s_lshl_b32 s32, s25, 10
    s_add_u32 s32, s32, s33
    s_add_u32 s32, s32, 0xd80000
    buffer_load_dword v154, v151, s[20:23], s32 offen sc1
    s_add_u32 s32, s32, 16384
    buffer_load_dword v155, v151, s[20:23], s32 offen sc1
    s_add_u32 s32, s32, 16384
    buffer_load_dword v156, v151, s[20:23], s32 offen sc1
    s_add_u32 s32, s32, 16384
    buffer_load_dword v157, v151, s[20:23], s32 offen sc1
    s_add_u32 s32, s32, 16384
    buffer_load_dword v158, v151, s[20:23], s32 offen sc1
    s_add_u32 s32, s32, 16384
    buffer_load_dword v159, v151, s[20:23], s32 offen sc1
    s_add_u32 s32, s32, 16384
    buffer_load_dword v160, v151, s[20:23], s32 offen sc1
    s_add_u32 s32, s32, 16384
    buffer_load_dword v161, v151, s[20:23], s32 offen sc1
    s_add_u32 s32, s32, 16384
    buffer_load_dword v162, v151, s[20:23], s32 offen sc1
    s_add_u32 s32, s32, 16384
    buffer_load_dword v163, v151, s[20:23], s32 offen sc1
    s_add_u32 s32, s32, 16384
    buffer_load_dword v164, v151, s[20:23], s32 offen sc1
    s_add_u32 s32, s32, 16384
    buffer_load_dword v165, v151, s[20:23], s32 offen sc1
    s_add_u32 s32, s32, 16384
    buffer_load_dword v166, v151, s[20:23], s32 offen sc1
    s_add_u32 s32, s32, 16384
    buffer_load_dword v167, v151, s[20:23], s32 offen sc1
    s_add_u32 s32, s32, 16384
    buffer_load_dword v168, v151, s[20:23], s32 offen sc1
    s_add_u32 s32, s32, 16384
    buffer_load_dword v169, v151, s[20:23], s32 offen sc1
    s_branch e_loop
e_evtab:
    s_cmp_lg_u32 s26, 0
    s_cbranch_scc1 e_evtab2
    s_mov_b32 s78, s27
    s_waitcnt vmcnt(0)
    s_branch pc_5
pl_4:
    s_lshl_b32 s32, s24, 14
    s_lshl_b32 s33, s3, 12
    s_add_u32 s32, s32, s33
    s_add_u32 s32, s32, 0xd80000
    buffer_load_dword v244, v152, s[20:23], s32 offen offset:768 sc1
    s_min_u32 s33, s3, 2
    s_lshl_b32 s33, s33, 8
    s_lshl_b32 s32, s25, 10
    s_add_u32 s32, s32, s33
    s_add_u32 s32, s32, 0xd80000
    buffer_load_dword v154, v151, s[20:23], s32 offen sc1
    s_add_u32 s32, s32, 16384
    buffer_load_dword v155, v151, s[20:23], s32 offen sc1
    s_add_u32 s32, s32, 16384
    buffer_load_dword v156, v151, s[20:23], s32 offen sc1
    s_add_u32 s32, s32, 16384
    buffer_load_dword v157, v151, s[20:23], s32 offen sc1
    s_add_u32 s32, s32, 16384
    buffer_load_dword v158, v151, s[20:23], s32 offen sc1
    s_add_u32 s32, s32, 16384
    buffer_load_dword v159, v151, s[20:23], s32 offen sc1
    s_add_u32 s32, s32, 16384
    buffer_load_dword v160, v151, s[20:23], s32 offen sc1
    s_add_u32 s32, s32, 16384
    buffer_load_dword v161, v151, s[20:23], s32 offen sc1
    s_add_u32 s32, s32, 16384
    buffer_load_dword v162, v151, s[20:23], s32 offen sc1
    s_add_u32 s32, s32, 16384
    buffer_load_dword v163, v151, s[20:23], s32 offen sc1
    s_add_u32 s32, s32, 16384
    buffer_load_dword v164, v151, s[20:23], s32 offen sc1
    s_add_u32 s32, s32, 16384
    buffer_load_dword v165, v151, s[20:23], s32 offen sc1
    s_add_u32 s32, s32, 16384
    buffer_load_dword v166, v151, s[20:23], s32 offen sc1
    s_add_u32 s32, s32, 16384
    buffer_load_dword v167, v151, s[20:23], s32 offen sc1
    s_add_u32 s32, s32, 16384
    buffer_load_dword v168, v151, s[20:23], s32 offen sc1
    s_add_u32 s32, s32, 16384
    buffer_load_dword v169, v151, s[20:23], s32 offen sc1
    s_waitcnt vmcnt(0)
pc_5:
    v_max3_u32 v150, v244, v154, v155
    v_max3_u32 v150, v150, v156, v157
    v_max3_u32 v150, v150, v158, v159
    v_max3_u32 v150, v150, v160, v161
    v_max3_u32 v150, v150, v162, v163
    v_max3_u32 v150, v150, v164, v165
    v_max3_u32 v150, v150, v166, v167
    v_max3_u32 v150, v150, v168, v169
    v_cmp_eq_u32 vcc, -1, v150
    s_cbranch_vccz pd_6
    s_sub_u32 s78, s78, 1
    s_cmp_lg_u32 s78, 0
    s_cbranch_scc1 pl_4
    s_mov_b32 s27, 1
pd_6:
    v_add_f32 v245, v154, v155
    v_add_f32 v245, v245, v156
    v_add_f32 v245, v245, v157
    v_add_f32 v245, v245, v158
    v_add_f32 v245, v245, v159
    v_add_f32 v245, v245, v160
    v_add_f32 v245, v245, v161
    v_add_f32 v245, v245, v162
    v_add_f32 v245, v245, v163
    v_add_f32 v245, v245, v164
    v_add_f32 v245, v245, v165
    v_add_f32 v245, v245, v166
    v_add_f32 v245, v245, v167
    v_add_f32 v245, v245, v168
    v_add_f32 v245, v245, v169
    s_mov_b32 s77, 9
e_evtab2:
    v_and_b32 v150, 31, v252
    v_lshrrev_b32 v151, 5, v252
    v_lshlrev_b32 v151, 9, v151
    v_lshl_add_u32 v150, v150, 2, v151
    s_lshl_b32 s32, s3, 7
    v_add_u32 v150, s32, v150
    ds_write_b32 v150, v244 offset:0
    s_lshl_b32 s32, s3, 8
    v_lshl_add_u32 v151, v252, 2, s32
    ds_write_b32 v151, v245 offset:1024
    s_branch e_loop
e_qdone:
    s_waitcnt lgkmcnt(0)
    s_and_b32 s34, s3, 1
    s_lshr_b32 s35, s3, 1
    v_and_b32 v96, 31, v252
    v_lshrrev_b32 v97, 5, v252
    s_lshl_b32 s30, s34, 8
    v_lshl_add_u32 v98, v96, 2, s30
    v_lshl_add_u32 v99, v97, 4, s30
    s_lshl_b32 s30, s35, 7
    v_lshl_add_u32 v100, v97, 4, s30
    v_lshl_add_u32 v101, v96, 2, s30
    ds_read_b32 v104, v98 offset:0
    ds_read_b32 v106, v98 offset:128
    ds_read_b32 v108, v98 offset:512
    ds_read_b32 v110, v98 offset:640
    ds_read_b128 v[132:135], v100 offset:1280
    ds_read_b128 v[136:139], v100 offset:1312
    ds_read_b128 v[140:143], v100 offset:1344
    ds_read_b128 v[144:147], v100 offset:1376
    ds_read_b32 v112, v101 offset:1536
    ds_read_b128 v[180:183], v99 offset:512
    ds_read_b128 v[184:187], v99 offset:544
    ds_read_b128 v[188:191], v99 offset:576
    ds_read_b128 v[192:195], v99 offset:608
    ds_read_b128 v[196:199], v99 offset:640
    ds_read_b128 v[200:203], v99 offset:672
    ds_read_b128 v[204:207], v99 offset:704
    ds_read_b128 v[208:211], v99 offset:736
    s_lshl_b32 s30, s25, 1
    s_add_u32 s30, s30, s35
    s_lshl_b32 s30, s30, 6
    s_lshl_b32 s31, s24, 2
    s_add_u32 s30, s30, s31
    s_lshl_b32 s31, s34, 1
    s_add_u32 s30, s30, s31
    s_lshl_b32 s32, s30, 12
    s_add_u32 s32, s32, s26
    s_add_u32 s33, s32, 4096
    s_mul_i32 s30, s35, 49152
    s_lshl_b32 s31, s34, 13
    s_add_u32 s30, s30, s31
    s_add_u32 s30, s30, 81920
    v_add_u32 v96, s30, v253
    s_lshl_b32 s30, s3, 12
    s_add_u32 s30, s30, 147456
    v_add_u32 v97, s30, v253
    s_waitcnt lgkmcnt(9)
    v_pk_fma_f32 v[32:33], v[132:133], v[108:109], v[32:33] op_sel_hi:[1,0,1] neg_lo:[0,1,0] neg_hi:[0,1,0]
    v_pk_fma_f32 v[34:35], v[134:135], v[108:109], v[34:35] op_sel_hi:[1,0,1] neg_lo:[0,1,0] neg_hi:[0,1,0]
    v_pk_fma_f32 v[36:37], v[136:137], v[108:109], v[36:37] op_sel_hi:[1,0,1] neg_lo:[0,1,0] neg_hi:[0,1,0]
    v_pk_fma_f32 v[38:39], v[138:139], v[108:109], v[38:39] op_sel_hi:[1,0,1] neg_lo:[0,1,0] neg_hi:[0,1,0]
    v_pk_fma_f32 v[40:41], v[140:141], v[108:109], v[40:41] op_sel_hi:[1,0,1] neg_lo:[0,1,0] neg_hi:[0,1,0]
    v_pk_fma_f32 v[42:43], v[142:143], v[108:109], v[42:43] op_sel_hi:[1,0,1] neg_lo:[0,1,0] neg_hi:[0,1,0]
    v_pk_fma_f32 v[44:45], v[144:145], v[108:109], v[44:45] op_sel_hi:[1,0,1] neg_lo:[0,1,0] neg_hi:[0,1,0]
    v_pk_fma_f32 v[46:47], v[146:147], v[108:109], v[46:47] op_sel_hi:[1,0,1] neg_lo:[0,1,0] neg_hi:[0,1,0]
    v_pk_mul_f32 v[32:33], v[32:33], v[104:105] op_sel_hi:[1,0]
    v_pk_mul_f32 v[34:35], v[34:35], v[104:105] op_sel_hi:[1,0]
    v_pk_mul_f32 v[36:37], v[36:37], v[104:105] op_sel_hi:[1,0]
    v_pk_mul_f32 v[38:39], v[38:39], v[104:105] op_sel_hi:[1,0]
    v_pk_mul_f32 v[40:41], v[40:41], v[104:105] op_sel_hi:[1,0]
    v_pk_mul_f32 v[42:43], v[42:43], v[104:105] op_sel_hi:[1,0]
    v_pk_mul_f32 v[44:45], v[44:45], v[104:105] op_sel_hi:[1,0]
    v_pk_mul_f32 v[46:47], v[46:47], v[104:105] op_sel_hi:[1,0]
    v_cvt_pk_bf16_f32 v32, v32, v33
    v_cvt_pk_bf16_f32 v33, v34, v35
    v_cvt_pk_bf16_f32 v34, v36, v37
    v_cvt_pk_bf16_f32 v35, v38, v39
    v_cvt_pk_bf16_f32 v36, v40, v41
    v_cvt_pk_bf16_f32 v37, v42, v43
    v_cvt_pk_bf16_f32 v38, v44, v45
    v_cvt_pk_bf16_f32 v39, v46, v47
    ds_read_b128 v[148:151], v99 offset:0
    ds_read_b128 v[152:155], v99 offset:32
    ds_read_b128 v[156:159], v99 offset:64
    ds_read_b128 v[160:163], v99 offset:96
    ds_read_b128 v[164:167], v99 offset:128
    ds_read_b128 v[168:171], v99 offset:160
    ds_read_b128 v[172:175], v99 offset:192
    ds_read_b128 v[176:179], v99 offset:224
    ds_read_b128 v[116:119], v100 offset:1024
    ds_read_b128 v[120:123], v100 offset:1056
    ds_read_b128 v[124:127], v100 offset:1088
    ds_read_b128 v[128:131], v100 offset:1120
    buffer_store_dwordx4 v[32:35], v253, s[20:23], s32 offen offset:0 sc1
    buffer_store_dwordx4 v[36:39], v253, s[20:23], s32 offen offset:1024 sc1
    v_pk_fma_f32 v[48:49], v[132:133], v[110:111], v[48:49] op_sel_hi:[1,0,1] neg_lo:[0,1,0] neg_hi:[0,1,0]
    v_pk_fma_f32 v[50:51], v[134:135], v[110:111], v[50:51] op_sel_hi:[1,0,1] neg_lo:[0,1,0] neg_hi:[0,1,0]
    v_pk_fma_f32 v[52:53], v[136:137], v[110:111], v[52:53] op_sel_hi:[1,0,1] neg_lo:[0,1,0] neg_hi:[0,1,0]
    v_pk_fma_f32 v[54:55], v[138:139], v[110:111], v[54:55] op_sel_hi:[1,0,1] neg_lo:[0,1,0] neg_hi:[0,1,0]
    v_pk_fma_f32 v[56:57], v[140:141], v[110:111], v[56:57] op_sel_hi:[1,0,1] neg_lo:[0,1,0] neg_hi:[0,1,0]
    v_pk_fma_f32 v[58:59], v[142:143], v[110:111], v[58:59] op_sel_hi:[1,0,1] neg_lo:[0,1,0] neg_hi:[0,1,0]
    v_pk_fma_f32 v[60:61], v[144:145], v[110:111], v[60:61] op_sel_hi:[1,0,1] neg_lo:[0,1,0] neg_hi:[0,1,0]
    v_pk_fma_f32 v[62:63], v[146:147], v[110:111], v[62:63] op_sel_hi:[1,0,1] neg_lo:[0,1,0] neg_hi:[0,1,0]
    v_pk_mul_f32 v[48:49], v[48:49], v[106:107] op_sel_hi:[1,0]
    v_pk_mul_f32 v[50:51], v[50:51], v[106:107] op_sel_hi:[1,0]
    v_pk_mul_f32 v[52:53], v[52:53], v[106:107] op_sel_hi:[1,0]
    v_pk_mul_f32 v[54:55], v[54:55], v[106:107] op_sel_hi:[1,0]
    v_pk_mul_f32 v[56:57], v[56:57], v[106:107] op_sel_hi:[1,0]
    v_pk_mul_f32 v[58:59], v[58:59], v[106:107] op_sel_hi:[1,0]
    v_pk_mul_f32 v[60:61], v[60:61], v[106:107] op_sel_hi:[1,0]
    v_pk_mul_f32 v[62:63], v[62:63], v[106:107] op_sel_hi:[1,0]
    v_cvt_pk_bf16_f32 v48, v48, v49
    v_cvt_pk_bf16_f32 v49, v50, v51
    v_cvt_pk_bf16_f32 v50, v52, v53
    v_cvt_pk_bf16_f32 v51, v54, v55
    v_cvt_pk_bf16_f32 v52, v56, v57
    v_cvt_pk_bf16_f32 v53, v58, v59
    v_cvt_pk_bf16_f32 v54, v60, v61
    v_cvt_pk_bf16_f32 v55, v62, v63
    buffer_store_dwordx4 v[48:51], v253, s[20:23], s33 offen offset:0 sc1
    buffer_store_dwordx4 v[52:55], v253, s[20:23], s33 offen offset:1024 sc1
    s_waitcnt lgkmcnt(0)
    v_pk_fma_f32 v[64:65], v[180:181], v[112:113], v[64:65] op_sel_hi:[1,0,1] neg_lo:[0,1,0] neg_hi:[0,1,0]
    v_pk_fma_f32 v[66:67], v[182:183], v[112:113], v[66:67] op_sel_hi:[1,0,1] neg_lo:[0,1,0] neg_hi:[0,1,0]
    v_pk_fma_f32 v[68:69], v[184:185], v[112:113], v[68:69] op_sel_hi:[1,0,1] neg_lo:[0,1,0] neg_hi:[0,1,0]
    v_pk_fma_f32 v[70:71], v[186:187], v[112:113], v[70:71] op_sel_hi:[1,0,1] neg_lo:[0,1,0] neg_hi:[0,1,0]
    v_pk_fma_f32 v[72:73], v[188:189], v[112:113], v[72:73] op_sel_hi:[1,0,1] neg_lo:[0,1,0] neg_hi:[0,1,0]
    v_pk_fma_f32 v[74:75], v[190:191], v[112:113], v[74:75] op_sel_hi:[1,0,1] neg_lo:[0,1,0] neg_hi:[0,1,0]
    v_pk_fma_f32 v[76:77], v[192:193], v[112:113], v[76:77] op_sel_hi:[1,0,1] neg_lo:[0,1,0] neg_hi:[0,1,0]
    v_pk_fma_f32 v[78:79], v[194:195], v[112:113], v[78:79] op_sel_hi:[1,0,1] neg_lo:[0,1,0] neg_hi:[0,1,0]
    v_pk_mul_f32 v[64:65], v[64:65], v[148:149]
    v_pk_mul_f32 v[66:67], v[66:67], v[150:151]
    v_pk_mul_f32 v[68:69], v[68:69], v[152:153]
    v_pk_mul_f32 v[70:71], v[70:71], v[154:155]
    v_pk_mul_f32 v[72:73], v[72:73], v[156:157]
    v_pk_mul_f32 v[74:75], v[74:75], v[158:159]
    v_pk_mul_f32 v[76:77], v[76:77], v[160:161]
    v_pk_mul_f32 v[78:79], v[78:79], v[162:163]
    v_cvt_pk_bf16_f32 v64, v64, v65
    v_cvt_pk_bf16_f32 v65, v66, v67
    v_cvt_pk_bf16_f32 v66, v68, v69
    v_cvt_pk_bf16_f32 v67, v70, v71
    v_cvt_pk_bf16_f32 v68, v72, v73
    v_cvt_pk_bf16_f32 v69, v74, v75
    v_cvt_pk_bf16_f32 v70, v76, v77
    v_cvt_pk_bf16_f32 v71, v78, v79
    buffer_store_dwordx4 v[64:67], v253, s[20:23], s32 offen offset:2048 sc1
    buffer_store_dwordx4 v[68:71], v253, s[20:23], s32 offen offset:3072 sc1
    v_pk_fma_f32 v[80:81], v[196:197], v[112:113], v[80:81] op_sel_hi:[1,0,1] neg_lo:[0,1,0] neg_hi:[0,1,0]
    v_pk_fma_f32 v[82:83], v[198:199], v[112:113], v[82:83] op_sel_hi:[1,0,1] neg_lo:[0,1,0] neg_hi:[0,1,0]
    v_pk_fma_f32 v[84:85], v[200:201], v[112:113], v[84:85] op_sel_hi:[1,0,1] neg_lo:[0,1,0] neg_hi:[0,1,0]
    v_pk_fma_f32 v[86:87], v[202:203], v[112:113], v[86:87] op_sel_hi:[1,0,1] neg_lo:[0,1,0] neg_hi:[0,1,0]
    v_pk_fma_f32 v[88:89], v[204:205], v[112:113], v[88:89] op_sel_hi:[1,0,1] neg_lo:[0,1,0] neg_hi:[0,1,0]
    v_pk_fma_f32 v[90:91], v[206:207], v[112:113], v[90:91] op_sel_hi:[1,0,1] neg_lo:[0,1,0] neg_hi:[0,1,0]
    v_pk_fma_f32 v[92:93], v[208:209], v[112:113], v[92:93] op_sel_hi:[1,0,1] neg_lo:[0,1,0] neg_hi:[0,1,0]
    v_pk_fma_f32 v[94:95], v[210:211], v[112:113], v[94:95] op_sel_hi:[1,0,1] neg_lo:[0,1,0] neg_hi:[0,1,0]
    v_pk_mul_f32 v[80:81], v[80:81], v[164:165]
    v_pk_mul_f32 v[82:83], v[82:83], v[166:167]
    v_pk_mul_f32 v[84:85], v[84:85], v[168:169]
    v_pk_mul_f32 v[86:87], v[86:87], v[170:171]
    v_pk_mul_f32 v[88:89], v[88:89], v[172:173]
    v_pk_mul_f32 v[90:91], v[90:91], v[174:175]
    v_pk_mul_f32 v[92:93], v[92:93], v[176:177]
    v_pk_mul_f32 v[94:95], v[94:95], v[178:179]
    v_cvt_pk_bf16_f32 v80, v80, v81
    v_cvt_pk_bf16_f32 v81, v82, v83
    v_cvt_pk_bf16_f32 v82, v84, v85
    v_cvt_pk_bf16_f32 v83, v86, v87
    v_cvt_pk_bf16_f32 v84, v88, v89
    v_cvt_pk_bf16_f32 v85, v90, v91
    v_cvt_pk_bf16_f32 v86, v92, v93
    v_cvt_pk_bf16_f32 v87, v94, v95
    buffer_store_dwordx4 v[80:83], v253, s[20:23], s33 offen offset:2048 sc1
    buffer_store_dwordx4 v[84:87], v253, s[20:23], s33 offen offset:3072 sc1
    ds_write_b128 v96, v[32:35] offset:0
    ds_write_b128 v96, v[64:67] offset:2048
    ds_write_b128 v96, v[36:39] offset:1024
    ds_write_b128 v96, v[68:71] offset:3072
    ds_write_b128 v96, v[48:51] offset:4096
    ds_write_b128 v96, v[80:83] offset:6144
    ds_write_b128 v96, v[52:55] offset:5120
    ds_write_b128 v96, v[84:87] offset:7168
    v_mul_f32 v104, 0x3e8293ee, v104
    v_mul_f32 v106, 0x3e8293ee, v106
    v_pk_fma_f32 v[0:1], v[116:117], v[108:109], v[0:1] op_sel_hi:[1,0,1] neg_lo:[0,1,0] neg_hi:[0,1,0]
    v_pk_fma_f32 v[2:3], v[118:119], v[108:109], v[2:3] op_sel_hi:[1,0,1] neg_lo:[0,1,0] neg_hi:[0,1,0]
    v_pk_fma_f32 v[4:5], v[120:121], v[108:109], v[4:5] op_sel_hi:[1,0,1] neg_lo:[0,1,0] neg_hi:[0,1,0]
    v_pk_fma_f32 v[6:7], v[122:123], v[108:109], v[6:7] op_sel_hi:[1,0,1] neg_lo:[0,1,0] neg_hi:[0,1,0]
    v_pk_fma_f32 v[8:9], v[124:125], v[108:109], v[8:9] op_sel_hi:[1,0,1] neg_lo:[0,1,0] neg_hi:[0,1,0]
    v_pk_fma_f32 v[10:11], v[126:127], v[108:109], v[10:11] op_sel_hi:[1,0,1] neg_lo:[0,1,0] neg_hi:[0,1,0]
    v_pk_fma_f32 v[12:13], v[128:129], v[108:109], v[12:13] op_sel_hi:[1,0,1] neg_lo:[0,1,0] neg_hi:[0,1,0]
    v_pk_fma_f32 v[14:15], v[130:131], v[108:109], v[14:15] op_sel_hi:[1,0,1] neg_lo:[0,1,0] neg_hi:[0,1,0]
    v_pk_mul_f32 v[0:1], v[0:1], v[104:105] op_sel_hi:[1,0]
    v_pk_mul_f32 v[2:3], v[2:3], v[104:105] op_sel_hi:[1,0]
    v_pk_mul_f32 v[4:5], v[4:5], v[104:105] op_sel_hi:[1,0]
    v_pk_mul_f32 v[6:7], v[6:7], v[104:105] op_sel_hi:[1,0]
    v_pk_mul_f32 v[8:9], v[8:9], v[104:105] op_sel_hi:[1,0]
    v_pk_mul_f32 v[10:11], v[10:11], v[104:105] op_sel_hi:[1,0]
    v_pk_mul_f32 v[12:13], v[12:13], v[104:105] op_sel_hi:[1,0]
    v_pk_mul_f32 v[14:15], v[14:15], v[104:105] op_sel_hi:[1,0]
    v_cvt_pk_bf16_f32 v0, v0, v1
    v_cvt_pk_bf16_f32 v1, v2, v3
    v_cvt_pk_bf16_f32 v2, v4, v5
    v_cvt_pk_bf16_f32 v3, v6, v7
    v_cvt_pk_bf16_f32 v4, v8, v9
    v_cvt_pk_bf16_f32 v5, v10, v11
    v_cvt_pk_bf16_f32 v6, v12, v13
    v_cvt_pk_bf16_f32 v7, v14, v15
    ds_write_b128 v97, v[0:3] offset:0
    ds_write_b128 v97, v[4:7] offset:1024
    v_pk_fma_f32 v[16:17], v[116:117], v[110:111], v[16:17] op_sel_hi:[1,0,1] neg_lo:[0,1,0] neg_hi:[0,1,0]
    v_pk_fma_f32 v[18:19], v[118:119], v[110:111], v[18:19] op_sel_hi:[1,0,1] neg_lo:[0,1,0] neg_hi:[0,1,0]
    v_pk_fma_f32 v[20:21], v[120:121], v[110:111], v[20:21] op_sel_hi:[1,0,1] neg_lo:[0,1,0] neg_hi:[0,1,0]
    v_pk_fma_f32 v[22:23], v[122:123], v[110:111], v[22:23] op_sel_hi:[1,0,1] neg_lo:[0,1,0] neg_hi:[0,1,0]
    v_pk_fma_f32 v[24:25], v[124:125], v[110:111], v[24:25] op_sel_hi:[1,0,1] neg_lo:[0,1,0] neg_hi:[0,1,0]
    v_pk_fma_f32 v[26:27], v[126:127], v[110:111], v[26:27] op_sel_hi:[1,0,1] neg_lo:[0,1,0] neg_hi:[0,1,0]
    v_pk_fma_f32 v[28:29], v[128:129], v[110:111], v[28:29] op_sel_hi:[1,0,1] neg_lo:[0,1,0] neg_hi:[0,1,0]
    v_pk_fma_f32 v[30:31], v[130:131], v[110:111], v[30:31] op_sel_hi:[1,0,1] neg_lo:[0,1,0] neg_hi:[0,1,0]
    v_pk_mul_f32 v[16:17], v[16:17], v[106:107] op_sel_hi:[1,0]
    v_pk_mul_f32 v[18:19], v[18:19], v[106:107] op_sel_hi:[1,0]
    v_pk_mul_f32 v[20:21], v[20:21], v[106:107] op_sel_hi:[1,0]
    v_pk_mul_f32 v[22:23], v[22:23], v[106:107] op_sel_hi:[1,0]
    v_pk_mul_f32 v[24:25], v[24:25], v[106:107] op_sel_hi:[1,0]
    v_pk_mul_f32 v[26:27], v[26:27], v[106:107] op_sel_hi:[1,0]
    v_pk_mul_f32 v[28:29], v[28:29], v[106:107] op_sel_hi:[1,0]
    v_pk_mul_f32 v[30:31], v[30:31], v[106:107] op_sel_hi:[1,0]
    v_cvt_pk_bf16_f32 v16, v16, v17
    v_cvt_pk_bf16_f32 v17, v18, v19
    v_cvt_pk_bf16_f32 v18, v20, v21
    v_cvt_pk_bf16_f32 v19, v22, v23
    v_cvt_pk_bf16_f32 v20, v24, v25
    v_cvt_pk_bf16_f32 v21, v26, v27
    v_cvt_pk_bf16_f32 v22, v28, v29
    v_cvt_pk_bf16_f32 v23, v30, v31
    ds_write_b128 v97, v[16:19] offset:2048
    ds_write_b128 v97, v[20:23] offset:3072
    s_lshl_b32 s30, s25, 8
    s_lshl_b32 s31, s24, 4
    s_add_u32 s30, s30, s31
    s_lshl_b32 s31, s34, 3
    s_add_u32 s30, s30, s31
    s_lshl_b32 s31, s35, 2
    s_add_u32 s30, s30, s31
    s_add_u32 s30, s30, s26
    s_add_u32 s30, s30, 0xdc1000
    v_mov_b32 v154, 0
    s_mov_b64 exec, 1
    s_waitcnt vmcnt(0)
    buffer_store_dword v154, v154, s[20:23], s30 offen sc1
    s_mov_b64 exec, -1
    s_mov_b32 s38, 0
    s_mov_b32 s39, 0
att:
    s_mov_b32 s40, 0xffffffff
    s_mov_b32 s41, 0xfffffff0
    s_mov_b32 s42, 0xfffffffe
    s_mov_b32 s43, 0xffffffe0
    s_mov_b32 s44, 0xfffffffc
    s_mov_b32 s45, 0xffffffc0
    s_mov_b32 s46, 0xfffffff8
    s_mov_b32 s47, 0xffffff80
    s_mov_b32 s48, 0xffffff00
    s_mov_b32 s49, 0xfffff000
    s_mov_b32 s50, 0xfffffe00
    s_mov_b32 s51, 0xffffe000
    s_mov_b32 s52, 0xfffffc00
    s_mov_b32 s53, 0xffffc000
    s_mov_b32 s54, 0xfffff800
    s_mov_b32 s55, 0xffff8000
    s_mov_b32 s56, 0xffff0000
    s_mov_b32 s57, 0xfff00000
    s_mov_b32 s58, 0xfffe0000
    s_mov_b32 s59, 0xffe00000
    s_mov_b32 s60, 0xfffc0000
    s_mov_b32 s61, 0xffc00000
    s_mov_b32 s62, 0xfff80000
    s_mov_b32 s63, 0xff800000
    s_mov_b32 s64, 0xff000000
    s_mov_b32 s65, 0xf0000000
    s_mov_b32 s66, 0xfe000000
    s_mov_b32 s67, 0xe0000000
    s_mov_b32 s68, 0xfc000000
    s_mov_b32 s69, 0xc0000000
    s_mov_b32 s70, 0xf8000000
    s_mov_b32 s71, 0x80000000
    v_mov_b32 v20, 0xffff
    v_mov_b32 v21, 0xffff0000
    v_cndmask_b32 v22, 0, v20, s[40:41]
    v_cndmask_b32 v23, 0, v21, s[42:43]
    v_or_b32 v12, v22, v23
    v_cndmask_b32 v22, 0, v20, s[44:45]
    v_cndmask_b32 v23, 0, v21, s[46:47]
    v_or_b32 v13, v22, v23
    v_cndmask_b32 v22, 0, v20, s[48:49]
    v_cndmask_b32 v23, 0, v21, s[50:51]
    v_or_b32 v14, v22, v23
    v_cndmask_b32 v22, 0, v20, s[52:53]
    v_cndmask_b32 v23, 0, v21, s[54:55]
    v_or_b32 v15, v22, v23
    v_cndmask_b32 v22, 0, v20, s[56:57]
    v_cndmask_b32 v23, 0, v21, s[58:59]
    v_or_b32 v16, v22, v23
    v_cndmask_b32 v22, 0, v20, s[60:61]
    v_cndmask_b32 v23, 0, v21, s[62:63]
    v_or_b32 v17, v22, v23
    v_cndmask_b32 v22, 0, v20, s[64:65]
    v_cndmask_b32 v23, 0, v21, s[66:67]
    v_or_b32 v18, v22, v23
    v_cndmask_b32 v22, 0, v20, s[68:69]
    v_cndmask_b32 v23, 0, v21, s[70:71]
    v_or_b32 v19, v22, v23
    s_lshl_b32 s37, s24, 2
    s_add_u32 s37, s37, s28
    s_lshr_b32 s35, s3, 2
    s_mul_i32 s34, s35, 12
    s_add_u32 s34, s34, s28
    s_lshl_b32 s34, s34, 12
    s_add_u32 s34, s34, 49152
    v_add_u32 v20, s34, v253
    s_lshl_b32 s34, s3, 11
    s_add_u32 s34, s34, 147456
    v_add_u32 v3, s34, v253
    v_mov_b32 v24, 0
    v_mov_b32 v25, 0
    v_mov_b32 v26, 0
    v_mov_b32 v27, 0
    v_mov_b32 v28, 0
    v_mov_b32 v29, 0
    v_mov_b32 v30, 0
    v_mov_b32 v31, 0
    v_mov_b32 v32, 0
    v_mov_b32 v33, 0
    v_mov_b32 v34, 0
    v_mov_b32 v35, 0
    v_mov_b32 v36, 0
    v_mov_b32 v37, 0
    v_mov_b32 v38, 0
    v_mov_b32 v39, 0
    s_waitcnt vmcnt(0) lgkmcnt(0)
    s_barrier
    s_cmp_eq_u32 s38, 0
    s_cbranch_scc1 att_nop
    ds_write_b16 v0, v1
    s_waitcnt lgkmcnt(0)
att_nop:
    s_barrier
    ds_read_b128 v[4:7], v3
    ds_read_b128 v[8:11], v3 offset:1024
    ds_read_b128 v[104:107], v20 offset:32768
    ds_read_b128 v[108:111], v20 offset:33792
    ds_read_b128 v[112:115], v20 offset:28672
    ds_read_b128 v[116:119], v20 offset:29696
    s_cmp_eq_u32 s39, 0
    s_cbranch_scc1 att_now
    s_load_dwordx2 s[80:81], s[0:1], 48
    s_mov_b32 s82, 0x700000
    s_mov_b32 s83, 0x20000
    v_lshrrev_b32 v153, 2, v252
    v_lshlrev_b32 v153, 2, v153
    v_bfe_u32 v154, v252, 1, 1
    v_add_u32 v153, v153, v154
    v_mul_u32_u24 v153, 28672, v153
    v_and_b32 v154, 1, v252
    v_lshl_add_u32 v153, v154, 4, v153
    s_mul_i32 s30, s28, 1835008
    s_lshl_b32 s31, s29, 5
    s_add_u32 s30, s30, s31
    s_waitcnt lgkmcnt(0)
    buffer_load_dwordx4 v[188:191], v153, s[80:83], s30 offen
    s_add_u32 s30, s30, 7168
    buffer_load_dwordx4 v[192:195], v153, s[80:83], s30 offen
    s_add_u32 s30, s30, 7168
    buffer_load_dwordx4 v[196:199], v153, s[80:83], s30 offen
    s_add_u32 s30, s30, 7168
    buffer_load_dwordx4 v[200:203], v153, s[80:83], s30 offen
    s_add_u32 s30, s30, 35840
    buffer_load_dwordx4 v[204:207], v153, s[80:83], s30 offen
    s_add_u32 s30, s30, 7168
    buffer_load_dwordx4 v[208:211], v153, s[80:83], s30 offen
    s_add_u32 s30, s30, 7168
    buffer_load_dwordx4 v[212:215], v153, s[80:83], s30 offen
    s_add_u32 s30, s30, 7168
    buffer_load_dwordx4 v[216:219], v153, s[80:83], s30 offen
    s_load_dwordx2 s[80:81], s[0:1], 56
    s_mov_b32 s82, 0x700000
    s_mov_b32 s83, 0x20000
    v_and_b32 v153, 1, v252
    v_lshlrev_b32 v153, 14, v153
    v_lshrrev_b32 v154, 1, v252
    v_lshl_add_u32 v153, v154, 4, v153
    s_lshl_b32 s30, s28, 9
    s_lshl_b32 s31, s29, 15
    s_add_u32 s30, s30, s31
    s_waitcnt lgkmcnt(0)
    buffer_load_dwordx4 v[220:223], v153, s[80:83], s30 offen
    s_add_u32 s30, s30, 2048
    buffer_load_dwordx4 v[224:227], v153, s[80:83], s30 offen
    s_add_u32 s30, s30, 2048
    buffer_load_dwordx4 v[228:231], v153, s[80:83], s30 offen
    s_add_u32 s30, s30, 2048
    buffer_load_dwordx4 v[232:235], v153, s[80:83], s30 offen
    s_add_u32 s30, s30, 2048
    buffer_load_dwordx4 v[236:239], v153, s[80:83], s30 offen
    s_add_u32 s30, s30, 2048
    buffer_load_dwordx4 v[240:243], v153, s[80:83], s30 offen
    s_add_u32 s30, s30, 2048
    buffer_load_dwordx4 v[244:247], v153, s[80:83], s30 offen
    s_add_u32 s30, s30, 2048
    buffer_load_dwordx4 v[248:251], v153, s[80:83], s30 offen
att_now:
    s_waitcnt lgkmcnt(2)
    v_mfma_f32_32x32x16_bf16 v[40:55], v[104:107], v[4:7], 0
    v_mfma_f32_32x32x16_bf16 v[40:55], v[108:111], v[8:11], v[40:55]
    ds_read_b128 v[104:107], v20 offset:24576
    ds_read_b128 v[108:111], v20 offset:25600
    s_cmp_eq_u32 s37, 0
    s_cbranch_scc0 att_a1
    v_mov_b32 v24, 0xf149f2ca
    v_mov_b32 v25, 0xf149f2ca
    v_mov_b32 v26, 0xf149f2ca
    v_mov_b32 v27, 0xf149f2ca
    v_mov_b32 v28, 0xf149f2ca
    v_mov_b32 v29, 0xf149f2ca
    v_mov_b32 v30, 0xf149f2ca
    v_mov_b32 v31, 0xf149f2ca
    v_mov_b32 v32, 0xf149f2ca
    v_mov_b32 v33, 0xf149f2ca
    v_mov_b32 v34, 0xf149f2ca
    v_mov_b32 v35, 0xf149f2ca
    v_mov_b32 v36, 0xf149f2ca
    v_mov_b32 v37, 0xf149f2ca
    v_mov_b32 v38, 0xf149f2ca
    v_mov_b32 v39, 0xf149f2ca
att_a1:
    s_waitcnt lgkmcnt(2)
    s_nop 0
    v_mfma_f32_32x32x16_bf16 v[72:87], v[112:115], v[4:7], v[24:39]
    v_mfma_f32_32x32x16_bf16 v[72:87], v[116:119], v[8:11], v[72:87]
    ds_read_b128 v[112:115], v20 offset:20480
    ds_read_b128 v[116:119], v20 offset:21504
    s_cmp_eq_u32 s37, 1
    s_cbranch_scc0 att_a2
    s_nop 1
    v_mov_b32 v24, 0xf149f2ca
    v_mov_b32 v25, 0xf149f2ca
    v_mov_b32 v26, 0xf149f2ca
    v_mov_b32 v27, 0xf149f2ca
    v_mov_b32 v28, 0xf149f2ca
    v_mov_b32 v29, 0xf149f2ca
    v_mov_b32 v30, 0xf149f2ca
    v_mov_b32 v31, 0xf149f2ca
    v_mov_b32 v32, 0xf149f2ca
    v_mov_b32 v33, 0xf149f2ca
    v_mov_b32 v34, 0xf149f2ca
    v_mov_b32 v35, 0xf149f2ca
    v_mov_b32 v36, 0xf149f2ca
    v_mov_b32 v37, 0xf149f2ca
    v_mov_b32 v38, 0xf149f2ca
    v_mov_b32 v39, 0xf149f2ca
att_a2:
    s_waitcnt lgkmcnt(2)
    s_nop 0
    v_mfma_f32_32x32x16_bf16 v[56:71], v[104:107], v[4:7], v[24:39]
    v_mfma_f32_32x32x16_bf16 v[56:71], v[108:111], v[8:11], v[56:71]
    s_nop 3
    v_max_f32 v21, v72, v73
    v_max3_f32 v21, v21, v74, v75
    v_max3_f32 v21, v21, v76, v77
    v_max3_f32 v21, v21, v78, v79
    v_max3_f32 v21, v21, v80, v81
    v_max3_f32 v21, v21, v82, v83
    v_max3_f32 v21, v21, v84, v85
    v_max3_f32 v21, v21, v86, v87
    ds_read_b128 v[104:107], v20 offset:16384
    ds_read_b128 v[108:111], v20 offset:17408
    s_cmp_eq_u32 s37, 2
    s_cbranch_scc0 att_a3
    v_mov_b32 v24, 0xf149f2ca
    v_mov_b32 v25, 0xf149f2ca
    v_mov_b32 v26, 0xf149f2ca
    v_mov_b32 v27, 0xf149f2ca
    v_mov_b32 v28, 0xf149f2ca
    v_mov_b32 v29, 0xf149f2ca
    v_mov_b32 v30, 0xf149f2ca
    v_mov_b32 v31, 0xf149f2ca
    v_mov_b32 v32, 0xf149f2ca
    v_mov_b32 v33, 0xf149f2ca
    v_mov_b32 v34, 0xf149f2ca
    v_mov_b32 v35, 0xf149f2ca
    v_mov_b32 v36, 0xf149f2ca
    v_mov_b32 v37, 0xf149f2ca
    v_mov_b32 v38, 0xf149f2ca
    v_mov_b32 v39, 0xf149f2ca
att_a3:
    s_waitcnt lgkmcnt(2)
    s_nop 0
    v_mfma_f32_32x32x16_bf16 v[72:87], v[112:115], v[4:7], v[24:39]
    v_mfma_f32_32x32x16_bf16 v[72:87], v[116:119], v[8:11], v[72:87]
    v_max3_f32 v21, v21, v56, v57
    v_max3_f32 v21, v21, v58, v59
    v_max3_f32 v21, v21, v60, v61
    v_max3_f32 v21, v21, v62, v63
    v_max3_f32 v21, v21, v64, v65
    v_max3_f32 v21, v21, v66, v67
    v_max3_f32 v21, v21, v68, v69
    v_max3_f32 v21, v21, v70, v71
    ds_read_b128 v[112:115], v20 offset:12288
    ds_read_b128 v[116:119], v20 offset:13312
    s_cmp_eq_u32 s37, 3
    s_cbranch_scc0 att_a4
    v_mov_b32 v24, 0xf149f2ca
    v_mov_b32 v25, 0xf149f2ca
    v_mov_b32 v26, 0xf149f2ca
    v_mov_b32 v27, 0xf149f2ca
    v_mov_b32 v28, 0xf149f2ca
    v_mov_b32 v29, 0xf149f2ca
    v_mov_b32 v30, 0xf149f2ca
    v_mov_b32 v31, 0xf149f2ca
    v_mov_b32 v32, 0xf149f2ca
    v_mov_b32 v33, 0xf149f2ca
    v_mov_b32 v34, 0xf149f2ca
    v_mov_b32 v35, 0xf149f2ca
    v_mov_b32 v36, 0xf149f2ca
    v_mov_b32 v37, 0xf149f2ca
    v_mov_b32 v38, 0xf149f2ca
    v_mov_b32 v39, 0xf149f2ca
att_a4:
    s_waitcnt lgkmcnt(2)
    s_nop 0
    v_mfma_f32_32x32x16_bf16 v[56:71], v[104:107], v[4:7], v[24:39]
    v_mfma_f32_32x32x16_bf16 v[56:71], v[108:111], v[8:11], v[56:71]
    v_max3_f32 v21, v21, v72, v73
    v_max3_f32 v21, v21, v74, v75
    v_max3_f32 v21, v21, v76, v77
    v_max3_f32 v21, v21, v78, v79
    v_max3_f32 v21, v21, v80, v81
    v_max3_f32 v21, v21, v82, v83
    v_max3_f32 v21, v21, v84, v85
    v_max3_f32 v21, v21, v86, v87
    ds_read_b128 v[104:107], v20 offset:8192
    ds_read_b128 v[108:111], v20 offset:9216
    s_cmp_eq_u32 s37, 4
    s_cbranch_scc0 att_a5
    v_mov_b32 v24, 0xf149f2ca
    v_mov_b32 v25, 0xf149f2ca
    v_mov_b32 v26, 0xf149f2ca
    v_mov_b32 v27, 0xf149f2ca
    v_mov_b32 v28, 0xf149f2ca
    v_mov_b32 v29, 0xf149f2ca
    v_mov_b32 v30, 0xf149f2ca
    v_mov_b32 v31, 0xf149f2ca
    v_mov_b32 v32, 0xf149f2ca
    v_mov_b32 v33, 0xf149f2ca
    v_mov_b32 v34, 0xf149f2ca
    v_mov_b32 v35, 0xf149f2ca
    v_mov_b32 v36, 0xf149f2ca
    v_mov_b32 v37, 0xf149f2ca
    v_mov_b32 v38, 0xf149f2ca
    v_mov_b32 v39, 0xf149f2ca
att_a5:
    s_waitcnt lgkmcnt(2)
    s_nop 0
    v_mfma_f32_32x32x16_bf16 v[72:87], v[112:115], v[4:7], v[24:39]
    v_mfma_f32_32x32x16_bf16 v[72:87], v[116:119], v[8:11], v[72:87]
    v_max3_f32 v21, v21, v56, v57
    v_max3_f32 v21, v21, v58, v59
    v_max3_f32 v21, v21, v60, v61
    v_max3_f32 v21, v21, v62, v63
    v_max3_f32 v21, v21, v64, v65
    v_max3_f32 v21, v21, v66, v67
    v_max3_f32 v21, v21, v68, v69
    v_max3_f32 v21, v21, v70, v71
    ds_read_b128 v[112:115], v20 offset:4096
    ds_read_b128 v[116:119], v20 offset:5120
    s_cmp_eq_u32 s37, 5
    s_cbranch_scc0 att_a6
    v_mov_b32 v24, 0xf149f2ca
    v_mov_b32 v25, 0xf149f2ca
    v_mov_b32 v26, 0xf149f2ca
    v_mov_b32 v27, 0xf149f2ca
    v_mov_b32 v28, 0xf149f2ca
    v_mov_b32 v29, 0xf149f2ca
    v_mov_b32 v30, 0xf149f2ca
    v_mov_b32 v31, 0xf149f2ca
    v_mov_b32 v32, 0xf149f2ca
    v_mov_b32 v33, 0xf149f2ca
    v_mov_b32 v34, 0xf149f2ca
    v_mov_b32 v35, 0xf149f2ca
    v_mov_b32 v36, 0xf149f2ca
    v_mov_b32 v37, 0xf149f2ca
    v_mov_b32 v38, 0xf149f2ca
    v_mov_b32 v39, 0xf149f2ca
att_a6:
    s_waitcnt lgkmcnt(2)
    s_nop 0
    v_mfma_f32_32x32x16_bf16 v[56:71], v[104:107], v[4:7], v[24:39]
    v_mfma_f32_32x32x16_bf16 v[56:71], v[108:111], v[8:11], v[56:71]
    v_max3_f32 v21, v21, v72, v73
    v_max3_f32 v21, v21, v74, v75
    v_max3_f32 v21, v21, v76, v77
    v_max3_f32 v21, v21, v78, v79
    v_max3_f32 v21, v21, v80, v81
    v_max3_f32 v21, v21, v82, v83
    v_max3_f32 v21, v21, v84, v85
    v_max3_f32 v21, v21, v86, v87
    ds_read_b128 v[104:107], v20 offset:0
    ds_read_b128 v[108:111], v20 offset:1024
    s_cmp_eq_u32 s37, 6
    s_cbranch_scc0 att_a7
    v_mov_b32 v24, 0xf149f2ca
    v_mov_b32 v25, 0xf149f2ca
    v_mov_b32 v26, 0xf149f2ca
    v_mov_b32 v27, 0xf149f2ca
    v_mov_b32 v28, 0xf149f2ca
    v_mov_b32 v29, 0xf149f2ca
    v_mov_b32 v30, 0xf149f2ca
    v_mov_b32 v31, 0xf149f2ca
    v_mov_b32 v32, 0xf149f2ca
    v_mov_b32 v33, 0xf149f2ca
    v_mov_b32 v34, 0xf149f2ca
    v_mov_b32 v35, 0xf149f2ca
    v_mov_b32 v36, 0xf149f2ca
    v_mov_b32 v37, 0xf149f2ca
    v_mov_b32 v38, 0xf149f2ca
    v_mov_b32 v39, 0xf149f2ca
att_a7:
    s_waitcnt lgkmcnt(2)
    s_nop 0
    v_mfma_f32_32x32x16_bf16 v[72:87], v[112:115], v[4:7], v[24:39]
    v_mfma_f32_32x32x16_bf16 v[72:87], v[116:119], v[8:11], v[72:87]
    v_max3_f32 v21, v21, v56, v57
    v_max3_f32 v21, v21, v58, v59
    v_max3_f32 v21, v21, v60, v61
    v_max3_f32 v21, v21, v62, v63
    v_max3_f32 v21, v21, v64, v65
    v_max3_f32 v21, v21, v66, v67
    v_max3_f32 v21, v21, v68, v69
    v_max3_f32 v21, v21, v70, v71
    s_cmp_eq_u32 s37, 7
    s_cbranch_scc0 att_a8
    v_mov_b32 v24, 0xf149f2ca
    v_mov_b32 v25, 0xf149f2ca
    v_mov_b32 v26, 0xf149f2ca
    v_mov_b32 v27, 0xf149f2ca
    v_mov_b32 v28, 0xf149f2ca
    v_mov_b32 v29, 0xf149f2ca
    v_mov_b32 v30, 0xf149f2ca
    v_mov_b32 v31, 0xf149f2ca
    v_mov_b32 v32, 0xf149f2ca
    v_mov_b32 v33, 0xf149f2ca
    v_mov_b32 v34, 0xf149f2ca
    v_mov_b32 v35, 0xf149f2ca
    v_mov_b32 v36, 0xf149f2ca
    v_mov_b32 v37, 0xf149f2ca
    v_mov_b32 v38, 0xf149f2ca
    v_mov_b32 v39, 0xf149f2ca
att_a8:
    s_waitcnt lgkmcnt(0)
    s_nop 0
    v_mfma_f32_32x32x16_bf16 v[56:71], v[104:107], v[4:7], v[24:39]
    v_mfma_f32_32x32x16_bf16 v[56:71], v[108:111], v[8:11], v[56:71]
    v_max3_f32 v21, v21, v72, v73
    v_max3_f32 v21, v21, v74, v75
    v_max3_f32 v21, v21, v76, v77
    v_max3_f32 v21, v21, v78, v79
    v_max3_f32 v21, v21, v80, v81
    v_max3_f32 v21, v21, v82, v83
    v_max3_f32 v21, v21, v84, v85
    v_max3_f32 v21, v21, v86, v87
    ds_read_b128 v[112:115], v20 offset:28672
    ds_read_b128 v[116:119], v20 offset:29696
    ds_read_b128 v[120:123], v20 offset:34816
    ds_read_b128 v[124:127], v20 offset:35840
    ds_read_b128 v[128:131], v20 offset:2048
    ds_read_b128 v[132:135], v20 offset:3072
    v_cndmask_b32 v40, v56, v40, s[40:41]
    v_cndmask_b32 v41, v57, v41, s[42:43]
    v_cndmask_b32 v42, v58, v42, s[44:45]
    v_cndmask_b32 v43, v59, v43, s[46:47]
    v_cndmask_b32 v44, v60, v44, s[48:49]
    v_cndmask_b32 v45, v61, v45, s[50:51]
    v_cndmask_b32 v46, v62, v46, s[52:53]
    v_cndmask_b32 v47, v63, v47, s[54:55]
    v_cndmask_b32 v48, v64, v48, s[56:57]
    v_cndmask_b32 v49, v65, v49, s[58:59]
    v_cndmask_b32 v50, v66, v50, s[60:61]
    v_cndmask_b32 v51, v67, v51, s[62:63]
    v_cndmask_b32 v52, v68, v52, s[64:65]
    v_cndmask_b32 v53, v69, v53, s[66:67]
    v_cndmask_b32 v54, v70, v54, s[68:69]
    v_cndmask_b32 v55, v71, v55, s[70:71]
    v_max3_f32 v21, v21, v40, v41
    v_max3_f32 v21, v21, v42, v43
    v_max3_f32 v21, v21, v44, v45
    v_max3_f32 v21, v21, v46, v47
    v_max3_f32 v21, v21, v48, v49
    v_max3_f32 v21, v21, v50, v51
    v_max3_f32 v21, v21, v52, v53
    v_max3_f32 v21, v21, v54, v55
    v_mov_b32 v152, v21
    s_nop 1
    v_permlane32_swap_b32 v21, v152
    v_max_f32 v21, v21, v152
    v_sub_f32 v24, 0, v21
    v_sub_f32 v25, 0, v21
    v_sub_f32 v26, 0, v21
    v_sub_f32 v27, 0, v21
    v_sub_f32 v28, 0, v21
    v_sub_f32 v29, 0, v21
    v_sub_f32 v30, 0, v21
    v_sub_f32 v31, 0, v21
    v_sub_f32 v32, 0, v21
    v_sub_f32 v33, 0, v21
    v_sub_f32 v34, 0, v21
    v_sub_f32 v35, 0, v21
    v_sub_f32 v36, 0, v21
    v_sub_f32 v37, 0, v21
    v_sub_f32 v38, 0, v21
    v_sub_f32 v39, 0, v21
    s_cmp_eq_u32 s37, 0
    s_cbranch_scc0 att_b1
    v_mov_b32 v24, 0xf149f2ca
    v_mov_b32 v25, 0xf149f2ca
    v_mov_b32 v26, 0xf149f2ca
    v_mov_b32 v27, 0xf149f2ca
    v_mov_b32 v28, 0xf149f2ca
    v_mov_b32 v29, 0xf149f2ca
    v_mov_b32 v30, 0xf149f2ca
    v_mov_b32 v31, 0xf149f2ca
    v_mov_b32 v32, 0xf149f2ca
    v_mov_b32 v33, 0xf149f2ca
    v_mov_b32 v34, 0xf149f2ca
    v_mov_b32 v35, 0xf149f2ca
    v_mov_b32 v36, 0xf149f2ca
    v_mov_b32 v37, 0xf149f2ca
    v_mov_b32 v38, 0xf149f2ca
    v_mov_b32 v39, 0xf149f2ca
att_b1:
    s_waitcnt lgkmcnt(4)
    s_nop 0
    v_mfma_f32_32x32x16_bf16 v[72:87], v[112:115], v[4:7], v[24:39]
    v_mfma_f32_32x32x16_bf16 v[72:87], v[116:119], v[8:11], v[72:87]
    ds_read_b128 v[104:107], v20 offset:24576
    ds_read_b128 v[108:111], v20 offset:25600
    v_sub_f32 v40, v40, v21
    v_sub_f32 v41, v41, v21
    v_sub_f32 v42, v42, v21
    v_sub_f32 v43, v43, v21
    v_sub_f32 v44, v44, v21
    v_sub_f32 v45, v45, v21
    v_sub_f32 v46, v46, v21
    v_sub_f32 v47, v47, v21
    v_sub_f32 v48, v48, v21
    v_sub_f32 v49, v49, v21
    v_sub_f32 v50, v50, v21
    v_sub_f32 v51, v51, v21
    v_sub_f32 v52, v52, v21
    v_sub_f32 v53, v53, v21
    v_sub_f32 v54, v54, v21
    v_sub_f32 v55, v55, v21
    v_exp_f32 v40, v40
    v_exp_f32 v41, v41
    v_exp_f32 v42, v42
    v_exp_f32 v43, v43
    v_exp_f32 v44, v44
    v_exp_f32 v45, v45
    v_exp_f32 v46, v46
    v_exp_f32 v47, v47
    v_exp_f32 v48, v48
    v_exp_f32 v49, v49
    v_exp_f32 v50, v50
    v_exp_f32 v51, v51
    v_exp_f32 v52, v52
    v_exp_f32 v53, v53
    v_exp_f32 v54, v54
    v_exp_f32 v55, v55
    v_add_f32 v22, v40, v41
    v_add_f32 v23, v42, v43
    v_add_f32 v22, v22, v44
    v_add_f32 v23, v23, v45
    v_add_f32 v22, v22, v46
    v_add_f32 v23, v23, v47
    v_add_f32 v22, v22, v48
    v_add_f32 v23, v23, v49
    v_add_f32 v22, v22, v50
    v_add_f32 v23, v23, v51
    v_add_f32 v22, v22, v52
    v_add_f32 v23, v23, v53
    v_add_f32 v22, v22, v54
    v_add_f32 v23, v23, v55
    v_cvt_pk_bf16_f32 v144, v40, v41
    v_cvt_pk_bf16_f32 v145, v42, v43
    v_cvt_pk_bf16_f32 v146, v44, v45
    v_cvt_pk_bf16_f32 v147, v46, v47
    v_cvt_pk_bf16_f32 v148, v48, v49
    v_cvt_pk_bf16_f32 v149, v50, v51
    v_cvt_pk_bf16_f32 v150, v52, v53
    v_cvt_pk_bf16_f32 v151, v54, v55
    v_and_b32 v136, v144, v12
    v_and_b32 v137, v145, v13
    v_and_b32 v138, v146, v14
    v_and_b32 v139, v147, v15
    v_and_b32 v140, v148, v16
    v_and_b32 v141, v149, v17
    v_and_b32 v142, v150, v18
    v_and_b32 v143, v151, v19
    v_xor_b32 v144, v144, v136
    v_xor_b32 v145, v145, v137
    v_xor_b32 v146, v146, v138
    v_xor_b32 v147, v147, v139
    v_xor_b32 v148, v148, v140
    v_xor_b32 v149, v149, v141
    v_xor_b32 v150, v150, v142
    v_xor_b32 v151, v151, v143
    s_waitcnt lgkmcnt(2)
    v_mfma_f32_32x32x16_bf16 v[88:103], v[120:123], v[136:139], 0
    v_mfma_f32_32x32x16_bf16 v[88:103], v[124:127], v[140:143], v[88:103]
    v_mfma_f32_32x32x16_bf16 v[88:103], v[128:131], v[144:147], v[88:103]
    v_mfma_f32_32x32x16_bf16 v[88:103], v[132:135], v[148:151], v[88:103]
    ds_read_b128 v[128:131], v20 offset:30720
    ds_read_b128 v[132:135], v20 offset:31744
    s_cmp_eq_u32 s37, 1
    s_cbranch_scc0 att_b2
    v_mov_b32 v24, 0xf149f2ca
    v_mov_b32 v25, 0xf149f2ca
    v_mov_b32 v26, 0xf149f2ca
    v_mov_b32 v27, 0xf149f2ca
    v_mov_b32 v28, 0xf149f2ca
    v_mov_b32 v29, 0xf149f2ca
    v_mov_b32 v30, 0xf149f2ca
    v_mov_b32 v31, 0xf149f2ca
    v_mov_b32 v32, 0xf149f2ca
    v_mov_b32 v33, 0xf149f2ca
    v_mov_b32 v34, 0xf149f2ca
    v_mov_b32 v35, 0xf149f2ca
    v_mov_b32 v36, 0xf149f2ca
    v_mov_b32 v37, 0xf149f2ca
    v_mov_b32 v38, 0xf149f2ca
    v_mov_b32 v39, 0xf149f2ca
att_b2:
    s_waitcnt lgkmcnt(2)
    s_nop 0
    v_mfma_f32_32x32x16_bf16 v[56:71], v[104:107], v[4:7], v[24:39]
    v_mfma_f32_32x32x16_bf16 v[56:71], v[108:111], v[8:11], v[56:71]
    ds_read_b128 v[112:115], v20 offset:20480
    ds_read_b128 v[116:119], v20 offset:21504
    v_exp_f32 v72, v72
    v_exp_f32 v73, v73
    v_exp_f32 v74, v74
    v_exp_f32 v75, v75
    v_exp_f32 v76, v76
    v_exp_f32 v77, v77
    v_exp_f32 v78, v78
    v_exp_f32 v79, v79
    v_exp_f32 v80, v80
    v_exp_f32 v81, v81
    v_exp_f32 v82, v82
    v_exp_f32 v83, v83
    v_exp_f32 v84, v84
    v_exp_f32 v85, v85
    v_exp_f32 v86, v86
    v_exp_f32 v87, v87
    v_add_f32 v22, v22, v72
    v_add_f32 v23, v23, v73
    v_add_f32 v22, v22, v74
    v_add_f32 v23, v23, v75
    v_add_f32 v22, v22, v76
    v_add_f32 v23, v23, v77
    v_add_f32 v22, v22, v78
    v_add_f32 v23, v23, v79
    v_add_f32 v22, v22, v80
    v_add_f32 v23, v23, v81
    v_add_f32 v22, v22, v82
    v_add_f32 v23, v23, v83
    v_add_f32 v22, v22, v84
    v_add_f32 v23, v23, v85
    v_add_f32 v22, v22, v86
    v_add_f32 v23, v23, v87
    v_cvt_pk_bf16_f32 v144, v72, v73
    v_cvt_pk_bf16_f32 v145, v74, v75
    v_cvt_pk_bf16_f32 v146, v76, v77
    v_cvt_pk_bf16_f32 v147, v78, v79
    v_cvt_pk_bf16_f32 v148, v80, v81
    v_cvt_pk_bf16_f32 v149, v82, v83
    v_cvt_pk_bf16_f32 v150, v84, v85
    v_cvt_pk_bf16_f32 v151, v86, v87
    s_waitcnt lgkmcnt(2)
    v_mfma_f32_32x32x16_bf16 v[88:103], v[128:131], v[144:147], v[88:103]
    v_mfma_f32_32x32x16_bf16 v[88:103], v[132:135], v[148:151], v[88:103]
    ds_read_b128 v[120:123], v20 offset:26624
    ds_read_b128 v[124:127], v20 offset:27648
    s_cmp_eq_u32 s37, 2
    s_cbranch_scc0 att_b3
    v_mov_b32 v24, 0xf149f2ca
    v_mov_b32 v25, 0xf149f2ca
    v_mov_b32 v26, 0xf149f2ca
    v_mov_b32 v27, 0xf149f2ca
    v_mov_b32 v28, 0xf149f2ca
    v_mov_b32 v29, 0xf149f2ca
    v_mov_b32 v30, 0xf149f2ca
    v_mov_b32 v31, 0xf149f2ca
    v_mov_b32 v32, 0xf149f2ca
    v_mov_b32 v33, 0xf149f2ca
    v_mov_b32 v34, 0xf149f2ca
    v_mov_b32 v35, 0xf149f2ca
    v_mov_b32 v36, 0xf149f2ca
    v_mov_b32 v37, 0xf149f2ca
    v_mov_b32 v38, 0xf149f2ca
    v_mov_b32 v39, 0xf149f2ca
att_b3:
    s_waitcnt lgkmcnt(2)
    s_nop 0
    v_mfma_f32_32x32x16_bf16 v[72:87], v[112:115], v[4:7], v[24:39]
    v_mfma_f32_32x32x16_bf16 v[72:87], v[116:119], v[8:11], v[72:87]
    ds_read_b128 v[104:107], v20 offset:16384
    ds_read_b128 v[108:111], v20 offset:17408
    v_exp_f32 v56, v56
    v_exp_f32 v57, v57
    v_exp_f32 v58, v58
    v_exp_f32 v59, v59
    v_exp_f32 v60, v60
    v_exp_f32 v61, v61
    v_exp_f32 v62, v62
    v_exp_f32 v63, v63
    v_exp_f32 v64, v64
    v_exp_f32 v65, v65
    v_exp_f32 v66, v66
    v_exp_f32 v67, v67
    v_exp_f32 v68, v68
    v_exp_f32 v69, v69
    v_exp_f32 v70, v70
    v_exp_f32 v71, v71
    v_add_f32 v22, v22, v56
    v_add_f32 v23, v23, v57
    v_add_f32 v22, v22, v58
    v_add_f32 v23, v23, v59
    v_add_f32 v22, v22, v60
    v_add_f32 v23, v23, v61
    v_add_f32 v22, v22, v62
    v_add_f32 v23, v23, v63
    v_add_f32 v22, v22, v64
    v_add_f32 v23, v23, v65
    v_add_f32 v22, v22, v66
    v_add_f32 v23, v23, v67
    v_add_f32 v22, v22, v68
    v_add_f32 v23, v23, v69
    v_add_f32 v22, v22, v70
    v_add_f32 v23, v23, v71
    v_cvt_pk_bf16_f32 v136, v56, v57
    v_cvt_pk_bf16_f32 v137, v58, v59
    v_cvt_pk_bf16_f32 v138, v60, v61
    v_cvt_pk_bf16_f32 v139, v62, v63
    v_cvt_pk_bf16_f32 v140, v64, v65
    v_cvt_pk_bf16_f32 v141, v66, v67
    v_cvt_pk_bf16_f32 v142, v68, v69
    v_cvt_pk_bf16_f32 v143, v70, v71
    s_waitcnt lgkmcnt(2)
    v_mfma_f32_32x32x16_bf16 v[88:103], v[120:123], v[136:139], v[88:103]
    v_mfma_f32_32x32x16_bf16 v[88:103], v[124:127], v[140:143], v[88:103]
    ds_read_b128 v[128:131], v20 offset:22528
    ds_read_b128 v[132:135], v20 offset:23552
    s_cmp_eq_u32 s37, 3
    s_cbranch_scc0 att_b4
    v_mov_b32 v24, 0xf149f2ca
    v_mov_b32 v25, 0xf149f2ca
    v_mov_b32 v26, 0xf149f2ca
    v_mov_b32 v27, 0xf149f2ca
    v_mov_b32 v28, 0xf149f2ca
    v_mov_b32 v29, 0xf149f2ca
    v_mov_b32 v30, 0xf149f2ca
    v_mov_b32 v31, 0xf149f2ca
    v_mov_b32 v32, 0xf149f2ca
    v_mov_b32 v33, 0xf149f2ca
    v_mov_b32 v34, 0xf149f2ca
    v_mov_b32 v35, 0xf149f2ca
    v_mov_b32 v36, 0xf149f2ca
    v_mov_b32 v37, 0xf149f2ca
    v_mov_b32 v38, 0xf149f2ca
    v_mov_b32 v39, 0xf149f2ca
att_b4:
    s_waitcnt lgkmcnt(2)
    s_nop 0
    v_mfma_f32_32x32x16_bf16 v[56:71], v[104:107], v[4:7], v[24:39]
    v_mfma_f32_32x32x16_bf16 v[56:71], v[108:111], v[8:11], v[56:71]
    ds_read_b128 v[112:115], v20 offset:12288
    ds_read_b128 v[116:119], v20 offset:13312
    v_exp_f32 v72, v72
    v_exp_f32 v73, v73
    v_exp_f32 v74, v74
    v_exp_f32 v75, v75
    v_exp_f32 v76, v76
    v_exp_f32 v77, v77
    v_exp_f32 v78, v78
    v_exp_f32 v79, v79
    v_exp_f32 v80, v80
    v_exp_f32 v81, v81
    v_exp_f32 v82, v82
    v_exp_f32 v83, v83
    v_exp_f32 v84, v84
    v_exp_f32 v85, v85
    v_exp_f32 v86, v86
    v_exp_f32 v87, v87
    v_add_f32 v22, v22, v72
    v_add_f32 v23, v23, v73
    v_add_f32 v22, v22, v74
    v_add_f32 v23, v23, v75
    v_add_f32 v22, v22, v76
    v_add_f32 v23, v23, v77
    v_add_f32 v22, v22, v78
    v_add_f32 v23, v23, v79
    v_add_f32 v22, v22, v80
    v_add_f32 v23, v23, v81
    v_add_f32 v22, v22, v82
    v_add_f32 v23, v23, v83
    v_add_f32 v22, v22, v84
    v_add_f32 v23, v23, v85
    v_add_f32 v22, v22, v86
    v_add_f32 v23, v23, v87
    v_cvt_pk_bf16_f32 v144, v72, v73
    v_cvt_pk_bf16_f32 v145, v74, v75
    v_cvt_pk_bf16_f32 v146, v76, v77
    v_cvt_pk_bf16_f32 v147, v78, v79
    v_cvt_pk_bf16_f32 v148, v80, v81
    v_cvt_pk_bf16_f32 v149, v82, v83
    v_cvt_pk_bf16_f32 v150, v84, v85
    v_cvt_pk_bf16_f32 v151, v86, v87
    s_waitcnt lgkmcnt(2)
    v_mfma_f32_32x32x16_bf16 v[88:103], v[128:131], v[144:147], v[88:103]
    v_mfma_f32_32x32x16_bf16 v[88:103], v[132:135], v[148:151], v[88:103]
    ds_read_b128 v[120:123], v20 offset:18432
    ds_read_b128 v[124:127], v20 offset:19456
    s_cmp_eq_u32 s37, 4
    s_cbranch_scc0 att_b5
    v_mov_b32 v24, 0xf149f2ca
    v_mov_b32 v25, 0xf149f2ca
    v_mov_b32 v26, 0xf149f2ca
    v_mov_b32 v27, 0xf149f2ca
    v_mov_b32 v28, 0xf149f2ca
    v_mov_b32 v29, 0xf149f2ca
    v_mov_b32 v30, 0xf149f2ca
    v_mov_b32 v31, 0xf149f2ca
    v_mov_b32 v32, 0xf149f2ca
    v_mov_b32 v33, 0xf149f2ca
    v_mov_b32 v34, 0xf149f2ca
    v_mov_b32 v35, 0xf149f2ca
    v_mov_b32 v36, 0xf149f2ca
    v_mov_b32 v37, 0xf149f2ca
    v_mov_b32 v38, 0xf149f2ca
    v_mov_b32 v39, 0xf149f2ca
att_b5:
    s_waitcnt lgkmcnt(2)
    s_nop 0
    v_mfma_f32_32x32x16_bf16 v[72:87], v[112:115], v[4:7], v[24:39]
    v_mfma_f32_32x32x16_bf16 v[72:87], v[116:119], v[8:11], v[72:87]
    ds_read_b128 v[104:107], v20 offset:8192
    ds_read_b128 v[108:111], v20 offset:9216
    v_exp_f32 v56, v56
    v_exp_f32 v57, v57
    v_exp_f32 v58, v58
    v_exp_f32 v59, v59
    v_exp_f32 v60, v60
    v_exp_f32 v61, v61
    v_exp_f32 v62, v62
    v_exp_f32 v63, v63
    v_exp_f32 v64, v64
    v_exp_f32 v65, v65
    v_exp_f32 v66, v66
    v_exp_f32 v67, v67
    v_exp_f32 v68, v68
    v_exp_f32 v69, v69
    v_exp_f32 v70, v70
    v_exp_f32 v71, v71
    v_add_f32 v22, v22, v56
    v_add_f32 v23, v23, v57
    v_add_f32 v22, v22, v58
    v_add_f32 v23, v23, v59
    v_add_f32 v22, v22, v60
    v_add_f32 v23, v23, v61
    v_add_f32 v22, v22, v62
    v_add_f32 v23, v23, v63
    v_add_f32 v22, v22, v64
    v_add_f32 v23, v23, v65
    v_add_f32 v22, v22, v66
    v_add_f32 v23, v23, v67
    v_add_f32 v22, v22, v68
    v_add_f32 v23, v23, v69
    v_add_f32 v22, v22, v70
    v_add_f32 v23, v23, v71
    v_cvt_pk_bf16_f32 v136, v56, v57
    v_cvt_pk_bf16_f32 v137, v58, v59
    v_cvt_pk_bf16_f32 v138, v60, v61
    v_cvt_pk_bf16_f32 v139, v62, v63
    v_cvt_pk_bf16_f32 v140, v64, v65
    v_cvt_pk_bf16_f32 v141, v66, v67
    v_cvt_pk_bf16_f32 v142, v68, v69
    v_cvt_pk_bf16_f32 v143, v70, v71
    s_waitcnt lgkmcnt(2)
    v_mfma_f32_32x32x16_bf16 v[88:103], v[120:123], v[136:139], v[88:103]
    v_mfma_f32_32x32x16_bf16 v[88:103], v[124:127], v[140:143], v[88:103]
    ds_read_b128 v[128:131], v20 offset:14336
    ds_read_b128 v[132:135], v20 offset:15360
    s_cmp_eq_u32 s37, 5
    s_cbranch_scc0 att_b6
    v_mov_b32 v24, 0xf149f2ca
    v_mov_b32 v25, 0xf149f2ca
    v_mov_b32 v26, 0xf149f2ca
    v_mov_b32 v27, 0xf149f2ca
    v_mov_b32 v28, 0xf149f2ca
    v_mov_b32 v29, 0xf149f2ca
    v_mov_b32 v30, 0xf149f2ca
    v_mov_b32 v31, 0xf149f2ca
    v_mov_b32 v32, 0xf149f2ca
    v_mov_b32 v33, 0xf149f2ca
    v_mov_b32 v34, 0xf149f2ca
    v_mov_b32 v35, 0xf149f2ca
    v_mov_b32 v36, 0xf149f2ca
    v_mov_b32 v37, 0xf149f2ca
    v_mov_b32 v38, 0xf149f2ca
    v_mov_b32 v39, 0xf149f2ca
att_b6:
    s_waitcnt lgkmcnt(2)
    s_nop 0
    v_mfma_f32_32x32x16_bf16 v[56:71], v[104:107], v[4:7], v[24:39]
    v_mfma_f32_32x32x16_bf16 v[56:71], v[108:111], v[8:11], v[56:71]
    ds_read_b128 v[112:115], v20 offset:4096
    ds_read_b128 v[116:119], v20 offset:5120
    v_exp_f32 v72, v72
    v_exp_f32 v73, v73
    v_exp_f32 v74, v74
    v_exp_f32 v75, v75
    v_exp_f32 v76, v76
    v_exp_f32 v77, v77
    v_exp_f32 v78, v78
    v_exp_f32 v79, v79
    v_exp_f32 v80, v80
    v_exp_f32 v81, v81
    v_exp_f32 v82, v82
    v_exp_f32 v83, v83
    v_exp_f32 v84, v84
    v_exp_f32 v85, v85
    v_exp_f32 v86, v86
    v_exp_f32 v87, v87
    v_add_f32 v22, v22, v72
    v_add_f32 v23, v23, v73
    v_add_f32 v22, v22, v74
    v_add_f32 v23, v23, v75
    v_add_f32 v22, v22, v76
    v_add_f32 v23, v23, v77
    v_add_f32 v22, v22, v78
    v_add_f32 v23, v23, v79
    v_add_f32 v22, v22, v80
    v_add_f32 v23, v23, v81
    v_add_f32 v22, v22, v82
    v_add_f32 v23, v23, v83
    v_add_f32 v22, v22, v84
    v_add_f32 v23, v23, v85
    v_add_f32 v22, v22, v86
    v_add_f32 v23, v23, v87
    v_cvt_pk_bf16_f32 v144, v72, v73
    v_cvt_pk_bf16_f32 v145, v74, v75
    v_cvt_pk_bf16_f32 v146, v76, v77
    v_cvt_pk_bf16_f32 v147, v78, v79
    v_cvt_pk_bf16_f32 v148, v80, v81
    v_cvt_pk_bf16_f32 v149, v82, v83
    v_cvt_pk_bf16_f32 v150, v84, v85
    v_cvt_pk_bf16_f32 v151, v86, v87
    s_waitcnt lgkmcnt(2)
    v_mfma_f32_32x32x16_bf16 v[88:103], v[128:131], v[144:147], v[88:103]
    v_mfma_f32_32x32x16_bf16 v[88:103], v[132:135], v[148:151], v[88:103]
    ds_read_b128 v[120:123], v20 offset:10240
    ds_read_b128 v[124:127], v20 offset:11264
    s_cmp_eq_u32 s37, 6
    s_cbranch_scc0 att_b7
    v_mov_b32 v24, 0xf149f2ca
    v_mov_b32 v25, 0xf149f2ca
    v_mov_b32 v26, 0xf149f2ca
    v_mov_b32 v27, 0xf149f2ca
    v_mov_b32 v28, 0xf149f2ca
    v_mov_b32 v29, 0xf149f2ca
    v_mov_b32 v30, 0xf149f2ca
    v_mov_b32 v31, 0xf149f2ca
    v_mov_b32 v32, 0xf149f2ca
    v_mov_b32 v33, 0xf149f2ca
    v_mov_b32 v34, 0xf149f2ca
    v_mov_b32 v35, 0xf149f2ca
    v_mov_b32 v36, 0xf149f2ca
    v_mov_b32 v37, 0xf149f2ca
    v_mov_b32 v38, 0xf149f2ca
    v_mov_b32 v39, 0xf149f2ca
att_b7:
    s_waitcnt lgkmcnt(2)
    s_nop 0
    v_mfma_f32_32x32x16_bf16 v[72:87], v[112:115], v[4:7], v[24:39]
    v_mfma_f32_32x32x16_bf16 v[72:87], v[116:119], v[8:11], v[72:87]
    v_exp_f32 v56, v56
    v_exp_f32 v57, v57
    v_exp_f32 v58, v58
    v_exp_f32 v59, v59
    v_exp_f32 v60, v60
    v_exp_f32 v61, v61
    v_exp_f32 v62, v62
    v_exp_f32 v63, v63
    v_exp_f32 v64, v64
    v_exp_f32 v65, v65
    v_exp_f32 v66, v66
    v_exp_f32 v67, v67
    v_exp_f32 v68, v68
    v_exp_f32 v69, v69
    v_exp_f32 v70, v70
    v_exp_f32 v71, v71
    v_add_f32 v22, v22, v56
    v_add_f32 v23, v23, v57
    v_add_f32 v22, v22, v58
    v_add_f32 v23, v23, v59
    v_add_f32 v22, v22, v60
    v_add_f32 v23, v23, v61
    v_add_f32 v22, v22, v62
    v_add_f32 v23, v23, v63
    v_add_f32 v22, v22, v64
    v_add_f32 v23, v23, v65
    v_add_f32 v22, v22, v66
    v_add_f32 v23, v23, v67
    v_add_f32 v22, v22, v68
    v_add_f32 v23, v23, v69
    v_add_f32 v22, v22, v70
    v_add_f32 v23, v23, v71
    v_cvt_pk_bf16_f32 v136, v56, v57
    v_cvt_pk_bf16_f32 v137, v58, v59
    v_cvt_pk_bf16_f32 v138, v60, v61
    v_cvt_pk_bf16_f32 v139, v62, v63
    v_cvt_pk_bf16_f32 v140, v64, v65
    v_cvt_pk_bf16_f32 v141, v66, v67
    v_cvt_pk_bf16_f32 v142, v68, v69
    v_cvt_pk_bf16_f32 v143, v70, v71
    s_waitcnt lgkmcnt(0)
    v_mfma_f32_32x32x16_bf16 v[88:103], v[120:123], v[136:139], v[88:103]
    v_mfma_f32_32x32x16_bf16 v[88:103], v[124:127], v[140:143], v[88:103]
    ds_read_b128 v[128:131], v20 offset:6144
    ds_read_b128 v[132:135], v20 offset:7168
    v_exp_f32 v72, v72
    v_exp_f32 v73, v73
    v_exp_f32 v74, v74
    v_exp_f32 v75, v75
    v_exp_f32 v76, v76
    v_exp_f32 v77, v77
    v_exp_f32 v78, v78
    v_exp_f32 v79, v79
    v_exp_f32 v80, v80
    v_exp_f32 v81, v81
    v_exp_f32 v82, v82
    v_exp_f32 v83, v83
    v_exp_f32 v84, v84
    v_exp_f32 v85, v85
    v_exp_f32 v86, v86
    v_exp_f32 v87, v87
    v_add_f32 v22, v22, v72
    v_add_f32 v23, v23, v73
    v_add_f32 v22, v22, v74
    v_add_f32 v23, v23, v75
    v_add_f32 v22, v22, v76
    v_add_f32 v23, v23, v77
    v_add_f32 v22, v22, v78
    v_add_f32 v23, v23, v79
    v_add_f32 v22, v22, v80
    v_add_f32 v23, v23, v81
    v_add_f32 v22, v22, v82
    v_add_f32 v23, v23, v83
    v_add_f32 v22, v22, v84
    v_add_f32 v23, v23, v85
    v_add_f32 v22, v22, v86
    v_add_f32 v23, v23, v87
    v_cvt_pk_bf16_f32 v144, v72, v73
    v_cvt_pk_bf16_f32 v145, v74, v75
    v_cvt_pk_bf16_f32 v146, v76, v77
    v_cvt_pk_bf16_f32 v147, v78, v79
    v_cvt_pk_bf16_f32 v148, v80, v81
    v_cvt_pk_bf16_f32 v149, v82, v83
    v_cvt_pk_bf16_f32 v150, v84, v85
    v_cvt_pk_bf16_f32 v151, v86, v87
    s_waitcnt lgkmcnt(0)
    v_mfma_f32_32x32x16_bf16 v[88:103], v[128:131], v[144:147], v[88:103]
    v_mfma_f32_32x32x16_bf16 v[88:103], v[132:135], v[148:151], v[88:103]
    v_add_f32 v22, v22, v23
    v_mov_b32 v152, v22
    s_nop 1
    v_permlane32_swap_b32 v22, v152
    v_add_f32 v22, v22, v152
    v_rcp_f32 v22, v22
    s_lshl_b32 s33, s37, 16
    s_lshl_b32 s34, s35, 15
    s_add_u32 s33, s33, s34
    s_lshl_b32 s34, s25, 11
    s_add_u32 s33, s33, s34
    s_add_u32 s33, s33, s26
    s_add_u32 s33, s33, 0x800000
    s_lshl_b32 s30, s24, 9
    s_lshl_b32 s31, s3, 6
    s_add_u32 s30, s30, s31
    s_add_u32 s30, s30, s26
    s_add_u32 s30, s30, 0xdc2000
    s_lshl_b32 s31, s25, 2
    s_add_u32 s31, s31, s30
    v_mul_f32 v88, v88, v22
    v_mul_f32 v89, v89, v22
    v_mul_f32 v90, v90, v22
    v_mul_f32 v91, v91, v22
    v_mul_f32 v92, v92, v22
    v_mul_f32 v93, v93, v22
    v_mul_f32 v94, v94, v22
    v_mul_f32 v95, v95, v22
    v_mul_f32 v96, v96, v22
    v_mul_f32 v97, v97, v22
    v_mul_f32 v98, v98, v22
    v_mul_f32 v99, v99, v22
    v_mul_f32 v100, v100, v22
    v_mul_f32 v101, v101, v22
    v_mul_f32 v102, v102, v22
    v_mul_f32 v103, v103, v22
    v_cvt_pk_bf16_f32 v88, v88, v89
    v_cvt_pk_bf16_f32 v89, v90, v91
    v_cvt_pk_bf16_f32 v90, v92, v93
    v_cvt_pk_bf16_f32 v91, v94, v95
    v_cvt_pk_bf16_f32 v92, v96, v97
    v_cvt_pk_bf16_f32 v93, v98, v99
    v_cvt_pk_bf16_f32 v94, v100, v101
    v_cvt_pk_bf16_f32 v95, v102, v103
    buffer_store_dwordx4 v[88:91], v253, s[20:23], s33 offen sc1
    buffer_store_dwordx4 v[92:95], v253, s[20:23], s33 offen offset:1024 sc1
    s_cmp_ge_u32 s3, 4
    s_cbranch_scc1 l_post
    v_mov_b32 v154, 0
    s_mov_b64 exec, 1
    s_waitcnt vmcnt(0)
    buffer_store_dword v154, v154, s[20:23], s31 offen sc1
    s_mov_b64 exec, -1
    s_load_dwordx2 s[12:13], s[0:1], 32
    s_mov_b32 s14, 0x800
    s_mov_b32 s15, 0x20000
    s_waitcnt lgkmcnt(0)
    v_lshrrev_b32 v32, 5, v252
    v_lshlrev_b32 v33, 3, v32
    s_lshl_b32 s33, s25, 7
    buffer_load_dwordx2 v[216:217], v33, s[12:15], s33 offen offset:0
    buffer_load_dwordx2 v[218:219], v33, s[12:15], s33 offen offset:16
    buffer_load_dwordx2 v[220:221], v33, s[12:15], s33 offen offset:32
    buffer_load_dwordx2 v[222:223], v33, s[12:15], s33 offen offset:48
    buffer_load_dwordx2 v[224:225], v33, s[12:15], s33 offen offset:64
    buffer_load_dwordx2 v[226:227], v33, s[12:15], s33 offen offset:80
    buffer_load_dwordx2 v[228:229], v33, s[12:15], s33 offen offset:96
    buffer_load_dwordx2 v[230:231], v33, s[12:15], s33 offen offset:112
    s_lshl_b32 s35, s72, 14
    s_lshl_b32 s34, s3, 12
    s_add_u32 s35, s35, s34
    s_add_u32 s35, s35, 0x2000000
    v_and_b32 v34, 31, v252
    s_cmp_lg_u32 s26, 0
    s_cbranch_scc1 wo_r1
    v_lshl_add_u32 v35, v34, 11, v33
    s_lshl_b32 s34, s37, 16
    s_add_u32 s34, s34, s33
    buffer_load_dwordx2 v[64:65], v35, s[4:7], s34 offen offset:0
    buffer_load_dwordx2 v[66:67], v35, s[4:7], s34 offen offset:16
    buffer_load_dwordx2 v[68:69], v35, s[4:7], s34 offen offset:32
    buffer_load_dwordx2 v[70:71], v35, s[4:7], s34 offen offset:48
    buffer_load_dwordx2 v[72:73], v35, s[4:7], s34 offen offset:64
    buffer_load_dwordx2 v[74:75], v35, s[4:7], s34 offen offset:80
    buffer_load_dwordx2 v[76:77], v35, s[4:7], s34 offen offset:96
    buffer_load_dwordx2 v[78:79], v35, s[4:7], s34 offen offset:112
    s_branch wo_r2
wo_r1:
    buffer_load_dwordx4 v[64:67], v253, s[20:23], s35 offen offset:0 sc1
    buffer_load_dwordx4 v[68:71], v253, s[20:23], s35 offen offset:1024 sc1
    buffer_load_dwordx4 v[72:75], v253, s[20:23], s35 offen offset:2048 sc1
    buffer_load_dwordx4 v[76:79], v253, s[20:23], s35 offen offset:3072 sc1
wo_r2:
    v_mov_b32 v36, 0
    ds_read_b32 v36, v36 offset:2048
    v_bfe_u32 v5, v252, 2, 2
    v_lshrrev_b32 v4, 5, v252
    v_lshl_add_u32 v6, v4, 3, v5
    v_lshlrev_b32 v6, 7, v6
    v_lshrrev_b32 v5, 1, v5
    v_lshl_add_u32 v6, v5, 6, v6
    v_bfe_u32 v5, v252, 4, 1
    v_lshl_add_u32 v6, v5, 5, v6
    v_and_b32 v5, 3, v252
    v_lshl_add_u32 v58, v5, 3, v6
    v_add_u32 v58, 4096, v58
    v_xor_b32 v59, 64, v58
    v_and_b32 v60, 15, v252
    v_lshlrev_b32 v60, 2, v60
    s_waitcnt vmcnt(0) lgkmcnt(0)
    v_lshlrev_b32 v0, 16, v64
    v_and_b32 v1, 0xffff0000, v64
    v_lshlrev_b32 v2, 16, v65
    v_and_b32 v3, 0xffff0000, v65
    v_lshlrev_b32 v4, 16, v66
    v_and_b32 v5, 0xffff0000, v66
    v_lshlrev_b32 v6, 16, v67
    v_and_b32 v7, 0xffff0000, v67
    v_lshlrev_b32 v8, 16, v68
    v_and_b32 v9, 0xffff0000, v68
    v_lshlrev_b32 v10, 16, v69
    v_and_b32 v11, 0xffff0000, v69
    v_lshlrev_b32 v12, 16, v70
    v_and_b32 v13, 0xffff0000, v70
    v_lshlrev_b32 v14, 16, v71
    v_and_b32 v15, 0xffff0000, v71
    v_lshlrev_b32 v16, 16, v72
    v_and_b32 v17, 0xffff0000, v72
    v_lshlrev_b32 v18, 16, v73
    v_and_b32 v19, 0xffff0000, v73
    v_lshlrev_b32 v20, 16, v74
    v_and_b32 v21, 0xffff0000, v74
    v_lshlrev_b32 v22, 16, v75
    v_and_b32 v23, 0xffff0000, v75
    v_lshlrev_b32 v24, 16, v76
    v_and_b32 v25, 0xffff0000, v76
    v_lshlrev_b32 v26, 16, v77
    v_and_b32 v27, 0xffff0000, v77
    v_lshlrev_b32 v28, 16, v78
    v_and_b32 v29, 0xffff0000, v78
    v_lshlrev_b32 v30, 16, v79
    v_and_b32 v31, 0xffff0000, v79
    v_fma_f32 v0, v0, v246, v247
    v_fma_f32 v1, v1, v246, v247
    v_fma_f32 v2, v2, v246, v247
    v_fma_f32 v3, v3, v246, v247
    v_fma_f32 v4, v4, v246, v247
    v_fma_f32 v5, v5, v246, v247
    v_fma_f32 v6, v6, v246, v247
    v_fma_f32 v7, v7, v246, v247
    v_fma_f32 v8, v8, v246, v247
    v_fma_f32 v9, v9, v246, v247
    v_fma_f32 v10, v10, v246, v247
    v_fma_f32 v11, v11, v246, v247
    v_fma_f32 v12, v12, v246, v247
    v_fma_f32 v13, v13, v246, v247
    v_fma_f32 v14, v14, v246, v247
    v_fma_f32 v15, v15, v246, v247
    v_fma_f32 v16, v16, v246, v247
    v_fma_f32 v17, v17, v246, v247
    v_fma_f32 v18, v18, v246, v247
    v_fma_f32 v19, v19, v246, v247
    v_fma_f32 v20, v20, v246, v247
    v_fma_f32 v21, v21, v246, v247
    v_fma_f32 v22, v22, v246, v247
    v_fma_f32 v23, v23, v246, v247
    v_fma_f32 v24, v24, v246, v247
    v_fma_f32 v25, v25, v246, v247
    v_fma_f32 v26, v26, v246, v247
    v_fma_f32 v27, v27, v246, v247
    v_fma_f32 v28, v28, v246, v247
    v_fma_f32 v29, v29, v246, v247
    v_fma_f32 v30, v30, v246, v247
    v_fma_f32 v31, v31, v246, v247
    v_mov_b32 v235, 0
    v_dot2c_f32_bf16 v235, 0x3f803f80, v216
    v_dot2c_f32_bf16 v235, 0x3f803f80, v217
    v_dot2c_f32_bf16 v235, 0x3f803f80, v218
    v_dot2c_f32_bf16 v235, 0x3f803f80, v219
    v_dot2c_f32_bf16 v235, 0x3f803f80, v220
    v_dot2c_f32_bf16 v235, 0x3f803f80, v221
    v_dot2c_f32_bf16 v235, 0x3f803f80, v222
    v_dot2c_f32_bf16 v235, 0x3f803f80, v223
    v_dot2c_f32_bf16 v235, 0x3f803f80, v224
    v_dot2c_f32_bf16 v235, 0x3f803f80, v225
    v_dot2c_f32_bf16 v235, 0x3f803f80, v226
    v_dot2c_f32_bf16 v235, 0x3f803f80, v227
    v_dot2c_f32_bf16 v235, 0x3f803f80, v228
    v_dot2c_f32_bf16 v235, 0x3f803f80, v229
    v_dot2c_f32_bf16 v235, 0x3f803f80, v230
    v_dot2c_f32_bf16 v235, 0x3f803f80, v231
    v_readfirstlane_b32 s32, v36
    s_cmp_eq_u32 s26, 0
    s_cbranch_scc1 wo_nofix
    s_lshr_b32 s34, s32, 5
    s_cmp_lg_u32 s34, s37
    s_cbranch_scc1 wo_nofix
    s_and_b32 s32, s32, 31
    v_cmp_eq_u32 vcc, s32, v34
    v_lshlrev_b32 v33, 4, v32
    s_lshl_b32 s34, s25, 8
    s_add_u32 s34, s34, 0xdc4000
    s_mov_b64 exec, vcc
    buffer_load_dwordx4 v[0:3], v33, s[20:23], s34 offen offset:0 sc1
    buffer_load_dwordx4 v[4:7], v33, s[20:23], s34 offen offset:32 sc1
    buffer_load_dwordx4 v[8:11], v33, s[20:23], s34 offen offset:64 sc1
    buffer_load_dwordx4 v[12:15], v33, s[20:23], s34 offen offset:96 sc1
    buffer_load_dwordx4 v[16:19], v33, s[20:23], s34 offen offset:128 sc1
    buffer_load_dwordx4 v[20:23], v33, s[20:23], s34 offen offset:160 sc1
    buffer_load_dwordx4 v[24:27], v33, s[20:23], s34 offen offset:192 sc1
    buffer_load_dwordx4 v[28:31], v33, s[20:23], s34 offen offset:224 sc1
    s_mov_b64 exec, -1
    s_waitcnt vmcnt(0)
wo_nofix:
    s_lshl_b32 s36, s37, 16
    s_add_u32 s36, s36, s26
    s_add_u32 s36, s36, 0x800000
    s_mov_b32 s38, 0
    s_barrier
wo_round:
    ds_read_b64_tr_b16 v[192:193], v58 offset:0
    ds_read_b64_tr_b16 v[194:195], v58 offset:512
    ds_read_b64_tr_b16 v[196:197], v59 offset:0
    ds_read_b64_tr_b16 v[198:199], v59 offset:512
    ds_read_b64_tr_b16 v[200:201], v58 offset:2048
    ds_read_b64_tr_b16 v[202:203], v58 offset:2560
    ds_read_b64_tr_b16 v[204:205], v59 offset:2048
    ds_read_b64_tr_b16 v[206:207], v59 offset:2560
    s_mov_b32 s78, s27
pl_7:
    buffer_load_dword v61, v60, s[20:23], s30 offen sc1
    s_waitcnt vmcnt(0)
pc_8:
    v_cmp_eq_u32 vcc, -1, v61
    s_cbranch_vccz pd_9
    s_sub_u32 s78, s78, 1
    s_cmp_lg_u32 s78, 0
    s_cbranch_scc1 pl_7
    s_mov_b32 s27, 1
pd_9:
    buffer_load_dwordx4 v[64:67], v253, s[20:23], s36 offen offset:0 sc1
    buffer_load_dwordx4 v[68:71], v253, s[20:23], s36 offen offset:1024 sc1
    buffer_load_dwordx4 v[72:75], v253, s[20:23], s36 offen offset:2048 sc1
    buffer_load_dwordx4 v[76:79], v253, s[20:23], s36 offen offset:3072 sc1
    s_add_u32 s36, s36, 4096
    buffer_load_dwordx4 v[80:83], v253, s[20:23], s36 offen offset:0 sc1
    buffer_load_dwordx4 v[84:87], v253, s[20:23], s36 offen offset:1024 sc1
    buffer_load_dwordx4 v[88:91], v253, s[20:23], s36 offen offset:2048 sc1
    buffer_load_dwordx4 v[92:95], v253, s[20:23], s36 offen offset:3072 sc1
    s_add_u32 s36, s36, 4096
    buffer_load_dwordx4 v[96:99], v253, s[20:23], s36 offen offset:0 sc1
    buffer_load_dwordx4 v[100:103], v253, s[20:23], s36 offen offset:1024 sc1
    buffer_load_dwordx4 v[104:107], v253, s[20:23], s36 offen offset:2048 sc1
    buffer_load_dwordx4 v[108:111], v253, s[20:23], s36 offen offset:3072 sc1
    s_add_u32 s36, s36, 4096
    buffer_load_dwordx4 v[112:115], v253, s[20:23], s36 offen offset:0 sc1
    buffer_load_dwordx4 v[116:119], v253, s[20:23], s36 offen offset:1024 sc1
    buffer_load_dwordx4 v[120:123], v253, s[20:23], s36 offen offset:2048 sc1
    buffer_load_dwordx4 v[124:127], v253, s[20:23], s36 offen offset:3072 sc1
    s_add_u32 s36, s36, 4096
    buffer_load_dwordx4 v[128:131], v253, s[20:23], s36 offen offset:0 sc1
    buffer_load_dwordx4 v[132:135], v253, s[20:23], s36 offen offset:1024 sc1
    buffer_load_dwordx4 v[136:139], v253, s[20:23], s36 offen offset:2048 sc1
    buffer_load_dwordx4 v[140:143], v253, s[20:23], s36 offen offset:3072 sc1
    s_add_u32 s36, s36, 4096
    buffer_load_dwordx4 v[144:147], v253, s[20:23], s36 offen offset:0 sc1
    buffer_load_dwordx4 v[148:151], v253, s[20:23], s36 offen offset:1024 sc1
    buffer_load_dwordx4 v[152:155], v253, s[20:23], s36 offen offset:2048 sc1
    buffer_load_dwordx4 v[156:159], v253, s[20:23], s36 offen offset:3072 sc1
    s_add_u32 s36, s36, 4096
    buffer_load_dwordx4 v[160:163], v253, s[20:23], s36 offen offset:0 sc1
    buffer_load_dwordx4 v[164:167], v253, s[20:23], s36 offen offset:1024 sc1
    buffer_load_dwordx4 v[168:171], v253, s[20:23], s36 offen offset:2048 sc1
    buffer_load_dwordx4 v[172:175], v253, s[20:23], s36 offen offset:3072 sc1
    s_add_u32 s36, s36, 4096
    buffer_load_dwordx4 v[176:179], v253, s[20:23], s36 offen offset:0 sc1
    buffer_load_dwordx4 v[180:183], v253, s[20:23], s36 offen offset:1024 sc1
    buffer_load_dwordx4 v[184:187], v253, s[20:23], s36 offen offset:2048 sc1
    buffer_load_dwordx4 v[188:191], v253, s[20:23], s36 offen offset:3072 sc1
    s_add_u32 s36, s36, 4096
    ds_read_b64_tr_b16 v[208:209], v58 offset:4096
    ds_read_b64_tr_b16 v[210:211], v58 offset:4608
    ds_read_b64_tr_b16 v[212:213], v59 offset:4096
    ds_read_b64_tr_b16 v[214:215], v59 offset:4608
    s_waitcnt vmcnt(31) lgkmcnt(8)
    v_mfma_f32_32x32x16_bf16 v[0:15], v[192:195], v[64:67], v[0:15]
    v_mfma_f32_32x32x16_bf16 v[16:31], v[196:199], v[64:67], v[16:31]
    ds_read_b64_tr_b16 v[192:193], v58 offset:6144
    ds_read_b64_tr_b16 v[194:195], v58 offset:6656
    ds_read_b64_tr_b16 v[196:197], v59 offset:6144
    ds_read_b64_tr_b16 v[198:199], v59 offset:6656
    s_waitcnt vmcnt(30) lgkmcnt(8)
    v_mfma_f32_32x32x16_bf16 v[0:15], v[200:203], v[68:71], v[0:15]
    v_mfma_f32_32x32x16_bf16 v[16:31], v[204:207], v[68:71], v[16:31]
    ds_read_b64_tr_b16 v[200:201], v58 offset:8192
    ds_read_b64_tr_b16 v[202:203], v58 offset:8704
    ds_read_b64_tr_b16 v[204:205], v59 offset:8192
    ds_read_b64_tr_b16 v[206:207], v59 offset:8704
    s_waitcnt vmcnt(29) lgkmcnt(8)
    v_mfma_f32_32x32x16_bf16 v[0:15], v[208:211], v[72:75], v[0:15]
    v_mfma_f32_32x32x16_bf16 v[16:31], v[212:215], v[72:75], v[16:31]
    ds_read_b64_tr_b16 v[208:209], v58 offset:10240
    ds_read_b64_tr_b16 v[210:211], v58 offset:10752
    ds_read_b64_tr_b16 v[212:213], v59 offset:10240
    ds_read_b64_tr_b16 v[214:215], v59 offset:10752
    s_waitcnt vmcnt(28) lgkmcnt(8)
    v_mfma_f32_32x32x16_bf16 v[0:15], v[192:195], v[76:79], v[0:15]
    v_mfma_f32_32x32x16_bf16 v[16:31], v[196:199], v[76:79], v[16:31]
    ds_read_b64_tr_b16 v[192:193], v58 offset:12288
    ds_read_b64_tr_b16 v[194:195], v58 offset:12800
    ds_read_b64_tr_b16 v[196:197], v59 offset:12288
    ds_read_b64_tr_b16 v[198:199], v59 offset:12800
    s_waitcnt vmcnt(27) lgkmcnt(8)
    v_mfma_f32_32x32x16_bf16 v[0:15], v[200:203], v[80:83], v[0:15]
    v_mfma_f32_32x32x16_bf16 v[16:31], v[204:207], v[80:83], v[16:31]
    ds_read_b64_tr_b16 v[200:201], v58 offset:14336
    ds_read_b64_tr_b16 v[202:203], v58 offset:14848
    ds_read_b64_tr_b16 v[204:205], v59 offset:14336
    ds_read_b64_tr_b16 v[206:207], v59 offset:14848
    s_waitcnt vmcnt(26) lgkmcnt(8)
    v_mfma_f32_32x32x16_bf16 v[0:15], v[208:211], v[84:87], v[0:15]
    v_mfma_f32_32x32x16_bf16 v[16:31], v[212:215], v[84:87], v[16:31]
    ds_read_b64_tr_b16 v[208:209], v58 offset:16384
    ds_read_b64_tr_b16 v[210:211], v58 offset:16896
    ds_read_b64_tr_b16 v[212:213], v59 offset:16384
    ds_read_b64_tr_b16 v[214:215], v59 offset:16896
    s_waitcnt vmcnt(25) lgkmcnt(8)
    v_mfma_f32_32x32x16_bf16 v[0:15], v[192:195], v[88:91], v[0:15]
    v_mfma_f32_32x32x16_bf16 v[16:31], v[196:199], v[88:91], v[16:31]
    ds_read_b64_tr_b16 v[192:193], v58 offset:18432
    ds_read_b64_tr_b16 v[194:195], v58 offset:18944
    ds_read_b64_tr_b16 v[196:197], v59 offset:18432
    ds_read_b64_tr_b16 v[198:199], v59 offset:18944
    s_waitcnt vmcnt(24) lgkmcnt(8)
    v_mfma_f32_32x32x16_bf16 v[0:15], v[200:203], v[92:95], v[0:15]
    v_mfma_f32_32x32x16_bf16 v[16:31], v[204:207], v[92:95], v[16:31]
    ds_read_b64_tr_b16 v[200:201], v58 offset:20480
    ds_read_b64_tr_b16 v[202:203], v58 offset:20992
    ds_read_b64_tr_b16 v[204:205], v59 offset:20480
    ds_read_b64_tr_b16 v[206:207], v59 offset:20992
    s_waitcnt vmcnt(23) lgkmcnt(8)
    v_mfma_f32_32x32x16_bf16 v[0:15], v[208:211], v[96:99], v[0:15]
    v_mfma_f32_32x32x16_bf16 v[16:31], v[212:215], v[96:99], v[16:31]
    ds_read_b64_tr_b16 v[208:209], v58 offset:22528
    ds_read_b64_tr_b16 v[210:211], v58 offset:23040
    ds_read_b64_tr_b16 v[212:213], v59 offset:22528
    ds_read_b64_tr_b16 v[214:215], v59 offset:23040
    s_waitcnt vmcnt(22) lgkmcnt(8)
    v_mfma_f32_32x32x16_bf16 v[0:15], v[192:195], v[100:103], v[0:15]
    v_mfma_f32_32x32x16_bf16 v[16:31], v[196:199], v[100:103], v[16:31]
    ds_read_b64_tr_b16 v[192:193], v58 offset:24576
    ds_read_b64_tr_b16 v[194:195], v58 offset:25088
    ds_read_b64_tr_b16 v[196:197], v59 offset:24576
    ds_read_b64_tr_b16 v[198:199], v59 offset:25088
    s_waitcnt vmcnt(21) lgkmcnt(8)
    v_mfma_f32_32x32x16_bf16 v[0:15], v[200:203], v[104:107], v[0:15]
    v_mfma_f32_32x32x16_bf16 v[16:31], v[204:207], v[104:107], v[16:31]
    ds_read_b64_tr_b16 v[200:201], v58 offset:26624
    ds_read_b64_tr_b16 v[202:203], v58 offset:27136
    ds_read_b64_tr_b16 v[204:205], v59 offset:26624
    ds_read_b64_tr_b16 v[206:207], v59 offset:27136
    s_waitcnt vmcnt(20) lgkmcnt(8)
    v_mfma_f32_32x32x16_bf16 v[0:15], v[208:211], v[108:111], v[0:15]
    v_mfma_f32_32x32x16_bf16 v[16:31], v[212:215], v[108:111], v[16:31]
    ds_read_b64_tr_b16 v[208:209], v58 offset:28672
    ds_read_b64_tr_b16 v[210:211], v58 offset:29184
    ds_read_b64_tr_b16 v[212:213], v59 offset:28672
    ds_read_b64_tr_b16 v[214:215], v59 offset:29184
    s_waitcnt vmcnt(19) lgkmcnt(8)
    v_mfma_f32_32x32x16_bf16 v[0:15], v[192:195], v[112:115], v[0:15]
    v_mfma_f32_32x32x16_bf16 v[16:31], v[196:199], v[112:115], v[16:31]
    ds_read_b64_tr_b16 v[192:193], v58 offset:30720
    ds_read_b64_tr_b16 v[194:195], v58 offset:31232
    ds_read_b64_tr_b16 v[196:197], v59 offset:30720
    ds_read_b64_tr_b16 v[198:199], v59 offset:31232
    s_waitcnt vmcnt(18) lgkmcnt(8)
    v_mfma_f32_32x32x16_bf16 v[0:15], v[200:203], v[116:119], v[0:15]
    v_mfma_f32_32x32x16_bf16 v[16:31], v[204:207], v[116:119], v[16:31]
    ds_read_b64_tr_b16 v[200:201], v58 offset:32768
    ds_read_b64_tr_b16 v[202:203], v58 offset:33280
    ds_read_b64_tr_b16 v[204:205], v59 offset:32768
    ds_read_b64_tr_b16 v[206:207], v59 offset:33280
    s_waitcnt vmcnt(17) lgkmcnt(8)
    v_mfma_f32_32x32x16_bf16 v[0:15], v[208:211], v[120:123], v[0:15]
    v_mfma_f32_32x32x16_bf16 v[16:31], v[212:215], v[120:123], v[16:31]
    ds_read_b64_tr_b16 v[208:209], v58 offset:34816
    ds_read_b64_tr_b16 v[210:211], v58 offset:35328
    ds_read_b64_tr_b16 v[212:213], v59 offset:34816
    ds_read_b64_tr_b16 v[214:215], v59 offset:35328
    s_waitcnt vmcnt(16) lgkmcnt(8)
    v_mfma_f32_32x32x16_bf16 v[0:15], v[192:195], v[124:127], v[0:15]
    v_mfma_f32_32x32x16_bf16 v[16:31], v[196:199], v[124:127], v[16:31]
    ds_read_b64_tr_b16 v[192:193], v58 offset:36864
    ds_read_b64_tr_b16 v[194:195], v58 offset:37376
    ds_read_b64_tr_b16 v[196:197], v59 offset:36864
    ds_read_b64_tr_b16 v[198:199], v59 offset:37376
    s_waitcnt vmcnt(15) lgkmcnt(8)
    v_mfma_f32_32x32x16_bf16 v[0:15], v[200:203], v[128:131], v[0:15]
    v_mfma_f32_32x32x16_bf16 v[16:31], v[204:207], v[128:131], v[16:31]
    ds_read_b64_tr_b16 v[200:201], v58 offset:38912
    ds_read_b64_tr_b16 v[202:203], v58 offset:39424
    ds_read_b64_tr_b16 v[204:205], v59 offset:38912
    ds_read_b64_tr_b16 v[206:207], v59 offset:39424
    s_waitcnt vmcnt(14) lgkmcnt(8)
    v_mfma_f32_32x32x16_bf16 v[0:15], v[208:211], v[132:135], v[0:15]
    v_mfma_f32_32x32x16_bf16 v[16:31], v[212:215], v[132:135], v[16:31]
    ds_read_b64_tr_b16 v[208:209], v58 offset:40960
    ds_read_b64_tr_b16 v[210:211], v58 offset:41472
    ds_read_b64_tr_b16 v[212:213], v59 offset:40960
    ds_read_b64_tr_b16 v[214:215], v59 offset:41472
    s_waitcnt vmcnt(13) lgkmcnt(8)
    v_mfma_f32_32x32x16_bf16 v[0:15], v[192:195], v[136:139], v[0:15]
    v_mfma_f32_32x32x16_bf16 v[16:31], v[196:199], v[136:139], v[16:31]
    ds_read_b64_tr_b16 v[192:193], v58 offset:43008
    ds_read_b64_tr_b16 v[194:195], v58 offset:43520
    ds_read_b64_tr_b16 v[196:197], v59 offset:43008
    ds_read_b64_tr_b16 v[198:199], v59 offset:43520
    s_waitcnt vmcnt(12) lgkmcnt(8)
    v_mfma_f32_32x32x16_bf16 v[0:15], v[200:203], v[140:143], v[0:15]
    v_mfma_f32_32x32x16_bf16 v[16:31], v[204:207], v[140:143], v[16:31]
    s_cmp_eq_u32 s38, 0
    s_cbranch_scc0 wo_nob
    s_barrier
wo_nob:
    ds_read_b64_tr_b16 v[200:201], v58 offset:45056
    ds_read_b64_tr_b16 v[202:203], v58 offset:45568
    ds_read_b64_tr_b16 v[204:205], v59 offset:45056
    ds_read_b64_tr_b16 v[206:207], v59 offset:45568
    s_waitcnt vmcnt(11) lgkmcnt(8)
    v_mfma_f32_32x32x16_bf16 v[0:15], v[208:211], v[144:147], v[0:15]
    v_mfma_f32_32x32x16_bf16 v[16:31], v[212:215], v[144:147], v[16:31]
    ds_read_b64_tr_b16 v[208:209], v58 offset:47104
    ds_read_b64_tr_b16 v[210:211], v58 offset:47616
    ds_read_b64_tr_b16 v[212:213], v59 offset:47104
    ds_read_b64_tr_b16 v[214:215], v59 offset:47616
    s_waitcnt vmcnt(10) lgkmcnt(8)
    v_mfma_f32_32x32x16_bf16 v[0:15], v[192:195], v[148:151], v[0:15]
    v_mfma_f32_32x32x16_bf16 v[16:31], v[196:199], v[148:151], v[16:31]
    ds_read_b64_tr_b16 v[192:193], v58 offset:49152
    ds_read_b64_tr_b16 v[194:195], v58 offset:49664
    ds_read_b64_tr_b16 v[196:197], v59 offset:49152
    ds_read_b64_tr_b16 v[198:199], v59 offset:49664
    s_waitcnt vmcnt(9) lgkmcnt(8)
    v_mfma_f32_32x32x16_bf16 v[0:15], v[200:203], v[152:155], v[0:15]
    v_mfma_f32_32x32x16_bf16 v[16:31], v[204:207], v[152:155], v[16:31]
    ds_read_b64_tr_b16 v[200:201], v58 offset:51200
    ds_read_b64_tr_b16 v[202:203], v58 offset:51712
    ds_read_b64_tr_b16 v[204:205], v59 offset:51200
    ds_read_b64_tr_b16 v[206:207], v59 offset:51712
    s_waitcnt vmcnt(8) lgkmcnt(8)
    v_mfma_f32_32x32x16_bf16 v[0:15], v[208:211], v[156:159], v[0:15]
    v_mfma_f32_32x32x16_bf16 v[16:31], v[212:215], v[156:159], v[16:31]
    ds_read_b64_tr_b16 v[208:209], v58 offset:53248
    ds_read_b64_tr_b16 v[210:211], v58 offset:53760
    ds_read_b64_tr_b16 v[212:213], v59 offset:53248
    ds_read_b64_tr_b16 v[214:215], v59 offset:53760
    s_waitcnt vmcnt(7) lgkmcnt(8)
    v_mfma_f32_32x32x16_bf16 v[0:15], v[192:195], v[160:163], v[0:15]
    v_mfma_f32_32x32x16_bf16 v[16:31], v[196:199], v[160:163], v[16:31]
    ds_read_b64_tr_b16 v[192:193], v58 offset:55296
    ds_read_b64_tr_b16 v[194:195], v58 offset:55808
    ds_read_b64_tr_b16 v[196:197], v59 offset:55296
    ds_read_b64_tr_b16 v[198:199], v59 offset:55808
    s_waitcnt vmcnt(6) lgkmcnt(8)
    v_mfma_f32_32x32x16_bf16 v[0:15], v[200:203], v[164:167], v[0:15]
    v_mfma_f32_32x32x16_bf16 v[16:31], v[204:207], v[164:167], v[16:31]
    ds_read_b64_tr_b16 v[200:201], v58 offset:57344
    ds_read_b64_tr_b16 v[202:203], v58 offset:57856
    ds_read_b64_tr_b16 v[204:205], v59 offset:57344
    ds_read_b64_tr_b16 v[206:207], v59 offset:57856
    s_waitcnt vmcnt(5) lgkmcnt(8)
    v_mfma_f32_32x32x16_bf16 v[0:15], v[208:211], v[168:171], v[0:15]
    v_mfma_f32_32x32x16_bf16 v[16:31], v[212:215], v[168:171], v[16:31]
    ds_read_b64_tr_b16 v[208:209], v58 offset:59392
    ds_read_b64_tr_b16 v[210:211], v58 offset:59904
    ds_read_b64_tr_b16 v[212:213], v59 offset:59392
    ds_read_b64_tr_b16 v[214:215], v59 offset:59904
    s_waitcnt vmcnt(4) lgkmcnt(8)
    v_mfma_f32_32x32x16_bf16 v[0:15], v[192:195], v[172:175], v[0:15]
    v_mfma_f32_32x32x16_bf16 v[16:31], v[196:199], v[172:175], v[16:31]
    ds_read_b64_tr_b16 v[192:193], v58 offset:61440
    ds_read_b64_tr_b16 v[194:195], v58 offset:61952
    ds_read_b64_tr_b16 v[196:197], v59 offset:61440
    ds_read_b64_tr_b16 v[198:199], v59 offset:61952
    s_waitcnt vmcnt(3) lgkmcnt(8)
    v_mfma_f32_32x32x16_bf16 v[0:15], v[200:203], v[176:179], v[0:15]
    v_mfma_f32_32x32x16_bf16 v[16:31], v[204:207], v[176:179], v[16:31]
    ds_read_b64_tr_b16 v[200:201], v58 offset:63488
    ds_read_b64_tr_b16 v[202:203], v58 offset:64000
    ds_read_b64_tr_b16 v[204:205], v59 offset:63488
    ds_read_b64_tr_b16 v[206:207], v59 offset:64000
    s_waitcnt vmcnt(2) lgkmcnt(8)
    v_mfma_f32_32x32x16_bf16 v[0:15], v[208:211], v[180:183], v[0:15]
    v_mfma_f32_32x32x16_bf16 v[16:31], v[212:215], v[180:183], v[16:31]
    s_waitcnt vmcnt(1) lgkmcnt(4)
    v_mfma_f32_32x32x16_bf16 v[0:15], v[192:195], v[184:187], v[0:15]
    v_mfma_f32_32x32x16_bf16 v[16:31], v[196:199], v[184:187], v[16:31]
    s_waitcnt vmcnt(0) lgkmcnt(0)
    v_mfma_f32_32x32x16_bf16 v[0:15], v[200:203], v[188:191], v[0:15]
    v_mfma_f32_32x32x16_bf16 v[16:31], v[204:207], v[188:191], v[16:31]
    v_add_u32 v58, 0x10000, v58
    v_add_u32 v59, 0x10000, v59
    s_add_u32 s30, s30, 256
    s_add_u32 s38, s38, 1
    s_cmp_eq_u32 s38, 1
    s_cbranch_scc1 wo_round
    s_barrier
    s_lshl_b32 s30, s37, 13
    s_add_u32 s30, s30, s26
    s_add_u32 s30, s30, 0xc00000
    s_lshl_b32 s31, s25, 9
    s_add_u32 s31, s31, s30
    v_mov_b32 v232, 0
    v_mov_b32 v233, 0
    v_mov_b32 v234, 0
    v_cvt_pk_bf16_f32 v32, v0, v1
    v_cvt_pk_bf16_f32 v33, v2, v3
    v_cvt_pk_bf16_f32 v34, v4, v5
    v_cvt_pk_bf16_f32 v35, v6, v7
    v_cvt_pk_bf16_f32 v36, v8, v9
    v_cvt_pk_bf16_f32 v37, v10, v11
    v_cvt_pk_bf16_f32 v38, v12, v13
    v_cvt_pk_bf16_f32 v39, v14, v15
    v_cvt_pk_bf16_f32 v40, v16, v17
    v_cvt_pk_bf16_f32 v41, v18, v19
    v_cvt_pk_bf16_f32 v42, v20, v21
    v_cvt_pk_bf16_f32 v43, v22, v23
    v_cvt_pk_bf16_f32 v44, v24, v25
    v_cvt_pk_bf16_f32 v45, v26, v27
    v_cvt_pk_bf16_f32 v46, v28, v29
    v_cvt_pk_bf16_f32 v47, v30, v31
    s_cmp_lg_u32 s26, 0
    s_cbranch_scc1 wo_nox
    buffer_store_dwordx4 v[32:35], v253, s[20:23], s35 offen offset:0 sc1
    buffer_store_dwordx4 v[36:39], v253, s[20:23], s35 offen offset:1024 sc1
    buffer_store_dwordx4 v[40:43], v253, s[20:23], s35 offen offset:2048 sc1
    buffer_store_dwordx4 v[44:47], v253, s[20:23], s35 offen offset:3072 sc1
wo_nox:
    v_dot2c_f32_bf16 v232, 0x3f803f80, v32
    v_dot2c_f32_bf16 v233, v32, v32
    v_dot2c_f32_bf16 v234, v216, v32
    v_dot2c_f32_bf16 v232, 0x3f803f80, v33
    v_dot2c_f32_bf16 v233, v33, v33
    v_dot2c_f32_bf16 v234, v217, v33
    v_dot2c_f32_bf16 v232, 0x3f803f80, v34
    v_dot2c_f32_bf16 v233, v34, v34
    v_dot2c_f32_bf16 v234, v218, v34
    v_dot2c_f32_bf16 v232, 0x3f803f80, v35
    v_dot2c_f32_bf16 v233, v35, v35
    v_dot2c_f32_bf16 v234, v219, v35
    v_dot2c_f32_bf16 v232, 0x3f803f80, v36
    v_dot2c_f32_bf16 v233, v36, v36
    v_dot2c_f32_bf16 v234, v220, v36
    v_dot2c_f32_bf16 v232, 0x3f803f80, v37
    v_dot2c_f32_bf16 v233, v37, v37
    v_dot2c_f32_bf16 v234, v221, v37
    v_dot2c_f32_bf16 v232, 0x3f803f80, v38
    v_dot2c_f32_bf16 v233, v38, v38
    v_dot2c_f32_bf16 v234, v222, v38
    v_dot2c_f32_bf16 v232, 0x3f803f80, v39
    v_dot2c_f32_bf16 v233, v39, v39
    v_dot2c_f32_bf16 v234, v223, v39
    v_dot2c_f32_bf16 v232, 0x3f803f80, v40
    v_dot2c_f32_bf16 v233, v40, v40
    v_dot2c_f32_bf16 v234, v224, v40
    v_dot2c_f32_bf16 v232, 0x3f803f80, v41
    v_dot2c_f32_bf16 v233, v41, v41
    v_dot2c_f32_bf16 v234, v225, v41
    v_dot2c_f32_bf16 v232, 0x3f803f80, v42
    v_dot2c_f32_bf16 v233, v42, v42
    v_dot2c_f32_bf16 v234, v226, v42
    v_dot2c_f32_bf16 v232, 0x3f803f80, v43
    v_dot2c_f32_bf16 v233, v43, v43
    v_dot2c_f32_bf16 v234, v227, v43
    v_dot2c_f32_bf16 v232, 0x3f803f80, v44
    v_dot2c_f32_bf16 v233, v44, v44
    v_dot2c_f32_bf16 v234, v228, v44
    v_dot2c_f32_bf16 v232, 0x3f803f80, v45
    v_dot2c_f32_bf16 v233, v45, v45
    v_dot2c_f32_bf16 v234, v229, v45
    v_dot2c_f32_bf16 v232, 0x3f803f80, v46
    v_dot2c_f32_bf16 v233, v46, v46
    v_dot2c_f32_bf16 v234, v230, v46
    v_dot2c_f32_bf16 v232, 0x3f803f80, v47
    v_dot2c_f32_bf16 v233, v47, v47
    v_dot2c_f32_bf16 v234, v231, v47
    s_nop 0
    v_mov_b32 v48, v232
    v_mov_b32 v49, v233
    v_mov_b32 v50, v234
    v_mov_b32 v51, v235
    v_permlane32_swap_b32 v232, v48
    v_permlane32_swap_b32 v233, v49
    v_permlane32_swap_b32 v234, v50
    v_permlane32_swap_b32 v235, v51
    v_add_f32 v232, v232, v48
    v_add_f32 v233, v233, v49
    v_add_f32 v234, v234, v50
    v_add_f32 v235, v235, v51
    s_mov_b32 exec_hi, 0
    s_waitcnt vmcnt(0)
    buffer_store_dwordx4 v[232:235], v253, s[20:23], s31 offen sc1
    s_mov_b64 exec, -1
    s_add_u32 s31, s30, 4096
    s_mov_b32 s78, s27
pl_10:
    buffer_load_dwordx4 v[64:67], v253, s[20:23], s30 offen offset:0 sc1
    buffer_load_dwordx4 v[68:71], v253, s[20:23], s30 offen offset:1024 sc1
    buffer_load_dwordx4 v[72:75], v253, s[20:23], s30 offen offset:2048 sc1
    buffer_load_dwordx4 v[76:79], v253, s[20:23], s30 offen offset:3072 sc1
    buffer_load_dwordx4 v[80:83], v253, s[20:23], s31 offen offset:0 sc1
    buffer_load_dwordx4 v[84:87], v253, s[20:23], s31 offen offset:1024 sc1
    buffer_load_dwordx4 v[88:91], v253, s[20:23], s31 offen offset:2048 sc1
    buffer_load_dwordx4 v[92:95], v253, s[20:23], s31 offen offset:3072 sc1
    s_waitcnt vmcnt(0)
pc_11:
    v_max3_u32 v48, v64, v65, v66
    v_max3_u32 v48, v48, v67, v68
    v_max3_u32 v48, v48, v69, v70
    v_max3_u32 v48, v48, v71, v72
    v_max3_u32 v48, v48, v73, v74
    v_max3_u32 v48, v48, v75, v76
    v_max3_u32 v48, v48, v77, v78
    v_max3_u32 v48, v48, v79, v80
    v_max3_u32 v48, v48, v81, v82
    v_max3_u32 v48, v48, v83, v84
    v_max3_u32 v48, v48, v85, v86
    v_max3_u32 v48, v48, v87, v88
    v_max3_u32 v48, v48, v89, v90
    v_max3_u32 v48, v48, v91, v92
    v_max3_u32 v48, v48, v93, v94
    v_max_u32 v48, v48, v95
    v_cmp_eq_u32 vcc, -1, v48
    s_cbranch_vccz pd_12
    s_sub_u32 s78, s78, 1
    s_cmp_lg_u32 s78, 0
    s_cbranch_scc1 pl_10
    s_mov_b32 s27, 1
pd_12:
    v_add_f32 v64, v64, v68
    v_add_f32 v65, v65, v69
    v_add_f32 v66, v66, v70
    v_add_f32 v67, v67, v71
    v_add_f32 v64, v64, v72
    v_add_f32 v65, v65, v73
    v_add_f32 v66, v66, v74
    v_add_f32 v67, v67, v75
    v_add_f32 v64, v64, v76
    v_add_f32 v65, v65, v77
    v_add_f32 v66, v66, v78
    v_add_f32 v67, v67, v79
    v_add_f32 v64, v64, v80
    v_add_f32 v65, v65, v81
    v_add_f32 v66, v66, v82
    v_add_f32 v67, v67, v83
    v_add_f32 v64, v64, v84
    v_add_f32 v65, v65, v85
    v_add_f32 v66, v66, v86
    v_add_f32 v67, v67, v87
    v_add_f32 v64, v64, v88
    v_add_f32 v65, v65, v89
    v_add_f32 v66, v66, v90
    v_add_f32 v67, v67, v91
    v_add_f32 v64, v64, v92
    v_add_f32 v65, v65, v93
    v_add_f32 v66, v66, v94
    v_add_f32 v67, v67, v95
    v_mov_b32 v48, v64
    v_mov_b32 v49, v65
    v_mov_b32 v50, v66
    v_mov_b32 v51, v67
    v_permlane32_swap_b32 v64, v48
    v_permlane32_swap_b32 v65, v49
    v_permlane32_swap_b32 v66, v50
    v_permlane32_swap_b32 v67, v51
    v_add_f32 v64, v64, v48
    v_add_f32 v65, v65, v49
    v_add_f32 v66, v66, v50
    v_add_f32 v67, v67, v51
    v_mul_f32 v54, 0x3a800000, v64
    v_mul_f32 v65, 0x3a800000, v65
    v_fma_f32 v65, -v54, v54, v65
    v_max_f32 v65, 0, v65
    v_add_f32 v55, 0x3727c5ac, v65
    v_rsq_f32 v55, v55
    v_fma_f32 v52, -v54, v67, v66
    v_and_b32 v53, 31, v252
    v_mul_f32 v52, v52, v55
    s_lshl_b32 s32, s37, 5
    v_add_u32 v53, s32, v53
    v_mov_b32 v48, v52
    s_nop 1
    v_max_f32_dpp v48, v48, v48 quad_perm:[1,0,3,2] row_mask:0xf bank_mask:0xf
    s_nop 1
    v_max_f32_dpp v48, v48, v48 quad_perm:[2,3,0,1] row_mask:0xf bank_mask:0xf
    s_nop 1
    v_max_f32_dpp v48, v48, v48 row_half_mirror row_mask:0xf bank_mask:0xf
    s_nop 1
    v_max_f32_dpp v48, v48, v48 row_mirror row_mask:0xf bank_mask:0xf
    v_mov_b32 v49, v48
    s_nop 1
    v_permlane16_swap_b32 v48, v49
    v_max_f32 v48, v48, v49
    v_cmp_eq_f32 vcc, v48, v52
    v_lshrrev_b32 v49, 5, v252
    v_lshlrev_b32 v50, 4, v49
    s_ff1_i32_b32 s33, vcc_lo
    s_and_b32 s33, s33, 31
    s_lshl_b32 s38, 1, s33
    s_add_u32 s39, s33, s32
    s_lshl_b32 s32, s37, 11
    s_lshl_b32 s33, s25, 7
    s_add_u32 s32, s32, s33
    s_add_u32 s32, s32, s26
    s_add_u32 s32, s32, 0xd60000
    s_lshl_b32 s34, s37, 4
    s_add_u32 s34, s34, s26
    s_add_u32 s34, s34, 0xdc0000
    s_mov_b32 exec_lo, s38
    s_mov_b32 exec_hi, s38
    buffer_store_dwordx4 v[32:35], v50, s[20:23], s32 offen offset:0 sc1
    buffer_store_dwordx4 v[36:39], v50, s[20:23], s32 offen offset:32 sc1
    buffer_store_dwordx4 v[40:43], v50, s[20:23], s32 offen offset:64 sc1
    buffer_store_dwordx4 v[44:47], v50, s[20:23], s32 offen offset:96 sc1
    s_cmp_lg_u32 s25, 0
    s_cbranch_scc1 wo_notab
    s_mov_b32 exec_hi, 0
    buffer_store_dwordx4 v[52:55], v50, s[20:23], s34 offen sc1
wo_notab:
    s_mov_b64 exec, -1
    v_add_f32 v246, 1.0, v55
    v_mul_f32 v247, v54, v55
    v_sub_f32 v247, 0, v247
    s_cmp_lg_u32 s26, 0
    s_cbranch_scc1 e_final
    v_mul_f32 v48, v246, v246
    v_mul_f32 v48, v48, v65
    v_add_f32 v48, 0x3727c5ac, v48
    v_rsq_f32 v48, v48
    v_cmp_eq_u32 vcc, 0, v49
    v_mul_f32 v48, v48, v246
    s_nop 0
    v_cndmask_b32 v244, v54, v48, vcc
    s_mov_b32 s26, 16777216
    s_and_b32 s30, s3, 1
    s_lshl_b32 s30, s30, 13
    v_add_u32 v136, s30, v253
    v_add_u32 v137, 1024, v136
    v_add_u32 v138, 2048, v136
    v_add_u32 v139, 3072, v136
    s_branch e_q
e_final:
    s_load_dwordx2 s[12:13], s[0:1], 64
    s_mov_b32 s14, 0x400000
    s_mov_b32 s15, 0x20000
    s_waitcnt lgkmcnt(0)
    v_fma_f32 v0, v0, v246, v247
    v_fma_f32 v1, v1, v246, v247
    v_fma_f32 v2, v2, v246, v247
    v_fma_f32 v3, v3, v246, v247
    v_fma_f32 v4, v4, v246, v247
    v_fma_f32 v5, v5, v246, v247
    v_fma_f32 v6, v6, v246, v247
    v_fma_f32 v7, v7, v246, v247
    v_fma_f32 v8, v8, v246, v247
    v_fma_f32 v9, v9, v246, v247
    v_fma_f32 v10, v10, v246, v247
    v_fma_f32 v11, v11, v246, v247
    v_fma_f32 v12, v12, v246, v247
    v_fma_f32 v13, v13, v246, v247
    v_fma_f32 v14, v14, v246, v247
    v_fma_f32 v15, v15, v246, v247
    v_fma_f32 v16, v16, v246, v247
    v_fma_f32 v17, v17, v246, v247
    v_fma_f32 v18, v18, v246, v247
    v_fma_f32 v19, v19, v246, v247
    v_fma_f32 v20, v20, v246, v247
    v_fma_f32 v21, v21, v246, v247
    v_fma_f32 v22, v22, v246, v247
    v_fma_f32 v23, v23, v246, v247
    v_fma_f32 v24, v24, v246, v247
    v_fma_f32 v25, v25, v246, v247
    v_fma_f32 v26, v26, v246, v247
    v_fma_f32 v27, v27, v246, v247
    v_fma_f32 v28, v28, v246, v247
    v_fma_f32 v29, v29, v246, v247
    v_fma_f32 v30, v30, v246, v247
    v_fma_f32 v31, v31, v246, v247
    v_cvt_pk_bf16_f32 v64, v0, v1
    v_cvt_pk_bf16_f32 v65, v2, v3
    v_cvt_pk_bf16_f32 v66, v4, v5
    v_cvt_pk_bf16_f32 v67, v6, v7
    v_cvt_pk_bf16_f32 v68, v8, v9
    v_cvt_pk_bf16_f32 v69, v10, v11
    v_cvt_pk_bf16_f32 v70, v12, v13
    v_cvt_pk_bf16_f32 v71, v14, v15
    v_cvt_pk_bf16_f32 v72, v16, v17
    v_cvt_pk_bf16_f32 v73, v18, v19
    v_cvt_pk_bf16_f32 v74, v20, v21
    v_cvt_pk_bf16_f32 v75, v22, v23
    v_cvt_pk_bf16_f32 v76, v24, v25
    v_cvt_pk_bf16_f32 v77, v26, v27
    v_cvt_pk_bf16_f32 v78, v28, v29
    v_cvt_pk_bf16_f32 v79, v30, v31
    v_permlane32_swap_b32 v64, v66
    v_permlane32_swap_b32 v65, v67
    v_permlane32_swap_b32 v68, v70
    v_permlane32_swap_b32 v69, v71
    v_permlane32_swap_b32 v72, v74
    v_permlane32_swap_b32 v73, v75
    v_permlane32_swap_b32 v76, v78
    v_permlane32_swap_b32 v77, v79
    v_lshl_add_u32 v50, v53, 11, v50
    s_not_b32 exec_lo, s38
    s_not_b32 exec_hi, s38
    buffer_store_dwordx4 v[64:67], v50, s[12:15], s33 offen offset:0
    buffer_store_dwordx4 v[68:71], v50, s[12:15], s33 offen offset:32
    buffer_store_dwordx4 v[72:75], v50, s[12:15], s33 offen offset:64
    buffer_store_dwordx4 v[76:79], v50, s[12:15], s33 offen offset:96
    s_mov_b64 exec, -1
    s_mov_b32 s79, s26
    s_mov_b32 s78, s27
pl_13:
    s_add_u32 s32, s79, 0xdc0000
    buffer_load_dwordx4 v[0:3], v253, s[20:23], s32 offen sc1
    s_waitcnt vmcnt(0)
pc_14:
    v_max3_u32 v4, v0, v1, v2
    v_max_u32 v4, v4, v3
    v_cmp_eq_u32 vcc, -1, v4
    s_cbranch_vccz pd_15
    s_sub_u32 s78, s78, 1
    s_cmp_lg_u32 s78, 0
    s_cbranch_scc1 pl_13
    s_mov_b32 s27, 1
pd_15:
    v_mov_b32 v4, v0
    s_nop 1
    v_max_f32_dpp v4, v4, v4 quad_perm:[1,0,3,2] row_mask:0xf bank_mask:0xf
    s_nop 1
    v_max_f32_dpp v4, v4, v4 quad_perm:[2,3,0,1] row_mask:0xf bank_mask:0xf
    s_nop 1
    v_max_f32_dpp v4, v4, v4 row_half_mirror row_mask:0xf bank_mask:0xf
    s_nop 1
    v_max_f32_dpp v4, v4, v4 row_mirror row_mask:0xf bank_mask:0xf
    v_mov_b32 v5, v4
    s_nop 1
    v_permlane16_swap_b32 v4, v5
    v_max_f32 v4, v4, v5
    v_mov_b32 v5, v4
    s_nop 1
    v_permlane32_swap_b32 v4, v5
    v_max_f32 v4, v4, v5
    v_cmp_eq_f32 vcc, v4, v0
    s_ff1_i32_b64 s32, vcc
    s_and_b32 s32, s32, 63
    v_readlane_b32 s74, v0, s32
    v_readlane_b32 s73, v1, s32
    v_readlane_b32 s75, v2, s32
    v_readlane_b32 s76, v3, s32
    s_and_b32 s73, s73, 2047
    s_cmp_eq_u32 s73, s39
    s_cbranch_scc1 e_fin2
    s_mov_b32 exec_lo, s38
    s_mov_b32 exec_hi, s38
    buffer_store_dwordx4 v[64:67], v50, s[12:15], s33 offen offset:0
    buffer_store_dwordx4 v[68:71], v50, s[12:15], s33 offen offset:32
    buffer_store_dwordx4 v[72:75], v50, s[12:15], s33 offen offset:64
    buffer_store_dwordx4 v[76:79], v50, s[12:15], s33 offen offset:96
    s_mov_b64 exec, -1
e_fin2:
    s_barrier
    s_branch k_end
l_start:
    v_lshrrev_b32 v20, 4, v252
    v_xor_b32 v20, v20, v252
    v_and_b32 v20, 7, v20
    v_lshlrev_b32 v20, 4, v20
    v_lshrrev_b32 v21, 3, v252
    v_lshl_add_u32 v4, v21, 11, v20
    v_lshrrev_b32 v20, 4, v252
    v_add_u32 v20, 4, v20
    v_xor_b32 v20, v20, v252
    v_and_b32 v20, 7, v20
    v_lshlrev_b32 v20, 4, v20
    v_lshrrev_b32 v21, 3, v252
    v_lshl_add_u32 v5, v21, 11, v20
    v_add_u32 v5, 15360, v5
    v_add_u32 v6, 30720, v4
    v_add_u32 v7, 30720, v5
    s_lshl_b32 s84, s24, 18
    s_lshl_b32 s32, s28, 16
    s_add_u32 s84, s84, s32
    v_lshrrev_b32 v20, 3, v252
    v_mul_u32_u24 v20, 6144, v20
    v_lshrrev_b32 v21, 2, v252
    v_and_b32 v21, 4, v21
    v_xor_b32 v21, v21, v252
    v_and_b32 v21, 7, v21
    v_lshl_add_u32 v20, v21, 4, v20
    s_mul_i32 s32, s28, 6
    s_and_b32 s33, s32, 7
    s_mul_i32 s33, s33, 49152
    s_lshr_b32 s34, s32, 3
    s_lshl_b32 s34, s34, 11
    s_add_u32 s33, s33, s34
    v_add_u32 v8, s33, v20
    s_add_u32 s32, s32, 1
    s_and_b32 s33, s32, 7
    s_mul_i32 s33, s33, 49152
    s_lshr_b32 s34, s32, 3
    s_lshl_b32 s34, s34, 11
    s_add_u32 s33, s33, s34
    s_sub_u32 s33, s33, 1024
    v_add_u32 v9, s33, v20
    s_add_u32 s32, s32, 1
    s_and_b32 s33, s32, 7
    s_mul_i32 s33, s33, 49152
    s_lshr_b32 s34, s32, 3
    s_lshl_b32 s34, s34, 11
    s_add_u32 s33, s33, s34
    s_sub_u32 s33, s33, 2048
    v_add_u32 v10, s33, v20
    s_add_u32 s32, s32, 1
    s_and_b32 s33, s32, 7
    s_mul_i32 s33, s33, 49152
    s_lshr_b32 s34, s32, 3
    s_lshl_b32 s34, s34, 11
    s_add_u32 s33, s33, s34
    s_sub_u32 s33, s33, 3072
    v_add_u32 v11, s33, v20
    s_add_u32 s32, s32, 1
    s_and_b32 s33, s32, 7
    s_mul_i32 s33, s33, 49152
    s_lshr_b32 s34, s32, 3
    s_lshl_b32 s34, s34, 11
    s_add_u32 s33, s33, s34
    v_add_u32 v12, s33, v20
    s_add_u32 s32, s32, 1
    s_and_b32 s33, s32, 7
    s_mul_i32 s33, s33, 49152
    s_lshr_b32 s34, s32, 3
    s_lshl_b32 s34, s34, 11
    s_add_u32 s33, s33, s34
    s_sub_u32 s33, s33, 1024
    v_add_u32 v13, s33, v20
    s_add_u32 s32, s32, 1
    s_lshl_b32 s85, s25, 7
    s_lshl_b32 s86, s28, 12
    s_mul_i32 s87, s28, 6144
    s_add_u32 m0, s86, 0
    s_add_u32 s32, s84, 0
    buffer_load_dwordx4 v4, s[4:7], s32 offen offset:0 lds
    buffer_load_dwordx4 v5, s[4:7], s32 offen offset:1024 lds
    buffer_load_dwordx4 v6, s[4:7], s32 offen offset:2048 lds
    buffer_load_dwordx4 v7, s[4:7], s32 offen offset:3072 lds
    s_add_u32 m0, s87, 16384
    s_add_u32 s32, s85, 0
    buffer_load_dwordx4 v8, s[16:19], s32 offen offset:0 lds
    buffer_load_dwordx4 v9, s[16:19], s32 offen offset:1024 lds
    buffer_load_dwordx4 v10, s[16:19], s32 offen offset:2048 lds
    buffer_load_dwordx4 v11, s[16:19], s32 offen offset:3072 lds
    s_add_u32 m0, s87, 20480
    s_nop 0
    buffer_load_dwordx4 v12, s[16:19], s32 offen offset:0 lds
    buffer_load_dwordx4 v13, s[16:19], s32 offen offset:1024 lds
    s_add_u32 m0, s86, 40960
    s_add_u32 s32, s84, 128
    buffer_load_dwordx4 v4, s[4:7], s32 offen offset:0 lds
    buffer_load_dwordx4 v5, s[4:7], s32 offen offset:1024 lds
    buffer_load_dwordx4 v6, s[4:7], s32 offen offset:2048 lds
    buffer_load_dwordx4 v7, s[4:7], s32 offen offset:3072 lds
    s_add_u32 m0, s87, 57344
    s_add_u32 s32, s85, 393216
    buffer_load_dwordx4 v8, s[16:19], s32 offen offset:0 lds
    buffer_load_dwordx4 v9, s[16:19], s32 offen offset:1024 lds
    buffer_load_dwordx4 v10, s[16:19], s32 offen offset:2048 lds
    buffer_load_dwordx4 v11, s[16:19], s32 offen offset:3072 lds
    s_add_u32 m0, s87, 61440
    s_nop 0
    buffer_load_dwordx4 v12, s[16:19], s32 offen offset:0 lds
    buffer_load_dwordx4 v13, s[16:19], s32 offen offset:1024 lds
    s_lshl_b32 s33, s72, 14
    s_lshl_b32 s34, s28, 12
    s_add_u32 s33, s33, s34
    buffer_load_dwordx4 v[32:35], v253, s[4:7], s33 offen offset:0
    buffer_load_dwordx4 v[36:39], v253, s[4:7], s33 offen offset:1024
    buffer_load_dwordx4 v[40:43], v253, s[4:7], s33 offen offset:2048
    buffer_load_dwordx4 v[44:47], v253, s[4:7], s33 offen offset:3072
    v_lshrrev_b32 v20, 3, v252
    v_mul_u32_u24 v20, 49152, v20
    v_and_b32 v21, 7, v252
    v_lshl_add_u32 v20, v21, 4, v20
    s_cmp_eq_u32 s28, 3
    s_cselect_b32 s32, 0x10000000, 0
    v_add_u32 v20, s32, v20
    s_mul_i32 s32, s24, 393216
    s_lshl_b32 s33, s28, 11
    s_add_u32 s32, s32, s33
    s_lshl_b32 s33, s25, 7
    s_add_u32 s32, s32, s33
    buffer_load_dwordx4 v[100:103], v20, s[16:19], s32 offen
    s_add_u32 s32, s32, 6144
    buffer_load_dwordx4 v[104:107], v20, s[16:19], s32 offen
    s_add_u32 s32, s32, 6144
    buffer_load_dwordx4 v[108:111], v20, s[16:19], s32 offen
    s_add_u32 s32, s32, 6144
    buffer_load_dwordx4 v[112:115], v20, s[16:19], s32 offen
    s_add_u32 s32, s32, 6144
    buffer_load_dwordx4 v[116:119], v20, s[16:19], s32 offen
    s_add_u32 s32, s32, 6144
    buffer_load_dwordx4 v[120:123], v20, s[16:19], s32 offen
    s_add_u32 s32, s32, 6144
    buffer_load_dwordx4 v[124:127], v20, s[16:19], s32 offen
    s_add_u32 s32, s32, 6144
    buffer_load_dwordx4 v[128:131], v20, s[16:19], s32 offen
    s_add_u32 m0, s86, 81920
    s_add_u32 s32, s84, 256
    buffer_load_dwordx4 v4, s[4:7], s32 offen offset:0 lds
    buffer_load_dwordx4 v5, s[4:7], s32 offen offset:1024 lds
    buffer_load_dwordx4 v6, s[4:7], s32 offen offset:2048 lds
    buffer_load_dwordx4 v7, s[4:7], s32 offen offset:3072 lds
    s_add_u32 m0, s87, 98304
    s_add_u32 s32, s85, 786432
    buffer_load_dwordx4 v8, s[16:19], s32 offen offset:0 lds
    buffer_load_dwordx4 v9, s[16:19], s32 offen offset:1024 lds
    buffer_load_dwordx4 v10, s[16:19], s32 offen offset:2048 lds
    buffer_load_dwordx4 v11, s[16:19], s32 offen offset:3072 lds
    s_add_u32 m0, s87, 102400
    s_nop 0
    buffer_load_dwordx4 v12, s[16:19], s32 offen offset:0 lds
    buffer_load_dwordx4 v13, s[16:19], s32 offen offset:1024 lds
    s_add_u32 m0, s86, 122880
    s_add_u32 s32, s84, 384
    buffer_load_dwordx4 v4, s[4:7], s32 offen offset:0 lds
    buffer_load_dwordx4 v5, s[4:7], s32 offen offset:1024 lds
    buffer_load_dwordx4 v6, s[4:7], s32 offen offset:2048 lds
    buffer_load_dwordx4 v7, s[4:7], s32 offen offset:3072 lds
    s_add_u32 m0, s87, 139264
    s_add_u32 s32, s85, 1179648
    buffer_load_dwordx4 v8, s[16:19], s32 offen offset:0 lds
    buffer_load_dwordx4 v9, s[16:19], s32 offen offset:1024 lds
    buffer_load_dwordx4 v10, s[16:19], s32 offen offset:2048 lds
    buffer_load_dwordx4 v11, s[16:19], s32 offen offset:3072 lds
    s_add_u32 m0, s87, 143360
    s_nop 0
    buffer_load_dwordx4 v12, s[16:19], s32 offen offset:0 lds
    buffer_load_dwordx4 v13, s[16:19], s32 offen offset:1024 lds
    v_bfe_u32 v20, v252, 3, 2
    v_lshrrev_b32 v21, 5, v252
    v_lshl_add_u32 v20, v21, 3, v20
    s_lshr_b32 s32, s28, 1
    s_lshl_b32 s32, s32, 4
    s_and_b32 s33, s28, 1
    s_lshl_b32 s33, s33, 2
    s_add_u32 s32, s32, s33
    v_add_u32 v20, s32, v20
    v_lshlrev_b32 v20, 11, v20
    v_lshrrev_b32 v21, 2, v252
    v_and_b32 v21, 4, v21
    v_xor_b32 v21, v21, v252
    v_and_b32 v21, 7, v21
    v_lshl_add_u32 v14, v21, 4, v20
    s_waitcnt vmcnt(42)
    s_barrier
    s_cmp_lg_u32 s3, 4
    s_cbranch_scc1 arr_16
    v_mov_b32 v20, 1
    v_mov_b32 v21, 0
    s_mov_b64 exec, 1
    buffer_store_byte v20, v21, s[12:15], s72 offen sc1
    s_mov_b64 exec, -1
arr_16:
    s_waitcnt vmcnt(32)
    s_barrier
    s_add_u32 m0, s86, 0
    s_add_u32 s32, s84, 512
    buffer_load_dwordx4 v4, s[4:7], s32 offen offset:0 lds
    buffer_load_dwordx4 v5, s[4:7], s32 offen offset:1024 lds
    buffer_load_dwordx4 v6, s[4:7], s32 offen offset:2048 lds
    buffer_load_dwordx4 v7, s[4:7], s32 offen offset:3072 lds
    s_add_u32 m0, s87, 16384
    s_add_u32 s32, s85, 1572864
    buffer_load_dwordx4 v8, s[16:19], s32 offen offset:0 lds
    buffer_load_dwordx4 v9, s[16:19], s32 offen offset:1024 lds
    buffer_load_dwordx4 v10, s[16:19], s32 offen offset:2048 lds
    buffer_load_dwordx4 v11, s[16:19], s32 offen offset:3072 lds
    s_add_u32 m0, s87, 20480
    s_nop 0
    buffer_load_dwordx4 v12, s[16:19], s32 offen offset:0 lds
    buffer_load_dwordx4 v13, s[16:19], s32 offen offset:1024 lds
    s_waitcnt vmcnt(20)
    s_barrier
    s_add_u32 m0, s86, 40960
    s_add_u32 s32, s84, 640
    buffer_load_dwordx4 v4, s[4:7], s32 offen offset:0 lds
    buffer_load_dwordx4 v5, s[4:7], s32 offen offset:1024 lds
    buffer_load_dwordx4 v6, s[4:7], s32 offen offset:2048 lds
    buffer_load_dwordx4 v7, s[4:7], s32 offen offset:3072 lds
    s_add_u32 m0, s87, 57344
    s_add_u32 s32, s85, 1966080
    buffer_load_dwordx4 v8, s[16:19], s32 offen offset:0 lds
    buffer_load_dwordx4 v9, s[16:19], s32 offen offset:1024 lds
    buffer_load_dwordx4 v10, s[16:19], s32 offen offset:2048 lds
    buffer_load_dwordx4 v11, s[16:19], s32 offen offset:3072 lds
    s_add_u32 m0, s87, 61440
    s_nop 0
    buffer_load_dwordx4 v12, s[16:19], s32 offen offset:0 lds
    buffer_load_dwordx4 v13, s[16:19], s32 offen offset:1024 lds
    v_mov_b32 v48, 0
    v_mov_b32 v50, 0
    v_mov_b32 v49, 0
    v_mov_b32 v51, 0
    v_dot2c_f32_bf16 v48, 0x3f803f80, v32
    v_dot2c_f32_bf16 v50, v32, v32
    v_dot2c_f32_bf16 v49, 0x3f803f80, v40
    v_dot2c_f32_bf16 v51, v40, v40
    v_dot2c_f32_bf16 v48, 0x3f803f80, v33
    v_dot2c_f32_bf16 v50, v33, v33
    v_dot2c_f32_bf16 v49, 0x3f803f80, v41
    v_dot2c_f32_bf16 v51, v41, v41
    v_dot2c_f32_bf16 v48, 0x3f803f80, v34
    v_dot2c_f32_bf16 v50, v34, v34
    v_dot2c_f32_bf16 v49, 0x3f803f80, v42
    v_dot2c_f32_bf16 v51, v42, v42
    v_dot2c_f32_bf16 v48, 0x3f803f80, v35
    v_dot2c_f32_bf16 v50, v35, v35
    v_dot2c_f32_bf16 v49, 0x3f803f80, v43
    v_dot2c_f32_bf16 v51, v43, v43
    v_dot2c_f32_bf16 v48, 0x3f803f80, v36
    v_dot2c_f32_bf16 v50, v36, v36
    v_dot2c_f32_bf16 v49, 0x3f803f80, v44
    v_dot2c_f32_bf16 v51, v44, v44
    v_dot2c_f32_bf16 v48, 0x3f803f80, v37
    v_dot2c_f32_bf16 v50, v37, v37
    v_dot2c_f32_bf16 v49, 0x3f803f80, v45
    v_dot2c_f32_bf16 v51, v45, v45
    v_dot2c_f32_bf16 v48, 0x3f803f80, v38
    v_dot2c_f32_bf16 v50, v38, v38
    v_dot2c_f32_bf16 v49, 0x3f803f80, v46
    v_dot2c_f32_bf16 v51, v46, v46
    v_dot2c_f32_bf16 v48, 0x3f803f80, v39
    v_dot2c_f32_bf16 v50, v39, v39
    v_dot2c_f32_bf16 v49, 0x3f803f80, v47
    v_dot2c_f32_bf16 v51, v47, v47
    s_nop 1
    v_permlane32_swap_b32 v48, v49
    v_permlane32_swap_b32 v50, v51
    v_add_f32 v48, v48, v49
    v_add_f32 v50, v50, v51
    s_nop 0
    v_add_f32_dpp v48, v48, v48 quad_perm:[1,0,3,2] row_mask:0xf bank_mask:0xf
    s_nop 1
    v_add_f32_dpp v48, v48, v48 quad_perm:[2,3,0,1] row_mask:0xf bank_mask:0xf
    s_nop 1
    v_add_f32_dpp v48, v48, v48 row_half_mirror row_mask:0xf bank_mask:0xf
    s_nop 1
    v_add_f32_dpp v48, v48, v48 row_mirror row_mask:0xf bank_mask:0xf
    v_mov_b32 v49, v48
    s_nop 1
    v_permlane16_swap_b32 v48, v49
    v_add_f32 v48, v48, v49
    v_add_f32_dpp v50, v50, v50 quad_perm:[1,0,3,2] row_mask:0xf bank_mask:0xf
    s_nop 1
    v_add_f32_dpp v50, v50, v50 quad_perm:[2,3,0,1] row_mask:0xf bank_mask:0xf
    s_nop 1
    v_add_f32_dpp v50, v50, v50 row_half_mirror row_mask:0xf bank_mask:0xf
    s_nop 1
    v_add_f32_dpp v50, v50, v50 row_mirror row_mask:0xf bank_mask:0xf
    v_mov_b32 v51, v50
    s_nop 1
    v_permlane16_swap_b32 v50, v51
    v_add_f32 v50, v50, v51
    v_mul_f32 v49, 0x3a800000, v48
    v_mul_f32 v50, 0x3a800000, v50
    v_fma_f32 v50, -v49, v49, v50
    v_max_f32 v50, 0, v50
    v_add_f32 v50, 0x3727c5ac, v50
    v_rsq_f32 v48, v50
    v_lshrrev_b32 v50, 2, v252
    s_lshl_b32 s32, s72, 10
    s_lshl_b32 s33, s28, 4
    s_add_u32 s32, s32, s33
    s_add_u32 s32, s32, 0xd80000
    s_mov_b32 exec_lo, 1
    s_mov_b32 exec_hi, 1
    buffer_store_dwordx2 v[48:49], v50, s[20:23], s32 offen offset:768 sc1
    s_mov_b64 exec, -1
    s_waitcnt vmcnt(20)
    s_barrier
    s_add_u32 m0, s86, 81920
    s_add_u32 s32, s84, 768
    buffer_load_dwordx4 v4, s[4:7], s32 offen offset:0 lds
    buffer_load_dwordx4 v5, s[4:7], s32 offen offset:1024 lds
    buffer_load_dwordx4 v6, s[4:7], s32 offen offset:2048 lds
    buffer_load_dwordx4 v7, s[4:7], s32 offen offset:3072 lds
    s_add_u32 m0, s87, 98304
    s_add_u32 s32, s85, 2359296
    buffer_load_dwordx4 v8, s[16:19], s32 offen offset:0 lds
    buffer_load_dwordx4 v9, s[16:19], s32 offen offset:1024 lds
    buffer_load_dwordx4 v10, s[16:19], s32 offen offset:2048 lds
    buffer_load_dwordx4 v11, s[16:19], s32 offen offset:3072 lds
    s_add_u32 m0, s87, 102400
    s_nop 0
    buffer_load_dwordx4 v12, s[16:19], s32 offen offset:0 lds
    buffer_load_dwordx4 v13, s[16:19], s32 offen offset:1024 lds
    s_cmp_eq_u32 s28, 3
    s_cbranch_scc1 sk_17
    v_lshlrev_b32 v140, 16, v100
    v_and_b32 v141, 0xffff0000, v100
    v_lshlrev_b32 v142, 16, v101
    v_and_b32 v143, 0xffff0000, v101
    v_lshlrev_b32 v144, 16, v102
    v_and_b32 v145, 0xffff0000, v102
    v_lshlrev_b32 v146, 16, v103
    v_and_b32 v147, 0xffff0000, v103
    v_lshlrev_b32 v20, 16, v104
    v_and_b32 v21, 0xffff0000, v104
    v_add_f32 v140, v140, v20
    v_add_f32 v141, v141, v21
    v_lshlrev_b32 v20, 16, v105
    v_and_b32 v21, 0xffff0000, v105
    v_add_f32 v142, v142, v20
    v_add_f32 v143, v143, v21
    v_lshlrev_b32 v20, 16, v106
    v_and_b32 v21, 0xffff0000, v106
    v_add_f32 v144, v144, v20
    v_add_f32 v145, v145, v21
    v_lshlrev_b32 v20, 16, v107
    v_and_b32 v21, 0xffff0000, v107
    v_add_f32 v146, v146, v20
    v_add_f32 v147, v147, v21
    v_lshlrev_b32 v20, 16, v108
    v_and_b32 v21, 0xffff0000, v108
    v_add_f32 v140, v140, v20
    v_add_f32 v141, v141, v21
    v_lshlrev_b32 v20, 16, v109
    v_and_b32 v21, 0xffff0000, v109
    v_add_f32 v142, v142, v20
    v_add_f32 v143, v143, v21
    v_lshlrev_b32 v20, 16, v110
    v_and_b32 v21, 0xffff0000, v110
    v_add_f32 v144, v144, v20
    v_add_f32 v145, v145, v21
    v_lshlrev_b32 v20, 16, v111
    v_and_b32 v21, 0xffff0000, v111
    v_add_f32 v146, v146, v20
    v_add_f32 v147, v147, v21
    v_lshlrev_b32 v20, 16, v112
    v_and_b32 v21, 0xffff0000, v112
    v_add_f32 v140, v140, v20
    v_add_f32 v141, v141, v21
    v_lshlrev_b32 v20, 16, v113
    v_and_b32 v21, 0xffff0000, v113
    v_add_f32 v142, v142, v20
    v_add_f32 v143, v143, v21
    v_lshlrev_b32 v20, 16, v114
    v_and_b32 v21, 0xffff0000, v114
    v_add_f32 v144, v144, v20
    v_add_f32 v145, v145, v21
    v_lshlrev_b32 v20, 16, v115
    v_and_b32 v21, 0xffff0000, v115
    v_add_f32 v146, v146, v20
    v_add_f32 v147, v147, v21
    v_lshlrev_b32 v20, 16, v116
    v_and_b32 v21, 0xffff0000, v116
    v_add_f32 v140, v140, v20
    v_add_f32 v141, v141, v21
    v_lshlrev_b32 v20, 16, v117
    v_and_b32 v21, 0xffff0000, v117
    v_add_f32 v142, v142, v20
    v_add_f32 v143, v143, v21
    v_lshlrev_b32 v20, 16, v118
    v_and_b32 v21, 0xffff0000, v118
    v_add_f32 v144, v144, v20
    v_add_f32 v145, v145, v21
    v_lshlrev_b32 v20, 16, v119
    v_and_b32 v21, 0xffff0000, v119
    v_add_f32 v146, v146, v20
    v_add_f32 v147, v147, v21
    v_lshlrev_b32 v20, 16, v120
    v_and_b32 v21, 0xffff0000, v120
    v_add_f32 v140, v140, v20
    v_add_f32 v141, v141, v21
    v_lshlrev_b32 v20, 16, v121
    v_and_b32 v21, 0xffff0000, v121
    v_add_f32 v142, v142, v20
    v_add_f32 v143, v143, v21
    v_lshlrev_b32 v20, 16, v122
    v_and_b32 v21, 0xffff0000, v122
    v_add_f32 v144, v144, v20
    v_add_f32 v145, v145, v21
    v_lshlrev_b32 v20, 16, v123
    v_and_b32 v21, 0xffff0000, v123
    v_add_f32 v146, v146, v20
    v_add_f32 v147, v147, v21
    v_lshlrev_b32 v20, 16, v124
    v_and_b32 v21, 0xffff0000, v124
    v_add_f32 v140, v140, v20
    v_add_f32 v141, v141, v21
    v_lshlrev_b32 v20, 16, v125
    v_and_b32 v21, 0xffff0000, v125
    v_add_f32 v142, v142, v20
    v_add_f32 v143, v143, v21
    v_lshlrev_b32 v20, 16, v126
    v_and_b32 v21, 0xffff0000, v126
    v_add_f32 v144, v144, v20
    v_add_f32 v145, v145, v21
    v_lshlrev_b32 v20, 16, v127
    v_and_b32 v21, 0xffff0000, v127
    v_add_f32 v146, v146, v20
    v_add_f32 v147, v147, v21
    v_lshlrev_b32 v20, 16, v128
    v_and_b32 v21, 0xffff0000, v128
    v_add_f32 v140, v140, v20
    v_add_f32 v141, v141, v21
    v_lshlrev_b32 v20, 16, v129
    v_and_b32 v21, 0xffff0000, v129
    v_add_f32 v142, v142, v20
    v_add_f32 v143, v143, v21
    v_lshlrev_b32 v20, 16, v130
    v_and_b32 v21, 0xffff0000, v130
    v_add_f32 v144, v144, v20
    v_add_f32 v145, v145, v21
    v_lshlrev_b32 v20, 16, v131
    v_and_b32 v21, 0xffff0000, v131
    v_add_f32 v146, v146, v20
    v_add_f32 v147, v147, v21
    v_and_b32 v20, 7, v252
    v_lshrrev_b32 v21, 3, v252
    v_lshl_add_u32 v20, v20, 3, v21
    v_lshlrev_b32 v20, 2, v20
    v_permlane32_swap_b32 v140, v144
    v_permlane32_swap_b32 v141, v145
    v_permlane32_swap_b32 v142, v146
    v_permlane32_swap_b32 v143, v147
    v_add_f32 v140, v140, v144
    v_add_f32 v141, v141, v145
    v_add_f32 v142, v142, v146
    v_add_f32 v143, v143, v147
    v_and_b32 v21, 1, v21
    v_cmp_eq_u32 vcc, 1, v21
    v_permlane16_swap_b32 v140, v142
    v_permlane16_swap_b32 v141, v143
    v_add_f32 v140, v140, v142
    v_add_f32 v141, v141, v143
    s_lshl_b32 s32, s72, 10
    s_lshl_b32 s33, s28, 8
    s_add_u32 s32, s32, s33
    s_add_u32 s32, s32, 0xd80000
    v_add_f32_dpp v140, v140, v140 row_ror:8 row_mask:0xf bank_mask:0xf
    v_add_f32_dpp v141, v141, v141 row_ror:8 row_mask:0xf bank_mask:0xf
    v_cndmask_b32 v140, v140, v141, vcc
    buffer_store_dword v140, v20, s[20:23], s32 offen sc1
sk_17:
    s_waitcnt vmcnt(20)
    s_barrier
    s_add_u32 m0, s86, 122880
    s_add_u32 s32, s84, 896
    buffer_load_dwordx4 v4, s[4:7], s32 offen offset:0 lds
    buffer_load_dwordx4 v5, s[4:7], s32 offen offset:1024 lds
    buffer_load_dwordx4 v6, s[4:7], s32 offen offset:2048 lds
    buffer_load_dwordx4 v7, s[4:7], s32 offen offset:3072 lds
    s_add_u32 m0, s87, 139264
    s_add_u32 s32, s85, 2752512
    buffer_load_dwordx4 v8, s[16:19], s32 offen offset:0 lds
    buffer_load_dwordx4 v9, s[16:19], s32 offen offset:1024 lds
    buffer_load_dwordx4 v10, s[16:19], s32 offen offset:2048 lds
    buffer_load_dwordx4 v11, s[16:19], s32 offen offset:3072 lds
    s_add_u32 m0, s87, 143360
    s_nop 0
    buffer_load_dwordx4 v12, s[16:19], s32 offen offset:0 lds
    buffer_load_dwordx4 v13, s[16:19], s32 offen offset:1024 lds
    s_waitcnt vmcnt(20)
    s_barrier
    s_add_u32 m0, s86, 0
    s_add_u32 s32, s84, 1024
    buffer_load_dwordx4 v4, s[4:7], s32 offen offset:0 lds
    buffer_load_dwordx4 v5, s[4:7], s32 offen offset:1024 lds
    buffer_load_dwordx4 v6, s[4:7], s32 offen offset:2048 lds
    buffer_load_dwordx4 v7, s[4:7], s32 offen offset:3072 lds
    s_add_u32 m0, s87, 16384
    s_add_u32 s32, s85, 3145728
    buffer_load_dwordx4 v8, s[16:19], s32 offen offset:0 lds
    buffer_load_dwordx4 v9, s[16:19], s32 offen offset:1024 lds
    buffer_load_dwordx4 v10, s[16:19], s32 offen offset:2048 lds
    buffer_load_dwordx4 v11, s[16:19], s32 offen offset:3072 lds
    s_add_u32 m0, s87, 20480
    s_nop 0
    buffer_load_dwordx4 v12, s[16:19], s32 offen offset:0 lds
    buffer_load_dwordx4 v13, s[16:19], s32 offen offset:1024 lds
    s_waitcnt vmcnt(20)
    s_barrier
    s_add_u32 m0, s86, 40960
    s_add_u32 s32, s84, 1152
    buffer_load_dwordx4 v4, s[4:7], s32 offen offset:0 lds
    buffer_load_dwordx4 v5, s[4:7], s32 offen offset:1024 lds
    buffer_load_dwordx4 v6, s[4:7], s32 offen offset:2048 lds
    buffer_load_dwordx4 v7, s[4:7], s32 offen offset:3072 lds
    s_add_u32 m0, s87, 57344
    s_add_u32 s32, s85, 3538944
    buffer_load_dwordx4 v8, s[16:19], s32 offen offset:0 lds
    buffer_load_dwordx4 v9, s[16:19], s32 offen offset:1024 lds
    buffer_load_dwordx4 v10, s[16:19], s32 offen offset:2048 lds
    buffer_load_dwordx4 v11, s[16:19], s32 offen offset:3072 lds
    s_add_u32 m0, s87, 61440
    s_nop 0
    buffer_load_dwordx4 v12, s[16:19], s32 offen offset:0 lds
    buffer_load_dwordx4 v13, s[16:19], s32 offen offset:1024 lds
    s_waitcnt vmcnt(20)
    s_barrier
    s_add_u32 m0, s86, 81920
    s_add_u32 s32, s84, 1280
    buffer_load_dwordx4 v4, s[4:7], s32 offen offset:0 lds
    buffer_load_dwordx4 v5, s[4:7], s32 offen offset:1024 lds
    buffer_load_dwordx4 v6, s[4:7], s32 offen offset:2048 lds
    buffer_load_dwordx4 v7, s[4:7], s32 offen offset:3072 lds
    s_add_u32 m0, s87, 98304
    s_add_u32 s32, s85, 3932160
    buffer_load_dwordx4 v8, s[16:19], s32 offen offset:0 lds
    buffer_load_dwordx4 v9, s[16:19], s32 offen offset:1024 lds
    buffer_load_dwordx4 v10, s[16:19], s32 offen offset:2048 lds
    buffer_load_dwordx4 v11, s[16:19], s32 offen offset:3072 lds
    s_add_u32 m0, s87, 102400
    s_nop 0
    buffer_load_dwordx4 v12, s[16:19], s32 offen offset:0 lds
    buffer_load_dwordx4 v13, s[16:19], s32 offen offset:1024 lds
    s_waitcnt vmcnt(20)
    s_barrier
    s_add_u32 m0, s86, 122880
    s_add_u32 s32, s84, 1408
    buffer_load_dwordx4 v4, s[4:7], s32 offen offset:0 lds
    buffer_load_dwordx4 v5, s[4:7], s32 offen offset:1024 lds
    buffer_load_dwordx4 v6, s[4:7], s32 offen offset:2048 lds
    buffer_load_dwordx4 v7, s[4:7], s32 offen offset:3072 lds
    s_add_u32 m0, s87, 139264
    s_add_u32 s32, s85, 4325376
    buffer_load_dwordx4 v8, s[16:19], s32 offen offset:0 lds
    buffer_load_dwordx4 v9, s[16:19], s32 offen offset:1024 lds
    buffer_load_dwordx4 v10, s[16:19], s32 offen offset:2048 lds
    buffer_load_dwordx4 v11, s[16:19], s32 offen offset:3072 lds
    s_add_u32 m0, s87, 143360
    s_nop 0
    buffer_load_dwordx4 v12, s[16:19], s32 offen offset:0 lds
    buffer_load_dwordx4 v13, s[16:19], s32 offen offset:1024 lds
    s_waitcnt vmcnt(20)
    s_barrier
    s_add_u32 m0, s86, 0
    s_add_u32 s32, s84, 1536
    buffer_load_dwordx4 v4, s[4:7], s32 offen offset:0 lds
    buffer_load_dwordx4 v5, s[4:7], s32 offen offset:1024 lds
    buffer_load_dwordx4 v6, s[4:7], s32 offen offset:2048 lds
    buffer_load_dwordx4 v7, s[4:7], s32 offen offset:3072 lds
    s_add_u32 m0, s87, 16384
    s_add_u32 s32, s85, 4718592
    buffer_load_dwordx4 v8, s[16:19], s32 offen offset:0 lds
    buffer_load_dwordx4 v9, s[16:19], s32 offen offset:1024 lds
    buffer_load_dwordx4 v10, s[16:19], s32 offen offset:2048 lds
    buffer_load_dwordx4 v11, s[16:19], s32 offen offset:3072 lds
    s_add_u32 m0, s87, 20480
    s_nop 0
    buffer_load_dwordx4 v12, s[16:19], s32 offen offset:0 lds
    buffer_load_dwordx4 v13, s[16:19], s32 offen offset:1024 lds
    s_waitcnt vmcnt(20)
    s_barrier
    s_add_u32 m0, s86, 40960
    s_add_u32 s32, s84, 1664
    buffer_load_dwordx4 v4, s[4:7], s32 offen offset:0 lds
    buffer_load_dwordx4 v5, s[4:7], s32 offen offset:1024 lds
    buffer_load_dwordx4 v6, s[4:7], s32 offen offset:2048 lds
    buffer_load_dwordx4 v7, s[4:7], s32 offen offset:3072 lds
    s_add_u32 m0, s87, 57344
    s_add_u32 s32, s85, 5111808
    buffer_load_dwordx4 v8, s[16:19], s32 offen offset:0 lds
    buffer_load_dwordx4 v9, s[16:19], s32 offen offset:1024 lds
    buffer_load_dwordx4 v10, s[16:19], s32 offen offset:2048 lds
    buffer_load_dwordx4 v11, s[16:19], s32 offen offset:3072 lds
    s_add_u32 m0, s87, 61440
    s_nop 0
    buffer_load_dwordx4 v12, s[16:19], s32 offen offset:0 lds
    buffer_load_dwordx4 v13, s[16:19], s32 offen offset:1024 lds
    s_waitcnt vmcnt(20)
    s_barrier
    s_add_u32 m0, s86, 81920
    s_add_u32 s32, s84, 1792
    buffer_load_dwordx4 v4, s[4:7], s32 offen offset:0 lds
    buffer_load_dwordx4 v5, s[4:7], s32 offen offset:1024 lds
    buffer_load_dwordx4 v6, s[4:7], s32 offen offset:2048 lds
    buffer_load_dwordx4 v7, s[4:7], s32 offen offset:3072 lds
    s_add_u32 m0, s87, 98304
    s_add_u32 s32, s85, 5505024
    buffer_load_dwordx4 v8, s[16:19], s32 offen offset:0 lds
    buffer_load_dwordx4 v9, s[16:19], s32 offen offset:1024 lds
    buffer_load_dwordx4 v10, s[16:19], s32 offen offset:2048 lds
    buffer_load_dwordx4 v11, s[16:19], s32 offen offset:3072 lds
    s_add_u32 m0, s87, 102400
    s_nop 0
    buffer_load_dwordx4 v12, s[16:19], s32 offen offset:0 lds
    buffer_load_dwordx4 v13, s[16:19], s32 offen offset:1024 lds
    s_waitcnt vmcnt(20)
    s_barrier
    s_add_u32 m0, s86, 122880
    s_add_u32 s32, s84, 1920
    buffer_load_dwordx4 v4, s[4:7], s32 offen offset:0 lds
    buffer_load_dwordx4 v5, s[4:7], s32 offen offset:1024 lds
    buffer_load_dwordx4 v6, s[4:7], s32 offen offset:2048 lds
    buffer_load_dwordx4 v7, s[4:7], s32 offen offset:3072 lds
    s_add_u32 m0, s87, 139264
    s_add_u32 s32, s85, 5898240
    buffer_load_dwordx4 v8, s[16:19], s32 offen offset:0 lds
    buffer_load_dwordx4 v9, s[16:19], s32 offen offset:1024 lds
    buffer_load_dwordx4 v10, s[16:19], s32 offen offset:2048 lds
    buffer_load_dwordx4 v11, s[16:19], s32 offen offset:3072 lds
    s_add_u32 m0, s87, 143360
    s_nop 0
    buffer_load_dwordx4 v12, s[16:19], s32 offen offset:0 lds
    buffer_load_dwordx4 v13, s[16:19], s32 offen offset:1024 lds
    s_waitcnt vmcnt(20)
    s_barrier
    s_waitcnt vmcnt(10)
    s_barrier
    s_lshl_b32 s32, s28, 10
    s_lshl_b32 s33, s25, 7
    s_add_u32 m0, s32, 4096
    s_add_u32 s34, s33, 0
    buffer_load_dwordx4 v14, s[8:11], s34 offen lds
    s_add_u32 m0, s32, 8192
    s_add_u32 s34, s33, 131072
    buffer_load_dwordx4 v14, s[8:11], s34 offen lds
    s_add_u32 m0, s32, 12288
    s_add_u32 s34, s33, 262144
    buffer_load_dwordx4 v14, s[8:11], s34 offen lds
    s_add_u32 m0, s32, 16384
    s_add_u32 s34, s33, 393216
    buffer_load_dwordx4 v14, s[8:11], s34 offen lds
    s_add_u32 m0, s32, 20480
    s_add_u32 s34, s33, 524288
    buffer_load_dwordx4 v14, s[8:11], s34 offen lds
    s_add_u32 m0, s32, 24576
    s_add_u32 s34, s33, 655360
    buffer_load_dwordx4 v14, s[8:11], s34 offen lds
    s_add_u32 m0, s32, 28672
    s_add_u32 s34, s33, 786432
    buffer_load_dwordx4 v14, s[8:11], s34 offen lds
    s_add_u32 m0, s32, 32768
    s_add_u32 s34, s33, 917504
    buffer_load_dwordx4 v14, s[8:11], s34 offen lds
    s_add_u32 m0, s32, 36864
    s_add_u32 s34, s33, 1048576
    buffer_load_dwordx4 v14, s[8:11], s34 offen lds
    s_add_u32 m0, s32, 40960
    s_add_u32 s34, s33, 1179648
    buffer_load_dwordx4 v14, s[8:11], s34 offen lds
    s_add_u32 m0, s32, 45056
    s_add_u32 s34, s33, 1310720
    buffer_load_dwordx4 v14, s[8:11], s34 offen lds
    s_waitcnt vmcnt(11)
    s_barrier
    s_cmp_ge_u32 s29, 224
    s_cbranch_scc1 sk_18
    s_load_dwordx2 s[80:81], s[0:1], 40
    s_mov_b32 s82, 0x700000
    s_mov_b32 s83, 0x20000
    v_lshrrev_b32 v153, 2, v252
    v_lshlrev_b32 v153, 2, v153
    v_bfe_u32 v154, v252, 1, 1
    v_add_u32 v153, v153, v154
    v_mul_u32_u24 v153, 28672, v153
    v_and_b32 v154, 1, v252
    v_lshl_add_u32 v153, v154, 4, v153
    s_mul_i32 s30, s28, 1835008
    s_lshl_b32 s31, s29, 5
    s_add_u32 s30, s30, s31
    s_waitcnt lgkmcnt(0)
    buffer_load_dwordx4 v[156:159], v153, s[80:83], s30 offen
    s_add_u32 s30, s30, 7168
    buffer_load_dwordx4 v[160:163], v153, s[80:83], s30 offen
    s_add_u32 s30, s30, 7168
    buffer_load_dwordx4 v[164:167], v153, s[80:83], s30 offen
    s_add_u32 s30, s30, 7168
    buffer_load_dwordx4 v[168:171], v153, s[80:83], s30 offen
    s_add_u32 s30, s30, 35840
    buffer_load_dwordx4 v[172:175], v153, s[80:83], s30 offen
    s_add_u32 s30, s30, 7168
    buffer_load_dwordx4 v[176:179], v153, s[80:83], s30 offen
    s_add_u32 s30, s30, 7168
    buffer_load_dwordx4 v[180:183], v153, s[80:83], s30 offen
    s_add_u32 s30, s30, 7168
    buffer_load_dwordx4 v[184:187], v153, s[80:83], s30 offen
sk_18:
    s_barrier
    s_lshr_b32 s33, s28, 1
    s_add_u32 s33, s33, s24
    s_sub_u32 s33, s33, 2
    s_and_b32 s34, s28, 1
    s_mov_b64 s[80:81], s[16:17]
    s_mov_b32 s82, 0x600000
    s_mov_b32 s83, 0x20000
    s_mov_b32 s35, 0
    s_cmp_lt_i32 s33, 0
    s_cbranch_scc1 halo_19
    s_mov_b64 s[80:81], s[20:21]
    s_mov_b32 s82, 0x8000000
    s_mov_b32 s83, 0x20000
    s_lshl_b32 s35, s25, 7
    s_lshl_b32 s30, s33, 2
    s_add_u32 s35, s35, s30
    s_lshl_b32 s30, s34, 1
    s_add_u32 s35, s35, s30
    s_lshl_b32 s35, s35, 12
    s_add_u32 s35, s35, s26
    s_lshl_b32 s30, s25, 8
    s_lshl_b32 s31, s33, 4
    s_add_u32 s30, s30, s31
    s_lshl_b32 s31, s34, 3
    s_add_u32 s30, s30, s31
    s_add_u32 s30, s30, s26
    s_add_u32 s30, s30, 0xdc1000
    v_mov_b32 v20, 0
    s_mov_b32 s78, s27
pl_20:
    buffer_load_dwordx2 v[22:23], v20, s[20:23], s30 offen sc1
    s_waitcnt vmcnt(0)
pc_21:
    v_max_u32 v21, v22, v23
    v_cmp_eq_u32 vcc, -1, v21
    s_cbranch_vccz pd_22
    s_sub_u32 s78, s78, 1
    s_cmp_lg_u32 s78, 0
    s_cbranch_scc1 pl_20
    s_mov_b32 s27, 1
pd_22:
halo_19:
    s_lshl_b32 s30, s28, 13
    s_add_u32 m0, s30, 49152
    s_add_u32 s31, s35, 0
    buffer_load_dwordx4 v253, s[80:83], s31 offen offset:0 sc1 lds
    buffer_load_dwordx4 v253, s[80:83], s31 offen offset:1024 sc1 lds
    buffer_load_dwordx4 v253, s[80:83], s31 offen offset:2048 sc1 lds
    buffer_load_dwordx4 v253, s[80:83], s31 offen offset:3072 sc1 lds
    s_add_u32 m0, s30, 53248
    s_add_u32 s31, s35, 4096
    buffer_load_dwordx4 v253, s[80:83], s31 offen offset:0 sc1 lds
    buffer_load_dwordx4 v253, s[80:83], s31 offen offset:1024 sc1 lds
    buffer_load_dwordx4 v253, s[80:83], s31 offen offset:2048 sc1 lds
    buffer_load_dwordx4 v253, s[80:83], s31 offen offset:3072 sc1 lds
    s_add_u32 m0, s30, 98304
    s_add_u32 s31, s35, 262144
    buffer_load_dwordx4 v253, s[80:83], s31 offen offset:0 sc1 lds
    buffer_load_dwordx4 v253, s[80:83], s31 offen offset:1024 sc1 lds
    buffer_load_dwordx4 v253, s[80:83], s31 offen offset:2048 sc1 lds
    buffer_load_dwordx4 v253, s[80:83], s31 offen offset:3072 sc1 lds
    s_add_u32 m0, s30, 102400
    s_add_u32 s31, s35, 266240
    buffer_load_dwordx4 v253, s[80:83], s31 offen offset:0 sc1 lds
    buffer_load_dwordx4 v253, s[80:83], s31 offen offset:1024 sc1 lds
    buffer_load_dwordx4 v253, s[80:83], s31 offen offset:2048 sc1 lds
    buffer_load_dwordx4 v253, s[80:83], s31 offen offset:3072 sc1 lds
    s_mov_b32 s38, 0
    s_cmp_lt_u32 s29, 224
    s_cselect_b32 s39, 1, 0
    s_branch att
l_post:
    v_bfe_u32 v20, v252, 3, 2
    v_lshrrev_b32 v21, 5, v252
    v_lshl_add_u32 v20, v21, 3, v20
    s_lshr_b32 s32, s28, 1
    s_lshl_b32 s32, s32, 4
    s_and_b32 s33, s28, 1
    s_lshl_b32 s33, s33, 2
    s_add_u32 s32, s32, s33
    v_add_u32 v20, s32, v20
    v_lshlrev_b32 v20, 11, v20
    v_lshrrev_b32 v21, 2, v252
    v_and_b32 v21, 4, v21
    v_xor_b32 v21, v21, v252
    v_and_b32 v21, 7, v21
    v_lshl_add_u32 v14, v21, 4, v20
    s_barrier
    s_lshl_b32 s32, s28, 10
    s_lshl_b32 s33, s25, 7
    s_add_u32 m0, s32, 49152
    s_add_u32 s34, s33, 1441792
    buffer_load_dwordx4 v14, s[8:11], s34 offen lds
    s_add_u32 m0, s32, 53248
    s_add_u32 s34, s33, 1572864
    buffer_load_dwordx4 v14, s[8:11], s34 offen lds
    s_add_u32 m0, s32, 57344
    s_add_u32 s34, s33, 1703936
    buffer_load_dwordx4 v14, s[8:11], s34 offen lds
    s_add_u32 m0, s32, 61440
    s_add_u32 s34, s33, 1835008
    buffer_load_dwordx4 v14, s[8:11], s34 offen lds
    s_add_u32 m0, s32, 65536
    s_add_u32 s34, s33, 1966080
    buffer_load_dwordx4 v14, s[8:11], s34 offen lds
    s_add_u32 m0, s32, 69632
    s_add_u32 s34, s33, 65536
    buffer_load_dwordx4 v14, s[8:11], s34 offen lds
    s_add_u32 m0, s32, 73728
    s_add_u32 s34, s33, 196608
    buffer_load_dwordx4 v14, s[8:11], s34 offen lds
    s_add_u32 m0, s32, 77824
    s_add_u32 s34, s33, 327680
    buffer_load_dwordx4 v14, s[8:11], s34 offen lds
    s_add_u32 m0, s32, 81920
    s_add_u32 s34, s33, 458752
    buffer_load_dwordx4 v14, s[8:11], s34 offen lds
    s_add_u32 m0, s32, 86016
    s_add_u32 s34, s33, 589824
    buffer_load_dwordx4 v14, s[8:11], s34 offen lds
    s_add_u32 m0, s32, 90112
    s_add_u32 s34, s33, 720896
    buffer_load_dwordx4 v14, s[8:11], s34 offen lds
    s_add_u32 m0, s32, 94208
    s_add_u32 s34, s33, 851968
    buffer_load_dwordx4 v14, s[8:11], s34 offen lds
    s_add_u32 m0, s32, 98304
    s_add_u32 s34, s33, 983040
    buffer_load_dwordx4 v14, s[8:11], s34 offen lds
    s_add_u32 m0, s32, 102400
    s_add_u32 s34, s33, 1114112
    buffer_load_dwordx4 v14, s[8:11], s34 offen lds
    s_add_u32 m0, s32, 106496
    s_add_u32 s34, s33, 1245184
    buffer_load_dwordx4 v14, s[8:11], s34 offen lds
    s_add_u32 m0, s32, 110592
    s_add_u32 s34, s33, 1376256
    buffer_load_dwordx4 v14, s[8:11], s34 offen lds
    s_add_u32 m0, s32, 114688
    s_add_u32 s34, s33, 1507328
    buffer_load_dwordx4 v14, s[8:11], s34 offen lds
    s_add_u32 m0, s32, 118784
    s_add_u32 s34, s33, 1638400
    buffer_load_dwordx4 v14, s[8:11], s34 offen lds
    s_add_u32 m0, s32, 122880
    s_add_u32 s34, s33, 1769472
    buffer_load_dwordx4 v14, s[8:11], s34 offen lds
    s_add_u32 m0, s32, 126976
    s_add_u32 s34, s33, 1900544
    buffer_load_dwordx4 v14, s[8:11], s34 offen lds
    s_add_u32 m0, s32, 131072
    s_add_u32 s34, s33, 2031616
    buffer_load_dwordx4 v14, s[8:11], s34 offen lds
    v_mov_b32 v154, 0
    s_mov_b64 exec, 1
    s_waitcnt vmcnt(21)
    buffer_store_dword v154, v154, s[20:23], s31 offen sc1
    s_mov_b64 exec, -1
    s_waitcnt vmcnt(0)
    s_barrier
    s_cmp_lg_u32 s26, 0
    s_cbranch_scc1 l_tail
    s_cmp_ge_u32 s29, 224
    s_cbranch_scc1 sk_23
    s_mov_b32 s30, 0x05040100
    s_mov_b32 s31, 0x07060302
    v_perm_b32 v155, v160, v156, s30
    v_perm_b32 v160, v160, v156, s31
    v_perm_b32 v156, v161, v157, s30
    v_perm_b32 v161, v161, v157, s31
    v_perm_b32 v157, v162, v158, s30
    v_perm_b32 v162, v162, v158, s31
    v_perm_b32 v158, v163, v159, s30
    v_perm_b32 v163, v163, v159, s31
    v_perm_b32 v159, v168, v164, s30
    v_perm_b32 v168, v168, v164, s31
    v_perm_b32 v164, v169, v165, s30
    v_perm_b32 v169, v169, v165, s31
    v_perm_b32 v165, v170, v166, s30
    v_perm_b32 v170, v170, v166, s31
    v_perm_b32 v166, v171, v167, s30
    v_perm_b32 v171, v171, v167, s31
    v_perm_b32 v167, v176, v172, s30
    v_perm_b32 v176, v176, v172, s31
    v_perm_b32 v172, v177, v173, s30
    v_perm_b32 v177, v177, v173, s31
    v_perm_b32 v173, v178, v174, s30
    v_perm_b32 v178, v178, v174, s31
    v_perm_b32 v174, v179, v175, s30
    v_perm_b32 v179, v179, v175, s31
    v_perm_b32 v175, v184, v180, s30
    v_perm_b32 v184, v184, v180, s31
    v_perm_b32 v180, v185, v181, s30
    v_perm_b32 v185, v185, v181, s31
    v_perm_b32 v181, v186, v182, s30
    v_perm_b32 v186, v186, v182, s31
    v_perm_b32 v182, v187, v183, s30
    v_perm_b32 v187, v187, v183, s31
    v_perm_b32 v183, v192, v188, s30
    v_perm_b32 v192, v192, v188, s31
    v_perm_b32 v188, v193, v189, s30
    v_perm_b32 v193, v193, v189, s31
    v_perm_b32 v189, v194, v190, s30
    v_perm_b32 v194, v194, v190, s31
    v_perm_b32 v190, v195, v191, s30
    v_perm_b32 v195, v195, v191, s31
    v_perm_b32 v191, v200, v196, s30
    v_perm_b32 v200, v200, v196, s31
    v_perm_b32 v196, v201, v197, s30
    v_perm_b32 v201, v201, v197, s31
    v_perm_b32 v197, v202, v198, s30
    v_perm_b32 v202, v202, v198, s31
    v_perm_b32 v198, v203, v199, s30
    v_perm_b32 v203, v203, v199, s31
    v_perm_b32 v199, v208, v204, s30
    v_perm_b32 v208, v208, v204, s31
    v_perm_b32 v204, v209, v205, s30
    v_perm_b32 v209, v209, v205, s31
    v_perm_b32 v205, v210, v206, s30
    v_perm_b32 v210, v210, v206, s31
    v_perm_b32 v206, v211, v207, s30
    v_perm_b32 v211, v211, v207, s31
    v_perm_b32 v207, v216, v212, s30
    v_perm_b32 v216, v216, v212, s31
    v_perm_b32 v212, v217, v213, s30
    v_perm_b32 v217, v217, v213, s31
    v_perm_b32 v213, v218, v214, s30
    v_perm_b32 v218, v218, v214, s31
    v_perm_b32 v214, v219, v215, s30
    v_perm_b32 v219, v219, v215, s31
    v_perm_b32 v215, v224, v220, s30
    v_perm_b32 v224, v224, v220, s31
    v_perm_b32 v220, v225, v221, s30
    v_perm_b32 v225, v225, v221, s31
    v_perm_b32 v221, v226, v222, s30
    v_perm_b32 v226, v226, v222, s31
    v_perm_b32 v222, v227, v223, s30
    v_perm_b32 v227, v227, v223, s31
    v_perm_b32 v223, v232, v228, s30
    v_perm_b32 v232, v232, v228, s31
    v_perm_b32 v228, v233, v229, s30
    v_perm_b32 v233, v233, v229, s31
    v_perm_b32 v229, v234, v230, s30
    v_perm_b32 v234, v234, v230, s31
    v_perm_b32 v230, v235, v231, s30
    v_perm_b32 v235, v235, v231, s31
    v_perm_b32 v231, v240, v236, s30
    v_perm_b32 v240, v240, v236, s31
    v_perm_b32 v236, v241, v237, s30
    v_perm_b32 v241, v241, v237, s31
    v_perm_b32 v237, v242, v238, s30
    v_perm_b32 v242, v242, v238, s31
    v_perm_b32 v238, v243, v239, s30
    v_perm_b32 v243, v243, v239, s31
    v_perm_b32 v239, v248, v244, s30
    v_perm_b32 v248, v248, v244, s31
    v_perm_b32 v244, v249, v245, s30
    v_perm_b32 v249, v249, v245, s31
    v_perm_b32 v245, v250, v246, s30
    v_perm_b32 v250, v250, v246, s31
    v_perm_b32 v246, v251, v247, s30
    v_perm_b32 v251, v251, v247, s31
sk_23:
    s_lshl_b32 s84, s24, 18
    s_lshl_b32 s32, s28, 12
    s_add_u32 s84, s84, s32
    s_add_u32 s84, s84, 0x2000000
    v_lshrrev_b32 v20, 3, v252
    v_and_b32 v20, 3, v20
    v_lshrrev_b32 v21, 5, v252
    v_lshl_add_u32 v20, v21, 3, v20
    v_mul_u32_u24 v20, 6144, v20
    v_lshrrev_b32 v21, 2, v252
    v_and_b32 v21, 4, v21
    v_xor_b32 v21, v21, v252
    v_and_b32 v21, 7, v21
    v_lshl_add_u32 v20, v21, 4, v20
    s_mul_i32 s32, s28, 6
    s_and_b32 s33, s32, 7
    s_and_b32 s34, s33, 1
    s_and_b32 s33, s33, 6
    s_lshl_b32 s33, s33, 1
    s_add_u32 s33, s33, s34
    s_mul_i32 s33, s33, 24576
    s_lshr_b32 s34, s32, 3
    s_lshl_b32 s34, s34, 11
    s_add_u32 s33, s33, s34
    v_add_u32 v8, s33, v20
    s_add_u32 s32, s32, 1
    s_and_b32 s33, s32, 7
    s_and_b32 s34, s33, 1
    s_and_b32 s33, s33, 6
    s_lshl_b32 s33, s33, 1
    s_add_u32 s33, s33, s34
    s_mul_i32 s33, s33, 24576
    s_lshr_b32 s34, s32, 3
    s_lshl_b32 s34, s34, 11
    s_add_u32 s33, s33, s34
    s_sub_u32 s33, s33, 1024
    v_add_u32 v9, s33, v20
    s_add_u32 s32, s32, 1
    s_and_b32 s33, s32, 7
    s_and_b32 s34, s33, 1
    s_and_b32 s33, s33, 6
    s_lshl_b32 s33, s33, 1
    s_add_u32 s33, s33, s34
    s_mul_i32 s33, s33, 24576
    s_lshr_b32 s34, s32, 3
    s_lshl_b32 s34, s34, 11
    s_add_u32 s33, s33, s34
    s_sub_u32 s33, s33, 2048
    v_add_u32 v10, s33, v20
    s_add_u32 s32, s32, 1
    s_and_b32 s33, s32, 7
    s_and_b32 s34, s33, 1
    s_and_b32 s33, s33, 6
    s_lshl_b32 s33, s33, 1
    s_add_u32 s33, s33, s34
    s_mul_i32 s33, s33, 24576
    s_lshr_b32 s34, s32, 3
    s_lshl_b32 s34, s34, 11
    s_add_u32 s33, s33, s34
    s_sub_u32 s33, s33, 3072
    v_add_u32 v11, s33, v20
    s_add_u32 s32, s32, 1
    s_and_b32 s33, s32, 7
    s_and_b32 s34, s33, 1
    s_and_b32 s33, s33, 6
    s_lshl_b32 s33, s33, 1
    s_add_u32 s33, s33, s34
    s_mul_i32 s33, s33, 24576
    s_lshr_b32 s34, s32, 3
    s_lshl_b32 s34, s34, 11
    s_add_u32 s33, s33, s34
    v_add_u32 v12, s33, v20
    s_add_u32 s32, s32, 1
    s_and_b32 s33, s32, 7
    s_and_b32 s34, s33, 1
    s_and_b32 s33, s33, 6
    s_lshl_b32 s33, s33, 1
    s_add_u32 s33, s33, s34
    s_mul_i32 s33, s33, 24576
    s_lshr_b32 s34, s32, 3
    s_lshl_b32 s34, s34, 11
    s_add_u32 s33, s33, s34
    s_sub_u32 s33, s33, 1024
    v_add_u32 v13, s33, v20
    s_add_u32 s32, s32, 1
    s_lshl_b32 s85, s25, 7
    s_lshl_b32 s86, s28, 12
    s_mul_i32 s87, s28, 6144
    v_and_b32 v16, 15, v252
    v_lshlrev_b32 v16, 9, v16
    s_lshl_b32 s30, s37, 13
    s_add_u32 s30, s30, 0xc00000
    s_mov_b32 s79, 0
    s_mov_b32 s26, 16777216
    s_sub_u32 s34, s29, 224
    s_lshl_b32 s34, s34, 1
    s_add_u32 s89, s34, s28
    s_barrier
    s_add_u32 m0, s87, 16384
    s_add_u32 s32, s85, 0
    buffer_load_dwordx4 v8, s[16:19], s32 offen offset:0 lds
    buffer_load_dwordx4 v9, s[16:19], s32 offen offset:1024 lds
    buffer_load_dwordx4 v10, s[16:19], s32 offen offset:2048 lds
    buffer_load_dwordx4 v11, s[16:19], s32 offen offset:3072 lds
    s_add_u32 m0, s87, 20480
    s_nop 0
    buffer_load_dwordx4 v12, s[16:19], s32 offen offset:0 lds
    buffer_load_dwordx4 v13, s[16:19], s32 offen offset:1024 lds
    s_add_u32 m0, s87, 57344
    s_add_u32 s32, s85, 393216
    buffer_load_dwordx4 v8, s[16:19], s32 offen offset:0 lds
    buffer_load_dwordx4 v9, s[16:19], s32 offen offset:1024 lds
    buffer_load_dwordx4 v10, s[16:19], s32 offen offset:2048 lds
    buffer_load_dwordx4 v11, s[16:19], s32 offen offset:3072 lds
    s_add_u32 m0, s87, 61440
    s_nop 0
    buffer_load_dwordx4 v12, s[16:19], s32 offen offset:0 lds
    buffer_load_dwordx4 v13, s[16:19], s32 offen offset:1024 lds
    s_add_u32 m0, s87, 98304
    s_add_u32 s32, s85, 786432
    buffer_load_dwordx4 v8, s[16:19], s32 offen offset:0 lds
    buffer_load_dwordx4 v9, s[16:19], s32 offen offset:1024 lds
    buffer_load_dwordx4 v10, s[16:19], s32 offen offset:2048 lds
    buffer_load_dwordx4 v11, s[16:19], s32 offen offset:3072 lds
    s_add_u32 m0, s87, 102400
    s_nop 0
    buffer_load_dwordx4 v12, s[16:19], s32 offen offset:0 lds
    buffer_load_dwordx4 v13, s[16:19], s32 offen offset:1024 lds
    s_add_u32 m0, s87, 139264
    s_add_u32 s32, s85, 1179648
    buffer_load_dwordx4 v8, s[16:19], s32 offen offset:0 lds
    buffer_load_dwordx4 v9, s[16:19], s32 offen offset:1024 lds
    buffer_load_dwordx4 v10, s[16:19], s32 offen offset:2048 lds
    buffer_load_dwordx4 v11, s[16:19], s32 offen offset:3072 lds
    s_add_u32 m0, s87, 143360
    s_nop 0
    buffer_load_dwordx4 v12, s[16:19], s32 offen offset:0 lds
    buffer_load_dwordx4 v13, s[16:19], s32 offen offset:1024 lds
    s_mov_b32 s78, s27
pl_24:
    buffer_load_dword v17, v16, s[20:23], s30 offen sc1
    s_waitcnt vmcnt(0)
pc_25:
    v_cmp_eq_u32 vcc, -1, v17
    s_cbranch_vccz pd_26
    s_sub_u32 s78, s78, 1
    s_cmp_lg_u32 s78, 0
    s_cbranch_scc1 pl_24
    s_mov_b32 s27, 1
pd_26:
    s_add_u32 m0, s86, 0
    s_add_u32 s32, s84, 0
    buffer_load_dwordx4 v253, s[20:23], s32 offen offset:0 sc1 lds
    buffer_load_dwordx4 v253, s[20:23], s32 offen offset:1024 sc1 lds
    buffer_load_dwordx4 v253, s[20:23], s32 offen offset:2048 sc1 lds
    buffer_load_dwordx4 v253, s[20:23], s32 offen offset:3072 sc1 lds
    s_add_u32 m0, s86, 40960
    s_add_u32 s32, s84, 16384
    buffer_load_dwordx4 v253, s[20:23], s32 offen offset:0 sc1 lds
    buffer_load_dwordx4 v253, s[20:23], s32 offen offset:1024 sc1 lds
    buffer_load_dwordx4 v253, s[20:23], s32 offen offset:2048 sc1 lds
    buffer_load_dwordx4 v253, s[20:23], s32 offen offset:3072 sc1 lds
    s_add_u32 m0, s86, 81920
    s_add_u32 s32, s84, 32768
    buffer_load_dwordx4 v253, s[20:23], s32 offen offset:0 sc1 lds
    buffer_load_dwordx4 v253, s[20:23], s32 offen offset:1024 sc1 lds
    buffer_load_dwordx4 v253, s[20:23], s32 offen offset:2048 sc1 lds
    buffer_load_dwordx4 v253, s[20:23], s32 offen offset:3072 sc1 lds
    s_add_u32 m0, s86, 122880
    s_add_u32 s32, s84, 49152
    buffer_load_dwordx4 v253, s[20:23], s32 offen offset:0 sc1 lds
    buffer_load_dwordx4 v253, s[20:23], s32 offen offset:1024 sc1 lds
    buffer_load_dwordx4 v253, s[20:23], s32 offen offset:2048 sc1 lds
    buffer_load_dwordx4 v253, s[20:23], s32 offen offset:3072 sc1 lds
    s_waitcnt vmcnt(12)
    s_barrier
    s_waitcnt vmcnt(8)
    s_barrier
    s_add_u32 s32, s79, 0xdc0000
    buffer_load_dwordx4 v[16:19], v253, s[20:23], s32 offen sc1
    s_add_u32 m0, s86, 0
    s_add_u32 s32, s84, 65536
    buffer_load_dwordx4 v253, s[20:23], s32 offen offset:0 sc1 lds
    buffer_load_dwordx4 v253, s[20:23], s32 offen offset:1024 sc1 lds
    buffer_load_dwordx4 v253, s[20:23], s32 offen offset:2048 sc1 lds
    buffer_load_dwordx4 v253, s[20:23], s32 offen offset:3072 sc1 lds
    s_add_u32 m0, s87, 16384
    s_add_u32 s32, s85, 1572864
    buffer_load_dwordx4 v8, s[16:19], s32 offen offset:0 lds
    buffer_load_dwordx4 v9, s[16:19], s32 offen offset:1024 lds
    buffer_load_dwordx4 v10, s[16:19], s32 offen offset:2048 lds
    buffer_load_dwordx4 v11, s[16:19], s32 offen offset:3072 lds
    s_add_u32 m0, s87, 20480
    s_nop 0
    buffer_load_dwordx4 v12, s[16:19], s32 offen offset:0 lds
    buffer_load_dwordx4 v13, s[16:19], s32 offen offset:1024 lds
    s_waitcnt vmcnt(14)
    s_barrier
    s_add_u32 m0, s86, 40960
    s_add_u32 s32, s84, 81920
    buffer_load_dwordx4 v253, s[20:23], s32 offen offset:0 sc1 lds
    buffer_load_dwordx4 v253, s[20:23], s32 offen offset:1024 sc1 lds
    buffer_load_dwordx4 v253, s[20:23], s32 offen offset:2048 sc1 lds
    buffer_load_dwordx4 v253, s[20:23], s32 offen offset:3072 sc1 lds
    s_add_u32 m0, s87, 57344
    s_add_u32 s32, s85, 1966080
    buffer_load_dwordx4 v8, s[16:19], s32 offen offset:0 lds
    buffer_load_dwordx4 v9, s[16:19], s32 offen offset:1024 lds
    buffer_load_dwordx4 v10, s[16:19], s32 offen offset:2048 lds
    buffer_load_dwordx4 v11, s[16:19], s32 offen offset:3072 lds
    s_add_u32 m0, s87, 61440
    s_nop 0
    buffer_load_dwordx4 v12, s[16:19], s32 offen offset:0 lds
    buffer_load_dwordx4 v13, s[16:19], s32 offen offset:1024 lds
    s_waitcnt vmcnt(20)
    s_barrier
    s_mov_b32 s78, s27
    s_branch pc_28
pl_27:
    s_add_u32 s32, s79, 0xdc0000
    buffer_load_dwordx4 v[16:19], v253, s[20:23], s32 offen sc1
    s_waitcnt vmcnt(0)
pc_28:
    v_max3_u32 v20, v16, v17, v18
    v_max_u32 v20, v20, v19
    v_cmp_eq_u32 vcc, -1, v20
    s_cbranch_vccz pd_29
    s_sub_u32 s78, s78, 1
    s_cmp_lg_u32 s78, 0
    s_cbranch_scc1 pl_27
    s_mov_b32 s27, 1
pd_29:
    v_mov_b32 v20, v16
    s_nop 1
    v_max_f32_dpp v20, v20, v20 quad_perm:[1,0,3,2] row_mask:0xf bank_mask:0xf
    s_nop 1
    v_max_f32_dpp v20, v20, v20 quad_perm:[2,3,0,1] row_mask:0xf bank_mask:0xf
    s_nop 1
    v_max_f32_dpp v20, v20, v20 row_half_mirror row_mask:0xf bank_mask:0xf
    s_nop 1
    v_max_f32_dpp v20, v20, v20 row_mirror row_mask:0xf bank_mask:0xf
    v_mov_b32 v21, v20
    s_nop 1
    v_permlane16_swap_b32 v20, v21
    v_max_f32 v20, v20, v21
    v_mov_b32 v21, v20
    s_nop 1
    v_permlane32_swap_b32 v20, v21
    v_max_f32 v20, v20, v21
    v_cmp_eq_f32 vcc, v20, v16
    s_ff1_i32_b64 s32, vcc
    s_and_b32 s32, s32, 63
    v_readlane_b32 s74, v16, s32
    v_readlane_b32 s73, v17, s32
    v_readlane_b32 s75, v18, s32
    v_readlane_b32 s76, v19, s32
    s_and_b32 s73, s73, 2047
    s_lshr_b32 s33, s73, 5
    s_lshl_b32 s33, s33, 11
    s_add_u32 s33, s33, s79
    s_add_u32 s33, s33, 0xd60000
    s_lshl_b32 s32, s28, 9
    s_sub_u32 s34, s29, 224
    s_lshl_b32 s34, s34, 1
    s_and_b32 s35, s28, 1
    s_add_u32 s34, s34, s35
    s_lshl_b32 s34, s34, 5
    v_lshrrev_b32 v22, 1, v252
    v_and_b32 v23, 1, v252
    s_cmp_lt_u32 s29, 224
    s_cselect_b32 s32, s32, s34
    s_cselect_b64 vcc, -1, 0
    s_add_u32 s88, s33, s32
    v_cndmask_b32 v22, v23, v22, vcc
    v_lshlrev_b32 v22, 4, v22
    buffer_load_dwordx4 v[24:27], v22, s[20:23], s88 offen sc1
    s_add_u32 m0, s86, 81920
    s_add_u32 s32, s84, 98304
    buffer_load_dwordx4 v253, s[20:23], s32 offen offset:0 sc1 lds
    buffer_load_dwordx4 v253, s[20:23], s32 offen offset:1024 sc1 lds
    buffer_load_dwordx4 v253, s[20:23], s32 offen offset:2048 sc1 lds
    buffer_load_dwordx4 v253, s[20:23], s32 offen offset:3072 sc1 lds
    s_add_u32 m0, s87, 98304
    s_add_u32 s32, s85, 2359296
    buffer_load_dwordx4 v8, s[16:19], s32 offen offset:0 lds
    buffer_load_dwordx4 v9, s[16:19], s32 offen offset:1024 lds
    buffer_load_dwordx4 v10, s[16:19], s32 offen offset:2048 lds
    buffer_load_dwordx4 v11, s[16:19], s32 offen offset:3072 lds
    s_add_u32 m0, s87, 102400
    s_nop 0
    buffer_load_dwordx4 v12, s[16:19], s32 offen offset:0 lds
    buffer_load_dwordx4 v13, s[16:19], s32 offen offset:1024 lds
    s_waitcnt vmcnt(20)
    s_barrier
    s_add_u32 m0, s86, 122880
    s_add_u32 s32, s84, 114688
    buffer_load_dwordx4 v253, s[20:23], s32 offen offset:0 sc1 lds
    buffer_load_dwordx4 v253, s[20:23], s32 offen offset:1024 sc1 lds
    buffer_load_dwordx4 v253, s[20:23], s32 offen offset:2048 sc1 lds
    buffer_load_dwordx4 v253, s[20:23], s32 offen offset:3072 sc1 lds
    s_add_u32 m0, s87, 139264
    s_add_u32 s32, s85, 2752512
    buffer_load_dwordx4 v8, s[16:19], s32 offen offset:0 lds
    buffer_load_dwordx4 v9, s[16:19], s32 offen offset:1024 lds
    buffer_load_dwordx4 v10, s[16:19], s32 offen offset:2048 lds
    buffer_load_dwordx4 v11, s[16:19], s32 offen offset:3072 lds
    s_add_u32 m0, s87, 143360
    s_nop 0
    buffer_load_dwordx4 v12, s[16:19], s32 offen offset:0 lds
    buffer_load_dwordx4 v13, s[16:19], s32 offen offset:1024 lds
    s_waitcnt vmcnt(20)
    s_barrier
    s_add_u32 m0, s86, 0
    s_add_u32 s32, s84, 131072
    buffer_load_dwordx4 v253, s[20:23], s32 offen offset:1024 sc1 lds
    buffer_load_dwordx4 v253, s[20:23], s32 offen offset:2048 sc1 lds
    buffer_load_dwordx4 v253, s[20:23], s32 offen offset:3072 sc1 lds
    s_add_u32 m0, s87, 16384
    s_add_u32 s32, s85, 3145728
    buffer_load_dwordx4 v8, s[16:19], s32 offen offset:0 lds
    buffer_load_dwordx4 v9, s[16:19], s32 offen offset:1024 lds
    buffer_load_dwordx4 v10, s[16:19], s32 offen offset:2048 lds
    buffer_load_dwordx4 v11, s[16:19], s32 offen offset:3072 lds
    s_add_u32 m0, s87, 20480
    s_nop 0
    buffer_load_dwordx4 v12, s[16:19], s32 offen offset:0 lds
    buffer_load_dwordx4 v13, s[16:19], s32 offen offset:1024 lds
    s_mov_b32 s78, s27
    s_branch pc_31
pl_30:
    buffer_load_dwordx4 v[24:27], v22, s[20:23], s88 offen sc1
    s_waitcnt vmcnt(0)
pc_31:
    v_max3_u32 v30, v24, v25, v26
    v_max_u32 v30, v30, v27
    v_cmp_eq_u32 vcc, -1, v30
    s_cbranch_vccz pd_32
    s_sub_u32 s78, s78, 1
    s_cmp_lg_u32 s78, 0
    s_cbranch_scc1 pl_30
    s_mov_b32 s27, 1
pd_32:
    s_cmp_ge_u32 s29, 224
    s_cbranch_scc1 sk_33
    v_mov_b32 v28, s76
    v_mul_f32 v29, s75, v28
    v_lshlrev_b32 v30, 16, v24
    v_and_b32 v31, 0xffff0000, v24
    v_fma_f32 v30, v30, v28, -v29
    v_fma_f32 v31, v31, v28, -v29
    v_cvt_pk_bf16_f32 v24, v30, v31
    v_lshlrev_b32 v30, 16, v25
    v_and_b32 v31, 0xffff0000, v25
    v_fma_f32 v30, v30, v28, -v29
    v_fma_f32 v31, v31, v28, -v29
    v_cvt_pk_bf16_f32 v25, v30, v31
    v_lshlrev_b32 v30, 16, v26
    v_and_b32 v31, 0xffff0000, v26
    v_fma_f32 v30, v30, v28, -v29
    v_fma_f32 v31, v31, v28, -v29
    v_cvt_pk_bf16_f32 v26, v30, v31
    v_lshlrev_b32 v30, 16, v27
    v_and_b32 v31, 0xffff0000, v27
    v_fma_f32 v30, v30, v28, -v29
    v_fma_f32 v31, v31, v28, -v29
    v_cvt_pk_bf16_f32 v27, v30, v31
    v_dot2_f32_bf16 v32, v155, v24, 0
    v_dot2_f32_bf16 v33, v160, v24, 0
    v_dot2_f32_bf16 v34, v156, v24, 0
    v_dot2_f32_bf16 v35, v161, v24, 0
    v_dot2_f32_bf16 v36, v157, v24, 0
    v_dot2_f32_bf16 v37, v162, v24, 0
    v_dot2_f32_bf16 v38, v158, v24, 0
    v_dot2_f32_bf16 v39, v163, v24, 0
    v_dot2_f32_bf16 v40, v183, v24, 0
    v_dot2_f32_bf16 v41, v192, v24, 0
    v_dot2_f32_bf16 v42, v188, v24, 0
    v_dot2_f32_bf16 v43, v193, v24, 0
    v_dot2_f32_bf16 v44, v189, v24, 0
    v_dot2_f32_bf16 v45, v194, v24, 0
    v_dot2_f32_bf16 v46, v190, v24, 0
    v_dot2_f32_bf16 v47, v195, v24, 0
    v_dot2_f32_bf16 v32, v159, v25, v32
    v_dot2_f32_bf16 v33, v168, v25, v33
    v_dot2_f32_bf16 v34, v164, v25, v34
    v_dot2_f32_bf16 v35, v169, v25, v35
    v_dot2_f32_bf16 v36, v165, v25, v36
    v_dot2_f32_bf16 v37, v170, v25, v37
    v_dot2_f32_bf16 v38, v166, v25, v38
    v_dot2_f32_bf16 v39, v171, v25, v39
    v_dot2_f32_bf16 v40, v191, v25, v40
    v_dot2_f32_bf16 v41, v200, v25, v41
    v_dot2_f32_bf16 v42, v196, v25, v42
    v_dot2_f32_bf16 v43, v201, v25, v43
    v_dot2_f32_bf16 v44, v197, v25, v44
    v_dot2_f32_bf16 v45, v202, v25, v45
    v_dot2_f32_bf16 v46, v198, v25, v46
    v_dot2_f32_bf16 v47, v203, v25, v47
    v_dot2_f32_bf16 v32, v167, v26, v32
    v_dot2_f32_bf16 v33, v176, v26, v33
    v_dot2_f32_bf16 v34, v172, v26, v34
    v_dot2_f32_bf16 v35, v177, v26, v35
    v_dot2_f32_bf16 v36, v173, v26, v36
    v_dot2_f32_bf16 v37, v178, v26, v37
    v_dot2_f32_bf16 v38, v174, v26, v38
    v_dot2_f32_bf16 v39, v179, v26, v39
    v_dot2_f32_bf16 v40, v199, v26, v40
    v_dot2_f32_bf16 v41, v208, v26, v41
    v_dot2_f32_bf16 v42, v204, v26, v42
    v_dot2_f32_bf16 v43, v209, v26, v43
    v_dot2_f32_bf16 v44, v205, v26, v44
    v_dot2_f32_bf16 v45, v210, v26, v45
    v_dot2_f32_bf16 v46, v206, v26, v46
    v_dot2_f32_bf16 v47, v211, v26, v47
    v_dot2_f32_bf16 v32, v175, v27, v32
    v_dot2_f32_bf16 v33, v184, v27, v33
    v_dot2_f32_bf16 v34, v180, v27, v34
    v_dot2_f32_bf16 v35, v185, v27, v35
    v_dot2_f32_bf16 v36, v181, v27, v36
    v_dot2_f32_bf16 v37, v186, v27, v37
    v_dot2_f32_bf16 v38, v182, v27, v38
    v_dot2_f32_bf16 v39, v187, v27, v39
    v_dot2_f32_bf16 v40, v207, v27, v40
    v_dot2_f32_bf16 v41, v216, v27, v41
    v_dot2_f32_bf16 v42, v212, v27, v42
    v_dot2_f32_bf16 v43, v217, v27, v43
    v_dot2_f32_bf16 v44, v213, v27, v44
    v_dot2_f32_bf16 v45, v218, v27, v45
    v_dot2_f32_bf16 v46, v214, v27, v46
    v_dot2_f32_bf16 v47, v219, v27, v47
    v_bfe_u32 v30, v252, 2, 2
    v_mul_u32_u24 v30, 4096, v30
    v_lshrrev_b32 v31, 5, v252
    v_lshl_add_u32 v30, v31, 6, v30
    v_permlane32_swap_b32 v32, v40
    v_permlane32_swap_b32 v33, v41
    v_permlane32_swap_b32 v34, v42
    v_permlane32_swap_b32 v35, v43
    v_permlane32_swap_b32 v36, v44
    v_permlane32_swap_b32 v37, v45
    v_permlane32_swap_b32 v38, v46
    v_permlane32_swap_b32 v39, v47
    v_add_f32 v32, v32, v40
    v_add_f32 v33, v33, v41
    v_add_f32 v34, v34, v42
    v_add_f32 v35, v35, v43
    v_add_f32 v36, v36, v44
    v_add_f32 v37, v37, v45
    v_add_f32 v38, v38, v46
    v_add_f32 v39, v39, v47
    v_and_b32 v31, 1, v252
    v_lshl_add_u32 v30, v31, 5, v30
    v_permlane16_swap_b32 v32, v36
    v_permlane16_swap_b32 v33, v37
    v_permlane16_swap_b32 v34, v38
    v_permlane16_swap_b32 v35, v39
    v_add_f32 v32, v32, v36
    v_add_f32 v33, v33, v37
    v_add_f32 v34, v34, v38
    v_add_f32 v35, v35, v39
    v_and_b32 v31, 16, v252
    v_add_u32 v30, v31, v30
    s_lshl_b32 s32, s28, 7
    v_add_u32 v30, s32, v30
    v_add_f32_dpp v32, v32, v32 quad_perm:[2,3,0,1] row_mask:0xf bank_mask:0xf
    v_add_f32_dpp v33, v33, v33 quad_perm:[2,3,0,1] row_mask:0xf bank_mask:0xf
    v_add_f32_dpp v34, v34, v34 quad_perm:[2,3,0,1] row_mask:0xf bank_mask:0xf
    v_add_f32_dpp v35, v35, v35 quad_perm:[2,3,0,1] row_mask:0xf bank_mask:0xf
    v_add_f32_dpp v32, v32, v32 row_ror:4 row_mask:0xf bank_mask:0xf
    v_add_f32_dpp v33, v33, v33 row_ror:4 row_mask:0xf bank_mask:0xf
    v_add_f32_dpp v34, v34, v34 row_ror:4 row_mask:0xf bank_mask:0xf
    v_add_f32_dpp v35, v35, v35 row_ror:4 row_mask:0xf bank_mask:0xf
    v_add_f32_dpp v32, v32, v32 row_ror:8 row_mask:0xf bank_mask:0xf
    v_add_f32_dpp v33, v33, v33 row_ror:8 row_mask:0xf bank_mask:0xf
    v_add_f32_dpp v34, v34, v34 row_ror:8 row_mask:0xf bank_mask:0xf
    v_add_f32_dpp v35, v35, v35 row_ror:8 row_mask:0xf bank_mask:0xf
    ds_write_b128 v30, v[32:35] offset:0
sk_33:
    s_cmp_lt_u32 s29, 224
    s_cbranch_scc1 sk_34
    s_cmp_ge_u32 s28, 2
    s_cbranch_scc1 sk_34
    v_and_b32 v30, 2, v252
    v_cmp_eq_u32 vcc, 2, v30
    v_mov_b32 v28, s76
    v_mul_f32 v29, s75, v28
    v_add_f32 v28, 1.0, v28
    v_cndmask_b32 v30, v24, v26, vcc
    v_cndmask_b32 v31, v25, v27, vcc
    v_lshlrev_b32 v92, 16, v30
    v_and_b32 v93, 0xffff0000, v30
    v_lshlrev_b32 v94, 16, v31
    v_and_b32 v95, 0xffff0000, v31
    v_fma_f32 v92, v92, v28, -v29
    v_fma_f32 v93, v93, v28, -v29
    v_fma_f32 v94, v94, v28, -v29
    v_fma_f32 v95, v95, v28, -v29
    v_mov_b32 v96, 0xbfb8aa3b
    v_mul_f32 v96, s74, v96
    v_exp_f32 v96, v96
    s_nop 0
    v_add_f32 v96, 1.0, v96
    v_rcp_f32 v96, v96
sk_34:
    s_waitcnt vmcnt(19) lgkmcnt(0)
    s_barrier
    s_cmp_ge_u32 s29, 224
    s_cbranch_scc1 sk_35
    v_and_b32 v30, 1, v252
    v_bfe_u32 v31, v252, 1, 3
    v_lshl_add_u32 v30, v30, 3, v31
    s_mul_i32 s32, s28, 4096
    v_lshl_add_u32 v30, v30, 2, s32
    ds_read_b32 v32, v30 offset:0
    ds_read_b32 v33, v30 offset:64
    ds_read_b32 v34, v30 offset:128
    ds_read_b32 v35, v30 offset:192
    ds_read_b32 v36, v30 offset:256
    ds_read_b32 v37, v30 offset:320
    ds_read_b32 v38, v30 offset:384
    ds_read_b32 v39, v30 offset:448
    s_waitcnt lgkmcnt(0)
sk_35:
    s_add_u32 m0, s86, 0
    s_add_u32 s32, s84, 131072
    buffer_load_dwordx4 v253, s[20:23], s32 offen offset:0 sc1 lds
    s_cmp_ge_u32 s29, 224
    s_cbranch_scc1 sk_36
    v_add_f32 v32, v32, v34
    v_add_f32 v36, v36, v38
    v_add_f32 v33, v33, v35
    v_add_f32 v37, v37, v39
    v_add_f32 v32, v32, v36
    v_add_f32 v33, v33, v37
    v_mul_f32 v34, 0xbfb8aa3b, v32
    v_exp_f32 v34, v34
    v_mul_f32 v32, v32, v33
    v_add_f32 v34, 1.0, v34
    v_rcp_f32 v34, v34
    v_lshrrev_b32 v30, 2, v252
    v_mul_f32 v32, v32, v34
    s_nop 1
    v_mov_b32_dpp v33, v32 quad_perm:[2,3,2,3] row_mask:0xf bank_mask:0xf
    v_cvt_pk_bf16_f32 v32, v32, v33
    ds_swizzle_b32 v36, v32 offset:0x1
    ds_swizzle_b32 v37, v32 offset:0x81
    ds_swizzle_b32 v38, v32 offset:0x101
    ds_swizzle_b32 v39, v32 offset:0x181
    v_mul_u32_u24 v30, 14336, v30
    v_and_b32 v31, 3, v252
    v_lshl_add_u32 v30, v31, 4, v30
    v_and_b32 v31, 1, v252
    v_cmp_eq_u32 vcc, 1, v31
    s_mul_i32 s32, s28, 229376
    s_lshl_b32 s33, s29, 6
    s_add_u32 s32, s32, s33
    s_add_u32 s32, s32, s79
    s_add_u32 s32, s32, 0xc80000
    s_waitcnt lgkmcnt(0)
    v_dot2_f32_bf16 v40, v215, v36, 0
    v_dot2_f32_bf16 v41, v224, v36, 0
    v_dot2_f32_bf16 v42, v220, v36, 0
    v_dot2_f32_bf16 v43, v225, v36, 0
    v_dot2_f32_bf16 v44, v221, v36, 0
    v_dot2_f32_bf16 v45, v226, v36, 0
    v_dot2_f32_bf16 v46, v222, v36, 0
    v_dot2_f32_bf16 v47, v227, v36, 0
    v_dot2_f32_bf16 v40, v223, v37, v40
    v_dot2_f32_bf16 v41, v232, v37, v41
    v_dot2_f32_bf16 v42, v228, v37, v42
    v_dot2_f32_bf16 v43, v233, v37, v43
    v_dot2_f32_bf16 v44, v229, v37, v44
    v_dot2_f32_bf16 v45, v234, v37, v45
    v_dot2_f32_bf16 v46, v230, v37, v46
    v_dot2_f32_bf16 v47, v235, v37, v47
    v_dot2_f32_bf16 v40, v231, v38, v40
    v_dot2_f32_bf16 v41, v240, v38, v41
    v_dot2_f32_bf16 v42, v236, v38, v42
    v_dot2_f32_bf16 v43, v241, v38, v43
    v_dot2_f32_bf16 v44, v237, v38, v44
    v_dot2_f32_bf16 v45, v242, v38, v45
    v_dot2_f32_bf16 v46, v238, v38, v46
    v_dot2_f32_bf16 v47, v243, v38, v47
    v_dot2_f32_bf16 v40, v239, v39, v40
    v_dot2_f32_bf16 v41, v248, v39, v41
    v_dot2_f32_bf16 v42, v244, v39, v42
    v_dot2_f32_bf16 v43, v249, v39, v43
    v_dot2_f32_bf16 v44, v245, v39, v44
    v_dot2_f32_bf16 v45, v250, v39, v45
    v_dot2_f32_bf16 v46, v246, v39, v46
    v_dot2_f32_bf16 v47, v251, v39, v47
    v_add_f32_dpp v40, v40, v40 quad_perm:[1,0,3,2] row_mask:0xf bank_mask:0xf
    v_add_f32_dpp v41, v41, v41 quad_perm:[1,0,3,2] row_mask:0xf bank_mask:0xf
    v_add_f32_dpp v42, v42, v42 quad_perm:[1,0,3,2] row_mask:0xf bank_mask:0xf
    v_add_f32_dpp v43, v43, v43 quad_perm:[1,0,3,2] row_mask:0xf bank_mask:0xf
    v_add_f32_dpp v44, v44, v44 quad_perm:[1,0,3,2] row_mask:0xf bank_mask:0xf
    v_add_f32_dpp v45, v45, v45 quad_perm:[1,0,3,2] row_mask:0xf bank_mask:0xf
    v_add_f32_dpp v46, v46, v46 quad_perm:[1,0,3,2] row_mask:0xf bank_mask:0xf
    v_add_f32_dpp v47, v47, v47 quad_perm:[1,0,3,2] row_mask:0xf bank_mask:0xf
    v_cndmask_b32 v40, v40, v44, vcc
    v_cndmask_b32 v41, v41, v45, vcc
    v_cndmask_b32 v42, v42, v46, vcc
    v_cndmask_b32 v43, v43, v47, vcc
    buffer_store_dwordx4 v[40:43], v30, s[20:23], s32 offen sc1
sk_36:
    s_add_u32 m0, s86, 40960
    s_add_u32 s32, s84, 147456
    buffer_load_dwordx4 v253, s[20:23], s32 offen offset:0 sc1 lds
    buffer_load_dwordx4 v253, s[20:23], s32 offen offset:1024 sc1 lds
    buffer_load_dwordx4 v253, s[20:23], s32 offen offset:2048 sc1 lds
    buffer_load_dwordx4 v253, s[20:23], s32 offen offset:3072 sc1 lds
    s_add_u32 m0, s87, 57344
    s_add_u32 s32, s85, 3538944
    buffer_load_dwordx4 v8, s[16:19], s32 offen offset:0 lds
    buffer_load_dwordx4 v9, s[16:19], s32 offen offset:1024 lds
    buffer_load_dwordx4 v10, s[16:19], s32 offen offset:2048 lds
    buffer_load_dwordx4 v11, s[16:19], s32 offen offset:3072 lds
    s_add_u32 m0, s87, 61440
    s_nop 0
    buffer_load_dwordx4 v12, s[16:19], s32 offen offset:0 lds
    buffer_load_dwordx4 v13, s[16:19], s32 offen offset:1024 lds
    s_waitcnt vmcnt(20)
    s_barrier
    s_add_u32 m0, s86, 81920
    s_add_u32 s32, s84, 163840
    buffer_load_dwordx4 v253, s[20:23], s32 offen offset:0 sc1 lds
    buffer_load_dwordx4 v253, s[20:23], s32 offen offset:1024 sc1 lds
    buffer_load_dwordx4 v253, s[20:23], s32 offen offset:2048 sc1 lds
    buffer_load_dwordx4 v253, s[20:23], s32 offen offset:3072 sc1 lds
    s_add_u32 m0, s87, 98304
    s_add_u32 s32, s85, 3932160
    buffer_load_dwordx4 v8, s[16:19], s32 offen offset:0 lds
    buffer_load_dwordx4 v9, s[16:19], s32 offen offset:1024 lds
    buffer_load_dwordx4 v10, s[16:19], s32 offen offset:2048 lds
    buffer_load_dwordx4 v11, s[16:19], s32 offen offset:3072 lds
    s_add_u32 m0, s87, 102400
    s_nop 0
    buffer_load_dwordx4 v12, s[16:19], s32 offen offset:0 lds
    buffer_load_dwordx4 v13, s[16:19], s32 offen offset:1024 lds
    s_waitcnt vmcnt(20)
    s_barrier
    s_cmp_lt_u32 s29, 224
    s_cbranch_scc1 sk_37
    s_cmp_ge_u32 s28, 2
    s_cbranch_scc1 sk_37
    s_mul_i32 s32, s89, 14336
    s_add_u32 s32, s32, s79
    s_add_u32 s32, s32, 0xc80000
    buffer_load_dwordx4 v[32:35], v253, s[20:23], s32 offen offset:0 sc1
    buffer_load_dwordx4 v[36:39], v253, s[20:23], s32 offen offset:1024 sc1
    buffer_load_dwordx4 v[40:43], v253, s[20:23], s32 offen offset:2048 sc1
    buffer_load_dwordx4 v[44:47], v253, s[20:23], s32 offen offset:3072 sc1
    s_add_u32 s32, s32, 4096
    buffer_load_dwordx4 v[48:51], v253, s[20:23], s32 offen offset:0 sc1
    buffer_load_dwordx4 v[52:55], v253, s[20:23], s32 offen offset:1024 sc1
    buffer_load_dwordx4 v[56:59], v253, s[20:23], s32 offen offset:2048 sc1
    buffer_load_dwordx4 v[60:63], v253, s[20:23], s32 offen offset:3072 sc1
    s_add_u32 s32, s32, 4096
    buffer_load_dwordx4 v[64:67], v253, s[20:23], s32 offen offset:0 sc1
    buffer_load_dwordx4 v[68:71], v253, s[20:23], s32 offen offset:1024 sc1
    buffer_load_dwordx4 v[72:75], v253, s[20:23], s32 offen offset:2048 sc1
    buffer_load_dwordx4 v[76:79], v253, s[20:23], s32 offen offset:3072 sc1
    s_add_u32 s32, s32, 4096
    buffer_load_dwordx4 v[80:83], v253, s[20:23], s32 offen offset:0 sc1
    buffer_load_dwordx4 v[84:87], v253, s[20:23], s32 offen offset:1024 sc1
sk_37:
    s_add_u32 m0, s86, 122880
    s_add_u32 s32, s84, 180224
    buffer_load_dwordx4 v253, s[20:23], s32 offen offset:0 sc1 lds
    buffer_load_dwordx4 v253, s[20:23], s32 offen offset:1024 sc1 lds
    buffer_load_dwordx4 v253, s[20:23], s32 offen offset:2048 sc1 lds
    buffer_load_dwordx4 v253, s[20:23], s32 offen offset:3072 sc1 lds
    s_add_u32 m0, s87, 139264
    s_add_u32 s32, s85, 4325376
    buffer_load_dwordx4 v8, s[16:19], s32 offen offset:0 lds
    buffer_load_dwordx4 v9, s[16:19], s32 offen offset:1024 lds
    buffer_load_dwordx4 v10, s[16:19], s32 offen offset:2048 lds
    buffer_load_dwordx4 v11, s[16:19], s32 offen offset:3072 lds
    s_add_u32 m0, s87, 143360
    s_nop 0
    buffer_load_dwordx4 v12, s[16:19], s32 offen offset:0 lds
    buffer_load_dwordx4 v13, s[16:19], s32 offen offset:1024 lds
    s_waitcnt vmcnt(20)
    s_barrier
    s_add_u32 m0, s86, 0
    s_add_u32 s32, s84, 196608
    buffer_load_dwordx4 v253, s[20:23], s32 offen offset:0 sc1 lds
    buffer_load_dwordx4 v253, s[20:23], s32 offen offset:1024 sc1 lds
    buffer_load_dwordx4 v253, s[20:23], s32 offen offset:2048 sc1 lds
    buffer_load_dwordx4 v253, s[20:23], s32 offen offset:3072 sc1 lds
    s_add_u32 m0, s87, 16384
    s_add_u32 s32, s85, 4718592
    buffer_load_dwordx4 v8, s[16:19], s32 offen offset:0 lds
    buffer_load_dwordx4 v9, s[16:19], s32 offen offset:1024 lds
    buffer_load_dwordx4 v10, s[16:19], s32 offen offset:2048 lds
    buffer_load_dwordx4 v11, s[16:19], s32 offen offset:3072 lds
    s_add_u32 m0, s87, 20480
    s_nop 0
    buffer_load_dwordx4 v12, s[16:19], s32 offen offset:0 lds
    buffer_load_dwordx4 v13, s[16:19], s32 offen offset:1024 lds
    s_waitcnt vmcnt(20)
    s_barrier
    s_cmp_lt_u32 s29, 224
    s_cbranch_scc1 sk_38
    s_cmp_ge_u32 s28, 2
    s_cbranch_scc1 sk_38
    s_mov_b32 s78, s27
    s_branch pc_40
pl_39:
    s_mul_i32 s32, s89, 14336
    s_add_u32 s32, s32, s79
    s_add_u32 s32, s32, 0xc80000
    buffer_load_dwordx4 v[32:35], v253, s[20:23], s32 offen offset:0 sc1
    buffer_load_dwordx4 v[36:39], v253, s[20:23], s32 offen offset:1024 sc1
    buffer_load_dwordx4 v[40:43], v253, s[20:23], s32 offen offset:2048 sc1
    buffer_load_dwordx4 v[44:47], v253, s[20:23], s32 offen offset:3072 sc1
    s_add_u32 s32, s32, 4096
    buffer_load_dwordx4 v[48:51], v253, s[20:23], s32 offen offset:0 sc1
    buffer_load_dwordx4 v[52:55], v253, s[20:23], s32 offen offset:1024 sc1
    buffer_load_dwordx4 v[56:59], v253, s[20:23], s32 offen offset:2048 sc1
    buffer_load_dwordx4 v[60:63], v253, s[20:23], s32 offen offset:3072 sc1
    s_add_u32 s32, s32, 4096
    buffer_load_dwordx4 v[64:67], v253, s[20:23], s32 offen offset:0 sc1
    buffer_load_dwordx4 v[68:71], v253, s[20:23], s32 offen offset:1024 sc1
    buffer_load_dwordx4 v[72:75], v253, s[20:23], s32 offen offset:2048 sc1
    buffer_load_dwordx4 v[76:79], v253, s[20:23], s32 offen offset:3072 sc1
    s_add_u32 s32, s32, 4096
    buffer_load_dwordx4 v[80:83], v253, s[20:23], s32 offen offset:0 sc1
    buffer_load_dwordx4 v[84:87], v253, s[20:23], s32 offen offset:1024 sc1
    s_waitcnt vmcnt(0)
pc_40:
    v_max3_u32 v30, v32, v33, v34
    v_max3_u32 v30, v30, v35, v36
    v_max3_u32 v30, v30, v37, v38
    v_max3_u32 v30, v30, v39, v40
    v_max3_u32 v30, v30, v41, v42
    v_max3_u32 v30, v30, v43, v44
    v_max3_u32 v30, v30, v45, v46
    v_max3_u32 v30, v30, v47, v48
    v_max3_u32 v30, v30, v49, v50
    v_max3_u32 v30, v30, v51, v52
    v_max3_u32 v30, v30, v53, v54
    v_max3_u32 v30, v30, v55, v56
    v_max3_u32 v30, v30, v57, v58
    v_max3_u32 v30, v30, v59, v60
    v_max3_u32 v30, v30, v61, v62
    v_max3_u32 v30, v30, v63, v64
    v_max3_u32 v30, v30, v65, v66
    v_max3_u32 v30, v30, v67, v68
    v_max3_u32 v30, v30, v69, v70
    v_max3_u32 v30, v30, v71, v72
    v_max3_u32 v30, v30, v73, v74
    v_max3_u32 v30, v30, v75, v76
    v_max3_u32 v30, v30, v77, v78
    v_max3_u32 v30, v30, v79, v80
    v_max3_u32 v30, v30, v81, v82
    v_max3_u32 v30, v30, v83, v84
    v_max3_u32 v30, v30, v85, v86
    v_max_u32 v30, v30, v87
    v_cmp_eq_u32 vcc, -1, v30
    s_cbranch_vccz pd_41
    s_sub_u32 s78, s78, 1
    s_cmp_lg_u32 s78, 0
    s_cbranch_scc1 pl_39
    s_mov_b32 s27, 1
pd_41:
    v_add_f32 v32, v32, v36
    v_add_f32 v33, v33, v37
    v_add_f32 v34, v34, v38
    v_add_f32 v35, v35, v39
    v_add_f32 v32, v32, v40
    v_add_f32 v33, v33, v41
    v_add_f32 v34, v34, v42
    v_add_f32 v35, v35, v43
    v_add_f32 v32, v32, v44
    v_add_f32 v33, v33, v45
    v_add_f32 v34, v34, v46
    v_add_f32 v35, v35, v47
    v_add_f32 v32, v32, v48
    v_add_f32 v33, v33, v49
    v_add_f32 v34, v34, v50
    v_add_f32 v35, v35, v51
    v_add_f32 v32, v32, v52
    v_add_f32 v33, v33, v53
    v_add_f32 v34, v34, v54
    v_add_f32 v35, v35, v55
    v_add_f32 v32, v32, v56
    v_add_f32 v33, v33, v57
    v_add_f32 v34, v34, v58
    v_add_f32 v35, v35, v59
    v_add_f32 v32, v32, v60
    v_add_f32 v33, v33, v61
    v_add_f32 v34, v34, v62
    v_add_f32 v35, v35, v63
    v_add_f32 v32, v32, v64
    v_add_f32 v33, v33, v65
    v_add_f32 v34, v34, v66
    v_add_f32 v35, v35, v67
    v_add_f32 v32, v32, v68
    v_add_f32 v33, v33, v69
    v_add_f32 v34, v34, v70
    v_add_f32 v35, v35, v71
    v_add_f32 v32, v32, v72
    v_add_f32 v33, v33, v73
    v_add_f32 v34, v34, v74
    v_add_f32 v35, v35, v75
    v_add_f32 v32, v32, v76
    v_add_f32 v33, v33, v77
    v_add_f32 v34, v34, v78
    v_add_f32 v35, v35, v79
    v_add_f32 v32, v32, v80
    v_add_f32 v33, v33, v81
    v_add_f32 v34, v34, v82
    v_add_f32 v35, v35, v83
    v_add_f32 v32, v32, v84
    v_add_f32 v33, v33, v85
    v_add_f32 v34, v34, v86
    v_add_f32 v35, v35, v87
    v_add_f32_dpp v32, v32, v32 row_ror:4 row_mask:0xf bank_mask:0xf
    v_add_f32_dpp v33, v33, v33 row_ror:4 row_mask:0xf bank_mask:0xf
    v_add_f32_dpp v34, v34, v34 row_ror:4 row_mask:0xf bank_mask:0xf
    v_add_f32_dpp v35, v35, v35 row_ror:4 row_mask:0xf bank_mask:0xf
    v_add_f32_dpp v32, v32, v32 row_ror:8 row_mask:0xf bank_mask:0xf
    v_add_f32_dpp v33, v33, v33 row_ror:8 row_mask:0xf bank_mask:0xf
    v_add_f32_dpp v34, v34, v34 row_ror:8 row_mask:0xf bank_mask:0xf
    v_add_f32_dpp v35, v35, v35 row_ror:8 row_mask:0xf bank_mask:0xf
    v_mov_b32 v36, v32
    v_mov_b32 v37, v33
    v_mov_b32 v38, v34
    v_mov_b32 v39, v35
    v_permlane16_swap_b32 v32, v36
    v_permlane16_swap_b32 v33, v37
    v_permlane16_swap_b32 v34, v38
    v_permlane16_swap_b32 v35, v39
    v_add_f32 v32, v32, v36
    v_add_f32 v33, v33, v37
    v_add_f32 v34, v34, v38
    v_add_f32 v35, v35, v39
    v_mov_b32 v36, v32
    v_mov_b32 v37, v33
    v_mov_b32 v38, v34
    v_mov_b32 v39, v35
    v_permlane32_swap_b32 v32, v36
    v_permlane32_swap_b32 v33, v37
    v_permlane32_swap_b32 v34, v38
    v_permlane32_swap_b32 v35, v39
    v_add_f32 v32, v32, v36
    v_add_f32 v33, v33, v37
    v_add_f32 v34, v34, v38
    v_add_f32 v35, v35, v39
    v_fma_f32 v32, v32, v96, v92
    v_fma_f32 v33, v33, v96, v93
    v_fma_f32 v34, v34, v96, v94
    v_fma_f32 v35, v35, v96, v95
    s_lshl_b32 s32, s89, 6
    s_add_u32 s32, s32, 0xdc4000
    s_mov_b64 exec, 15
    buffer_store_dwordx4 v[32:35], v253, s[20:23], s32 offen sc1
    s_mov_b64 exec, -1
sk_38:
    s_add_u32 m0, s86, 40960
    s_add_u32 s32, s84, 212992
    buffer_load_dwordx4 v253, s[20:23], s32 offen offset:0 sc1 lds
    buffer_load_dwordx4 v253, s[20:23], s32 offen offset:1024 sc1 lds
    buffer_load_dwordx4 v253, s[20:23], s32 offen offset:2048 sc1 lds
    buffer_load_dwordx4 v253, s[20:23], s32 offen offset:3072 sc1 lds
    s_add_u32 m0, s87, 57344
    s_add_u32 s32, s85, 5111808
    buffer_load_dwordx4 v8, s[16:19], s32 offen offset:0 lds
    buffer_load_dwordx4 v9, s[16:19], s32 offen offset:1024 lds
    buffer_load_dwordx4 v10, s[16:19], s32 offen offset:2048 lds
    buffer_load_dwordx4 v11, s[16:19], s32 offen offset:3072 lds
    s_add_u32 m0, s87, 61440
    s_nop 0
    buffer_load_dwordx4 v12, s[16:19], s32 offen offset:0 lds
    buffer_load_dwordx4 v13, s[16:19], s32 offen offset:1024 lds
    s_waitcnt vmcnt(20)
    s_barrier
    v_lshrrev_b32 v20, 3, v252
    v_mul_u32_u24 v20, 49152, v20
    v_and_b32 v21, 7, v252
    v_lshl_add_u32 v20, v21, 4, v20
    s_cmp_eq_u32 s28, 3
    s_cselect_b32 s32, 0x10000000, 0
    v_add_u32 v20, s32, v20
    s_mul_i32 s32, s24, 393216
    s_lshl_b32 s33, s28, 11
    s_add_u32 s32, s32, s33
    s_lshl_b32 s33, s25, 7
    s_add_u32 s32, s32, s33
    buffer_load_dwordx4 v[100:103], v20, s[16:19], s32 offen
    s_add_u32 s32, s32, 6144
    buffer_load_dwordx4 v[104:107], v20, s[16:19], s32 offen
    s_add_u32 s32, s32, 6144
    buffer_load_dwordx4 v[108:111], v20, s[16:19], s32 offen
    s_add_u32 s32, s32, 6144
    buffer_load_dwordx4 v[112:115], v20, s[16:19], s32 offen
    s_add_u32 s32, s32, 6144
    buffer_load_dwordx4 v[116:119], v20, s[16:19], s32 offen
    s_add_u32 s32, s32, 6144
    buffer_load_dwordx4 v[120:123], v20, s[16:19], s32 offen
    s_add_u32 s32, s32, 6144
    buffer_load_dwordx4 v[124:127], v20, s[16:19], s32 offen
    s_add_u32 s32, s32, 6144
    buffer_load_dwordx4 v[128:131], v20, s[16:19], s32 offen
    s_add_u32 m0, s86, 81920
    s_add_u32 s32, s84, 229376
    buffer_load_dwordx4 v253, s[20:23], s32 offen offset:0 sc1 lds
    buffer_load_dwordx4 v253, s[20:23], s32 offen offset:1024 sc1 lds
    buffer_load_dwordx4 v253, s[20:23], s32 offen offset:2048 sc1 lds
    buffer_load_dwordx4 v253, s[20:23], s32 offen offset:3072 sc1 lds
    s_add_u32 m0, s87, 98304
    s_add_u32 s32, s85, 5505024
    buffer_load_dwordx4 v8, s[16:19], s32 offen offset:0 lds
    buffer_load_dwordx4 v9, s[16:19], s32 offen offset:1024 lds
    buffer_load_dwordx4 v10, s[16:19], s32 offen offset:2048 lds
    buffer_load_dwordx4 v11, s[16:19], s32 offen offset:3072 lds
    s_add_u32 m0, s87, 102400
    s_nop 0
    buffer_load_dwordx4 v12, s[16:19], s32 offen offset:0 lds
    buffer_load_dwordx4 v13, s[16:19], s32 offen offset:1024 lds
    s_waitcnt vmcnt(20)
    s_barrier
    v_lshrrev_b32 v19, 3, v252
    v_lshlrev_b32 v19, 5, v19
    s_lshl_b32 s32, s24, 8
    s_add_u32 s32, s32, 0xdc4000
    buffer_load_dwordx4 v[132:135], v19, s[20:23], s32 offen offset:0 sc1
    buffer_load_dwordx4 v[136:139], v19, s[20:23], s32 offen offset:16 sc1
    s_add_u32 m0, s86, 122880
    s_add_u32 s32, s84, 245760
    buffer_load_dwordx4 v253, s[20:23], s32 offen offset:0 sc1 lds
    buffer_load_dwordx4 v253, s[20:23], s32 offen offset:1024 sc1 lds
    buffer_load_dwordx4 v253, s[20:23], s32 offen offset:2048 sc1 lds
    buffer_load_dwordx4 v253, s[20:23], s32 offen offset:3072 sc1 lds
    s_add_u32 m0, s87, 139264
    s_add_u32 s32, s85, 5898240
    buffer_load_dwordx4 v8, s[16:19], s32 offen offset:0 lds
    buffer_load_dwordx4 v9, s[16:19], s32 offen offset:1024 lds
    buffer_load_dwordx4 v10, s[16:19], s32 offen offset:2048 lds
    buffer_load_dwordx4 v11, s[16:19], s32 offen offset:3072 lds
    s_add_u32 m0, s87, 143360
    s_nop 0
    buffer_load_dwordx4 v12, s[16:19], s32 offen offset:0 lds
    buffer_load_dwordx4 v13, s[16:19], s32 offen offset:1024 lds
    s_waitcnt vmcnt(20)
    s_barrier
    s_waitcnt vmcnt(10)
    s_barrier
    s_lshl_b32 s32, s28, 10
    s_lshl_b32 s33, s25, 7
    s_add_u32 m0, s32, 4096
    s_add_u32 s34, s33, 0
    buffer_load_dwordx4 v14, s[8:11], s34 offen lds
    s_add_u32 m0, s32, 8192
    s_add_u32 s34, s33, 131072
    buffer_load_dwordx4 v14, s[8:11], s34 offen lds
    s_add_u32 m0, s32, 12288
    s_add_u32 s34, s33, 262144
    buffer_load_dwordx4 v14, s[8:11], s34 offen lds
    s_add_u32 m0, s32, 16384
    s_add_u32 s34, s33, 393216
    buffer_load_dwordx4 v14, s[8:11], s34 offen lds
    s_add_u32 m0, s32, 20480
    s_add_u32 s34, s33, 524288
    buffer_load_dwordx4 v14, s[8:11], s34 offen lds
    s_add_u32 m0, s32, 24576
    s_add_u32 s34, s33, 655360
    buffer_load_dwordx4 v14, s[8:11], s34 offen lds
    s_add_u32 m0, s32, 28672
    s_add_u32 s34, s33, 786432
    buffer_load_dwordx4 v14, s[8:11], s34 offen lds
    s_add_u32 m0, s32, 32768
    s_add_u32 s34, s33, 917504
    buffer_load_dwordx4 v14, s[8:11], s34 offen lds
    s_add_u32 m0, s32, 36864
    s_add_u32 s34, s33, 1048576
    buffer_load_dwordx4 v14, s[8:11], s34 offen lds
    s_add_u32 m0, s32, 40960
    s_add_u32 s34, s33, 1179648
    buffer_load_dwordx4 v14, s[8:11], s34 offen lds
    s_add_u32 m0, s32, 45056
    s_add_u32 s34, s33, 1310720
    buffer_load_dwordx4 v14, s[8:11], s34 offen lds
    s_cmp_eq_u32 s28, 3
    s_cbranch_scc1 sk_42
    s_mov_b32 s78, s27
    s_branch pc_44
pl_43:
    s_lshl_b32 s32, s24, 8
    s_add_u32 s32, s32, 0xdc4000
    buffer_load_dwordx4 v[132:135], v19, s[20:23], s32 offen offset:0 sc1
    buffer_load_dwordx4 v[136:139], v19, s[20:23], s32 offen offset:16 sc1
    s_waitcnt vmcnt(0)
pc_44:
    v_max3_u32 v30, v132, v133, v134
    v_max3_u32 v30, v30, v135, v136
    v_max3_u32 v30, v30, v137, v138
    v_max_u32 v30, v30, v139
    v_cmp_eq_u32 vcc, -1, v30
    s_cbranch_vccz pd_45
    s_sub_u32 s78, s78, 1
    s_cmp_lg_u32 s78, 0
    s_cbranch_scc1 pl_43
    s_mov_b32 s27, 1
pd_45:
    v_lshlrev_b32 v20, 16, v100
    v_and_b32 v21, 0xffff0000, v100
    v_mul_f32 v140, v20, v132
    v_mul_f32 v141, v21, v132
    v_lshlrev_b32 v20, 16, v101
    v_and_b32 v21, 0xffff0000, v101
    v_mul_f32 v142, v20, v132
    v_mul_f32 v143, v21, v132
    v_lshlrev_b32 v20, 16, v102
    v_and_b32 v21, 0xffff0000, v102
    v_mul_f32 v144, v20, v132
    v_mul_f32 v145, v21, v132
    v_lshlrev_b32 v20, 16, v103
    v_and_b32 v21, 0xffff0000, v103
    v_mul_f32 v146, v20, v132
    v_mul_f32 v147, v21, v132
    v_lshlrev_b32 v20, 16, v104
    v_and_b32 v21, 0xffff0000, v104
    v_fmac_f32 v140, v20, v133
    v_fmac_f32 v141, v21, v133
    v_lshlrev_b32 v20, 16, v105
    v_and_b32 v21, 0xffff0000, v105
    v_fmac_f32 v142, v20, v133
    v_fmac_f32 v143, v21, v133
    v_lshlrev_b32 v20, 16, v106
    v_and_b32 v21, 0xffff0000, v106
    v_fmac_f32 v144, v20, v133
    v_fmac_f32 v145, v21, v133
    v_lshlrev_b32 v20, 16, v107
    v_and_b32 v21, 0xffff0000, v107
    v_fmac_f32 v146, v20, v133
    v_fmac_f32 v147, v21, v133
    v_lshlrev_b32 v20, 16, v108
    v_and_b32 v21, 0xffff0000, v108
    v_fmac_f32 v140, v20, v134
    v_fmac_f32 v141, v21, v134
    v_lshlrev_b32 v20, 16, v109
    v_and_b32 v21, 0xffff0000, v109
    v_fmac_f32 v142, v20, v134
    v_fmac_f32 v143, v21, v134
    v_lshlrev_b32 v20, 16, v110
    v_and_b32 v21, 0xffff0000, v110
    v_fmac_f32 v144, v20, v134
    v_fmac_f32 v145, v21, v134
    v_lshlrev_b32 v20, 16, v111
    v_and_b32 v21, 0xffff0000, v111
    v_fmac_f32 v146, v20, v134
    v_fmac_f32 v147, v21, v134
    v_lshlrev_b32 v20, 16, v112
    v_and_b32 v21, 0xffff0000, v112
    v_fmac_f32 v140, v20, v135
    v_fmac_f32 v141, v21, v135
    v_lshlrev_b32 v20, 16, v113
    v_and_b32 v21, 0xffff0000, v113
    v_fmac_f32 v142, v20, v135
    v_fmac_f32 v143, v21, v135
    v_lshlrev_b32 v20, 16, v114
    v_and_b32 v21, 0xffff0000, v114
    v_fmac_f32 v144, v20, v135
    v_fmac_f32 v145, v21, v135
    v_lshlrev_b32 v20, 16, v115
    v_and_b32 v21, 0xffff0000, v115
    v_fmac_f32 v146, v20, v135
    v_fmac_f32 v147, v21, v135
    v_lshlrev_b32 v20, 16, v116
    v_and_b32 v21, 0xffff0000, v116
    v_fmac_f32 v140, v20, v136
    v_fmac_f32 v141, v21, v136
    v_lshlrev_b32 v20, 16, v117
    v_and_b32 v21, 0xffff0000, v117
    v_fmac_f32 v142, v20, v136
    v_fmac_f32 v143, v21, v136
    v_lshlrev_b32 v20, 16, v118
    v_and_b32 v21, 0xffff0000, v118
    v_fmac_f32 v144, v20, v136
    v_fmac_f32 v145, v21, v136
    v_lshlrev_b32 v20, 16, v119
    v_and_b32 v21, 0xffff0000, v119
    v_fmac_f32 v146, v20, v136
    v_fmac_f32 v147, v21, v136
    v_lshlrev_b32 v20, 16, v120
    v_and_b32 v21, 0xffff0000, v120
    v_fmac_f32 v140, v20, v137
    v_fmac_f32 v141, v21, v137
    v_lshlrev_b32 v20, 16, v121
    v_and_b32 v21, 0xffff0000, v121
    v_fmac_f32 v142, v20, v137
    v_fmac_f32 v143, v21, v137
    v_lshlrev_b32 v20, 16, v122
    v_and_b32 v21, 0xffff0000, v122
    v_fmac_f32 v144, v20, v137
    v_fmac_f32 v145, v21, v137
    v_lshlrev_b32 v20, 16, v123
    v_and_b32 v21, 0xffff0000, v123
    v_fmac_f32 v146, v20, v137
    v_fmac_f32 v147, v21, v137
    v_lshlrev_b32 v20, 16, v124
    v_and_b32 v21, 0xffff0000, v124
    v_fmac_f32 v140, v20, v138
    v_fmac_f32 v141, v21, v138
    v_lshlrev_b32 v20, 16, v125
    v_and_b32 v21, 0xffff0000, v125
    v_fmac_f32 v142, v20, v138
    v_fmac_f32 v143, v21, v138
    v_lshlrev_b32 v20, 16, v126
    v_and_b32 v21, 0xffff0000, v126
    v_fmac_f32 v144, v20, v138
    v_fmac_f32 v145, v21, v138
    v_lshlrev_b32 v20, 16, v127
    v_and_b32 v21, 0xffff0000, v127
    v_fmac_f32 v146, v20, v138
    v_fmac_f32 v147, v21, v138
    v_lshlrev_b32 v20, 16, v128
    v_and_b32 v21, 0xffff0000, v128
    v_fmac_f32 v140, v20, v139
    v_fmac_f32 v141, v21, v139
    v_lshlrev_b32 v20, 16, v129
    v_and_b32 v21, 0xffff0000, v129
    v_fmac_f32 v142, v20, v139
    v_fmac_f32 v143, v21, v139
    v_lshlrev_b32 v20, 16, v130
    v_and_b32 v21, 0xffff0000, v130
    v_fmac_f32 v144, v20, v139
    v_fmac_f32 v145, v21, v139
    v_lshlrev_b32 v20, 16, v131
    v_and_b32 v21, 0xffff0000, v131
    v_fmac_f32 v146, v20, v139
    v_fmac_f32 v147, v21, v139
    v_and_b32 v20, 7, v252
    v_lshrrev_b32 v21, 3, v252
    v_lshl_add_u32 v20, v20, 3, v21
    v_lshlrev_b32 v20, 2, v20
    v_permlane32_swap_b32 v140, v144
    v_permlane32_swap_b32 v141, v145
    v_permlane32_swap_b32 v142, v146
    v_permlane32_swap_b32 v143, v147
    v_add_f32 v140, v140, v144
    v_add_f32 v141, v141, v145
    v_add_f32 v142, v142, v146
    v_add_f32 v143, v143, v147
    v_and_b32 v21, 1, v21
    v_cmp_eq_u32 vcc, 1, v21
    v_permlane16_swap_b32 v140, v142
    v_permlane16_swap_b32 v141, v143
    v_add_f32 v140, v140, v142
    v_add_f32 v141, v141, v143
    s_lshl_b32 s32, s72, 10
    s_lshl_b32 s33, s28, 8
    s_add_u32 s32, s32, s33
    s_add_u32 s32, s32, 0x1d80000
    v_add_f32_dpp v140, v140, v140 row_ror:8 row_mask:0xf bank_mask:0xf
    v_add_f32_dpp v141, v141, v141 row_ror:8 row_mask:0xf bank_mask:0xf
    v_cndmask_b32 v140, v140, v141, vcc
    buffer_store_dword v140, v20, s[20:23], s32 offen sc1
sk_42:
    s_waitcnt vmcnt(11)
    s_barrier
    v_mov_b32 v20, s73
    v_mov_b32 v21, 0
    ds_write_b32 v21, v20 offset:2048
    s_waitcnt lgkmcnt(0)
    s_barrier
    s_lshl_b32 s32, s28, 8
    v_lshl_add_u32 v19, v252, 2, s32
    ds_read_b32 v18, v19 offset:1024
    s_mov_b32 s38, 0
    s_mov_b32 s39, 0
    s_lshr_b32 s33, s73, 5
    s_lshl_b32 s34, s24, 2
    s_sub_u32 s33, s33, s34
    s_add_u32 s33, s33, 8
    s_cmp_ge_u32 s33, 12
    s_cbranch_scc1 l_nopatch
    s_cmp_eq_u32 s28, 3
    s_cbranch_scc1 l_nopatch
    s_cmp_eq_u32 s28, 0
    s_cselect_b32 s34, 8, 0
    s_cmp_lt_u32 s33, s34
    s_cbranch_scc1 l_nopatch
    s_mov_b32 s38, 1
    s_mov_b32 s78, s27
pl_46:
    s_lshl_b32 s32, s25, 10
    s_add_u32 s32, s32, 0x1d80000
    buffer_load_dword v32, v19, s[20:23], s32 offen sc1
    s_add_u32 s32, s32, 16384
    buffer_load_dword v33, v19, s[20:23], s32 offen sc1
    s_add_u32 s32, s32, 16384
    buffer_load_dword v34, v19, s[20:23], s32 offen sc1
    s_add_u32 s32, s32, 16384
    buffer_load_dword v35, v19, s[20:23], s32 offen sc1
    s_add_u32 s32, s32, 16384
    buffer_load_dword v36, v19, s[20:23], s32 offen sc1
    s_add_u32 s32, s32, 16384
    buffer_load_dword v37, v19, s[20:23], s32 offen sc1
    s_add_u32 s32, s32, 16384
    buffer_load_dword v38, v19, s[20:23], s32 offen sc1
    s_add_u32 s32, s32, 16384
    buffer_load_dword v39, v19, s[20:23], s32 offen sc1
    s_add_u32 s32, s32, 16384
    buffer_load_dword v40, v19, s[20:23], s32 offen sc1
    s_add_u32 s32, s32, 16384
    buffer_load_dword v41, v19, s[20:23], s32 offen sc1
    s_add_u32 s32, s32, 16384
    buffer_load_dword v42, v19, s[20:23], s32 offen sc1
    s_add_u32 s32, s32, 16384
    buffer_load_dword v43, v19, s[20:23], s32 offen sc1
    s_add_u32 s32, s32, 16384
    buffer_load_dword v44, v19, s[20:23], s32 offen sc1
    s_add_u32 s32, s32, 16384
    buffer_load_dword v45, v19, s[20:23], s32 offen sc1
    s_add_u32 s32, s32, 16384
    buffer_load_dword v46, v19, s[20:23], s32 offen sc1
    s_add_u32 s32, s32, 16384
    buffer_load_dword v47, v19, s[20:23], s32 offen sc1
    s_add_u32 s32, s32, 16384
    s_mov_b32 s32, 0xdc4000
    buffer_load_dwordx4 v[48:51], v253, s[20:23], s32 offen offset:0 sc1
    buffer_load_dwordx4 v[52:55], v253, s[20:23], s32 offen offset:1024 sc1
    buffer_load_dwordx4 v[56:59], v253, s[20:23], s32 offen offset:2048 sc1
    buffer_load_dwordx4 v[60:63], v253, s[20:23], s32 offen offset:3072 sc1
    s_waitcnt vmcnt(0)
pc_47:
    v_max3_u32 v30, v32, v33, v34
    v_max3_u32 v30, v30, v35, v36
    v_max3_u32 v30, v30, v37, v38
    v_max3_u32 v30, v30, v39, v40
    v_max3_u32 v30, v30, v41, v42
    v_max3_u32 v30, v30, v43, v44
    v_max3_u32 v30, v30, v45, v46
    v_max3_u32 v30, v30, v47, v48
    v_max3_u32 v30, v30, v49, v50
    v_max3_u32 v30, v30, v51, v52
    v_max3_u32 v30, v30, v53, v54
    v_max3_u32 v30, v30, v55, v56
    v_max3_u32 v30, v30, v57, v58
    v_max3_u32 v30, v30, v59, v60
    v_max3_u32 v30, v30, v61, v62
    v_max_u32 v30, v30, v63
    v_cmp_eq_u32 vcc, -1, v30
    s_cbranch_vccz pd_48
    s_sub_u32 s78, s78, 1
    s_cmp_lg_u32 s78, 0
    s_cbranch_scc1 pl_46
    s_mov_b32 s27, 1
pd_48:
    v_add_f32 v32, v32, v33
    v_add_f32 v32, v32, v34
    v_add_f32 v32, v32, v35
    v_add_f32 v32, v32, v36
    v_add_f32 v32, v32, v37
    v_add_f32 v32, v32, v38
    v_add_f32 v32, v32, v39
    v_add_f32 v32, v32, v40
    v_add_f32 v32, v32, v41
    v_add_f32 v32, v32, v42
    v_add_f32 v32, v32, v43
    v_add_f32 v32, v32, v44
    v_add_f32 v32, v32, v45
    v_add_f32 v32, v32, v46
    v_add_f32 v32, v32, v47
    v_mul_f32 v31, v48, v48
    v_fmac_f32 v31, v49, v49
    v_add_f32 v48, v48, v49
    v_fmac_f32 v31, v50, v50
    v_add_f32 v48, v48, v50
    v_fmac_f32 v31, v51, v51
    v_add_f32 v48, v48, v51
    v_fmac_f32 v31, v52, v52
    v_add_f32 v48, v48, v52
    v_fmac_f32 v31, v53, v53
    v_add_f32 v48, v48, v53
    v_fmac_f32 v31, v54, v54
    v_add_f32 v48, v48, v54
    v_fmac_f32 v31, v55, v55
    v_add_f32 v48, v48, v55
    v_fmac_f32 v31, v56, v56
    v_add_f32 v48, v48, v56
    v_fmac_f32 v31, v57, v57
    v_add_f32 v48, v48, v57
    v_fmac_f32 v31, v58, v58
    v_add_f32 v48, v48, v58
    v_fmac_f32 v31, v59, v59
    v_add_f32 v48, v48, v59
    v_fmac_f32 v31, v60, v60
    v_add_f32 v48, v48, v60
    v_fmac_f32 v31, v61, v61
    v_add_f32 v48, v48, v61
    v_fmac_f32 v31, v62, v62
    v_add_f32 v48, v48, v62
    v_fmac_f32 v31, v63, v63
    v_add_f32 v48, v48, v63
    s_nop 1
    v_add_f32_dpp v48, v48, v48 quad_perm:[1,0,3,2] row_mask:0xf bank_mask:0xf
    s_nop 1
    v_add_f32_dpp v48, v48, v48 quad_perm:[2,3,0,1] row_mask:0xf bank_mask:0xf
    s_nop 1
    v_add_f32_dpp v48, v48, v48 row_half_mirror row_mask:0xf bank_mask:0xf
    s_nop 1
    v_add_f32_dpp v48, v48, v48 row_mirror row_mask:0xf bank_mask:0xf
    v_mov_b32 v30, v48
    s_nop 1
    v_permlane16_swap_b32 v48, v30
    v_add_f32 v48, v48, v30
    v_mov_b32 v30, v48
    s_nop 1
    v_permlane32_swap_b32 v48, v30
    v_add_f32 v48, v48, v30
    v_add_f32_dpp v31, v31, v31 quad_perm:[1,0,3,2] row_mask:0xf bank_mask:0xf
    s_nop 1
    v_add_f32_dpp v31, v31, v31 quad_perm:[2,3,0,1] row_mask:0xf bank_mask:0xf
    s_nop 1
    v_add_f32_dpp v31, v31, v31 row_half_mirror row_mask:0xf bank_mask:0xf
    s_nop 1
    v_add_f32_dpp v31, v31, v31 row_mirror row_mask:0xf bank_mask:0xf
    v_mov_b32 v30, v31
    s_nop 1
    v_permlane16_swap_b32 v31, v30
    v_add_f32 v31, v31, v30
    v_mov_b32 v30, v31
    s_nop 1
    v_permlane32_swap_b32 v31, v30
    v_add_f32 v31, v31, v30
    v_mul_f32 v48, 0x3a800000, v48
    v_mul_f32 v31, 0x3a800000, v31
    v_fma_f32 v31, -v48, v48, v31
    v_max_f32 v31, 0, v31
    v_add_f32 v31, 0x3727c5ac, v31
    v_rsq_f32 v31, v31
    s_waitcnt lgkmcnt(0)
    v_fma_f32 v32, -v48, v18, v32
    s_cmp_eq_u32 s28, 0
    s_cselect_b32 s34, 0x3e8293ee, 1.0
    v_mul_f32 v32, v32, v31
    v_mul_f32 v32, s34, v32
    v_cvt_pk_bf16_f32 v1, v32, v32
    s_and_b32 s34, s73, 31
    v_mov_b32 v20, s34
    v_and_b32 v21, 31, v252
    s_cmp_eq_u32 s28, 2
    s_cselect_b64 vcc, -1, 0
    v_cndmask_b32 v22, v20, v21, vcc
    v_cndmask_b32 v23, v21, v20, vcc
    v_lshlrev_b32 v0, 4, v22
    v_lshrrev_b32 v20, 4, v23
    v_lshl_add_u32 v0, v20, 10, v0
    v_bfe_u32 v20, v23, 2, 1
    v_lshl_add_u32 v0, v20, 9, v0
    v_and_b32 v20, 3, v23
    v_lshl_add_u32 v0, v20, 1, v0
    v_and_b32 v20, 8, v23
    v_add_u32 v0, v20, v0
    s_lshl_b32 s34, s33, 11
    s_add_u32 s34, s34, 131072
    s_lshl_b32 s35, s33, 12
    s_lshl_b32 s32, s28, 11
    s_add_u32 s35, s35, s32
    s_add_u32 s35, s35, 47104
    s_cmp_eq_u32 s28, 0
    s_cselect_b32 s34, s34, s35
    s_movk_i32 s35, 8192
    s_cselect_b32 s35, s35, 49152
    v_lshrrev_b32 v20, 5, v252
    v_mul_u32_u24 v20, s35, v20
    v_add3_u32 v0, v0, v20, s34
l_nopatch:
    s_lshr_b32 s33, s28, 1
    s_add_u32 s33, s33, s24
    s_sub_u32 s33, s33, 2
    s_and_b32 s34, s28, 1
    s_mov_b64 s[80:81], s[16:17]
    s_mov_b32 s82, 0x600000
    s_mov_b32 s83, 0x20000
    s_mov_b32 s35, 0
    s_cmp_lt_i32 s33, 0
    s_cbranch_scc1 halo_49
    s_mov_b64 s[80:81], s[20:21]
    s_mov_b32 s82, 0x8000000
    s_mov_b32 s83, 0x20000
    s_lshl_b32 s35, s25, 7
    s_lshl_b32 s30, s33, 2
    s_add_u32 s35, s35, s30
    s_lshl_b32 s30, s34, 1
    s_add_u32 s35, s35, s30
    s_lshl_b32 s35, s35, 12
    s_add_u32 s35, s35, s26
    s_lshl_b32 s30, s25, 8
    s_lshl_b32 s31, s33, 4
    s_add_u32 s30, s30, s31
    s_lshl_b32 s31, s34, 3
    s_add_u32 s30, s30, s31
    s_add_u32 s30, s30, s26
    s_add_u32 s30, s30, 0xdc1000
    v_mov_b32 v20, 0
    s_mov_b32 s78, s27
pl_50:
    buffer_load_dwordx2 v[22:23], v20, s[20:23], s30 offen sc1
    s_waitcnt vmcnt(0)
pc_51:
    v_max_u32 v21, v22, v23
    v_cmp_eq_u32 vcc, -1, v21
    s_cbranch_vccz pd_52
    s_sub_u32 s78, s78, 1
    s_cmp_lg_u32 s78, 0
    s_cbranch_scc1 pl_50
    s_mov_b32 s27, 1
pd_52:
halo_49:
    s_lshl_b32 s30, s28, 13
    s_add_u32 m0, s30, 49152
    s_add_u32 s31, s35, 0
    buffer_load_dwordx4 v253, s[80:83], s31 offen offset:0 sc1 lds
    buffer_load_dwordx4 v253, s[80:83], s31 offen offset:1024 sc1 lds
    buffer_load_dwordx4 v253, s[80:83], s31 offen offset:2048 sc1 lds
    buffer_load_dwordx4 v253, s[80:83], s31 offen offset:3072 sc1 lds
    s_add_u32 m0, s30, 53248
    s_add_u32 s31, s35, 4096
    buffer_load_dwordx4 v253, s[80:83], s31 offen offset:0 sc1 lds
    buffer_load_dwordx4 v253, s[80:83], s31 offen offset:1024 sc1 lds
    buffer_load_dwordx4 v253, s[80:83], s31 offen offset:2048 sc1 lds
    buffer_load_dwordx4 v253, s[80:83], s31 offen offset:3072 sc1 lds
    s_add_u32 m0, s30, 98304
    s_add_u32 s31, s35, 262144
    buffer_load_dwordx4 v253, s[80:83], s31 offen offset:0 sc1 lds
    buffer_load_dwordx4 v253, s[80:83], s31 offen offset:1024 sc1 lds
    buffer_load_dwordx4 v253, s[80:83], s31 offen offset:2048 sc1 lds
    buffer_load_dwordx4 v253, s[80:83], s31 offen offset:3072 sc1 lds
    s_add_u32 m0, s30, 102400
    s_add_u32 s31, s35, 266240
    buffer_load_dwordx4 v253, s[80:83], s31 offen offset:0 sc1 lds
    buffer_load_dwordx4 v253, s[80:83], s31 offen offset:1024 sc1 lds
    buffer_load_dwordx4 v253, s[80:83], s31 offen offset:2048 sc1 lds
    buffer_load_dwordx4 v253, s[80:83], s31 offen offset:3072 sc1 lds
    s_branch att
l_tail:
    s_mov_b32 s79, s26
    s_load_dwordx2 s[12:13], s[0:1], 64
    s_mov_b32 s14, 0x400000
    s_mov_b32 s15, 0x20000
    s_waitcnt lgkmcnt(0)
    s_barrier
    s_mov_b32 s78, s27
pl_53:
    s_add_u32 s32, s79, 0xdc0000
    buffer_load_dwordx4 v[16:19], v253, s[20:23], s32 offen sc1
    s_waitcnt vmcnt(0)
pc_54:
    v_max3_u32 v20, v16, v17, v18
    v_max_u32 v20, v20, v19
    v_cmp_eq_u32 vcc, -1, v20
    s_cbranch_vccz pd_55
    s_sub_u32 s78, s78, 1
    s_cmp_lg_u32 s78, 0
    s_cbranch_scc1 pl_53
    s_mov_b32 s27, 1
pd_55:
    v_mov_b32 v20, v16
    s_nop 1
    v_max_f32_dpp v20, v20, v20 quad_perm:[1,0,3,2] row_mask:0xf bank_mask:0xf
    s_nop 1
    v_max_f32_dpp v20, v20, v20 quad_perm:[2,3,0,1] row_mask:0xf bank_mask:0xf
    s_nop 1
    v_max_f32_dpp v20, v20, v20 row_half_mirror row_mask:0xf bank_mask:0xf
    s_nop 1
    v_max_f32_dpp v20, v20, v20 row_mirror row_mask:0xf bank_mask:0xf
    v_mov_b32 v21, v20
    s_nop 1
    v_permlane16_swap_b32 v20, v21
    v_max_f32 v20, v20, v21
    v_mov_b32 v21, v20
    s_nop 1
    v_permlane32_swap_b32 v20, v21
    v_max_f32 v20, v20, v21
    v_cmp_eq_f32 vcc, v20, v16
    s_ff1_i32_b64 s32, vcc
    s_and_b32 s32, s32, 63
    v_readlane_b32 s74, v16, s32
    v_readlane_b32 s73, v17, s32
    v_readlane_b32 s75, v18, s32
    v_readlane_b32 s76, v19, s32
    s_and_b32 s73, s73, 2047
    s_lshr_b32 s33, s73, 5
    s_lshl_b32 s33, s33, 11
    s_add_u32 s33, s33, s79
    s_add_u32 s33, s33, 0xd60000
    s_lshl_b32 s32, s28, 9
    s_sub_u32 s34, s29, 224
    s_lshl_b32 s34, s34, 1
    s_and_b32 s35, s28, 1
    s_add_u32 s34, s34, s35
    s_lshl_b32 s34, s34, 5
    v_lshrrev_b32 v22, 1, v252
    v_and_b32 v23, 1, v252
    s_cmp_lt_u32 s29, 224
    s_cselect_b32 s32, s32, s34
    s_cselect_b64 vcc, -1, 0
    s_add_u32 s88, s33, s32
    v_cndmask_b32 v22, v23, v22, vcc
    v_lshlrev_b32 v22, 4, v22
    s_mov_b32 s78, s27
pl_56:
    buffer_load_dwordx4 v[24:27], v22, s[20:23], s88 offen sc1
    s_waitcnt vmcnt(0)
pc_57:
    v_max3_u32 v30, v24, v25, v26
    v_max_u32 v30, v30, v27
    v_cmp_eq_u32 vcc, -1, v30
    s_cbranch_vccz pd_58
    s_sub_u32 s78, s78, 1
    s_cmp_lg_u32 s78, 0
    s_cbranch_scc1 pl_56
    s_mov_b32 s27, 1
pd_58:
    s_cmp_ge_u32 s29, 224
    s_cbranch_scc1 l_tred
    v_mov_b32 v28, s76
    v_mul_f32 v29, s75, v28
    v_lshlrev_b32 v30, 16, v24
    v_and_b32 v31, 0xffff0000, v24
    v_fma_f32 v30, v30, v28, -v29
    v_fma_f32 v31, v31, v28, -v29
    v_cvt_pk_bf16_f32 v24, v30, v31
    v_lshlrev_b32 v30, 16, v25
    v_and_b32 v31, 0xffff0000, v25
    v_fma_f32 v30, v30, v28, -v29
    v_fma_f32 v31, v31, v28, -v29
    v_cvt_pk_bf16_f32 v25, v30, v31
    v_lshlrev_b32 v30, 16, v26
    v_and_b32 v31, 0xffff0000, v26
    v_fma_f32 v30, v30, v28, -v29
    v_fma_f32 v31, v31, v28, -v29
    v_cvt_pk_bf16_f32 v26, v30, v31
    v_lshlrev_b32 v30, 16, v27
    v_and_b32 v31, 0xffff0000, v27
    v_fma_f32 v30, v30, v28, -v29
    v_fma_f32 v31, v31, v28, -v29
    v_cvt_pk_bf16_f32 v27, v30, v31
    v_dot2_f32_bf16 v32, v155, v24, 0
    v_dot2_f32_bf16 v33, v160, v24, 0
    v_dot2_f32_bf16 v34, v156, v24, 0
    v_dot2_f32_bf16 v35, v161, v24, 0
    v_dot2_f32_bf16 v36, v157, v24, 0
    v_dot2_f32_bf16 v37, v162, v24, 0
    v_dot2_f32_bf16 v38, v158, v24, 0
    v_dot2_f32_bf16 v39, v163, v24, 0
    v_dot2_f32_bf16 v40, v183, v24, 0
    v_dot2_f32_bf16 v41, v192, v24, 0
    v_dot2_f32_bf16 v42, v188, v24, 0
    v_dot2_f32_bf16 v43, v193, v24, 0
    v_dot2_f32_bf16 v44, v189, v24, 0
    v_dot2_f32_bf16 v45, v194, v24, 0
    v_dot2_f32_bf16 v46, v190, v24, 0
    v_dot2_f32_bf16 v47, v195, v24, 0
    v_dot2_f32_bf16 v32, v159, v25, v32
    v_dot2_f32_bf16 v33, v168, v25, v33
    v_dot2_f32_bf16 v34, v164, v25, v34
    v_dot2_f32_bf16 v35, v169, v25, v35
    v_dot2_f32_bf16 v36, v165, v25, v36
    v_dot2_f32_bf16 v37, v170, v25, v37
    v_dot2_f32_bf16 v38, v166, v25, v38
    v_dot2_f32_bf16 v39, v171, v25, v39
    v_dot2_f32_bf16 v40, v191, v25, v40
    v_dot2_f32_bf16 v41, v200, v25, v41
    v_dot2_f32_bf16 v42, v196, v25, v42
    v_dot2_f32_bf16 v43, v201, v25, v43
    v_dot2_f32_bf16 v44, v197, v25, v44
    v_dot2_f32_bf16 v45, v202, v25, v45
    v_dot2_f32_bf16 v46, v198, v25, v46
    v_dot2_f32_bf16 v47, v203, v25, v47
    v_dot2_f32_bf16 v32, v167, v26, v32
    v_dot2_f32_bf16 v33, v176, v26, v33
    v_dot2_f32_bf16 v34, v172, v26, v34
    v_dot2_f32_bf16 v35, v177, v26, v35
    v_dot2_f32_bf16 v36, v173, v26, v36
    v_dot2_f32_bf16 v37, v178, v26, v37
    v_dot2_f32_bf16 v38, v174, v26, v38
    v_dot2_f32_bf16 v39, v179, v26, v39
    v_dot2_f32_bf16 v40, v199, v26, v40
    v_dot2_f32_bf16 v41, v208, v26, v41
    v_dot2_f32_bf16 v42, v204, v26, v42
    v_dot2_f32_bf16 v43, v209, v26, v43
    v_dot2_f32_bf16 v44, v205, v26, v44
    v_dot2_f32_bf16 v45, v210, v26, v45
    v_dot2_f32_bf16 v46, v206, v26, v46
    v_dot2_f32_bf16 v47, v211, v26, v47
    v_dot2_f32_bf16 v32, v175, v27, v32
    v_dot2_f32_bf16 v33, v184, v27, v33
    v_dot2_f32_bf16 v34, v180, v27, v34
    v_dot2_f32_bf16 v35, v185, v27, v35
    v_dot2_f32_bf16 v36, v181, v27, v36
    v_dot2_f32_bf16 v37, v186, v27, v37
    v_dot2_f32_bf16 v38, v182, v27, v38
    v_dot2_f32_bf16 v39, v187, v27, v39
    v_dot2_f32_bf16 v40, v207, v27, v40
    v_dot2_f32_bf16 v41, v216, v27, v41
    v_dot2_f32_bf16 v42, v212, v27, v42
    v_dot2_f32_bf16 v43, v217, v27, v43
    v_dot2_f32_bf16 v44, v213, v27, v44
    v_dot2_f32_bf16 v45, v218, v27, v45
    v_dot2_f32_bf16 v46, v214, v27, v46
    v_dot2_f32_bf16 v47, v219, v27, v47
    v_bfe_u32 v30, v252, 2, 2
    v_mul_u32_u24 v30, 4096, v30
    v_lshrrev_b32 v31, 5, v252
    v_lshl_add_u32 v30, v31, 6, v30
    v_permlane32_swap_b32 v32, v40
    v_permlane32_swap_b32 v33, v41
    v_permlane32_swap_b32 v34, v42
    v_permlane32_swap_b32 v35, v43
    v_permlane32_swap_b32 v36, v44
    v_permlane32_swap_b32 v37, v45
    v_permlane32_swap_b32 v38, v46
    v_permlane32_swap_b32 v39, v47
    v_add_f32 v32, v32, v40
    v_add_f32 v33, v33, v41
    v_add_f32 v34, v34, v42
    v_add_f32 v35, v35, v43
    v_add_f32 v36, v36, v44
    v_add_f32 v37, v37, v45
    v_add_f32 v38, v38, v46
    v_add_f32 v39, v39, v47
    v_and_b32 v31, 1, v252
    v_lshl_add_u32 v30, v31, 5, v30
    v_permlane16_swap_b32 v32, v36
    v_permlane16_swap_b32 v33, v37
    v_permlane16_swap_b32 v34, v38
    v_permlane16_swap_b32 v35, v39
    v_add_f32 v32, v32, v36
    v_add_f32 v33, v33, v37
    v_add_f32 v34, v34, v38
    v_add_f32 v35, v35, v39
    v_and_b32 v31, 16, v252
    v_add_u32 v30, v31, v30
    s_lshl_b32 s32, s28, 7
    v_add_u32 v30, s32, v30
    v_add_f32_dpp v32, v32, v32 quad_perm:[2,3,0,1] row_mask:0xf bank_mask:0xf
    v_add_f32_dpp v33, v33, v33 quad_perm:[2,3,0,1] row_mask:0xf bank_mask:0xf
    v_add_f32_dpp v34, v34, v34 quad_perm:[2,3,0,1] row_mask:0xf bank_mask:0xf
    v_add_f32_dpp v35, v35, v35 quad_perm:[2,3,0,1] row_mask:0xf bank_mask:0xf
    v_add_f32_dpp v32, v32, v32 row_ror:4 row_mask:0xf bank_mask:0xf
    v_add_f32_dpp v33, v33, v33 row_ror:4 row_mask:0xf bank_mask:0xf
    v_add_f32_dpp v34, v34, v34 row_ror:4 row_mask:0xf bank_mask:0xf
    v_add_f32_dpp v35, v35, v35 row_ror:4 row_mask:0xf bank_mask:0xf
    v_add_f32_dpp v32, v32, v32 row_ror:8 row_mask:0xf bank_mask:0xf
    v_add_f32_dpp v33, v33, v33 row_ror:8 row_mask:0xf bank_mask:0xf
    v_add_f32_dpp v34, v34, v34 row_ror:8 row_mask:0xf bank_mask:0xf
    v_add_f32_dpp v35, v35, v35 row_ror:8 row_mask:0xf bank_mask:0xf
    ds_write_b128 v30, v[32:35] offset:0
    s_waitcnt lgkmcnt(0)
    s_barrier
    v_and_b32 v30, 1, v252
    v_bfe_u32 v31, v252, 1, 3
    v_lshl_add_u32 v30, v30, 3, v31
    s_mul_i32 s32, s28, 4096
    v_lshl_add_u32 v30, v30, 2, s32
    ds_read_b32 v32, v30 offset:0
    ds_read_b32 v33, v30 offset:64
    ds_read_b32 v34, v30 offset:128
    ds_read_b32 v35, v30 offset:192
    ds_read_b32 v36, v30 offset:256
    ds_read_b32 v37, v30 offset:320
    ds_read_b32 v38, v30 offset:384
    ds_read_b32 v39, v30 offset:448
    s_waitcnt lgkmcnt(0)
    v_add_f32 v32, v32, v34
    v_add_f32 v36, v36, v38
    v_add_f32 v33, v33, v35
    v_add_f32 v37, v37, v39
    v_add_f32 v32, v32, v36
    v_add_f32 v33, v33, v37
    v_mul_f32 v34, 0xbfb8aa3b, v32
    v_exp_f32 v34, v34
    v_mul_f32 v32, v32, v33
    v_add_f32 v34, 1.0, v34
    v_rcp_f32 v34, v34
    v_lshrrev_b32 v30, 2, v252
    v_mul_f32 v32, v32, v34
    s_nop 1
    v_mov_b32_dpp v33, v32 quad_perm:[2,3,2,3] row_mask:0xf bank_mask:0xf
    v_cvt_pk_bf16_f32 v32, v32, v33
    ds_swizzle_b32 v36, v32 offset:0x1
    ds_swizzle_b32 v37, v32 offset:0x81
    ds_swizzle_b32 v38, v32 offset:0x101
    ds_swizzle_b32 v39, v32 offset:0x181
    v_mul_u32_u24 v30, 14336, v30
    v_and_b32 v31, 3, v252
    v_lshl_add_u32 v30, v31, 4, v30
    v_and_b32 v31, 1, v252
    v_cmp_eq_u32 vcc, 1, v31
    s_mul_i32 s32, s28, 229376
    s_lshl_b32 s33, s29, 6
    s_add_u32 s32, s32, s33
    s_add_u32 s32, s32, s79
    s_add_u32 s32, s32, 0xc80000
    s_waitcnt lgkmcnt(0)
    v_dot2_f32_bf16 v40, v215, v36, 0
    v_dot2_f32_bf16 v41, v224, v36, 0
    v_dot2_f32_bf16 v42, v220, v36, 0
    v_dot2_f32_bf16 v43, v225, v36, 0
    v_dot2_f32_bf16 v44, v221, v36, 0
    v_dot2_f32_bf16 v45, v226, v36, 0
    v_dot2_f32_bf16 v46, v222, v36, 0
    v_dot2_f32_bf16 v47, v227, v36, 0
    v_dot2_f32_bf16 v40, v223, v37, v40
    v_dot2_f32_bf16 v41, v232, v37, v41
    v_dot2_f32_bf16 v42, v228, v37, v42
    v_dot2_f32_bf16 v43, v233, v37, v43
    v_dot2_f32_bf16 v44, v229, v37, v44
    v_dot2_f32_bf16 v45, v234, v37, v45
    v_dot2_f32_bf16 v46, v230, v37, v46
    v_dot2_f32_bf16 v47, v235, v37, v47
    v_dot2_f32_bf16 v40, v231, v38, v40
    v_dot2_f32_bf16 v41, v240, v38, v41
    v_dot2_f32_bf16 v42, v236, v38, v42
    v_dot2_f32_bf16 v43, v241, v38, v43
    v_dot2_f32_bf16 v44, v237, v38, v44
    v_dot2_f32_bf16 v45, v242, v38, v45
    v_dot2_f32_bf16 v46, v238, v38, v46
    v_dot2_f32_bf16 v47, v243, v38, v47
    v_dot2_f32_bf16 v40, v239, v39, v40
    v_dot2_f32_bf16 v41, v248, v39, v41
    v_dot2_f32_bf16 v42, v244, v39, v42
    v_dot2_f32_bf16 v43, v249, v39, v43
    v_dot2_f32_bf16 v44, v245, v39, v44
    v_dot2_f32_bf16 v45, v250, v39, v45
    v_dot2_f32_bf16 v46, v246, v39, v46
    v_dot2_f32_bf16 v47, v251, v39, v47
    v_add_f32_dpp v40, v40, v40 quad_perm:[1,0,3,2] row_mask:0xf bank_mask:0xf
    v_add_f32_dpp v41, v41, v41 quad_perm:[1,0,3,2] row_mask:0xf bank_mask:0xf
    v_add_f32_dpp v42, v42, v42 quad_perm:[1,0,3,2] row_mask:0xf bank_mask:0xf
    v_add_f32_dpp v43, v43, v43 quad_perm:[1,0,3,2] row_mask:0xf bank_mask:0xf
    v_add_f32_dpp v44, v44, v44 quad_perm:[1,0,3,2] row_mask:0xf bank_mask:0xf
    v_add_f32_dpp v45, v45, v45 quad_perm:[1,0,3,2] row_mask:0xf bank_mask:0xf
    v_add_f32_dpp v46, v46, v46 quad_perm:[1,0,3,2] row_mask:0xf bank_mask:0xf
    v_add_f32_dpp v47, v47, v47 quad_perm:[1,0,3,2] row_mask:0xf bank_mask:0xf
    v_cndmask_b32 v40, v40, v44, vcc
    v_cndmask_b32 v41, v41, v45, vcc
    v_cndmask_b32 v42, v42, v46, vcc
    v_cndmask_b32 v43, v43, v47, vcc
    buffer_store_dwordx4 v[40:43], v30, s[20:23], s32 offen sc1
    s_branch k_end
l_tred:
    s_barrier
    s_cmp_ge_u32 s28, 2
    s_cbranch_scc1 k_end
    v_and_b32 v30, 2, v252
    v_cmp_eq_u32 vcc, 2, v30
    v_mov_b32 v28, s76
    v_mul_f32 v29, s75, v28
    v_add_f32 v28, 1.0, v28
    v_cndmask_b32 v30, v24, v26, vcc
    v_cndmask_b32 v31, v25, v27, vcc
    v_lshlrev_b32 v92, 16, v30
    v_and_b32 v93, 0xffff0000, v30
    v_lshlrev_b32 v94, 16, v31
    v_and_b32 v95, 0xffff0000, v31
    v_fma_f32 v92, v92, v28, -v29
    v_fma_f32 v93, v93, v28, -v29
    v_fma_f32 v94, v94, v28, -v29
    v_fma_f32 v95, v95, v28, -v29
    v_mov_b32 v96, 0xbfb8aa3b
    v_mul_f32 v96, s74, v96
    v_exp_f32 v96, v96
    s_nop 0
    v_add_f32 v96, 1.0, v96
    v_rcp_f32 v96, v96
    s_mov_b32 s78, s27
pl_59:
    s_mul_i32 s32, s89, 14336
    s_add_u32 s32, s32, s79
    s_add_u32 s32, s32, 0xc80000
    buffer_load_dwordx4 v[32:35], v253, s[20:23], s32 offen offset:0 sc1
    buffer_load_dwordx4 v[36:39], v253, s[20:23], s32 offen offset:1024 sc1
    buffer_load_dwordx4 v[40:43], v253, s[20:23], s32 offen offset:2048 sc1
    buffer_load_dwordx4 v[44:47], v253, s[20:23], s32 offen offset:3072 sc1
    s_add_u32 s32, s32, 4096
    buffer_load_dwordx4 v[48:51], v253, s[20:23], s32 offen offset:0 sc1
    buffer_load_dwordx4 v[52:55], v253, s[20:23], s32 offen offset:1024 sc1
    buffer_load_dwordx4 v[56:59], v253, s[20:23], s32 offen offset:2048 sc1
    buffer_load_dwordx4 v[60:63], v253, s[20:23], s32 offen offset:3072 sc1
    s_add_u32 s32, s32, 4096
    buffer_load_dwordx4 v[64:67], v253, s[20:23], s32 offen offset:0 sc1
    buffer_load_dwordx4 v[68:71], v253, s[20:23], s32 offen offset:1024 sc1
    buffer_load_dwordx4 v[72:75], v253, s[20:23], s32 offen offset:2048 sc1
    buffer_load_dwordx4 v[76:79], v253, s[20:23], s32 offen offset:3072 sc1
    s_add_u32 s32, s32, 4096
    buffer_load_dwordx4 v[80:83], v253, s[20:23], s32 offen offset:0 sc1
    buffer_load_dwordx4 v[84:87], v253, s[20:23], s32 offen offset:1024 sc1
    s_waitcnt vmcnt(0)
pc_60:
    v_max3_u32 v30, v32, v33, v34
    v_max3_u32 v30, v30, v35, v36
    v_max3_u32 v30, v30, v37, v38
    v_max3_u32 v30, v30, v39, v40
    v_max3_u32 v30, v30, v41, v42
    v_max3_u32 v30, v30, v43, v44
    v_max3_u32 v30, v30, v45, v46
    v_max3_u32 v30, v30, v47, v48
    v_max3_u32 v30, v30, v49, v50
    v_max3_u32 v30, v30, v51, v52
    v_max3_u32 v30, v30, v53, v54
    v_max3_u32 v30, v30, v55, v56
    v_max3_u32 v30, v30, v57, v58
    v_max3_u32 v30, v30, v59, v60
    v_max3_u32 v30, v30, v61, v62
    v_max3_u32 v30, v30, v63, v64
    v_max3_u32 v30, v30, v65, v66
    v_max3_u32 v30, v30, v67, v68
    v_max3_u32 v30, v30, v69, v70
    v_max3_u32 v30, v30, v71, v72
    v_max3_u32 v30, v30, v73, v74
    v_max3_u32 v30, v30, v75, v76
    v_max3_u32 v30, v30, v77, v78
    v_max3_u32 v30, v30, v79, v80
    v_max3_u32 v30, v30, v81, v82
    v_max3_u32 v30, v30, v83, v84
    v_max3_u32 v30, v30, v85, v86
    v_max_u32 v30, v30, v87
    v_cmp_eq_u32 vcc, -1, v30
    s_cbranch_vccz pd_61
    s_sub_u32 s78, s78, 1
    s_cmp_lg_u32 s78, 0
    s_cbranch_scc1 pl_59
    s_mov_b32 s27, 1
pd_61:
    v_add_f32 v32, v32, v36
    v_add_f32 v33, v33, v37
    v_add_f32 v34, v34, v38
    v_add_f32 v35, v35, v39
    v_add_f32 v32, v32, v40
    v_add_f32 v33, v33, v41
    v_add_f32 v34, v34, v42
    v_add_f32 v35, v35, v43
    v_add_f32 v32, v32, v44
    v_add_f32 v33, v33, v45
    v_add_f32 v34, v34, v46
    v_add_f32 v35, v35, v47
    v_add_f32 v32, v32, v48
    v_add_f32 v33, v33, v49
    v_add_f32 v34, v34, v50
    v_add_f32 v35, v35, v51
    v_add_f32 v32, v32, v52
    v_add_f32 v33, v33, v53
    v_add_f32 v34, v34, v54
    v_add_f32 v35, v35, v55
    v_add_f32 v32, v32, v56
    v_add_f32 v33, v33, v57
    v_add_f32 v34, v34, v58
    v_add_f32 v35, v35, v59
    v_add_f32 v32, v32, v60
    v_add_f32 v33, v33, v61
    v_add_f32 v34, v34, v62
    v_add_f32 v35, v35, v63
    v_add_f32 v32, v32, v64
    v_add_f32 v33, v33, v65
    v_add_f32 v34, v34, v66
    v_add_f32 v35, v35, v67
    v_add_f32 v32, v32, v68
    v_add_f32 v33, v33, v69
    v_add_f32 v34, v34, v70
    v_add_f32 v35, v35, v71
    v_add_f32 v32, v32, v72
    v_add_f32 v33, v33, v73
    v_add_f32 v34, v34, v74
    v_add_f32 v35, v35, v75
    v_add_f32 v32, v32, v76
    v_add_f32 v33, v33, v77
    v_add_f32 v34, v34, v78
    v_add_f32 v35, v35, v79
    v_add_f32 v32, v32, v80
    v_add_f32 v33, v33, v81
    v_add_f32 v34, v34, v82
    v_add_f32 v35, v35, v83
    v_add_f32 v32, v32, v84
    v_add_f32 v33, v33, v85
    v_add_f32 v34, v34, v86
    v_add_f32 v35, v35, v87
    v_add_f32_dpp v32, v32, v32 row_ror:4 row_mask:0xf bank_mask:0xf
    v_add_f32_dpp v33, v33, v33 row_ror:4 row_mask:0xf bank_mask:0xf
    v_add_f32_dpp v34, v34, v34 row_ror:4 row_mask:0xf bank_mask:0xf
    v_add_f32_dpp v35, v35, v35 row_ror:4 row_mask:0xf bank_mask:0xf
    v_add_f32_dpp v32, v32, v32 row_ror:8 row_mask:0xf bank_mask:0xf
    v_add_f32_dpp v33, v33, v33 row_ror:8 row_mask:0xf bank_mask:0xf
    v_add_f32_dpp v34, v34, v34 row_ror:8 row_mask:0xf bank_mask:0xf
    v_add_f32_dpp v35, v35, v35 row_ror:8 row_mask:0xf bank_mask:0xf
    v_mov_b32 v36, v32
    v_mov_b32 v37, v33
    v_mov_b32 v38, v34
    v_mov_b32 v39, v35
    v_permlane16_swap_b32 v32, v36
    v_permlane16_swap_b32 v33, v37
    v_permlane16_swap_b32 v34, v38
    v_permlane16_swap_b32 v35, v39
    v_add_f32 v32, v32, v36
    v_add_f32 v33, v33, v37
    v_add_f32 v34, v34, v38
    v_add_f32 v35, v35, v39
    v_mov_b32 v36, v32
    v_mov_b32 v37, v33
    v_mov_b32 v38, v34
    v_mov_b32 v39, v35
    v_permlane32_swap_b32 v32, v36
    v_permlane32_swap_b32 v33, v37
    v_permlane32_swap_b32 v34, v38
    v_permlane32_swap_b32 v35, v39
    v_add_f32 v32, v32, v36
    v_add_f32 v33, v33, v37
    v_add_f32 v34, v34, v38
    v_add_f32 v35, v35, v39
    v_fma_f32 v32, v32, v96, v92
    v_fma_f32 v33, v33, v96, v93
    v_fma_f32 v34, v34, v96, v94
    v_fma_f32 v35, v35, v96, v95
    v_cvt_pk_bf16_f32 v32, v32, v33
    v_cvt_pk_bf16_f32 v33, v34, v35
    s_lshl_b32 s32, s73, 11
    s_lshl_b32 s33, s89, 5
    s_add_u32 s32, s32, s33
    v_lshlrev_b32 v30, 3, v252
    s_mov_b64 exec, 15
    buffer_store_dwordx2 v[32:33], v30, s[12:15], s32 offen sc1
    s_mov_b64 exec, -1
k_end:
k_exit:
    s_endpgm
.section .rodata,"a"
.p2align 6
.amdhsa_kernel interleave_layers__sliding_block__moe_arch_mod__prompt_kernel
  .amdhsa_next_free_vgpr 256
  .amdhsa_next_free_sgpr 102
  .amdhsa_accum_offset 256
  .amdhsa_group_segment_fixed_size 0
  .amdhsa_kernarg_size 88
  .amdhsa_user_sgpr_count 2
  .amdhsa_user_sgpr_kernarg_segment_ptr 1
  .amdhsa_system_sgpr_workgroup_id_x 1
.end_amdhsa_kernel
```

```asm
; @launch grid=(256,1,1) block=(512,1,1) lds=163840
.amdgcn_target "amdgcn-amd-amdhsa--gfx950"
.text
.globl interleave_layers__sliding_block__moe_arch_mod__prompt_kernel
.p2align 8
.type interleave_layers__sliding_block__moe_arch_mod__prompt_kernel,@function
interleave_layers__sliding_block__moe_arch_mod__prompt_kernel:
    s_cmp_ge_u32 s2, 256
    s_cbranch_scc1 k_exit
    s_load_dwordx4 s[4:7], s[0:1], 0
    s_load_dwordx2 s[8:9], s[0:1], 16
    s_load_dwordx2 s[20:21], s[0:1], 80
    s_load_dwordx2 s[12:13], s[0:1], 72
    s_load_dwordx2 s[80:81], s[0:1], 32
    v_lshrrev_b32 v1, 6, v0
    v_and_b32 v252, 63, v0
    v_readfirstlane_b32 s3, v1
    v_lshlrev_b32 v253, 4, v252
    s_and_b32 s30, s2, 7
    s_lshr_b32 s31, s2, 3
    s_and_b32 s32, s31, 1
    s_lshl_b32 s33, s30, 1
    s_add_u32 s24, s33, s32
    s_lshr_b32 s25, s31, 1
    s_add_u32 s33, s33, s25
    s_add_u32 s94, s33, s32
    s_sub_u32 s95, s33, s32
    s_add_u32 s98, s95, 15
    s_and_b32 s98, s98, 15
    s_mul_i32 s29, s30, 28
    s_lshl_b32 s32, s30, 2
    s_add_u32 s32, s32, 196
    s_cmp_lt_u32 s31, 28
    s_cselect_b32 s29, s29, s32
    s_add_u32 s29, s29, s31
    s_lshl_b32 s72, s24, 4
    s_add_u32 s72, s72, s25
    s_mov_b32 s26, 0
    s_mov_b32 s27, 20000
    s_and_b32 s28, s3, 3
    s_lshl_b32 s99, s24, 2
    s_add_u32 s99, s99, s28
    s_lshl_b32 s101, s28, 10
    s_mov_b32 s18, 0x600000
    s_mov_b32 s19, 0x20000
    s_mov_b32 s10, 0x200000
    s_mov_b32 s11, 0x20000
    s_mov_b32 s22, 0x8000000
    s_mov_b32 s23, 0x20000
    s_mov_b32 s14, 0x100
    s_mov_b32 s15, 0x20000
    s_mov_b32 s82, 0x800
    s_mov_b32 s83, 0x20000
    s_cmp_ge_u32 s3, 4
    s_cbranch_scc1 l_start
    s_waitcnt lgkmcnt(0)
    s_mov_b64 s[16:17], s[6:7]
    s_mov_b32 s6, 0x400000
    s_mov_b32 s7, 0x20000
    v_lshrrev_b32 v5, 5, v252
    v_lshlrev_b32 v6, 3, v5
    s_lshl_b32 s33, s98, 7
    buffer_load_dwordx2 v[224:225], v6, s[80:83], s33 offen offset:0
    buffer_load_dwordx2 v[226:227], v6, s[80:83], s33 offen offset:16
    buffer_load_dwordx2 v[228:229], v6, s[80:83], s33 offen offset:32
    buffer_load_dwordx2 v[230:231], v6, s[80:83], s33 offen offset:48
    buffer_load_dwordx2 v[232:233], v6, s[80:83], s33 offen offset:64
    buffer_load_dwordx2 v[234:235], v6, s[80:83], s33 offen offset:80
    buffer_load_dwordx2 v[236:237], v6, s[80:83], s33 offen offset:96
    buffer_load_dwordx2 v[238:239], v6, s[80:83], s33 offen offset:112
    s_mov_b32 s40, 0xffffffff
    s_mov_b32 s41, 0xfffffff0
    s_mov_b32 s42, 0xfffffffe
    s_mov_b32 s43, 0xffffffe0
    s_mov_b32 s44, 0xfffffffc
    s_mov_b32 s45, 0xffffffc0
    s_mov_b32 s46, 0xfffffff8
    s_mov_b32 s47, 0xffffff80
    s_mov_b32 s48, 0xffff0000
    s_mov_b32 s49, 0xfff00000
    s_mov_b32 s50, 0xfffe0000
    s_mov_b32 s51, 0xffe00000
    s_mov_b32 s52, 0xfffc0000
    s_mov_b32 s53, 0xffc00000
    s_mov_b32 s54, 0xfff80000
    s_mov_b32 s55, 0xff800000
    s_mov_b32 s56, 0xffffff00
    s_mov_b32 s57, 0xfffff000
    s_mov_b32 s58, 0xfffffe00
    s_mov_b32 s59, 0xffffe000
    s_mov_b32 s60, 0xfffffc00
    s_mov_b32 s61, 0xffffc000
    s_mov_b32 s62, 0xfffff800
    s_mov_b32 s63, 0xffff8000
    s_mov_b32 s64, 0xff000000
    s_mov_b32 s65, 0xf0000000
    s_mov_b32 s66, 0xfe000000
    s_mov_b32 s67, 0xe0000000
    s_mov_b32 s68, 0xfc000000
    s_mov_b32 s69, 0xc0000000
    s_mov_b32 s70, 0xf8000000
    s_mov_b32 s71, 0x80000000
    v_bfe_u32 v20, v252, 3, 2
    v_lshrrev_b32 v21, 5, v252
    v_lshl_add_u32 v20, v21, 3, v20
    s_lshr_b32 s32, s28, 1
    s_lshl_b32 s32, s32, 4
    s_and_b32 s33, s28, 1
    s_lshl_b32 s33, s33, 2
    s_add_u32 s32, s32, s33
    v_add_u32 v20, s32, v20
    v_lshlrev_b32 v20, 11, v20
    v_lshrrev_b32 v21, 2, v252
    v_and_b32 v21, 4, v21
    v_xor_b32 v21, v21, v252
    v_and_b32 v21, 7, v21
    v_lshl_add_u32 v20, v21, 4, v20
    s_lshl_b32 s32, s98, 7
    v_add_u32 v243, s32, v20
    s_and_b32 s34, s3, 1
    s_lshr_b32 s35, s3, 1
    v_and_b32 v4, 15, v252
    v_lshrrev_b32 v7, 4, v252
    v_lshrrev_b32 v6, 1, v4
    v_xor_b32 v6, v6, v7
    v_lshlrev_b32 v6, 4, v6
    v_lshl_add_u32 v6, v4, 7, v6
    s_lshl_b32 s30, s34, 13
    v_add_u32 v176, s30, v6
    v_xor_b32 v177, 64, v176
    s_lshl_b32 s30, s35, 1
    v_lshrrev_b32 v20, 2, v252
    v_bfe_u32 v21, v20, 1, 2
    v_xor_b32 v21, s30, v21
    v_lshlrev_b32 v20, 7, v20
    v_lshl_add_u32 v20, v21, 5, v20
    v_and_b32 v21, 3, v252
    v_lshl_add_u32 v20, v21, 3, v20
    v_add_u32 v178, 40960, v20
    v_xor_b32 v179, 32, v178
    v_and_b32 v8, 31, v252
    v_bfe_u32 v6, v8, 1, 3
    v_xor_b32 v6, v6, v5
    v_lshlrev_b32 v6, 4, v6
    v_lshl_add_u32 v6, v8, 7, v6
    s_lshl_b32 s30, s3, 12
    s_add_u32 s30, s30, 147456
    v_add_u32 v192, s30, v6
    v_xor_b32 v193, 32, v192
    v_xor_b32 v194, 64, v192
    v_xor_b32 v195, 96, v192
    s_lshl_b32 s30, s34, 8
    v_lshl_add_u32 v184, v4, 2, s30
    v_lshl_add_u32 v185, v7, 4, s30
    s_lshl_b32 s30, s35, 7
    v_lshl_add_u32 v186, v7, 4, s30
    s_add_u32 s30, s30, 1536
    v_lshl_add_u32 v187, v4, 2, s30
    s_lshl_b32 s30, s3, 7
    s_add_u32 s30, s30, 2048
    v_lshl_add_u32 v188, v8, 2, s30
    v_mov_b32 v189, 0
    v_lshlrev_b32 v6, 9, v7
    v_lshl_add_u32 v245, v4, 4, v6
    v_and_b32 v9, 8, v4
    v_lshl_add_u32 v244, v9, 4, v245
    s_mul_i32 s30, s35, 49152
    s_lshl_b32 s31, s34, 13
    s_add_u32 s30, s30, s31
    s_add_u32 s30, s30, 98304
    v_add_u32 v246, s30, v244
    v_add_u32 v247, s30, v245
    s_lshl_b32 s30, s3, 12
    s_add_u32 s30, s30, 49152
    v_add_u32 v248, s30, v245
    v_mov_b32 v242, 0
    v_mov_b32 v0, 0
    v_mov_b32 v1, 0
    v_mov_b32 v2, 0
    v_mov_b32 v3, 0
    v_mov_b32 v4, 0
    v_mov_b32 v5, 0
    v_mov_b32 v6, 0
    v_mov_b32 v7, 0
    v_mov_b32 v8, 0
    v_mov_b32 v9, 0
    v_mov_b32 v10, 0
    v_mov_b32 v11, 0
    v_mov_b32 v12, 0
    v_mov_b32 v13, 0
    v_mov_b32 v14, 0
    v_mov_b32 v15, 0
    v_mov_b32 v16, 0
    v_mov_b32 v17, 0
    v_mov_b32 v18, 0
    v_mov_b32 v19, 0
    v_mov_b32 v20, 0
    v_mov_b32 v21, 0
    v_mov_b32 v22, 0
    v_mov_b32 v23, 0
    v_mov_b32 v24, 0
    v_mov_b32 v25, 0
    v_mov_b32 v26, 0
    v_mov_b32 v27, 0
    v_mov_b32 v28, 0
    v_mov_b32 v29, 0
    v_mov_b32 v30, 0
    v_mov_b32 v31, 0
    v_mov_b32 v32, 0
    v_mov_b32 v33, 0
    v_mov_b32 v34, 0
    v_mov_b32 v35, 0
    v_mov_b32 v36, 0
    v_mov_b32 v37, 0
    v_mov_b32 v38, 0
    v_mov_b32 v39, 0
    v_mov_b32 v40, 0
    v_mov_b32 v41, 0
    v_mov_b32 v42, 0
    v_mov_b32 v43, 0
    v_mov_b32 v44, 0
    v_mov_b32 v45, 0
    v_mov_b32 v46, 0
    v_mov_b32 v47, 0
    v_mov_b32 v48, 0
    v_mov_b32 v49, 0
    v_mov_b32 v50, 0
    v_mov_b32 v51, 0
    v_mov_b32 v52, 0
    v_mov_b32 v53, 0
    v_mov_b32 v54, 0
    v_mov_b32 v55, 0
    v_mov_b32 v56, 0
    v_mov_b32 v57, 0
    v_mov_b32 v58, 0
    v_mov_b32 v59, 0
    v_mov_b32 v60, 0
    v_mov_b32 v61, 0
    v_mov_b32 v62, 0
    v_mov_b32 v63, 0
    v_mov_b32 v64, 0
    v_mov_b32 v65, 0
    v_mov_b32 v66, 0
    v_mov_b32 v67, 0
    v_mov_b32 v68, 0
    v_mov_b32 v69, 0
    v_mov_b32 v70, 0
    v_mov_b32 v71, 0
    v_mov_b32 v72, 0
    v_mov_b32 v73, 0
    v_mov_b32 v74, 0
    v_mov_b32 v75, 0
    v_mov_b32 v76, 0
    v_mov_b32 v77, 0
    v_mov_b32 v78, 0
    v_mov_b32 v79, 0
    v_mov_b32 v80, 0
    v_mov_b32 v81, 0
    v_mov_b32 v82, 0
    v_mov_b32 v83, 0
    v_mov_b32 v84, 0
    v_mov_b32 v85, 0
    v_mov_b32 v86, 0
    v_mov_b32 v87, 0
    v_mov_b32 v88, 0
    v_mov_b32 v89, 0
    v_mov_b32 v90, 0
    v_mov_b32 v91, 0
    v_mov_b32 v92, 0
    v_mov_b32 v93, 0
    v_mov_b32 v94, 0
    v_mov_b32 v95, 0
    s_waitcnt vmcnt(0)
    v_dot2c_f32_bf16 v242, 0x3f803f80, v224
    v_dot2c_f32_bf16 v242, 0x3f803f80, v225
    v_dot2c_f32_bf16 v242, 0x3f803f80, v226
    v_dot2c_f32_bf16 v242, 0x3f803f80, v227
    v_dot2c_f32_bf16 v242, 0x3f803f80, v228
    v_dot2c_f32_bf16 v242, 0x3f803f80, v229
    v_dot2c_f32_bf16 v242, 0x3f803f80, v230
    v_dot2c_f32_bf16 v242, 0x3f803f80, v231
    v_dot2c_f32_bf16 v242, 0x3f803f80, v232
    v_dot2c_f32_bf16 v242, 0x3f803f80, v233
    v_dot2c_f32_bf16 v242, 0x3f803f80, v234
    v_dot2c_f32_bf16 v242, 0x3f803f80, v235
    v_dot2c_f32_bf16 v242, 0x3f803f80, v236
    v_dot2c_f32_bf16 v242, 0x3f803f80, v237
    v_dot2c_f32_bf16 v242, 0x3f803f80, v238
    v_dot2c_f32_bf16 v242, 0x3f803f80, v239
    s_setprio 1
e_q:
    s_mov_b32 s31, 0
    s_mov_b32 s32, 147456
    s_mov_b32 s36, 15
    v_add_u32 v180, s32, v176
    v_mov_b32 v182, v178
    v_add_u32 v181, s32, v177
    v_mov_b32 v183, v179
    s_barrier
    ds_read_b128 v[96:99], v180 offset:0
    ds_read_b64_tr_b16 v[112:113], v182 offset:0
    ds_read_b64_tr_b16 v[114:115], v182 offset:2048
    ds_read_b128 v[100:103], v180 offset:2048
    ds_read_b128 v[104:107], v180 offset:4096
    ds_read_b128 v[108:111], v180 offset:6144
    ds_read_b64_tr_b16 v[116:117], v183 offset:0
    ds_read_b64_tr_b16 v[118:119], v183 offset:2048
    ds_read_b64_tr_b16 v[120:121], v182 offset:8192
    ds_read_b64_tr_b16 v[122:123], v182 offset:10240
    ds_read_b64_tr_b16 v[124:125], v183 offset:8192
    ds_read_b64_tr_b16 v[126:127], v183 offset:10240
    ds_read_b64_tr_b16 v[128:129], v182 offset:16384
    ds_read_b64_tr_b16 v[130:131], v182 offset:18432
    ds_read_b64_tr_b16 v[132:133], v183 offset:16384
    ds_read_b64_tr_b16 v[134:135], v183 offset:18432
e_loop:
    s_waitcnt lgkmcnt(0)
    v_mfma_f32_16x16x32_bf16 v[0:3], v[112:115], v[96:99], v[0:3]
    ds_read_b128 v[136:139], v181 offset:0
    v_mfma_f32_16x16x32_bf16 v[8:11], v[112:115], v[100:103], v[8:11]
    ds_read_b64_tr_b16 v[152:153], v182 offset:4096
    v_mfma_f32_16x16x32_bf16 v[16:19], v[112:115], v[104:107], v[16:19]
    ds_read_b64_tr_b16 v[154:155], v182 offset:6144
    v_mfma_f32_16x16x32_bf16 v[24:27], v[112:115], v[108:111], v[24:27]
    ds_read_b128 v[140:143], v181 offset:2048
    v_mfma_f32_16x16x32_bf16 v[28:31], v[116:119], v[108:111], v[28:31]
    ds_read_b128 v[144:147], v181 offset:4096
    v_mfma_f32_16x16x32_bf16 v[20:23], v[116:119], v[104:107], v[20:23]
    ds_read_b128 v[148:151], v181 offset:6144
    v_mfma_f32_16x16x32_bf16 v[12:15], v[116:119], v[100:103], v[12:15]
    ds_read_b64_tr_b16 v[156:157], v183 offset:4096
    v_mfma_f32_16x16x32_bf16 v[4:7], v[116:119], v[96:99], v[4:7]
    ds_read_b64_tr_b16 v[158:159], v183 offset:6144
    v_mfma_f32_16x16x32_bf16 v[32:35], v[120:123], v[96:99], v[32:35]
    ds_read_b64_tr_b16 v[160:161], v182 offset:12288
    v_mfma_f32_16x16x32_bf16 v[40:43], v[120:123], v[100:103], v[40:43]
    ds_read_b64_tr_b16 v[162:163], v182 offset:14336
    v_mfma_f32_16x16x32_bf16 v[48:51], v[120:123], v[104:107], v[48:51]
    ds_read_b64_tr_b16 v[164:165], v183 offset:12288
    v_mfma_f32_16x16x32_bf16 v[56:59], v[120:123], v[108:111], v[56:59]
    ds_read_b64_tr_b16 v[166:167], v183 offset:14336
    v_mfma_f32_16x16x32_bf16 v[60:63], v[124:127], v[108:111], v[60:63]
    ds_read_b64_tr_b16 v[168:169], v182 offset:20480
    v_mfma_f32_16x16x32_bf16 v[52:55], v[124:127], v[104:107], v[52:55]
    ds_read_b64_tr_b16 v[170:171], v182 offset:22528
    v_mfma_f32_16x16x32_bf16 v[44:47], v[124:127], v[100:103], v[44:47]
    ds_read_b64_tr_b16 v[172:173], v183 offset:20480
    v_mfma_f32_16x16x32_bf16 v[36:39], v[124:127], v[96:99], v[36:39]
    ds_read_b64_tr_b16 v[174:175], v183 offset:22528
    v_mfma_f32_16x16x32_bf16 v[64:67], v[96:99], v[128:131], v[64:67]
    s_add_u32 s31, s31, 24576
    s_sub_u32 s32, s32, 16384
    v_mfma_f32_16x16x32_bf16 v[68:71], v[100:103], v[128:131], v[68:71]
    s_cmp_ge_u32 s31, 73728
    s_cselect_b32 s31, 0, s31
    s_cselect_b32 s32, 147456, s32
    v_mfma_f32_16x16x32_bf16 v[72:75], v[104:107], v[128:131], v[72:75]
    v_add_u32 v182, s31, v178
    v_add_u32 v180, s32, v176
    v_mfma_f32_16x16x32_bf16 v[76:79], v[108:111], v[128:131], v[76:79]
    v_add_u32 v183, s31, v179
    v_add_u32 v181, s32, v177
    v_mfma_f32_16x16x32_bf16 v[92:95], v[108:111], v[132:135], v[92:95]
    s_sub_u32 s36, s36, 1
    s_cmp_eq_u32 s36, 0
    v_mfma_f32_16x16x32_bf16 v[88:91], v[104:107], v[132:135], v[88:91]
    v_mfma_f32_16x16x32_bf16 v[84:87], v[100:103], v[132:135], v[84:87]
    v_mfma_f32_16x16x32_bf16 v[80:83], v[96:99], v[132:135], v[80:83]
    s_waitcnt lgkmcnt(0)
    v_mfma_f32_16x16x32_bf16 v[0:3], v[152:155], v[136:139], v[0:3]
    s_barrier
    ds_read_b128 v[96:99], v180 offset:0
    v_mfma_f32_16x16x32_bf16 v[8:11], v[152:155], v[140:143], v[8:11]
    ds_read_b64_tr_b16 v[112:113], v182 offset:0
    v_mfma_f32_16x16x32_bf16 v[16:19], v[152:155], v[144:147], v[16:19]
    ds_read_b64_tr_b16 v[114:115], v182 offset:2048
    v_mfma_f32_16x16x32_bf16 v[24:27], v[152:155], v[148:151], v[24:27]
    ds_read_b128 v[100:103], v180 offset:2048
    v_mfma_f32_16x16x32_bf16 v[28:31], v[156:159], v[148:151], v[28:31]
    ds_read_b128 v[104:107], v180 offset:4096
    v_mfma_f32_16x16x32_bf16 v[20:23], v[156:159], v[144:147], v[20:23]
    ds_read_b128 v[108:111], v180 offset:6144
    v_mfma_f32_16x16x32_bf16 v[12:15], v[156:159], v[140:143], v[12:15]
    ds_read_b64_tr_b16 v[116:117], v183 offset:0
    v_mfma_f32_16x16x32_bf16 v[4:7], v[156:159], v[136:139], v[4:7]
    ds_read_b64_tr_b16 v[118:119], v183 offset:2048
    v_mfma_f32_16x16x32_bf16 v[32:35], v[160:163], v[136:139], v[32:35]
    ds_read_b64_tr_b16 v[120:121], v182 offset:8192
    v_mfma_f32_16x16x32_bf16 v[40:43], v[160:163], v[140:143], v[40:43]
    ds_read_b64_tr_b16 v[122:123], v182 offset:10240
    v_mfma_f32_16x16x32_bf16 v[48:51], v[160:163], v[144:147], v[48:51]
    ds_read_b64_tr_b16 v[124:125], v183 offset:8192
    v_mfma_f32_16x16x32_bf16 v[56:59], v[160:163], v[148:151], v[56:59]
    ds_read_b64_tr_b16 v[126:127], v183 offset:10240
    v_mfma_f32_16x16x32_bf16 v[60:63], v[164:167], v[148:151], v[60:63]
    ds_read_b64_tr_b16 v[128:129], v182 offset:16384
    v_mfma_f32_16x16x32_bf16 v[52:55], v[164:167], v[144:147], v[52:55]
    ds_read_b64_tr_b16 v[130:131], v182 offset:18432
    v_mfma_f32_16x16x32_bf16 v[44:47], v[164:167], v[140:143], v[44:47]
    ds_read_b64_tr_b16 v[132:133], v183 offset:16384
    v_mfma_f32_16x16x32_bf16 v[36:39], v[164:167], v[136:139], v[36:39]
    ds_read_b64_tr_b16 v[134:135], v183 offset:18432
    v_mfma_f32_16x16x32_bf16 v[64:67], v[136:139], v[168:171], v[64:67]
    v_mfma_f32_16x16x32_bf16 v[68:71], v[140:143], v[168:171], v[68:71]
    v_mfma_f32_16x16x32_bf16 v[72:75], v[144:147], v[168:171], v[72:75]
    v_mfma_f32_16x16x32_bf16 v[76:79], v[148:151], v[168:171], v[76:79]
    v_mfma_f32_16x16x32_bf16 v[92:95], v[148:151], v[172:175], v[92:95]
    v_mfma_f32_16x16x32_bf16 v[88:91], v[144:147], v[172:175], v[88:91]
    v_mfma_f32_16x16x32_bf16 v[84:87], v[140:143], v[172:175], v[84:87]
    v_mfma_f32_16x16x32_bf16 v[80:83], v[136:139], v[172:175], v[80:83]
    s_cbranch_scc0 e_loop
    s_waitcnt lgkmcnt(0)
    v_mfma_f32_16x16x32_bf16 v[0:3], v[112:115], v[96:99], v[0:3]
    ds_read_b128 v[136:139], v181 offset:0
    v_mfma_f32_16x16x32_bf16 v[8:11], v[112:115], v[100:103], v[8:11]
    ds_read_b64_tr_b16 v[152:153], v182 offset:4096
    v_mfma_f32_16x16x32_bf16 v[16:19], v[112:115], v[104:107], v[16:19]
    ds_read_b64_tr_b16 v[154:155], v182 offset:6144
    v_mfma_f32_16x16x32_bf16 v[24:27], v[112:115], v[108:111], v[24:27]
    ds_read_b128 v[140:143], v181 offset:2048
    v_mfma_f32_16x16x32_bf16 v[28:31], v[116:119], v[108:111], v[28:31]
    ds_read_b128 v[144:147], v181 offset:4096
    v_mfma_f32_16x16x32_bf16 v[20:23], v[116:119], v[104:107], v[20:23]
    ds_read_b128 v[148:151], v181 offset:6144
    v_mfma_f32_16x16x32_bf16 v[12:15], v[116:119], v[100:103], v[12:15]
    ds_read_b64_tr_b16 v[156:157], v183 offset:4096
    v_mfma_f32_16x16x32_bf16 v[4:7], v[116:119], v[96:99], v[4:7]
    ds_read_b64_tr_b16 v[158:159], v183 offset:6144
    v_mfma_f32_16x16x32_bf16 v[32:35], v[120:123], v[96:99], v[32:35]
    ds_read_b64_tr_b16 v[160:161], v182 offset:12288
    v_mfma_f32_16x16x32_bf16 v[40:43], v[120:123], v[100:103], v[40:43]
    ds_read_b64_tr_b16 v[162:163], v182 offset:14336
    v_mfma_f32_16x16x32_bf16 v[48:51], v[120:123], v[104:107], v[48:51]
    ds_read_b64_tr_b16 v[164:165], v183 offset:12288
    v_mfma_f32_16x16x32_bf16 v[56:59], v[120:123], v[108:111], v[56:59]
    ds_read_b64_tr_b16 v[166:167], v183 offset:14336
    v_mfma_f32_16x16x32_bf16 v[60:63], v[124:127], v[108:111], v[60:63]
    ds_read_b64_tr_b16 v[168:169], v182 offset:20480
    v_mfma_f32_16x16x32_bf16 v[52:55], v[124:127], v[104:107], v[52:55]
    ds_read_b64_tr_b16 v[170:171], v182 offset:22528
    v_mfma_f32_16x16x32_bf16 v[44:47], v[124:127], v[100:103], v[44:47]
    ds_read_b64_tr_b16 v[172:173], v183 offset:20480
    v_mfma_f32_16x16x32_bf16 v[36:39], v[124:127], v[96:99], v[36:39]
    ds_read_b64_tr_b16 v[174:175], v183 offset:22528
    v_mfma_f32_16x16x32_bf16 v[64:67], v[96:99], v[128:131], v[64:67]
    s_cmp_lg_u32 s26, 0
    s_cbranch_scc1 e_nores
    ds_read_b128 v[208:211], v192
    ds_read_b128 v[212:215], v193
    ds_read_b128 v[216:219], v194
    ds_read_b128 v[220:223], v195
e_nores:
    v_mfma_f32_16x16x32_bf16 v[68:71], v[100:103], v[128:131], v[68:71]
    s_and_b32 s34, s3, 1
    s_lshr_b32 s35, s3, 1
    s_lshl_b32 s30, s25, 1
    v_mfma_f32_16x16x32_bf16 v[72:75], v[104:107], v[128:131], v[72:75]
    s_add_u32 s30, s30, s35
    s_lshl_b32 s30, s30, 6
    s_lshl_b32 s31, s24, 2
    v_mfma_f32_16x16x32_bf16 v[76:79], v[108:111], v[128:131], v[76:79]
    s_add_u32 s30, s30, s31
    s_lshl_b32 s31, s34, 1
    s_add_u32 s30, s30, s31
    v_mfma_f32_16x16x32_bf16 v[92:95], v[108:111], v[132:135], v[92:95]
    s_lshl_b32 s32, s30, 12
    s_add_u32 s32, s32, s26
    s_add_u32 s33, s32, 4096
    v_mfma_f32_16x16x32_bf16 v[88:91], v[104:107], v[132:135], v[88:91]
    v_mfma_f32_16x16x32_bf16 v[84:87], v[100:103], v[132:135], v[84:87]
    v_mfma_f32_16x16x32_bf16 v[80:83], v[96:99], v[132:135], v[80:83]
    s_waitcnt lgkmcnt(0)
    v_mfma_f32_16x16x32_bf16 v[32:35], v[160:163], v[136:139], v[32:35]
    s_barrier
    ds_read2_b32 v[204:205], v184 offset0:128 offset1:144
    ds_read_b128 v[128:131], v186 offset:1280
    v_mfma_f32_16x16x32_bf16 v[40:43], v[160:163], v[140:143], v[40:43]
    ds_read_b128 v[132:135], v186 offset:1344
    ds_read2_b32 v[192:193], v184 offset0:0 offset1:16
    v_mfma_f32_16x16x32_bf16 v[48:51], v[160:163], v[144:147], v[48:51]
    ds_read2_b32 v[206:207], v184 offset0:160 offset1:176
    ds_read2_b32 v[194:195], v184 offset0:32 offset1:48
    v_mfma_f32_16x16x32_bf16 v[56:59], v[160:163], v[148:151], v[56:59]
    ds_read2_b32 v[190:191], v187 offset0:0 offset1:16
    ds_read_b128 v[112:115], v185 offset:512
    v_mfma_f32_16x16x32_bf16 v[36:39], v[164:167], v[136:139], v[36:39]
    ds_read_b128 v[96:99], v185 offset:0
    ds_read_b128 v[116:119], v185 offset:576
    v_mfma_f32_16x16x32_bf16 v[44:47], v[164:167], v[140:143], v[44:47]
    ds_read_b128 v[100:103], v185 offset:64
    ds_read_b128 v[120:123], v185 offset:640
    v_mfma_f32_16x16x32_bf16 v[52:55], v[164:167], v[144:147], v[52:55]
    ds_read_b128 v[104:107], v185 offset:128
    ds_read_b128 v[124:127], v185 offset:704
    v_mfma_f32_16x16x32_bf16 v[60:63], v[164:167], v[148:151], v[60:63]
    ds_read_b128 v[108:111], v185 offset:192
    ds_read_b128 v[196:199], v186 offset:1024
    v_mfma_f32_16x16x32_bf16 v[64:67], v[136:139], v[168:171], v[64:67]
    ds_read_b128 v[200:203], v186 offset:1088
    ds_read2_b32 v[240:241], v188 offset0:0 offset1:128
    v_mfma_f32_16x16x32_bf16 v[68:71], v[140:143], v[168:171], v[68:71]
    ds_read_b64 v[250:251], v189 offset:3072
    v_mfma_f32_16x16x32_bf16 v[72:75], v[144:147], v[168:171], v[72:75]
    s_waitcnt lgkmcnt(13)
    v_fma_f32 v32, v128, -v204, v32
    v_fma_f32 v33, v129, -v204, v33
    v_fma_f32 v34, v130, -v204, v34
    v_mfma_f32_16x16x32_bf16 v[76:79], v[148:151], v[168:171], v[76:79]
    v_fma_f32 v35, v131, -v204, v35
    v_fma_f32 v36, v132, -v204, v36
    v_fma_f32 v37, v133, -v204, v37
    v_mfma_f32_16x16x32_bf16 v[80:83], v[136:139], v[172:175], v[80:83]
    v_fma_f32 v38, v134, -v204, v38
    v_fma_f32 v39, v135, -v204, v39
    v_mul_f32 v32, v32, v192
    v_mfma_f32_16x16x32_bf16 v[84:87], v[140:143], v[172:175], v[84:87]
    v_mul_f32 v33, v33, v192
    v_mul_f32 v34, v34, v192
    v_mul_f32 v35, v35, v192
    v_mfma_f32_16x16x32_bf16 v[88:91], v[144:147], v[172:175], v[88:91]
    v_mul_f32 v36, v36, v192
    v_mul_f32 v37, v37, v192
    v_mul_f32 v38, v38, v192
    v_mfma_f32_16x16x32_bf16 v[92:95], v[148:151], v[172:175], v[92:95]
    v_mul_f32 v39, v39, v192
    v_cvt_pk_bf16_f32 v32, v32, v33
    v_cvt_pk_bf16_f32 v33, v34, v35
    v_mfma_f32_16x16x32_bf16 v[0:3], v[152:155], v[136:139], v[0:3]
    v_cvt_pk_bf16_f32 v34, v36, v37
    v_cvt_pk_bf16_f32 v35, v38, v39
    buffer_store_dwordx4 v[32:35], v244, s[20:23], s32 offen offset:0 sc1
    v_mfma_f32_16x16x32_bf16 v[8:11], v[152:155], v[140:143], v[8:11]
    v_fma_f32 v40, v128, -v205, v40
    v_fma_f32 v41, v129, -v205, v41
    v_fma_f32 v42, v130, -v205, v42
    v_mfma_f32_16x16x32_bf16 v[16:19], v[152:155], v[144:147], v[16:19]
    v_fma_f32 v43, v131, -v205, v43
    v_fma_f32 v44, v132, -v205, v44
    v_fma_f32 v45, v133, -v205, v45
    v_mfma_f32_16x16x32_bf16 v[24:27], v[152:155], v[148:151], v[24:27]
    v_fma_f32 v46, v134, -v205, v46
    v_fma_f32 v47, v135, -v205, v47
    v_mul_f32 v40, v40, v193
    v_mfma_f32_16x16x32_bf16 v[4:7], v[156:159], v[136:139], v[4:7]
    v_mul_f32 v41, v41, v193
    v_mul_f32 v42, v42, v193
    v_mul_f32 v43, v43, v193
    v_mfma_f32_16x16x32_bf16 v[12:15], v[156:159], v[140:143], v[12:15]
    v_mul_f32 v44, v44, v193
    v_mul_f32 v45, v45, v193
    v_mul_f32 v46, v46, v193
    v_mfma_f32_16x16x32_bf16 v[20:23], v[156:159], v[144:147], v[20:23]
    v_mul_f32 v47, v47, v193
    v_cvt_pk_bf16_f32 v40, v40, v41
    v_cvt_pk_bf16_f32 v41, v42, v43
    v_mfma_f32_16x16x32_bf16 v[28:31], v[156:159], v[148:151], v[28:31]
    v_cvt_pk_bf16_f32 v42, v44, v45
    v_cvt_pk_bf16_f32 v43, v46, v47
    buffer_store_dwordx4 v[40:43], v244, s[20:23], s32 offen offset:128 sc1
    v_pk_fma_f32 v[48:49], v[128:129], v[206:207], v[48:49] op_sel_hi:[1,0,1] neg_lo:[0,1,0] neg_hi:[0,1,0]
    v_pk_fma_f32 v[50:51], v[130:131], v[206:207], v[50:51] op_sel_hi:[1,0,1] neg_lo:[0,1,0] neg_hi:[0,1,0]
    v_pk_fma_f32 v[52:53], v[132:133], v[206:207], v[52:53] op_sel_hi:[1,0,1] neg_lo:[0,1,0] neg_hi:[0,1,0]
    v_pk_fma_f32 v[54:55], v[134:135], v[206:207], v[54:55] op_sel_hi:[1,0,1] neg_lo:[0,1,0] neg_hi:[0,1,0]
    v_pk_mul_f32 v[48:49], v[48:49], v[194:195] op_sel_hi:[1,0]
    v_pk_mul_f32 v[50:51], v[50:51], v[194:195] op_sel_hi:[1,0]
    v_pk_mul_f32 v[52:53], v[52:53], v[194:195] op_sel_hi:[1,0]
    v_pk_mul_f32 v[54:55], v[54:55], v[194:195] op_sel_hi:[1,0]
    v_cvt_pk_bf16_f32 v48, v48, v49
    v_cvt_pk_bf16_f32 v49, v50, v51
    v_cvt_pk_bf16_f32 v50, v52, v53
    v_cvt_pk_bf16_f32 v51, v54, v55
    buffer_store_dwordx4 v[48:51], v244, s[20:23], s33 offen offset:0 sc1
    v_pk_fma_f32 v[56:57], v[128:129], v[206:207], v[56:57] op_sel:[0,1,0] op_sel_hi:[1,1,1] neg_lo:[0,1,0] neg_hi:[0,1,0]
    v_pk_fma_f32 v[58:59], v[130:131], v[206:207], v[58:59] op_sel:[0,1,0] op_sel_hi:[1,1,1] neg_lo:[0,1,0] neg_hi:[0,1,0]
    v_pk_fma_f32 v[60:61], v[132:133], v[206:207], v[60:61] op_sel:[0,1,0] op_sel_hi:[1,1,1] neg_lo:[0,1,0] neg_hi:[0,1,0]
    v_pk_fma_f32 v[62:63], v[134:135], v[206:207], v[62:63] op_sel:[0,1,0] op_sel_hi:[1,1,1] neg_lo:[0,1,0] neg_hi:[0,1,0]
    v_pk_mul_f32 v[56:57], v[56:57], v[194:195] op_sel:[0,1] op_sel_hi:[1,1]
    v_pk_mul_f32 v[58:59], v[58:59], v[194:195] op_sel:[0,1] op_sel_hi:[1,1]
    v_pk_mul_f32 v[60:61], v[60:61], v[194:195] op_sel:[0,1] op_sel_hi:[1,1]
    v_pk_mul_f32 v[62:63], v[62:63], v[194:195] op_sel:[0,1] op_sel_hi:[1,1]
    v_cvt_pk_bf16_f32 v56, v56, v57
    v_cvt_pk_bf16_f32 v57, v58, v59
    v_cvt_pk_bf16_f32 v58, v60, v61
    v_cvt_pk_bf16_f32 v59, v62, v63
    buffer_store_dwordx4 v[56:59], v244, s[20:23], s33 offen offset:128 sc1
    s_waitcnt lgkmcnt(0)
    v_pk_fma_f32 v[64:65], v[112:113], v[190:191], v[64:65] op_sel_hi:[1,0,1] neg_lo:[0,1,0] neg_hi:[0,1,0]
    v_pk_fma_f32 v[66:67], v[114:115], v[190:191], v[66:67] op_sel_hi:[1,0,1] neg_lo:[0,1,0] neg_hi:[0,1,0]
    v_pk_fma_f32 v[68:69], v[116:117], v[190:191], v[68:69] op_sel_hi:[1,0,1] neg_lo:[0,1,0] neg_hi:[0,1,0]
    v_pk_fma_f32 v[70:71], v[118:119], v[190:191], v[70:71] op_sel_hi:[1,0,1] neg_lo:[0,1,0] neg_hi:[0,1,0]
    v_pk_mul_f32 v[64:65], v[64:65], v[96:97]
    v_pk_mul_f32 v[66:67], v[66:67], v[98:99]
    v_pk_mul_f32 v[68:69], v[68:69], v[100:101]
    v_pk_mul_f32 v[70:71], v[70:71], v[102:103]
    v_cvt_pk_bf16_f32 v64, v64, v65
    v_cvt_pk_bf16_f32 v65, v66, v67
    v_cvt_pk_bf16_f32 v66, v68, v69
    v_cvt_pk_bf16_f32 v67, v70, v71
    buffer_store_dwordx4 v[64:67], v245, s[20:23], s32 offen offset:2048 sc1
    v_pk_fma_f32 v[80:81], v[112:113], v[190:191], v[80:81] op_sel:[0,1,0] op_sel_hi:[1,1,1] neg_lo:[0,1,0] neg_hi:[0,1,0]
    v_pk_fma_f32 v[82:83], v[114:115], v[190:191], v[82:83] op_sel:[0,1,0] op_sel_hi:[1,1,1] neg_lo:[0,1,0] neg_hi:[0,1,0]
    v_pk_fma_f32 v[84:85], v[116:117], v[190:191], v[84:85] op_sel:[0,1,0] op_sel_hi:[1,1,1] neg_lo:[0,1,0] neg_hi:[0,1,0]
    v_pk_fma_f32 v[86:87], v[118:119], v[190:191], v[86:87] op_sel:[0,1,0] op_sel_hi:[1,1,1] neg_lo:[0,1,0] neg_hi:[0,1,0]
    v_pk_mul_f32 v[80:81], v[80:81], v[96:97]
    v_pk_mul_f32 v[82:83], v[82:83], v[98:99]
    v_pk_mul_f32 v[84:85], v[84:85], v[100:101]
    v_pk_mul_f32 v[86:87], v[86:87], v[102:103]
    v_cvt_pk_bf16_f32 v80, v80, v81
    v_cvt_pk_bf16_f32 v81, v82, v83
    v_cvt_pk_bf16_f32 v82, v84, v85
    v_cvt_pk_bf16_f32 v83, v86, v87
    buffer_store_dwordx4 v[80:83], v245, s[20:23], s32 offen offset:2304 sc1
    v_pk_fma_f32 v[72:73], v[120:121], v[190:191], v[72:73] op_sel_hi:[1,0,1] neg_lo:[0,1,0] neg_hi:[0,1,0]
    v_pk_fma_f32 v[74:75], v[122:123], v[190:191], v[74:75] op_sel_hi:[1,0,1] neg_lo:[0,1,0] neg_hi:[0,1,0]
    v_pk_fma_f32 v[76:77], v[124:125], v[190:191], v[76:77] op_sel_hi:[1,0,1] neg_lo:[0,1,0] neg_hi:[0,1,0]
    v_pk_fma_f32 v[78:79], v[126:127], v[190:191], v[78:79] op_sel_hi:[1,0,1] neg_lo:[0,1,0] neg_hi:[0,1,0]
    v_pk_mul_f32 v[72:73], v[72:73], v[104:105]
    v_pk_mul_f32 v[74:75], v[74:75], v[106:107]
    v_pk_mul_f32 v[76:77], v[76:77], v[108:109]
    v_pk_mul_f32 v[78:79], v[78:79], v[110:111]
    v_cvt_pk_bf16_f32 v72, v72, v73
    v_cvt_pk_bf16_f32 v73, v74, v75
    v_cvt_pk_bf16_f32 v74, v76, v77
    v_cvt_pk_bf16_f32 v75, v78, v79
    buffer_store_dwordx4 v[72:75], v245, s[20:23], s33 offen offset:2048 sc1
    v_pk_fma_f32 v[88:89], v[120:121], v[190:191], v[88:89] op_sel:[0,1,0] op_sel_hi:[1,1,1] neg_lo:[0,1,0] neg_hi:[0,1,0]
    v_pk_fma_f32 v[90:91], v[122:123], v[190:191], v[90:91] op_sel:[0,1,0] op_sel_hi:[1,1,1] neg_lo:[0,1,0] neg_hi:[0,1,0]
    v_pk_fma_f32 v[92:93], v[124:125], v[190:191], v[92:93] op_sel:[0,1,0] op_sel_hi:[1,1,1] neg_lo:[0,1,0] neg_hi:[0,1,0]
    v_pk_fma_f32 v[94:95], v[126:127], v[190:191], v[94:95] op_sel:[0,1,0] op_sel_hi:[1,1,1] neg_lo:[0,1,0] neg_hi:[0,1,0]
    v_pk_mul_f32 v[88:89], v[88:89], v[104:105]
    v_pk_mul_f32 v[90:91], v[90:91], v[106:107]
    v_pk_mul_f32 v[92:93], v[92:93], v[108:109]
    v_pk_mul_f32 v[94:95], v[94:95], v[110:111]
    v_cvt_pk_bf16_f32 v88, v88, v89
    v_cvt_pk_bf16_f32 v89, v90, v91
    v_cvt_pk_bf16_f32 v90, v92, v93
    v_cvt_pk_bf16_f32 v91, v94, v95
    buffer_store_dwordx4 v[88:91], v245, s[20:23], s33 offen offset:2304 sc1
    ds_write_b128 v246, v[32:35] offset:0
    v_mul_f32 v192, 0x3e8293ee, v192
    ds_write_b128 v246, v[40:43] offset:128
    v_mul_f32 v193, 0x3e8293ee, v193
    ds_write_b128 v246, v[48:51] offset:4096
    v_mul_f32 v194, 0x3e8293ee, v194
    ds_write_b128 v246, v[56:59] offset:4224
    v_mul_f32 v195, 0x3e8293ee, v195
    v_pk_fma_f32 v[0:1], v[196:197], v[204:205], v[0:1] op_sel_hi:[1,0,1] neg_lo:[0,1,0] neg_hi:[0,1,0]
    v_pk_fma_f32 v[2:3], v[198:199], v[204:205], v[2:3] op_sel_hi:[1,0,1] neg_lo:[0,1,0] neg_hi:[0,1,0]
    v_pk_fma_f32 v[4:5], v[200:201], v[204:205], v[4:5] op_sel_hi:[1,0,1] neg_lo:[0,1,0] neg_hi:[0,1,0]
    v_pk_fma_f32 v[6:7], v[202:203], v[204:205], v[6:7] op_sel_hi:[1,0,1] neg_lo:[0,1,0] neg_hi:[0,1,0]
    v_pk_mul_f32 v[0:1], v[0:1], v[192:193] op_sel_hi:[1,0]
    v_pk_mul_f32 v[2:3], v[2:3], v[192:193] op_sel_hi:[1,0]
    v_pk_mul_f32 v[4:5], v[4:5], v[192:193] op_sel_hi:[1,0]
    v_pk_mul_f32 v[6:7], v[6:7], v[192:193] op_sel_hi:[1,0]
    v_cvt_pk_bf16_f32 v0, v0, v1
    v_cvt_pk_bf16_f32 v1, v2, v3
    v_cvt_pk_bf16_f32 v2, v4, v5
    v_cvt_pk_bf16_f32 v3, v6, v7
    ds_write_b128 v247, v[64:67] offset:2048
    ds_write_b128 v248, v[0:3] offset:0
    v_pk_fma_f32 v[8:9], v[196:197], v[204:205], v[8:9] op_sel:[0,1,0] op_sel_hi:[1,1,1] neg_lo:[0,1,0] neg_hi:[0,1,0]
    v_pk_fma_f32 v[10:11], v[198:199], v[204:205], v[10:11] op_sel:[0,1,0] op_sel_hi:[1,1,1] neg_lo:[0,1,0] neg_hi:[0,1,0]
    v_pk_fma_f32 v[12:13], v[200:201], v[204:205], v[12:13] op_sel:[0,1,0] op_sel_hi:[1,1,1] neg_lo:[0,1,0] neg_hi:[0,1,0]
    v_pk_fma_f32 v[14:15], v[202:203], v[204:205], v[14:15] op_sel:[0,1,0] op_sel_hi:[1,1,1] neg_lo:[0,1,0] neg_hi:[0,1,0]
    v_pk_mul_f32 v[8:9], v[8:9], v[192:193] op_sel:[0,1] op_sel_hi:[1,1]
    v_pk_mul_f32 v[10:11], v[10:11], v[192:193] op_sel:[0,1] op_sel_hi:[1,1]
    v_pk_mul_f32 v[12:13], v[12:13], v[192:193] op_sel:[0,1] op_sel_hi:[1,1]
    v_pk_mul_f32 v[14:15], v[14:15], v[192:193] op_sel:[0,1] op_sel_hi:[1,1]
    v_cvt_pk_bf16_f32 v8, v8, v9
    v_cvt_pk_bf16_f32 v9, v10, v11
    v_cvt_pk_bf16_f32 v10, v12, v13
    v_cvt_pk_bf16_f32 v11, v14, v15
    ds_write_b128 v247, v[80:83] offset:2304
    ds_write_b128 v248, v[8:11] offset:256
    v_pk_fma_f32 v[16:17], v[196:197], v[206:207], v[16:17] op_sel_hi:[1,0,1] neg_lo:[0,1,0] neg_hi:[0,1,0]
    v_pk_fma_f32 v[18:19], v[198:199], v[206:207], v[18:19] op_sel_hi:[1,0,1] neg_lo:[0,1,0] neg_hi:[0,1,0]
    v_pk_fma_f32 v[20:21], v[200:201], v[206:207], v[20:21] op_sel_hi:[1,0,1] neg_lo:[0,1,0] neg_hi:[0,1,0]
    v_pk_fma_f32 v[22:23], v[202:203], v[206:207], v[22:23] op_sel_hi:[1,0,1] neg_lo:[0,1,0] neg_hi:[0,1,0]
    v_pk_mul_f32 v[16:17], v[16:17], v[194:195] op_sel_hi:[1,0]
    v_pk_mul_f32 v[18:19], v[18:19], v[194:195] op_sel_hi:[1,0]
    v_pk_mul_f32 v[20:21], v[20:21], v[194:195] op_sel_hi:[1,0]
    v_pk_mul_f32 v[22:23], v[22:23], v[194:195] op_sel_hi:[1,0]
    v_cvt_pk_bf16_f32 v16, v16, v17
    v_cvt_pk_bf16_f32 v17, v18, v19
    v_cvt_pk_bf16_f32 v18, v20, v21
    v_cvt_pk_bf16_f32 v19, v22, v23
    ds_write_b128 v247, v[72:75] offset:6144
    ds_write_b128 v248, v[16:19] offset:2048
    v_pk_fma_f32 v[24:25], v[196:197], v[206:207], v[24:25] op_sel:[0,1,0] op_sel_hi:[1,1,1] neg_lo:[0,1,0] neg_hi:[0,1,0]
    v_pk_fma_f32 v[26:27], v[198:199], v[206:207], v[26:27] op_sel:[0,1,0] op_sel_hi:[1,1,1] neg_lo:[0,1,0] neg_hi:[0,1,0]
    v_pk_fma_f32 v[28:29], v[200:201], v[206:207], v[28:29] op_sel:[0,1,0] op_sel_hi:[1,1,1] neg_lo:[0,1,0] neg_hi:[0,1,0]
    v_pk_fma_f32 v[30:31], v[202:203], v[206:207], v[30:31] op_sel:[0,1,0] op_sel_hi:[1,1,1] neg_lo:[0,1,0] neg_hi:[0,1,0]
    v_pk_mul_f32 v[24:25], v[24:25], v[194:195] op_sel:[0,1] op_sel_hi:[1,1]
    v_pk_mul_f32 v[26:27], v[26:27], v[194:195] op_sel:[0,1] op_sel_hi:[1,1]
    v_pk_mul_f32 v[28:29], v[28:29], v[194:195] op_sel:[0,1] op_sel_hi:[1,1]
    v_pk_mul_f32 v[30:31], v[30:31], v[194:195] op_sel:[0,1] op_sel_hi:[1,1]
    v_cvt_pk_bf16_f32 v24, v24, v25
    v_cvt_pk_bf16_f32 v25, v26, v27
    v_cvt_pk_bf16_f32 v26, v28, v29
    v_cvt_pk_bf16_f32 v27, v30, v31
    ds_write_b128 v247, v[88:91] offset:6400
    ds_write_b128 v248, v[24:27] offset:2304
    s_lshl_b32 s30, s25, 8
    s_lshl_b32 s31, s24, 4
    s_add_u32 s30, s30, s31
    s_lshl_b32 s31, s34, 3
    s_add_u32 s30, s30, s31
    s_lshl_b32 s31, s35, 2
    s_add_u32 s30, s30, s31
    s_add_u32 s30, s30, s26
    s_add_u32 s30, s30, 0xdc1000
    v_mov_b32 v154, 0
    s_mov_b64 exec, 1
    s_waitcnt vmcnt(0)
    buffer_store_dword v154, v154, s[20:23], s30 offen sc1
    s_mov_b64 exec, -1
    v_readfirstlane_b32 s73, v250
    v_readfirstlane_b32 s77, v251
    s_lshr_b32 s39, s73, 5
    s_lshl_b32 s34, s24, 2
    s_sub_u32 s39, s39, s34
    s_add_u32 s39, s39, 8
    s_cmp_lt_u32 s39, 12
    s_cselect_b32 s100, 1, 0
    s_cmp_lg_u32 s26, 0
    s_cbranch_scc1 sk_1
    v_permlane32_swap_b32 v208, v210
    v_permlane32_swap_b32 v209, v211
    v_permlane32_swap_b32 v212, v214
    v_permlane32_swap_b32 v213, v215
    v_permlane32_swap_b32 v216, v218
    v_permlane32_swap_b32 v217, v219
    v_permlane32_swap_b32 v220, v222
    v_permlane32_swap_b32 v221, v223
sk_1:
    v_mov_b32 v20, 0xffff
    v_mov_b32 v21, 0xffff0000
    v_cndmask_b32 v22, 0, v20, s[40:41]
    v_cndmask_b32 v23, 0, v21, s[42:43]
    v_or_b32 v12, v22, v23
    v_cndmask_b32 v22, 0, v20, s[44:45]
    v_cndmask_b32 v23, 0, v21, s[46:47]
    v_or_b32 v13, v22, v23
    v_cndmask_b32 v22, 0, v20, s[48:49]
    v_cndmask_b32 v23, 0, v21, s[50:51]
    v_or_b32 v14, v22, v23
    v_cndmask_b32 v22, 0, v20, s[52:53]
    v_cndmask_b32 v23, 0, v21, s[54:55]
    v_or_b32 v15, v22, v23
    v_cndmask_b32 v22, 0, v20, s[56:57]
    v_cndmask_b32 v23, 0, v21, s[58:59]
    v_or_b32 v16, v22, v23
    v_cndmask_b32 v22, 0, v20, s[60:61]
    v_cndmask_b32 v23, 0, v21, s[62:63]
    v_or_b32 v17, v22, v23
    v_cndmask_b32 v22, 0, v20, s[64:65]
    v_cndmask_b32 v23, 0, v21, s[66:67]
    v_or_b32 v18, v22, v23
    v_cndmask_b32 v22, 0, v20, s[68:69]
    v_cndmask_b32 v23, 0, v21, s[70:71]
    v_or_b32 v19, v22, v23
    s_lshl_b32 s34, s28, 12
    s_add_u32 s34, s34, 65536
    v_add_u32 v20, s34, v253
    s_lshl_b32 s34, s3, 11
    s_add_u32 s34, s34, 49152
    v_add_u32 v3, s34, v253
    v_mov_b32 v24, 0
    v_mov_b32 v25, 0
    v_mov_b32 v26, 0
    v_mov_b32 v27, 0
    v_mov_b32 v28, 0
    v_mov_b32 v29, 0
    v_mov_b32 v30, 0
    v_mov_b32 v31, 0
    v_mov_b32 v32, 0
    v_mov_b32 v33, 0
    v_mov_b32 v34, 0
    v_mov_b32 v35, 0
    v_mov_b32 v36, 0
    v_mov_b32 v37, 0
    v_mov_b32 v38, 0
    v_mov_b32 v39, 0
    s_waitcnt lgkmcnt(0)
    s_barrier
    s_cmp_eq_u32 s100, 0
    s_cbranch_scc1 sk_2
    s_barrier
    s_lshr_b32 s34, s73, 5
    s_cmp_lg_u32 s34, s99
    s_cbranch_scc1 sk_3
    s_and_b32 s32, s73, 31
    v_and_b32 v0, 31, v252
    v_cmp_eq_u32 vcc, s32, v0
    v_lshrrev_b32 v0, 5, v252
    v_lshlrev_b32 v0, 4, v0
    s_lshl_b32 s34, s98, 7
    s_add_u32 s34, s34, 0xdc4000
    s_mov_b64 exec, vcc
    buffer_load_dwordx4 v[208:211], v0, s[20:23], s34 offen offset:0 sc1
    buffer_load_dwordx4 v[212:215], v0, s[20:23], s34 offen offset:32 sc1
    buffer_load_dwordx4 v[216:219], v0, s[20:23], s34 offen offset:64 sc1
    buffer_load_dwordx4 v[220:223], v0, s[20:23], s34 offen offset:96 sc1
    v_mov_b32 v240, 1.0
    v_mov_b32 v241, 0
    s_mov_b64 exec, -1
sk_3:
sk_2:
    ds_read_b128 v[4:7], v3
    ds_read_b128 v[8:11], v3 offset:1024
    ds_read_b128 v[104:107], v20 offset:32768
    ds_read_b128 v[108:111], v20 offset:33792
    ds_read_b128 v[112:115], v20 offset:28672
    ds_read_b128 v[116:119], v20 offset:29696
    s_waitcnt lgkmcnt(2)
    v_mfma_f32_32x32x16_bf16 v[40:55], v[104:107], v[4:7], 0
    v_mfma_f32_32x32x16_bf16 v[40:55], v[108:111], v[8:11], v[40:55]
    ds_read_b128 v[104:107], v20 offset:24576
    ds_read_b128 v[108:111], v20 offset:25600
    s_cmp_eq_u32 s99, 0
    s_cbranch_scc0 ng_4
    v_mov_b32 v24, 0xf149f2ca
    v_mov_b32 v25, 0xf149f2ca
    v_mov_b32 v26, 0xf149f2ca
    v_mov_b32 v27, 0xf149f2ca
    v_mov_b32 v28, 0xf149f2ca
    v_mov_b32 v29, 0xf149f2ca
    v_mov_b32 v30, 0xf149f2ca
    v_mov_b32 v31, 0xf149f2ca
    v_mov_b32 v32, 0xf149f2ca
    v_mov_b32 v33, 0xf149f2ca
    v_mov_b32 v34, 0xf149f2ca
    v_mov_b32 v35, 0xf149f2ca
    v_mov_b32 v36, 0xf149f2ca
    v_mov_b32 v37, 0xf149f2ca
    v_mov_b32 v38, 0xf149f2ca
    v_mov_b32 v39, 0xf149f2ca
ng_4:
    s_waitcnt lgkmcnt(2)
    s_nop 0
    v_mfma_f32_32x32x16_bf16 v[72:87], v[112:115], v[4:7], v[24:39]
    v_mfma_f32_32x32x16_bf16 v[72:87], v[116:119], v[8:11], v[72:87]
    ds_read_b128 v[112:115], v20 offset:20480
    ds_read_b128 v[116:119], v20 offset:21504
    s_cmp_eq_u32 s99, 1
    s_cbranch_scc0 ng_5
    s_nop 1
    v_mov_b32 v24, 0xf149f2ca
    v_mov_b32 v25, 0xf149f2ca
    v_mov_b32 v26, 0xf149f2ca
    v_mov_b32 v27, 0xf149f2ca
    v_mov_b32 v28, 0xf149f2ca
    v_mov_b32 v29, 0xf149f2ca
    v_mov_b32 v30, 0xf149f2ca
    v_mov_b32 v31, 0xf149f2ca
    v_mov_b32 v32, 0xf149f2ca
    v_mov_b32 v33, 0xf149f2ca
    v_mov_b32 v34, 0xf149f2ca
    v_mov_b32 v35, 0xf149f2ca
    v_mov_b32 v36, 0xf149f2ca
    v_mov_b32 v37, 0xf149f2ca
    v_mov_b32 v38, 0xf149f2ca
    v_mov_b32 v39, 0xf149f2ca
ng_5:
    s_waitcnt lgkmcnt(2)
    s_nop 0
    v_mfma_f32_32x32x16_bf16 v[56:71], v[104:107], v[4:7], v[24:39]
    v_mfma_f32_32x32x16_bf16 v[56:71], v[108:111], v[8:11], v[56:71]
    s_nop 3
    v_max_f32 v21, v72, v73
    v_max3_f32 v21, v21, v74, v75
    v_max3_f32 v21, v21, v76, v77
    v_max3_f32 v21, v21, v78, v79
    v_max3_f32 v21, v21, v80, v81
    v_max3_f32 v21, v21, v82, v83
    v_max3_f32 v21, v21, v84, v85
    v_max3_f32 v21, v21, v86, v87
    ds_read_b128 v[104:107], v20 offset:16384
    ds_read_b128 v[108:111], v20 offset:17408
    s_cmp_eq_u32 s99, 2
    s_cbranch_scc0 ng_6
    v_mov_b32 v24, 0xf149f2ca
    v_mov_b32 v25, 0xf149f2ca
    v_mov_b32 v26, 0xf149f2ca
    v_mov_b32 v27, 0xf149f2ca
    v_mov_b32 v28, 0xf149f2ca
    v_mov_b32 v29, 0xf149f2ca
    v_mov_b32 v30, 0xf149f2ca
    v_mov_b32 v31, 0xf149f2ca
    v_mov_b32 v32, 0xf149f2ca
    v_mov_b32 v33, 0xf149f2ca
    v_mov_b32 v34, 0xf149f2ca
    v_mov_b32 v35, 0xf149f2ca
    v_mov_b32 v36, 0xf149f2ca
    v_mov_b32 v37, 0xf149f2ca
    v_mov_b32 v38, 0xf149f2ca
    v_mov_b32 v39, 0xf149f2ca
ng_6:
    s_waitcnt lgkmcnt(2)
    s_nop 0
    v_mfma_f32_32x32x16_bf16 v[72:87], v[112:115], v[4:7], v[24:39]
    v_mfma_f32_32x32x16_bf16 v[72:87], v[116:119], v[8:11], v[72:87]
    v_max3_f32 v21, v21, v56, v57
    v_max3_f32 v21, v21, v58, v59
    v_max3_f32 v21, v21, v60, v61
    v_max3_f32 v21, v21, v62, v63
    v_max3_f32 v21, v21, v64, v65
    v_max3_f32 v21, v21, v66, v67
    v_max3_f32 v21, v21, v68, v69
    v_max3_f32 v21, v21, v70, v71
    ds_read_b128 v[112:115], v20 offset:12288
    ds_read_b128 v[116:119], v20 offset:13312
    s_cmp_eq_u32 s99, 3
    s_cbranch_scc0 ng_7
    v_mov_b32 v24, 0xf149f2ca
    v_mov_b32 v25, 0xf149f2ca
    v_mov_b32 v26, 0xf149f2ca
    v_mov_b32 v27, 0xf149f2ca
    v_mov_b32 v28, 0xf149f2ca
    v_mov_b32 v29, 0xf149f2ca
    v_mov_b32 v30, 0xf149f2ca
    v_mov_b32 v31, 0xf149f2ca
    v_mov_b32 v32, 0xf149f2ca
    v_mov_b32 v33, 0xf149f2ca
    v_mov_b32 v34, 0xf149f2ca
    v_mov_b32 v35, 0xf149f2ca
    v_mov_b32 v36, 0xf149f2ca
    v_mov_b32 v37, 0xf149f2ca
    v_mov_b32 v38, 0xf149f2ca
    v_mov_b32 v39, 0xf149f2ca
ng_7:
    s_waitcnt lgkmcnt(2)
    s_nop 0
    v_mfma_f32_32x32x16_bf16 v[56:71], v[104:107], v[4:7], v[24:39]
    v_mfma_f32_32x32x16_bf16 v[56:71], v[108:111], v[8:11], v[56:71]
    v_max3_f32 v21, v21, v72, v73
    v_max3_f32 v21, v21, v74, v75
    v_max3_f32 v21, v21, v76, v77
    v_max3_f32 v21, v21, v78, v79
    v_max3_f32 v21, v21, v80, v81
    v_max3_f32 v21, v21, v82, v83
    v_max3_f32 v21, v21, v84, v85
    v_max3_f32 v21, v21, v86, v87
    ds_read_b128 v[104:107], v20 offset:8192
    ds_read_b128 v[108:111], v20 offset:9216
    s_cmp_eq_u32 s99, 4
    s_cbranch_scc0 ng_8
    v_mov_b32 v24, 0xf149f2ca
    v_mov_b32 v25, 0xf149f2ca
    v_mov_b32 v26, 0xf149f2ca
    v_mov_b32 v27, 0xf149f2ca
    v_mov_b32 v28, 0xf149f2ca
    v_mov_b32 v29, 0xf149f2ca
    v_mov_b32 v30, 0xf149f2ca
    v_mov_b32 v31, 0xf149f2ca
    v_mov_b32 v32, 0xf149f2ca
    v_mov_b32 v33, 0xf149f2ca
    v_mov_b32 v34, 0xf149f2ca
    v_mov_b32 v35, 0xf149f2ca
    v_mov_b32 v36, 0xf149f2ca
    v_mov_b32 v37, 0xf149f2ca
    v_mov_b32 v38, 0xf149f2ca
    v_mov_b32 v39, 0xf149f2ca
ng_8:
    s_waitcnt lgkmcnt(2)
    s_nop 0
    v_mfma_f32_32x32x16_bf16 v[72:87], v[112:115], v[4:7], v[24:39]
    v_mfma_f32_32x32x16_bf16 v[72:87], v[116:119], v[8:11], v[72:87]
    v_max3_f32 v21, v21, v56, v57
    v_max3_f32 v21, v21, v58, v59
    v_max3_f32 v21, v21, v60, v61
    v_max3_f32 v21, v21, v62, v63
    v_max3_f32 v21, v21, v64, v65
    v_max3_f32 v21, v21, v66, v67
    v_max3_f32 v21, v21, v68, v69
    v_max3_f32 v21, v21, v70, v71
    s_barrier
    s_add_u32 s96, s25, 0
    s_and_b32 s96, s96, 15
    s_lshl_b32 s96, s96, 17
    s_add_u32 m0, s101, 0
    s_nop 0
    buffer_load_dwordx4 v243, s[8:11], s96 offen lds
    ds_read_b128 v[112:115], v20 offset:4096
    ds_read_b128 v[116:119], v20 offset:5120
    s_cmp_eq_u32 s99, 5
    s_cbranch_scc0 ng_9
    v_mov_b32 v24, 0xf149f2ca
    v_mov_b32 v25, 0xf149f2ca
    v_mov_b32 v26, 0xf149f2ca
    v_mov_b32 v27, 0xf149f2ca
    v_mov_b32 v28, 0xf149f2ca
    v_mov_b32 v29, 0xf149f2ca
    v_mov_b32 v30, 0xf149f2ca
    v_mov_b32 v31, 0xf149f2ca
    v_mov_b32 v32, 0xf149f2ca
    v_mov_b32 v33, 0xf149f2ca
    v_mov_b32 v34, 0xf149f2ca
    v_mov_b32 v35, 0xf149f2ca
    v_mov_b32 v36, 0xf149f2ca
    v_mov_b32 v37, 0xf149f2ca
    v_mov_b32 v38, 0xf149f2ca
    v_mov_b32 v39, 0xf149f2ca
ng_9:
    s_waitcnt lgkmcnt(2)
    s_nop 0
    v_mfma_f32_32x32x16_bf16 v[56:71], v[104:107], v[4:7], v[24:39]
    v_mfma_f32_32x32x16_bf16 v[56:71], v[108:111], v[8:11], v[56:71]
    v_max3_f32 v21, v21, v72, v73
    v_max3_f32 v21, v21, v74, v75
    v_max3_f32 v21, v21, v76, v77
    v_max3_f32 v21, v21, v78, v79
    v_max3_f32 v21, v21, v80, v81
    v_max3_f32 v21, v21, v82, v83
    v_max3_f32 v21, v21, v84, v85
    v_max3_f32 v21, v21, v86, v87
    s_add_u32 s96, s25, 12
    s_and_b32 s96, s96, 15
    s_lshl_b32 s96, s96, 17
    s_add_u32 m0, s101, 49152
    s_nop 0
    buffer_load_dwordx4 v243, s[8:11], s96 offen lds
    ds_read_b128 v[104:107], v20 offset:0
    ds_read_b128 v[108:111], v20 offset:1024
    s_cmp_eq_u32 s99, 6
    s_cbranch_scc0 ng_10
    v_mov_b32 v24, 0xf149f2ca
    v_mov_b32 v25, 0xf149f2ca
    v_mov_b32 v26, 0xf149f2ca
    v_mov_b32 v27, 0xf149f2ca
    v_mov_b32 v28, 0xf149f2ca
    v_mov_b32 v29, 0xf149f2ca
    v_mov_b32 v30, 0xf149f2ca
    v_mov_b32 v31, 0xf149f2ca
    v_mov_b32 v32, 0xf149f2ca
    v_mov_b32 v33, 0xf149f2ca
    v_mov_b32 v34, 0xf149f2ca
    v_mov_b32 v35, 0xf149f2ca
    v_mov_b32 v36, 0xf149f2ca
    v_mov_b32 v37, 0xf149f2ca
    v_mov_b32 v38, 0xf149f2ca
    v_mov_b32 v39, 0xf149f2ca
ng_10:
    s_waitcnt lgkmcnt(2)
    s_nop 0
    v_mfma_f32_32x32x16_bf16 v[72:87], v[112:115], v[4:7], v[24:39]
    v_mfma_f32_32x32x16_bf16 v[72:87], v[116:119], v[8:11], v[72:87]
    v_max3_f32 v21, v21, v56, v57
    v_max3_f32 v21, v21, v58, v59
    v_max3_f32 v21, v21, v60, v61
    v_max3_f32 v21, v21, v62, v63
    v_max3_f32 v21, v21, v64, v65
    v_max3_f32 v21, v21, v66, v67
    v_max3_f32 v21, v21, v68, v69
    v_max3_f32 v21, v21, v70, v71
    s_add_u32 s96, s25, 13
    s_and_b32 s96, s96, 15
    s_lshl_b32 s96, s96, 17
    s_add_u32 m0, s101, 53248
    s_nop 0
    buffer_load_dwordx4 v243, s[8:11], s96 offen lds
    s_cmp_eq_u32 s99, 7
    s_cbranch_scc0 ng_11
    v_mov_b32 v24, 0xf149f2ca
    v_mov_b32 v25, 0xf149f2ca
    v_mov_b32 v26, 0xf149f2ca
    v_mov_b32 v27, 0xf149f2ca
    v_mov_b32 v28, 0xf149f2ca
    v_mov_b32 v29, 0xf149f2ca
    v_mov_b32 v30, 0xf149f2ca
    v_mov_b32 v31, 0xf149f2ca
    v_mov_b32 v32, 0xf149f2ca
    v_mov_b32 v33, 0xf149f2ca
    v_mov_b32 v34, 0xf149f2ca
    v_mov_b32 v35, 0xf149f2ca
    v_mov_b32 v36, 0xf149f2ca
    v_mov_b32 v37, 0xf149f2ca
    v_mov_b32 v38, 0xf149f2ca
    v_mov_b32 v39, 0xf149f2ca
ng_11:
    s_waitcnt lgkmcnt(0)
    s_nop 0
    v_mfma_f32_32x32x16_bf16 v[56:71], v[104:107], v[4:7], v[24:39]
    v_mfma_f32_32x32x16_bf16 v[56:71], v[108:111], v[8:11], v[56:71]
    v_max3_f32 v21, v21, v72, v73
    v_max3_f32 v21, v21, v74, v75
    v_max3_f32 v21, v21, v76, v77
    v_max3_f32 v21, v21, v78, v79
    v_max3_f32 v21, v21, v80, v81
    v_max3_f32 v21, v21, v82, v83
    v_max3_f32 v21, v21, v84, v85
    v_max3_f32 v21, v21, v86, v87
    s_add_u32 s96, s25, 14
    s_and_b32 s96, s96, 15
    s_lshl_b32 s96, s96, 17
    s_add_u32 m0, s101, 57344
    s_nop 0
    buffer_load_dwordx4 v243, s[8:11], s96 offen lds
    ds_read_b128 v[112:115], v20 offset:28672
    ds_read_b128 v[116:119], v20 offset:29696
    ds_read_b128 v[120:123], v20 offset:34816
    ds_read_b128 v[124:127], v20 offset:35840
    ds_read_b128 v[128:131], v20 offset:2048
    ds_read_b128 v[132:135], v20 offset:3072
    v_cndmask_b32 v40, v56, v40, s[40:41]
    v_cndmask_b32 v41, v57, v41, s[42:43]
    v_cndmask_b32 v42, v58, v42, s[44:45]
    v_cndmask_b32 v43, v59, v43, s[46:47]
    v_cndmask_b32 v44, v60, v44, s[48:49]
    v_cndmask_b32 v45, v61, v45, s[50:51]
    v_cndmask_b32 v46, v62, v46, s[52:53]
    v_cndmask_b32 v47, v63, v47, s[54:55]
    v_cndmask_b32 v48, v64, v48, s[56:57]
    v_cndmask_b32 v49, v65, v49, s[58:59]
    v_cndmask_b32 v50, v66, v50, s[60:61]
    v_cndmask_b32 v51, v67, v51, s[62:63]
    v_cndmask_b32 v52, v68, v52, s[64:65]
    v_cndmask_b32 v53, v69, v53, s[66:67]
    v_cndmask_b32 v54, v70, v54, s[68:69]
    v_cndmask_b32 v55, v71, v55, s[70:71]
    v_max3_f32 v21, v21, v40, v41
    v_max3_f32 v21, v21, v42, v43
    v_max3_f32 v21, v21, v44, v45
    v_max3_f32 v21, v21, v46, v47
    v_max3_f32 v21, v21, v48, v49
    v_max3_f32 v21, v21, v50, v51
    v_max3_f32 v21, v21, v52, v53
    v_max3_f32 v21, v21, v54, v55
    v_mov_b32 v152, v21
    s_nop 1
    v_permlane32_swap_b32 v21, v152
    v_max_f32 v21, v21, v152
    v_sub_f32 v24, 0, v21
    v_sub_f32 v25, 0, v21
    v_sub_f32 v26, 0, v21
    v_sub_f32 v27, 0, v21
    v_sub_f32 v28, 0, v21
    v_sub_f32 v29, 0, v21
    v_sub_f32 v30, 0, v21
    v_sub_f32 v31, 0, v21
    v_sub_f32 v32, 0, v21
    v_sub_f32 v33, 0, v21
    v_sub_f32 v34, 0, v21
    v_sub_f32 v35, 0, v21
    v_sub_f32 v36, 0, v21
    v_sub_f32 v37, 0, v21
    v_sub_f32 v38, 0, v21
    v_sub_f32 v39, 0, v21
    s_cmp_eq_u32 s99, 0
    s_cbranch_scc0 ng_12
    v_mov_b32 v24, 0xf149f2ca
    v_mov_b32 v25, 0xf149f2ca
    v_mov_b32 v26, 0xf149f2ca
    v_mov_b32 v27, 0xf149f2ca
    v_mov_b32 v28, 0xf149f2ca
    v_mov_b32 v29, 0xf149f2ca
    v_mov_b32 v30, 0xf149f2ca
    v_mov_b32 v31, 0xf149f2ca
    v_mov_b32 v32, 0xf149f2ca
    v_mov_b32 v33, 0xf149f2ca
    v_mov_b32 v34, 0xf149f2ca
    v_mov_b32 v35, 0xf149f2ca
    v_mov_b32 v36, 0xf149f2ca
    v_mov_b32 v37, 0xf149f2ca
    v_mov_b32 v38, 0xf149f2ca
    v_mov_b32 v39, 0xf149f2ca
ng_12:
    s_waitcnt lgkmcnt(4)
    s_nop 0
    v_mfma_f32_32x32x16_bf16 v[72:87], v[112:115], v[4:7], v[24:39]
    v_mfma_f32_32x32x16_bf16 v[72:87], v[116:119], v[8:11], v[72:87]
    ds_read_b128 v[104:107], v20 offset:24576
    ds_read_b128 v[108:111], v20 offset:25600
    v_sub_f32 v40, v40, v21
    v_sub_f32 v41, v41, v21
    v_sub_f32 v42, v42, v21
    v_sub_f32 v43, v43, v21
    v_sub_f32 v44, v44, v21
    v_sub_f32 v45, v45, v21
    v_sub_f32 v46, v46, v21
    v_sub_f32 v47, v47, v21
    v_sub_f32 v48, v48, v21
    v_sub_f32 v49, v49, v21
    v_sub_f32 v50, v50, v21
    v_sub_f32 v51, v51, v21
    v_sub_f32 v52, v52, v21
    v_sub_f32 v53, v53, v21
    v_sub_f32 v54, v54, v21
    v_sub_f32 v55, v55, v21
    v_exp_f32 v40, v40
    v_exp_f32 v41, v41
    v_exp_f32 v42, v42
    v_exp_f32 v43, v43
    v_exp_f32 v44, v44
    v_exp_f32 v45, v45
    v_exp_f32 v46, v46
    v_exp_f32 v47, v47
    v_exp_f32 v48, v48
    v_exp_f32 v49, v49
    v_exp_f32 v50, v50
    v_exp_f32 v51, v51
    v_exp_f32 v52, v52
    v_exp_f32 v53, v53
    v_exp_f32 v54, v54
    v_exp_f32 v55, v55
    v_add_f32 v22, v40, v41
    v_add_f32 v23, v42, v43
    v_add_f32 v22, v22, v44
    v_add_f32 v23, v23, v45
    v_add_f32 v22, v22, v46
    v_add_f32 v23, v23, v47
    v_add_f32 v22, v22, v48
    v_add_f32 v23, v23, v49
    v_add_f32 v22, v22, v50
    v_add_f32 v23, v23, v51
    v_add_f32 v22, v22, v52
    v_add_f32 v23, v23, v53
    v_add_f32 v22, v22, v54
    v_add_f32 v23, v23, v55
    v_cvt_pk_bf16_f32 v144, v40, v41
    v_cvt_pk_bf16_f32 v145, v42, v43
    v_cvt_pk_bf16_f32 v146, v44, v45
    v_cvt_pk_bf16_f32 v147, v46, v47
    v_cvt_pk_bf16_f32 v148, v48, v49
    v_cvt_pk_bf16_f32 v149, v50, v51
    v_cvt_pk_bf16_f32 v150, v52, v53
    v_cvt_pk_bf16_f32 v151, v54, v55
    v_and_b32 v136, v144, v12
    v_and_b32 v137, v145, v13
    v_and_b32 v138, v146, v14
    v_and_b32 v139, v147, v15
    v_and_b32 v140, v148, v16
    v_and_b32 v141, v149, v17
    v_and_b32 v142, v150, v18
    v_and_b32 v143, v151, v19
    v_xor_b32 v144, v144, v136
    v_xor_b32 v145, v145, v137
    v_xor_b32 v146, v146, v138
    v_xor_b32 v147, v147, v139
    v_xor_b32 v148, v148, v140
    v_xor_b32 v149, v149, v141
    v_xor_b32 v150, v150, v142
    v_xor_b32 v151, v151, v143
    s_waitcnt lgkmcnt(2)
    v_mfma_f32_32x32x16_bf16 v[88:103], v[120:123], v[136:139], 0
    v_mfma_f32_32x32x16_bf16 v[88:103], v[124:127], v[140:143], v[88:103]
    v_mfma_f32_32x32x16_bf16 v[88:103], v[128:131], v[144:147], v[88:103]
    v_mfma_f32_32x32x16_bf16 v[88:103], v[132:135], v[148:151], v[88:103]
    s_add_u32 s96, s25, 15
    s_and_b32 s96, s96, 15
    s_lshl_b32 s96, s96, 17
    s_add_u32 m0, s101, 61440
    s_nop 0
    buffer_load_dwordx4 v243, s[8:11], s96 offen lds
    ds_read_b128 v[128:131], v20 offset:30720
    ds_read_b128 v[132:135], v20 offset:31744
    s_cmp_eq_u32 s99, 1
    s_cbranch_scc0 ng_13
    v_mov_b32 v24, 0xf149f2ca
    v_mov_b32 v25, 0xf149f2ca
    v_mov_b32 v26, 0xf149f2ca
    v_mov_b32 v27, 0xf149f2ca
    v_mov_b32 v28, 0xf149f2ca
    v_mov_b32 v29, 0xf149f2ca
    v_mov_b32 v30, 0xf149f2ca
    v_mov_b32 v31, 0xf149f2ca
    v_mov_b32 v32, 0xf149f2ca
    v_mov_b32 v33, 0xf149f2ca
    v_mov_b32 v34, 0xf149f2ca
    v_mov_b32 v35, 0xf149f2ca
    v_mov_b32 v36, 0xf149f2ca
    v_mov_b32 v37, 0xf149f2ca
    v_mov_b32 v38, 0xf149f2ca
    v_mov_b32 v39, 0xf149f2ca
ng_13:
    s_waitcnt lgkmcnt(2)
    s_nop 0
    v_mfma_f32_32x32x16_bf16 v[56:71], v[104:107], v[4:7], v[24:39]
    v_mfma_f32_32x32x16_bf16 v[56:71], v[108:111], v[8:11], v[56:71]
    ds_read_b128 v[112:115], v20 offset:20480
    ds_read_b128 v[116:119], v20 offset:21504
    v_exp_f32 v72, v72
    v_exp_f32 v73, v73
    v_exp_f32 v74, v74
    v_exp_f32 v75, v75
    v_exp_f32 v76, v76
    v_exp_f32 v77, v77
    v_exp_f32 v78, v78
    v_exp_f32 v79, v79
    v_exp_f32 v80, v80
    v_exp_f32 v81, v81
    v_exp_f32 v82, v82
    v_exp_f32 v83, v83
    v_exp_f32 v84, v84
    v_exp_f32 v85, v85
    v_exp_f32 v86, v86
    v_exp_f32 v87, v87
    v_add_f32 v22, v22, v72
    v_add_f32 v23, v23, v73
    v_add_f32 v22, v22, v74
    v_add_f32 v23, v23, v75
    v_add_f32 v22, v22, v76
    v_add_f32 v23, v23, v77
    v_add_f32 v22, v22, v78
    v_add_f32 v23, v23, v79
    v_add_f32 v22, v22, v80
    v_add_f32 v23, v23, v81
    v_add_f32 v22, v22, v82
    v_add_f32 v23, v23, v83
    v_add_f32 v22, v22, v84
    v_add_f32 v23, v23, v85
    v_add_f32 v22, v22, v86
    v_add_f32 v23, v23, v87
    v_cvt_pk_bf16_f32 v144, v72, v73
    v_cvt_pk_bf16_f32 v145, v74, v75
    v_cvt_pk_bf16_f32 v146, v76, v77
    v_cvt_pk_bf16_f32 v147, v78, v79
    v_cvt_pk_bf16_f32 v148, v80, v81
    v_cvt_pk_bf16_f32 v149, v82, v83
    v_cvt_pk_bf16_f32 v150, v84, v85
    v_cvt_pk_bf16_f32 v151, v86, v87
    s_waitcnt lgkmcnt(2)
    v_mfma_f32_32x32x16_bf16 v[88:103], v[128:131], v[144:147], v[88:103]
    v_mfma_f32_32x32x16_bf16 v[88:103], v[132:135], v[148:151], v[88:103]
    ds_read_b128 v[120:123], v20 offset:26624
    ds_read_b128 v[124:127], v20 offset:27648
    s_cmp_eq_u32 s99, 2
    s_cbranch_scc0 ng_14
    v_mov_b32 v24, 0xf149f2ca
    v_mov_b32 v25, 0xf149f2ca
    v_mov_b32 v26, 0xf149f2ca
    v_mov_b32 v27, 0xf149f2ca
    v_mov_b32 v28, 0xf149f2ca
    v_mov_b32 v29, 0xf149f2ca
    v_mov_b32 v30, 0xf149f2ca
    v_mov_b32 v31, 0xf149f2ca
    v_mov_b32 v32, 0xf149f2ca
    v_mov_b32 v33, 0xf149f2ca
    v_mov_b32 v34, 0xf149f2ca
    v_mov_b32 v35, 0xf149f2ca
    v_mov_b32 v36, 0xf149f2ca
    v_mov_b32 v37, 0xf149f2ca
    v_mov_b32 v38, 0xf149f2ca
    v_mov_b32 v39, 0xf149f2ca
ng_14:
    s_waitcnt lgkmcnt(2)
    s_nop 0
    v_mfma_f32_32x32x16_bf16 v[72:87], v[112:115], v[4:7], v[24:39]
    v_mfma_f32_32x32x16_bf16 v[72:87], v[116:119], v[8:11], v[72:87]
    ds_read_b128 v[104:107], v20 offset:16384
    ds_read_b128 v[108:111], v20 offset:17408
    v_exp_f32 v56, v56
    v_exp_f32 v57, v57
    v_exp_f32 v58, v58
    v_exp_f32 v59, v59
    v_exp_f32 v60, v60
    v_exp_f32 v61, v61
    v_exp_f32 v62, v62
    v_exp_f32 v63, v63
    v_exp_f32 v64, v64
    v_exp_f32 v65, v65
    v_exp_f32 v66, v66
    v_exp_f32 v67, v67
    v_exp_f32 v68, v68
    v_exp_f32 v69, v69
    v_exp_f32 v70, v70
    v_exp_f32 v71, v71
    v_add_f32 v22, v22, v56
    v_add_f32 v23, v23, v57
    v_add_f32 v22, v22, v58
    v_add_f32 v23, v23, v59
    v_add_f32 v22, v22, v60
    v_add_f32 v23, v23, v61
    v_add_f32 v22, v22, v62
    v_add_f32 v23, v23, v63
    v_add_f32 v22, v22, v64
    v_add_f32 v23, v23, v65
    v_add_f32 v22, v22, v66
    v_add_f32 v23, v23, v67
    v_add_f32 v22, v22, v68
    v_add_f32 v23, v23, v69
    v_add_f32 v22, v22, v70
    v_add_f32 v23, v23, v71
    v_cvt_pk_bf16_f32 v136, v56, v57
    v_cvt_pk_bf16_f32 v137, v58, v59
    v_cvt_pk_bf16_f32 v138, v60, v61
    v_cvt_pk_bf16_f32 v139, v62, v63
    v_cvt_pk_bf16_f32 v140, v64, v65
    v_cvt_pk_bf16_f32 v141, v66, v67
    v_cvt_pk_bf16_f32 v142, v68, v69
    v_cvt_pk_bf16_f32 v143, v70, v71
    s_waitcnt lgkmcnt(2)
    v_mfma_f32_32x32x16_bf16 v[88:103], v[120:123], v[136:139], v[88:103]
    v_mfma_f32_32x32x16_bf16 v[88:103], v[124:127], v[140:143], v[88:103]
    ds_read_b128 v[128:131], v20 offset:22528
    ds_read_b128 v[132:135], v20 offset:23552
    s_cmp_eq_u32 s99, 3
    s_cbranch_scc0 ng_15
    v_mov_b32 v24, 0xf149f2ca
    v_mov_b32 v25, 0xf149f2ca
    v_mov_b32 v26, 0xf149f2ca
    v_mov_b32 v27, 0xf149f2ca
    v_mov_b32 v28, 0xf149f2ca
    v_mov_b32 v29, 0xf149f2ca
    v_mov_b32 v30, 0xf149f2ca
    v_mov_b32 v31, 0xf149f2ca
    v_mov_b32 v32, 0xf149f2ca
    v_mov_b32 v33, 0xf149f2ca
    v_mov_b32 v34, 0xf149f2ca
    v_mov_b32 v35, 0xf149f2ca
    v_mov_b32 v36, 0xf149f2ca
    v_mov_b32 v37, 0xf149f2ca
    v_mov_b32 v38, 0xf149f2ca
    v_mov_b32 v39, 0xf149f2ca
ng_15:
    s_waitcnt lgkmcnt(2)
    s_nop 0
    v_mfma_f32_32x32x16_bf16 v[56:71], v[104:107], v[4:7], v[24:39]
    v_mfma_f32_32x32x16_bf16 v[56:71], v[108:111], v[8:11], v[56:71]
    ds_read_b128 v[112:115], v20 offset:12288
    ds_read_b128 v[116:119], v20 offset:13312
    v_exp_f32 v72, v72
    v_exp_f32 v73, v73
    v_exp_f32 v74, v74
    v_exp_f32 v75, v75
    v_exp_f32 v76, v76
    v_exp_f32 v77, v77
    v_exp_f32 v78, v78
    v_exp_f32 v79, v79
    v_exp_f32 v80, v80
    v_exp_f32 v81, v81
    v_exp_f32 v82, v82
    v_exp_f32 v83, v83
    v_exp_f32 v84, v84
    v_exp_f32 v85, v85
    v_exp_f32 v86, v86
    v_exp_f32 v87, v87
    v_add_f32 v22, v22, v72
    v_add_f32 v23, v23, v73
    v_add_f32 v22, v22, v74
    v_add_f32 v23, v23, v75
    v_add_f32 v22, v22, v76
    v_add_f32 v23, v23, v77
    v_add_f32 v22, v22, v78
    v_add_f32 v23, v23, v79
    v_add_f32 v22, v22, v80
    v_add_f32 v23, v23, v81
    v_add_f32 v22, v22, v82
    v_add_f32 v23, v23, v83
    v_add_f32 v22, v22, v84
    v_add_f32 v23, v23, v85
    v_add_f32 v22, v22, v86
    v_add_f32 v23, v23, v87
    v_cvt_pk_bf16_f32 v144, v72, v73
    v_cvt_pk_bf16_f32 v145, v74, v75
    v_cvt_pk_bf16_f32 v146, v76, v77
    v_cvt_pk_bf16_f32 v147, v78, v79
    v_cvt_pk_bf16_f32 v148, v80, v81
    v_cvt_pk_bf16_f32 v149, v82, v83
    v_cvt_pk_bf16_f32 v150, v84, v85
    v_cvt_pk_bf16_f32 v151, v86, v87
    s_waitcnt lgkmcnt(2)
    v_mfma_f32_32x32x16_bf16 v[88:103], v[128:131], v[144:147], v[88:103]
    v_mfma_f32_32x32x16_bf16 v[88:103], v[132:135], v[148:151], v[88:103]
    ds_read_b128 v[120:123], v20 offset:18432
    ds_read_b128 v[124:127], v20 offset:19456
    s_cmp_eq_u32 s99, 4
    s_cbranch_scc0 ng_16
    v_mov_b32 v24, 0xf149f2ca
    v_mov_b32 v25, 0xf149f2ca
    v_mov_b32 v26, 0xf149f2ca
    v_mov_b32 v27, 0xf149f2ca
    v_mov_b32 v28, 0xf149f2ca
    v_mov_b32 v29, 0xf149f2ca
    v_mov_b32 v30, 0xf149f2ca
    v_mov_b32 v31, 0xf149f2ca
    v_mov_b32 v32, 0xf149f2ca
    v_mov_b32 v33, 0xf149f2ca
    v_mov_b32 v34, 0xf149f2ca
    v_mov_b32 v35, 0xf149f2ca
    v_mov_b32 v36, 0xf149f2ca
    v_mov_b32 v37, 0xf149f2ca
    v_mov_b32 v38, 0xf149f2ca
    v_mov_b32 v39, 0xf149f2ca
ng_16:
    s_waitcnt lgkmcnt(2)
    s_nop 0
    v_mfma_f32_32x32x16_bf16 v[72:87], v[112:115], v[4:7], v[24:39]
    v_mfma_f32_32x32x16_bf16 v[72:87], v[116:119], v[8:11], v[72:87]
    ds_read_b128 v[104:107], v20 offset:8192
    ds_read_b128 v[108:111], v20 offset:9216
    v_exp_f32 v56, v56
    v_exp_f32 v57, v57
    v_exp_f32 v58, v58
    v_exp_f32 v59, v59
    v_exp_f32 v60, v60
    v_exp_f32 v61, v61
    v_exp_f32 v62, v62
    v_exp_f32 v63, v63
    v_exp_f32 v64, v64
    v_exp_f32 v65, v65
    v_exp_f32 v66, v66
    v_exp_f32 v67, v67
    v_exp_f32 v68, v68
    v_exp_f32 v69, v69
    v_exp_f32 v70, v70
    v_exp_f32 v71, v71
    v_add_f32 v22, v22, v56
    v_add_f32 v23, v23, v57
    v_add_f32 v22, v22, v58
    v_add_f32 v23, v23, v59
    v_add_f32 v22, v22, v60
    v_add_f32 v23, v23, v61
    v_add_f32 v22, v22, v62
    v_add_f32 v23, v23, v63
    v_add_f32 v22, v22, v64
    v_add_f32 v23, v23, v65
    v_add_f32 v22, v22, v66
    v_add_f32 v23, v23, v67
    v_add_f32 v22, v22, v68
    v_add_f32 v23, v23, v69
    v_add_f32 v22, v22, v70
    v_add_f32 v23, v23, v71
    v_cvt_pk_bf16_f32 v136, v56, v57
    v_cvt_pk_bf16_f32 v137, v58, v59
    v_cvt_pk_bf16_f32 v138, v60, v61
    v_cvt_pk_bf16_f32 v139, v62, v63
    v_cvt_pk_bf16_f32 v140, v64, v65
    v_cvt_pk_bf16_f32 v141, v66, v67
    v_cvt_pk_bf16_f32 v142, v68, v69
    v_cvt_pk_bf16_f32 v143, v70, v71
    s_waitcnt lgkmcnt(2)
    v_mfma_f32_32x32x16_bf16 v[88:103], v[120:123], v[136:139], v[88:103]
    v_mfma_f32_32x32x16_bf16 v[88:103], v[124:127], v[140:143], v[88:103]
    ds_read_b128 v[128:131], v20 offset:14336
    ds_read_b128 v[132:135], v20 offset:15360
    s_cmp_eq_u32 s99, 5
    s_cbranch_scc0 ng_17
    v_mov_b32 v24, 0xf149f2ca
    v_mov_b32 v25, 0xf149f2ca
    v_mov_b32 v26, 0xf149f2ca
    v_mov_b32 v27, 0xf149f2ca
    v_mov_b32 v28, 0xf149f2ca
    v_mov_b32 v29, 0xf149f2ca
    v_mov_b32 v30, 0xf149f2ca
    v_mov_b32 v31, 0xf149f2ca
    v_mov_b32 v32, 0xf149f2ca
    v_mov_b32 v33, 0xf149f2ca
    v_mov_b32 v34, 0xf149f2ca
    v_mov_b32 v35, 0xf149f2ca
    v_mov_b32 v36, 0xf149f2ca
    v_mov_b32 v37, 0xf149f2ca
    v_mov_b32 v38, 0xf149f2ca
    v_mov_b32 v39, 0xf149f2ca
ng_17:
    s_waitcnt lgkmcnt(2)
    s_nop 0
    v_mfma_f32_32x32x16_bf16 v[56:71], v[104:107], v[4:7], v[24:39]
    v_mfma_f32_32x32x16_bf16 v[56:71], v[108:111], v[8:11], v[56:71]
    ds_read_b128 v[112:115], v20 offset:4096
    ds_read_b128 v[116:119], v20 offset:5120
    v_exp_f32 v72, v72
    v_exp_f32 v73, v73
    v_exp_f32 v74, v74
    v_exp_f32 v75, v75
    v_exp_f32 v76, v76
    v_exp_f32 v77, v77
    v_exp_f32 v78, v78
    v_exp_f32 v79, v79
    v_exp_f32 v80, v80
    v_exp_f32 v81, v81
    v_exp_f32 v82, v82
    v_exp_f32 v83, v83
    v_exp_f32 v84, v84
    v_exp_f32 v85, v85
    v_exp_f32 v86, v86
    v_exp_f32 v87, v87
    v_add_f32 v22, v22, v72
    v_add_f32 v23, v23, v73
    v_add_f32 v22, v22, v74
    v_add_f32 v23, v23, v75
    v_add_f32 v22, v22, v76
    v_add_f32 v23, v23, v77
    v_add_f32 v22, v22, v78
    v_add_f32 v23, v23, v79
    v_add_f32 v22, v22, v80
    v_add_f32 v23, v23, v81
    v_add_f32 v22, v22, v82
    v_add_f32 v23, v23, v83
    v_add_f32 v22, v22, v84
    v_add_f32 v23, v23, v85
    v_add_f32 v22, v22, v86
    v_add_f32 v23, v23, v87
    v_cvt_pk_bf16_f32 v144, v72, v73
    v_cvt_pk_bf16_f32 v145, v74, v75
    v_cvt_pk_bf16_f32 v146, v76, v77
    v_cvt_pk_bf16_f32 v147, v78, v79
    v_cvt_pk_bf16_f32 v148, v80, v81
    v_cvt_pk_bf16_f32 v149, v82, v83
    v_cvt_pk_bf16_f32 v150, v84, v85
    v_cvt_pk_bf16_f32 v151, v86, v87
    s_waitcnt lgkmcnt(2)
    v_mfma_f32_32x32x16_bf16 v[88:103], v[128:131], v[144:147], v[88:103]
    v_mfma_f32_32x32x16_bf16 v[88:103], v[132:135], v[148:151], v[88:103]
    ds_read_b128 v[120:123], v20 offset:10240
    ds_read_b128 v[124:127], v20 offset:11264
    s_cmp_eq_u32 s99, 6
    s_cbranch_scc0 ng_18
    v_mov_b32 v24, 0xf149f2ca
    v_mov_b32 v25, 0xf149f2ca
    v_mov_b32 v26, 0xf149f2ca
    v_mov_b32 v27, 0xf149f2ca
    v_mov_b32 v28, 0xf149f2ca
    v_mov_b32 v29, 0xf149f2ca
    v_mov_b32 v30, 0xf149f2ca
    v_mov_b32 v31, 0xf149f2ca
    v_mov_b32 v32, 0xf149f2ca
    v_mov_b32 v33, 0xf149f2ca
    v_mov_b32 v34, 0xf149f2ca
    v_mov_b32 v35, 0xf149f2ca
    v_mov_b32 v36, 0xf149f2ca
    v_mov_b32 v37, 0xf149f2ca
    v_mov_b32 v38, 0xf149f2ca
    v_mov_b32 v39, 0xf149f2ca
ng_18:
    s_waitcnt lgkmcnt(2)
    s_nop 0
    v_mfma_f32_32x32x16_bf16 v[72:87], v[112:115], v[4:7], v[24:39]
    v_mfma_f32_32x32x16_bf16 v[72:87], v[116:119], v[8:11], v[72:87]
    v_exp_f32 v56, v56
    v_exp_f32 v57, v57
    v_exp_f32 v58, v58
    v_exp_f32 v59, v59
    v_exp_f32 v60, v60
    v_exp_f32 v61, v61
    v_exp_f32 v62, v62
    v_exp_f32 v63, v63
    v_exp_f32 v64, v64
    v_exp_f32 v65, v65
    v_exp_f32 v66, v66
    v_exp_f32 v67, v67
    v_exp_f32 v68, v68
    v_exp_f32 v69, v69
    v_exp_f32 v70, v70
    v_exp_f32 v71, v71
    v_add_f32 v22, v22, v56
    v_add_f32 v23, v23, v57
    v_add_f32 v22, v22, v58
    v_add_f32 v23, v23, v59
    v_add_f32 v22, v22, v60
    v_add_f32 v23, v23, v61
    v_add_f32 v22, v22, v62
    v_add_f32 v23, v23, v63
    v_add_f32 v22, v22, v64
    v_add_f32 v23, v23, v65
    v_add_f32 v22, v22, v66
    v_add_f32 v23, v23, v67
    v_add_f32 v22, v22, v68
    v_add_f32 v23, v23, v69
    v_add_f32 v22, v22, v70
    v_add_f32 v23, v23, v71
    v_cvt_pk_bf16_f32 v136, v56, v57
    v_cvt_pk_bf16_f32 v137, v58, v59
    v_cvt_pk_bf16_f32 v138, v60, v61
    v_cvt_pk_bf16_f32 v139, v62, v63
    v_cvt_pk_bf16_f32 v140, v64, v65
    v_cvt_pk_bf16_f32 v141, v66, v67
    v_cvt_pk_bf16_f32 v142, v68, v69
    v_cvt_pk_bf16_f32 v143, v70, v71
    s_waitcnt lgkmcnt(0)
    v_mfma_f32_32x32x16_bf16 v[88:103], v[120:123], v[136:139], v[88:103]
    v_mfma_f32_32x32x16_bf16 v[88:103], v[124:127], v[140:143], v[88:103]
    ds_read_b128 v[128:131], v20 offset:6144
    ds_read_b128 v[132:135], v20 offset:7168
    v_exp_f32 v72, v72
    v_exp_f32 v73, v73
    v_exp_f32 v74, v74
    v_exp_f32 v75, v75
    v_exp_f32 v76, v76
    v_exp_f32 v77, v77
    v_exp_f32 v78, v78
    v_exp_f32 v79, v79
    v_exp_f32 v80, v80
    v_exp_f32 v81, v81
    v_exp_f32 v82, v82
    v_exp_f32 v83, v83
    v_exp_f32 v84, v84
    v_exp_f32 v85, v85
    v_exp_f32 v86, v86
    v_exp_f32 v87, v87
    v_add_f32 v22, v22, v72
    v_add_f32 v23, v23, v73
    v_add_f32 v22, v22, v74
    v_add_f32 v23, v23, v75
    v_add_f32 v22, v22, v76
    v_add_f32 v23, v23, v77
    v_add_f32 v22, v22, v78
    v_add_f32 v23, v23, v79
    v_add_f32 v22, v22, v80
    v_add_f32 v23, v23, v81
    v_add_f32 v22, v22, v82
    v_add_f32 v23, v23, v83
    v_add_f32 v22, v22, v84
    v_add_f32 v23, v23, v85
    v_add_f32 v22, v22, v86
    v_add_f32 v23, v23, v87
    v_cvt_pk_bf16_f32 v144, v72, v73
    v_cvt_pk_bf16_f32 v145, v74, v75
    v_cvt_pk_bf16_f32 v146, v76, v77
    v_cvt_pk_bf16_f32 v147, v78, v79
    v_cvt_pk_bf16_f32 v148, v80, v81
    v_cvt_pk_bf16_f32 v149, v82, v83
    v_cvt_pk_bf16_f32 v150, v84, v85
    v_cvt_pk_bf16_f32 v151, v86, v87
    s_waitcnt lgkmcnt(0)
    v_mfma_f32_32x32x16_bf16 v[88:103], v[128:131], v[144:147], v[88:103]
    v_mfma_f32_32x32x16_bf16 v[88:103], v[132:135], v[148:151], v[88:103]
    v_add_f32 v22, v22, v23
    v_mov_b32 v152, v22
    s_nop 1
    v_permlane32_swap_b32 v22, v152
    v_add_f32 v22, v22, v152
    v_rcp_f32 v22, v22
    s_lshl_b32 s36, s99, 16
    s_add_u32 s36, s36, s26
    s_add_u32 s36, s36, 0x800000
    s_lshl_b32 s33, s25, 11
    s_add_u32 s33, s33, s36
    s_lshl_b32 s30, s24, 9
    s_lshl_b32 s31, s3, 6
    s_add_u32 s30, s30, s31
    s_add_u32 s30, s30, s26
    s_add_u32 s30, s30, 0xdc2000
    s_lshl_b32 s31, s25, 2
    s_add_u32 s31, s31, s30
    v_pk_mul_f32 v[88:89], v[88:89], v[22:23] op_sel_hi:[1,0]
    v_pk_mul_f32 v[90:91], v[90:91], v[22:23] op_sel_hi:[1,0]
    v_pk_mul_f32 v[92:93], v[92:93], v[22:23] op_sel_hi:[1,0]
    v_pk_mul_f32 v[94:95], v[94:95], v[22:23] op_sel_hi:[1,0]
    v_pk_mul_f32 v[96:97], v[96:97], v[22:23] op_sel_hi:[1,0]
    v_pk_mul_f32 v[98:99], v[98:99], v[22:23] op_sel_hi:[1,0]
    v_pk_mul_f32 v[100:101], v[100:101], v[22:23] op_sel_hi:[1,0]
    v_pk_mul_f32 v[102:103], v[102:103], v[22:23] op_sel_hi:[1,0]
    v_cvt_pk_bf16_f32 v88, v88, v89
    v_cvt_pk_bf16_f32 v89, v90, v91
    v_cvt_pk_bf16_f32 v90, v92, v93
    v_cvt_pk_bf16_f32 v91, v94, v95
    v_cvt_pk_bf16_f32 v92, v96, v97
    v_cvt_pk_bf16_f32 v93, v98, v99
    v_cvt_pk_bf16_f32 v94, v100, v101
    v_cvt_pk_bf16_f32 v95, v102, v103
    s_cmp_lg_u32 s77, 0
    s_cbranch_scc1 lc_19
    buffer_store_dwordx4 v[88:91], v253, s[20:23], s33 offen sc1
    buffer_store_dwordx4 v[92:95], v253, s[20:23], s33 offen offset:1024 sc1
    s_branch lc_20
lc_19:
    buffer_store_dwordx4 v[88:91], v253, s[20:23], s33 offen
    buffer_store_dwordx4 v[92:95], v253, s[20:23], s33 offen offset:1024
lc_20:
    v_bfe_u32 v33, v252, 2, 2
    v_lshrrev_b32 v32, 5, v252
    v_lshl_add_u32 v34, v32, 3, v33
    v_lshlrev_b32 v34, 7, v34
    v_lshrrev_b32 v33, 1, v33
    v_lshl_add_u32 v34, v33, 6, v34
    v_bfe_u32 v33, v252, 4, 1
    v_lshl_add_u32 v34, v33, 5, v34
    v_and_b32 v33, 3, v252
    v_lshl_add_u32 v56, v33, 3, v34
    v_xor_b32 v57, 64, v56
    v_add_u32 v58, 0x10000, v56
    v_add_u32 v59, 0x10000, v57
    v_and_b32 v60, 15, v252
    v_lshlrev_b32 v60, 2, v60
    s_waitcnt vmcnt(2)
    v_lshlrev_b32 v0, 16, v208
    v_and_b32 v1, 0xffff0000, v208
    v_lshlrev_b32 v2, 16, v209
    v_and_b32 v3, 0xffff0000, v209
    v_lshlrev_b32 v4, 16, v210
    v_and_b32 v5, 0xffff0000, v210
    v_lshlrev_b32 v6, 16, v211
    v_and_b32 v7, 0xffff0000, v211
    v_lshlrev_b32 v8, 16, v212
    v_and_b32 v9, 0xffff0000, v212
    v_lshlrev_b32 v10, 16, v213
    v_and_b32 v11, 0xffff0000, v213
    v_lshlrev_b32 v12, 16, v214
    v_and_b32 v13, 0xffff0000, v214
    v_lshlrev_b32 v14, 16, v215
    v_and_b32 v15, 0xffff0000, v215
    v_lshlrev_b32 v16, 16, v216
    v_and_b32 v17, 0xffff0000, v216
    v_lshlrev_b32 v18, 16, v217
    v_and_b32 v19, 0xffff0000, v217
    v_lshlrev_b32 v20, 16, v218
    v_and_b32 v21, 0xffff0000, v218
    v_lshlrev_b32 v22, 16, v219
    v_and_b32 v23, 0xffff0000, v219
    v_lshlrev_b32 v24, 16, v220
    v_and_b32 v25, 0xffff0000, v220
    v_lshlrev_b32 v26, 16, v221
    v_and_b32 v27, 0xffff0000, v221
    v_lshlrev_b32 v28, 16, v222
    v_and_b32 v29, 0xffff0000, v222
    v_lshlrev_b32 v30, 16, v223
    v_and_b32 v31, 0xffff0000, v223
    v_pk_fma_f32 v[0:1], v[0:1], v[240:241], v[240:241] op_sel:[0,0,1] op_sel_hi:[1,0,1]
    v_pk_fma_f32 v[2:3], v[2:3], v[240:241], v[240:241] op_sel:[0,0,1] op_sel_hi:[1,0,1]
    v_pk_fma_f32 v[4:5], v[4:5], v[240:241], v[240:241] op_sel:[0,0,1] op_sel_hi:[1,0,1]
    v_pk_fma_f32 v[6:7], v[6:7], v[240:241], v[240:241] op_sel:[0,0,1] op_sel_hi:[1,0,1]
    v_pk_fma_f32 v[8:9], v[8:9], v[240:241], v[240:241] op_sel:[0,0,1] op_sel_hi:[1,0,1]
    v_pk_fma_f32 v[10:11], v[10:11], v[240:241], v[240:241] op_sel:[0,0,1] op_sel_hi:[1,0,1]
    v_pk_fma_f32 v[12:13], v[12:13], v[240:241], v[240:241] op_sel:[0,0,1] op_sel_hi:[1,0,1]
    v_pk_fma_f32 v[14:15], v[14:15], v[240:241], v[240:241] op_sel:[0,0,1] op_sel_hi:[1,0,1]
    v_pk_fma_f32 v[16:17], v[16:17], v[240:241], v[240:241] op_sel:[0,0,1] op_sel_hi:[1,0,1]
    v_pk_fma_f32 v[18:19], v[18:19], v[240:241], v[240:241] op_sel:[0,0,1] op_sel_hi:[1,0,1]
    v_pk_fma_f32 v[20:21], v[20:21], v[240:241], v[240:241] op_sel:[0,0,1] op_sel_hi:[1,0,1]
    v_pk_fma_f32 v[22:23], v[22:23], v[240:241], v[240:241] op_sel:[0,0,1] op_sel_hi:[1,0,1]
    v_pk_fma_f32 v[24:25], v[24:25], v[240:241], v[240:241] op_sel:[0,0,1] op_sel_hi:[1,0,1]
    v_pk_fma_f32 v[26:27], v[26:27], v[240:241], v[240:241] op_sel:[0,0,1] op_sel_hi:[1,0,1]
    v_pk_fma_f32 v[28:29], v[28:29], v[240:241], v[240:241] op_sel:[0,0,1] op_sel_hi:[1,0,1]
    v_pk_fma_f32 v[30:31], v[30:31], v[240:241], v[240:241] op_sel:[0,0,1] op_sel_hi:[1,0,1]
    v_mov_b32 v154, 0
    s_mov_b64 exec, 1
    s_waitcnt vmcnt(0)
    s_cmp_lg_u32 s77, 0
    s_cbranch_scc1 lc_21
    buffer_store_dword v154, v154, s[20:23], s31 offen sc1
    s_branch lc_22
lc_21:
    buffer_store_dword v154, v154, s[20:23], s31 offen
lc_22:
    s_mov_b64 exec, -1
    s_barrier
    s_add_u32 s96, s25, 0
    s_and_b32 s96, s96, 15
    s_lshl_b32 s96, s96, 17
    s_add_u32 s96, s96, 65536
    s_add_u32 m0, s101, 65536
    s_nop 0
    buffer_load_dwordx4 v243, s[8:11], s96 offen lds
    s_add_u32 s96, s25, 1
    s_and_b32 s96, s96, 15
    s_lshl_b32 s96, s96, 17
    s_add_u32 s96, s96, 65536
    s_add_u32 m0, s101, 69632
    s_nop 0
    buffer_load_dwordx4 v243, s[8:11], s96 offen lds
    s_add_u32 s96, s25, 2
    s_and_b32 s96, s96, 15
    s_lshl_b32 s96, s96, 17
    s_add_u32 s96, s96, 65536
    s_add_u32 m0, s101, 73728
    s_nop 0
    buffer_load_dwordx4 v243, s[8:11], s96 offen lds
    s_add_u32 s96, s25, 3
    s_and_b32 s96, s96, 15
    s_lshl_b32 s96, s96, 17
    s_add_u32 s96, s96, 65536
    s_add_u32 m0, s101, 77824
    s_nop 0
    buffer_load_dwordx4 v243, s[8:11], s96 offen lds
    s_add_u32 s96, s25, 4
    s_and_b32 s96, s96, 15
    s_lshl_b32 s96, s96, 17
    s_add_u32 s96, s96, 65536
    s_add_u32 m0, s101, 81920
    s_nop 0
    buffer_load_dwordx4 v243, s[8:11], s96 offen lds
    s_add_u32 s96, s25, 5
    s_and_b32 s96, s96, 15
    s_lshl_b32 s96, s96, 17
    s_add_u32 s96, s96, 65536
    s_add_u32 m0, s101, 86016
    s_nop 0
    buffer_load_dwordx4 v243, s[8:11], s96 offen lds
    s_add_u32 s96, s25, 6
    s_and_b32 s96, s96, 15
    s_lshl_b32 s96, s96, 17
    s_add_u32 s96, s96, 65536
    s_add_u32 m0, s101, 90112
    s_nop 0
    buffer_load_dwordx4 v243, s[8:11], s96 offen lds
    s_add_u32 s96, s25, 7
    s_and_b32 s96, s96, 15
    s_lshl_b32 s96, s96, 17
    s_add_u32 s96, s96, 65536
    s_add_u32 m0, s101, 94208
    s_nop 0
    buffer_load_dwordx4 v243, s[8:11], s96 offen lds
    s_add_u32 s96, s25, 8
    s_and_b32 s96, s96, 15
    s_lshl_b32 s96, s96, 17
    s_add_u32 s96, s96, 65536
    s_add_u32 m0, s101, 98304
    s_nop 0
    buffer_load_dwordx4 v243, s[8:11], s96 offen lds
    s_add_u32 s96, s25, 9
    s_and_b32 s96, s96, 15
    s_lshl_b32 s96, s96, 17
    s_add_u32 s96, s96, 65536
    s_add_u32 m0, s101, 102400
    s_nop 0
    buffer_load_dwordx4 v243, s[8:11], s96 offen lds
    s_add_u32 s96, s25, 10
    s_and_b32 s96, s96, 15
    s_lshl_b32 s96, s96, 17
    s_add_u32 s96, s96, 65536
    s_add_u32 m0, s101, 106496
    s_nop 0
    buffer_load_dwordx4 v243, s[8:11], s96 offen lds
    s_add_u32 s96, s25, 11
    s_and_b32 s96, s96, 15
    s_lshl_b32 s96, s96, 17
    s_add_u32 s96, s96, 65536
    s_add_u32 m0, s101, 110592
    s_nop 0
    buffer_load_dwordx4 v243, s[8:11], s96 offen lds
    v_bfe_u32 v100, v252, 4, 1
    v_lshlrev_b32 v100, 11, v100
    v_lshrrev_b32 v101, 5, v252
    v_lshl_add_u32 v100, v101, 8, v100
    v_and_b32 v101, 15, v252
    v_lshl_add_u32 v100, v101, 4, v100
    s_lshl_b32 s34, s28, 12
    s_add_u32 s34, s34, 147456
    v_add_u32 v101, s34, v100
    s_lshl_b32 s37, s25, 11
    ds_read_b64_tr_b16 v[32:33], v56 offset:0
    ds_read_b64_tr_b16 v[34:35], v56 offset:512
    ds_read_b64_tr_b16 v[36:37], v57 offset:0
    ds_read_b64_tr_b16 v[38:39], v57 offset:512
    ds_read_b64_tr_b16 v[40:41], v56 offset:2048
    ds_read_b64_tr_b16 v[42:43], v56 offset:2560
    ds_read_b64_tr_b16 v[44:45], v57 offset:2048
    ds_read_b64_tr_b16 v[46:47], v57 offset:2560
    s_mov_b32 s78, s27
pl_23:
    buffer_load_dword v61, v60, s[20:23], s30 offen offset:0 sc1
    s_waitcnt vmcnt(0)
pc_24:
    v_cmp_eq_u32 vcc, -1, v61
    s_cbranch_vccz pd_25
    s_sub_u32 s78, s78, 1
    s_cmp_lg_u32 s78, 0
    s_cbranch_scc1 pl_23
    s_mov_b32 s27, 1
pd_25:
    s_add_u32 s38, s36, s37
    buffer_load_dwordx4 v[104:107], v253, s[20:23], s38 offen offset:0 sc1
    s_add_u32 s37, s37, 2048
    s_and_b32 s37, s37, 0x7800
    buffer_load_dwordx4 v[108:111], v253, s[20:23], s38 offen offset:1024 sc1
    s_add_u32 s38, s36, s37
    buffer_load_dwordx4 v[112:115], v253, s[20:23], s38 offen offset:0 sc1
    s_add_u32 s37, s37, 2048
    s_and_b32 s37, s37, 0x7800
    buffer_load_dwordx4 v[116:119], v253, s[20:23], s38 offen offset:1024 sc1
    s_add_u32 s38, s36, s37
    buffer_load_dwordx4 v[120:123], v253, s[20:23], s38 offen offset:0 sc1
    s_add_u32 s37, s37, 2048
    s_and_b32 s37, s37, 0x7800
    buffer_load_dwordx4 v[124:127], v253, s[20:23], s38 offen offset:1024 sc1
    s_add_u32 s38, s36, s37
    buffer_load_dwordx4 v[128:131], v253, s[20:23], s38 offen offset:0 sc1
    s_add_u32 s37, s37, 2048
    s_and_b32 s37, s37, 0x7800
    buffer_load_dwordx4 v[132:135], v253, s[20:23], s38 offen offset:1024 sc1
    s_waitcnt vmcnt(7) lgkmcnt(4)
    v_mfma_f32_32x32x16_bf16 v[0:15], v[32:35], v[104:107], v[0:15]
    s_add_u32 s38, s36, s37
    buffer_load_dwordx4 v[136:139], v253, s[20:23], s38 offen offset:0 sc1
    ds_read_b64_tr_b16 v[48:49], v56 offset:4096
    ds_read_b64_tr_b16 v[50:51], v56 offset:4608
    v_mfma_f32_32x32x16_bf16 v[16:31], v[36:39], v[104:107], v[16:31]
    ds_read_b64_tr_b16 v[52:53], v57 offset:4096
    ds_read_b64_tr_b16 v[54:55], v57 offset:4608
    s_waitcnt vmcnt(7) lgkmcnt(4)
    v_mfma_f32_32x32x16_bf16 v[0:15], v[40:43], v[108:111], v[0:15]
    s_add_u32 s37, s37, 2048
    s_and_b32 s37, s37, 0x7800
    buffer_load_dwordx4 v[104:107], v253, s[20:23], s38 offen offset:1024 sc1
    ds_read_b64_tr_b16 v[32:33], v56 offset:6144
    ds_read_b64_tr_b16 v[34:35], v56 offset:6656
    v_mfma_f32_32x32x16_bf16 v[16:31], v[44:47], v[108:111], v[16:31]
    ds_read_b64_tr_b16 v[36:37], v57 offset:6144
    ds_read_b64_tr_b16 v[38:39], v57 offset:6656
    s_waitcnt vmcnt(7) lgkmcnt(4)
    v_mfma_f32_32x32x16_bf16 v[0:15], v[48:51], v[112:115], v[0:15]
    s_add_u32 s38, s36, s37
    buffer_load_dwordx4 v[108:111], v253, s[20:23], s38 offen offset:0 sc1
    ds_read_b64_tr_b16 v[40:41], v56 offset:8192
    ds_read_b64_tr_b16 v[42:43], v56 offset:8704
    v_mfma_f32_32x32x16_bf16 v[16:31], v[52:55], v[112:115], v[16:31]
    ds_read_b64_tr_b16 v[44:45], v57 offset:8192
    ds_read_b64_tr_b16 v[46:47], v57 offset:8704
    s_waitcnt vmcnt(7) lgkmcnt(4)
    v_mfma_f32_32x32x16_bf16 v[0:15], v[32:35], v[116:119], v[0:15]
    s_add_u32 s37, s37, 2048
    s_and_b32 s37, s37, 0x7800
    buffer_load_dwordx4 v[112:115], v253, s[20:23], s38 offen offset:1024 sc1
    ds_read_b64_tr_b16 v[48:49], v56 offset:10240
    ds_read_b64_tr_b16 v[50:51], v56 offset:10752
    v_mfma_f32_32x32x16_bf16 v[16:31], v[36:39], v[116:119], v[16:31]
    ds_read_b64_tr_b16 v[52:53], v57 offset:10240
    ds_read_b64_tr_b16 v[54:55], v57 offset:10752
    s_waitcnt vmcnt(7) lgkmcnt(4)
    v_mfma_f32_32x32x16_bf16 v[0:15], v[40:43], v[120:123], v[0:15]
    s_add_u32 s38, s36, s37
    buffer_load_dwordx4 v[116:119], v253, s[20:23], s38 offen offset:0 sc1
    ds_read_b64_tr_b16 v[32:33], v56 offset:12288
    ds_read_b64_tr_b16 v[34:35], v56 offset:12800
    v_mfma_f32_32x32x16_bf16 v[16:31], v[44:47], v[120:123], v[16:31]
    ds_read_b64_tr_b16 v[36:37], v57 offset:12288
    ds_read_b64_tr_b16 v[38:39], v57 offset:12800
    s_waitcnt vmcnt(7) lgkmcnt(4)
    v_mfma_f32_32x32x16_bf16 v[0:15], v[48:51], v[124:127], v[0:15]
    s_add_u32 s37, s37, 2048
    s_and_b32 s37, s37, 0x7800
    buffer_load_dwordx4 v[120:123], v253, s[20:23], s38 offen offset:1024 sc1
    ds_read_b64_tr_b16 v[40:41], v56 offset:14336
    ds_read_b64_tr_b16 v[42:43], v56 offset:14848
    v_mfma_f32_32x32x16_bf16 v[16:31], v[52:55], v[124:127], v[16:31]
    ds_read_b64_tr_b16 v[44:45], v57 offset:14336
    ds_read_b64_tr_b16 v[46:47], v57 offset:14848
    s_waitcnt vmcnt(7) lgkmcnt(4)
    v_mfma_f32_32x32x16_bf16 v[0:15], v[32:35], v[128:131], v[0:15]
    s_add_u32 s38, s36, s37
    buffer_load_dwordx4 v[124:127], v253, s[20:23], s38 offen offset:0 sc1
    ds_read_b64_tr_b16 v[48:49], v56 offset:16384
    ds_read_b64_tr_b16 v[50:51], v56 offset:16896
    v_mfma_f32_32x32x16_bf16 v[16:31], v[36:39], v[128:131], v[16:31]
    ds_read_b64_tr_b16 v[52:53], v57 offset:16384
    ds_read_b64_tr_b16 v[54:55], v57 offset:16896
    s_waitcnt vmcnt(7) lgkmcnt(4)
    v_mfma_f32_32x32x16_bf16 v[0:15], v[40:43], v[132:135], v[0:15]
    s_add_u32 s37, s37, 2048
    s_and_b32 s37, s37, 0x7800
    buffer_load_dwordx4 v[128:131], v253, s[20:23], s38 offen offset:1024 sc1
    ds_read_b64_tr_b16 v[32:33], v56 offset:18432
    ds_read_b64_tr_b16 v[34:35], v56 offset:18944
    v_mfma_f32_32x32x16_bf16 v[16:31], v[44:47], v[132:135], v[16:31]
    ds_read_b64_tr_b16 v[36:37], v57 offset:18432
    ds_read_b64_tr_b16 v[38:39], v57 offset:18944
    s_waitcnt vmcnt(7) lgkmcnt(4)
    v_mfma_f32_32x32x16_bf16 v[0:15], v[48:51], v[136:139], v[0:15]
    s_add_u32 s38, s36, s37
    buffer_load_dwordx4 v[132:135], v253, s[20:23], s38 offen offset:0 sc1
    ds_read_b64_tr_b16 v[40:41], v56 offset:20480
    ds_read_b64_tr_b16 v[42:43], v56 offset:20992
    v_mfma_f32_32x32x16_bf16 v[16:31], v[52:55], v[136:139], v[16:31]
    ds_read_b64_tr_b16 v[44:45], v57 offset:20480
    ds_read_b64_tr_b16 v[46:47], v57 offset:20992
    s_waitcnt vmcnt(7) lgkmcnt(4)
    v_mfma_f32_32x32x16_bf16 v[0:15], v[32:35], v[104:107], v[0:15]
    s_add_u32 s37, s37, 2048
    s_and_b32 s37, s37, 0x7800
    buffer_load_dwordx4 v[136:139], v253, s[20:23], s38 offen offset:1024 sc1
    ds_read_b64_tr_b16 v[48:49], v56 offset:22528
    ds_read_b64_tr_b16 v[50:51], v56 offset:23040
    v_mfma_f32_32x32x16_bf16 v[16:31], v[36:39], v[104:107], v[16:31]
    ds_read_b64_tr_b16 v[52:53], v57 offset:22528
    ds_read_b64_tr_b16 v[54:55], v57 offset:23040
    s_waitcnt vmcnt(7) lgkmcnt(4)
    v_mfma_f32_32x32x16_bf16 v[0:15], v[40:43], v[108:111], v[0:15]
    s_add_u32 s38, s36, s37
    buffer_load_dwordx4 v[104:107], v253, s[20:23], s38 offen offset:0 sc1
    ds_read_b64_tr_b16 v[32:33], v56 offset:24576
    ds_read_b64_tr_b16 v[34:35], v56 offset:25088
    v_mfma_f32_32x32x16_bf16 v[16:31], v[44:47], v[108:111], v[16:31]
    ds_read_b64_tr_b16 v[36:37], v57 offset:24576
    ds_read_b64_tr_b16 v[38:39], v57 offset:25088
    s_waitcnt vmcnt(7) lgkmcnt(4)
    v_mfma_f32_32x32x16_bf16 v[0:15], v[48:51], v[112:115], v[0:15]
    s_add_u32 s37, s37, 2048
    s_and_b32 s37, s37, 0x7800
    buffer_load_dwordx4 v[108:111], v253, s[20:23], s38 offen offset:1024 sc1
    ds_read_b64_tr_b16 v[40:41], v56 offset:26624
    ds_read_b64_tr_b16 v[42:43], v56 offset:27136
    v_mfma_f32_32x32x16_bf16 v[16:31], v[52:55], v[112:115], v[16:31]
    ds_read_b64_tr_b16 v[44:45], v57 offset:26624
    ds_read_b64_tr_b16 v[46:47], v57 offset:27136
    s_waitcnt vmcnt(7) lgkmcnt(4)
    v_mfma_f32_32x32x16_bf16 v[0:15], v[32:35], v[116:119], v[0:15]
    s_add_u32 s38, s36, s37
    buffer_load_dwordx4 v[112:115], v253, s[20:23], s38 offen offset:0 sc1
    ds_read_b64_tr_b16 v[48:49], v56 offset:28672
    ds_read_b64_tr_b16 v[50:51], v56 offset:29184
    v_mfma_f32_32x32x16_bf16 v[16:31], v[36:39], v[116:119], v[16:31]
    ds_read_b64_tr_b16 v[52:53], v57 offset:28672
    ds_read_b64_tr_b16 v[54:55], v57 offset:29184
    s_waitcnt vmcnt(7) lgkmcnt(4)
    v_mfma_f32_32x32x16_bf16 v[0:15], v[40:43], v[120:123], v[0:15]
    s_add_u32 s37, s37, 2048
    s_and_b32 s37, s37, 0x7800
    buffer_load_dwordx4 v[116:119], v253, s[20:23], s38 offen offset:1024 sc1
    ds_read_b64_tr_b16 v[32:33], v56 offset:30720
    ds_read_b64_tr_b16 v[34:35], v56 offset:31232
    v_mfma_f32_32x32x16_bf16 v[16:31], v[44:47], v[120:123], v[16:31]
    ds_read_b64_tr_b16 v[36:37], v57 offset:30720
    ds_read_b64_tr_b16 v[38:39], v57 offset:31232
    s_waitcnt vmcnt(7) lgkmcnt(4)
    v_mfma_f32_32x32x16_bf16 v[0:15], v[48:51], v[124:127], v[0:15]
    s_add_u32 s38, s36, s37
    buffer_load_dwordx4 v[120:123], v253, s[20:23], s38 offen offset:0 sc1
    ds_read_b64_tr_b16 v[40:41], v56 offset:32768
    ds_read_b64_tr_b16 v[42:43], v56 offset:33280
    v_mfma_f32_32x32x16_bf16 v[16:31], v[52:55], v[124:127], v[16:31]
    ds_read_b64_tr_b16 v[44:45], v57 offset:32768
    ds_read_b64_tr_b16 v[46:47], v57 offset:33280
    s_waitcnt vmcnt(7) lgkmcnt(4)
    v_mfma_f32_32x32x16_bf16 v[0:15], v[32:35], v[128:131], v[0:15]
    s_add_u32 s37, s37, 2048
    s_and_b32 s37, s37, 0x7800
    buffer_load_dwordx4 v[124:127], v253, s[20:23], s38 offen offset:1024 sc1
    ds_read_b64_tr_b16 v[48:49], v56 offset:34816
    ds_read_b64_tr_b16 v[50:51], v56 offset:35328
    v_mfma_f32_32x32x16_bf16 v[16:31], v[36:39], v[128:131], v[16:31]
    ds_read_b64_tr_b16 v[52:53], v57 offset:34816
    ds_read_b64_tr_b16 v[54:55], v57 offset:35328
    s_waitcnt vmcnt(7) lgkmcnt(4)
    v_mfma_f32_32x32x16_bf16 v[0:15], v[40:43], v[132:135], v[0:15]
    s_add_u32 s38, s36, s37
    buffer_load_dwordx4 v[128:131], v253, s[20:23], s38 offen offset:0 sc1
    ds_read_b64_tr_b16 v[32:33], v56 offset:36864
    ds_read_b64_tr_b16 v[34:35], v56 offset:37376
    v_mfma_f32_32x32x16_bf16 v[16:31], v[44:47], v[132:135], v[16:31]
    ds_read_b64_tr_b16 v[36:37], v57 offset:36864
    ds_read_b64_tr_b16 v[38:39], v57 offset:37376
    s_waitcnt vmcnt(7) lgkmcnt(4)
    v_mfma_f32_32x32x16_bf16 v[0:15], v[48:51], v[136:139], v[0:15]
    s_add_u32 s37, s37, 2048
    s_and_b32 s37, s37, 0x7800
    buffer_load_dwordx4 v[132:135], v253, s[20:23], s38 offen offset:1024 sc1
    ds_read_b64_tr_b16 v[40:41], v56 offset:38912
    ds_read_b64_tr_b16 v[42:43], v56 offset:39424
    v_mfma_f32_32x32x16_bf16 v[16:31], v[52:55], v[136:139], v[16:31]
    ds_read_b64_tr_b16 v[44:45], v57 offset:38912
    ds_read_b64_tr_b16 v[46:47], v57 offset:39424
    s_waitcnt vmcnt(7) lgkmcnt(4)
    v_mfma_f32_32x32x16_bf16 v[0:15], v[32:35], v[104:107], v[0:15]
    s_add_u32 s38, s36, s37
    buffer_load_dwordx4 v[136:139], v253, s[20:23], s38 offen offset:0 sc1
    ds_read_b64_tr_b16 v[48:49], v56 offset:40960
    ds_read_b64_tr_b16 v[50:51], v56 offset:41472
    v_mfma_f32_32x32x16_bf16 v[16:31], v[36:39], v[104:107], v[16:31]
    ds_read_b64_tr_b16 v[52:53], v57 offset:40960
    ds_read_b64_tr_b16 v[54:55], v57 offset:41472
    s_waitcnt vmcnt(7) lgkmcnt(4)
    v_mfma_f32_32x32x16_bf16 v[0:15], v[40:43], v[108:111], v[0:15]
    s_add_u32 s37, s37, 2048
    s_and_b32 s37, s37, 0x7800
    buffer_load_dwordx4 v[104:107], v253, s[20:23], s38 offen offset:1024 sc1
    ds_read_b64_tr_b16 v[32:33], v56 offset:43008
    ds_read_b64_tr_b16 v[34:35], v56 offset:43520
    v_mfma_f32_32x32x16_bf16 v[16:31], v[44:47], v[108:111], v[16:31]
    ds_read_b64_tr_b16 v[36:37], v57 offset:43008
    ds_read_b64_tr_b16 v[38:39], v57 offset:43520
    s_waitcnt vmcnt(7) lgkmcnt(4)
    v_mfma_f32_32x32x16_bf16 v[0:15], v[48:51], v[112:115], v[0:15]
    buffer_load_dword v61, v60, s[20:23], s30 offen offset:256 sc1
    s_add_u32 s38, s36, s37
    buffer_load_dwordx4 v[108:111], v253, s[20:23], s38 offen offset:0 sc1
    ds_read_b64_tr_b16 v[40:41], v56 offset:45056
    ds_read_b64_tr_b16 v[42:43], v56 offset:45568
    v_mfma_f32_32x32x16_bf16 v[16:31], v[52:55], v[112:115], v[16:31]
    ds_read_b64_tr_b16 v[44:45], v57 offset:45056
    ds_read_b64_tr_b16 v[46:47], v57 offset:45568
    s_waitcnt vmcnt(8) lgkmcnt(4)
    v_mfma_f32_32x32x16_bf16 v[0:15], v[32:35], v[116:119], v[0:15]
    s_add_u32 s37, s37, 2048
    s_and_b32 s37, s37, 0x7800
    buffer_load_dwordx4 v[112:115], v253, s[20:23], s38 offen offset:1024 sc1
    ds_read_b64_tr_b16 v[48:49], v56 offset:47104
    ds_read_b64_tr_b16 v[50:51], v56 offset:47616
    v_mfma_f32_32x32x16_bf16 v[16:31], v[36:39], v[116:119], v[16:31]
    ds_read_b64_tr_b16 v[52:53], v57 offset:47104
    ds_read_b64_tr_b16 v[54:55], v57 offset:47616
    s_waitcnt vmcnt(8) lgkmcnt(4)
    v_mfma_f32_32x32x16_bf16 v[0:15], v[40:43], v[120:123], v[0:15]
    s_add_u32 s38, s36, s37
    buffer_load_dwordx4 v[116:119], v253, s[20:23], s38 offen offset:0 sc1
    ds_read_b64_tr_b16 v[32:33], v56 offset:49152
    ds_read_b64_tr_b16 v[34:35], v56 offset:49664
    v_mfma_f32_32x32x16_bf16 v[16:31], v[44:47], v[120:123], v[16:31]
    ds_read_b64_tr_b16 v[36:37], v57 offset:49152
    ds_read_b64_tr_b16 v[38:39], v57 offset:49664
    s_waitcnt vmcnt(8) lgkmcnt(4)
    v_mfma_f32_32x32x16_bf16 v[0:15], v[48:51], v[124:127], v[0:15]
    s_add_u32 s37, s37, 2048
    s_and_b32 s37, s37, 0x7800
    buffer_load_dwordx4 v[120:123], v253, s[20:23], s38 offen offset:1024 sc1
    ds_read_b64_tr_b16 v[40:41], v56 offset:51200
    ds_read_b64_tr_b16 v[42:43], v56 offset:51712
    v_mfma_f32_32x32x16_bf16 v[16:31], v[52:55], v[124:127], v[16:31]
    ds_read_b64_tr_b16 v[44:45], v57 offset:51200
    ds_read_b64_tr_b16 v[46:47], v57 offset:51712
    s_waitcnt vmcnt(8) lgkmcnt(4)
    v_mfma_f32_32x32x16_bf16 v[0:15], v[32:35], v[128:131], v[0:15]
    s_mov_b32 s78, s27
    s_waitcnt vmcnt(4)
    s_branch pc_27
pl_26:
    buffer_load_dword v61, v60, s[20:23], s30 offen offset:256 sc1
    s_waitcnt vmcnt(0)
pc_27:
    v_cmp_eq_u32 vcc, -1, v61
    s_cbranch_vccz pd_28
    s_sub_u32 s78, s78, 1
    s_cmp_lg_u32 s78, 0
    s_cbranch_scc1 pl_26
    s_mov_b32 s27, 1
pd_28:
    s_add_u32 s36, s36, 32768
    s_add_u32 s38, s36, s37
    buffer_load_dwordx4 v[124:127], v253, s[20:23], s38 offen offset:0 sc1
    ds_read_b64_tr_b16 v[48:49], v56 offset:53248
    ds_read_b64_tr_b16 v[50:51], v56 offset:53760
    v_mfma_f32_32x32x16_bf16 v[16:31], v[36:39], v[128:131], v[16:31]
    ds_read_b64_tr_b16 v[52:53], v57 offset:53248
    ds_read_b64_tr_b16 v[54:55], v57 offset:53760
    s_waitcnt vmcnt(8) lgkmcnt(4)
    v_mfma_f32_32x32x16_bf16 v[0:15], v[40:43], v[132:135], v[0:15]
    s_add_u32 s37, s37, 2048
    s_and_b32 s37, s37, 0x7800
    buffer_load_dwordx4 v[128:131], v253, s[20:23], s38 offen offset:1024 sc1
    ds_read_b64_tr_b16 v[32:33], v56 offset:55296
    ds_read_b64_tr_b16 v[34:35], v56 offset:55808
    v_mfma_f32_32x32x16_bf16 v[16:31], v[44:47], v[132:135], v[16:31]
    ds_read_b64_tr_b16 v[36:37], v57 offset:55296
    ds_read_b64_tr_b16 v[38:39], v57 offset:55808
    s_waitcnt vmcnt(8) lgkmcnt(4)
    v_mfma_f32_32x32x16_bf16 v[0:15], v[48:51], v[136:139], v[0:15]
    s_add_u32 s38, s36, s37
    buffer_load_dwordx4 v[132:135], v253, s[20:23], s38 offen offset:0 sc1
    ds_read_b64_tr_b16 v[40:41], v56 offset:57344
    ds_read_b64_tr_b16 v[42:43], v56 offset:57856
    v_mfma_f32_32x32x16_bf16 v[16:31], v[52:55], v[136:139], v[16:31]
    ds_read_b64_tr_b16 v[44:45], v57 offset:57344
    ds_read_b64_tr_b16 v[46:47], v57 offset:57856
    s_waitcnt vmcnt(8) lgkmcnt(4)
    v_mfma_f32_32x32x16_bf16 v[0:15], v[32:35], v[104:107], v[0:15]
    s_add_u32 s37, s37, 2048
    s_and_b32 s37, s37, 0x7800
    buffer_load_dwordx4 v[136:139], v253, s[20:23], s38 offen offset:1024 sc1
    ds_read_b64_tr_b16 v[48:49], v56 offset:59392
    ds_read_b64_tr_b16 v[50:51], v56 offset:59904
    v_mfma_f32_32x32x16_bf16 v[16:31], v[36:39], v[104:107], v[16:31]
    ds_read_b64_tr_b16 v[52:53], v57 offset:59392
    ds_read_b64_tr_b16 v[54:55], v57 offset:59904
    s_waitcnt vmcnt(7) lgkmcnt(4)
    v_mfma_f32_32x32x16_bf16 v[0:15], v[40:43], v[108:111], v[0:15]
    s_add_u32 s38, s36, s37
    buffer_load_dwordx4 v[104:107], v253, s[20:23], s38 offen offset:0 sc1
    ds_read_b64_tr_b16 v[32:33], v56 offset:61440
    ds_read_b64_tr_b16 v[34:35], v56 offset:61952
    v_mfma_f32_32x32x16_bf16 v[16:31], v[44:47], v[108:111], v[16:31]
    ds_read_b64_tr_b16 v[36:37], v57 offset:61440
    ds_read_b64_tr_b16 v[38:39], v57 offset:61952
    s_waitcnt vmcnt(7) lgkmcnt(4)
    v_mfma_f32_32x32x16_bf16 v[0:15], v[48:51], v[112:115], v[0:15]
    s_add_u32 s37, s37, 2048
    s_and_b32 s37, s37, 0x7800
    buffer_load_dwordx4 v[108:111], v253, s[20:23], s38 offen offset:1024 sc1
    ds_read_b64_tr_b16 v[40:41], v56 offset:63488
    ds_read_b64_tr_b16 v[42:43], v56 offset:64000
    v_mfma_f32_32x32x16_bf16 v[16:31], v[52:55], v[112:115], v[16:31]
    ds_read_b64_tr_b16 v[44:45], v57 offset:63488
    ds_read_b64_tr_b16 v[46:47], v57 offset:64000
    s_barrier
    s_waitcnt vmcnt(7) lgkmcnt(4)
    v_mfma_f32_32x32x16_bf16 v[0:15], v[32:35], v[116:119], v[0:15]
    s_add_u32 s38, s36, s37
    buffer_load_dwordx4 v[112:115], v253, s[20:23], s38 offen offset:0 sc1
    ds_read_b64_tr_b16 v[48:49], v58 offset:0
    ds_read_b64_tr_b16 v[50:51], v58 offset:512
    v_mfma_f32_32x32x16_bf16 v[16:31], v[36:39], v[116:119], v[16:31]
    ds_read_b64_tr_b16 v[52:53], v59 offset:0
    ds_read_b64_tr_b16 v[54:55], v59 offset:512
    s_waitcnt vmcnt(7) lgkmcnt(4)
    v_mfma_f32_32x32x16_bf16 v[0:15], v[40:43], v[120:123], v[0:15]
    s_add_u32 s37, s37, 2048
    s_and_b32 s37, s37, 0x7800
    buffer_load_dwordx4 v[116:119], v253, s[20:23], s38 offen offset:1024 sc1
    ds_read_b64_tr_b16 v[32:33], v58 offset:2048
    ds_read_b64_tr_b16 v[34:35], v58 offset:2560
    v_mfma_f32_32x32x16_bf16 v[16:31], v[44:47], v[120:123], v[16:31]
    ds_read_b64_tr_b16 v[36:37], v59 offset:2048
    ds_read_b64_tr_b16 v[38:39], v59 offset:2560
    s_waitcnt vmcnt(7) lgkmcnt(4)
    v_mfma_f32_32x32x16_bf16 v[0:15], v[48:51], v[124:127], v[0:15]
    s_add_u32 s38, s36, s37
    buffer_load_dwordx4 v[120:123], v253, s[20:23], s38 offen offset:0 sc1
    ds_read_b64_tr_b16 v[40:41], v58 offset:4096
    ds_read_b64_tr_b16 v[42:43], v58 offset:4608
    v_mfma_f32_32x32x16_bf16 v[16:31], v[52:55], v[124:127], v[16:31]
    ds_read_b64_tr_b16 v[44:45], v59 offset:4096
    ds_read_b64_tr_b16 v[46:47], v59 offset:4608
    s_waitcnt vmcnt(7) lgkmcnt(4)
    v_mfma_f32_32x32x16_bf16 v[0:15], v[32:35], v[128:131], v[0:15]
    s_add_u32 s37, s37, 2048
    s_and_b32 s37, s37, 0x7800
    buffer_load_dwordx4 v[124:127], v253, s[20:23], s38 offen offset:1024 sc1
    ds_read_b64_tr_b16 v[48:49], v58 offset:6144
    ds_read_b64_tr_b16 v[50:51], v58 offset:6656
    v_mfma_f32_32x32x16_bf16 v[16:31], v[36:39], v[128:131], v[16:31]
    ds_read_b64_tr_b16 v[52:53], v59 offset:6144
    ds_read_b64_tr_b16 v[54:55], v59 offset:6656
    s_waitcnt vmcnt(7) lgkmcnt(4)
    v_mfma_f32_32x32x16_bf16 v[0:15], v[40:43], v[132:135], v[0:15]
    s_add_u32 s38, s36, s37
    buffer_load_dwordx4 v[128:131], v253, s[20:23], s38 offen offset:0 sc1
    ds_read_b64_tr_b16 v[32:33], v58 offset:8192
    ds_read_b64_tr_b16 v[34:35], v58 offset:8704
    v_mfma_f32_32x32x16_bf16 v[16:31], v[44:47], v[132:135], v[16:31]
    ds_read_b64_tr_b16 v[36:37], v59 offset:8192
    ds_read_b64_tr_b16 v[38:39], v59 offset:8704
    s_waitcnt vmcnt(7) lgkmcnt(4)
    v_mfma_f32_32x32x16_bf16 v[0:15], v[48:51], v[136:139], v[0:15]
    s_add_u32 s37, s37, 2048
    s_and_b32 s37, s37, 0x7800
    buffer_load_dwordx4 v[132:135], v253, s[20:23], s38 offen offset:1024 sc1
    ds_read_b64_tr_b16 v[40:41], v58 offset:10240
    ds_read_b64_tr_b16 v[42:43], v58 offset:10752
    v_mfma_f32_32x32x16_bf16 v[16:31], v[52:55], v[136:139], v[16:31]
    ds_read_b64_tr_b16 v[44:45], v59 offset:10240
    ds_read_b64_tr_b16 v[46:47], v59 offset:10752
    s_waitcnt vmcnt(7) lgkmcnt(4)
    v_mfma_f32_32x32x16_bf16 v[0:15], v[32:35], v[104:107], v[0:15]
    s_add_u32 s38, s36, s37
    buffer_load_dwordx4 v[136:139], v253, s[20:23], s38 offen offset:0 sc1
    ds_read_b64_tr_b16 v[48:49], v58 offset:12288
    ds_read_b64_tr_b16 v[50:51], v58 offset:12800
    v_mfma_f32_32x32x16_bf16 v[16:31], v[36:39], v[104:107], v[16:31]
    ds_read_b64_tr_b16 v[52:53], v59 offset:12288
    ds_read_b64_tr_b16 v[54:55], v59 offset:12800
    s_waitcnt vmcnt(7) lgkmcnt(4)
    v_mfma_f32_32x32x16_bf16 v[0:15], v[40:43], v[108:111], v[0:15]
    s_add_u32 s37, s37, 2048
    s_and_b32 s37, s37, 0x7800
    buffer_load_dwordx4 v[104:107], v253, s[20:23], s38 offen offset:1024 sc1
    ds_read_b64_tr_b16 v[32:33], v58 offset:14336
    ds_read_b64_tr_b16 v[34:35], v58 offset:14848
    v_mfma_f32_32x32x16_bf16 v[16:31], v[44:47], v[108:111], v[16:31]
    ds_read_b64_tr_b16 v[36:37], v59 offset:14336
    ds_read_b64_tr_b16 v[38:39], v59 offset:14848
    s_waitcnt vmcnt(7) lgkmcnt(4)
    v_mfma_f32_32x32x16_bf16 v[0:15], v[48:51], v[112:115], v[0:15]
    s_add_u32 s38, s36, s37
    buffer_load_dwordx4 v[108:111], v253, s[20:23], s38 offen offset:0 sc1
    ds_read_b64_tr_b16 v[40:41], v58 offset:16384
    ds_read_b64_tr_b16 v[42:43], v58 offset:16896
    v_mfma_f32_32x32x16_bf16 v[16:31], v[52:55], v[112:115], v[16:31]
    ds_read_b64_tr_b16 v[44:45], v59 offset:16384
    ds_read_b64_tr_b16 v[46:47], v59 offset:16896
    s_waitcnt vmcnt(7) lgkmcnt(4)
    v_mfma_f32_32x32x16_bf16 v[0:15], v[32:35], v[116:119], v[0:15]
    s_add_u32 s37, s37, 2048
    s_and_b32 s37, s37, 0x7800
    buffer_load_dwordx4 v[112:115], v253, s[20:23], s38 offen offset:1024 sc1
    ds_read_b64_tr_b16 v[48:49], v58 offset:18432
    ds_read_b64_tr_b16 v[50:51], v58 offset:18944
    v_mfma_f32_32x32x16_bf16 v[16:31], v[36:39], v[116:119], v[16:31]
    ds_read_b64_tr_b16 v[52:53], v59 offset:18432
    ds_read_b64_tr_b16 v[54:55], v59 offset:18944
    s_waitcnt vmcnt(7) lgkmcnt(4)
    v_mfma_f32_32x32x16_bf16 v[0:15], v[40:43], v[120:123], v[0:15]
    s_add_u32 s38, s36, s37
    buffer_load_dwordx4 v[116:119], v253, s[20:23], s38 offen offset:0 sc1
    ds_read_b64_tr_b16 v[32:33], v58 offset:20480
    ds_read_b64_tr_b16 v[34:35], v58 offset:20992
    v_mfma_f32_32x32x16_bf16 v[16:31], v[44:47], v[120:123], v[16:31]
    ds_read_b64_tr_b16 v[36:37], v59 offset:20480
    ds_read_b64_tr_b16 v[38:39], v59 offset:20992
    s_waitcnt vmcnt(7) lgkmcnt(4)
    v_mfma_f32_32x32x16_bf16 v[0:15], v[48:51], v[124:127], v[0:15]
    s_add_u32 s37, s37, 2048
    s_and_b32 s37, s37, 0x7800
    buffer_load_dwordx4 v[120:123], v253, s[20:23], s38 offen offset:1024 sc1
    ds_read_b64_tr_b16 v[40:41], v58 offset:22528
    ds_read_b64_tr_b16 v[42:43], v58 offset:23040
    v_mfma_f32_32x32x16_bf16 v[16:31], v[52:55], v[124:127], v[16:31]
    ds_read_b64_tr_b16 v[44:45], v59 offset:22528
    ds_read_b64_tr_b16 v[46:47], v59 offset:23040
    s_waitcnt vmcnt(7) lgkmcnt(4)
    v_mfma_f32_32x32x16_bf16 v[0:15], v[32:35], v[128:131], v[0:15]
    s_add_u32 s38, s36, s37
    buffer_load_dwordx4 v[124:127], v253, s[20:23], s38 offen offset:0 sc1
    ds_read_b64_tr_b16 v[48:49], v58 offset:24576
    ds_read_b64_tr_b16 v[50:51], v58 offset:25088
    v_mfma_f32_32x32x16_bf16 v[16:31], v[36:39], v[128:131], v[16:31]
    ds_read_b64_tr_b16 v[52:53], v59 offset:24576
    ds_read_b64_tr_b16 v[54:55], v59 offset:25088
    s_waitcnt vmcnt(7) lgkmcnt(4)
    v_mfma_f32_32x32x16_bf16 v[0:15], v[40:43], v[132:135], v[0:15]
    s_add_u32 s37, s37, 2048
    s_and_b32 s37, s37, 0x7800
    buffer_load_dwordx4 v[128:131], v253, s[20:23], s38 offen offset:1024 sc1
    ds_read_b64_tr_b16 v[32:33], v58 offset:26624
    ds_read_b64_tr_b16 v[34:35], v58 offset:27136
    v_mfma_f32_32x32x16_bf16 v[16:31], v[44:47], v[132:135], v[16:31]
    ds_read_b64_tr_b16 v[36:37], v59 offset:26624
    ds_read_b64_tr_b16 v[38:39], v59 offset:27136
    s_waitcnt vmcnt(7) lgkmcnt(4)
    v_mfma_f32_32x32x16_bf16 v[0:15], v[48:51], v[136:139], v[0:15]
    s_add_u32 s38, s36, s37
    buffer_load_dwordx4 v[132:135], v253, s[20:23], s38 offen offset:0 sc1
    ds_read_b64_tr_b16 v[40:41], v58 offset:28672
    ds_read_b64_tr_b16 v[42:43], v58 offset:29184
    v_mfma_f32_32x32x16_bf16 v[16:31], v[52:55], v[136:139], v[16:31]
    ds_read_b64_tr_b16 v[44:45], v59 offset:28672
    ds_read_b64_tr_b16 v[46:47], v59 offset:29184
    s_waitcnt vmcnt(7) lgkmcnt(4)
    v_mfma_f32_32x32x16_bf16 v[0:15], v[32:35], v[104:107], v[0:15]
    s_add_u32 s37, s37, 2048
    s_and_b32 s37, s37, 0x7800
    buffer_load_dwordx4 v[136:139], v253, s[20:23], s38 offen offset:1024 sc1
    ds_read_b64_tr_b16 v[48:49], v58 offset:30720
    ds_read_b64_tr_b16 v[50:51], v58 offset:31232
    v_mfma_f32_32x32x16_bf16 v[16:31], v[36:39], v[104:107], v[16:31]
    ds_read_b64_tr_b16 v[52:53], v59 offset:30720
    ds_read_b64_tr_b16 v[54:55], v59 offset:31232
    s_waitcnt vmcnt(7) lgkmcnt(4)
    v_mfma_f32_32x32x16_bf16 v[0:15], v[40:43], v[108:111], v[0:15]
    s_add_u32 s38, s36, s37
    buffer_load_dwordx4 v[104:107], v253, s[20:23], s38 offen offset:0 sc1
    ds_read_b64_tr_b16 v[32:33], v58 offset:32768
    ds_read_b64_tr_b16 v[34:35], v58 offset:33280
    v_mfma_f32_32x32x16_bf16 v[16:31], v[44:47], v[108:111], v[16:31]
    ds_read_b64_tr_b16 v[36:37], v59 offset:32768
    ds_read_b64_tr_b16 v[38:39], v59 offset:33280
    s_waitcnt vmcnt(7) lgkmcnt(4)
    v_mfma_f32_32x32x16_bf16 v[0:15], v[48:51], v[112:115], v[0:15]
    s_add_u32 s37, s37, 2048
    s_and_b32 s37, s37, 0x7800
    buffer_load_dwordx4 v[108:111], v253, s[20:23], s38 offen offset:1024 sc1
    ds_read_b64_tr_b16 v[40:41], v58 offset:34816
    ds_read_b64_tr_b16 v[42:43], v58 offset:35328
    v_mfma_f32_32x32x16_bf16 v[16:31], v[52:55], v[112:115], v[16:31]
    ds_read_b64_tr_b16 v[44:45], v59 offset:34816
    ds_read_b64_tr_b16 v[46:47], v59 offset:35328
    s_waitcnt vmcnt(7) lgkmcnt(4)
    v_mfma_f32_32x32x16_bf16 v[0:15], v[32:35], v[116:119], v[0:15]
    s_add_u32 s38, s36, s37
    buffer_load_dwordx4 v[112:115], v253, s[20:23], s38 offen offset:0 sc1
    ds_read_b64_tr_b16 v[48:49], v58 offset:36864
    ds_read_b64_tr_b16 v[50:51], v58 offset:37376
    v_mfma_f32_32x32x16_bf16 v[16:31], v[36:39], v[116:119], v[16:31]
    ds_read_b64_tr_b16 v[52:53], v59 offset:36864
    ds_read_b64_tr_b16 v[54:55], v59 offset:37376
    s_waitcnt vmcnt(7) lgkmcnt(4)
    v_mfma_f32_32x32x16_bf16 v[0:15], v[40:43], v[120:123], v[0:15]
    s_add_u32 s37, s37, 2048
    s_and_b32 s37, s37, 0x7800
    buffer_load_dwordx4 v[116:119], v253, s[20:23], s38 offen offset:1024 sc1
    ds_read_b64_tr_b16 v[32:33], v58 offset:38912
    ds_read_b64_tr_b16 v[34:35], v58 offset:39424
    v_mfma_f32_32x32x16_bf16 v[16:31], v[44:47], v[120:123], v[16:31]
    ds_read_b64_tr_b16 v[36:37], v59 offset:38912
    ds_read_b64_tr_b16 v[38:39], v59 offset:39424
    s_waitcnt vmcnt(7) lgkmcnt(4)
    v_mfma_f32_32x32x16_bf16 v[0:15], v[48:51], v[124:127], v[0:15]
    s_add_u32 s38, s36, s37
    buffer_load_dwordx4 v[120:123], v253, s[20:23], s38 offen offset:0 sc1
    ds_read_b64_tr_b16 v[40:41], v58 offset:40960
    ds_read_b64_tr_b16 v[42:43], v58 offset:41472
    v_mfma_f32_32x32x16_bf16 v[16:31], v[52:55], v[124:127], v[16:31]
    ds_read_b64_tr_b16 v[44:45], v59 offset:40960
    ds_read_b64_tr_b16 v[46:47], v59 offset:41472
    s_waitcnt vmcnt(7) lgkmcnt(4)
    v_mfma_f32_32x32x16_bf16 v[0:15], v[32:35], v[128:131], v[0:15]
    s_add_u32 s37, s37, 2048
    s_and_b32 s37, s37, 0x7800
    buffer_load_dwordx4 v[124:127], v253, s[20:23], s38 offen offset:1024 sc1
    ds_read_b64_tr_b16 v[48:49], v58 offset:43008
    ds_read_b64_tr_b16 v[50:51], v58 offset:43520
    v_mfma_f32_32x32x16_bf16 v[16:31], v[36:39], v[128:131], v[16:31]
    ds_read_b64_tr_b16 v[52:53], v59 offset:43008
    ds_read_b64_tr_b16 v[54:55], v59 offset:43520
    s_waitcnt vmcnt(7) lgkmcnt(4)
    v_mfma_f32_32x32x16_bf16 v[0:15], v[40:43], v[132:135], v[0:15]
    s_add_u32 s38, s36, s37
    buffer_load_dwordx4 v[128:131], v253, s[20:23], s38 offen offset:0 sc1
    ds_read_b64_tr_b16 v[32:33], v58 offset:45056
    ds_read_b64_tr_b16 v[34:35], v58 offset:45568
    v_mfma_f32_32x32x16_bf16 v[16:31], v[44:47], v[132:135], v[16:31]
    ds_read_b64_tr_b16 v[36:37], v59 offset:45056
    ds_read_b64_tr_b16 v[38:39], v59 offset:45568
    s_waitcnt vmcnt(7) lgkmcnt(4)
    v_mfma_f32_32x32x16_bf16 v[0:15], v[48:51], v[136:139], v[0:15]
    s_add_u32 s37, s37, 2048
    s_and_b32 s37, s37, 0x7800
    buffer_load_dwordx4 v[132:135], v253, s[20:23], s38 offen offset:1024 sc1
    ds_read_b64_tr_b16 v[40:41], v58 offset:47104
    ds_read_b64_tr_b16 v[42:43], v58 offset:47616
    v_mfma_f32_32x32x16_bf16 v[16:31], v[52:55], v[136:139], v[16:31]
    ds_read_b64_tr_b16 v[44:45], v59 offset:47104
    ds_read_b64_tr_b16 v[46:47], v59 offset:47616
    s_barrier
    s_waitcnt vmcnt(7) lgkmcnt(4)
    v_mfma_f32_32x32x16_bf16 v[0:15], v[32:35], v[104:107], v[0:15]
    s_add_u32 s38, s36, s37
    buffer_load_dwordx4 v[136:139], v253, s[20:23], s38 offen offset:0 sc1
    ds_read_b64_tr_b16 v[48:49], v58 offset:49152
    ds_read_b64_tr_b16 v[50:51], v58 offset:49664
    v_mfma_f32_32x32x16_bf16 v[16:31], v[36:39], v[104:107], v[16:31]
    ds_read_b64_tr_b16 v[52:53], v59 offset:49152
    ds_read_b64_tr_b16 v[54:55], v59 offset:49664
    s_waitcnt vmcnt(7) lgkmcnt(4)
    v_mfma_f32_32x32x16_bf16 v[0:15], v[40:43], v[108:111], v[0:15]
    s_add_u32 s37, s37, 2048
    s_and_b32 s37, s37, 0x7800
    buffer_load_dwordx4 v[104:107], v253, s[20:23], s38 offen offset:1024 sc1
    ds_read_b64_tr_b16 v[32:33], v58 offset:51200
    ds_read_b64_tr_b16 v[34:35], v58 offset:51712
    v_mfma_f32_32x32x16_bf16 v[16:31], v[44:47], v[108:111], v[16:31]
    ds_read_b64_tr_b16 v[36:37], v59 offset:51200
    ds_read_b64_tr_b16 v[38:39], v59 offset:51712
    s_waitcnt vmcnt(7) lgkmcnt(4)
    v_mfma_f32_32x32x16_bf16 v[0:15], v[48:51], v[112:115], v[0:15]
    ds_read_b64_tr_b16 v[40:41], v58 offset:53248
    ds_read_b64_tr_b16 v[42:43], v58 offset:53760
    v_mfma_f32_32x32x16_bf16 v[16:31], v[52:55], v[112:115], v[16:31]
    ds_read_b64_tr_b16 v[44:45], v59 offset:53248
    ds_read_b64_tr_b16 v[46:47], v59 offset:53760
    s_waitcnt vmcnt(6) lgkmcnt(4)
    v_mfma_f32_32x32x16_bf16 v[0:15], v[32:35], v[116:119], v[0:15]
    ds_read_b64_tr_b16 v[48:49], v58 offset:55296
    ds_read_b64_tr_b16 v[50:51], v58 offset:55808
    v_mfma_f32_32x32x16_bf16 v[16:31], v[36:39], v[116:119], v[16:31]
    ds_read_b64_tr_b16 v[52:53], v59 offset:55296
    ds_read_b64_tr_b16 v[54:55], v59 offset:55808
    s_waitcnt vmcnt(5) lgkmcnt(4)
    v_mfma_f32_32x32x16_bf16 v[0:15], v[40:43], v[120:123], v[0:15]
    ds_read_b64_tr_b16 v[32:33], v58 offset:57344
    ds_read_b64_tr_b16 v[34:35], v58 offset:57856
    v_mfma_f32_32x32x16_bf16 v[16:31], v[44:47], v[120:123], v[16:31]
    ds_read_b64_tr_b16 v[36:37], v59 offset:57344
    ds_read_b64_tr_b16 v[38:39], v59 offset:57856
    s_waitcnt vmcnt(4) lgkmcnt(4)
    v_mfma_f32_32x32x16_bf16 v[0:15], v[48:51], v[124:127], v[0:15]
    ds_read_b64_tr_b16 v[40:41], v58 offset:59392
    ds_read_b64_tr_b16 v[42:43], v58 offset:59904
    v_mfma_f32_32x32x16_bf16 v[16:31], v[52:55], v[124:127], v[16:31]
    ds_read_b64_tr_b16 v[44:45], v59 offset:59392
    ds_read_b64_tr_b16 v[46:47], v59 offset:59904
    s_waitcnt vmcnt(3) lgkmcnt(4)
    v_mfma_f32_32x32x16_bf16 v[0:15], v[32:35], v[128:131], v[0:15]
    ds_read_b64_tr_b16 v[48:49], v58 offset:61440
    ds_read_b64_tr_b16 v[50:51], v58 offset:61952
    v_mfma_f32_32x32x16_bf16 v[16:31], v[36:39], v[128:131], v[16:31]
    ds_read_b64_tr_b16 v[52:53], v59 offset:61440
    ds_read_b64_tr_b16 v[54:55], v59 offset:61952
    s_waitcnt vmcnt(2) lgkmcnt(4)
    v_mfma_f32_32x32x16_bf16 v[0:15], v[40:43], v[132:135], v[0:15]
    ds_read_b64_tr_b16 v[32:33], v58 offset:63488
    ds_read_b64_tr_b16 v[34:35], v58 offset:64000
    v_mfma_f32_32x32x16_bf16 v[16:31], v[44:47], v[132:135], v[16:31]
    ds_read_b64_tr_b16 v[36:37], v59 offset:63488
    ds_read_b64_tr_b16 v[38:39], v59 offset:64000
    s_waitcnt vmcnt(1) lgkmcnt(4)
    v_mfma_f32_32x32x16_bf16 v[0:15], v[48:51], v[136:139], v[0:15]
    v_mfma_f32_32x32x16_bf16 v[16:31], v[52:55], v[136:139], v[16:31]
    s_waitcnt vmcnt(0) lgkmcnt(0)
    v_mfma_f32_32x32x16_bf16 v[0:15], v[32:35], v[104:107], v[0:15]
    v_mfma_f32_32x32x16_bf16 v[16:31], v[36:39], v[104:107], v[16:31]
    s_lshl_b32 s35, s24, 4
    s_add_u32 s35, s35, s98
    s_lshl_b32 s35, s35, 14
    s_lshl_b32 s34, s3, 12
    s_add_u32 s35, s35, s34
    s_add_u32 s35, s35, 0x2000000
    s_lshl_b32 s30, s99, 13
    s_add_u32 s30, s30, s26
    s_add_u32 s30, s30, 0xc00000
    s_lshl_b32 s31, s98, 9
    s_add_u32 s31, s31, s30
    v_mov_b32 v96, 0
    v_mov_b32 v97, 0
    v_mov_b32 v98, 0
    v_mov_b32 v99, v242
    v_cvt_pk_bf16_f32 v208, v0, v1
    v_cvt_pk_bf16_f32 v209, v2, v3
    v_cvt_pk_bf16_f32 v210, v4, v5
    v_cvt_pk_bf16_f32 v211, v6, v7
    v_cvt_pk_bf16_f32 v212, v8, v9
    v_cvt_pk_bf16_f32 v213, v10, v11
    v_cvt_pk_bf16_f32 v214, v12, v13
    v_cvt_pk_bf16_f32 v215, v14, v15
    v_cvt_pk_bf16_f32 v216, v16, v17
    v_cvt_pk_bf16_f32 v217, v18, v19
    v_cvt_pk_bf16_f32 v218, v20, v21
    v_cvt_pk_bf16_f32 v219, v22, v23
    v_cvt_pk_bf16_f32 v220, v24, v25
    v_cvt_pk_bf16_f32 v221, v26, v27
    v_cvt_pk_bf16_f32 v222, v28, v29
    v_cvt_pk_bf16_f32 v223, v30, v31
    s_cmp_lg_u32 s26, 0
    s_cbranch_scc1 sk_29
    s_cmp_lg_u32 s77, 0
    s_cbranch_scc1 lc_30
    buffer_store_dwordx4 v[208:211], v100, s[20:23], s35 offen offset:0 sc1
    buffer_store_dwordx4 v[212:215], v100, s[20:23], s35 offen offset:512 sc1
    buffer_store_dwordx4 v[216:219], v100, s[20:23], s35 offen offset:1024 sc1
    buffer_store_dwordx4 v[220:223], v100, s[20:23], s35 offen offset:1536 sc1
    s_branch lc_31
lc_30:
    buffer_store_dwordx4 v[208:211], v100, s[20:23], s35 offen offset:0
    buffer_store_dwordx4 v[212:215], v100, s[20:23], s35 offen offset:512
    buffer_store_dwordx4 v[216:219], v100, s[20:23], s35 offen offset:1024
    buffer_store_dwordx4 v[220:223], v100, s[20:23], s35 offen offset:1536
lc_31:
    ds_write_b128 v101, v[208:211] offset:0
    ds_write_b128 v101, v[212:215] offset:512
    ds_write_b128 v101, v[216:219] offset:1024
    ds_write_b128 v101, v[220:223] offset:1536
sk_29:
    v_dot2c_f32_bf16 v96, 0x3f803f80, v208
    v_dot2c_f32_bf16 v97, v208, v208
    v_dot2c_f32_bf16 v98, v224, v208
    v_dot2c_f32_bf16 v96, 0x3f803f80, v209
    v_dot2c_f32_bf16 v97, v209, v209
    v_dot2c_f32_bf16 v98, v225, v209
    v_dot2c_f32_bf16 v96, 0x3f803f80, v210
    v_dot2c_f32_bf16 v97, v210, v210
    v_dot2c_f32_bf16 v98, v226, v210
    v_dot2c_f32_bf16 v96, 0x3f803f80, v211
    v_dot2c_f32_bf16 v97, v211, v211
    v_dot2c_f32_bf16 v98, v227, v211
    v_dot2c_f32_bf16 v96, 0x3f803f80, v212
    v_dot2c_f32_bf16 v97, v212, v212
    v_dot2c_f32_bf16 v98, v228, v212
    v_dot2c_f32_bf16 v96, 0x3f803f80, v213
    v_dot2c_f32_bf16 v97, v213, v213
    v_dot2c_f32_bf16 v98, v229, v213
    v_dot2c_f32_bf16 v96, 0x3f803f80, v214
    v_dot2c_f32_bf16 v97, v214, v214
    v_dot2c_f32_bf16 v98, v230, v214
    v_dot2c_f32_bf16 v96, 0x3f803f80, v215
    v_dot2c_f32_bf16 v97, v215, v215
    v_dot2c_f32_bf16 v98, v231, v215
    v_dot2c_f32_bf16 v96, 0x3f803f80, v216
    v_dot2c_f32_bf16 v97, v216, v216
    v_dot2c_f32_bf16 v98, v232, v216
    v_dot2c_f32_bf16 v96, 0x3f803f80, v217
    v_dot2c_f32_bf16 v97, v217, v217
    v_dot2c_f32_bf16 v98, v233, v217
    v_dot2c_f32_bf16 v96, 0x3f803f80, v218
    v_dot2c_f32_bf16 v97, v218, v218
    v_dot2c_f32_bf16 v98, v234, v218
    v_dot2c_f32_bf16 v96, 0x3f803f80, v219
    v_dot2c_f32_bf16 v97, v219, v219
    v_dot2c_f32_bf16 v98, v235, v219
    v_dot2c_f32_bf16 v96, 0x3f803f80, v220
    v_dot2c_f32_bf16 v97, v220, v220
    v_dot2c_f32_bf16 v98, v236, v220
    v_dot2c_f32_bf16 v96, 0x3f803f80, v221
    v_dot2c_f32_bf16 v97, v221, v221
    v_dot2c_f32_bf16 v98, v237, v221
    v_dot2c_f32_bf16 v96, 0x3f803f80, v222
    v_dot2c_f32_bf16 v97, v222, v222
    v_dot2c_f32_bf16 v98, v238, v222
    v_dot2c_f32_bf16 v96, 0x3f803f80, v223
    v_dot2c_f32_bf16 v97, v223, v223
    v_dot2c_f32_bf16 v98, v239, v223
    s_nop 0
    v_mov_b32 v48, v96
    v_mov_b32 v49, v97
    v_mov_b32 v50, v98
    v_mov_b32 v51, v99
    v_permlane32_swap_b32 v96, v48
    v_permlane32_swap_b32 v97, v49
    v_permlane32_swap_b32 v98, v50
    v_permlane32_swap_b32 v99, v51
    v_add_f32 v96, v96, v48
    v_add_f32 v97, v97, v49
    v_add_f32 v98, v98, v50
    v_add_f32 v99, v99, v51
    s_mov_b32 exec_hi, 0
    s_waitcnt vmcnt(0)
    s_cmp_lg_u32 s77, 0
    s_cbranch_scc1 lc_32
    buffer_store_dwordx4 v[96:99], v253, s[20:23], s31 offen sc1
    s_branch lc_33
lc_32:
    buffer_store_dwordx4 v[96:99], v253, s[20:23], s31 offen
lc_33:
    s_mov_b64 exec, -1
    s_cmp_lg_u32 s26, 0
    s_cbranch_scc1 e_final
    s_mov_b32 s26, 16777216
    s_and_b32 s30, s3, 1
    s_lshl_b32 s30, s30, 13
    v_add_u32 v176, s30, v253
    v_add_u32 v177, 1024, v176
    v_mov_b32 v0, 0
    v_mov_b32 v1, 0
    v_mov_b32 v2, 0
    v_mov_b32 v3, 0
    v_mov_b32 v4, 0
    v_mov_b32 v5, 0
    v_mov_b32 v6, 0
    v_mov_b32 v7, 0
    v_mov_b32 v8, 0
    v_mov_b32 v9, 0
    v_mov_b32 v10, 0
    v_mov_b32 v11, 0
    v_mov_b32 v12, 0
    v_mov_b32 v13, 0
    v_mov_b32 v14, 0
    v_mov_b32 v15, 0
    v_mov_b32 v16, 0
    v_mov_b32 v17, 0
    v_mov_b32 v18, 0
    v_mov_b32 v19, 0
    v_mov_b32 v20, 0
    v_mov_b32 v21, 0
    v_mov_b32 v22, 0
    v_mov_b32 v23, 0
    v_mov_b32 v24, 0
    v_mov_b32 v25, 0
    v_mov_b32 v26, 0
    v_mov_b32 v27, 0
    v_mov_b32 v28, 0
    v_mov_b32 v29, 0
    v_mov_b32 v30, 0
    v_mov_b32 v31, 0
    v_mov_b32 v32, 0
    v_mov_b32 v33, 0
    v_mov_b32 v34, 0
    v_mov_b32 v35, 0
    v_mov_b32 v36, 0
    v_mov_b32 v37, 0
    v_mov_b32 v38, 0
    v_mov_b32 v39, 0
    v_mov_b32 v40, 0
    v_mov_b32 v41, 0
    v_mov_b32 v42, 0
    v_mov_b32 v43, 0
    v_mov_b32 v44, 0
    v_mov_b32 v45, 0
    v_mov_b32 v46, 0
    v_mov_b32 v47, 0
    v_mov_b32 v48, 0
    v_mov_b32 v49, 0
    v_mov_b32 v50, 0
    v_mov_b32 v51, 0
    v_mov_b32 v52, 0
    v_mov_b32 v53, 0
    v_mov_b32 v54, 0
    v_mov_b32 v55, 0
    v_mov_b32 v56, 0
    v_mov_b32 v57, 0
    v_mov_b32 v58, 0
    v_mov_b32 v59, 0
    v_mov_b32 v60, 0
    v_mov_b32 v61, 0
    v_mov_b32 v62, 0
    v_mov_b32 v63, 0
    v_mov_b32 v64, 0
    v_mov_b32 v65, 0
    v_mov_b32 v66, 0
    v_mov_b32 v67, 0
    v_mov_b32 v68, 0
    v_mov_b32 v69, 0
    v_mov_b32 v70, 0
    v_mov_b32 v71, 0
    v_mov_b32 v72, 0
    v_mov_b32 v73, 0
    v_mov_b32 v74, 0
    v_mov_b32 v75, 0
    v_mov_b32 v76, 0
    v_mov_b32 v77, 0
    v_mov_b32 v78, 0
    v_mov_b32 v79, 0
    v_mov_b32 v80, 0
    v_mov_b32 v81, 0
    v_mov_b32 v82, 0
    v_mov_b32 v83, 0
    v_mov_b32 v84, 0
    v_mov_b32 v85, 0
    v_mov_b32 v86, 0
    v_mov_b32 v87, 0
    v_mov_b32 v88, 0
    v_mov_b32 v89, 0
    v_mov_b32 v90, 0
    v_mov_b32 v91, 0
    v_mov_b32 v92, 0
    v_mov_b32 v93, 0
    v_mov_b32 v94, 0
    v_mov_b32 v95, 0
    s_waitcnt lgkmcnt(0)
    s_branch e_q
e_final:
    s_load_dwordx2 s[12:13], s[0:1], 64
    s_mov_b32 s14, 0x400000
    s_mov_b32 s15, 0x20000
    s_mov_b32 s78, s27
pl_34:
    s_lshl_b32 s30, s99, 13
    s_add_u32 s30, s30, 0x1c00000
    s_add_u32 s31, s30, 4096
    buffer_load_dwordx4 v[64:67], v253, s[20:23], s30 offen offset:0 sc1
    buffer_load_dwordx4 v[68:71], v253, s[20:23], s30 offen offset:1024 sc1
    buffer_load_dwordx4 v[72:75], v253, s[20:23], s30 offen offset:2048 sc1
    buffer_load_dwordx4 v[76:79], v253, s[20:23], s30 offen offset:3072 sc1
    buffer_load_dwordx4 v[80:83], v253, s[20:23], s31 offen offset:0 sc1
    buffer_load_dwordx4 v[84:87], v253, s[20:23], s31 offen offset:1024 sc1
    buffer_load_dwordx4 v[88:91], v253, s[20:23], s31 offen offset:2048 sc1
    buffer_load_dwordx4 v[92:95], v253, s[20:23], s31 offen offset:3072 sc1
    s_waitcnt vmcnt(0)
pc_35:
    v_max3_u32 v48, v64, v65, v66
    v_max3_u32 v48, v48, v67, v68
    v_max3_u32 v48, v48, v69, v70
    v_max3_u32 v48, v48, v71, v72
    v_max3_u32 v48, v48, v73, v74
    v_max3_u32 v48, v48, v75, v76
    v_max3_u32 v48, v48, v77, v78
    v_max3_u32 v48, v48, v79, v80
    v_max3_u32 v48, v48, v81, v82
    v_max3_u32 v48, v48, v83, v84
    v_max3_u32 v48, v48, v85, v86
    v_max3_u32 v48, v48, v87, v88
    v_max3_u32 v48, v48, v89, v90
    v_max3_u32 v48, v48, v91, v92
    v_max3_u32 v48, v48, v93, v94
    v_max_u32 v48, v48, v95
    v_cmp_eq_u32 vcc, -1, v48
    s_cbranch_vccz pd_36
    s_sub_u32 s78, s78, 1
    s_cmp_lg_u32 s78, 0
    s_cbranch_scc1 pl_34
    s_mov_b32 s27, 1
pd_36:
    v_pk_add_f32 v[64:65], v[64:65], v[68:69]
    v_pk_add_f32 v[66:67], v[66:67], v[70:71]
    v_pk_add_f32 v[64:65], v[64:65], v[72:73]
    v_pk_add_f32 v[66:67], v[66:67], v[74:75]
    v_pk_add_f32 v[64:65], v[64:65], v[76:77]
    v_pk_add_f32 v[66:67], v[66:67], v[78:79]
    v_pk_add_f32 v[64:65], v[64:65], v[80:81]
    v_pk_add_f32 v[66:67], v[66:67], v[82:83]
    v_pk_add_f32 v[64:65], v[64:65], v[84:85]
    v_pk_add_f32 v[66:67], v[66:67], v[86:87]
    v_pk_add_f32 v[64:65], v[64:65], v[88:89]
    v_pk_add_f32 v[66:67], v[66:67], v[90:91]
    v_pk_add_f32 v[64:65], v[64:65], v[92:93]
    v_pk_add_f32 v[66:67], v[66:67], v[94:95]
    v_mov_b32 v48, v64
    v_mov_b32 v49, v65
    v_mov_b32 v50, v66
    v_mov_b32 v51, v67
    v_permlane32_swap_b32 v64, v48
    v_permlane32_swap_b32 v65, v49
    v_permlane32_swap_b32 v66, v50
    v_permlane32_swap_b32 v67, v51
    v_add_f32 v64, v64, v48
    v_add_f32 v65, v65, v49
    v_add_f32 v66, v66, v50
    v_add_f32 v67, v67, v51
    v_mul_f32 v54, 0x3a800000, v64
    v_mul_f32 v65, 0x3a800000, v65
    v_fma_f32 v65, -v54, v54, v65
    v_max_f32 v65, 0, v65
    v_add_f32 v55, 0x3727c5ac, v65
    v_rsq_f32 v55, v55
    v_fma_f32 v52, -v54, v67, v66
    v_and_b32 v53, 31, v252
    v_mul_f32 v52, v52, v55
    s_lshl_b32 s32, s99, 5
    v_add_u32 v53, s32, v53
    v_mov_b32 v48, v52
    s_nop 1
    v_max_f32_dpp v48, v48, v48 quad_perm:[1,0,3,2] row_mask:0xf bank_mask:0xf
    s_nop 1
    v_max_f32_dpp v48, v48, v48 quad_perm:[2,3,0,1] row_mask:0xf bank_mask:0xf
    s_nop 1
    v_max_f32_dpp v48, v48, v48 row_half_mirror row_mask:0xf bank_mask:0xf
    s_nop 1
    v_max_f32_dpp v48, v48, v48 row_mirror row_mask:0xf bank_mask:0xf
    v_mov_b32 v49, v48
    s_nop 1
    v_permlane16_swap_b32 v48, v49
    v_max_f32 v48, v48, v49
    v_cmp_eq_f32 vcc, v48, v52
    v_lshrrev_b32 v50, 5, v252
    v_lshlrev_b32 v50, 4, v50
    s_lshl_b32 s32, s99, 11
    s_lshl_b32 s33, s98, 7
    s_add_u32 s32, s32, s33
    s_add_u32 s32, s32, 0x1d60000
    s_lshl_b32 s34, s99, 4
    s_add_u32 s34, s34, 0x1dc0000
    s_ff1_i32_b32 s35, vcc_lo
    s_lshl_b32 s35, 1, s35
    s_cmp_eq_u32 s25, 0
    s_cselect_b32 exec_lo, s35, 0
    s_mov_b32 exec_hi, 0
    buffer_store_dwordx4 v[52:55], v50, s[20:23], s34 offen sc1
    s_mov_b32 exec_lo, s35
    s_mov_b32 exec_hi, s35
    buffer_store_dwordx4 v[208:211], v50, s[20:23], s32 offen offset:0 sc1
    buffer_store_dwordx4 v[212:215], v50, s[20:23], s32 offen offset:32 sc1
    buffer_store_dwordx4 v[216:219], v50, s[20:23], s32 offen offset:64 sc1
    buffer_store_dwordx4 v[220:223], v50, s[20:23], s32 offen offset:96 sc1
    s_mov_b64 exec, -1
    v_add_f32 v240, 1.0, v55
    v_mul_f32 v241, v54, v55
    v_sub_f32 v241, 0, v241
    v_pk_fma_f32 v[0:1], v[0:1], v[240:241], v[240:241] op_sel:[0,0,1] op_sel_hi:[1,0,1]
    v_pk_fma_f32 v[2:3], v[2:3], v[240:241], v[240:241] op_sel:[0,0,1] op_sel_hi:[1,0,1]
    v_pk_fma_f32 v[4:5], v[4:5], v[240:241], v[240:241] op_sel:[0,0,1] op_sel_hi:[1,0,1]
    v_pk_fma_f32 v[6:7], v[6:7], v[240:241], v[240:241] op_sel:[0,0,1] op_sel_hi:[1,0,1]
    v_pk_fma_f32 v[8:9], v[8:9], v[240:241], v[240:241] op_sel:[0,0,1] op_sel_hi:[1,0,1]
    v_pk_fma_f32 v[10:11], v[10:11], v[240:241], v[240:241] op_sel:[0,0,1] op_sel_hi:[1,0,1]
    v_pk_fma_f32 v[12:13], v[12:13], v[240:241], v[240:241] op_sel:[0,0,1] op_sel_hi:[1,0,1]
    v_pk_fma_f32 v[14:15], v[14:15], v[240:241], v[240:241] op_sel:[0,0,1] op_sel_hi:[1,0,1]
    v_pk_fma_f32 v[16:17], v[16:17], v[240:241], v[240:241] op_sel:[0,0,1] op_sel_hi:[1,0,1]
    v_pk_fma_f32 v[18:19], v[18:19], v[240:241], v[240:241] op_sel:[0,0,1] op_sel_hi:[1,0,1]
    v_pk_fma_f32 v[20:21], v[20:21], v[240:241], v[240:241] op_sel:[0,0,1] op_sel_hi:[1,0,1]
    v_pk_fma_f32 v[22:23], v[22:23], v[240:241], v[240:241] op_sel:[0,0,1] op_sel_hi:[1,0,1]
    v_pk_fma_f32 v[24:25], v[24:25], v[240:241], v[240:241] op_sel:[0,0,1] op_sel_hi:[1,0,1]
    v_pk_fma_f32 v[26:27], v[26:27], v[240:241], v[240:241] op_sel:[0,0,1] op_sel_hi:[1,0,1]
    v_pk_fma_f32 v[28:29], v[28:29], v[240:241], v[240:241] op_sel:[0,0,1] op_sel_hi:[1,0,1]
    v_pk_fma_f32 v[30:31], v[30:31], v[240:241], v[240:241] op_sel:[0,0,1] op_sel_hi:[1,0,1]
    v_cvt_pk_bf16_f32 v64, v0, v1
    v_cvt_pk_bf16_f32 v65, v2, v3
    v_cvt_pk_bf16_f32 v66, v4, v5
    v_cvt_pk_bf16_f32 v67, v6, v7
    v_cvt_pk_bf16_f32 v68, v8, v9
    v_cvt_pk_bf16_f32 v69, v10, v11
    v_cvt_pk_bf16_f32 v70, v12, v13
    v_cvt_pk_bf16_f32 v71, v14, v15
    v_cvt_pk_bf16_f32 v72, v16, v17
    v_cvt_pk_bf16_f32 v73, v18, v19
    v_cvt_pk_bf16_f32 v74, v20, v21
    v_cvt_pk_bf16_f32 v75, v22, v23
    v_cvt_pk_bf16_f32 v76, v24, v25
    v_cvt_pk_bf16_f32 v77, v26, v27
    v_cvt_pk_bf16_f32 v78, v28, v29
    v_cvt_pk_bf16_f32 v79, v30, v31
    v_permlane32_swap_b32 v64, v66
    v_permlane32_swap_b32 v65, v67
    v_permlane32_swap_b32 v68, v70
    v_permlane32_swap_b32 v69, v71
    v_permlane32_swap_b32 v72, v74
    v_permlane32_swap_b32 v73, v75
    v_permlane32_swap_b32 v76, v78
    v_permlane32_swap_b32 v77, v79
    v_lshl_add_u32 v50, v53, 11, v50
    s_mov_b32 s79, s26
    s_cmp_lg_u32 s3, 0
    s_cbranch_scc1 sk_38
    s_mov_b32 s78, s27
pl_39:
    s_add_u32 s32, s79, 0xdc0000
    buffer_load_dwordx4 v[0:3], v253, s[20:23], s32 offen sc1
    s_waitcnt vmcnt(0)
pc_40:
    v_max3_u32 v4, v0, v1, v2
    v_max_u32 v4, v4, v3
    v_cmp_eq_u32 vcc, -1, v4
    s_cbranch_vccz pd_41
    s_sub_u32 s78, s78, 1
    s_cmp_lg_u32 s78, 0
    s_cbranch_scc1 pl_39
    s_mov_b32 s27, 1
pd_41:
    v_mov_b32 v4, v0
    s_nop 1
    v_max_f32_dpp v4, v4, v4 quad_perm:[1,0,3,2] row_mask:0xf bank_mask:0xf
    s_nop 1
    v_max_f32_dpp v4, v4, v4 quad_perm:[2,3,0,1] row_mask:0xf bank_mask:0xf
    s_nop 1
    v_max_f32_dpp v4, v4, v4 row_half_mirror row_mask:0xf bank_mask:0xf
    s_nop 1
    v_max_f32_dpp v4, v4, v4 row_mirror row_mask:0xf bank_mask:0xf
    v_mov_b32 v5, v4
    s_nop 1
    v_permlane16_swap_b32 v4, v5
    v_max_f32 v4, v4, v5
    v_mov_b32 v5, v4
    s_nop 1
    v_permlane32_swap_b32 v4, v5
    v_max_f32 v4, v4, v5
    v_cmp_eq_f32 vcc, v4, v0
    s_ff1_i32_b64 s32, vcc
    s_and_b32 s32, s32, 63
    s_lshl_b64 exec, 1, s32
    ds_write_b128 v189, v[0:3] offset:3072
    s_mov_b64 exec, -1
sk_38:
    s_waitcnt lgkmcnt(0)
    s_barrier
    ds_read_b32 v0, v189 offset:3076
    s_waitcnt lgkmcnt(0)
    v_and_b32 v0, 0x7ff, v0
    v_cmp_ne_u32 vcc, v0, v53
    s_mov_b64 exec, vcc
    buffer_store_dwordx4 v[64:67], v50, s[12:15], s33 offen offset:0
    buffer_store_dwordx4 v[68:71], v50, s[12:15], s33 offen offset:32
    buffer_store_dwordx4 v[72:75], v50, s[12:15], s33 offen offset:64
    buffer_store_dwordx4 v[76:79], v50, s[12:15], s33 offen offset:96
    s_mov_b64 exec, -1
    s_branch k_end
l_start:
    v_lshrrev_b32 v21, 3, v252
    v_lshrrev_b32 v20, 4, v252
    v_xor_b32 v20, v20, v252
    v_and_b32 v20, 7, v20
    v_lshlrev_b32 v20, 4, v20
    v_lshl_add_u32 v4, v21, 11, v20
    v_xor_b32 v5, 64, v4
    v_add_u32 v5, 15360, v5
    v_add_u32 v6, 30720, v4
    v_add_u32 v7, 30720, v5
    s_lshl_b32 s84, s99, 16
    s_lshl_b32 s85, s25, 7
    s_lshl_b32 s86, s28, 12
    s_mul_i32 s87, s28, 6144
    v_and_b32 v20, 4, v21
    v_add_u32 v20, v20, v21
    v_mul_u32_u24 v20, 6144, v20
    v_and_b32 v21, 6, v21
    v_xor_b32 v21, v21, v252
    v_and_b32 v21, 7, v21
    v_lshl_add_u32 v20, v21, 4, v20
    s_mul_i32 s32, s28, 3
    s_bfe_u32 s33, s32, 0x10001
    s_mul_i32 s33, s33, 196608
    s_and_b32 s34, s32, 1
    s_mul_i32 s34, s34, 24576
    s_add_u32 s33, s33, s34
    s_lshr_b32 s34, s32, 2
    s_lshl_b32 s34, s34, 11
    s_add_u32 s33, s33, s34
    v_add_u32 v8, s33, v20
    v_add_u32 v9, 97280, v8
    s_add_u32 s32, s32, 1
    s_bfe_u32 s33, s32, 0x10001
    s_mul_i32 s33, s33, 196608
    s_and_b32 s34, s32, 1
    s_mul_i32 s34, s34, 24576
    s_add_u32 s33, s33, s34
    s_lshr_b32 s34, s32, 2
    s_lshl_b32 s34, s34, 11
    s_add_u32 s33, s33, s34
    s_sub_u32 s33, s33, 2048
    v_add_u32 v10, s33, v20
    v_add_u32 v11, 97280, v10
    s_add_u32 s32, s32, 1
    s_bfe_u32 s33, s32, 0x10001
    s_mul_i32 s33, s33, 196608
    s_and_b32 s34, s32, 1
    s_mul_i32 s34, s34, 24576
    s_add_u32 s33, s33, s34
    s_lshr_b32 s34, s32, 2
    s_lshl_b32 s34, s34, 11
    s_add_u32 s33, s33, s34
    v_add_u32 v12, s33, v20
    v_add_u32 v13, 97280, v12
    s_waitcnt lgkmcnt(0)
    s_mov_b64 s[16:17], s[6:7]
    s_mov_b32 s6, 0x400000
    s_mov_b32 s7, 0x20000
    s_add_u32 s96, s94, 0
    s_and_b32 s96, s96, 15
    s_lshl_b32 s97, s96, 7
    s_add_u32 s97, s97, s84
    s_add_u32 m0, s86, 147456
    s_nop 0
    buffer_load_dwordx4 v4, s[4:7], s97 offen offset:0 lds
    buffer_load_dwordx4 v5, s[4:7], s97 offen offset:1024 lds
    buffer_load_dwordx4 v6, s[4:7], s97 offen offset:2048 lds
    buffer_load_dwordx4 v7, s[4:7], s97 offen offset:3072 lds
    s_add_u32 s96, s94, 0
    s_and_b32 s96, s96, 15
    s_mul_i32 s96, s96, 393216
    s_add_u32 s96, s96, s85
    s_add_u32 m0, s87, 40960
    s_nop 0
    buffer_load_dwordx4 v8, s[16:19], s96 offen offset:0 lds
    buffer_load_dwordx4 v9, s[16:19], s96 offen offset:1024 lds
    buffer_load_dwordx4 v10, s[16:19], s96 offen offset:2048 lds
    buffer_load_dwordx4 v11, s[16:19], s96 offen offset:3072 lds
    s_mov_b32 s40, 0xffffffff
    s_mov_b32 s41, 0xfffffff0
    s_mov_b32 s42, 0xfffffffe
    s_mov_b32 s43, 0xffffffe0
    s_mov_b32 s44, 0xfffffffc
    s_mov_b32 s45, 0xffffffc0
    s_mov_b32 s46, 0xfffffff8
    s_mov_b32 s47, 0xffffff80
    s_mov_b32 s48, 0xffff0000
    s_mov_b32 s49, 0xfff00000
    s_mov_b32 s50, 0xfffe0000
    s_mov_b32 s51, 0xffe00000
    s_mov_b32 s52, 0xfffc0000
    s_mov_b32 s53, 0xffc00000
    s_mov_b32 s54, 0xfff80000
    s_mov_b32 s55, 0xff800000
    s_mov_b32 s56, 0xffffff00
    s_mov_b32 s57, 0xfffff000
    s_mov_b32 s58, 0xfffffe00
    s_mov_b32 s59, 0xffffe000
    s_mov_b32 s60, 0xfffffc00
    s_mov_b32 s61, 0xffffc000
    s_mov_b32 s62, 0xfffff800
    s_mov_b32 s63, 0xffff8000
    s_mov_b32 s64, 0xff000000
    s_mov_b32 s65, 0xf0000000
    s_mov_b32 s66, 0xfe000000
    s_mov_b32 s67, 0xe0000000
    s_mov_b32 s68, 0xfc000000
    s_mov_b32 s69, 0xc0000000
    s_mov_b32 s70, 0xf8000000
    s_mov_b32 s71, 0x80000000
    v_bfe_u32 v20, v252, 3, 2
    v_lshrrev_b32 v21, 5, v252
    v_lshl_add_u32 v20, v21, 3, v20
    s_lshr_b32 s32, s28, 1
    s_lshl_b32 s32, s32, 4
    s_and_b32 s33, s28, 1
    s_lshl_b32 s33, s33, 2
    s_add_u32 s32, s32, s33
    v_add_u32 v20, s32, v20
    v_lshlrev_b32 v20, 11, v20
    v_lshrrev_b32 v21, 2, v252
    v_and_b32 v21, 4, v21
    v_xor_b32 v21, v21, v252
    v_and_b32 v21, 7, v21
    v_lshl_add_u32 v20, v21, 4, v20
    s_lshl_b32 s32, s98, 7
    v_add_u32 v14, s32, v20
    v_lshrrev_b32 v20, 2, v252
    v_lshlrev_b32 v20, 2, v20
    v_bfe_u32 v21, v252, 1, 1
    v_add_u32 v20, v20, v21
    v_mul_u32_u24 v20, 28672, v20
    v_and_b32 v21, 1, v252
    v_lshl_add_u32 v20, v21, 4, v20
    s_mul_i32 s30, s28, 1835008
    s_lshl_b32 s31, s29, 5
    s_add_u32 s30, s30, s31
    v_add_u32 v152, s30, v20
    v_lshlrev_b32 v21, 14, v21
    v_lshrrev_b32 v20, 1, v252
    v_lshl_add_u32 v20, v20, 4, v21
    s_lshl_b32 s30, s28, 9
    s_lshl_b32 s31, s29, 15
    s_add_u32 s30, s30, s31
    v_add_u32 v153, s30, v20
    s_getreg_b32 s88, hwreg(HW_REG_XCC_ID, 0, 4)
    s_or_b32 s88, s88, 16
    s_mov_b32 s73, -1
    s_mov_b32 s100, 0
    v_lshlrev_b32 v15, 2, v252
    s_add_u32 m0, s87, 45056
    s_nop 0
    buffer_load_dwordx4 v12, s[16:19], s96 offen offset:0 lds
    buffer_load_dwordx4 v13, s[16:19], s96 offen offset:1024 lds
    s_add_u32 s96, s95, 1
    s_and_b32 s96, s96, 15
    s_lshl_b32 s97, s96, 7
    s_add_u32 s97, s97, s84
    s_add_u32 m0, s86, 131072
    s_nop 0
    buffer_load_dwordx4 v4, s[4:7], s97 offen offset:0 lds
    buffer_load_dwordx4 v5, s[4:7], s97 offen offset:1024 lds
    buffer_load_dwordx4 v6, s[4:7], s97 offen offset:2048 lds
    buffer_load_dwordx4 v7, s[4:7], s97 offen offset:3072 lds
    s_add_u32 s96, s95, 1
    s_and_b32 s96, s96, 15
    s_mul_i32 s96, s96, 393216
    s_add_u32 s96, s96, s85
    s_add_u32 m0, s87, 65536
    s_nop 0
    buffer_load_dwordx4 v8, s[16:19], s96 offen offset:0 lds
    buffer_load_dwordx4 v9, s[16:19], s96 offen offset:1024 lds
    buffer_load_dwordx4 v10, s[16:19], s96 offen offset:2048 lds
    s_waitcnt vmcnt(7)
    s_barrier
    buffer_load_dwordx4 v11, s[16:19], s96 offen offset:3072 lds
    s_add_u32 m0, s87, 69632
    s_nop 0
    buffer_load_dwordx4 v12, s[16:19], s96 offen offset:0 lds
    buffer_load_dwordx4 v13, s[16:19], s96 offen offset:1024 lds
    s_add_u32 s96, s94, 2
    s_and_b32 s96, s96, 15
    s_lshl_b32 s97, s96, 7
    s_add_u32 s97, s97, s84
    s_add_u32 m0, s86, 114688
    s_nop 0
    buffer_load_dwordx4 v4, s[4:7], s97 offen offset:0 lds
    buffer_load_dwordx4 v5, s[4:7], s97 offen offset:1024 lds
    buffer_load_dwordx4 v6, s[4:7], s97 offen offset:2048 lds
    buffer_load_dwordx4 v7, s[4:7], s97 offen offset:3072 lds
    s_add_u32 s96, s94, 2
    s_and_b32 s96, s96, 15
    s_mul_i32 s96, s96, 393216
    s_add_u32 s96, s96, s85
    s_add_u32 m0, s87, 90112
    s_nop 0
    buffer_load_dwordx4 v8, s[16:19], s96 offen offset:0 lds
    buffer_load_dwordx4 v9, s[16:19], s96 offen offset:1024 lds
    buffer_load_dwordx4 v10, s[16:19], s96 offen offset:2048 lds
    buffer_load_dwordx4 v11, s[16:19], s96 offen offset:3072 lds
    s_add_u32 m0, s87, 94208
    s_nop 0
    buffer_load_dwordx4 v12, s[16:19], s96 offen offset:0 lds
    buffer_load_dwordx4 v13, s[16:19], s96 offen offset:1024 lds
    s_waitcnt vmcnt(10) lgkmcnt(0)
    s_barrier
    s_add_u32 s96, s95, 3
    s_and_b32 s96, s96, 15
    s_lshl_b32 s97, s96, 7
    s_add_u32 s97, s97, s84
    s_add_u32 m0, s86, 147456
    s_nop 0
    buffer_load_dwordx4 v4, s[4:7], s97 offen offset:0 lds
    buffer_load_dwordx4 v5, s[4:7], s97 offen offset:1024 lds
    buffer_load_dwordx4 v6, s[4:7], s97 offen offset:2048 lds
    buffer_load_dwordx4 v7, s[4:7], s97 offen offset:3072 lds
    s_add_u32 s96, s95, 3
    s_and_b32 s96, s96, 15
    s_mul_i32 s96, s96, 393216
    s_add_u32 s96, s96, s85
    s_add_u32 m0, s87, 40960
    s_nop 0
    buffer_load_dwordx4 v8, s[16:19], s96 offen offset:0 lds
    buffer_load_dwordx4 v9, s[16:19], s96 offen offset:1024 lds
    buffer_load_dwordx4 v10, s[16:19], s96 offen offset:2048 lds
    buffer_load_dwordx4 v11, s[16:19], s96 offen offset:3072 lds
    s_add_u32 m0, s87, 45056
    s_nop 0
    buffer_load_dwordx4 v12, s[16:19], s96 offen offset:0 lds
    buffer_load_dwordx4 v13, s[16:19], s96 offen offset:1024 lds
    v_mov_b32 v16, -1
    v_mov_b32 v17, -1
    v_mov_b32 v18, -1
    v_mov_b32 v19, -1
    s_lshr_b32 s30, s28, 1
    s_mul_i32 s30, s30, 16777216
    s_and_b32 s31, s28, 1
    s_lshl_b32 s32, s31, 20
    s_lshl_b32 s33, s72, 10
    s_add_u32 s32, s32, s33
    s_add_u32 s32, s32, s30
    s_add_u32 s32, s32, 0xc00000
    buffer_store_dwordx4 v[16:19], v253, s[20:23], s32 offen sc1
    s_add_u32 s32, s32, 262144
    buffer_store_dwordx4 v[16:19], v253, s[20:23], s32 offen sc1
    s_add_u32 s32, s32, 262144
    buffer_store_dwordx4 v[16:19], v253, s[20:23], s32 offen sc1
    s_add_u32 s32, s32, 262144
    s_lshl_b32 s33, s72, 7
    s_add_u32 s33, s33, s30
    s_add_u32 s33, s33, 0xdc0000
    s_cmp_eq_u32 s31, 0
    s_cselect_b32 s32, s32, s33
    s_cselect_b64 exec, -1, 0xff
    buffer_store_dwordx4 v[16:19], v253, s[20:23], s32 offen sc1
    s_mov_b64 exec, -1
    s_waitcnt vmcnt(14) lgkmcnt(0)
    s_barrier
    s_add_u32 s96, s94, 4
    s_and_b32 s96, s96, 15
    s_lshl_b32 s97, s96, 7
    s_add_u32 s97, s97, s84
    s_add_u32 m0, s86, 131072
    s_nop 0
    buffer_load_dwordx4 v4, s[4:7], s97 offen offset:0 lds
    buffer_load_dwordx4 v5, s[4:7], s97 offen offset:1024 lds
    v_and_b32 v28, 31, v252
    v_bfe_u32 v29, v28, 1, 3
    v_lshrrev_b32 v30, 5, v252
    v_xor_b32 v29, v29, v30
    v_lshlrev_b32 v29, 4, v29
    v_lshl_add_u32 v28, v28, 7, v29
    s_add_u32 s30, s86, 114688
    v_add_u32 v28, s30, v28
    v_xor_b32 v29, 32, v28
    v_xor_b32 v30, 64, v28
    v_xor_b32 v31, 96, v28
    ds_read_b128 v[32:35], v28
    ds_read_b128 v[36:39], v29
    ds_read_b128 v[40:43], v30
    ds_read_b128 v[44:47], v31
    buffer_load_dwordx4 v6, s[4:7], s97 offen offset:2048 lds
    s_min_u32 s30, s28, 2
    s_lshl_b32 s30, s30, 13
    s_add_u32 s30, s30, 90112
    v_lshrrev_b32 v20, 2, v252
    v_bfe_u32 v21, v20, 1, 2
    v_lshlrev_b32 v20, 7, v20
    v_lshl_add_u32 v20, v21, 5, v20
    v_and_b32 v21, 3, v252
    v_lshl_add_u32 v20, v21, 3, v20
    v_add_u32 v144, s30, v20
    v_xor_b32 v145, 32, v144
    v_xor_b32 v146, 64, v144
    v_xor_b32 v147, 96, v144
    ds_read_b64_tr_b16 v[100:101], v144 offset:0
    buffer_load_dwordx4 v7, s[4:7], s97 offen offset:3072 lds
    ds_read_b64_tr_b16 v[102:103], v144 offset:2048
    ds_read_b64_tr_b16 v[104:105], v144 offset:4096
    ds_read_b64_tr_b16 v[106:107], v144 offset:6144
    ds_read_b64_tr_b16 v[108:109], v145 offset:0
    ds_read_b64_tr_b16 v[110:111], v145 offset:2048
    ds_read_b64_tr_b16 v[112:113], v145 offset:4096
    ds_read_b64_tr_b16 v[114:115], v145 offset:6144
    ds_read_b64_tr_b16 v[116:117], v146 offset:0
    ds_read_b64_tr_b16 v[118:119], v146 offset:2048
    ds_read_b64_tr_b16 v[120:121], v146 offset:4096
    ds_read_b64_tr_b16 v[122:123], v146 offset:6144
    ds_read_b64_tr_b16 v[124:125], v147 offset:0
    ds_read_b64_tr_b16 v[126:127], v147 offset:2048
    ds_read_b64_tr_b16 v[128:129], v147 offset:4096
    ds_read_b64_tr_b16 v[130:131], v147 offset:6144
    s_add_u32 s96, s94, 4
    s_and_b32 s96, s96, 15
    s_mul_i32 s96, s96, 393216
    s_add_u32 s96, s96, s85
    s_add_u32 m0, s87, 65536
    s_nop 0
    buffer_load_dwordx4 v8, s[16:19], s96 offen offset:0 lds
    v_mov_b32 v48, 0
    v_mov_b32 v49, 0
    v_mov_b32 v50, 0
    v_mov_b32 v51, 0
    s_lshl_b32 s30, s99, 13
    s_lshl_b32 s31, s25, 9
    s_add_u32 s30, s30, s31
    s_add_u32 s30, s30, 0x2400000
    s_waitcnt lgkmcnt(0)
    v_dot2c_f32_bf16 v48, 0x3f803f80, v32
    v_dot2c_f32_bf16 v49, v32, v32
    v_dot2c_f32_bf16 v50, 0x3f803f80, v33
    v_dot2c_f32_bf16 v51, v33, v33
    v_dot2c_f32_bf16 v48, 0x3f803f80, v34
    buffer_load_dwordx4 v9, s[16:19], s96 offen offset:1024 lds
    v_dot2c_f32_bf16 v49, v34, v34
    v_dot2c_f32_bf16 v50, 0x3f803f80, v35
    v_dot2c_f32_bf16 v51, v35, v35
    v_dot2c_f32_bf16 v48, 0x3f803f80, v36
    v_dot2c_f32_bf16 v49, v36, v36
    v_dot2c_f32_bf16 v50, 0x3f803f80, v37
    v_dot2c_f32_bf16 v51, v37, v37
    v_dot2c_f32_bf16 v48, 0x3f803f80, v38
    v_dot2c_f32_bf16 v49, v38, v38
    v_dot2c_f32_bf16 v50, 0x3f803f80, v39
    v_dot2c_f32_bf16 v51, v39, v39
    v_dot2c_f32_bf16 v48, 0x3f803f80, v40
    v_dot2c_f32_bf16 v49, v40, v40
    v_dot2c_f32_bf16 v50, 0x3f803f80, v41
    v_dot2c_f32_bf16 v51, v41, v41
    buffer_load_dwordx4 v10, s[16:19], s96 offen offset:2048 lds
    v_dot2c_f32_bf16 v48, 0x3f803f80, v42
    v_dot2c_f32_bf16 v49, v42, v42
    v_dot2c_f32_bf16 v50, 0x3f803f80, v43
    v_dot2c_f32_bf16 v51, v43, v43
    v_dot2c_f32_bf16 v48, 0x3f803f80, v44
    v_dot2c_f32_bf16 v49, v44, v44
    v_dot2c_f32_bf16 v50, 0x3f803f80, v45
    v_dot2c_f32_bf16 v51, v45, v45
    v_dot2c_f32_bf16 v48, 0x3f803f80, v46
    v_dot2c_f32_bf16 v49, v46, v46
    v_dot2c_f32_bf16 v50, 0x3f803f80, v47
    v_dot2c_f32_bf16 v51, v47, v47
    s_nop 2
    v_pk_add_f32 v[48:49], v[48:49], v[50:51]
    v_mov_b32 v50, v48
    buffer_load_dwordx4 v11, s[16:19], s96 offen offset:3072 lds
    v_mov_b32 v51, v49
    v_permlane32_swap_b32 v48, v50
    s_nop 0
    v_permlane32_swap_b32 v49, v51
    v_pk_add_f32 v[48:49], v[48:49], v[50:51]
    s_mov_b32 exec_hi, 0
    buffer_store_dwordx4 v[48:51], v253, s[20:23], s30 offen sc1
    s_mov_b64 exec, -1
    v_mov_b32 v140, 0
    v_mov_b32 v141, 0
    v_mov_b32 v142, 0
    v_mov_b32 v143, 0
    v_dot2c_f32_bf16 v140, 0x3f803f80, v100
    v_dot2c_f32_bf16 v141, 0x3f803f80, v108
    v_dot2c_f32_bf16 v142, 0x3f803f80, v116
    v_dot2c_f32_bf16 v143, 0x3f803f80, v124
    s_add_u32 m0, s87, 69632
    s_nop 0
    buffer_load_dwordx4 v12, s[16:19], s96 offen offset:0 lds
    v_dot2c_f32_bf16 v140, 0x3f803f80, v101
    v_dot2c_f32_bf16 v141, 0x3f803f80, v109
    v_dot2c_f32_bf16 v142, 0x3f803f80, v117
    v_dot2c_f32_bf16 v143, 0x3f803f80, v125
    v_dot2c_f32_bf16 v140, 0x3f803f80, v102
    v_dot2c_f32_bf16 v141, 0x3f803f80, v110
    v_dot2c_f32_bf16 v142, 0x3f803f80, v118
    v_dot2c_f32_bf16 v143, 0x3f803f80, v126
    v_dot2c_f32_bf16 v140, 0x3f803f80, v103
    v_dot2c_f32_bf16 v141, 0x3f803f80, v111
    v_dot2c_f32_bf16 v142, 0x3f803f80, v119
    v_dot2c_f32_bf16 v143, 0x3f803f80, v127
    v_dot2c_f32_bf16 v140, 0x3f803f80, v104
    v_dot2c_f32_bf16 v141, 0x3f803f80, v112
    buffer_load_dwordx4 v13, s[16:19], s96 offen offset:1024 lds
    v_dot2c_f32_bf16 v142, 0x3f803f80, v120
    v_dot2c_f32_bf16 v143, 0x3f803f80, v128
    v_dot2c_f32_bf16 v140, 0x3f803f80, v105
    v_dot2c_f32_bf16 v141, 0x3f803f80, v113
    v_dot2c_f32_bf16 v142, 0x3f803f80, v121
    v_dot2c_f32_bf16 v143, 0x3f803f80, v129
    v_dot2c_f32_bf16 v140, 0x3f803f80, v106
    v_dot2c_f32_bf16 v141, 0x3f803f80, v114
    v_dot2c_f32_bf16 v142, 0x3f803f80, v122
    v_dot2c_f32_bf16 v143, 0x3f803f80, v130
    v_dot2c_f32_bf16 v140, 0x3f803f80, v107
    v_dot2c_f32_bf16 v141, 0x3f803f80, v115
    v_dot2c_f32_bf16 v142, 0x3f803f80, v123
    v_dot2c_f32_bf16 v143, 0x3f803f80, v131
    s_min_u32 s32, s28, 2
    s_load_dwordx2 s[80:81], s[0:1], 40
    s_cmp_lt_u32 s29, 224
    s_cselect_b32 s82, 0x700000, 0
    s_mov_b32 s83, 0x20000
    s_waitcnt lgkmcnt(0)
    s_xor_b32 s96, s29, 0
    s_and_b32 s97, s96, 2
    s_and_b32 s96, s96, 3
    s_mul_i32 s97, s97, 14336
    s_mul_i32 s96, s96, 14336
    s_add_u32 s96, s96, s97
    buffer_load_dwordx4 v[156:159], v152, s[80:83], s96 offen
    s_lshl_b32 s32, s32, 12
    s_lshl_b32 s33, s25, 14
    s_add_u32 s32, s32, s33
    s_add_u32 s32, s32, 0x2500000
    s_lshl_b32 s33, s24, 8
    s_add_u32 s32, s32, s33
    v_lshlrev_b32 v20, 2, v252
    v_permlane32_swap_b32 v140, v142
    v_permlane32_swap_b32 v141, v143
    v_add_f32 v140, v140, v142
    v_add_f32 v141, v141, v143
    s_nop 1
    v_permlane16_swap_b32 v140, v141
    v_add_f32 v140, v140, v141
    buffer_store_dword v140, v20, s[20:23], s32 offen sc1
    s_waitcnt vmcnt(17) lgkmcnt(0)
    s_barrier
    s_add_u32 s96, s95, 5
    s_and_b32 s96, s96, 15
    s_lshl_b32 s97, s96, 7
    s_add_u32 s97, s97, s84
    s_add_u32 m0, s86, 114688
    s_nop 0
    buffer_load_dwordx4 v4, s[4:7], s97 offen offset:0 lds
    buffer_load_dwordx4 v5, s[4:7], s97 offen offset:1024 lds
    buffer_load_dwordx4 v6, s[4:7], s97 offen offset:2048 lds
    buffer_load_dwordx4 v7, s[4:7], s97 offen offset:3072 lds
    s_add_u32 s96, s95, 5
    s_and_b32 s96, s96, 15
    s_mul_i32 s96, s96, 393216
    s_add_u32 s96, s96, s85
    s_add_u32 m0, s87, 90112
    s_nop 0
    buffer_load_dwordx4 v8, s[16:19], s96 offen offset:0 lds
    buffer_load_dwordx4 v9, s[16:19], s96 offen offset:1024 lds
    buffer_load_dwordx4 v10, s[16:19], s96 offen offset:2048 lds
    buffer_load_dwordx4 v11, s[16:19], s96 offen offset:3072 lds
    s_add_u32 m0, s87, 94208
    s_nop 0
    buffer_load_dwordx4 v12, s[16:19], s96 offen offset:0 lds
    buffer_load_dwordx4 v13, s[16:19], s96 offen offset:1024 lds
    s_add_u32 s96, s25, 1
    s_and_b32 s96, s96, 15
    s_lshl_b32 s96, s96, 17
    s_add_u32 m0, s101, 4096
    s_nop 0
    buffer_load_dwordx4 v14, s[8:11], s96 offen lds
    s_xor_b32 s96, s29, 0
    s_and_b32 s97, s96, 2
    s_and_b32 s96, s96, 3
    s_mul_i32 s97, s97, 14336
    s_mul_i32 s96, s96, 14336
    s_add_u32 s96, s96, s97
    s_add_u32 s96, s96, 7168
    buffer_load_dwordx4 v[160:163], v152, s[80:83], s96 offen
    s_waitcnt vmcnt(14) lgkmcnt(0)
    s_barrier
    s_add_u32 s96, s94, 6
    s_and_b32 s96, s96, 15
    s_lshl_b32 s97, s96, 7
    s_add_u32 s97, s97, s84
    s_add_u32 m0, s86, 147456
    s_nop 0
    buffer_load_dwordx4 v4, s[4:7], s97 offen offset:0 lds
    buffer_load_dwordx4 v5, s[4:7], s97 offen offset:1024 lds
    buffer_load_dwordx4 v6, s[4:7], s97 offen offset:2048 lds
    buffer_load_dwordx4 v7, s[4:7], s97 offen offset:3072 lds
    s_add_u32 s96, s94, 6
    s_and_b32 s96, s96, 15
    s_mul_i32 s96, s96, 393216
    s_add_u32 s96, s96, s85
    s_add_u32 m0, s87, 40960
    s_nop 0
    buffer_load_dwordx4 v8, s[16:19], s96 offen offset:0 lds
    buffer_load_dwordx4 v9, s[16:19], s96 offen offset:1024 lds
    buffer_load_dwordx4 v10, s[16:19], s96 offen offset:2048 lds
    buffer_load_dwordx4 v11, s[16:19], s96 offen offset:3072 lds
    s_add_u32 m0, s87, 45056
    s_nop 0
    buffer_load_dwordx4 v12, s[16:19], s96 offen offset:0 lds
    buffer_load_dwordx4 v13, s[16:19], s96 offen offset:1024 lds
    s_add_u32 s96, s25, 2
    s_and_b32 s96, s96, 15
    s_lshl_b32 s96, s96, 17
    s_add_u32 m0, s101, 8192
    s_nop 0
    buffer_load_dwordx4 v14, s[8:11], s96 offen lds
    s_xor_b32 s96, s29, 1
    s_and_b32 s97, s96, 2
    s_and_b32 s96, s96, 3
    s_mul_i32 s97, s97, 14336
    s_mul_i32 s96, s96, 14336
    s_add_u32 s96, s96, s97
    buffer_load_dwordx4 v[164:167], v152, s[80:83], s96 offen
    s_waitcnt vmcnt(14) lgkmcnt(0)
    s_barrier
    s_cmp_lg_u32 s3, 4
    s_cbranch_scc1 sk_42
    v_mov_b32 v20, s88
    v_mov_b32 v21, 0
    s_mov_b64 exec, 1
    buffer_store_byte v20, v21, s[12:15], s72 offen sc1
    s_mov_b64 exec, -1
sk_42:
    s_add_u32 s96, s95, 7
    s_and_b32 s96, s96, 15
    s_lshl_b32 s97, s96, 7
    s_add_u32 s97, s97, s84
    s_add_u32 m0, s86, 131072
    s_nop 0
    buffer_load_dwordx4 v4, s[4:7], s97 offen offset:0 lds
    buffer_load_dwordx4 v5, s[4:7], s97 offen offset:1024 lds
    buffer_load_dwordx4 v6, s[4:7], s97 offen offset:2048 lds
    buffer_load_dwordx4 v7, s[4:7], s97 offen offset:3072 lds
    s_add_u32 s96, s95, 7
    s_and_b32 s96, s96, 15
    s_mul_i32 s96, s96, 393216
    s_add_u32 s96, s96, s85
    s_add_u32 m0, s87, 65536
    s_nop 0
    buffer_load_dwordx4 v8, s[16:19], s96 offen offset:0 lds
    buffer_load_dwordx4 v9, s[16:19], s96 offen offset:1024 lds
    buffer_load_dwordx4 v10, s[16:19], s96 offen offset:2048 lds
    buffer_load_dwordx4 v11, s[16:19], s96 offen offset:3072 lds
    s_add_u32 m0, s87, 69632
    s_nop 0
    buffer_load_dwordx4 v12, s[16:19], s96 offen offset:0 lds
    buffer_load_dwordx4 v13, s[16:19], s96 offen offset:1024 lds
    s_add_u32 s96, s25, 3
    s_and_b32 s96, s96, 15
    s_lshl_b32 s96, s96, 17
    s_add_u32 m0, s101, 12288
    s_nop 0
    buffer_load_dwordx4 v14, s[8:11], s96 offen lds
    s_xor_b32 s96, s29, 1
    s_and_b32 s97, s96, 2
    s_and_b32 s96, s96, 3
    s_mul_i32 s97, s97, 14336
    s_mul_i32 s96, s96, 14336
    s_add_u32 s96, s96, s97
    s_add_u32 s96, s96, 7168
    buffer_load_dwordx4 v[168:171], v152, s[80:83], s96 offen
    s_waitcnt vmcnt(14) lgkmcnt(0)
    s_barrier
    s_add_u32 s96, s94, 8
    s_and_b32 s96, s96, 15
    s_lshl_b32 s97, s96, 7
    s_add_u32 s97, s97, s84
    s_add_u32 m0, s86, 114688
    s_nop 0
    buffer_load_dwordx4 v4, s[4:7], s97 offen offset:0 lds
    buffer_load_dwordx4 v5, s[4:7], s97 offen offset:1024 lds
    buffer_load_dwordx4 v6, s[4:7], s97 offen offset:2048 lds
    buffer_load_dwordx4 v7, s[4:7], s97 offen offset:3072 lds
    s_add_u32 s96, s94, 8
    s_and_b32 s96, s96, 15
    s_mul_i32 s96, s96, 393216
    s_add_u32 s96, s96, s85
    s_add_u32 m0, s87, 90112
    s_nop 0
    buffer_load_dwordx4 v8, s[16:19], s96 offen offset:0 lds
    buffer_load_dwordx4 v9, s[16:19], s96 offen offset:1024 lds
    buffer_load_dwordx4 v10, s[16:19], s96 offen offset:2048 lds
    buffer_load_dwordx4 v11, s[16:19], s96 offen offset:3072 lds
    s_add_u32 m0, s87, 94208
    s_nop 0
    buffer_load_dwordx4 v12, s[16:19], s96 offen offset:0 lds
    buffer_load_dwordx4 v13, s[16:19], s96 offen offset:1024 lds
    s_add_u32 s96, s25, 4
    s_and_b32 s96, s96, 15
    s_lshl_b32 s96, s96, 17
    s_add_u32 m0, s101, 16384
    s_nop 0
    buffer_load_dwordx4 v14, s[8:11], s96 offen lds
    s_xor_b32 s96, s29, 2
    s_and_b32 s97, s96, 2
    s_and_b32 s96, s96, 3
    s_mul_i32 s97, s97, 14336
    s_mul_i32 s96, s96, 14336
    s_add_u32 s96, s96, s97
    buffer_load_dwordx4 v[172:175], v152, s[80:83], s96 offen
    s_waitcnt vmcnt(14) lgkmcnt(0)
    s_barrier
    s_add_u32 s96, s95, 9
    s_and_b32 s96, s96, 15
    s_lshl_b32 s97, s96, 7
    s_add_u32 s97, s97, s84
    s_add_u32 m0, s86, 147456
    s_nop 0
    buffer_load_dwordx4 v4, s[4:7], s97 offen offset:0 lds
    buffer_load_dwordx4 v5, s[4:7], s97 offen offset:1024 lds
    buffer_load_dwordx4 v6, s[4:7], s97 offen offset:2048 lds
    buffer_load_dwordx4 v7, s[4:7], s97 offen offset:3072 lds
    s_add_u32 s96, s95, 9
    s_and_b32 s96, s96, 15
    s_mul_i32 s96, s96, 393216
    s_add_u32 s96, s96, s85
    s_add_u32 m0, s87, 40960
    s_nop 0
    buffer_load_dwordx4 v8, s[16:19], s96 offen offset:0 lds
    buffer_load_dwordx4 v9, s[16:19], s96 offen offset:1024 lds
    buffer_load_dwordx4 v10, s[16:19], s96 offen offset:2048 lds
    buffer_load_dwordx4 v11, s[16:19], s96 offen offset:3072 lds
    s_add_u32 m0, s87, 45056
    s_nop 0
    buffer_load_dwordx4 v12, s[16:19], s96 offen offset:0 lds
    buffer_load_dwordx4 v13, s[16:19], s96 offen offset:1024 lds
    s_add_u32 s96, s25, 5
    s_and_b32 s96, s96, 15
    s_lshl_b32 s96, s96, 17
    s_add_u32 m0, s101, 20480
    s_nop 0
    buffer_load_dwordx4 v14, s[8:11], s96 offen lds
    s_xor_b32 s96, s29, 2
    s_and_b32 s97, s96, 2
    s_and_b32 s96, s96, 3
    s_mul_i32 s97, s97, 14336
    s_mul_i32 s96, s96, 14336
    s_add_u32 s96, s96, s97
    s_add_u32 s96, s96, 7168
    buffer_load_dwordx4 v[176:179], v152, s[80:83], s96 offen
    s_waitcnt vmcnt(14) lgkmcnt(0)
    s_barrier
    buffer_load_dword v16, v15, s[12:15], 0 offen sc1
    s_add_u32 s96, s94, 10
    s_and_b32 s96, s96, 15
    s_lshl_b32 s97, s96, 7
    s_add_u32 s97, s97, s84
    s_add_u32 m0, s86, 131072
    s_nop 0
    buffer_load_dwordx4 v4, s[4:7], s97 offen offset:0 lds
    buffer_load_dwordx4 v5, s[4:7], s97 offen offset:1024 lds
    buffer_load_dwordx4 v6, s[4:7], s97 offen offset:2048 lds
    buffer_load_dwordx4 v7, s[4:7], s97 offen offset:3072 lds
    s_add_u32 s96, s94, 10
    s_and_b32 s96, s96, 15
    s_mul_i32 s96, s96, 393216
    s_add_u32 s96, s96, s85
    s_add_u32 m0, s87, 65536
    s_nop 0
    buffer_load_dwordx4 v8, s[16:19], s96 offen offset:0 lds
    buffer_load_dwordx4 v9, s[16:19], s96 offen offset:1024 lds
    buffer_load_dwordx4 v10, s[16:19], s96 offen offset:2048 lds
    buffer_load_dwordx4 v11, s[16:19], s96 offen offset:3072 lds
    s_add_u32 m0, s87, 69632
    s_nop 0
    buffer_load_dwordx4 v12, s[16:19], s96 offen offset:0 lds
    buffer_load_dwordx4 v13, s[16:19], s96 offen offset:1024 lds
    s_add_u32 s96, s25, 6
    s_and_b32 s96, s96, 15
    s_lshl_b32 s96, s96, 17
    s_add_u32 m0, s101, 24576
    s_nop 0
    buffer_load_dwordx4 v14, s[8:11], s96 offen lds
    s_xor_b32 s96, s29, 3
    s_and_b32 s97, s96, 2
    s_and_b32 s96, s96, 3
    s_mul_i32 s97, s97, 14336
    s_mul_i32 s96, s96, 14336
    s_add_u32 s96, s96, s97
    buffer_load_dwordx4 v[180:183], v152, s[80:83], s96 offen
    s_waitcnt vmcnt(15) lgkmcnt(0)
    s_barrier
    s_mov_b32 s78, s27
    s_waitcnt vmcnt(12)
    s_branch pc_44
pl_43:
    buffer_load_dword v16, v15, s[12:15], 0 offen sc1
    s_waitcnt vmcnt(0)
pc_44:
    v_and_b32 v17, 0x10101010, v16
    v_cmp_ne_u32 vcc, 0x10101010, v17
    s_cbranch_vccz pd_45
    s_sub_u32 s78, s78, 1
    s_cmp_lg_u32 s78, 0
    s_cbranch_scc1 pl_43
    s_mov_b32 s27, 1
pd_45:
    s_add_u32 s96, s95, 11
    s_and_b32 s96, s96, 15
    s_lshl_b32 s97, s96, 7
    s_add_u32 s97, s97, s84
    s_add_u32 m0, s86, 114688
    s_nop 0
    buffer_load_dwordx4 v4, s[4:7], s97 offen offset:0 lds
    buffer_load_dwordx4 v5, s[4:7], s97 offen offset:1024 lds
    buffer_load_dwordx4 v6, s[4:7], s97 offen offset:2048 lds
    buffer_load_dwordx4 v7, s[4:7], s97 offen offset:3072 lds
    s_lshl_b32 s30, s99, 13
    s_add_u32 s30, s30, 0x2400000
    s_add_u32 s96, s95, 11
    s_and_b32 s96, s96, 15
    s_mul_i32 s96, s96, 393216
    s_add_u32 s96, s96, s85
    s_add_u32 m0, s87, 90112
    s_nop 0
    buffer_load_dwordx4 v8, s[16:19], s96 offen offset:0 lds
    s_add_u32 s31, s30, 4096
    buffer_load_dwordx4 v[64:67], v253, s[20:23], s30 offen offset:0 sc1
    buffer_load_dwordx4 v[68:71], v253, s[20:23], s30 offen offset:1024 sc1
    buffer_load_dwordx4 v[72:75], v253, s[20:23], s30 offen offset:2048 sc1
    buffer_load_dwordx4 v9, s[16:19], s96 offen offset:1024 lds
    buffer_load_dwordx4 v[76:79], v253, s[20:23], s30 offen offset:3072 sc1
    buffer_load_dwordx4 v[80:83], v253, s[20:23], s31 offen offset:0 sc1
    buffer_load_dwordx4 v[84:87], v253, s[20:23], s31 offen offset:1024 sc1
    buffer_load_dwordx4 v10, s[16:19], s96 offen offset:2048 lds
    buffer_load_dwordx4 v[88:91], v253, s[20:23], s31 offen offset:2048 sc1
    buffer_load_dwordx4 v[92:95], v253, s[20:23], s31 offen offset:3072 sc1
    s_min_u32 s32, s28, 2
    s_lshl_b32 s32, s32, 12
    buffer_load_dwordx4 v11, s[16:19], s96 offen offset:3072 lds
    s_lshl_b32 s33, s25, 14
    s_add_u32 s32, s32, s33
    s_add_u32 s32, s32, 0x2500000
    buffer_load_dwordx4 v[32:35], v253, s[20:23], s32 offen offset:0 sc1
    s_add_u32 m0, s87, 94208
    s_nop 0
    buffer_load_dwordx4 v12, s[16:19], s96 offen offset:0 lds
    buffer_load_dwordx4 v[36:39], v253, s[20:23], s32 offen offset:1024 sc1
    buffer_load_dwordx4 v[40:43], v253, s[20:23], s32 offen offset:2048 sc1
    buffer_load_dwordx4 v[44:47], v253, s[20:23], s32 offen offset:3072 sc1
    buffer_load_dwordx4 v13, s[16:19], s96 offen offset:1024 lds
    s_mul_i32 s30, s88, 0x01010101
    v_cmp_eq_u32 vcc, s30, v16
    s_lshl_b32 s31, s24, 2
    s_lshr_b64 s[30:31], vcc, s31
    s_add_u32 s96, s25, 7
    s_and_b32 s96, s96, 15
    s_lshl_b32 s96, s96, 17
    s_add_u32 m0, s101, 28672
    s_nop 0
    buffer_load_dwordx4 v14, s[8:11], s96 offen lds
    s_and_b32 s30, s30, 15
    s_cmp_eq_u32 s30, 15
    s_cselect_b32 s77, 1, 0
    v_mov_b32 v20, s73
    s_xor_b32 s96, s29, 3
    s_and_b32 s97, s96, 2
    s_and_b32 s96, s96, 3
    s_mul_i32 s97, s97, 14336
    s_mul_i32 s96, s96, 14336
    s_add_u32 s96, s96, s97
    s_add_u32 s96, s96, 7168
    buffer_load_dwordx4 v[184:187], v152, s[80:83], s96 offen
    v_mov_b32 v21, s77
    v_mov_b32 v19, 0
    ds_write_b64 v19, v[20:21] offset:3072
    s_waitcnt vmcnt(26) lgkmcnt(0)
    s_barrier
    s_add_u32 s96, s94, 12
    s_and_b32 s96, s96, 15
    s_lshl_b32 s97, s96, 7
    s_add_u32 s97, s97, s84
    s_add_u32 m0, s86, 147456
    s_nop 0
    buffer_load_dwordx4 v4, s[4:7], s97 offen offset:0 lds
    buffer_load_dwordx4 v5, s[4:7], s97 offen offset:1024 lds
    buffer_load_dwordx4 v6, s[4:7], s97 offen offset:2048 lds
    buffer_load_dwordx4 v7, s[4:7], s97 offen offset:3072 lds
    s_add_u32 s96, s94, 12
    s_and_b32 s96, s96, 15
    s_mul_i32 s96, s96, 393216
    s_add_u32 s96, s96, s85
    s_add_u32 m0, s87, 40960
    s_nop 0
    buffer_load_dwordx4 v8, s[16:19], s96 offen offset:0 lds
    buffer_load_dwordx4 v9, s[16:19], s96 offen offset:1024 lds
    buffer_load_dwordx4 v10, s[16:19], s96 offen offset:2048 lds
    buffer_load_dwordx4 v11, s[16:19], s96 offen offset:3072 lds
    s_add_u32 m0, s87, 45056
    s_nop 0
    buffer_load_dwordx4 v12, s[16:19], s96 offen offset:0 lds
    buffer_load_dwordx4 v13, s[16:19], s96 offen offset:1024 lds
    s_add_u32 s96, s25, 8
    s_and_b32 s96, s96, 15
    s_lshl_b32 s96, s96, 17
    s_add_u32 m0, s101, 32768
    s_nop 0
    buffer_load_dwordx4 v14, s[8:11], s96 offen lds
    s_load_dwordx2 s[80:81], s[0:1], 48
    s_cmp_lt_u32 s29, 224
    s_cselect_b32 s82, 0x700000, 0
    s_mov_b32 s83, 0x20000
    s_waitcnt lgkmcnt(0)
    s_xor_b32 s96, s29, 0
    s_and_b32 s97, s96, 2
    s_and_b32 s96, s96, 3
    s_mul_i32 s97, s97, 14336
    s_mul_i32 s96, s96, 14336
    s_add_u32 s96, s96, s97
    buffer_load_dwordx4 v[188:191], v152, s[80:83], s96 offen
    s_waitcnt vmcnt(14) lgkmcnt(0)
    s_barrier
    s_add_u32 s96, s95, 13
    s_and_b32 s96, s96, 15
    s_lshl_b32 s97, s96, 7
    s_add_u32 s97, s97, s84
    s_add_u32 m0, s86, 131072
    s_nop 0
    buffer_load_dwordx4 v4, s[4:7], s97 offen offset:0 lds
    buffer_load_dwordx4 v5, s[4:7], s97 offen offset:1024 lds
    s_waitcnt vmcnt(17)
    v_pk_add_f32 v[64:65], v[64:65], v[68:69]
    v_pk_add_f32 v[64:65], v[64:65], v[72:73]
    v_pk_add_f32 v[64:65], v[64:65], v[76:77]
    v_pk_add_f32 v[64:65], v[64:65], v[80:81]
    buffer_load_dwordx4 v6, s[4:7], s97 offen offset:2048 lds
    v_pk_add_f32 v[64:65], v[64:65], v[84:85]
    v_pk_add_f32 v[64:65], v[64:65], v[88:89]
    v_pk_add_f32 v[64:65], v[64:65], v[92:93]
    v_mov_b32 v48, v64
    v_mov_b32 v49, v65
    buffer_load_dwordx4 v7, s[4:7], s97 offen offset:3072 lds
    v_permlane32_swap_b32 v64, v48
    v_permlane32_swap_b32 v65, v49
    v_add_f32 v64, v64, v48
    v_add_f32 v65, v65, v49
    s_add_u32 s96, s95, 13
    s_and_b32 s96, s96, 15
    s_mul_i32 s96, s96, 393216
    s_add_u32 s96, s96, s85
    s_add_u32 m0, s87, 65536
    s_nop 0
    buffer_load_dwordx4 v8, s[16:19], s96 offen offset:0 lds
    v_mul_f32 v54, 0x3a800000, v64
    v_mul_f32 v65, 0x3a800000, v65
    v_fma_f32 v65, -v54, v54, v65
    v_max_f32 v65, 0, v65
    v_add_f32 v55, 0x3727c5ac, v65
    buffer_load_dwordx4 v9, s[16:19], s96 offen offset:1024 lds
    v_rsq_f32 v55, v55
    v_pk_add_f32 v[32:33], v[32:33], v[36:37]
    v_pk_add_f32 v[34:35], v[34:35], v[38:39]
    v_pk_add_f32 v[32:33], v[32:33], v[40:41]
    v_pk_add_f32 v[34:35], v[34:35], v[42:43]
    buffer_load_dwordx4 v10, s[16:19], s96 offen offset:2048 lds
    v_pk_add_f32 v[32:33], v[32:33], v[44:45]
    v_pk_add_f32 v[34:35], v[34:35], v[46:47]
    s_nop 1
    v_permlane32_swap_b32 v32, v34
    v_permlane32_swap_b32 v33, v35
    buffer_load_dwordx4 v11, s[16:19], s96 offen offset:3072 lds
    v_add_f32 v32, v32, v34
    v_add_f32 v33, v33, v35
    s_nop 1
    v_permlane16_swap_b32 v32, v33
    v_add_f32 v32, v32, v33
    v_mov_b32 v2, v32
    s_add_u32 m0, s87, 69632
    s_nop 0
    buffer_load_dwordx4 v12, s[16:19], s96 offen offset:0 lds
    v_cmp_gt_u32 vcc, 32, v252
    v_and_b32 v48, 31, v252
    v_lshrrev_b32 v49, 5, v252
    v_lshlrev_b32 v49, 9, v49
    v_lshl_add_u32 v48, v48, 2, v49
    buffer_load_dwordx4 v13, s[16:19], s96 offen offset:1024 lds
    s_lshl_b32 s32, s28, 7
    v_add_u32 v48, s32, v48
    v_cndmask_b32 v49, v54, v55, vcc
    v_cndmask_b32 v50, 0, 1.0, vcc
    s_add_u32 s96, s25, 9
    s_and_b32 s96, s96, 15
    s_lshl_b32 s96, s96, 17
    s_add_u32 m0, s101, 36864
    s_nop 0
    buffer_load_dwordx4 v14, s[8:11], s96 offen lds
    ds_write_b32 v48, v49 offset:0
    ds_write_b32 v48, v50 offset:2048
    v_and_b32 v48, 15, v252
    v_lshrrev_b32 v51, 4, v252
    v_lshl_add_u32 v48, v48, 2, v51
    s_xor_b32 s96, s29, 0
    s_and_b32 s97, s96, 2
    s_and_b32 s96, s96, 3
    s_mul_i32 s97, s97, 14336
    s_mul_i32 s96, s96, 14336
    s_add_u32 s96, s96, s97
    s_add_u32 s96, s96, 7168
    buffer_load_dwordx4 v[192:195], v152, s[80:83], s96 offen
    s_min_u32 s32, s28, 2
    s_lshl_b32 s32, s32, 8
    v_lshl_add_u32 v48, v48, 2, s32
    ds_write_b32 v48, v2 offset:1024
    s_waitcnt vmcnt(14) lgkmcnt(0)
    s_barrier
    s_add_u32 s96, s94, 14
    s_and_b32 s96, s96, 15
    s_lshl_b32 s97, s96, 7
    s_add_u32 s97, s97, s84
    s_add_u32 m0, s86, 114688
    s_nop 0
    buffer_load_dwordx4 v4, s[4:7], s97 offen offset:0 lds
    buffer_load_dwordx4 v5, s[4:7], s97 offen offset:1024 lds
    buffer_load_dwordx4 v6, s[4:7], s97 offen offset:2048 lds
    buffer_load_dwordx4 v7, s[4:7], s97 offen offset:3072 lds
    s_add_u32 s96, s94, 14
    s_and_b32 s96, s96, 15
    s_mul_i32 s96, s96, 393216
    s_add_u32 s96, s96, s85
    s_add_u32 m0, s87, 90112
    s_nop 0
    buffer_load_dwordx4 v8, s[16:19], s96 offen offset:0 lds
    buffer_load_dwordx4 v9, s[16:19], s96 offen offset:1024 lds
    buffer_load_dwordx4 v10, s[16:19], s96 offen offset:2048 lds
    buffer_load_dwordx4 v11, s[16:19], s96 offen offset:3072 lds
    s_add_u32 m0, s87, 94208
    s_nop 0
    buffer_load_dwordx4 v12, s[16:19], s96 offen offset:0 lds
    buffer_load_dwordx4 v13, s[16:19], s96 offen offset:1024 lds
    s_xor_b32 s96, s29, 1
    s_and_b32 s97, s96, 2
    s_and_b32 s96, s96, 3
    s_mul_i32 s97, s97, 14336
    s_mul_i32 s96, s96, 14336
    s_add_u32 s96, s96, s97
    buffer_load_dwordx4 v[196:199], v152, s[80:83], s96 offen
    s_waitcnt vmcnt(13) lgkmcnt(0)
    s_barrier
    s_add_u32 s96, s95, 15
    s_and_b32 s96, s96, 15
    s_lshl_b32 s97, s96, 7
    s_add_u32 s97, s97, s84
    s_add_u32 m0, s86, 147456
    s_nop 0
    buffer_load_dwordx4 v4, s[4:7], s97 offen offset:0 lds
    buffer_load_dwordx4 v5, s[4:7], s97 offen offset:1024 lds
    buffer_load_dwordx4 v6, s[4:7], s97 offen offset:2048 lds
    buffer_load_dwordx4 v7, s[4:7], s97 offen offset:3072 lds
    s_add_u32 s96, s95, 15
    s_and_b32 s96, s96, 15
    s_mul_i32 s96, s96, 393216
    s_add_u32 s96, s96, s85
    s_add_u32 m0, s87, 40960
    s_nop 0
    buffer_load_dwordx4 v8, s[16:19], s96 offen offset:0 lds
    buffer_load_dwordx4 v9, s[16:19], s96 offen offset:1024 lds
    buffer_load_dwordx4 v10, s[16:19], s96 offen offset:2048 lds
    buffer_load_dwordx4 v11, s[16:19], s96 offen offset:3072 lds
    s_add_u32 m0, s87, 45056
    s_nop 0
    buffer_load_dwordx4 v12, s[16:19], s96 offen offset:0 lds
    buffer_load_dwordx4 v13, s[16:19], s96 offen offset:1024 lds
    s_xor_b32 s96, s29, 1
    s_and_b32 s97, s96, 2
    s_and_b32 s96, s96, 3
    s_mul_i32 s97, s97, 14336
    s_mul_i32 s96, s96, 14336
    s_add_u32 s96, s96, s97
    s_add_u32 s96, s96, 7168
    buffer_load_dwordx4 v[200:203], v152, s[80:83], s96 offen
    s_waitcnt vmcnt(12) lgkmcnt(0)
    s_barrier
    s_load_dwordx2 s[12:13], s[0:1], 56
    s_cmp_lt_u32 s29, 224
    s_cselect_b32 s14, 0x700000, 0
    s_mov_b32 s15, 0x20000
    s_waitcnt lgkmcnt(0)
    s_mov_b32 s96, 0
    buffer_load_dwordx4 v[220:223], v153, s[12:15], s96 offen
    s_mov_b32 s96, 2048
    buffer_load_dwordx4 v[224:227], v153, s[12:15], s96 offen
    s_mov_b32 s96, 4096
    buffer_load_dwordx4 v[228:231], v153, s[12:15], s96 offen
    s_mov_b32 s96, 6144
    buffer_load_dwordx4 v[232:235], v153, s[12:15], s96 offen
    s_mov_b32 s96, 8192
    buffer_load_dwordx4 v[236:239], v153, s[12:15], s96 offen
    s_mov_b32 s96, 10240
    buffer_load_dwordx4 v[240:243], v153, s[12:15], s96 offen
    s_mov_b32 s96, 12288
    buffer_load_dwordx4 v[244:247], v153, s[12:15], s96 offen
    s_mov_b32 s96, 14336
    buffer_load_dwordx4 v[248:251], v153, s[12:15], s96 offen
    s_xor_b32 s96, s29, 2
    s_and_b32 s97, s96, 2
    s_and_b32 s96, s96, 3
    s_mul_i32 s97, s97, 14336
    s_mul_i32 s96, s96, 14336
    s_add_u32 s96, s96, s97
    buffer_load_dwordx4 v[204:207], v152, s[80:83], s96 offen
    s_xor_b32 s96, s29, 2
    s_and_b32 s97, s96, 2
    s_and_b32 s96, s96, 3
    s_mul_i32 s97, s97, 14336
    s_mul_i32 s96, s96, 14336
    s_add_u32 s96, s96, s97
    s_add_u32 s96, s96, 7168
    buffer_load_dwordx4 v[208:211], v152, s[80:83], s96 offen
    s_waitcnt vmcnt(11) lgkmcnt(0)
    s_barrier
    s_xor_b32 s96, s29, 3
    s_and_b32 s97, s96, 2
    s_and_b32 s96, s96, 3
    s_mul_i32 s97, s97, 14336
    s_mul_i32 s96, s96, 14336
    s_add_u32 s96, s96, s97
    buffer_load_dwordx4 v[212:215], v152, s[80:83], s96 offen
    s_xor_b32 s96, s29, 3
    s_and_b32 s97, s96, 2
    s_and_b32 s96, s96, 3
    s_mul_i32 s97, s97, 14336
    s_mul_i32 s96, s96, 14336
    s_add_u32 s96, s96, s97
    s_add_u32 s96, s96, 7168
    buffer_load_dwordx4 v[216:219], v152, s[80:83], s96 offen
    s_waitcnt lgkmcnt(0)
    s_barrier
l_att:
    s_add_u32 s96, s25, 10
    s_and_b32 s96, s96, 15
    s_lshl_b32 s96, s96, 17
    s_add_u32 m0, s101, 40960
    s_nop 0
    buffer_load_dwordx4 v14, s[8:11], s96 offen lds
    s_add_u32 s96, s25, 11
    s_and_b32 s96, s96, 15
    s_lshl_b32 s96, s96, 17
    s_add_u32 m0, s101, 45056
    s_nop 0
    buffer_load_dwordx4 v14, s[8:11], s96 offen lds
    v_mov_b32 v20, 0xffff
    v_mov_b32 v21, 0xffff0000
    v_cndmask_b32 v22, 0, v20, s[40:41]
    v_cndmask_b32 v23, 0, v21, s[42:43]
    v_or_b32 v12, v22, v23
    v_cndmask_b32 v22, 0, v20, s[44:45]
    v_cndmask_b32 v23, 0, v21, s[46:47]
    v_or_b32 v13, v22, v23
    v_cndmask_b32 v22, 0, v20, s[48:49]
    v_cndmask_b32 v23, 0, v21, s[50:51]
    v_or_b32 v14, v22, v23
    v_cndmask_b32 v22, 0, v20, s[52:53]
    v_cndmask_b32 v23, 0, v21, s[54:55]
    v_or_b32 v15, v22, v23
    v_cndmask_b32 v22, 0, v20, s[56:57]
    v_cndmask_b32 v23, 0, v21, s[58:59]
    v_or_b32 v16, v22, v23
    v_cndmask_b32 v22, 0, v20, s[60:61]
    v_cndmask_b32 v23, 0, v21, s[62:63]
    v_or_b32 v17, v22, v23
    v_cndmask_b32 v22, 0, v20, s[64:65]
    v_cndmask_b32 v23, 0, v21, s[66:67]
    v_or_b32 v18, v22, v23
    v_cndmask_b32 v22, 0, v20, s[68:69]
    v_cndmask_b32 v23, 0, v21, s[70:71]
    v_or_b32 v19, v22, v23
    s_lshl_b32 s34, s28, 12
    s_add_u32 s34, s34, 114688
    v_add_u32 v20, s34, v253
    s_lshl_b32 s34, s3, 11
    s_add_u32 s34, s34, 49152
    v_add_u32 v3, s34, v253
    v_mov_b32 v24, 0
    v_mov_b32 v25, 0
    v_mov_b32 v26, 0
    v_mov_b32 v27, 0
    v_mov_b32 v28, 0
    v_mov_b32 v29, 0
    v_mov_b32 v30, 0
    v_mov_b32 v31, 0
    v_mov_b32 v32, 0
    v_mov_b32 v33, 0
    v_mov_b32 v34, 0
    v_mov_b32 v35, 0
    v_mov_b32 v36, 0
    v_mov_b32 v37, 0
    v_mov_b32 v38, 0
    v_mov_b32 v39, 0
    s_lshr_b32 s33, s28, 1
    s_add_u32 s33, s33, s24
    s_sub_u32 s33, s33, 2
    s_cmp_lt_i32 s33, 0
    s_cbranch_scc1 sk_46
    s_and_b32 s34, s28, 1
    s_lshl_b32 s35, s25, 7
    s_lshl_b32 s30, s33, 2
    s_add_u32 s35, s35, s30
    s_lshl_b32 s30, s34, 1
    s_add_u32 s35, s35, s30
    s_lshl_b32 s35, s35, 12
    s_add_u32 s35, s35, s26
    s_lshl_b32 s30, s25, 8
    s_lshl_b32 s31, s33, 4
    s_add_u32 s30, s30, s31
    s_lshl_b32 s31, s34, 3
    s_add_u32 s30, s30, s31
    s_add_u32 s30, s30, s26
    s_add_u32 s30, s30, 0xdc1000
    v_mov_b32 v40, 0
    s_mov_b32 s78, s27
pl_47:
    buffer_load_dwordx2 v[42:43], v40, s[20:23], s30 offen sc1
    s_waitcnt vmcnt(0)
pc_48:
    v_max_u32 v41, v42, v43
    v_cmp_eq_u32 vcc, -1, v41
    s_cbranch_vccz pd_49
    s_sub_u32 s78, s78, 1
    s_cmp_lg_u32 s78, 0
    s_cbranch_scc1 pl_47
    s_mov_b32 s27, 1
pd_49:
    s_lshl_b32 s30, s28, 13
    s_add_u32 m0, s30, 65536
    s_add_u32 s31, s35, 0
    buffer_load_dwordx4 v253, s[20:23], s31 offen offset:0 sc1 lds
    buffer_load_dwordx4 v253, s[20:23], s31 offen offset:1024 sc1 lds
    s_add_u32 m0, s30, 69632
    s_add_u32 s31, s35, 4096
    buffer_load_dwordx4 v253, s[20:23], s31 offen offset:0 sc1 lds
    buffer_load_dwordx4 v253, s[20:23], s31 offen offset:1024 sc1 lds
    s_add_u32 m0, s30, 65536
    s_add_u32 s31, s35, 0
    buffer_load_dwordx4 v253, s[20:23], s31 offen offset:2048 sc1 lds
    buffer_load_dwordx4 v253, s[20:23], s31 offen offset:3072 sc1 lds
    s_add_u32 m0, s30, 69632
    s_add_u32 s31, s35, 4096
    buffer_load_dwordx4 v253, s[20:23], s31 offen offset:2048 sc1 lds
    buffer_load_dwordx4 v253, s[20:23], s31 offen offset:3072 sc1 lds
    s_add_u32 m0, s30, 114688
    s_add_u32 s31, s35, 262144
    buffer_load_dwordx4 v253, s[20:23], s31 offen offset:0 sc1 lds
    buffer_load_dwordx4 v253, s[20:23], s31 offen offset:1024 sc1 lds
    s_add_u32 m0, s30, 118784
    s_add_u32 s31, s35, 266240
    buffer_load_dwordx4 v253, s[20:23], s31 offen offset:0 sc1 lds
    buffer_load_dwordx4 v253, s[20:23], s31 offen offset:1024 sc1 lds
    s_add_u32 m0, s30, 114688
    s_add_u32 s31, s35, 262144
    buffer_load_dwordx4 v253, s[20:23], s31 offen offset:2048 sc1 lds
    buffer_load_dwordx4 v253, s[20:23], s31 offen offset:3072 sc1 lds
    s_add_u32 m0, s30, 118784
    s_add_u32 s31, s35, 266240
    buffer_load_dwordx4 v253, s[20:23], s31 offen offset:2048 sc1 lds
    buffer_load_dwordx4 v253, s[20:23], s31 offen offset:3072 sc1 lds
    s_waitcnt vmcnt(12)
sk_46:
    s_cmp_eq_u32 s100, 0
    s_cbranch_scc1 sk_50
    s_waitcnt vmcnt(0)
sk_50:
    s_barrier
    s_cmp_eq_u32 s100, 0
    s_cbranch_scc1 sk_51
    s_cmp_lg_u32 s38, 0
    s_cselect_b64 exec, -1, 0
    ds_write_b16 v0, v1
    s_mov_b64 exec, -1
    s_waitcnt lgkmcnt(0)
    s_barrier
sk_51:
    ds_read_b128 v[4:7], v3
    ds_read_b128 v[8:11], v3 offset:1024
    s_waitcnt vmcnt(0) lgkmcnt(0)
    s_barrier
    ds_read_b128 v[104:107], v20 offset:32768
    ds_read_b128 v[108:111], v20 offset:33792
    ds_read_b128 v[112:115], v20 offset:28672
    ds_read_b128 v[116:119], v20 offset:29696
    s_waitcnt lgkmcnt(2)
    v_mfma_f32_32x32x16_bf16 v[40:55], v[104:107], v[4:7], 0
    v_mfma_f32_32x32x16_bf16 v[40:55], v[108:111], v[8:11], v[40:55]
    ds_read_b128 v[104:107], v20 offset:24576
    ds_read_b128 v[108:111], v20 offset:25600
    s_cmp_eq_u32 s99, 0
    s_cbranch_scc0 ng_52
    v_mov_b32 v24, 0xf149f2ca
    v_mov_b32 v25, 0xf149f2ca
    v_mov_b32 v26, 0xf149f2ca
    v_mov_b32 v27, 0xf149f2ca
    v_mov_b32 v28, 0xf149f2ca
    v_mov_b32 v29, 0xf149f2ca
    v_mov_b32 v30, 0xf149f2ca
    v_mov_b32 v31, 0xf149f2ca
    v_mov_b32 v32, 0xf149f2ca
    v_mov_b32 v33, 0xf149f2ca
    v_mov_b32 v34, 0xf149f2ca
    v_mov_b32 v35, 0xf149f2ca
    v_mov_b32 v36, 0xf149f2ca
    v_mov_b32 v37, 0xf149f2ca
    v_mov_b32 v38, 0xf149f2ca
    v_mov_b32 v39, 0xf149f2ca
ng_52:
    s_waitcnt lgkmcnt(2)
    s_nop 0
    v_mfma_f32_32x32x16_bf16 v[72:87], v[112:115], v[4:7], v[24:39]
    v_mfma_f32_32x32x16_bf16 v[72:87], v[116:119], v[8:11], v[72:87]
    ds_read_b128 v[112:115], v20 offset:20480
    ds_read_b128 v[116:119], v20 offset:21504
    s_cmp_eq_u32 s99, 1
    s_cbranch_scc0 ng_53
    s_nop 1
    v_mov_b32 v24, 0xf149f2ca
    v_mov_b32 v25, 0xf149f2ca
    v_mov_b32 v26, 0xf149f2ca
    v_mov_b32 v27, 0xf149f2ca
    v_mov_b32 v28, 0xf149f2ca
    v_mov_b32 v29, 0xf149f2ca
    v_mov_b32 v30, 0xf149f2ca
    v_mov_b32 v31, 0xf149f2ca
    v_mov_b32 v32, 0xf149f2ca
    v_mov_b32 v33, 0xf149f2ca
    v_mov_b32 v34, 0xf149f2ca
    v_mov_b32 v35, 0xf149f2ca
    v_mov_b32 v36, 0xf149f2ca
    v_mov_b32 v37, 0xf149f2ca
    v_mov_b32 v38, 0xf149f2ca
    v_mov_b32 v39, 0xf149f2ca
ng_53:
    s_waitcnt lgkmcnt(2)
    s_nop 0
    v_mfma_f32_32x32x16_bf16 v[56:71], v[104:107], v[4:7], v[24:39]
    v_mfma_f32_32x32x16_bf16 v[56:71], v[108:111], v[8:11], v[56:71]
    s_nop 3
    v_max_f32 v21, v72, v73
    v_max3_f32 v21, v21, v74, v75
    v_max3_f32 v21, v21, v76, v77
    v_max3_f32 v21, v21, v78, v79
    v_max3_f32 v21, v21, v80, v81
    v_max3_f32 v21, v21, v82, v83
    v_max3_f32 v21, v21, v84, v85
    v_max3_f32 v21, v21, v86, v87
    ds_read_b128 v[104:107], v20 offset:16384
    ds_read_b128 v[108:111], v20 offset:17408
    s_cmp_eq_u32 s99, 2
    s_cbranch_scc0 ng_54
    v_mov_b32 v24, 0xf149f2ca
    v_mov_b32 v25, 0xf149f2ca
    v_mov_b32 v26, 0xf149f2ca
    v_mov_b32 v27, 0xf149f2ca
    v_mov_b32 v28, 0xf149f2ca
    v_mov_b32 v29, 0xf149f2ca
    v_mov_b32 v30, 0xf149f2ca
    v_mov_b32 v31, 0xf149f2ca
    v_mov_b32 v32, 0xf149f2ca
    v_mov_b32 v33, 0xf149f2ca
    v_mov_b32 v34, 0xf149f2ca
    v_mov_b32 v35, 0xf149f2ca
    v_mov_b32 v36, 0xf149f2ca
    v_mov_b32 v37, 0xf149f2ca
    v_mov_b32 v38, 0xf149f2ca
    v_mov_b32 v39, 0xf149f2ca
ng_54:
    s_waitcnt lgkmcnt(2)
    s_nop 0
    v_mfma_f32_32x32x16_bf16 v[72:87], v[112:115], v[4:7], v[24:39]
    v_mfma_f32_32x32x16_bf16 v[72:87], v[116:119], v[8:11], v[72:87]
    v_max3_f32 v21, v21, v56, v57
    v_max3_f32 v21, v21, v58, v59
    v_max3_f32 v21, v21, v60, v61
    v_max3_f32 v21, v21, v62, v63
    v_max3_f32 v21, v21, v64, v65
    v_max3_f32 v21, v21, v66, v67
    v_max3_f32 v21, v21, v68, v69
    v_max3_f32 v21, v21, v70, v71
    ds_read_b128 v[112:115], v20 offset:12288
    ds_read_b128 v[116:119], v20 offset:13312
    s_cmp_eq_u32 s99, 3
    s_cbranch_scc0 ng_55
    v_mov_b32 v24, 0xf149f2ca
    v_mov_b32 v25, 0xf149f2ca
    v_mov_b32 v26, 0xf149f2ca
    v_mov_b32 v27, 0xf149f2ca
    v_mov_b32 v28, 0xf149f2ca
    v_mov_b32 v29, 0xf149f2ca
    v_mov_b32 v30, 0xf149f2ca
    v_mov_b32 v31, 0xf149f2ca
    v_mov_b32 v32, 0xf149f2ca
    v_mov_b32 v33, 0xf149f2ca
    v_mov_b32 v34, 0xf149f2ca
    v_mov_b32 v35, 0xf149f2ca
    v_mov_b32 v36, 0xf149f2ca
    v_mov_b32 v37, 0xf149f2ca
    v_mov_b32 v38, 0xf149f2ca
    v_mov_b32 v39, 0xf149f2ca
ng_55:
    s_waitcnt lgkmcnt(2)
    s_nop 0
    v_mfma_f32_32x32x16_bf16 v[56:71], v[104:107], v[4:7], v[24:39]
    v_mfma_f32_32x32x16_bf16 v[56:71], v[108:111], v[8:11], v[56:71]
    v_max3_f32 v21, v21, v72, v73
    v_max3_f32 v21, v21, v74, v75
    v_max3_f32 v21, v21, v76, v77
    v_max3_f32 v21, v21, v78, v79
    v_max3_f32 v21, v21, v80, v81
    v_max3_f32 v21, v21, v82, v83
    v_max3_f32 v21, v21, v84, v85
    v_max3_f32 v21, v21, v86, v87
    ds_read_b128 v[104:107], v20 offset:8192
    ds_read_b128 v[108:111], v20 offset:9216
    s_cmp_eq_u32 s99, 4
    s_cbranch_scc0 ng_56
    v_mov_b32 v24, 0xf149f2ca
    v_mov_b32 v25, 0xf149f2ca
    v_mov_b32 v26, 0xf149f2ca
    v_mov_b32 v27, 0xf149f2ca
    v_mov_b32 v28, 0xf149f2ca
    v_mov_b32 v29, 0xf149f2ca
    v_mov_b32 v30, 0xf149f2ca
    v_mov_b32 v31, 0xf149f2ca
    v_mov_b32 v32, 0xf149f2ca
    v_mov_b32 v33, 0xf149f2ca
    v_mov_b32 v34, 0xf149f2ca
    v_mov_b32 v35, 0xf149f2ca
    v_mov_b32 v36, 0xf149f2ca
    v_mov_b32 v37, 0xf149f2ca
    v_mov_b32 v38, 0xf149f2ca
    v_mov_b32 v39, 0xf149f2ca
ng_56:
    s_waitcnt lgkmcnt(2)
    s_nop 0
    v_mfma_f32_32x32x16_bf16 v[72:87], v[112:115], v[4:7], v[24:39]
    v_mfma_f32_32x32x16_bf16 v[72:87], v[116:119], v[8:11], v[72:87]
    v_max3_f32 v21, v21, v56, v57
    v_max3_f32 v21, v21, v58, v59
    v_max3_f32 v21, v21, v60, v61
    v_max3_f32 v21, v21, v62, v63
    v_max3_f32 v21, v21, v64, v65
    v_max3_f32 v21, v21, v66, v67
    v_max3_f32 v21, v21, v68, v69
    v_max3_f32 v21, v21, v70, v71
    ds_read_b128 v[112:115], v20 offset:4096
    ds_read_b128 v[116:119], v20 offset:5120
    s_cmp_eq_u32 s99, 5
    s_cbranch_scc0 ng_57
    v_mov_b32 v24, 0xf149f2ca
    v_mov_b32 v25, 0xf149f2ca
    v_mov_b32 v26, 0xf149f2ca
    v_mov_b32 v27, 0xf149f2ca
    v_mov_b32 v28, 0xf149f2ca
    v_mov_b32 v29, 0xf149f2ca
    v_mov_b32 v30, 0xf149f2ca
    v_mov_b32 v31, 0xf149f2ca
    v_mov_b32 v32, 0xf149f2ca
    v_mov_b32 v33, 0xf149f2ca
    v_mov_b32 v34, 0xf149f2ca
    v_mov_b32 v35, 0xf149f2ca
    v_mov_b32 v36, 0xf149f2ca
    v_mov_b32 v37, 0xf149f2ca
    v_mov_b32 v38, 0xf149f2ca
    v_mov_b32 v39, 0xf149f2ca
ng_57:
    s_waitcnt lgkmcnt(2)
    s_nop 0
    v_mfma_f32_32x32x16_bf16 v[56:71], v[104:107], v[4:7], v[24:39]
    v_mfma_f32_32x32x16_bf16 v[56:71], v[108:111], v[8:11], v[56:71]
    v_max3_f32 v21, v21, v72, v73
    v_max3_f32 v21, v21, v74, v75
    v_max3_f32 v21, v21, v76, v77
    v_max3_f32 v21, v21, v78, v79
    v_max3_f32 v21, v21, v80, v81
    v_max3_f32 v21, v21, v82, v83
    v_max3_f32 v21, v21, v84, v85
    v_max3_f32 v21, v21, v86, v87
    ds_read_b128 v[104:107], v20 offset:0
    ds_read_b128 v[108:111], v20 offset:1024
    s_cmp_eq_u32 s99, 6
    s_cbranch_scc0 ng_58
    v_mov_b32 v24, 0xf149f2ca
    v_mov_b32 v25, 0xf149f2ca
    v_mov_b32 v26, 0xf149f2ca
    v_mov_b32 v27, 0xf149f2ca
    v_mov_b32 v28, 0xf149f2ca
    v_mov_b32 v29, 0xf149f2ca
    v_mov_b32 v30, 0xf149f2ca
    v_mov_b32 v31, 0xf149f2ca
    v_mov_b32 v32, 0xf149f2ca
    v_mov_b32 v33, 0xf149f2ca
    v_mov_b32 v34, 0xf149f2ca
    v_mov_b32 v35, 0xf149f2ca
    v_mov_b32 v36, 0xf149f2ca
    v_mov_b32 v37, 0xf149f2ca
    v_mov_b32 v38, 0xf149f2ca
    v_mov_b32 v39, 0xf149f2ca
ng_58:
    s_waitcnt lgkmcnt(2)
    s_nop 0
    v_mfma_f32_32x32x16_bf16 v[72:87], v[112:115], v[4:7], v[24:39]
    v_mfma_f32_32x32x16_bf16 v[72:87], v[116:119], v[8:11], v[72:87]
    v_max3_f32 v21, v21, v56, v57
    v_max3_f32 v21, v21, v58, v59
    v_max3_f32 v21, v21, v60, v61
    v_max3_f32 v21, v21, v62, v63
    v_max3_f32 v21, v21, v64, v65
    v_max3_f32 v21, v21, v66, v67
    v_max3_f32 v21, v21, v68, v69
    v_max3_f32 v21, v21, v70, v71
    s_cmp_eq_u32 s99, 7
    s_cbranch_scc0 ng_59
    v_mov_b32 v24, 0xf149f2ca
    v_mov_b32 v25, 0xf149f2ca
    v_mov_b32 v26, 0xf149f2ca
    v_mov_b32 v27, 0xf149f2ca
    v_mov_b32 v28, 0xf149f2ca
    v_mov_b32 v29, 0xf149f2ca
    v_mov_b32 v30, 0xf149f2ca
    v_mov_b32 v31, 0xf149f2ca
    v_mov_b32 v32, 0xf149f2ca
    v_mov_b32 v33, 0xf149f2ca
    v_mov_b32 v34, 0xf149f2ca
    v_mov_b32 v35, 0xf149f2ca
    v_mov_b32 v36, 0xf149f2ca
    v_mov_b32 v37, 0xf149f2ca
    v_mov_b32 v38, 0xf149f2ca
    v_mov_b32 v39, 0xf149f2ca
ng_59:
    s_waitcnt lgkmcnt(0)
    s_nop 0
    v_mfma_f32_32x32x16_bf16 v[56:71], v[104:107], v[4:7], v[24:39]
    v_mfma_f32_32x32x16_bf16 v[56:71], v[108:111], v[8:11], v[56:71]
    v_max3_f32 v21, v21, v72, v73
    v_max3_f32 v21, v21, v74, v75
    v_max3_f32 v21, v21, v76, v77
    v_max3_f32 v21, v21, v78, v79
    v_max3_f32 v21, v21, v80, v81
    v_max3_f32 v21, v21, v82, v83
    v_max3_f32 v21, v21, v84, v85
    v_max3_f32 v21, v21, v86, v87
    ds_read_b128 v[112:115], v20 offset:28672
    ds_read_b128 v[116:119], v20 offset:29696
    ds_read_b128 v[120:123], v20 offset:34816
    ds_read_b128 v[124:127], v20 offset:35840
    ds_read_b128 v[128:131], v20 offset:2048
    ds_read_b128 v[132:135], v20 offset:3072
    v_cndmask_b32 v40, v56, v40, s[40:41]
    v_cndmask_b32 v41, v57, v41, s[42:43]
    v_cndmask_b32 v42, v58, v42, s[44:45]
    v_cndmask_b32 v43, v59, v43, s[46:47]
    v_cndmask_b32 v44, v60, v44, s[48:49]
    v_cndmask_b32 v45, v61, v45, s[50:51]
    v_cndmask_b32 v46, v62, v46, s[52:53]
    v_cndmask_b32 v47, v63, v47, s[54:55]
    v_cndmask_b32 v48, v64, v48, s[56:57]
    v_cndmask_b32 v49, v65, v49, s[58:59]
    v_cndmask_b32 v50, v66, v50, s[60:61]
    v_cndmask_b32 v51, v67, v51, s[62:63]
    v_cndmask_b32 v52, v68, v52, s[64:65]
    v_cndmask_b32 v53, v69, v53, s[66:67]
    v_cndmask_b32 v54, v70, v54, s[68:69]
    v_cndmask_b32 v55, v71, v55, s[70:71]
    v_max3_f32 v21, v21, v40, v41
    v_max3_f32 v21, v21, v42, v43
    v_max3_f32 v21, v21, v44, v45
    v_max3_f32 v21, v21, v46, v47
    v_max3_f32 v21, v21, v48, v49
    v_max3_f32 v21, v21, v50, v51
    v_max3_f32 v21, v21, v52, v53
    v_max3_f32 v21, v21, v54, v55
    v_mov_b32 v152, v21
    s_nop 1
    v_permlane32_swap_b32 v21, v152
    v_max_f32 v21, v21, v152
    v_sub_f32 v24, 0, v21
    v_sub_f32 v25, 0, v21
    v_sub_f32 v26, 0, v21
    v_sub_f32 v27, 0, v21
    v_sub_f32 v28, 0, v21
    v_sub_f32 v29, 0, v21
    v_sub_f32 v30, 0, v21
    v_sub_f32 v31, 0, v21
    v_sub_f32 v32, 0, v21
    v_sub_f32 v33, 0, v21
    v_sub_f32 v34, 0, v21
    v_sub_f32 v35, 0, v21
    v_sub_f32 v36, 0, v21
    v_sub_f32 v37, 0, v21
    v_sub_f32 v38, 0, v21
    v_sub_f32 v39, 0, v21
    s_cmp_eq_u32 s99, 0
    s_cbranch_scc0 ng_60
    v_mov_b32 v24, 0xf149f2ca
    v_mov_b32 v25, 0xf149f2ca
    v_mov_b32 v26, 0xf149f2ca
    v_mov_b32 v27, 0xf149f2ca
    v_mov_b32 v28, 0xf149f2ca
    v_mov_b32 v29, 0xf149f2ca
    v_mov_b32 v30, 0xf149f2ca
    v_mov_b32 v31, 0xf149f2ca
    v_mov_b32 v32, 0xf149f2ca
    v_mov_b32 v33, 0xf149f2ca
    v_mov_b32 v34, 0xf149f2ca
    v_mov_b32 v35, 0xf149f2ca
    v_mov_b32 v36, 0xf149f2ca
    v_mov_b32 v37, 0xf149f2ca
    v_mov_b32 v38, 0xf149f2ca
    v_mov_b32 v39, 0xf149f2ca
ng_60:
    s_waitcnt lgkmcnt(4)
    s_nop 0
    v_mfma_f32_32x32x16_bf16 v[72:87], v[112:115], v[4:7], v[24:39]
    v_mfma_f32_32x32x16_bf16 v[72:87], v[116:119], v[8:11], v[72:87]
    ds_read_b128 v[104:107], v20 offset:24576
    ds_read_b128 v[108:111], v20 offset:25600
    v_sub_f32 v40, v40, v21
    v_sub_f32 v41, v41, v21
    v_sub_f32 v42, v42, v21
    v_sub_f32 v43, v43, v21
    v_sub_f32 v44, v44, v21
    v_sub_f32 v45, v45, v21
    v_sub_f32 v46, v46, v21
    v_sub_f32 v47, v47, v21
    v_sub_f32 v48, v48, v21
    v_sub_f32 v49, v49, v21
    v_sub_f32 v50, v50, v21
    v_sub_f32 v51, v51, v21
    v_sub_f32 v52, v52, v21
    v_sub_f32 v53, v53, v21
    v_sub_f32 v54, v54, v21
    v_sub_f32 v55, v55, v21
    v_exp_f32 v40, v40
    v_exp_f32 v41, v41
    v_exp_f32 v42, v42
    v_exp_f32 v43, v43
    v_exp_f32 v44, v44
    v_exp_f32 v45, v45
    v_exp_f32 v46, v46
    v_exp_f32 v47, v47
    v_exp_f32 v48, v48
    v_exp_f32 v49, v49
    v_exp_f32 v50, v50
    v_exp_f32 v51, v51
    v_exp_f32 v52, v52
    v_exp_f32 v53, v53
    v_exp_f32 v54, v54
    v_exp_f32 v55, v55
    v_add_f32 v22, v40, v41
    v_add_f32 v23, v42, v43
    v_add_f32 v22, v22, v44
    v_add_f32 v23, v23, v45
    v_add_f32 v22, v22, v46
    v_add_f32 v23, v23, v47
    v_add_f32 v22, v22, v48
    v_add_f32 v23, v23, v49
    v_add_f32 v22, v22, v50
    v_add_f32 v23, v23, v51
    v_add_f32 v22, v22, v52
    v_add_f32 v23, v23, v53
    v_add_f32 v22, v22, v54
    v_add_f32 v23, v23, v55
    v_cvt_pk_bf16_f32 v144, v40, v41
    v_cvt_pk_bf16_f32 v145, v42, v43
    v_cvt_pk_bf16_f32 v146, v44, v45
    v_cvt_pk_bf16_f32 v147, v46, v47
    v_cvt_pk_bf16_f32 v148, v48, v49
    v_cvt_pk_bf16_f32 v149, v50, v51
    v_cvt_pk_bf16_f32 v150, v52, v53
    v_cvt_pk_bf16_f32 v151, v54, v55
    v_and_b32 v136, v144, v12
    v_and_b32 v137, v145, v13
    v_and_b32 v138, v146, v14
    v_and_b32 v139, v147, v15
    v_and_b32 v140, v148, v16
    v_and_b32 v141, v149, v17
    v_and_b32 v142, v150, v18
    v_and_b32 v143, v151, v19
    v_xor_b32 v144, v144, v136
    v_xor_b32 v145, v145, v137
    v_xor_b32 v146, v146, v138
    v_xor_b32 v147, v147, v139
    v_xor_b32 v148, v148, v140
    v_xor_b32 v149, v149, v141
    v_xor_b32 v150, v150, v142
    v_xor_b32 v151, v151, v143
    s_waitcnt lgkmcnt(2)
    v_mfma_f32_32x32x16_bf16 v[88:103], v[120:123], v[136:139], 0
    v_mfma_f32_32x32x16_bf16 v[88:103], v[124:127], v[140:143], v[88:103]
    v_mfma_f32_32x32x16_bf16 v[88:103], v[128:131], v[144:147], v[88:103]
    v_mfma_f32_32x32x16_bf16 v[88:103], v[132:135], v[148:151], v[88:103]
    ds_read_b128 v[128:131], v20 offset:30720
    ds_read_b128 v[132:135], v20 offset:31744
    s_cmp_eq_u32 s99, 1
    s_cbranch_scc0 ng_61
    v_mov_b32 v24, 0xf149f2ca
    v_mov_b32 v25, 0xf149f2ca
    v_mov_b32 v26, 0xf149f2ca
    v_mov_b32 v27, 0xf149f2ca
    v_mov_b32 v28, 0xf149f2ca
    v_mov_b32 v29, 0xf149f2ca
    v_mov_b32 v30, 0xf149f2ca
    v_mov_b32 v31, 0xf149f2ca
    v_mov_b32 v32, 0xf149f2ca
    v_mov_b32 v33, 0xf149f2ca
    v_mov_b32 v34, 0xf149f2ca
    v_mov_b32 v35, 0xf149f2ca
    v_mov_b32 v36, 0xf149f2ca
    v_mov_b32 v37, 0xf149f2ca
    v_mov_b32 v38, 0xf149f2ca
    v_mov_b32 v39, 0xf149f2ca
ng_61:
    s_waitcnt lgkmcnt(2)
    s_nop 0
    v_mfma_f32_32x32x16_bf16 v[56:71], v[104:107], v[4:7], v[24:39]
    v_mfma_f32_32x32x16_bf16 v[56:71], v[108:111], v[8:11], v[56:71]
    ds_read_b128 v[112:115], v20 offset:20480
    ds_read_b128 v[116:119], v20 offset:21504
    v_exp_f32 v72, v72
    v_exp_f32 v73, v73
    v_exp_f32 v74, v74
    v_exp_f32 v75, v75
    v_exp_f32 v76, v76
    v_exp_f32 v77, v77
    v_exp_f32 v78, v78
    v_exp_f32 v79, v79
    v_exp_f32 v80, v80
    v_exp_f32 v81, v81
    v_exp_f32 v82, v82
    v_exp_f32 v83, v83
    v_exp_f32 v84, v84
    v_exp_f32 v85, v85
    v_exp_f32 v86, v86
    v_exp_f32 v87, v87
    v_add_f32 v22, v22, v72
    v_add_f32 v23, v23, v73
    v_add_f32 v22, v22, v74
    v_add_f32 v23, v23, v75
    v_add_f32 v22, v22, v76
    v_add_f32 v23, v23, v77
    v_add_f32 v22, v22, v78
    v_add_f32 v23, v23, v79
    v_add_f32 v22, v22, v80
    v_add_f32 v23, v23, v81
    v_add_f32 v22, v22, v82
    v_add_f32 v23, v23, v83
    v_add_f32 v22, v22, v84
    v_add_f32 v23, v23, v85
    v_add_f32 v22, v22, v86
    v_add_f32 v23, v23, v87
    v_cvt_pk_bf16_f32 v144, v72, v73
    v_cvt_pk_bf16_f32 v145, v74, v75
    v_cvt_pk_bf16_f32 v146, v76, v77
    v_cvt_pk_bf16_f32 v147, v78, v79
    v_cvt_pk_bf16_f32 v148, v80, v81
    v_cvt_pk_bf16_f32 v149, v82, v83
    v_cvt_pk_bf16_f32 v150, v84, v85
    v_cvt_pk_bf16_f32 v151, v86, v87
    s_waitcnt lgkmcnt(2)
    v_mfma_f32_32x32x16_bf16 v[88:103], v[128:131], v[144:147], v[88:103]
    v_mfma_f32_32x32x16_bf16 v[88:103], v[132:135], v[148:151], v[88:103]
    ds_read_b128 v[120:123], v20 offset:26624
    ds_read_b128 v[124:127], v20 offset:27648
    s_cmp_eq_u32 s99, 2
    s_cbranch_scc0 ng_62
    v_mov_b32 v24, 0xf149f2ca
    v_mov_b32 v25, 0xf149f2ca
    v_mov_b32 v26, 0xf149f2ca
    v_mov_b32 v27, 0xf149f2ca
    v_mov_b32 v28, 0xf149f2ca
    v_mov_b32 v29, 0xf149f2ca
    v_mov_b32 v30, 0xf149f2ca
    v_mov_b32 v31, 0xf149f2ca
    v_mov_b32 v32, 0xf149f2ca
    v_mov_b32 v33, 0xf149f2ca
    v_mov_b32 v34, 0xf149f2ca
    v_mov_b32 v35, 0xf149f2ca
    v_mov_b32 v36, 0xf149f2ca
    v_mov_b32 v37, 0xf149f2ca
    v_mov_b32 v38, 0xf149f2ca
    v_mov_b32 v39, 0xf149f2ca
ng_62:
    s_waitcnt lgkmcnt(2)
    s_nop 0
    v_mfma_f32_32x32x16_bf16 v[72:87], v[112:115], v[4:7], v[24:39]
    v_mfma_f32_32x32x16_bf16 v[72:87], v[116:119], v[8:11], v[72:87]
    ds_read_b128 v[104:107], v20 offset:16384
    ds_read_b128 v[108:111], v20 offset:17408
    v_exp_f32 v56, v56
    v_exp_f32 v57, v57
    v_exp_f32 v58, v58
    v_exp_f32 v59, v59
    v_exp_f32 v60, v60
    v_exp_f32 v61, v61
    v_exp_f32 v62, v62
    v_exp_f32 v63, v63
    v_exp_f32 v64, v64
    v_exp_f32 v65, v65
    v_exp_f32 v66, v66
    v_exp_f32 v67, v67
    v_exp_f32 v68, v68
    v_exp_f32 v69, v69
    v_exp_f32 v70, v70
    v_exp_f32 v71, v71
    v_add_f32 v22, v22, v56
    v_add_f32 v23, v23, v57
    v_add_f32 v22, v22, v58
    v_add_f32 v23, v23, v59
    v_add_f32 v22, v22, v60
    v_add_f32 v23, v23, v61
    v_add_f32 v22, v22, v62
    v_add_f32 v23, v23, v63
    v_add_f32 v22, v22, v64
    v_add_f32 v23, v23, v65
    v_add_f32 v22, v22, v66
    v_add_f32 v23, v23, v67
    v_add_f32 v22, v22, v68
    v_add_f32 v23, v23, v69
    v_add_f32 v22, v22, v70
    v_add_f32 v23, v23, v71
    v_cvt_pk_bf16_f32 v136, v56, v57
    v_cvt_pk_bf16_f32 v137, v58, v59
    v_cvt_pk_bf16_f32 v138, v60, v61
    v_cvt_pk_bf16_f32 v139, v62, v63
    v_cvt_pk_bf16_f32 v140, v64, v65
    v_cvt_pk_bf16_f32 v141, v66, v67
    v_cvt_pk_bf16_f32 v142, v68, v69
    v_cvt_pk_bf16_f32 v143, v70, v71
    s_waitcnt lgkmcnt(2)
    v_mfma_f32_32x32x16_bf16 v[88:103], v[120:123], v[136:139], v[88:103]
    v_mfma_f32_32x32x16_bf16 v[88:103], v[124:127], v[140:143], v[88:103]
    ds_read_b128 v[128:131], v20 offset:22528
    ds_read_b128 v[132:135], v20 offset:23552
    s_cmp_eq_u32 s99, 3
    s_cbranch_scc0 ng_63
    v_mov_b32 v24, 0xf149f2ca
    v_mov_b32 v25, 0xf149f2ca
    v_mov_b32 v26, 0xf149f2ca
    v_mov_b32 v27, 0xf149f2ca
    v_mov_b32 v28, 0xf149f2ca
    v_mov_b32 v29, 0xf149f2ca
    v_mov_b32 v30, 0xf149f2ca
    v_mov_b32 v31, 0xf149f2ca
    v_mov_b32 v32, 0xf149f2ca
    v_mov_b32 v33, 0xf149f2ca
    v_mov_b32 v34, 0xf149f2ca
    v_mov_b32 v35, 0xf149f2ca
    v_mov_b32 v36, 0xf149f2ca
    v_mov_b32 v37, 0xf149f2ca
    v_mov_b32 v38, 0xf149f2ca
    v_mov_b32 v39, 0xf149f2ca
ng_63:
    s_waitcnt lgkmcnt(2)
    s_nop 0
    v_mfma_f32_32x32x16_bf16 v[56:71], v[104:107], v[4:7], v[24:39]
    v_mfma_f32_32x32x16_bf16 v[56:71], v[108:111], v[8:11], v[56:71]
    ds_read_b128 v[112:115], v20 offset:12288
    ds_read_b128 v[116:119], v20 offset:13312
    v_exp_f32 v72, v72
    v_exp_f32 v73, v73
    v_exp_f32 v74, v74
    v_exp_f32 v75, v75
    v_exp_f32 v76, v76
    v_exp_f32 v77, v77
    v_exp_f32 v78, v78
    v_exp_f32 v79, v79
    v_exp_f32 v80, v80
    v_exp_f32 v81, v81
    v_exp_f32 v82, v82
    v_exp_f32 v83, v83
    v_exp_f32 v84, v84
    v_exp_f32 v85, v85
    v_exp_f32 v86, v86
    v_exp_f32 v87, v87
    v_add_f32 v22, v22, v72
    v_add_f32 v23, v23, v73
    v_add_f32 v22, v22, v74
    v_add_f32 v23, v23, v75
    v_add_f32 v22, v22, v76
    v_add_f32 v23, v23, v77
    v_add_f32 v22, v22, v78
    v_add_f32 v23, v23, v79
    v_add_f32 v22, v22, v80
    v_add_f32 v23, v23, v81
    v_add_f32 v22, v22, v82
    v_add_f32 v23, v23, v83
    v_add_f32 v22, v22, v84
    v_add_f32 v23, v23, v85
    v_add_f32 v22, v22, v86
    v_add_f32 v23, v23, v87
    v_cvt_pk_bf16_f32 v144, v72, v73
    v_cvt_pk_bf16_f32 v145, v74, v75
    v_cvt_pk_bf16_f32 v146, v76, v77
    v_cvt_pk_bf16_f32 v147, v78, v79
    v_cvt_pk_bf16_f32 v148, v80, v81
    v_cvt_pk_bf16_f32 v149, v82, v83
    v_cvt_pk_bf16_f32 v150, v84, v85
    v_cvt_pk_bf16_f32 v151, v86, v87
    s_waitcnt lgkmcnt(2)
    v_mfma_f32_32x32x16_bf16 v[88:103], v[128:131], v[144:147], v[88:103]
    v_mfma_f32_32x32x16_bf16 v[88:103], v[132:135], v[148:151], v[88:103]
    ds_read_b128 v[120:123], v20 offset:18432
    ds_read_b128 v[124:127], v20 offset:19456
    s_cmp_eq_u32 s99, 4
    s_cbranch_scc0 ng_64
    v_mov_b32 v24, 0xf149f2ca
    v_mov_b32 v25, 0xf149f2ca
    v_mov_b32 v26, 0xf149f2ca
    v_mov_b32 v27, 0xf149f2ca
    v_mov_b32 v28, 0xf149f2ca
    v_mov_b32 v29, 0xf149f2ca
    v_mov_b32 v30, 0xf149f2ca
    v_mov_b32 v31, 0xf149f2ca
    v_mov_b32 v32, 0xf149f2ca
    v_mov_b32 v33, 0xf149f2ca
    v_mov_b32 v34, 0xf149f2ca
    v_mov_b32 v35, 0xf149f2ca
    v_mov_b32 v36, 0xf149f2ca
    v_mov_b32 v37, 0xf149f2ca
    v_mov_b32 v38, 0xf149f2ca
    v_mov_b32 v39, 0xf149f2ca
ng_64:
    s_waitcnt lgkmcnt(2)
    s_nop 0
    v_mfma_f32_32x32x16_bf16 v[72:87], v[112:115], v[4:7], v[24:39]
    v_mfma_f32_32x32x16_bf16 v[72:87], v[116:119], v[8:11], v[72:87]
    ds_read_b128 v[104:107], v20 offset:8192
    ds_read_b128 v[108:111], v20 offset:9216
    v_exp_f32 v56, v56
    v_exp_f32 v57, v57
    v_exp_f32 v58, v58
    v_exp_f32 v59, v59
    v_exp_f32 v60, v60
    v_exp_f32 v61, v61
    v_exp_f32 v62, v62
    v_exp_f32 v63, v63
    v_exp_f32 v64, v64
    v_exp_f32 v65, v65
    v_exp_f32 v66, v66
    v_exp_f32 v67, v67
    v_exp_f32 v68, v68
    v_exp_f32 v69, v69
    v_exp_f32 v70, v70
    v_exp_f32 v71, v71
    v_add_f32 v22, v22, v56
    v_add_f32 v23, v23, v57
    v_add_f32 v22, v22, v58
    v_add_f32 v23, v23, v59
    v_add_f32 v22, v22, v60
    v_add_f32 v23, v23, v61
    v_add_f32 v22, v22, v62
    v_add_f32 v23, v23, v63
    v_add_f32 v22, v22, v64
    v_add_f32 v23, v23, v65
    v_add_f32 v22, v22, v66
    v_add_f32 v23, v23, v67
    v_add_f32 v22, v22, v68
    v_add_f32 v23, v23, v69
    v_add_f32 v22, v22, v70
    v_add_f32 v23, v23, v71
    v_cvt_pk_bf16_f32 v136, v56, v57
    v_cvt_pk_bf16_f32 v137, v58, v59
    v_cvt_pk_bf16_f32 v138, v60, v61
    v_cvt_pk_bf16_f32 v139, v62, v63
    v_cvt_pk_bf16_f32 v140, v64, v65
    v_cvt_pk_bf16_f32 v141, v66, v67
    v_cvt_pk_bf16_f32 v142, v68, v69
    v_cvt_pk_bf16_f32 v143, v70, v71
    s_waitcnt lgkmcnt(2)
    v_mfma_f32_32x32x16_bf16 v[88:103], v[120:123], v[136:139], v[88:103]
    v_mfma_f32_32x32x16_bf16 v[88:103], v[124:127], v[140:143], v[88:103]
    s_barrier
    ds_read_b128 v[128:131], v20 offset:14336
    ds_read_b128 v[132:135], v20 offset:15360
    s_cmp_eq_u32 s99, 5
    s_cbranch_scc0 ng_65
    v_mov_b32 v24, 0xf149f2ca
    v_mov_b32 v25, 0xf149f2ca
    v_mov_b32 v26, 0xf149f2ca
    v_mov_b32 v27, 0xf149f2ca
    v_mov_b32 v28, 0xf149f2ca
    v_mov_b32 v29, 0xf149f2ca
    v_mov_b32 v30, 0xf149f2ca
    v_mov_b32 v31, 0xf149f2ca
    v_mov_b32 v32, 0xf149f2ca
    v_mov_b32 v33, 0xf149f2ca
    v_mov_b32 v34, 0xf149f2ca
    v_mov_b32 v35, 0xf149f2ca
    v_mov_b32 v36, 0xf149f2ca
    v_mov_b32 v37, 0xf149f2ca
    v_mov_b32 v38, 0xf149f2ca
    v_mov_b32 v39, 0xf149f2ca
ng_65:
    s_waitcnt lgkmcnt(2)
    s_nop 0
    v_mfma_f32_32x32x16_bf16 v[56:71], v[104:107], v[4:7], v[24:39]
    v_mfma_f32_32x32x16_bf16 v[56:71], v[108:111], v[8:11], v[56:71]
    ds_read_b128 v[112:115], v20 offset:4096
    ds_read_b128 v[116:119], v20 offset:5120
    v_exp_f32 v72, v72
    v_exp_f32 v73, v73
    v_exp_f32 v74, v74
    v_exp_f32 v75, v75
    v_exp_f32 v76, v76
    v_exp_f32 v77, v77
    v_exp_f32 v78, v78
    v_exp_f32 v79, v79
    v_exp_f32 v80, v80
    v_exp_f32 v81, v81
    v_exp_f32 v82, v82
    v_exp_f32 v83, v83
    v_exp_f32 v84, v84
    v_exp_f32 v85, v85
    v_exp_f32 v86, v86
    v_exp_f32 v87, v87
    v_add_f32 v22, v22, v72
    v_add_f32 v23, v23, v73
    v_add_f32 v22, v22, v74
    v_add_f32 v23, v23, v75
    v_add_f32 v22, v22, v76
    v_add_f32 v23, v23, v77
    v_add_f32 v22, v22, v78
    v_add_f32 v23, v23, v79
    v_add_f32 v22, v22, v80
    v_add_f32 v23, v23, v81
    v_add_f32 v22, v22, v82
    v_add_f32 v23, v23, v83
    v_add_f32 v22, v22, v84
    v_add_f32 v23, v23, v85
    v_add_f32 v22, v22, v86
    v_add_f32 v23, v23, v87
    v_cvt_pk_bf16_f32 v144, v72, v73
    v_cvt_pk_bf16_f32 v145, v74, v75
    v_cvt_pk_bf16_f32 v146, v76, v77
    v_cvt_pk_bf16_f32 v147, v78, v79
    v_cvt_pk_bf16_f32 v148, v80, v81
    v_cvt_pk_bf16_f32 v149, v82, v83
    v_cvt_pk_bf16_f32 v150, v84, v85
    v_cvt_pk_bf16_f32 v151, v86, v87
    s_waitcnt lgkmcnt(2)
    v_mfma_f32_32x32x16_bf16 v[88:103], v[128:131], v[144:147], v[88:103]
    v_mfma_f32_32x32x16_bf16 v[88:103], v[132:135], v[148:151], v[88:103]
    ds_read_b128 v[120:123], v20 offset:10240
    ds_read_b128 v[124:127], v20 offset:11264
    s_cmp_eq_u32 s99, 6
    s_cbranch_scc0 ng_66
    v_mov_b32 v24, 0xf149f2ca
    v_mov_b32 v25, 0xf149f2ca
    v_mov_b32 v26, 0xf149f2ca
    v_mov_b32 v27, 0xf149f2ca
    v_mov_b32 v28, 0xf149f2ca
    v_mov_b32 v29, 0xf149f2ca
    v_mov_b32 v30, 0xf149f2ca
    v_mov_b32 v31, 0xf149f2ca
    v_mov_b32 v32, 0xf149f2ca
    v_mov_b32 v33, 0xf149f2ca
    v_mov_b32 v34, 0xf149f2ca
    v_mov_b32 v35, 0xf149f2ca
    v_mov_b32 v36, 0xf149f2ca
    v_mov_b32 v37, 0xf149f2ca
    v_mov_b32 v38, 0xf149f2ca
    v_mov_b32 v39, 0xf149f2ca
ng_66:
    s_waitcnt lgkmcnt(2)
    s_nop 0
    v_mfma_f32_32x32x16_bf16 v[72:87], v[112:115], v[4:7], v[24:39]
    v_mfma_f32_32x32x16_bf16 v[72:87], v[116:119], v[8:11], v[72:87]
    v_exp_f32 v56, v56
    v_exp_f32 v57, v57
    v_exp_f32 v58, v58
    v_exp_f32 v59, v59
    v_exp_f32 v60, v60
    v_exp_f32 v61, v61
    v_exp_f32 v62, v62
    v_exp_f32 v63, v63
    v_exp_f32 v64, v64
    v_exp_f32 v65, v65
    v_exp_f32 v66, v66
    v_exp_f32 v67, v67
    v_exp_f32 v68, v68
    v_exp_f32 v69, v69
    v_exp_f32 v70, v70
    v_exp_f32 v71, v71
    v_add_f32 v22, v22, v56
    v_add_f32 v23, v23, v57
    v_add_f32 v22, v22, v58
    v_add_f32 v23, v23, v59
    v_add_f32 v22, v22, v60
    v_add_f32 v23, v23, v61
    v_add_f32 v22, v22, v62
    v_add_f32 v23, v23, v63
    v_add_f32 v22, v22, v64
    v_add_f32 v23, v23, v65
    v_add_f32 v22, v22, v66
    v_add_f32 v23, v23, v67
    v_add_f32 v22, v22, v68
    v_add_f32 v23, v23, v69
    v_add_f32 v22, v22, v70
    v_add_f32 v23, v23, v71
    v_cvt_pk_bf16_f32 v136, v56, v57
    v_cvt_pk_bf16_f32 v137, v58, v59
    v_cvt_pk_bf16_f32 v138, v60, v61
    v_cvt_pk_bf16_f32 v139, v62, v63
    v_cvt_pk_bf16_f32 v140, v64, v65
    v_cvt_pk_bf16_f32 v141, v66, v67
    v_cvt_pk_bf16_f32 v142, v68, v69
    v_cvt_pk_bf16_f32 v143, v70, v71
    s_waitcnt lgkmcnt(0)
    v_mfma_f32_32x32x16_bf16 v[88:103], v[120:123], v[136:139], v[88:103]
    v_mfma_f32_32x32x16_bf16 v[88:103], v[124:127], v[140:143], v[88:103]
    ds_read_b128 v[128:131], v20 offset:6144
    ds_read_b128 v[132:135], v20 offset:7168
    v_exp_f32 v72, v72
    v_exp_f32 v73, v73
    v_exp_f32 v74, v74
    v_exp_f32 v75, v75
    v_exp_f32 v76, v76
    v_exp_f32 v77, v77
    v_exp_f32 v78, v78
    v_exp_f32 v79, v79
    v_exp_f32 v80, v80
    v_exp_f32 v81, v81
    v_exp_f32 v82, v82
    v_exp_f32 v83, v83
    v_exp_f32 v84, v84
    v_exp_f32 v85, v85
    v_exp_f32 v86, v86
    v_exp_f32 v87, v87
    v_add_f32 v22, v22, v72
    v_add_f32 v23, v23, v73
    v_add_f32 v22, v22, v74
    v_add_f32 v23, v23, v75
    v_add_f32 v22, v22, v76
    v_add_f32 v23, v23, v77
    v_add_f32 v22, v22, v78
    v_add_f32 v23, v23, v79
    v_add_f32 v22, v22, v80
    v_add_f32 v23, v23, v81
    v_add_f32 v22, v22, v82
    v_add_f32 v23, v23, v83
    v_add_f32 v22, v22, v84
    v_add_f32 v23, v23, v85
    v_add_f32 v22, v22, v86
    v_add_f32 v23, v23, v87
    v_cvt_pk_bf16_f32 v144, v72, v73
    v_cvt_pk_bf16_f32 v145, v74, v75
    v_cvt_pk_bf16_f32 v146, v76, v77
    v_cvt_pk_bf16_f32 v147, v78, v79
    v_cvt_pk_bf16_f32 v148, v80, v81
    v_cvt_pk_bf16_f32 v149, v82, v83
    v_cvt_pk_bf16_f32 v150, v84, v85
    v_cvt_pk_bf16_f32 v151, v86, v87
    s_waitcnt lgkmcnt(0)
    v_mfma_f32_32x32x16_bf16 v[88:103], v[128:131], v[144:147], v[88:103]
    v_mfma_f32_32x32x16_bf16 v[88:103], v[132:135], v[148:151], v[88:103]
    v_add_f32 v22, v22, v23
    v_mov_b32 v152, v22
    s_nop 1
    v_permlane32_swap_b32 v22, v152
    v_add_f32 v22, v22, v152
    v_rcp_f32 v22, v22
    s_lshl_b32 s36, s99, 16
    s_add_u32 s36, s36, s26
    s_add_u32 s36, s36, 0x808000
    s_lshl_b32 s33, s25, 11
    s_add_u32 s33, s33, s36
    s_lshl_b32 s30, s24, 9
    s_lshl_b32 s31, s3, 6
    s_add_u32 s30, s30, s31
    s_add_u32 s30, s30, s26
    s_add_u32 s30, s30, 0xdc2000
    s_lshl_b32 s31, s25, 2
    s_add_u32 s31, s31, s30
    v_pk_mul_f32 v[88:89], v[88:89], v[22:23] op_sel_hi:[1,0]
    v_pk_mul_f32 v[90:91], v[90:91], v[22:23] op_sel_hi:[1,0]
    v_pk_mul_f32 v[92:93], v[92:93], v[22:23] op_sel_hi:[1,0]
    v_pk_mul_f32 v[94:95], v[94:95], v[22:23] op_sel_hi:[1,0]
    v_pk_mul_f32 v[96:97], v[96:97], v[22:23] op_sel_hi:[1,0]
    v_pk_mul_f32 v[98:99], v[98:99], v[22:23] op_sel_hi:[1,0]
    v_pk_mul_f32 v[100:101], v[100:101], v[22:23] op_sel_hi:[1,0]
    v_pk_mul_f32 v[102:103], v[102:103], v[22:23] op_sel_hi:[1,0]
    v_cvt_pk_bf16_f32 v88, v88, v89
    v_cvt_pk_bf16_f32 v89, v90, v91
    v_cvt_pk_bf16_f32 v90, v92, v93
    v_cvt_pk_bf16_f32 v91, v94, v95
    v_cvt_pk_bf16_f32 v92, v96, v97
    v_cvt_pk_bf16_f32 v93, v98, v99
    v_cvt_pk_bf16_f32 v94, v100, v101
    v_cvt_pk_bf16_f32 v95, v102, v103
    s_cmp_lg_u32 s77, 0
    s_cbranch_scc1 lc_67
    buffer_store_dwordx4 v[88:91], v253, s[20:23], s33 offen sc1
    buffer_store_dwordx4 v[92:95], v253, s[20:23], s33 offen offset:1024 sc1
    s_branch lc_68
lc_67:
    buffer_store_dwordx4 v[88:91], v253, s[20:23], s33 offen
    buffer_store_dwordx4 v[92:95], v253, s[20:23], s33 offen offset:1024
lc_68:
    v_mov_b32 v154, 0
    s_mov_b64 exec, 1
    s_waitcnt vmcnt(0)
    s_cmp_lg_u32 s77, 0
    s_cbranch_scc1 lc_69
    buffer_store_dword v154, v154, s[20:23], s31 offen sc1
    s_branch lc_70
lc_69:
    buffer_store_dword v154, v154, s[20:23], s31 offen
lc_70:
    s_mov_b64 exec, -1
    v_bfe_u32 v20, v252, 3, 2
    v_lshrrev_b32 v21, 5, v252
    v_lshl_add_u32 v20, v21, 3, v20
    s_lshr_b32 s32, s28, 1
    s_lshl_b32 s32, s32, 4
    s_and_b32 s33, s28, 1
    s_lshl_b32 s33, s33, 2
    s_add_u32 s32, s32, s33
    v_add_u32 v20, s32, v20
    v_lshlrev_b32 v20, 11, v20
    v_lshrrev_b32 v21, 2, v252
    v_and_b32 v21, 4, v21
    v_xor_b32 v21, v21, v252
    v_and_b32 v21, 7, v21
    v_lshl_add_u32 v20, v21, 4, v20
    s_lshl_b32 s32, s98, 7
    v_add_u32 v14, s32, v20
    s_lshl_b32 s32, s28, 9
    s_sub_u32 s34, s29, 224
    s_lshl_b32 s34, s34, 1
    s_add_u32 s89, s34, s28
    s_and_b32 s35, s28, 1
    s_add_u32 s34, s34, s35
    s_lshl_b32 s34, s34, 5
    v_lshrrev_b32 v22, 1, v252
    v_and_b32 v23, 1, v252
    s_cmp_lt_u32 s29, 224
    s_cselect_b32 s32, s32, s34
    s_cselect_b64 vcc, -1, 0
    v_cndmask_b32 v22, v23, v22, vcc
    v_lshl_add_u32 v22, v22, 4, s32
    s_mov_b32 s79, s26
    s_cmp_lg_u32 s26, 0
    s_cbranch_scc1 sk_71
    s_mov_b32 s30, 0x05040100
    s_mov_b32 s31, 0x07060302
    v_perm_b32 v155, v160, v156, s30
    v_perm_b32 v160, v160, v156, s31
    v_perm_b32 v156, v161, v157, s30
    v_perm_b32 v161, v161, v157, s31
    v_perm_b32 v157, v162, v158, s30
    v_perm_b32 v162, v162, v158, s31
    v_perm_b32 v158, v163, v159, s30
    v_perm_b32 v163, v163, v159, s31
    v_perm_b32 v159, v168, v164, s30
    v_perm_b32 v168, v168, v164, s31
    v_perm_b32 v164, v169, v165, s30
    v_perm_b32 v169, v169, v165, s31
    v_perm_b32 v165, v170, v166, s30
    v_perm_b32 v170, v170, v166, s31
    v_perm_b32 v166, v171, v167, s30
    v_perm_b32 v171, v171, v167, s31
    v_perm_b32 v167, v176, v172, s30
    v_perm_b32 v176, v176, v172, s31
    v_perm_b32 v172, v177, v173, s30
    v_perm_b32 v177, v177, v173, s31
    v_perm_b32 v173, v178, v174, s30
    v_perm_b32 v178, v178, v174, s31
    v_perm_b32 v174, v179, v175, s30
    v_perm_b32 v179, v179, v175, s31
    v_perm_b32 v175, v184, v180, s30
    v_perm_b32 v184, v184, v180, s31
    v_perm_b32 v180, v185, v181, s30
    v_perm_b32 v185, v185, v181, s31
    v_perm_b32 v181, v186, v182, s30
    v_perm_b32 v186, v186, v182, s31
    v_perm_b32 v182, v187, v183, s30
    v_perm_b32 v187, v187, v183, s31
    v_perm_b32 v183, v192, v188, s30
    v_perm_b32 v192, v192, v188, s31
    v_perm_b32 v188, v193, v189, s30
    v_perm_b32 v193, v193, v189, s31
    v_perm_b32 v189, v194, v190, s30
    v_perm_b32 v194, v194, v190, s31
    v_perm_b32 v190, v195, v191, s30
    v_perm_b32 v195, v195, v191, s31
    v_perm_b32 v191, v200, v196, s30
    v_perm_b32 v200, v200, v196, s31
    v_perm_b32 v196, v201, v197, s30
    v_perm_b32 v201, v201, v197, s31
    v_perm_b32 v197, v202, v198, s30
    v_perm_b32 v202, v202, v198, s31
    v_perm_b32 v198, v203, v199, s30
    v_perm_b32 v203, v203, v199, s31
    v_perm_b32 v199, v208, v204, s30
    v_perm_b32 v208, v208, v204, s31
    v_perm_b32 v204, v209, v205, s30
    v_perm_b32 v209, v209, v205, s31
    v_perm_b32 v205, v210, v206, s30
    v_perm_b32 v210, v210, v206, s31
    v_perm_b32 v206, v211, v207, s30
    v_perm_b32 v211, v211, v207, s31
    v_perm_b32 v207, v216, v212, s30
    v_perm_b32 v216, v216, v212, s31
    v_perm_b32 v212, v217, v213, s30
    v_perm_b32 v217, v217, v213, s31
    v_perm_b32 v213, v218, v214, s30
    v_perm_b32 v218, v218, v214, s31
    v_perm_b32 v214, v219, v215, s30
    v_perm_b32 v219, v219, v215, s31
    v_perm_b32 v215, v224, v220, s30
    v_perm_b32 v224, v224, v220, s31
    v_perm_b32 v220, v225, v221, s30
    v_perm_b32 v225, v225, v221, s31
    v_perm_b32 v221, v226, v222, s30
    v_perm_b32 v226, v226, v222, s31
    v_perm_b32 v222, v227, v223, s30
    v_perm_b32 v227, v227, v223, s31
    v_perm_b32 v223, v232, v228, s30
    v_perm_b32 v232, v232, v228, s31
    v_perm_b32 v228, v233, v229, s30
    v_perm_b32 v233, v233, v229, s31
    v_perm_b32 v229, v234, v230, s30
    v_perm_b32 v234, v234, v230, s31
    v_perm_b32 v230, v235, v231, s30
    v_perm_b32 v235, v235, v231, s31
    v_perm_b32 v231, v240, v236, s30
    v_perm_b32 v240, v240, v236, s31
    v_perm_b32 v236, v241, v237, s30
    v_perm_b32 v241, v241, v237, s31
    v_perm_b32 v237, v242, v238, s30
    v_perm_b32 v242, v242, v238, s31
    v_perm_b32 v238, v243, v239, s30
    v_perm_b32 v243, v243, v239, s31
    v_perm_b32 v239, v248, v244, s30
    v_perm_b32 v248, v248, v244, s31
    v_perm_b32 v244, v249, v245, s30
    v_perm_b32 v249, v249, v245, s31
    v_perm_b32 v245, v250, v246, s30
    v_perm_b32 v250, v250, v246, s31
    v_perm_b32 v246, v251, v247, s30
    v_perm_b32 v251, v251, v247, s31
    v_lshrrev_b32 v21, 3, v252
    s_lshl_b32 s84, s24, 18
    s_add_u32 s84, s84, s86
    s_add_u32 s84, s84, 0x2000000
    v_mul_u32_u24 v20, 6144, v21
    v_and_b32 v21, 6, v21
    v_xor_b32 v21, v21, v252
    v_and_b32 v21, 7, v21
    v_lshl_add_u32 v20, v21, 4, v20
    s_mul_i32 s32, s28, 3
    s_bfe_u32 s33, s32, 0x10001
    s_mul_i32 s33, s33, 196608
    s_and_b32 s34, s32, 1
    s_mul_i32 s34, s34, 49152
    s_add_u32 s33, s33, s34
    s_lshr_b32 s34, s32, 2
    s_lshl_b32 s34, s34, 11
    s_add_u32 s33, s33, s34
    v_add_u32 v8, s33, v20
    v_add_u32 v9, 97280, v8
    s_add_u32 s32, s32, 1
    s_bfe_u32 s33, s32, 0x10001
    s_mul_i32 s33, s33, 196608
    s_and_b32 s34, s32, 1
    s_mul_i32 s34, s34, 49152
    s_add_u32 s33, s33, s34
    s_lshr_b32 s34, s32, 2
    s_lshl_b32 s34, s34, 11
    s_add_u32 s33, s33, s34
    s_sub_u32 s33, s33, 2048
    v_add_u32 v10, s33, v20
    v_add_u32 v11, 97280, v10
    s_add_u32 s32, s32, 1
    s_bfe_u32 s33, s32, 0x10001
    s_mul_i32 s33, s33, 196608
    s_and_b32 s34, s32, 1
    s_mul_i32 s34, s34, 49152
    s_add_u32 s33, s33, s34
    s_lshr_b32 s34, s32, 2
    s_lshl_b32 s34, s34, 11
    s_add_u32 s33, s33, s34
    v_add_u32 v12, s33, v20
    v_add_u32 v13, 97280, v12
    s_sub_u32 s30, s95, 1
    s_sub_u32 s95, s94, 3
    s_mov_b32 s94, s30
    v_bfe_u32 v116, v252, 4, 1
    v_lshlrev_b32 v116, 11, v116
    v_lshrrev_b32 v117, 5, v252
    v_lshl_add_u32 v116, v117, 8, v116
    v_and_b32 v117, 15, v252
    v_lshl_add_u32 v116, v117, 4, v116
    s_lshl_b32 s34, s28, 12
    s_add_u32 s34, s34, 147456
    v_add_u32 v117, s34, v116
    v_and_b32 v16, 15, v252
    v_lshlrev_b32 v16, 9, v16
    s_load_dwordx2 s[12:13], s[0:1], 64
    s_mov_b32 s14, 0x400000
    s_mov_b32 s15, 0x20000
    s_waitcnt lgkmcnt(0)
sk_71:
    s_barrier
    s_add_u32 s96, s25, 12
    s_and_b32 s96, s96, 15
    s_lshl_b32 s96, s96, 17
    s_add_u32 s96, s96, 65536
    s_add_u32 m0, s101, 114688
    s_nop 0
    buffer_load_dwordx4 v14, s[8:11], s96 offen lds
    s_add_u32 s96, s25, 13
    s_and_b32 s96, s96, 15
    s_lshl_b32 s96, s96, 17
    s_add_u32 s96, s96, 65536
    s_add_u32 m0, s101, 118784
    s_nop 0
    buffer_load_dwordx4 v14, s[8:11], s96 offen lds
    s_add_u32 s96, s25, 14
    s_and_b32 s96, s96, 15
    s_lshl_b32 s96, s96, 17
    s_add_u32 s96, s96, 65536
    s_add_u32 m0, s101, 122880
    s_nop 0
    buffer_load_dwordx4 v14, s[8:11], s96 offen lds
    s_add_u32 s96, s25, 15
    s_and_b32 s96, s96, 15
    s_lshl_b32 s96, s96, 17
    s_add_u32 s96, s96, 65536
    s_add_u32 m0, s101, 126976
    s_nop 0
    buffer_load_dwordx4 v14, s[8:11], s96 offen lds
    s_waitcnt vmcnt(0)
    s_barrier
    s_cmp_lg_u32 s26, 0
    s_cbranch_scc1 l_tail
    s_mov_b32 s26, 16777216
    s_add_u32 s96, s94, 0
    s_and_b32 s96, s96, 15
    s_mul_i32 s96, s96, 393216
    s_add_u32 s96, s96, s85
    s_add_u32 m0, s87, 40960
    s_nop 0
    buffer_load_dwordx4 v8, s[16:19], s96 offen offset:0 lds
    buffer_load_dwordx4 v9, s[16:19], s96 offen offset:1024 lds
    buffer_load_dwordx4 v10, s[16:19], s96 offen offset:2048 lds
    buffer_load_dwordx4 v11, s[16:19], s96 offen offset:3072 lds
    s_add_u32 m0, s87, 45056
    s_nop 0
    buffer_load_dwordx4 v12, s[16:19], s96 offen offset:0 lds
    buffer_load_dwordx4 v13, s[16:19], s96 offen offset:1024 lds
    s_add_u32 s96, s95, 1
    s_and_b32 s96, s96, 15
    s_mul_i32 s96, s96, 393216
    s_add_u32 s96, s96, s85
    s_add_u32 m0, s87, 65536
    s_nop 0
    buffer_load_dwordx4 v8, s[16:19], s96 offen offset:0 lds
    buffer_load_dwordx4 v9, s[16:19], s96 offen offset:1024 lds
    buffer_load_dwordx4 v10, s[16:19], s96 offen offset:2048 lds
    buffer_load_dwordx4 v11, s[16:19], s96 offen offset:3072 lds
    s_add_u32 m0, s87, 69632
    s_nop 0
    buffer_load_dwordx4 v12, s[16:19], s96 offen offset:0 lds
    buffer_load_dwordx4 v13, s[16:19], s96 offen offset:1024 lds
    s_lshl_b32 s30, s99, 13
    s_add_u32 s30, s30, 0xc00000
    s_waitcnt vmcnt(6)
    s_barrier
    s_add_u32 s96, s94, 2
    s_and_b32 s96, s96, 15
    s_mul_i32 s96, s96, 393216
    s_add_u32 s96, s96, s85
    s_add_u32 m0, s87, 90112
    s_nop 0
    buffer_load_dwordx4 v8, s[16:19], s96 offen offset:0 lds
    buffer_load_dwordx4 v9, s[16:19], s96 offen offset:1024 lds
    buffer_load_dwordx4 v10, s[16:19], s96 offen offset:2048 lds
    buffer_load_dwordx4 v11, s[16:19], s96 offen offset:3072 lds
    s_add_u32 m0, s87, 94208
    s_nop 0
    buffer_load_dwordx4 v12, s[16:19], s96 offen offset:0 lds
    buffer_load_dwordx4 v13, s[16:19], s96 offen offset:1024 lds
    ds_read_b128 v[100:103], v117 offset:0
    ds_read_b128 v[104:107], v117 offset:512
    ds_read_b128 v[108:111], v117 offset:1024
    ds_read_b128 v[112:115], v117 offset:1536
    s_mov_b32 s78, s27
pl_72:
    buffer_load_dword v17, v16, s[20:23], s30 offen sc1
    s_waitcnt vmcnt(0)
pc_73:
    v_cmp_eq_u32 vcc, -1, v17
    s_cbranch_vccz pd_74
    s_sub_u32 s78, s78, 1
    s_cmp_lg_u32 s78, 0
    s_cbranch_scc1 pl_72
    s_mov_b32 s27, 1
pd_74:
    s_add_u32 s96, s95, 1
    s_and_b32 s96, s96, 15
    s_lshl_b32 s97, s96, 14
    s_add_u32 s97, s97, s84
    s_add_u32 m0, s86, 131072
    s_nop 0
    buffer_load_dwordx4 v253, s[20:23], s97 offen offset:0 sc1 lds
    buffer_load_dwordx4 v253, s[20:23], s97 offen offset:1024 sc1 lds
    buffer_load_dwordx4 v253, s[20:23], s97 offen offset:2048 sc1 lds
    buffer_load_dwordx4 v253, s[20:23], s97 offen offset:3072 sc1 lds
    s_lshl_b32 s30, s99, 13
    s_add_u32 s30, s30, 0xc00000
    s_add_u32 s31, s30, 4096
    buffer_load_dwordx4 v[64:67], v253, s[20:23], s30 offen offset:0 sc1
    buffer_load_dwordx4 v[68:71], v253, s[20:23], s30 offen offset:1024 sc1
    buffer_load_dwordx4 v[72:75], v253, s[20:23], s30 offen offset:2048 sc1
    buffer_load_dwordx4 v[76:79], v253, s[20:23], s30 offen offset:3072 sc1
    buffer_load_dwordx4 v[80:83], v253, s[20:23], s31 offen offset:0 sc1
    buffer_load_dwordx4 v[84:87], v253, s[20:23], s31 offen offset:1024 sc1
    buffer_load_dwordx4 v[88:91], v253, s[20:23], s31 offen offset:2048 sc1
    buffer_load_dwordx4 v[92:95], v253, s[20:23], s31 offen offset:3072 sc1
    s_waitcnt vmcnt(8) lgkmcnt(0)
    s_barrier
    s_add_u32 s96, s94, 2
    s_and_b32 s96, s96, 15
    s_lshl_b32 s97, s96, 14
    s_add_u32 s97, s97, s84
    s_add_u32 m0, s86, 114688
    s_nop 0
    buffer_load_dwordx4 v253, s[20:23], s97 offen offset:0 sc1 lds
    buffer_load_dwordx4 v253, s[20:23], s97 offen offset:1024 sc1 lds
    buffer_load_dwordx4 v253, s[20:23], s97 offen offset:2048 sc1 lds
    buffer_load_dwordx4 v253, s[20:23], s97 offen offset:3072 sc1 lds
    s_mov_b32 s78, s27
    s_waitcnt vmcnt(4)
    s_branch pc_76
pl_75:
    s_lshl_b32 s30, s99, 13
    s_add_u32 s30, s30, 0xc00000
    s_add_u32 s31, s30, 4096
    buffer_load_dwordx4 v[64:67], v253, s[20:23], s30 offen offset:0 sc1
    buffer_load_dwordx4 v[68:71], v253, s[20:23], s30 offen offset:1024 sc1
    buffer_load_dwordx4 v[72:75], v253, s[20:23], s30 offen offset:2048 sc1
    buffer_load_dwordx4 v[76:79], v253, s[20:23], s30 offen offset:3072 sc1
    buffer_load_dwordx4 v[80:83], v253, s[20:23], s31 offen offset:0 sc1
    buffer_load_dwordx4 v[84:87], v253, s[20:23], s31 offen offset:1024 sc1
    buffer_load_dwordx4 v[88:91], v253, s[20:23], s31 offen offset:2048 sc1
    buffer_load_dwordx4 v[92:95], v253, s[20:23], s31 offen offset:3072 sc1
    s_waitcnt vmcnt(0)
pc_76:
    v_max3_u32 v48, v64, v65, v66
    v_max3_u32 v48, v48, v67, v68
    v_max3_u32 v48, v48, v69, v70
    v_max3_u32 v48, v48, v71, v72
    v_max3_u32 v48, v48, v73, v74
    v_max3_u32 v48, v48, v75, v76
    v_max3_u32 v48, v48, v77, v78
    v_max3_u32 v48, v48, v79, v80
    v_max3_u32 v48, v48, v81, v82
    v_max3_u32 v48, v48, v83, v84
    v_max3_u32 v48, v48, v85, v86
    v_max3_u32 v48, v48, v87, v88
    v_max3_u32 v48, v48, v89, v90
    v_max3_u32 v48, v48, v91, v92
    v_max3_u32 v48, v48, v93, v94
    v_max_u32 v48, v48, v95
    v_cmp_eq_u32 vcc, -1, v48
    s_cbranch_vccz pd_77
    s_sub_u32 s78, s78, 1
    s_cmp_lg_u32 s78, 0
    s_cbranch_scc1 pl_75
    s_mov_b32 s27, 1
pd_77:
    s_add_u32 s96, s95, 3
    s_and_b32 s96, s96, 15
    s_lshl_b32 s97, s96, 14
    s_add_u32 s97, s97, s84
    s_add_u32 m0, s86, 147456
    s_nop 0
    buffer_load_dwordx4 v253, s[20:23], s97 offen offset:0 sc1 lds
    buffer_load_dwordx4 v253, s[20:23], s97 offen offset:1024 sc1 lds
    buffer_load_dwordx4 v253, s[20:23], s97 offen offset:2048 sc1 lds
    v_pk_add_f32 v[64:65], v[64:65], v[68:69]
    v_pk_add_f32 v[66:67], v[66:67], v[70:71]
    v_pk_add_f32 v[64:65], v[64:65], v[72:73]
    v_pk_add_f32 v[66:67], v[66:67], v[74:75]
    v_pk_add_f32 v[64:65], v[64:65], v[76:77]
    v_pk_add_f32 v[66:67], v[66:67], v[78:79]
    v_pk_add_f32 v[64:65], v[64:65], v[80:81]
    v_pk_add_f32 v[66:67], v[66:67], v[82:83]
    buffer_load_dwordx4 v253, s[20:23], s97 offen offset:3072 sc1 lds
    v_pk_add_f32 v[64:65], v[64:65], v[84:85]
    v_pk_add_f32 v[66:67], v[66:67], v[86:87]
    v_pk_add_f32 v[64:65], v[64:65], v[88:89]
    v_pk_add_f32 v[66:67], v[66:67], v[90:91]
    v_pk_add_f32 v[64:65], v[64:65], v[92:93]
    v_pk_add_f32 v[66:67], v[66:67], v[94:95]
    v_mov_b32 v48, v64
    v_mov_b32 v49, v65
    v_mov_b32 v50, v66
    v_mov_b32 v51, v67
    v_permlane32_swap_b32 v64, v48
    v_permlane32_swap_b32 v65, v49
    v_permlane32_swap_b32 v66, v50
    s_add_u32 s96, s95, 3
    s_and_b32 s96, s96, 15
    s_mul_i32 s96, s96, 393216
    s_add_u32 s96, s96, s85
    s_add_u32 m0, s87, 40960
    s_nop 0
    buffer_load_dwordx4 v8, s[16:19], s96 offen offset:0 lds
    v_permlane32_swap_b32 v67, v51
    v_add_f32 v64, v64, v48
    v_add_f32 v65, v65, v49
    v_add_f32 v66, v66, v50
    v_add_f32 v67, v67, v51
    v_mul_f32 v54, 0x3a800000, v64
    v_mul_f32 v65, 0x3a800000, v65
    v_fma_f32 v65, -v54, v54, v65
    v_max_f32 v65, 0, v65
    v_add_f32 v55, 0x3727c5ac, v65
    v_rsq_f32 v55, v55
    v_fma_f32 v52, -v54, v67, v66
    buffer_load_dwordx4 v9, s[16:19], s96 offen offset:1024 lds
    v_and_b32 v53, 31, v252
    v_mul_f32 v52, v52, v55
    s_lshl_b32 s32, s99, 5
    v_add_u32 v53, s32, v53
    v_mov_b32 v48, v52
    s_nop 1
    v_max_f32_dpp v48, v48, v48 quad_perm:[1,0,3,2] row_mask:0xf bank_mask:0xf
    s_nop 1
    v_max_f32_dpp v48, v48, v48 quad_perm:[2,3,0,1] row_mask:0xf bank_mask:0xf
    s_nop 1
    v_max_f32_dpp v48, v48, v48 row_half_mirror row_mask:0xf bank_mask:0xf
    s_nop 1
    v_max_f32_dpp v48, v48, v48 row_mirror row_mask:0xf bank_mask:0xf
    v_mov_b32 v49, v48
    s_nop 1
    v_permlane16_swap_b32 v48, v49
    v_max_f32 v48, v48, v49
    v_cmp_eq_f32 vcc, v48, v52
    buffer_load_dwordx4 v10, s[16:19], s96 offen offset:2048 lds
    v_lshrrev_b32 v50, 5, v252
    v_lshlrev_b32 v50, 4, v50
    s_lshl_b32 s32, s99, 11
    s_lshl_b32 s33, s98, 7
    s_add_u32 s32, s32, s33
    s_add_u32 s32, s32, 0xd60000
    s_lshl_b32 s34, s99, 4
    s_add_u32 s34, s34, 0xdc0000
    s_ff1_i32_b32 s35, vcc_lo
    s_lshl_b32 s35, 1, s35
    s_cmp_eq_u32 s25, 0
    s_cselect_b32 exec_lo, s35, 0
    s_mov_b32 exec_hi, 0
    buffer_store_dwordx4 v[52:55], v50, s[20:23], s34 offen sc1
    s_mov_b32 exec_lo, s35
    s_mov_b32 exec_hi, s35
    buffer_store_dwordx4 v[100:103], v50, s[20:23], s32 offen offset:0 sc1
    buffer_store_dwordx4 v[104:107], v50, s[20:23], s32 offen offset:32 sc1
    buffer_store_dwordx4 v[108:111], v50, s[20:23], s32 offen offset:64 sc1
    buffer_store_dwordx4 v[112:115], v50, s[20:23], s32 offen offset:96 sc1
    s_mov_b64 exec, -1
    buffer_load_dwordx4 v11, s[16:19], s96 offen offset:3072 lds
    v_add_f32 v56, 1.0, v55
    v_mul_f32 v57, v54, v55
    s_add_u32 m0, s87, 45056
    s_nop 0
    buffer_load_dwordx4 v12, s[16:19], s96 offen offset:0 lds
    v_mul_f32 v58, v56, v56
    v_sub_f32 v57, 0, v57
    v_mul_f32 v58, v58, v65
    v_add_f32 v58, 0x3727c5ac, v58
    v_rsq_f32 v58, v58
    s_nop 0
    v_mul_f32 v58, v58, v56
    v_cmp_gt_u32 vcc, 32, v252
    v_and_b32 v48, 31, v252
    v_lshrrev_b32 v49, 5, v252
    v_lshlrev_b32 v49, 9, v49
    v_lshl_add_u32 v48, v48, 2, v49
    s_lshl_b32 s32, s28, 7
    buffer_load_dwordx4 v13, s[16:19], s96 offen offset:1024 lds
    v_add_u32 v48, s32, v48
    v_cndmask_b32 v49, v54, v58, vcc
    v_cndmask_b32 v50, v57, v56, vcc
    ds_write_b32 v48, v49 offset:0
    ds_write_b32 v48, v50 offset:2048
    v_and_b32 v48, 15, v252
    v_lshrrev_b32 v51, 4, v252
    v_lshl_add_u32 v48, v48, 2, v51
    s_min_u32 s32, s28, 2
    s_lshl_b32 s32, s32, 8
    v_lshl_add_u32 v48, v48, 2, s32
    ds_write_b32 v48, v2 offset:1024
    s_waitcnt vmcnt(14) lgkmcnt(0)
    s_barrier
    s_add_u32 s96, s94, 4
    s_and_b32 s96, s96, 15
    s_lshl_b32 s97, s96, 14
    s_add_u32 s97, s97, s84
    s_add_u32 m0, s86, 131072
    s_nop 0
    buffer_load_dwordx4 v253, s[20:23], s97 offen offset:0 sc1 lds
    buffer_load_dwordx4 v253, s[20:23], s97 offen offset:1024 sc1 lds
    buffer_load_dwordx4 v253, s[20:23], s97 offen offset:2048 sc1 lds
    buffer_load_dwordx4 v253, s[20:23], s97 offen offset:3072 sc1 lds
    s_add_u32 s96, s94, 4
    s_and_b32 s96, s96, 15
    s_mul_i32 s96, s96, 393216
    s_add_u32 s96, s96, s85
    s_add_u32 m0, s87, 65536
    s_nop 0
    buffer_load_dwordx4 v8, s[16:19], s96 offen offset:0 lds
    buffer_load_dwordx4 v9, s[16:19], s96 offen offset:1024 lds
    buffer_load_dwordx4 v10, s[16:19], s96 offen offset:2048 lds
    buffer_load_dwordx4 v11, s[16:19], s96 offen offset:3072 lds
    s_add_u32 m0, s87, 69632
    s_nop 0
    buffer_load_dwordx4 v12, s[16:19], s96 offen offset:0 lds
    buffer_load_dwordx4 v13, s[16:19], s96 offen offset:1024 lds
    s_waitcnt vmcnt(10) lgkmcnt(0)
    s_barrier
    s_add_u32 s96, s95, 5
    s_and_b32 s96, s96, 15
    s_lshl_b32 s97, s96, 14
    s_add_u32 s97, s97, s84
    s_add_u32 m0, s86, 114688
    s_nop 0
    buffer_load_dwordx4 v253, s[20:23], s97 offen offset:0 sc1 lds
    buffer_load_dwordx4 v253, s[20:23], s97 offen offset:1024 sc1 lds
    buffer_load_dwordx4 v253, s[20:23], s97 offen offset:2048 sc1 lds
    buffer_load_dwordx4 v253, s[20:23], s97 offen offset:3072 sc1 lds
    s_add_u32 s96, s95, 5
    s_and_b32 s96, s96, 15
    s_mul_i32 s96, s96, 393216
    s_add_u32 s96, s96, s85
    s_add_u32 m0, s87, 90112
    s_nop 0
    buffer_load_dwordx4 v8, s[16:19], s96 offen offset:0 lds
    buffer_load_dwordx4 v9, s[16:19], s96 offen offset:1024 lds
    buffer_load_dwordx4 v10, s[16:19], s96 offen offset:2048 lds
    buffer_load_dwordx4 v11, s[16:19], s96 offen offset:3072 lds
    s_add_u32 m0, s87, 94208
    s_nop 0
    buffer_load_dwordx4 v12, s[16:19], s96 offen offset:0 lds
    buffer_load_dwordx4 v13, s[16:19], s96 offen offset:1024 lds
    s_waitcnt vmcnt(10) lgkmcnt(0)
    s_barrier
    s_add_u32 s32, s79, 0xdc0000
    s_add_u32 s96, s94, 6
    s_and_b32 s96, s96, 15
    s_lshl_b32 s97, s96, 14
    s_add_u32 s97, s97, s84
    s_add_u32 m0, s86, 147456
    s_nop 0
    buffer_load_dwordx4 v253, s[20:23], s97 offen offset:0 sc1 lds
    buffer_load_dwordx4 v253, s[20:23], s97 offen offset:1024 sc1 lds
    buffer_load_dwordx4 v253, s[20:23], s97 offen offset:2048 sc1 lds
    buffer_load_dwordx4 v253, s[20:23], s97 offen offset:3072 sc1 lds
    s_add_u32 s96, s94, 6
    s_and_b32 s96, s96, 15
    s_mul_i32 s96, s96, 393216
    s_add_u32 s96, s96, s85
    s_add_u32 m0, s87, 40960
    s_nop 0
    buffer_load_dwordx4 v8, s[16:19], s96 offen offset:0 lds
    buffer_load_dwordx4 v[16:19], v253, s[20:23], s32 offen sc1
    buffer_load_dwordx4 v9, s[16:19], s96 offen offset:1024 lds
    buffer_load_dwordx4 v10, s[16:19], s96 offen offset:2048 lds
    buffer_load_dwordx4 v11, s[16:19], s96 offen offset:3072 lds
    s_add_u32 m0, s87, 45056
    s_nop 0
    buffer_load_dwordx4 v12, s[16:19], s96 offen offset:0 lds
    buffer_load_dwordx4 v13, s[16:19], s96 offen offset:1024 lds
    s_waitcnt vmcnt(11) lgkmcnt(0)
    s_barrier
    s_mov_b32 s78, s27
    s_waitcnt vmcnt(5)
    s_branch pc_80
pl_79:
    s_add_u32 s32, s79, 0xdc0000
    buffer_load_dwordx4 v[16:19], v253, s[20:23], s32 offen sc1
    s_waitcnt vmcnt(0)
pc_80:
    v_max3_u32 v20, v16, v17, v18
    v_max_u32 v20, v20, v19
    v_cmp_eq_u32 vcc, -1, v20
    s_cbranch_vccz pd_81
    s_sub_u32 s78, s78, 1
    s_cmp_lg_u32 s78, 0
    s_cbranch_scc1 pl_79
    s_mov_b32 s27, 1
pd_81:
    s_add_u32 s96, s95, 7
    s_and_b32 s96, s96, 15
    s_lshl_b32 s97, s96, 14
    s_add_u32 s97, s97, s84
    s_add_u32 m0, s86, 131072
    s_nop 0
    buffer_load_dwordx4 v253, s[20:23], s97 offen offset:0 sc1 lds
    buffer_load_dwordx4 v253, s[20:23], s97 offen offset:1024 sc1 lds
    buffer_load_dwordx4 v253, s[20:23], s97 offen offset:2048 sc1 lds
    v_mov_b32 v20, v16
    buffer_load_dwordx4 v253, s[20:23], s97 offen offset:3072 sc1 lds
    s_nop 0
    v_max_f32_dpp v20, v20, v20 quad_perm:[1,0,3,2] row_mask:0xf bank_mask:0xf
    s_nop 1
    v_max_f32_dpp v20, v20, v20 quad_perm:[2,3,0,1] row_mask:0xf bank_mask:0xf
    s_nop 1
    v_max_f32_dpp v20, v20, v20 row_half_mirror row_mask:0xf bank_mask:0xf
    s_nop 1
    v_max_f32_dpp v20, v20, v20 row_mirror row_mask:0xf bank_mask:0xf
    v_mov_b32 v21, v20
    s_add_u32 s96, s95, 7
    s_and_b32 s96, s96, 15
    s_mul_i32 s96, s96, 393216
    s_add_u32 s96, s96, s85
    s_add_u32 m0, s87, 65536
    s_nop 0
    buffer_load_dwordx4 v8, s[16:19], s96 offen offset:0 lds
    v_permlane16_swap_b32 v20, v21
    v_max_f32 v20, v20, v21
    v_mov_b32 v21, v20
    s_nop 1
    v_permlane32_swap_b32 v20, v21
    buffer_load_dwordx4 v9, s[16:19], s96 offen offset:1024 lds
    v_max_f32 v20, v20, v21
    v_cmp_eq_f32 vcc, v20, v16
    s_ff1_i32_b64 s32, vcc
    s_and_b32 s32, s32, 63
    v_readlane_b32 s74, v16, s32
    buffer_load_dwordx4 v10, s[16:19], s96 offen offset:2048 lds
    v_readlane_b32 s73, v17, s32
    v_readlane_b32 s75, v18, s32
    v_readlane_b32 s76, v19, s32
    s_and_b32 s73, s73, 2047
    s_lshr_b32 s33, s73, 5
    buffer_load_dwordx4 v11, s[16:19], s96 offen offset:3072 lds
    s_lshl_b32 s33, s33, 11
    s_add_u32 s33, s33, s79
    s_add_u32 s33, s33, 0xd60000
    buffer_load_dwordx4 v[24:27], v22, s[20:23], s33 offen sc1
    v_mov_b32 v20, s73
    s_add_u32 m0, s87, 69632
    s_nop 0
    buffer_load_dwordx4 v12, s[16:19], s96 offen offset:0 lds
    v_mov_b32 v21, s77
    v_mov_b32 v19, 0
    ds_write_b64 v19, v[20:21] offset:3072
    s_lshr_b32 s39, s73, 5
    s_lshl_b32 s34, s24, 2
    buffer_load_dwordx4 v13, s[16:19], s96 offen offset:1024 lds
    s_sub_u32 s39, s39, s34
    s_add_u32 s39, s39, 8
    s_cmp_lt_u32 s39, 12
    s_cselect_b32 s100, 1, 0
    s_waitcnt vmcnt(11) lgkmcnt(0)
    s_barrier
    s_add_u32 s96, s94, 8
    s_and_b32 s96, s96, 15
    s_lshl_b32 s97, s96, 14
    s_add_u32 s97, s97, s84
    s_add_u32 m0, s86, 114688
    s_nop 0
    buffer_load_dwordx4 v253, s[20:23], s97 offen offset:0 sc1 lds
    buffer_load_dwordx4 v253, s[20:23], s97 offen offset:1024 sc1 lds
    s_mov_b32 s78, s27
    s_waitcnt vmcnt(4)
    s_branch pc_83
pl_82:
    s_lshr_b32 s33, s73, 5
    s_lshl_b32 s33, s33, 11
    s_add_u32 s33, s33, s79
    s_add_u32 s33, s33, 0xd60000
    buffer_load_dwordx4 v[24:27], v22, s[20:23], s33 offen sc1
    s_waitcnt vmcnt(0)
pc_83:
    v_max3_u32 v30, v24, v25, v26
    v_max_u32 v30, v30, v27
    v_cmp_eq_u32 vcc, -1, v30
    s_cbranch_vccz pd_84
    s_sub_u32 s78, s78, 1
    s_cmp_lg_u32 s78, 0
    s_cbranch_scc1 pl_82
    s_mov_b32 s27, 1
pd_84:
    buffer_load_dwordx4 v253, s[20:23], s97 offen offset:2048 sc1 lds
    v_and_b32 v30, 2, v252
    v_cmp_eq_u32 vcc, 2, v30
    v_mov_b32 v28, s76
    v_mul_f32 v29, s75, v28
    v_add_f32 v28, 1.0, v28
    v_cndmask_b32 v30, v24, v26, vcc
    v_cndmask_b32 v31, v25, v27, vcc
    v_lshlrev_b32 v92, 16, v30
    v_and_b32 v93, 0xffff0000, v30
    v_lshlrev_b32 v94, 16, v31
    v_and_b32 v95, 0xffff0000, v31
    v_fma_f32 v92, v92, v28, -v29
    v_fma_f32 v93, v93, v28, -v29
    v_fma_f32 v94, v94, v28, -v29
    v_fma_f32 v95, v95, v28, -v29
    v_mov_b32 v96, 0xbfb8aa3b
    v_mul_f32 v96, s74, v96
    v_exp_f32 v96, v96
    s_nop 0
    v_add_f32 v96, 1.0, v96
    v_rcp_f32 v96, v96
    buffer_load_dwordx4 v253, s[20:23], s97 offen offset:3072 sc1 lds
    v_mov_b32 v28, s76
    v_mul_f32 v29, s75, v28
    v_lshlrev_b32 v30, 16, v24
    v_and_b32 v31, 0xffff0000, v24
    v_fma_f32 v30, v30, v28, -v29
    v_fma_f32 v31, v31, v28, -v29
    v_cvt_pk_bf16_f32 v24, v30, v31
    v_lshlrev_b32 v30, 16, v25
    v_and_b32 v31, 0xffff0000, v25
    v_fma_f32 v30, v30, v28, -v29
    v_fma_f32 v31, v31, v28, -v29
    v_cvt_pk_bf16_f32 v25, v30, v31
    v_lshlrev_b32 v30, 16, v26
    v_and_b32 v31, 0xffff0000, v26
    v_fma_f32 v30, v30, v28, -v29
    v_fma_f32 v31, v31, v28, -v29
    v_cvt_pk_bf16_f32 v26, v30, v31
    v_lshlrev_b32 v30, 16, v27
    v_and_b32 v31, 0xffff0000, v27
    v_fma_f32 v30, v30, v28, -v29
    v_fma_f32 v31, v31, v28, -v29
    s_add_u32 s96, s94, 8
    s_and_b32 s96, s96, 15
    s_mul_i32 s96, s96, 393216
    s_add_u32 s96, s96, s85
    s_add_u32 m0, s87, 90112
    s_nop 0
    buffer_load_dwordx4 v8, s[16:19], s96 offen offset:0 lds
    v_cvt_pk_bf16_f32 v27, v30, v31
    s_bitcmp0_b32 s29, 0
    s_cbranch_scc1 sk_85
    v_swap_b32 v24, v25
    v_swap_b32 v26, v27
sk_85:
    s_bitcmp0_b32 s29, 1
    s_cbranch_scc1 sk_86
    v_swap_b32 v24, v26
    v_swap_b32 v25, v27
sk_86:
    v_dot2_f32_bf16 v32, v155, v24, 0
    v_dot2_f32_bf16 v33, v160, v24, 0
    v_dot2_f32_bf16 v34, v156, v24, 0
    v_dot2_f32_bf16 v35, v161, v24, 0
    v_dot2_f32_bf16 v36, v157, v24, 0
    v_dot2_f32_bf16 v37, v162, v24, 0
    buffer_load_dwordx4 v9, s[16:19], s96 offen offset:1024 lds
    v_dot2_f32_bf16 v38, v158, v24, 0
    v_dot2_f32_bf16 v39, v163, v24, 0
    v_dot2_f32_bf16 v40, v183, v24, 0
    v_dot2_f32_bf16 v41, v192, v24, 0
    v_dot2_f32_bf16 v42, v188, v24, 0
    v_dot2_f32_bf16 v43, v193, v24, 0
    v_dot2_f32_bf16 v44, v189, v24, 0
    v_dot2_f32_bf16 v45, v194, v24, 0
    v_dot2_f32_bf16 v46, v190, v24, 0
    v_dot2_f32_bf16 v47, v195, v24, 0
    v_dot2_f32_bf16 v32, v159, v25, v32
    v_dot2_f32_bf16 v33, v168, v25, v33
    v_dot2_f32_bf16 v34, v164, v25, v34
    v_dot2_f32_bf16 v35, v169, v25, v35
    v_dot2_f32_bf16 v36, v165, v25, v36
    v_dot2_f32_bf16 v37, v170, v25, v37
    v_dot2_f32_bf16 v38, v166, v25, v38
    v_dot2_f32_bf16 v39, v171, v25, v39
    v_dot2_f32_bf16 v40, v191, v25, v40
    v_dot2_f32_bf16 v41, v200, v25, v41
    v_dot2_f32_bf16 v42, v196, v25, v42
    buffer_load_dwordx4 v10, s[16:19], s96 offen offset:2048 lds
    v_dot2_f32_bf16 v43, v201, v25, v43
    v_dot2_f32_bf16 v44, v197, v25, v44
    v_dot2_f32_bf16 v45, v202, v25, v45
    v_dot2_f32_bf16 v46, v198, v25, v46
    v_dot2_f32_bf16 v47, v203, v25, v47
    v_dot2_f32_bf16 v32, v167, v26, v32
    v_dot2_f32_bf16 v33, v176, v26, v33
    v_dot2_f32_bf16 v34, v172, v26, v34
    v_dot2_f32_bf16 v35, v177, v26, v35
    v_dot2_f32_bf16 v36, v173, v26, v36
    v_dot2_f32_bf16 v37, v178, v26, v37
    v_dot2_f32_bf16 v38, v174, v26, v38
    v_dot2_f32_bf16 v39, v179, v26, v39
    v_dot2_f32_bf16 v40, v199, v26, v40
    v_dot2_f32_bf16 v41, v208, v26, v41
    v_dot2_f32_bf16 v42, v204, v26, v42
    v_dot2_f32_bf16 v43, v209, v26, v43
    v_dot2_f32_bf16 v44, v205, v26, v44
    v_dot2_f32_bf16 v45, v210, v26, v45
    v_dot2_f32_bf16 v46, v206, v26, v46
    v_dot2_f32_bf16 v47, v211, v26, v47
    buffer_load_dwordx4 v11, s[16:19], s96 offen offset:3072 lds
    v_dot2_f32_bf16 v32, v175, v27, v32
    v_dot2_f32_bf16 v33, v184, v27, v33
    v_dot2_f32_bf16 v34, v180, v27, v34
    v_dot2_f32_bf16 v35, v185, v27, v35
    v_dot2_f32_bf16 v36, v181, v27, v36
    v_dot2_f32_bf16 v37, v186, v27, v37
    v_dot2_f32_bf16 v38, v182, v27, v38
    v_dot2_f32_bf16 v39, v187, v27, v39
    v_dot2_f32_bf16 v40, v207, v27, v40
    v_dot2_f32_bf16 v41, v216, v27, v41
    v_dot2_f32_bf16 v42, v212, v27, v42
    v_dot2_f32_bf16 v43, v217, v27, v43
    v_dot2_f32_bf16 v44, v213, v27, v44
    v_dot2_f32_bf16 v45, v218, v27, v45
    v_dot2_f32_bf16 v46, v214, v27, v46
    v_dot2_f32_bf16 v47, v219, v27, v47
    v_lshrrev_b32 v31, 5, v252
    v_lshlrev_b32 v30, 6, v31
    v_permlane32_swap_b32 v32, v40
    v_permlane32_swap_b32 v33, v41
    v_permlane32_swap_b32 v34, v42
    s_add_u32 m0, s87, 94208
    s_nop 0
    buffer_load_dwordx4 v12, s[16:19], s96 offen offset:0 lds
    v_permlane32_swap_b32 v35, v43
    v_permlane32_swap_b32 v36, v44
    v_permlane32_swap_b32 v37, v45
    v_permlane32_swap_b32 v38, v46
    v_permlane32_swap_b32 v39, v47
    v_add_f32 v32, v32, v40
    v_add_f32 v33, v33, v41
    v_add_f32 v34, v34, v42
    v_add_f32 v35, v35, v43
    v_add_f32 v36, v36, v44
    v_add_f32 v37, v37, v45
    v_add_f32 v38, v38, v46
    v_add_f32 v39, v39, v47
    v_and_b32 v31, 1, v252
    v_lshl_add_u32 v30, v31, 5, v30
    v_permlane16_swap_b32 v32, v36
    v_permlane16_swap_b32 v33, v37
    v_permlane16_swap_b32 v34, v38
    v_permlane16_swap_b32 v35, v39
    v_add_f32 v32, v32, v36
    v_add_f32 v33, v33, v37
    buffer_load_dwordx4 v13, s[16:19], s96 offen offset:1024 lds
    v_add_f32 v34, v34, v38
    v_add_f32 v35, v35, v39
    v_and_b32 v31, 16, v252
    s_lshl_b32 s32, s28, 7
    v_add3_u32 v30, v31, v30, s32
    v_add_f32_dpp v32, v32, v32 quad_perm:[2,3,0,1] row_mask:0xf bank_mask:0xf
    v_add_f32_dpp v33, v33, v33 quad_perm:[2,3,0,1] row_mask:0xf bank_mask:0xf
    v_add_f32_dpp v34, v34, v34 quad_perm:[2,3,0,1] row_mask:0xf bank_mask:0xf
    v_add_f32_dpp v35, v35, v35 quad_perm:[2,3,0,1] row_mask:0xf bank_mask:0xf
    v_add_f32_dpp v32, v32, v32 row_ror:4 row_mask:0xf bank_mask:0xf
    v_add_f32_dpp v33, v33, v33 row_ror:4 row_mask:0xf bank_mask:0xf
    v_add_f32_dpp v34, v34, v34 row_ror:4 row_mask:0xf bank_mask:0xf
    v_add_f32_dpp v35, v35, v35 row_ror:4 row_mask:0xf bank_mask:0xf
    v_add_f32_dpp v32, v32, v32 row_ror:8 row_mask:0xf bank_mask:0xf
    v_add_f32_dpp v33, v33, v33 row_ror:8 row_mask:0xf bank_mask:0xf
    v_add_f32_dpp v34, v34, v34 row_ror:8 row_mask:0xf bank_mask:0xf
    v_add_f32_dpp v35, v35, v35 row_ror:8 row_mask:0xf bank_mask:0xf
    s_mov_b32 exec_lo, 0x00030003
    s_mov_b32 exec_hi, 0x00030003
    ds_write_b128 v30, v[32:35] offset:3328
    s_mov_b64 exec, -1
    s_waitcnt vmcnt(10) lgkmcnt(0)
    s_barrier
    s_add_u32 s96, s95, 9
    s_and_b32 s96, s96, 15
    s_lshl_b32 s97, s96, 14
    s_add_u32 s97, s97, s84
    s_add_u32 m0, s86, 147456
    s_nop 0
    buffer_load_dwordx4 v253, s[20:23], s97 offen offset:0 sc1 lds
    buffer_load_dwordx4 v253, s[20:23], s97 offen offset:1024 sc1 lds
    v_and_b32 v30, 1, v252
    v_bfe_u32 v31, v252, 1, 3
    v_lshl_add_u32 v30, v30, 3, v31
    v_lshlrev_b32 v30, 2, v30
    v_add_u32 v30, 3328, v30
    ds_read2_b32 v[32:33], v30 offset0:0 offset1:16
    ds_read2_b32 v[34:35], v30 offset0:32 offset1:48
    ds_read2_b32 v[36:37], v30 offset0:64 offset1:80
    ds_read2_b32 v[38:39], v30 offset0:96 offset1:112
    v_lshrrev_b32 v30, 2, v252
    buffer_load_dwordx4 v253, s[20:23], s97 offen offset:2048 sc1 lds
    v_mul_u32_u24 v30, 14336, v30
    v_and_b32 v31, 3, v252
    v_lshl_add_u32 v30, v31, 4, v30
    v_and_b32 v31, 1, v252
    v_cmp_eq_u32 vcc, 1, v31
    s_mul_i32 s32, s28, 229376
    s_lshl_b32 s33, s29, 6
    s_add_u32 s32, s32, s33
    s_add_u32 s32, s32, s79
    s_add_u32 s32, s32, 0xc80000
    buffer_load_dwordx4 v253, s[20:23], s97 offen offset:3072 sc1 lds
    s_waitcnt lgkmcnt(0)
    v_pk_add_f32 v[32:33], v[32:33], v[34:35]
    v_pk_add_f32 v[36:37], v[36:37], v[38:39]
    v_pk_add_f32 v[32:33], v[32:33], v[36:37]
    v_mul_f32 v34, 0xbfb8aa3b, v32
    v_exp_f32 v34, v34
    v_mul_f32 v32, v32, v33
    v_add_f32 v34, 1.0, v34
    v_rcp_f32 v34, v34
    s_add_u32 s96, s95, 9
    s_and_b32 s96, s96, 15
    s_mul_i32 s96, s96, 393216
    s_add_u32 s96, s96, s85
    s_add_u32 m0, s87, 40960
    s_nop 0
    buffer_load_dwordx4 v8, s[16:19], s96 offen offset:0 lds
    v_mul_f32 v32, v32, v34
    s_nop 1
    v_mov_b32_dpp v33, v32 quad_perm:[2,3,2,3] row_mask:0xf bank_mask:0xf
    v_cvt_pk_bf16_f32 v32, v32, v33
    ds_swizzle_b32 v36, v32 offset:0x1
    ds_swizzle_b32 v37, v32 offset:0x81
    ds_swizzle_b32 v38, v32 offset:0x101
    ds_swizzle_b32 v39, v32 offset:0x181
    s_waitcnt lgkmcnt(0)
    v_dot2_f32_bf16 v40, v215, v36, 0
    v_dot2_f32_bf16 v41, v224, v36, 0
    buffer_load_dwordx4 v9, s[16:19], s96 offen offset:1024 lds
    v_dot2_f32_bf16 v42, v220, v36, 0
    v_dot2_f32_bf16 v43, v225, v36, 0
    v_dot2_f32_bf16 v44, v221, v36, 0
    v_dot2_f32_bf16 v45, v226, v36, 0
    v_dot2_f32_bf16 v46, v222, v36, 0
    v_dot2_f32_bf16 v47, v227, v36, 0
    v_dot2_f32_bf16 v40, v223, v37, v40
    v_dot2_f32_bf16 v41, v232, v37, v41
    v_dot2_f32_bf16 v42, v228, v37, v42
    v_dot2_f32_bf16 v43, v233, v37, v43
    buffer_load_dwordx4 v10, s[16:19], s96 offen offset:2048 lds
    v_dot2_f32_bf16 v44, v229, v37, v44
    v_dot2_f32_bf16 v45, v234, v37, v45
    v_dot2_f32_bf16 v46, v230, v37, v46
    v_dot2_f32_bf16 v47, v235, v37, v47
    v_dot2_f32_bf16 v40, v231, v38, v40
    v_dot2_f32_bf16 v41, v240, v38, v41
    v_dot2_f32_bf16 v42, v236, v38, v42
    v_dot2_f32_bf16 v43, v241, v38, v43
    v_dot2_f32_bf16 v44, v237, v38, v44
    buffer_load_dwordx4 v11, s[16:19], s96 offen offset:3072 lds
    v_dot2_f32_bf16 v45, v242, v38, v45
    v_dot2_f32_bf16 v46, v238, v38, v46
    v_dot2_f32_bf16 v47, v243, v38, v47
    v_dot2_f32_bf16 v40, v239, v39, v40
    v_dot2_f32_bf16 v41, v248, v39, v41
    v_dot2_f32_bf16 v42, v244, v39, v42
    v_dot2_f32_bf16 v43, v249, v39, v43
    v_dot2_f32_bf16 v44, v245, v39, v44
    v_dot2_f32_bf16 v45, v250, v39, v45
    v_dot2_f32_bf16 v46, v246, v39, v46
    s_add_u32 m0, s87, 45056
    s_nop 0
    buffer_load_dwordx4 v12, s[16:19], s96 offen offset:0 lds
    v_dot2_f32_bf16 v47, v251, v39, v47
    v_add_f32_dpp v40, v40, v40 quad_perm:[1,0,3,2] row_mask:0xf bank_mask:0xf
    v_add_f32_dpp v41, v41, v41 quad_perm:[1,0,3,2] row_mask:0xf bank_mask:0xf
    v_add_f32_dpp v42, v42, v42 quad_perm:[1,0,3,2] row_mask:0xf bank_mask:0xf
    v_add_f32_dpp v43, v43, v43 quad_perm:[1,0,3,2] row_mask:0xf bank_mask:0xf
    v_add_f32_dpp v44, v44, v44 quad_perm:[1,0,3,2] row_mask:0xf bank_mask:0xf
    v_add_f32_dpp v45, v45, v45 quad_perm:[1,0,3,2] row_mask:0xf bank_mask:0xf
    v_add_f32_dpp v46, v46, v46 quad_perm:[1,0,3,2] row_mask:0xf bank_mask:0xf
    v_add_f32_dpp v47, v47, v47 quad_perm:[1,0,3,2] row_mask:0xf bank_mask:0xf
    v_cndmask_b32 v40, v40, v44, vcc
    buffer_load_dwordx4 v13, s[16:19], s96 offen offset:1024 lds
    v_cndmask_b32 v41, v41, v45, vcc
    v_cndmask_b32 v42, v42, v46, vcc
    v_cndmask_b32 v43, v43, v47, vcc
    s_cmp_lt_u32 s29, 224
    s_cselect_b64 exec, -1, 0
    buffer_store_dwordx4 v[40:43], v30, s[20:23], s32 offen sc1
    s_mov_b64 exec, -1
    s_waitcnt vmcnt(10) lgkmcnt(0)
    s_barrier
    s_add_u32 s96, s94, 10
    s_and_b32 s96, s96, 15
    s_lshl_b32 s97, s96, 14
    s_add_u32 s97, s97, s84
    s_add_u32 m0, s86, 131072
    s_nop 0
    buffer_load_dwordx4 v253, s[20:23], s97 offen offset:0 sc1 lds
    buffer_load_dwordx4 v253, s[20:23], s97 offen offset:1024 sc1 lds
    buffer_load_dwordx4 v253, s[20:23], s97 offen offset:2048 sc1 lds
    buffer_load_dwordx4 v253, s[20:23], s97 offen offset:3072 sc1 lds
    s_add_u32 s96, s94, 10
    s_and_b32 s96, s96, 15
    s_mul_i32 s96, s96, 393216
    s_add_u32 s96, s96, s85
    s_add_u32 m0, s87, 65536
    s_nop 0
    buffer_load_dwordx4 v8, s[16:19], s96 offen offset:0 lds
    buffer_load_dwordx4 v9, s[16:19], s96 offen offset:1024 lds
    buffer_load_dwordx4 v10, s[16:19], s96 offen offset:2048 lds
    buffer_load_dwordx4 v11, s[16:19], s96 offen offset:3072 lds
    s_add_u32 m0, s87, 69632
    s_nop 0
    buffer_load_dwordx4 v12, s[16:19], s96 offen offset:0 lds
    buffer_load_dwordx4 v13, s[16:19], s96 offen offset:1024 lds
    s_waitcnt vmcnt(10) lgkmcnt(0)
    s_barrier
    s_cmp_lt_u32 s29, 224
    s_cbranch_scc1 sk_88
    s_cmp_ge_u32 s28, 2
    s_cbranch_scc1 sk_88
    s_mul_i32 s32, s89, 14336
    s_add_u32 s32, s32, s79
    s_add_u32 s32, s32, 0xc80000
    buffer_load_dwordx4 v[32:35], v253, s[20:23], s32 offen offset:0 sc1
    buffer_load_dwordx4 v[36:39], v253, s[20:23], s32 offen offset:1024 sc1
    buffer_load_dwordx4 v[40:43], v253, s[20:23], s32 offen offset:2048 sc1
    buffer_load_dwordx4 v[44:47], v253, s[20:23], s32 offen offset:3072 sc1
    s_add_u32 s32, s32, 4096
    buffer_load_dwordx4 v[48:51], v253, s[20:23], s32 offen offset:0 sc1
    buffer_load_dwordx4 v[52:55], v253, s[20:23], s32 offen offset:1024 sc1
    buffer_load_dwordx4 v[56:59], v253, s[20:23], s32 offen offset:2048 sc1
    buffer_load_dwordx4 v[60:63], v253, s[20:23], s32 offen offset:3072 sc1
    s_add_u32 s32, s32, 4096
    buffer_load_dwordx4 v[64:67], v253, s[20:23], s32 offen offset:0 sc1
    buffer_load_dwordx4 v[68:71], v253, s[20:23], s32 offen offset:1024 sc1
    buffer_load_dwordx4 v[72:75], v253, s[20:23], s32 offen offset:2048 sc1
    buffer_load_dwordx4 v[76:79], v253, s[20:23], s32 offen offset:3072 sc1
    s_add_u32 s32, s32, 4096
    buffer_load_dwordx4 v[80:83], v253, s[20:23], s32 offen offset:0 sc1
    buffer_load_dwordx4 v[84:87], v253, s[20:23], s32 offen offset:1024 sc1
sk_88:
    s_add_u32 s96, s95, 11
    s_and_b32 s96, s96, 15
    s_lshl_b32 s97, s96, 14
    s_add_u32 s97, s97, s84
    s_add_u32 m0, s86, 114688
    s_nop 0
    buffer_load_dwordx4 v253, s[20:23], s97 offen offset:0 sc1 lds
    buffer_load_dwordx4 v253, s[20:23], s97 offen offset:1024 sc1 lds
    buffer_load_dwordx4 v253, s[20:23], s97 offen offset:2048 sc1 lds
    buffer_load_dwordx4 v253, s[20:23], s97 offen offset:3072 sc1 lds
    s_add_u32 s96, s95, 11
    s_and_b32 s96, s96, 15
    s_mul_i32 s96, s96, 393216
    s_add_u32 s96, s96, s85
    s_add_u32 m0, s87, 90112
    s_nop 0
    buffer_load_dwordx4 v8, s[16:19], s96 offen offset:0 lds
    buffer_load_dwordx4 v9, s[16:19], s96 offen offset:1024 lds
    buffer_load_dwordx4 v10, s[16:19], s96 offen offset:2048 lds
    buffer_load_dwordx4 v11, s[16:19], s96 offen offset:3072 lds
    s_add_u32 m0, s87, 94208
    s_nop 0
    buffer_load_dwordx4 v12, s[16:19], s96 offen offset:0 lds
    buffer_load_dwordx4 v13, s[16:19], s96 offen offset:1024 lds
    s_waitcnt vmcnt(10) lgkmcnt(0)
    s_barrier
    s_add_u32 s96, s94, 12
    s_and_b32 s96, s96, 15
    s_lshl_b32 s97, s96, 14
    s_add_u32 s97, s97, s84
    s_add_u32 m0, s86, 147456
    s_nop 0
    buffer_load_dwordx4 v253, s[20:23], s97 offen offset:0 sc1 lds
    buffer_load_dwordx4 v253, s[20:23], s97 offen offset:1024 sc1 lds
    buffer_load_dwordx4 v253, s[20:23], s97 offen offset:2048 sc1 lds
    buffer_load_dwordx4 v253, s[20:23], s97 offen offset:3072 sc1 lds
    s_add_u32 s96, s94, 12
    s_and_b32 s96, s96, 15
    s_mul_i32 s96, s96, 393216
    s_add_u32 s96, s96, s85
    s_add_u32 m0, s87, 40960
    s_nop 0
    buffer_load_dwordx4 v8, s[16:19], s96 offen offset:0 lds
    buffer_load_dwordx4 v9, s[16:19], s96 offen offset:1024 lds
    buffer_load_dwordx4 v10, s[16:19], s96 offen offset:2048 lds
    buffer_load_dwordx4 v11, s[16:19], s96 offen offset:3072 lds
    s_add_u32 m0, s87, 45056
    s_nop 0
    buffer_load_dwordx4 v12, s[16:19], s96 offen offset:0 lds
    buffer_load_dwordx4 v13, s[16:19], s96 offen offset:1024 lds
    s_cmp_lt_u32 s29, 224
    s_cbranch_scc1 sk_89
    s_cmp_ge_u32 s28, 2
    s_cbranch_scc1 sk_89
    s_mov_b32 s78, s27
    s_waitcnt vmcnt(20)
    s_branch pc_91
pl_90:
    s_mul_i32 s32, s89, 14336
    s_add_u32 s32, s32, s79
    s_add_u32 s32, s32, 0xc80000
    buffer_load_dwordx4 v[32:35], v253, s[20:23], s32 offen offset:0 sc1
    buffer_load_dwordx4 v[36:39], v253, s[20:23], s32 offen offset:1024 sc1
    buffer_load_dwordx4 v[40:43], v253, s[20:23], s32 offen offset:2048 sc1
    buffer_load_dwordx4 v[44:47], v253, s[20:23], s32 offen offset:3072 sc1
    s_add_u32 s32, s32, 4096
    buffer_load_dwordx4 v[48:51], v253, s[20:23], s32 offen offset:0 sc1
    buffer_load_dwordx4 v[52:55], v253, s[20:23], s32 offen offset:1024 sc1
    buffer_load_dwordx4 v[56:59], v253, s[20:23], s32 offen offset:2048 sc1
    buffer_load_dwordx4 v[60:63], v253, s[20:23], s32 offen offset:3072 sc1
    s_add_u32 s32, s32, 4096
    buffer_load_dwordx4 v[64:67], v253, s[20:23], s32 offen offset:0 sc1
    buffer_load_dwordx4 v[68:71], v253, s[20:23], s32 offen offset:1024 sc1
    buffer_load_dwordx4 v[72:75], v253, s[20:23], s32 offen offset:2048 sc1
    buffer_load_dwordx4 v[76:79], v253, s[20:23], s32 offen offset:3072 sc1
    s_add_u32 s32, s32, 4096
    buffer_load_dwordx4 v[80:83], v253, s[20:23], s32 offen offset:0 sc1
    buffer_load_dwordx4 v[84:87], v253, s[20:23], s32 offen offset:1024 sc1
    s_waitcnt vmcnt(0)
pc_91:
    v_max3_u32 v30, v32, v33, v34
    v_max3_u32 v30, v30, v35, v36
    v_max3_u32 v30, v30, v37, v38
    v_max3_u32 v30, v30, v39, v40
    v_max3_u32 v30, v30, v41, v42
    v_max3_u32 v30, v30, v43, v44
    v_max3_u32 v30, v30, v45, v46
    v_max3_u32 v30, v30, v47, v48
    v_max3_u32 v30, v30, v49, v50
    v_max3_u32 v30, v30, v51, v52
    v_max3_u32 v30, v30, v53, v54
    v_max3_u32 v30, v30, v55, v56
    v_max3_u32 v30, v30, v57, v58
    v_max3_u32 v30, v30, v59, v60
    v_max3_u32 v30, v30, v61, v62
    v_max3_u32 v30, v30, v63, v64
    v_max3_u32 v30, v30, v65, v66
    v_max3_u32 v30, v30, v67, v68
    v_max3_u32 v30, v30, v69, v70
    v_max3_u32 v30, v30, v71, v72
    v_max3_u32 v30, v30, v73, v74
    v_max3_u32 v30, v30, v75, v76
    v_max3_u32 v30, v30, v77, v78
    v_max3_u32 v30, v30, v79, v80
    v_max3_u32 v30, v30, v81, v82
    v_max3_u32 v30, v30, v83, v84
    v_max3_u32 v30, v30, v85, v86
    v_max_u32 v30, v30, v87
    v_cmp_eq_u32 vcc, -1, v30
    s_cbranch_vccz pd_92
    s_sub_u32 s78, s78, 1
    s_cmp_lg_u32 s78, 0
    s_cbranch_scc1 pl_90
    s_mov_b32 s27, 1
pd_92:
    v_pk_add_f32 v[32:33], v[32:33], v[36:37]
    v_pk_add_f32 v[34:35], v[34:35], v[38:39]
    v_pk_add_f32 v[32:33], v[32:33], v[40:41]
    v_pk_add_f32 v[34:35], v[34:35], v[42:43]
    v_pk_add_f32 v[32:33], v[32:33], v[44:45]
    v_pk_add_f32 v[34:35], v[34:35], v[46:47]
    v_pk_add_f32 v[32:33], v[32:33], v[48:49]
    v_pk_add_f32 v[34:35], v[34:35], v[50:51]
    v_pk_add_f32 v[32:33], v[32:33], v[52:53]
    v_pk_add_f32 v[34:35], v[34:35], v[54:55]
    v_pk_add_f32 v[32:33], v[32:33], v[56:57]
    v_pk_add_f32 v[34:35], v[34:35], v[58:59]
    v_pk_add_f32 v[32:33], v[32:33], v[60:61]
    v_pk_add_f32 v[34:35], v[34:35], v[62:63]
    v_pk_add_f32 v[32:33], v[32:33], v[64:65]
    v_pk_add_f32 v[34:35], v[34:35], v[66:67]
    v_pk_add_f32 v[32:33], v[32:33], v[68:69]
    v_pk_add_f32 v[34:35], v[34:35], v[70:71]
    v_pk_add_f32 v[32:33], v[32:33], v[72:73]
    v_pk_add_f32 v[34:35], v[34:35], v[74:75]
    v_pk_add_f32 v[32:33], v[32:33], v[76:77]
    v_pk_add_f32 v[34:35], v[34:35], v[78:79]
    v_pk_add_f32 v[32:33], v[32:33], v[80:81]
    v_pk_add_f32 v[34:35], v[34:35], v[82:83]
    v_pk_add_f32 v[32:33], v[32:33], v[84:85]
    v_pk_add_f32 v[34:35], v[34:35], v[86:87]
    s_nop 0
    v_add_f32_dpp v32, v32, v32 row_ror:4 row_mask:0xf bank_mask:0xf
    v_add_f32_dpp v33, v33, v33 row_ror:4 row_mask:0xf bank_mask:0xf
    v_add_f32_dpp v34, v34, v34 row_ror:4 row_mask:0xf bank_mask:0xf
    v_add_f32_dpp v35, v35, v35 row_ror:4 row_mask:0xf bank_mask:0xf
    v_add_f32_dpp v32, v32, v32 row_ror:8 row_mask:0xf bank_mask:0xf
    v_add_f32_dpp v33, v33, v33 row_ror:8 row_mask:0xf bank_mask:0xf
    v_add_f32_dpp v34, v34, v34 row_ror:8 row_mask:0xf bank_mask:0xf
    v_add_f32_dpp v35, v35, v35 row_ror:8 row_mask:0xf bank_mask:0xf
    v_mov_b32 v36, v32
    v_mov_b32 v37, v33
    v_mov_b32 v38, v34
    v_mov_b32 v39, v35
    v_permlane16_swap_b32 v32, v36
    v_permlane16_swap_b32 v33, v37
    v_permlane16_swap_b32 v34, v38
    v_permlane16_swap_b32 v35, v39
    v_add_f32 v32, v32, v36
    v_add_f32 v33, v33, v37
    v_add_f32 v34, v34, v38
    v_add_f32 v35, v35, v39
    v_mov_b32 v36, v32
    v_mov_b32 v37, v33
    v_mov_b32 v38, v34
    v_mov_b32 v39, v35
    v_permlane32_swap_b32 v32, v36
    v_permlane32_swap_b32 v33, v37
    v_permlane32_swap_b32 v34, v38
    v_permlane32_swap_b32 v35, v39
    v_add_f32 v32, v32, v36
    v_add_f32 v33, v33, v37
    v_add_f32 v34, v34, v38
    v_add_f32 v35, v35, v39
    v_fma_f32 v32, v32, v96, v92
    v_fma_f32 v33, v33, v96, v93
    v_fma_f32 v34, v34, v96, v94
    v_fma_f32 v35, v35, v96, v95
    v_cvt_pk_bf16_f32 v32, v32, v33
    v_cvt_pk_bf16_f32 v33, v34, v35
    s_lshl_b32 s32, s89, 5
    s_add_u32 s32, s32, 0xdc4000
    v_and_b32 v30, 1, v252
    v_bfe_u32 v31, v252, 1, 1
    v_lshlrev_b32 v30, 4, v30
    v_lshl_add_u32 v30, v31, 3, v30
    s_mov_b64 exec, 15
    buffer_store_dwordx2 v[32:33], v30, s[20:23], s32 offen sc1
    s_mov_b64 exec, -1
sk_89:
    s_waitcnt vmcnt(10) lgkmcnt(0)
    s_barrier
    s_add_u32 s96, s95, 13
    s_and_b32 s96, s96, 15
    s_lshl_b32 s97, s96, 14
    s_add_u32 s97, s97, s84
    s_add_u32 m0, s86, 131072
    s_nop 0
    buffer_load_dwordx4 v253, s[20:23], s97 offen offset:0 sc1 lds
    buffer_load_dwordx4 v253, s[20:23], s97 offen offset:1024 sc1 lds
    buffer_load_dwordx4 v253, s[20:23], s97 offen offset:2048 sc1 lds
    buffer_load_dwordx4 v253, s[20:23], s97 offen offset:3072 sc1 lds
    s_add_u32 s96, s95, 13
    s_and_b32 s96, s96, 15
    s_mul_i32 s96, s96, 393216
    s_add_u32 s96, s96, s85
    s_add_u32 m0, s87, 65536
    s_nop 0
    buffer_load_dwordx4 v8, s[16:19], s96 offen offset:0 lds
    buffer_load_dwordx4 v9, s[16:19], s96 offen offset:1024 lds
    buffer_load_dwordx4 v10, s[16:19], s96 offen offset:2048 lds
    buffer_load_dwordx4 v11, s[16:19], s96 offen offset:3072 lds
    s_add_u32 m0, s87, 69632
    s_nop 0
    buffer_load_dwordx4 v12, s[16:19], s96 offen offset:0 lds
    buffer_load_dwordx4 v13, s[16:19], s96 offen offset:1024 lds
    s_waitcnt vmcnt(10) lgkmcnt(0)
    s_barrier
    s_add_u32 s35, s94, 12
    s_and_b32 s35, s35, 15
    s_lshl_b32 s35, s35, 7
    s_add_u32 s35, s35, 0xdc4000
    s_add_u32 s96, s94, 14
    s_and_b32 s96, s96, 15
    s_lshl_b32 s97, s96, 14
    s_add_u32 s97, s97, s84
    s_add_u32 m0, s86, 114688
    s_nop 0
    buffer_load_dwordx4 v253, s[20:23], s97 offen offset:0 sc1 lds
    v_and_b32 v19, 48, v252
    buffer_load_dwordx4 v[132:135], v19, s[20:23], s35 offen offset:0 sc1
    buffer_load_dwordx4 v[136:139], v19, s[20:23], s35 offen offset:64 sc1
    buffer_load_dwordx4 v253, s[20:23], s97 offen offset:1024 sc1 lds
    s_min_u32 s30, s28, 2
    s_lshl_b32 s30, s30, 13
    s_add_u32 s30, s30, 40960
    buffer_load_dwordx4 v253, s[20:23], s97 offen offset:2048 sc1 lds
    v_lshrrev_b32 v20, 2, v252
    v_bfe_u32 v21, v20, 1, 2
    v_lshlrev_b32 v20, 7, v20
    v_lshl_add_u32 v20, v21, 5, v20
    buffer_load_dwordx4 v253, s[20:23], s97 offen offset:3072 sc1 lds
    v_and_b32 v21, 3, v252
    v_lshl_add_u32 v20, v21, 3, v20
    v_add_u32 v144, s30, v20
    s_add_u32 s96, s94, 14
    s_and_b32 s96, s96, 15
    s_mul_i32 s96, s96, 393216
    s_add_u32 s96, s96, s85
    s_add_u32 m0, s87, 90112
    s_nop 0
    buffer_load_dwordx4 v8, s[16:19], s96 offen offset:0 lds
    v_xor_b32 v145, 32, v144
    v_xor_b32 v146, 64, v144
    v_xor_b32 v147, 96, v144
    buffer_load_dwordx4 v9, s[16:19], s96 offen offset:1024 lds
    ds_read_b64_tr_b16 v[100:101], v144 offset:0
    ds_read_b64_tr_b16 v[102:103], v144 offset:2048
    ds_read_b64_tr_b16 v[104:105], v144 offset:4096
    buffer_load_dwordx4 v10, s[16:19], s96 offen offset:2048 lds
    ds_read_b64_tr_b16 v[106:107], v144 offset:6144
    ds_read_b64_tr_b16 v[108:109], v145 offset:0
    ds_read_b64_tr_b16 v[110:111], v145 offset:2048
    ds_read_b64_tr_b16 v[112:113], v145 offset:4096
    buffer_load_dwordx4 v11, s[16:19], s96 offen offset:3072 lds
    ds_read_b64_tr_b16 v[114:115], v145 offset:6144
    ds_read_b64_tr_b16 v[116:117], v146 offset:0
    ds_read_b64_tr_b16 v[118:119], v146 offset:2048
    s_add_u32 m0, s87, 94208
    s_nop 0
    buffer_load_dwordx4 v12, s[16:19], s96 offen offset:0 lds
    ds_read_b64_tr_b16 v[120:121], v146 offset:4096
    ds_read_b64_tr_b16 v[122:123], v146 offset:6144
    ds_read_b64_tr_b16 v[124:125], v147 offset:0
    buffer_load_dwordx4 v13, s[16:19], s96 offen offset:1024 lds
    ds_read_b64_tr_b16 v[126:127], v147 offset:2048
    ds_read_b64_tr_b16 v[128:129], v147 offset:4096
    ds_read_b64_tr_b16 v[130:131], v147 offset:6144
    s_waitcnt vmcnt(12) lgkmcnt(0)
    s_barrier
    s_add_u32 s96, s95, 15
    s_and_b32 s96, s96, 15
    s_lshl_b32 s97, s96, 14
    s_add_u32 s97, s97, s84
    s_add_u32 m0, s86, 147456
    s_nop 0
    buffer_load_dwordx4 v253, s[20:23], s97 offen offset:0 sc1 lds
    buffer_load_dwordx4 v253, s[20:23], s97 offen offset:1024 sc1 lds
    s_mov_b32 s78, s27
    s_waitcnt vmcnt(11)
    s_branch pc_94
pl_93:
    buffer_load_dwordx4 v[132:135], v19, s[20:23], s35 offen offset:0 sc1
    buffer_load_dwordx4 v[136:139], v19, s[20:23], s35 offen offset:64 sc1
    s_waitcnt vmcnt(0)
pc_94:
    v_max3_u32 v30, v132, v133, v134
    v_max3_u32 v30, v30, v135, v136
    v_max3_u32 v30, v30, v137, v138
    v_max_u32 v30, v30, v139
    v_cmp_eq_u32 vcc, -1, v30
    s_cbranch_vccz pd_95
    s_sub_u32 s78, s78, 1
    s_cmp_lg_u32 s78, 0
    s_cbranch_scc1 pl_93
    s_mov_b32 s27, 1
pd_95:
    buffer_load_dwordx4 v253, s[20:23], s97 offen offset:2048 sc1 lds
    buffer_load_dwordx4 v253, s[20:23], s97 offen offset:3072 sc1 lds
    v_mov_b32 v140, 0
    v_mov_b32 v141, 0
    v_mov_b32 v142, 0
    s_add_u32 s96, s95, 15
    s_and_b32 s96, s96, 15
    s_mul_i32 s96, s96, 393216
    s_add_u32 s96, s96, s85
    s_add_u32 m0, s87, 40960
    s_nop 0
    buffer_load_dwordx4 v8, s[16:19], s96 offen offset:0 lds
    v_mov_b32 v143, 0
    v_dot2c_f32_bf16 v140, v132, v100
    v_dot2c_f32_bf16 v141, v132, v108
    v_dot2c_f32_bf16 v142, v132, v116
    v_dot2c_f32_bf16 v143, v132, v124
    v_dot2c_f32_bf16 v140, v133, v101
    v_dot2c_f32_bf16 v141, v133, v109
    v_dot2c_f32_bf16 v142, v133, v117
    buffer_load_dwordx4 v9, s[16:19], s96 offen offset:1024 lds
    v_dot2c_f32_bf16 v143, v133, v125
    v_dot2c_f32_bf16 v140, v134, v102
    v_dot2c_f32_bf16 v141, v134, v110
    v_dot2c_f32_bf16 v142, v134, v118
    v_dot2c_f32_bf16 v143, v134, v126
    v_dot2c_f32_bf16 v140, v135, v103
    v_dot2c_f32_bf16 v141, v135, v111
    v_dot2c_f32_bf16 v142, v135, v119
    buffer_load_dwordx4 v10, s[16:19], s96 offen offset:2048 lds
    v_dot2c_f32_bf16 v143, v135, v127
    v_dot2c_f32_bf16 v140, v136, v104
    v_dot2c_f32_bf16 v141, v136, v112
    v_dot2c_f32_bf16 v142, v136, v120
    v_dot2c_f32_bf16 v143, v136, v128
    v_dot2c_f32_bf16 v140, v137, v105
    v_dot2c_f32_bf16 v141, v137, v113
    v_dot2c_f32_bf16 v142, v137, v121
    buffer_load_dwordx4 v11, s[16:19], s96 offen offset:3072 lds
    v_dot2c_f32_bf16 v143, v137, v129
    v_dot2c_f32_bf16 v140, v138, v106
    v_dot2c_f32_bf16 v141, v138, v114
    v_dot2c_f32_bf16 v142, v138, v122
    v_dot2c_f32_bf16 v143, v138, v130
    v_dot2c_f32_bf16 v140, v139, v107
    v_dot2c_f32_bf16 v141, v139, v115
    v_dot2c_f32_bf16 v142, v139, v123
    s_add_u32 m0, s87, 45056
    s_nop 0
    buffer_load_dwordx4 v12, s[16:19], s96 offen offset:0 lds
    v_dot2c_f32_bf16 v143, v139, v131
    s_min_u32 s32, s28, 2
    s_lshl_b32 s32, s32, 12
    s_lshl_b32 s33, s25, 14
    s_add_u32 s32, s32, s33
    s_add_u32 s32, s32, 0x1d80000
    s_lshl_b32 s33, s24, 8
    s_add_u32 s32, s32, s33
    buffer_load_dwordx4 v13, s[16:19], s96 offen offset:1024 lds
    v_lshlrev_b32 v20, 2, v252
    v_permlane32_swap_b32 v140, v142
    v_permlane32_swap_b32 v141, v143
    v_add_f32 v140, v140, v142
    v_add_f32 v141, v141, v143
    s_nop 1
    v_permlane16_swap_b32 v140, v141
    v_add_f32 v140, v140, v141
    buffer_store_dword v140, v20, s[20:23], s32 offen sc1
    s_waitcnt vmcnt(11) lgkmcnt(0)
    s_barrier
    s_waitcnt vmcnt(1) lgkmcnt(0)
    s_barrier
    s_cmp_eq_u32 s100, 0
    s_cbranch_scc1 sk_96
    s_min_u32 s32, s28, 2
    s_lshl_b32 s32, s32, 12
    s_lshl_b32 s33, s25, 14
    s_add_u32 s32, s32, s33
    s_add_u32 s32, s32, 0x1d80000
    buffer_load_dwordx4 v[32:35], v253, s[20:23], s32 offen offset:0 sc1
    buffer_load_dwordx4 v[36:39], v253, s[20:23], s32 offen offset:1024 sc1
    buffer_load_dwordx4 v[40:43], v253, s[20:23], s32 offen offset:2048 sc1
    buffer_load_dwordx4 v[44:47], v253, s[20:23], s32 offen offset:3072 sc1
    s_mov_b32 s32, 0xdc4000
    buffer_load_dwordx4 v[48:51], v253, s[20:23], s32 offen offset:0 sc1
    buffer_load_dwordx4 v[52:55], v253, s[20:23], s32 offen offset:1024 sc1
    v_and_b32 v20, 7, v252
    v_lshrrev_b32 v21, 4, v252
    v_lshl_add_u32 v21, v20, 2, v21
    s_and_b32 s34, s73, 31
    s_and_b32 s32, s34, 7
    s_and_b32 s33, s34, 8
    s_lshl_b32 s33, s33, 1
    s_add_u32 s32, s32, s33
    s_lshr_b32 s33, s34, 4
    s_lshl_b32 s33, s33, 3
    s_add_u32 s32, s32, s33
    s_cmp_eq_u32 s28, 1
    s_cselect_b32 s34, s32, s34
    v_mov_b32 v20, s34
    s_cmp_ge_u32 s28, 2
    s_cselect_b64 vcc, -1, 0
    s_cselect_b32 s32, 2048, 0
    v_cndmask_b32 v30, v20, v21, vcc
    v_cndmask_b32 v31, v21, v20, vcc
    v_lshlrev_b32 v0, 4, v30
    v_bfe_u32 v20, v31, 2, 2
    v_lshl_add_u32 v0, v20, 9, v0
    v_lshrrev_b32 v20, 4, v31
    v_lshl_add_u32 v0, v20, 3, v0
    v_and_b32 v20, 3, v31
    v_lshl_add_u32 v0, v20, 1, v0
    s_lshl_b32 s33, s39, 12
    s_add_u32 s33, s33, s32
    s_add_u32 s33, s33, 65536
    s_lshl_b32 s34, s39, 11
    s_add_u32 s34, s34, 32768
    s_cmp_ge_u32 s39, 8
    s_cselect_b32 s38, 1, 0
    s_movk_i32 s32, 8192
    s_cmp_eq_u32 s28, 0
    s_cselect_b32 s33, s34, s33
    s_cselect_b32 s32, s32, 49152
    s_cselect_b32 s38, s38, 1
    s_cselect_b32 s37, 0x3e8293ee, 1.0
    v_bfe_u32 v20, v252, 3, 1
    v_mul_u32_u24 v20, s32, v20
    v_add3_u32 v0, v0, v20, s33
sk_96:
    s_waitcnt lgkmcnt(0)
    s_barrier
    s_cmp_eq_u32 s100, 0
    s_cbranch_scc1 sk_97
    s_mov_b32 s78, s27
    s_waitcnt vmcnt(0)
    s_branch pc_99
pl_98:
    s_min_u32 s32, s28, 2
    s_lshl_b32 s32, s32, 12
    s_lshl_b32 s33, s25, 14
    s_add_u32 s32, s32, s33
    s_add_u32 s32, s32, 0x1d80000
    buffer_load_dwordx4 v[32:35], v253, s[20:23], s32 offen offset:0 sc1
    buffer_load_dwordx4 v[36:39], v253, s[20:23], s32 offen offset:1024 sc1
    buffer_load_dwordx4 v[40:43], v253, s[20:23], s32 offen offset:2048 sc1
    buffer_load_dwordx4 v[44:47], v253, s[20:23], s32 offen offset:3072 sc1
    s_mov_b32 s32, 0xdc4000
    buffer_load_dwordx4 v[48:51], v253, s[20:23], s32 offen offset:0 sc1
    buffer_load_dwordx4 v[52:55], v253, s[20:23], s32 offen offset:1024 sc1
    s_waitcnt vmcnt(0)
pc_99:
    v_max3_u32 v30, v32, v33, v34
    v_max3_u32 v30, v30, v35, v36
    v_max3_u32 v30, v30, v37, v38
    v_max3_u32 v30, v30, v39, v40
    v_max3_u32 v30, v30, v41, v42
    v_max3_u32 v30, v30, v43, v44
    v_max3_u32 v30, v30, v45, v46
    v_max3_u32 v30, v30, v47, v48
    v_max3_u32 v30, v30, v49, v50
    v_max3_u32 v30, v30, v51, v52
    v_max3_u32 v30, v30, v53, v54
    v_max_u32 v30, v30, v55
    v_cmp_eq_u32 vcc, -1, v30
    s_cbranch_vccz pd_100
    s_sub_u32 s78, s78, 1
    s_cmp_lg_u32 s78, 0
    s_cbranch_scc1 pl_98
    s_mov_b32 s27, 1
pd_100:
    v_mov_b32 v28, 0
    v_mov_b32 v29, 0
    v_dot2c_f32_bf16 v28, 0x3f803f80, v48
    v_dot2c_f32_bf16 v29, v48, v48
    v_dot2c_f32_bf16 v28, 0x3f803f80, v49
    v_dot2c_f32_bf16 v29, v49, v49
    v_dot2c_f32_bf16 v28, 0x3f803f80, v50
    v_dot2c_f32_bf16 v29, v50, v50
    v_dot2c_f32_bf16 v28, 0x3f803f80, v51
    v_dot2c_f32_bf16 v29, v51, v51
    v_dot2c_f32_bf16 v28, 0x3f803f80, v52
    v_dot2c_f32_bf16 v29, v52, v52
    v_dot2c_f32_bf16 v28, 0x3f803f80, v53
    v_dot2c_f32_bf16 v29, v53, v53
    v_dot2c_f32_bf16 v28, 0x3f803f80, v54
    v_dot2c_f32_bf16 v29, v54, v54
    v_dot2c_f32_bf16 v28, 0x3f803f80, v55
    v_dot2c_f32_bf16 v29, v55, v55
    v_pk_add_f32 v[32:33], v[32:33], v[36:37]
    v_pk_add_f32 v[34:35], v[34:35], v[38:39]
    v_pk_add_f32 v[32:33], v[32:33], v[40:41]
    v_pk_add_f32 v[34:35], v[34:35], v[42:43]
    v_pk_add_f32 v[32:33], v[32:33], v[44:45]
    v_pk_add_f32 v[34:35], v[34:35], v[46:47]
    s_nop 1
    v_permlane32_swap_b32 v32, v34
    v_permlane32_swap_b32 v33, v35
    v_add_f32 v32, v32, v34
    v_add_f32 v33, v33, v35
    s_nop 1
    v_permlane16_swap_b32 v32, v33
    v_add_f32 v32, v32, v33
    v_add_f32_dpp v28, v28, v28 quad_perm:[1,0,3,2] row_mask:0xf bank_mask:0xf
    s_nop 1
    v_add_f32_dpp v28, v28, v28 quad_perm:[2,3,0,1] row_mask:0xf bank_mask:0xf
    s_nop 1
    v_add_f32_dpp v28, v28, v28 row_half_mirror row_mask:0xf bank_mask:0xf
    s_nop 1
    v_add_f32_dpp v28, v28, v28 row_mirror row_mask:0xf bank_mask:0xf
    v_mov_b32 v30, v28
    s_nop 1
    v_permlane16_swap_b32 v28, v30
    v_add_f32 v28, v28, v30
    v_mov_b32 v30, v28
    s_nop 1
    v_permlane32_swap_b32 v28, v30
    v_add_f32 v28, v28, v30
    v_add_f32_dpp v29, v29, v29 quad_perm:[1,0,3,2] row_mask:0xf bank_mask:0xf
    s_nop 1
    v_add_f32_dpp v29, v29, v29 quad_perm:[2,3,0,1] row_mask:0xf bank_mask:0xf
    s_nop 1
    v_add_f32_dpp v29, v29, v29 row_half_mirror row_mask:0xf bank_mask:0xf
    s_nop 1
    v_add_f32_dpp v29, v29, v29 row_mirror row_mask:0xf bank_mask:0xf
    v_mov_b32 v30, v29
    s_nop 1
    v_permlane16_swap_b32 v29, v30
    v_add_f32 v29, v29, v30
    v_mov_b32 v30, v29
    s_nop 1
    v_permlane32_swap_b32 v29, v30
    v_add_f32 v29, v29, v30
    v_mul_f32 v28, 0x3a800000, v28
    v_mul_f32 v29, 0x3a800000, v29
    v_fma_f32 v29, -v28, v28, v29
    v_max_f32 v29, 0, v29
    v_add_f32 v29, 0x3727c5ac, v29
    v_rsq_f32 v29, v29
    v_fma_f32 v32, -v28, v2, v32
    v_mul_f32 v29, s37, v29
    v_mul_f32 v32, v32, v29
    v_cvt_pk_bf16_f32 v1, v32, v32
sk_97:
    s_branch l_att
l_tail:
    v_mov_b32 v20, 0
    s_barrier
    ds_read_b128 v[16:19], v20 offset:3072
    s_waitcnt lgkmcnt(0)
    v_readlane_b32 s74, v16, 0
    v_readlane_b32 s73, v17, 0
    v_readlane_b32 s75, v18, 0
    v_readlane_b32 s76, v19, 0
    s_and_b32 s73, s73, 2047
    s_mov_b32 s78, s27
pl_101:
    s_lshr_b32 s33, s73, 5
    s_lshl_b32 s33, s33, 11
    s_add_u32 s33, s33, s79
    s_add_u32 s33, s33, 0xd60000
    buffer_load_dwordx4 v[24:27], v22, s[20:23], s33 offen sc1
    s_waitcnt vmcnt(0)
pc_102:
    v_max3_u32 v30, v24, v25, v26
    v_max_u32 v30, v30, v27
    v_cmp_eq_u32 vcc, -1, v30
    s_cbranch_vccz pd_103
    s_sub_u32 s78, s78, 1
    s_cmp_lg_u32 s78, 0
    s_cbranch_scc1 pl_101
    s_mov_b32 s27, 1
pd_103:
    s_cmp_ge_u32 s29, 224
    s_cbranch_scc1 l_tred
    v_mov_b32 v28, s76
    v_mul_f32 v29, s75, v28
    v_lshlrev_b32 v30, 16, v24
    v_and_b32 v31, 0xffff0000, v24
    v_fma_f32 v30, v30, v28, -v29
    v_fma_f32 v31, v31, v28, -v29
    v_cvt_pk_bf16_f32 v24, v30, v31
    v_lshlrev_b32 v30, 16, v25
    v_and_b32 v31, 0xffff0000, v25
    v_fma_f32 v30, v30, v28, -v29
    v_fma_f32 v31, v31, v28, -v29
    v_cvt_pk_bf16_f32 v25, v30, v31
    v_lshlrev_b32 v30, 16, v26
    v_and_b32 v31, 0xffff0000, v26
    v_fma_f32 v30, v30, v28, -v29
    v_fma_f32 v31, v31, v28, -v29
    v_cvt_pk_bf16_f32 v26, v30, v31
    v_lshlrev_b32 v30, 16, v27
    v_and_b32 v31, 0xffff0000, v27
    v_fma_f32 v30, v30, v28, -v29
    v_fma_f32 v31, v31, v28, -v29
    v_cvt_pk_bf16_f32 v27, v30, v31
    s_bitcmp0_b32 s29, 0
    s_cbranch_scc1 sk_104
    v_swap_b32 v24, v25
    v_swap_b32 v26, v27
sk_104:
    s_bitcmp0_b32 s29, 1
    s_cbranch_scc1 sk_105
    v_swap_b32 v24, v26
    v_swap_b32 v25, v27
sk_105:
    v_dot2_f32_bf16 v32, v155, v24, 0
    v_dot2_f32_bf16 v33, v160, v24, 0
    v_dot2_f32_bf16 v34, v156, v24, 0
    v_dot2_f32_bf16 v35, v161, v24, 0
    v_dot2_f32_bf16 v36, v157, v24, 0
    v_dot2_f32_bf16 v37, v162, v24, 0
    v_dot2_f32_bf16 v38, v158, v24, 0
    v_dot2_f32_bf16 v39, v163, v24, 0
    v_dot2_f32_bf16 v40, v183, v24, 0
    v_dot2_f32_bf16 v41, v192, v24, 0
    v_dot2_f32_bf16 v42, v188, v24, 0
    v_dot2_f32_bf16 v43, v193, v24, 0
    v_dot2_f32_bf16 v44, v189, v24, 0
    v_dot2_f32_bf16 v45, v194, v24, 0
    v_dot2_f32_bf16 v46, v190, v24, 0
    v_dot2_f32_bf16 v47, v195, v24, 0
    v_dot2_f32_bf16 v32, v159, v25, v32
    v_dot2_f32_bf16 v33, v168, v25, v33
    v_dot2_f32_bf16 v34, v164, v25, v34
    v_dot2_f32_bf16 v35, v169, v25, v35
    v_dot2_f32_bf16 v36, v165, v25, v36
    v_dot2_f32_bf16 v37, v170, v25, v37
    v_dot2_f32_bf16 v38, v166, v25, v38
    v_dot2_f32_bf16 v39, v171, v25, v39
    v_dot2_f32_bf16 v40, v191, v25, v40
    v_dot2_f32_bf16 v41, v200, v25, v41
    v_dot2_f32_bf16 v42, v196, v25, v42
    v_dot2_f32_bf16 v43, v201, v25, v43
    v_dot2_f32_bf16 v44, v197, v25, v44
    v_dot2_f32_bf16 v45, v202, v25, v45
    v_dot2_f32_bf16 v46, v198, v25, v46
    v_dot2_f32_bf16 v47, v203, v25, v47
    v_dot2_f32_bf16 v32, v167, v26, v32
    v_dot2_f32_bf16 v33, v176, v26, v33
    v_dot2_f32_bf16 v34, v172, v26, v34
    v_dot2_f32_bf16 v35, v177, v26, v35
    v_dot2_f32_bf16 v36, v173, v26, v36
    v_dot2_f32_bf16 v37, v178, v26, v37
    v_dot2_f32_bf16 v38, v174, v26, v38
    v_dot2_f32_bf16 v39, v179, v26, v39
    v_dot2_f32_bf16 v40, v199, v26, v40
    v_dot2_f32_bf16 v41, v208, v26, v41
    v_dot2_f32_bf16 v42, v204, v26, v42
    v_dot2_f32_bf16 v43, v209, v26, v43
    v_dot2_f32_bf16 v44, v205, v26, v44
    v_dot2_f32_bf16 v45, v210, v26, v45
    v_dot2_f32_bf16 v46, v206, v26, v46
    v_dot2_f32_bf16 v47, v211, v26, v47
    v_dot2_f32_bf16 v32, v175, v27, v32
    v_dot2_f32_bf16 v33, v184, v27, v33
    v_dot2_f32_bf16 v34, v180, v27, v34
    v_dot2_f32_bf16 v35, v185, v27, v35
    v_dot2_f32_bf16 v36, v181, v27, v36
    v_dot2_f32_bf16 v37, v186, v27, v37
    v_dot2_f32_bf16 v38, v182, v27, v38
    v_dot2_f32_bf16 v39, v187, v27, v39
    v_dot2_f32_bf16 v40, v207, v27, v40
    v_dot2_f32_bf16 v41, v216, v27, v41
    v_dot2_f32_bf16 v42, v212, v27, v42
    v_dot2_f32_bf16 v43, v217, v27, v43
    v_dot2_f32_bf16 v44, v213, v27, v44
    v_dot2_f32_bf16 v45, v218, v27, v45
    v_dot2_f32_bf16 v46, v214, v27, v46
    v_dot2_f32_bf16 v47, v219, v27, v47
    v_lshrrev_b32 v31, 5, v252
    v_lshlrev_b32 v30, 6, v31
    v_permlane32_swap_b32 v32, v40
    v_permlane32_swap_b32 v33, v41
    v_permlane32_swap_b32 v34, v42
    v_permlane32_swap_b32 v35, v43
    v_permlane32_swap_b32 v36, v44
    v_permlane32_swap_b32 v37, v45
    v_permlane32_swap_b32 v38, v46
    v_permlane32_swap_b32 v39, v47
    v_add_f32 v32, v32, v40
    v_add_f32 v33, v33, v41
    v_add_f32 v34, v34, v42
    v_add_f32 v35, v35, v43
    v_add_f32 v36, v36, v44
    v_add_f32 v37, v37, v45
    v_add_f32 v38, v38, v46
    v_add_f32 v39, v39, v47
    v_and_b32 v31, 1, v252
    v_lshl_add_u32 v30, v31, 5, v30
    v_permlane16_swap_b32 v32, v36
    v_permlane16_swap_b32 v33, v37
    v_permlane16_swap_b32 v34, v38
    v_permlane16_swap_b32 v35, v39
    v_add_f32 v32, v32, v36
    v_add_f32 v33, v33, v37
    v_add_f32 v34, v34, v38
    v_add_f32 v35, v35, v39
    v_and_b32 v31, 16, v252
    s_lshl_b32 s32, s28, 7
    v_add3_u32 v30, v31, v30, s32
    v_add_f32_dpp v32, v32, v32 quad_perm:[2,3,0,1] row_mask:0xf bank_mask:0xf
    v_add_f32_dpp v33, v33, v33 quad_perm:[2,3,0,1] row_mask:0xf bank_mask:0xf
    v_add_f32_dpp v34, v34, v34 quad_perm:[2,3,0,1] row_mask:0xf bank_mask:0xf
    v_add_f32_dpp v35, v35, v35 quad_perm:[2,3,0,1] row_mask:0xf bank_mask:0xf
    v_add_f32_dpp v32, v32, v32 row_ror:4 row_mask:0xf bank_mask:0xf
    v_add_f32_dpp v33, v33, v33 row_ror:4 row_mask:0xf bank_mask:0xf
    v_add_f32_dpp v34, v34, v34 row_ror:4 row_mask:0xf bank_mask:0xf
    v_add_f32_dpp v35, v35, v35 row_ror:4 row_mask:0xf bank_mask:0xf
    v_add_f32_dpp v32, v32, v32 row_ror:8 row_mask:0xf bank_mask:0xf
    v_add_f32_dpp v33, v33, v33 row_ror:8 row_mask:0xf bank_mask:0xf
    v_add_f32_dpp v34, v34, v34 row_ror:8 row_mask:0xf bank_mask:0xf
    v_add_f32_dpp v35, v35, v35 row_ror:8 row_mask:0xf bank_mask:0xf
    s_mov_b32 exec_lo, 0x00030003
    s_mov_b32 exec_hi, 0x00030003
    ds_write_b128 v30, v[32:35] offset:3328
    s_mov_b64 exec, -1
    s_waitcnt lgkmcnt(0)
    s_barrier
    v_and_b32 v30, 1, v252
    v_bfe_u32 v31, v252, 1, 3
    v_lshl_add_u32 v30, v30, 3, v31
    v_lshlrev_b32 v30, 2, v30
    v_add_u32 v30, 3328, v30
    ds_read2_b32 v[32:33], v30 offset0:0 offset1:16
    ds_read2_b32 v[34:35], v30 offset0:32 offset1:48
    ds_read2_b32 v[36:37], v30 offset0:64 offset1:80
    ds_read2_b32 v[38:39], v30 offset0:96 offset1:112
    v_lshrrev_b32 v30, 2, v252
    v_mul_u32_u24 v30, 14336, v30
    v_and_b32 v31, 3, v252
    v_lshl_add_u32 v30, v31, 4, v30
    v_and_b32 v31, 1, v252
    v_cmp_eq_u32 vcc, 1, v31
    s_mul_i32 s32, s28, 229376
    s_lshl_b32 s33, s29, 6
    s_add_u32 s32, s32, s33
    s_add_u32 s32, s32, s79
    s_add_u32 s32, s32, 0xc80000
    s_waitcnt lgkmcnt(0)
    v_pk_add_f32 v[32:33], v[32:33], v[34:35]
    v_pk_add_f32 v[36:37], v[36:37], v[38:39]
    v_pk_add_f32 v[32:33], v[32:33], v[36:37]
    v_mul_f32 v34, 0xbfb8aa3b, v32
    v_exp_f32 v34, v34
    v_mul_f32 v32, v32, v33
    v_add_f32 v34, 1.0, v34
    v_rcp_f32 v34, v34
    s_nop 0
    v_mul_f32 v32, v32, v34
    s_nop 1
    v_mov_b32_dpp v33, v32 quad_perm:[2,3,2,3] row_mask:0xf bank_mask:0xf
    v_cvt_pk_bf16_f32 v32, v32, v33
    ds_swizzle_b32 v36, v32 offset:0x1
    ds_swizzle_b32 v37, v32 offset:0x81
    ds_swizzle_b32 v38, v32 offset:0x101
    ds_swizzle_b32 v39, v32 offset:0x181
    s_waitcnt lgkmcnt(0)
    v_dot2_f32_bf16 v40, v215, v36, 0
    v_dot2_f32_bf16 v41, v224, v36, 0
    v_dot2_f32_bf16 v42, v220, v36, 0
    v_dot2_f32_bf16 v43, v225, v36, 0
    v_dot2_f32_bf16 v44, v221, v36, 0
    v_dot2_f32_bf16 v45, v226, v36, 0
    v_dot2_f32_bf16 v46, v222, v36, 0
    v_dot2_f32_bf16 v47, v227, v36, 0
    v_dot2_f32_bf16 v40, v223, v37, v40
    v_dot2_f32_bf16 v41, v232, v37, v41
    v_dot2_f32_bf16 v42, v228, v37, v42
    v_dot2_f32_bf16 v43, v233, v37, v43
    v_dot2_f32_bf16 v44, v229, v37, v44
    v_dot2_f32_bf16 v45, v234, v37, v45
    v_dot2_f32_bf16 v46, v230, v37, v46
    v_dot2_f32_bf16 v47, v235, v37, v47
    v_dot2_f32_bf16 v40, v231, v38, v40
    v_dot2_f32_bf16 v41, v240, v38, v41
    v_dot2_f32_bf16 v42, v236, v38, v42
    v_dot2_f32_bf16 v43, v241, v38, v43
    v_dot2_f32_bf16 v44, v237, v38, v44
    v_dot2_f32_bf16 v45, v242, v38, v45
    v_dot2_f32_bf16 v46, v238, v38, v46
    v_dot2_f32_bf16 v47, v243, v38, v47
    v_dot2_f32_bf16 v40, v239, v39, v40
    v_dot2_f32_bf16 v41, v248, v39, v41
    v_dot2_f32_bf16 v42, v244, v39, v42
    v_dot2_f32_bf16 v43, v249, v39, v43
    v_dot2_f32_bf16 v44, v245, v39, v44
    v_dot2_f32_bf16 v45, v250, v39, v45
    v_dot2_f32_bf16 v46, v246, v39, v46
    v_dot2_f32_bf16 v47, v251, v39, v47
    v_add_f32_dpp v40, v40, v40 quad_perm:[1,0,3,2] row_mask:0xf bank_mask:0xf
    v_add_f32_dpp v41, v41, v41 quad_perm:[1,0,3,2] row_mask:0xf bank_mask:0xf
    v_add_f32_dpp v42, v42, v42 quad_perm:[1,0,3,2] row_mask:0xf bank_mask:0xf
    v_add_f32_dpp v43, v43, v43 quad_perm:[1,0,3,2] row_mask:0xf bank_mask:0xf
    v_add_f32_dpp v44, v44, v44 quad_perm:[1,0,3,2] row_mask:0xf bank_mask:0xf
    v_add_f32_dpp v45, v45, v45 quad_perm:[1,0,3,2] row_mask:0xf bank_mask:0xf
    v_add_f32_dpp v46, v46, v46 quad_perm:[1,0,3,2] row_mask:0xf bank_mask:0xf
    v_add_f32_dpp v47, v47, v47 quad_perm:[1,0,3,2] row_mask:0xf bank_mask:0xf
    v_cndmask_b32 v40, v40, v44, vcc
    v_cndmask_b32 v41, v41, v45, vcc
    v_cndmask_b32 v42, v42, v46, vcc
    v_cndmask_b32 v43, v43, v47, vcc
    s_cmp_lt_u32 s29, 224
    s_cselect_b64 exec, -1, 0
    buffer_store_dwordx4 v[40:43], v30, s[20:23], s32 offen sc1
    s_mov_b64 exec, -1
    s_branch k_end
l_tred:
    s_cmp_ge_u32 s28, 2
    s_cbranch_scc1 k_end
    v_and_b32 v30, 2, v252
    v_cmp_eq_u32 vcc, 2, v30
    v_mov_b32 v28, s76
    v_mul_f32 v29, s75, v28
    v_add_f32 v28, 1.0, v28
    v_cndmask_b32 v30, v24, v26, vcc
    v_cndmask_b32 v31, v25, v27, vcc
    v_lshlrev_b32 v92, 16, v30
    v_and_b32 v93, 0xffff0000, v30
    v_lshlrev_b32 v94, 16, v31
    v_and_b32 v95, 0xffff0000, v31
    v_fma_f32 v92, v92, v28, -v29
    v_fma_f32 v93, v93, v28, -v29
    v_fma_f32 v94, v94, v28, -v29
    v_fma_f32 v95, v95, v28, -v29
    v_mov_b32 v96, 0xbfb8aa3b
    v_mul_f32 v96, s74, v96
    v_exp_f32 v96, v96
    s_nop 0
    v_add_f32 v96, 1.0, v96
    v_rcp_f32 v96, v96
    s_mov_b32 s78, s27
pl_107:
    s_mul_i32 s32, s89, 14336
    s_add_u32 s32, s32, s79
    s_add_u32 s32, s32, 0xc80000
    buffer_load_dwordx4 v[32:35], v253, s[20:23], s32 offen offset:0 sc1
    buffer_load_dwordx4 v[36:39], v253, s[20:23], s32 offen offset:1024 sc1
    buffer_load_dwordx4 v[40:43], v253, s[20:23], s32 offen offset:2048 sc1
    buffer_load_dwordx4 v[44:47], v253, s[20:23], s32 offen offset:3072 sc1
    s_add_u32 s32, s32, 4096
    buffer_load_dwordx4 v[48:51], v253, s[20:23], s32 offen offset:0 sc1
    buffer_load_dwordx4 v[52:55], v253, s[20:23], s32 offen offset:1024 sc1
    buffer_load_dwordx4 v[56:59], v253, s[20:23], s32 offen offset:2048 sc1
    buffer_load_dwordx4 v[60:63], v253, s[20:23], s32 offen offset:3072 sc1
    s_add_u32 s32, s32, 4096
    buffer_load_dwordx4 v[64:67], v253, s[20:23], s32 offen offset:0 sc1
    buffer_load_dwordx4 v[68:71], v253, s[20:23], s32 offen offset:1024 sc1
    buffer_load_dwordx4 v[72:75], v253, s[20:23], s32 offen offset:2048 sc1
    buffer_load_dwordx4 v[76:79], v253, s[20:23], s32 offen offset:3072 sc1
    s_add_u32 s32, s32, 4096
    buffer_load_dwordx4 v[80:83], v253, s[20:23], s32 offen offset:0 sc1
    buffer_load_dwordx4 v[84:87], v253, s[20:23], s32 offen offset:1024 sc1
    s_waitcnt vmcnt(0)
pc_108:
    v_max3_u32 v30, v32, v33, v34
    v_max3_u32 v30, v30, v35, v36
    v_max3_u32 v30, v30, v37, v38
    v_max3_u32 v30, v30, v39, v40
    v_max3_u32 v30, v30, v41, v42
    v_max3_u32 v30, v30, v43, v44
    v_max3_u32 v30, v30, v45, v46
    v_max3_u32 v30, v30, v47, v48
    v_max3_u32 v30, v30, v49, v50
    v_max3_u32 v30, v30, v51, v52
    v_max3_u32 v30, v30, v53, v54
    v_max3_u32 v30, v30, v55, v56
    v_max3_u32 v30, v30, v57, v58
    v_max3_u32 v30, v30, v59, v60
    v_max3_u32 v30, v30, v61, v62
    v_max3_u32 v30, v30, v63, v64
    v_max3_u32 v30, v30, v65, v66
    v_max3_u32 v30, v30, v67, v68
    v_max3_u32 v30, v30, v69, v70
    v_max3_u32 v30, v30, v71, v72
    v_max3_u32 v30, v30, v73, v74
    v_max3_u32 v30, v30, v75, v76
    v_max3_u32 v30, v30, v77, v78
    v_max3_u32 v30, v30, v79, v80
    v_max3_u32 v30, v30, v81, v82
    v_max3_u32 v30, v30, v83, v84
    v_max3_u32 v30, v30, v85, v86
    v_max_u32 v30, v30, v87
    v_cmp_eq_u32 vcc, -1, v30
    s_cbranch_vccz pd_109
    s_sub_u32 s78, s78, 1
    s_cmp_lg_u32 s78, 0
    s_cbranch_scc1 pl_107
    s_mov_b32 s27, 1
pd_109:
    v_pk_add_f32 v[32:33], v[32:33], v[36:37]
    v_pk_add_f32 v[34:35], v[34:35], v[38:39]
    v_pk_add_f32 v[32:33], v[32:33], v[40:41]
    v_pk_add_f32 v[34:35], v[34:35], v[42:43]
    v_pk_add_f32 v[32:33], v[32:33], v[44:45]
    v_pk_add_f32 v[34:35], v[34:35], v[46:47]
    v_pk_add_f32 v[32:33], v[32:33], v[48:49]
    v_pk_add_f32 v[34:35], v[34:35], v[50:51]
    v_pk_add_f32 v[32:33], v[32:33], v[52:53]
    v_pk_add_f32 v[34:35], v[34:35], v[54:55]
    v_pk_add_f32 v[32:33], v[32:33], v[56:57]
    v_pk_add_f32 v[34:35], v[34:35], v[58:59]
    v_pk_add_f32 v[32:33], v[32:33], v[60:61]
    v_pk_add_f32 v[34:35], v[34:35], v[62:63]
    v_pk_add_f32 v[32:33], v[32:33], v[64:65]
    v_pk_add_f32 v[34:35], v[34:35], v[66:67]
    v_pk_add_f32 v[32:33], v[32:33], v[68:69]
    v_pk_add_f32 v[34:35], v[34:35], v[70:71]
    v_pk_add_f32 v[32:33], v[32:33], v[72:73]
    v_pk_add_f32 v[34:35], v[34:35], v[74:75]
    v_pk_add_f32 v[32:33], v[32:33], v[76:77]
    v_pk_add_f32 v[34:35], v[34:35], v[78:79]
    v_pk_add_f32 v[32:33], v[32:33], v[80:81]
    v_pk_add_f32 v[34:35], v[34:35], v[82:83]
    v_pk_add_f32 v[32:33], v[32:33], v[84:85]
    v_pk_add_f32 v[34:35], v[34:35], v[86:87]
    s_nop 0
    v_add_f32_dpp v32, v32, v32 row_ror:4 row_mask:0xf bank_mask:0xf
    v_add_f32_dpp v33, v33, v33 row_ror:4 row_mask:0xf bank_mask:0xf
    v_add_f32_dpp v34, v34, v34 row_ror:4 row_mask:0xf bank_mask:0xf
    v_add_f32_dpp v35, v35, v35 row_ror:4 row_mask:0xf bank_mask:0xf
    v_add_f32_dpp v32, v32, v32 row_ror:8 row_mask:0xf bank_mask:0xf
    v_add_f32_dpp v33, v33, v33 row_ror:8 row_mask:0xf bank_mask:0xf
    v_add_f32_dpp v34, v34, v34 row_ror:8 row_mask:0xf bank_mask:0xf
    v_add_f32_dpp v35, v35, v35 row_ror:8 row_mask:0xf bank_mask:0xf
    v_mov_b32 v36, v32
    v_mov_b32 v37, v33
    v_mov_b32 v38, v34
    v_mov_b32 v39, v35
    v_permlane16_swap_b32 v32, v36
    v_permlane16_swap_b32 v33, v37
    v_permlane16_swap_b32 v34, v38
    v_permlane16_swap_b32 v35, v39
    v_add_f32 v32, v32, v36
    v_add_f32 v33, v33, v37
    v_add_f32 v34, v34, v38
    v_add_f32 v35, v35, v39
    v_mov_b32 v36, v32
    v_mov_b32 v37, v33
    v_mov_b32 v38, v34
    v_mov_b32 v39, v35
    v_permlane32_swap_b32 v32, v36
    v_permlane32_swap_b32 v33, v37
    v_permlane32_swap_b32 v34, v38
    v_permlane32_swap_b32 v35, v39
    v_add_f32 v32, v32, v36
    v_add_f32 v33, v33, v37
    v_add_f32 v34, v34, v38
    v_add_f32 v35, v35, v39
    v_fma_f32 v32, v32, v96, v92
    v_fma_f32 v33, v33, v96, v93
    v_fma_f32 v34, v34, v96, v94
    v_fma_f32 v35, v35, v96, v95
    v_cvt_pk_bf16_f32 v32, v32, v33
    v_cvt_pk_bf16_f32 v33, v34, v35
    s_lshl_b32 s32, s73, 11
    s_lshl_b32 s33, s89, 5
    s_add_u32 s32, s32, s33
    v_lshlrev_b32 v30, 3, v252
    s_mov_b64 exec, 15
    buffer_store_dwordx2 v[32:33], v30, s[12:15], s32 offen sc1
    s_mov_b64 exec, -1
k_end:
k_exit:
    s_endpgm
.section .rodata,"a"
.p2align 6
.amdhsa_kernel interleave_layers__sliding_block__moe_arch_mod__prompt_kernel
  .amdhsa_next_free_vgpr 256
  .amdhsa_next_free_sgpr 102
  .amdhsa_accum_offset 256
  .amdhsa_group_segment_fixed_size 0
  .amdhsa_kernarg_size 88
  .amdhsa_user_sgpr_count 2
  .amdhsa_user_sgpr_kernarg_segment_ptr 1
  .amdhsa_system_sgpr_workgroup_id_x 1
.end_amdhsa_kernel
```

```asm
; @launch grid=(256,1,1) block=(512,1,1) lds=163840
.amdgcn_target "amdgcn-amd-amdhsa--gfx950"
.text
.globl interleave_layers__sliding_block__moe_arch_mod__prompt_kernel
.p2align 8
.type interleave_layers__sliding_block__moe_arch_mod__prompt_kernel,@function
interleave_layers__sliding_block__moe_arch_mod__prompt_kernel:
    s_cmp_ge_u32 s2, 256
    s_cbranch_scc1 k_exit
    s_load_dwordx4 s[4:7], s[0:1], 0
    s_load_dwordx2 s[8:9], s[0:1], 16
    s_load_dwordx2 s[20:21], s[0:1], 80
    s_load_dwordx2 s[12:13], s[0:1], 72
    s_load_dwordx2 s[80:81], s[0:1], 32
    v_lshrrev_b32 v1, 6, v0
    v_and_b32 v252, 63, v0
    v_readfirstlane_b32 s3, v1
    v_lshlrev_b32 v253, 4, v252
    s_and_b32 s30, s2, 7
    s_lshr_b32 s31, s2, 3
    s_and_b32 s32, s31, 1
    s_lshl_b32 s33, s30, 1
    s_add_u32 s24, s33, s32
    s_lshr_b32 s25, s31, 1
    s_add_u32 s33, s33, s25
    s_add_u32 s94, s33, s32
    s_sub_u32 s95, s33, s32
    s_add_u32 s98, s95, 15
    s_and_b32 s98, s98, 15
    s_mul_i32 s29, s30, 28
    s_lshl_b32 s32, s30, 2
    s_add_u32 s32, s32, 196
    s_cmp_lt_u32 s31, 28
    s_cselect_b32 s29, s29, s32
    s_add_u32 s29, s29, s31
    s_lshl_b32 s72, s24, 4
    s_add_u32 s72, s72, s25
    s_mov_b32 s26, 0
    s_mov_b32 s27, 20000
    s_and_b32 s28, s3, 3
    s_lshl_b32 s99, s24, 2
    s_add_u32 s99, s99, s28
    s_lshl_b32 s101, s28, 10
    s_mov_b32 s18, 0x600000
    s_mov_b32 s19, 0x20000
    s_mov_b32 s10, 0x200000
    s_mov_b32 s11, 0x20000
    s_mov_b32 s22, 0x8000000
    s_mov_b32 s23, 0x20000
    s_mov_b32 s14, 0x100
    s_mov_b32 s15, 0x20000
    s_mov_b32 s82, 0x800
    s_mov_b32 s83, 0x20000
    s_cmp_ge_u32 s3, 4
    s_cbranch_scc1 l_start
    s_waitcnt lgkmcnt(0)
    s_mov_b64 s[16:17], s[6:7]
    s_mov_b32 s6, 0x400000
    s_mov_b32 s7, 0x20000
    v_lshrrev_b32 v5, 5, v252
    v_lshlrev_b32 v6, 3, v5
    s_lshl_b32 s33, s98, 7
    buffer_load_dwordx2 v[224:225], v6, s[80:83], s33 offen offset:0
    buffer_load_dwordx2 v[226:227], v6, s[80:83], s33 offen offset:16
    buffer_load_dwordx2 v[228:229], v6, s[80:83], s33 offen offset:32
    buffer_load_dwordx2 v[230:231], v6, s[80:83], s33 offen offset:48
    buffer_load_dwordx2 v[232:233], v6, s[80:83], s33 offen offset:64
    buffer_load_dwordx2 v[234:235], v6, s[80:83], s33 offen offset:80
    buffer_load_dwordx2 v[236:237], v6, s[80:83], s33 offen offset:96
    buffer_load_dwordx2 v[238:239], v6, s[80:83], s33 offen offset:112
    s_mov_b32 s40, 0xffffffff
    s_mov_b32 s41, 0xfffffff0
    s_mov_b32 s42, 0xfffffffe
    s_mov_b32 s43, 0xffffffe0
    s_mov_b32 s44, 0xfffffffc
    s_mov_b32 s45, 0xffffffc0
    s_mov_b32 s46, 0xfffffff8
    s_mov_b32 s47, 0xffffff80
    s_mov_b32 s48, 0xffff0000
    s_mov_b32 s49, 0xfff00000
    s_mov_b32 s50, 0xfffe0000
    s_mov_b32 s51, 0xffe00000
    s_mov_b32 s52, 0xfffc0000
    s_mov_b32 s53, 0xffc00000
    s_mov_b32 s54, 0xfff80000
    s_mov_b32 s55, 0xff800000
    s_mov_b32 s56, 0xffffff00
    s_mov_b32 s57, 0xfffff000
    s_mov_b32 s58, 0xfffffe00
    s_mov_b32 s59, 0xffffe000
    s_mov_b32 s60, 0xfffffc00
    s_mov_b32 s61, 0xffffc000
    s_mov_b32 s62, 0xfffff800
    s_mov_b32 s63, 0xffff8000
    s_mov_b32 s64, 0xff000000
    s_mov_b32 s65, 0xf0000000
    s_mov_b32 s66, 0xfe000000
    s_mov_b32 s67, 0xe0000000
    s_mov_b32 s68, 0xfc000000
    s_mov_b32 s69, 0xc0000000
    s_mov_b32 s70, 0xf8000000
    s_mov_b32 s71, 0x80000000
    v_bfe_u32 v20, v252, 3, 2
    v_lshrrev_b32 v21, 5, v252
    v_lshl_add_u32 v20, v21, 3, v20
    s_lshr_b32 s32, s28, 1
    s_lshl_b32 s32, s32, 4
    s_and_b32 s33, s28, 1
    s_lshl_b32 s33, s33, 2
    s_add_u32 s32, s32, s33
    v_add_u32 v20, s32, v20
    v_lshlrev_b32 v20, 11, v20
    v_lshrrev_b32 v21, 2, v252
    v_and_b32 v21, 4, v21
    v_xor_b32 v21, v21, v252
    v_and_b32 v21, 7, v21
    v_lshl_add_u32 v20, v21, 4, v20
    s_lshl_b32 s32, s98, 7
    v_add_u32 v243, s32, v20
    s_and_b32 s34, s3, 1
    s_lshr_b32 s35, s3, 1
    v_and_b32 v4, 15, v252
    v_lshrrev_b32 v7, 4, v252
    v_lshrrev_b32 v6, 1, v4
    v_xor_b32 v6, v6, v7
    v_lshlrev_b32 v6, 4, v6
    v_lshl_add_u32 v6, v4, 7, v6
    s_lshl_b32 s30, s34, 13
    v_add_u32 v176, s30, v6
    v_xor_b32 v177, 64, v176
    s_lshl_b32 s30, s35, 1
    v_lshrrev_b32 v20, 2, v252
    v_bfe_u32 v21, v20, 1, 2
    v_xor_b32 v21, s30, v21
    v_lshlrev_b32 v20, 7, v20
    v_lshl_add_u32 v20, v21, 5, v20
    v_and_b32 v21, 3, v252
    v_lshl_add_u32 v20, v21, 3, v20
    v_add_u32 v178, 40960, v20
    v_xor_b32 v179, 32, v178
    v_and_b32 v8, 31, v252
    v_bfe_u32 v6, v8, 1, 3
    v_xor_b32 v6, v6, v5
    v_lshlrev_b32 v6, 4, v6
    v_lshl_add_u32 v6, v8, 7, v6
    s_lshl_b32 s30, s3, 12
    s_add_u32 s30, s30, 147456
    v_add_u32 v192, s30, v6
    v_xor_b32 v193, 32, v192
    v_xor_b32 v194, 64, v192
    v_xor_b32 v195, 96, v192
    s_lshl_b32 s30, s34, 8
    v_lshl_add_u32 v184, v4, 2, s30
    v_lshl_add_u32 v185, v7, 4, s30
    s_lshl_b32 s30, s35, 7
    v_lshl_add_u32 v186, v7, 4, s30
    s_add_u32 s30, s30, 1536
    v_lshl_add_u32 v187, v4, 2, s30
    s_lshl_b32 s30, s3, 7
    s_add_u32 s30, s30, 2048
    v_lshl_add_u32 v188, v8, 2, s30
    v_mov_b32 v189, 0
    v_lshlrev_b32 v6, 9, v7
    v_lshl_add_u32 v245, v4, 4, v6
    v_and_b32 v9, 8, v4
    v_lshl_add_u32 v244, v9, 4, v245
    s_mul_i32 s30, s35, 49152
    s_lshl_b32 s31, s34, 13
    s_add_u32 s30, s30, s31
    s_add_u32 s30, s30, 98304
    v_add_u32 v246, s30, v244
    v_add_u32 v247, s30, v245
    s_lshl_b32 s30, s3, 12
    s_add_u32 s30, s30, 49152
    v_add_u32 v248, s30, v245
    s_getreg_b32 s88, hwreg(HW_REG_XCC_ID, 0, 4)
    s_or_b32 s88, s88, 16
    v_mov_b32 v249, s88
    s_cmp_eq_u32 s3, 0
    s_cselect_b32 s88, 10, -1
    v_mov_b32 v242, 0
    v_mov_b32 v0, 0
    v_mov_b32 v1, 0
    v_mov_b32 v2, 0
    v_mov_b32 v3, 0
    v_mov_b32 v4, 0
    v_mov_b32 v5, 0
    v_mov_b32 v6, 0
    v_mov_b32 v7, 0
    v_mov_b32 v8, 0
    v_mov_b32 v9, 0
    v_mov_b32 v10, 0
    v_mov_b32 v11, 0
    v_mov_b32 v12, 0
    v_mov_b32 v13, 0
    v_mov_b32 v14, 0
    v_mov_b32 v15, 0
    v_mov_b32 v16, 0
    v_mov_b32 v17, 0
    v_mov_b32 v18, 0
    v_mov_b32 v19, 0
    v_mov_b32 v20, 0
    v_mov_b32 v21, 0
    v_mov_b32 v22, 0
    v_mov_b32 v23, 0
    v_mov_b32 v24, 0
    v_mov_b32 v25, 0
    v_mov_b32 v26, 0
    v_mov_b32 v27, 0
    v_mov_b32 v28, 0
    v_mov_b32 v29, 0
    v_mov_b32 v30, 0
    v_mov_b32 v31, 0
    v_mov_b32 v32, 0
    v_mov_b32 v33, 0
    v_mov_b32 v34, 0
    v_mov_b32 v35, 0
    v_mov_b32 v36, 0
    v_mov_b32 v37, 0
    v_mov_b32 v38, 0
    v_mov_b32 v39, 0
    v_mov_b32 v40, 0
    v_mov_b32 v41, 0
    v_mov_b32 v42, 0
    v_mov_b32 v43, 0
    v_mov_b32 v44, 0
    v_mov_b32 v45, 0
    v_mov_b32 v46, 0
    v_mov_b32 v47, 0
    v_mov_b32 v48, 0
    v_mov_b32 v49, 0
    v_mov_b32 v50, 0
    v_mov_b32 v51, 0
    v_mov_b32 v52, 0
    v_mov_b32 v53, 0
    v_mov_b32 v54, 0
    v_mov_b32 v55, 0
    v_mov_b32 v56, 0
    v_mov_b32 v57, 0
    v_mov_b32 v58, 0
    v_mov_b32 v59, 0
    v_mov_b32 v60, 0
    v_mov_b32 v61, 0
    v_mov_b32 v62, 0
    v_mov_b32 v63, 0
    v_mov_b32 v64, 0
    v_mov_b32 v65, 0
    v_mov_b32 v66, 0
    v_mov_b32 v67, 0
    v_mov_b32 v68, 0
    v_mov_b32 v69, 0
    v_mov_b32 v70, 0
    v_mov_b32 v71, 0
    v_mov_b32 v72, 0
    v_mov_b32 v73, 0
    v_mov_b32 v74, 0
    v_mov_b32 v75, 0
    v_mov_b32 v76, 0
    v_mov_b32 v77, 0
    v_mov_b32 v78, 0
    v_mov_b32 v79, 0
    v_mov_b32 v80, 0
    v_mov_b32 v81, 0
    v_mov_b32 v82, 0
    v_mov_b32 v83, 0
    v_mov_b32 v84, 0
    v_mov_b32 v85, 0
    v_mov_b32 v86, 0
    v_mov_b32 v87, 0
    v_mov_b32 v88, 0
    v_mov_b32 v89, 0
    v_mov_b32 v90, 0
    v_mov_b32 v91, 0
    v_mov_b32 v92, 0
    v_mov_b32 v93, 0
    v_mov_b32 v94, 0
    v_mov_b32 v95, 0
    s_waitcnt vmcnt(0)
    v_dot2c_f32_bf16 v242, 0x3f803f80, v224
    v_dot2c_f32_bf16 v242, 0x3f803f80, v225
    v_dot2c_f32_bf16 v242, 0x3f803f80, v226
    v_dot2c_f32_bf16 v242, 0x3f803f80, v227
    v_dot2c_f32_bf16 v242, 0x3f803f80, v228
    v_dot2c_f32_bf16 v242, 0x3f803f80, v229
    v_dot2c_f32_bf16 v242, 0x3f803f80, v230
    v_dot2c_f32_bf16 v242, 0x3f803f80, v231
    v_dot2c_f32_bf16 v242, 0x3f803f80, v232
    v_dot2c_f32_bf16 v242, 0x3f803f80, v233
    v_dot2c_f32_bf16 v242, 0x3f803f80, v234
    v_dot2c_f32_bf16 v242, 0x3f803f80, v235
    v_dot2c_f32_bf16 v242, 0x3f803f80, v236
    v_dot2c_f32_bf16 v242, 0x3f803f80, v237
    v_dot2c_f32_bf16 v242, 0x3f803f80, v238
    v_dot2c_f32_bf16 v242, 0x3f803f80, v239
    s_setprio 1
e_q:
    s_mov_b32 s31, 0
    s_mov_b32 s32, 147456
    s_mov_b32 s36, 15
    v_add_u32 v180, s32, v176
    v_mov_b32 v182, v178
    v_add_u32 v181, s32, v177
    v_mov_b32 v183, v179
    s_barrier
    ds_read_b128 v[96:99], v180 offset:0
    ds_read_b64_tr_b16 v[112:113], v182 offset:0
    ds_read_b64_tr_b16 v[114:115], v182 offset:2048
    ds_read_b128 v[100:103], v180 offset:2048
    ds_read_b128 v[104:107], v180 offset:4096
    ds_read_b128 v[108:111], v180 offset:6144
    ds_read_b64_tr_b16 v[116:117], v183 offset:0
    ds_read_b64_tr_b16 v[118:119], v183 offset:2048
    ds_read_b64_tr_b16 v[120:121], v182 offset:8192
    ds_read_b64_tr_b16 v[122:123], v182 offset:10240
    ds_read_b64_tr_b16 v[124:125], v183 offset:8192
    ds_read_b64_tr_b16 v[126:127], v183 offset:10240
    ds_read_b64_tr_b16 v[128:129], v182 offset:16384
    ds_read_b64_tr_b16 v[130:131], v182 offset:18432
    ds_read_b64_tr_b16 v[132:133], v183 offset:16384
    ds_read_b64_tr_b16 v[134:135], v183 offset:18432
e_loop:
    s_waitcnt lgkmcnt(0)
    v_mfma_f32_16x16x32_bf16 v[0:3], v[112:115], v[96:99], v[0:3]
    ds_read_b128 v[136:139], v181 offset:0
    v_mfma_f32_16x16x32_bf16 v[8:11], v[112:115], v[100:103], v[8:11]
    ds_read_b64_tr_b16 v[152:153], v182 offset:4096
    v_mfma_f32_16x16x32_bf16 v[16:19], v[112:115], v[104:107], v[16:19]
    ds_read_b64_tr_b16 v[154:155], v182 offset:6144
    v_mfma_f32_16x16x32_bf16 v[24:27], v[112:115], v[108:111], v[24:27]
    ds_read_b128 v[140:143], v181 offset:2048
    v_mfma_f32_16x16x32_bf16 v[28:31], v[116:119], v[108:111], v[28:31]
    ds_read_b128 v[144:147], v181 offset:4096
    v_mfma_f32_16x16x32_bf16 v[20:23], v[116:119], v[104:107], v[20:23]
    ds_read_b128 v[148:151], v181 offset:6144
    v_mfma_f32_16x16x32_bf16 v[12:15], v[116:119], v[100:103], v[12:15]
    ds_read_b64_tr_b16 v[156:157], v183 offset:4096
    v_mfma_f32_16x16x32_bf16 v[4:7], v[116:119], v[96:99], v[4:7]
    ds_read_b64_tr_b16 v[158:159], v183 offset:6144
    v_mfma_f32_16x16x32_bf16 v[32:35], v[120:123], v[96:99], v[32:35]
    ds_read_b64_tr_b16 v[160:161], v182 offset:12288
    v_mfma_f32_16x16x32_bf16 v[40:43], v[120:123], v[100:103], v[40:43]
    ds_read_b64_tr_b16 v[162:163], v182 offset:14336
    v_mfma_f32_16x16x32_bf16 v[48:51], v[120:123], v[104:107], v[48:51]
    ds_read_b64_tr_b16 v[164:165], v183 offset:12288
    v_mfma_f32_16x16x32_bf16 v[56:59], v[120:123], v[108:111], v[56:59]
    ds_read_b64_tr_b16 v[166:167], v183 offset:14336
    v_mfma_f32_16x16x32_bf16 v[60:63], v[124:127], v[108:111], v[60:63]
    ds_read_b64_tr_b16 v[168:169], v182 offset:20480
    v_mfma_f32_16x16x32_bf16 v[52:55], v[124:127], v[104:107], v[52:55]
    ds_read_b64_tr_b16 v[170:171], v182 offset:22528
    v_mfma_f32_16x16x32_bf16 v[44:47], v[124:127], v[100:103], v[44:47]
    ds_read_b64_tr_b16 v[172:173], v183 offset:20480
    v_mfma_f32_16x16x32_bf16 v[36:39], v[124:127], v[96:99], v[36:39]
    ds_read_b64_tr_b16 v[174:175], v183 offset:22528
    v_mfma_f32_16x16x32_bf16 v[64:67], v[96:99], v[128:131], v[64:67]
    s_cmp_eq_u32 s36, s88
    s_cbranch_scc1 e_arr
e_arr_ret:
    v_mfma_f32_16x16x32_bf16 v[68:71], v[100:103], v[128:131], v[68:71]
    s_add_u32 s31, s31, 24576
    s_sub_u32 s32, s32, 16384
    v_mfma_f32_16x16x32_bf16 v[72:75], v[104:107], v[128:131], v[72:75]
    s_cmp_ge_u32 s31, 73728
    s_cselect_b32 s31, 0, s31
    s_cselect_b32 s32, 147456, s32
    v_mfma_f32_16x16x32_bf16 v[76:79], v[108:111], v[128:131], v[76:79]
    v_add_u32 v182, s31, v178
    v_add_u32 v180, s32, v176
    v_mfma_f32_16x16x32_bf16 v[92:95], v[108:111], v[132:135], v[92:95]
    v_add_u32 v183, s31, v179
    v_add_u32 v181, s32, v177
    v_mfma_f32_16x16x32_bf16 v[88:91], v[104:107], v[132:135], v[88:91]
    s_sub_u32 s36, s36, 1
    s_cmp_eq_u32 s36, 0
    v_mfma_f32_16x16x32_bf16 v[84:87], v[100:103], v[132:135], v[84:87]
    v_mfma_f32_16x16x32_bf16 v[80:83], v[96:99], v[132:135], v[80:83]
    s_waitcnt lgkmcnt(0)
    v_mfma_f32_16x16x32_bf16 v[0:3], v[152:155], v[136:139], v[0:3]
    s_barrier
    ds_read_b128 v[96:99], v180 offset:0
    v_mfma_f32_16x16x32_bf16 v[8:11], v[152:155], v[140:143], v[8:11]
    ds_read_b64_tr_b16 v[112:113], v182 offset:0
    v_mfma_f32_16x16x32_bf16 v[16:19], v[152:155], v[144:147], v[16:19]
    ds_read_b64_tr_b16 v[114:115], v182 offset:2048
    v_mfma_f32_16x16x32_bf16 v[24:27], v[152:155], v[148:151], v[24:27]
    ds_read_b128 v[100:103], v180 offset:2048
    v_mfma_f32_16x16x32_bf16 v[28:31], v[156:159], v[148:151], v[28:31]
    ds_read_b128 v[104:107], v180 offset:4096
    v_mfma_f32_16x16x32_bf16 v[20:23], v[156:159], v[144:147], v[20:23]
    ds_read_b128 v[108:111], v180 offset:6144
    v_mfma_f32_16x16x32_bf16 v[12:15], v[156:159], v[140:143], v[12:15]
    ds_read_b64_tr_b16 v[116:117], v183 offset:0
    v_mfma_f32_16x16x32_bf16 v[4:7], v[156:159], v[136:139], v[4:7]
    ds_read_b64_tr_b16 v[118:119], v183 offset:2048
    v_mfma_f32_16x16x32_bf16 v[32:35], v[160:163], v[136:139], v[32:35]
    ds_read_b64_tr_b16 v[120:121], v182 offset:8192
    v_mfma_f32_16x16x32_bf16 v[40:43], v[160:163], v[140:143], v[40:43]
    ds_read_b64_tr_b16 v[122:123], v182 offset:10240
    v_mfma_f32_16x16x32_bf16 v[48:51], v[160:163], v[144:147], v[48:51]
    ds_read_b64_tr_b16 v[124:125], v183 offset:8192
    v_mfma_f32_16x16x32_bf16 v[56:59], v[160:163], v[148:151], v[56:59]
    ds_read_b64_tr_b16 v[126:127], v183 offset:10240
    v_mfma_f32_16x16x32_bf16 v[60:63], v[164:167], v[148:151], v[60:63]
    ds_read_b64_tr_b16 v[128:129], v182 offset:16384
    v_mfma_f32_16x16x32_bf16 v[52:55], v[164:167], v[144:147], v[52:55]
    ds_read_b64_tr_b16 v[130:131], v182 offset:18432
    v_mfma_f32_16x16x32_bf16 v[44:47], v[164:167], v[140:143], v[44:47]
    ds_read_b64_tr_b16 v[132:133], v183 offset:16384
    v_mfma_f32_16x16x32_bf16 v[36:39], v[164:167], v[136:139], v[36:39]
    ds_read_b64_tr_b16 v[134:135], v183 offset:18432
    v_mfma_f32_16x16x32_bf16 v[64:67], v[136:139], v[168:171], v[64:67]
    v_mfma_f32_16x16x32_bf16 v[68:71], v[140:143], v[168:171], v[68:71]
    v_mfma_f32_16x16x32_bf16 v[72:75], v[144:147], v[168:171], v[72:75]
    v_mfma_f32_16x16x32_bf16 v[76:79], v[148:151], v[168:171], v[76:79]
    v_mfma_f32_16x16x32_bf16 v[92:95], v[148:151], v[172:175], v[92:95]
    v_mfma_f32_16x16x32_bf16 v[88:91], v[144:147], v[172:175], v[88:91]
    v_mfma_f32_16x16x32_bf16 v[84:87], v[140:143], v[172:175], v[84:87]
    v_mfma_f32_16x16x32_bf16 v[80:83], v[136:139], v[172:175], v[80:83]
    s_cbranch_scc0 e_loop
    s_waitcnt lgkmcnt(0)
    v_mfma_f32_16x16x32_bf16 v[0:3], v[112:115], v[96:99], v[0:3]
    ds_read_b128 v[136:139], v181 offset:0
    v_mfma_f32_16x16x32_bf16 v[8:11], v[112:115], v[100:103], v[8:11]
    ds_read_b64_tr_b16 v[152:153], v182 offset:4096
    v_mfma_f32_16x16x32_bf16 v[16:19], v[112:115], v[104:107], v[16:19]
    ds_read_b64_tr_b16 v[154:155], v182 offset:6144
    v_mfma_f32_16x16x32_bf16 v[24:27], v[112:115], v[108:111], v[24:27]
    ds_read_b128 v[140:143], v181 offset:2048
    v_mfma_f32_16x16x32_bf16 v[28:31], v[116:119], v[108:111], v[28:31]
    ds_read_b128 v[144:147], v181 offset:4096
    v_mfma_f32_16x16x32_bf16 v[20:23], v[116:119], v[104:107], v[20:23]
    ds_read_b128 v[148:151], v181 offset:6144
    v_mfma_f32_16x16x32_bf16 v[12:15], v[116:119], v[100:103], v[12:15]
    ds_read_b64_tr_b16 v[156:157], v183 offset:4096
    v_mfma_f32_16x16x32_bf16 v[4:7], v[116:119], v[96:99], v[4:7]
    ds_read_b64_tr_b16 v[158:159], v183 offset:6144
    v_mfma_f32_16x16x32_bf16 v[32:35], v[120:123], v[96:99], v[32:35]
    ds_read_b64_tr_b16 v[160:161], v182 offset:12288
    v_mfma_f32_16x16x32_bf16 v[40:43], v[120:123], v[100:103], v[40:43]
    ds_read_b64_tr_b16 v[162:163], v182 offset:14336
    v_mfma_f32_16x16x32_bf16 v[48:51], v[120:123], v[104:107], v[48:51]
    ds_read_b64_tr_b16 v[164:165], v183 offset:12288
    v_mfma_f32_16x16x32_bf16 v[56:59], v[120:123], v[108:111], v[56:59]
    ds_read_b64_tr_b16 v[166:167], v183 offset:14336
    v_mfma_f32_16x16x32_bf16 v[60:63], v[124:127], v[108:111], v[60:63]
    ds_read_b64_tr_b16 v[168:169], v182 offset:20480
    v_mfma_f32_16x16x32_bf16 v[52:55], v[124:127], v[104:107], v[52:55]
    ds_read_b64_tr_b16 v[170:171], v182 offset:22528
    v_mfma_f32_16x16x32_bf16 v[44:47], v[124:127], v[100:103], v[44:47]
    ds_read_b64_tr_b16 v[172:173], v183 offset:20480
    v_mfma_f32_16x16x32_bf16 v[36:39], v[124:127], v[96:99], v[36:39]
    ds_read_b64_tr_b16 v[174:175], v183 offset:22528
    v_mfma_f32_16x16x32_bf16 v[64:67], v[96:99], v[128:131], v[64:67]
    s_cmp_lg_u32 s26, 0
    s_cbranch_scc1 e_nores
    ds_read_b128 v[208:211], v192
    ds_read_b128 v[212:215], v193
    ds_read_b128 v[216:219], v194
    ds_read_b128 v[220:223], v195
e_nores:
    v_mfma_f32_16x16x32_bf16 v[68:71], v[100:103], v[128:131], v[68:71]
    s_and_b32 s34, s3, 1
    s_lshr_b32 s35, s3, 1
    s_lshl_b32 s30, s25, 1
    v_mfma_f32_16x16x32_bf16 v[72:75], v[104:107], v[128:131], v[72:75]
    s_add_u32 s30, s30, s35
    s_lshl_b32 s30, s30, 6
    s_lshl_b32 s31, s24, 2
    v_mfma_f32_16x16x32_bf16 v[76:79], v[108:111], v[128:131], v[76:79]
    s_add_u32 s30, s30, s31
    s_lshl_b32 s31, s34, 1
    s_add_u32 s30, s30, s31
    v_mfma_f32_16x16x32_bf16 v[92:95], v[108:111], v[132:135], v[92:95]
    s_lshl_b32 s32, s30, 12
    s_add_u32 s32, s32, s26
    s_add_u32 s33, s32, 4096
    v_mfma_f32_16x16x32_bf16 v[88:91], v[104:107], v[132:135], v[88:91]
    v_mfma_f32_16x16x32_bf16 v[84:87], v[100:103], v[132:135], v[84:87]
    v_mfma_f32_16x16x32_bf16 v[80:83], v[96:99], v[132:135], v[80:83]
    s_waitcnt lgkmcnt(0)
    v_mfma_f32_16x16x32_bf16 v[32:35], v[160:163], v[136:139], v[32:35]
    s_barrier
    ds_read2_b32 v[204:205], v184 offset0:128 offset1:144
    ds_read_b128 v[128:131], v186 offset:1280
    v_mfma_f32_16x16x32_bf16 v[40:43], v[160:163], v[140:143], v[40:43]
    ds_read_b128 v[132:135], v186 offset:1344
    ds_read2_b32 v[192:193], v184 offset0:0 offset1:16
    v_mfma_f32_16x16x32_bf16 v[48:51], v[160:163], v[144:147], v[48:51]
    ds_read2_b32 v[206:207], v184 offset0:160 offset1:176
    ds_read2_b32 v[194:195], v184 offset0:32 offset1:48
    v_mfma_f32_16x16x32_bf16 v[56:59], v[160:163], v[148:151], v[56:59]
    ds_read2_b32 v[190:191], v187 offset0:0 offset1:16
    ds_read_b128 v[112:115], v185 offset:512
    v_mfma_f32_16x16x32_bf16 v[36:39], v[164:167], v[136:139], v[36:39]
    ds_read_b128 v[96:99], v185 offset:0
    ds_read_b128 v[116:119], v185 offset:576
    v_mfma_f32_16x16x32_bf16 v[44:47], v[164:167], v[140:143], v[44:47]
    ds_read_b128 v[100:103], v185 offset:64
    ds_read_b128 v[120:123], v185 offset:640
    v_mfma_f32_16x16x32_bf16 v[52:55], v[164:167], v[144:147], v[52:55]
    ds_read_b128 v[104:107], v185 offset:128
    ds_read_b128 v[124:127], v185 offset:704
    v_mfma_f32_16x16x32_bf16 v[60:63], v[164:167], v[148:151], v[60:63]
    ds_read_b128 v[108:111], v185 offset:192
    ds_read_b128 v[196:199], v186 offset:1024
    v_mfma_f32_16x16x32_bf16 v[64:67], v[136:139], v[168:171], v[64:67]
    ds_read_b128 v[200:203], v186 offset:1088
    ds_read2_b32 v[240:241], v188 offset0:0 offset1:128
    v_mfma_f32_16x16x32_bf16 v[68:71], v[140:143], v[168:171], v[68:71]
    ds_read_b64 v[250:251], v189 offset:3072
    v_mfma_f32_16x16x32_bf16 v[72:75], v[144:147], v[168:171], v[72:75]
    s_waitcnt lgkmcnt(13)
    v_fma_f32 v32, v128, -v204, v32
    v_fma_f32 v33, v129, -v204, v33
    v_fma_f32 v34, v130, -v204, v34
    v_mfma_f32_16x16x32_bf16 v[76:79], v[148:151], v[168:171], v[76:79]
    v_fma_f32 v35, v131, -v204, v35
    v_fma_f32 v36, v132, -v204, v36
    v_fma_f32 v37, v133, -v204, v37
    v_mfma_f32_16x16x32_bf16 v[80:83], v[136:139], v[172:175], v[80:83]
    v_fma_f32 v38, v134, -v204, v38
    v_fma_f32 v39, v135, -v204, v39
    v_mul_f32 v32, v32, v192
    v_mfma_f32_16x16x32_bf16 v[84:87], v[140:143], v[172:175], v[84:87]
    v_mul_f32 v33, v33, v192
    v_mul_f32 v34, v34, v192
    v_mul_f32 v35, v35, v192
    v_mfma_f32_16x16x32_bf16 v[88:91], v[144:147], v[172:175], v[88:91]
    v_mul_f32 v36, v36, v192
    v_mul_f32 v37, v37, v192
    v_mul_f32 v38, v38, v192
    v_mfma_f32_16x16x32_bf16 v[92:95], v[148:151], v[172:175], v[92:95]
    v_mul_f32 v39, v39, v192
    v_cvt_pk_bf16_f32 v32, v32, v33
    v_cvt_pk_bf16_f32 v33, v34, v35
    v_mfma_f32_16x16x32_bf16 v[0:3], v[152:155], v[136:139], v[0:3]
    v_cvt_pk_bf16_f32 v34, v36, v37
    v_cvt_pk_bf16_f32 v35, v38, v39
    buffer_store_dwordx4 v[32:35], v244, s[20:23], s32 offen offset:0 sc1
    v_mfma_f32_16x16x32_bf16 v[8:11], v[152:155], v[140:143], v[8:11]
    v_fma_f32 v40, v128, -v205, v40
    v_fma_f32 v41, v129, -v205, v41
    v_fma_f32 v42, v130, -v205, v42
    v_mfma_f32_16x16x32_bf16 v[16:19], v[152:155], v[144:147], v[16:19]
    v_fma_f32 v43, v131, -v205, v43
    v_fma_f32 v44, v132, -v205, v44
    v_fma_f32 v45, v133, -v205, v45
    v_mfma_f32_16x16x32_bf16 v[24:27], v[152:155], v[148:151], v[24:27]
    v_fma_f32 v46, v134, -v205, v46
    v_fma_f32 v47, v135, -v205, v47
    v_mul_f32 v40, v40, v193
    v_mfma_f32_16x16x32_bf16 v[4:7], v[156:159], v[136:139], v[4:7]
    v_mul_f32 v41, v41, v193
    v_mul_f32 v42, v42, v193
    v_mul_f32 v43, v43, v193
    v_mfma_f32_16x16x32_bf16 v[12:15], v[156:159], v[140:143], v[12:15]
    v_mul_f32 v44, v44, v193
    v_mul_f32 v45, v45, v193
    v_mul_f32 v46, v46, v193
    v_mfma_f32_16x16x32_bf16 v[20:23], v[156:159], v[144:147], v[20:23]
    v_mul_f32 v47, v47, v193
    v_cvt_pk_bf16_f32 v40, v40, v41
    v_cvt_pk_bf16_f32 v41, v42, v43
    v_mfma_f32_16x16x32_bf16 v[28:31], v[156:159], v[148:151], v[28:31]
    v_cvt_pk_bf16_f32 v42, v44, v45
    v_cvt_pk_bf16_f32 v43, v46, v47
    buffer_store_dwordx4 v[40:43], v244, s[20:23], s32 offen offset:128 sc1
    v_pk_fma_f32 v[48:49], v[128:129], v[206:207], v[48:49] op_sel_hi:[1,0,1] neg_lo:[0,1,0] neg_hi:[0,1,0]
    v_pk_fma_f32 v[50:51], v[130:131], v[206:207], v[50:51] op_sel_hi:[1,0,1] neg_lo:[0,1,0] neg_hi:[0,1,0]
    v_pk_fma_f32 v[52:53], v[132:133], v[206:207], v[52:53] op_sel_hi:[1,0,1] neg_lo:[0,1,0] neg_hi:[0,1,0]
    v_pk_fma_f32 v[54:55], v[134:135], v[206:207], v[54:55] op_sel_hi:[1,0,1] neg_lo:[0,1,0] neg_hi:[0,1,0]
    v_pk_mul_f32 v[48:49], v[48:49], v[194:195] op_sel_hi:[1,0]
    v_pk_mul_f32 v[50:51], v[50:51], v[194:195] op_sel_hi:[1,0]
    v_pk_mul_f32 v[52:53], v[52:53], v[194:195] op_sel_hi:[1,0]
    v_pk_mul_f32 v[54:55], v[54:55], v[194:195] op_sel_hi:[1,0]
    v_cvt_pk_bf16_f32 v48, v48, v49
    v_cvt_pk_bf16_f32 v49, v50, v51
    v_cvt_pk_bf16_f32 v50, v52, v53
    v_cvt_pk_bf16_f32 v51, v54, v55
    buffer_store_dwordx4 v[48:51], v244, s[20:23], s33 offen offset:0 sc1
    v_pk_fma_f32 v[56:57], v[128:129], v[206:207], v[56:57] op_sel:[0,1,0] op_sel_hi:[1,1,1] neg_lo:[0,1,0] neg_hi:[0,1,0]
    v_pk_fma_f32 v[58:59], v[130:131], v[206:207], v[58:59] op_sel:[0,1,0] op_sel_hi:[1,1,1] neg_lo:[0,1,0] neg_hi:[0,1,0]
    v_pk_fma_f32 v[60:61], v[132:133], v[206:207], v[60:61] op_sel:[0,1,0] op_sel_hi:[1,1,1] neg_lo:[0,1,0] neg_hi:[0,1,0]
    v_pk_fma_f32 v[62:63], v[134:135], v[206:207], v[62:63] op_sel:[0,1,0] op_sel_hi:[1,1,1] neg_lo:[0,1,0] neg_hi:[0,1,0]
    v_pk_mul_f32 v[56:57], v[56:57], v[194:195] op_sel:[0,1] op_sel_hi:[1,1]
    v_pk_mul_f32 v[58:59], v[58:59], v[194:195] op_sel:[0,1] op_sel_hi:[1,1]
    v_pk_mul_f32 v[60:61], v[60:61], v[194:195] op_sel:[0,1] op_sel_hi:[1,1]
    v_pk_mul_f32 v[62:63], v[62:63], v[194:195] op_sel:[0,1] op_sel_hi:[1,1]
    v_cvt_pk_bf16_f32 v56, v56, v57
    v_cvt_pk_bf16_f32 v57, v58, v59
    v_cvt_pk_bf16_f32 v58, v60, v61
    v_cvt_pk_bf16_f32 v59, v62, v63
    buffer_store_dwordx4 v[56:59], v244, s[20:23], s33 offen offset:128 sc1
    s_waitcnt lgkmcnt(0)
    v_pk_fma_f32 v[64:65], v[112:113], v[190:191], v[64:65] op_sel_hi:[1,0,1] neg_lo:[0,1,0] neg_hi:[0,1,0]
    v_pk_fma_f32 v[66:67], v[114:115], v[190:191], v[66:67] op_sel_hi:[1,0,1] neg_lo:[0,1,0] neg_hi:[0,1,0]
    v_pk_fma_f32 v[68:69], v[116:117], v[190:191], v[68:69] op_sel_hi:[1,0,1] neg_lo:[0,1,0] neg_hi:[0,1,0]
    v_pk_fma_f32 v[70:71], v[118:119], v[190:191], v[70:71] op_sel_hi:[1,0,1] neg_lo:[0,1,0] neg_hi:[0,1,0]
    v_pk_mul_f32 v[64:65], v[64:65], v[96:97]
    v_pk_mul_f32 v[66:67], v[66:67], v[98:99]
    v_pk_mul_f32 v[68:69], v[68:69], v[100:101]
    v_pk_mul_f32 v[70:71], v[70:71], v[102:103]
    v_cvt_pk_bf16_f32 v64, v64, v65
    v_cvt_pk_bf16_f32 v65, v66, v67
    v_cvt_pk_bf16_f32 v66, v68, v69
    v_cvt_pk_bf16_f32 v67, v70, v71
    buffer_store_dwordx4 v[64:67], v245, s[20:23], s32 offen offset:2048 sc1
    v_pk_fma_f32 v[80:81], v[112:113], v[190:191], v[80:81] op_sel:[0,1,0] op_sel_hi:[1,1,1] neg_lo:[0,1,0] neg_hi:[0,1,0]
    v_pk_fma_f32 v[82:83], v[114:115], v[190:191], v[82:83] op_sel:[0,1,0] op_sel_hi:[1,1,1] neg_lo:[0,1,0] neg_hi:[0,1,0]
    v_pk_fma_f32 v[84:85], v[116:117], v[190:191], v[84:85] op_sel:[0,1,0] op_sel_hi:[1,1,1] neg_lo:[0,1,0] neg_hi:[0,1,0]
    v_pk_fma_f32 v[86:87], v[118:119], v[190:191], v[86:87] op_sel:[0,1,0] op_sel_hi:[1,1,1] neg_lo:[0,1,0] neg_hi:[0,1,0]
    v_pk_mul_f32 v[80:81], v[80:81], v[96:97]
    v_pk_mul_f32 v[82:83], v[82:83], v[98:99]
    v_pk_mul_f32 v[84:85], v[84:85], v[100:101]
    v_pk_mul_f32 v[86:87], v[86:87], v[102:103]
    v_cvt_pk_bf16_f32 v80, v80, v81
    v_cvt_pk_bf16_f32 v81, v82, v83
    v_cvt_pk_bf16_f32 v82, v84, v85
    v_cvt_pk_bf16_f32 v83, v86, v87
    buffer_store_dwordx4 v[80:83], v245, s[20:23], s32 offen offset:2304 sc1
    v_pk_fma_f32 v[72:73], v[120:121], v[190:191], v[72:73] op_sel_hi:[1,0,1] neg_lo:[0,1,0] neg_hi:[0,1,0]
    v_pk_fma_f32 v[74:75], v[122:123], v[190:191], v[74:75] op_sel_hi:[1,0,1] neg_lo:[0,1,0] neg_hi:[0,1,0]
    v_pk_fma_f32 v[76:77], v[124:125], v[190:191], v[76:77] op_sel_hi:[1,0,1] neg_lo:[0,1,0] neg_hi:[0,1,0]
    v_pk_fma_f32 v[78:79], v[126:127], v[190:191], v[78:79] op_sel_hi:[1,0,1] neg_lo:[0,1,0] neg_hi:[0,1,0]
    v_pk_mul_f32 v[72:73], v[72:73], v[104:105]
    v_pk_mul_f32 v[74:75], v[74:75], v[106:107]
    v_pk_mul_f32 v[76:77], v[76:77], v[108:109]
    v_pk_mul_f32 v[78:79], v[78:79], v[110:111]
    v_cvt_pk_bf16_f32 v72, v72, v73
    v_cvt_pk_bf16_f32 v73, v74, v75
    v_cvt_pk_bf16_f32 v74, v76, v77
    v_cvt_pk_bf16_f32 v75, v78, v79
    buffer_store_dwordx4 v[72:75], v245, s[20:23], s33 offen offset:2048 sc1
    v_pk_fma_f32 v[88:89], v[120:121], v[190:191], v[88:89] op_sel:[0,1,0] op_sel_hi:[1,1,1] neg_lo:[0,1,0] neg_hi:[0,1,0]
    v_pk_fma_f32 v[90:91], v[122:123], v[190:191], v[90:91] op_sel:[0,1,0] op_sel_hi:[1,1,1] neg_lo:[0,1,0] neg_hi:[0,1,0]
    v_pk_fma_f32 v[92:93], v[124:125], v[190:191], v[92:93] op_sel:[0,1,0] op_sel_hi:[1,1,1] neg_lo:[0,1,0] neg_hi:[0,1,0]
    v_pk_fma_f32 v[94:95], v[126:127], v[190:191], v[94:95] op_sel:[0,1,0] op_sel_hi:[1,1,1] neg_lo:[0,1,0] neg_hi:[0,1,0]
    v_pk_mul_f32 v[88:89], v[88:89], v[104:105]
    v_pk_mul_f32 v[90:91], v[90:91], v[106:107]
    v_pk_mul_f32 v[92:93], v[92:93], v[108:109]
    v_pk_mul_f32 v[94:95], v[94:95], v[110:111]
    v_cvt_pk_bf16_f32 v88, v88, v89
    v_cvt_pk_bf16_f32 v89, v90, v91
    v_cvt_pk_bf16_f32 v90, v92, v93
    v_cvt_pk_bf16_f32 v91, v94, v95
    buffer_store_dwordx4 v[88:91], v245, s[20:23], s33 offen offset:2304 sc1
    ds_write_b128 v246, v[32:35] offset:0
    v_mul_f32 v192, 0x3e8293ee, v192
    ds_write_b128 v246, v[40:43] offset:128
    v_mul_f32 v193, 0x3e8293ee, v193
    ds_write_b128 v246, v[48:51] offset:4096
    v_mul_f32 v194, 0x3e8293ee, v194
    ds_write_b128 v246, v[56:59] offset:4224
    v_mul_f32 v195, 0x3e8293ee, v195
    v_pk_fma_f32 v[0:1], v[196:197], v[204:205], v[0:1] op_sel_hi:[1,0,1] neg_lo:[0,1,0] neg_hi:[0,1,0]
    v_pk_fma_f32 v[2:3], v[198:199], v[204:205], v[2:3] op_sel_hi:[1,0,1] neg_lo:[0,1,0] neg_hi:[0,1,0]
    v_pk_fma_f32 v[4:5], v[200:201], v[204:205], v[4:5] op_sel_hi:[1,0,1] neg_lo:[0,1,0] neg_hi:[0,1,0]
    v_pk_fma_f32 v[6:7], v[202:203], v[204:205], v[6:7] op_sel_hi:[1,0,1] neg_lo:[0,1,0] neg_hi:[0,1,0]
    v_pk_mul_f32 v[0:1], v[0:1], v[192:193] op_sel_hi:[1,0]
    v_pk_mul_f32 v[2:3], v[2:3], v[192:193] op_sel_hi:[1,0]
    v_pk_mul_f32 v[4:5], v[4:5], v[192:193] op_sel_hi:[1,0]
    v_pk_mul_f32 v[6:7], v[6:7], v[192:193] op_sel_hi:[1,0]
    v_cvt_pk_bf16_f32 v0, v0, v1
    v_cvt_pk_bf16_f32 v1, v2, v3
    v_cvt_pk_bf16_f32 v2, v4, v5
    v_cvt_pk_bf16_f32 v3, v6, v7
    ds_write_b128 v247, v[64:67] offset:2048
    ds_write_b128 v248, v[0:3] offset:0
    v_pk_fma_f32 v[8:9], v[196:197], v[204:205], v[8:9] op_sel:[0,1,0] op_sel_hi:[1,1,1] neg_lo:[0,1,0] neg_hi:[0,1,0]
    v_pk_fma_f32 v[10:11], v[198:199], v[204:205], v[10:11] op_sel:[0,1,0] op_sel_hi:[1,1,1] neg_lo:[0,1,0] neg_hi:[0,1,0]
    v_pk_fma_f32 v[12:13], v[200:201], v[204:205], v[12:13] op_sel:[0,1,0] op_sel_hi:[1,1,1] neg_lo:[0,1,0] neg_hi:[0,1,0]
    v_pk_fma_f32 v[14:15], v[202:203], v[204:205], v[14:15] op_sel:[0,1,0] op_sel_hi:[1,1,1] neg_lo:[0,1,0] neg_hi:[0,1,0]
    v_pk_mul_f32 v[8:9], v[8:9], v[192:193] op_sel:[0,1] op_sel_hi:[1,1]
    v_pk_mul_f32 v[10:11], v[10:11], v[192:193] op_sel:[0,1] op_sel_hi:[1,1]
    v_pk_mul_f32 v[12:13], v[12:13], v[192:193] op_sel:[0,1] op_sel_hi:[1,1]
    v_pk_mul_f32 v[14:15], v[14:15], v[192:193] op_sel:[0,1] op_sel_hi:[1,1]
    v_cvt_pk_bf16_f32 v8, v8, v9
    v_cvt_pk_bf16_f32 v9, v10, v11
    v_cvt_pk_bf16_f32 v10, v12, v13
    v_cvt_pk_bf16_f32 v11, v14, v15
    ds_write_b128 v247, v[80:83] offset:2304
    ds_write_b128 v248, v[8:11] offset:256
    v_pk_fma_f32 v[16:17], v[196:197], v[206:207], v[16:17] op_sel_hi:[1,0,1] neg_lo:[0,1,0] neg_hi:[0,1,0]
    v_pk_fma_f32 v[18:19], v[198:199], v[206:207], v[18:19] op_sel_hi:[1,0,1] neg_lo:[0,1,0] neg_hi:[0,1,0]
    v_pk_fma_f32 v[20:21], v[200:201], v[206:207], v[20:21] op_sel_hi:[1,0,1] neg_lo:[0,1,0] neg_hi:[0,1,0]
    v_pk_fma_f32 v[22:23], v[202:203], v[206:207], v[22:23] op_sel_hi:[1,0,1] neg_lo:[0,1,0] neg_hi:[0,1,0]
    v_pk_mul_f32 v[16:17], v[16:17], v[194:195] op_sel_hi:[1,0]
    v_pk_mul_f32 v[18:19], v[18:19], v[194:195] op_sel_hi:[1,0]
    v_pk_mul_f32 v[20:21], v[20:21], v[194:195] op_sel_hi:[1,0]
    v_pk_mul_f32 v[22:23], v[22:23], v[194:195] op_sel_hi:[1,0]
    v_cvt_pk_bf16_f32 v16, v16, v17
    v_cvt_pk_bf16_f32 v17, v18, v19
    v_cvt_pk_bf16_f32 v18, v20, v21
    v_cvt_pk_bf16_f32 v19, v22, v23
    ds_write_b128 v247, v[72:75] offset:6144
    ds_write_b128 v248, v[16:19] offset:2048
    v_pk_fma_f32 v[24:25], v[196:197], v[206:207], v[24:25] op_sel:[0,1,0] op_sel_hi:[1,1,1] neg_lo:[0,1,0] neg_hi:[0,1,0]
    v_pk_fma_f32 v[26:27], v[198:199], v[206:207], v[26:27] op_sel:[0,1,0] op_sel_hi:[1,1,1] neg_lo:[0,1,0] neg_hi:[0,1,0]
    v_pk_fma_f32 v[28:29], v[200:201], v[206:207], v[28:29] op_sel:[0,1,0] op_sel_hi:[1,1,1] neg_lo:[0,1,0] neg_hi:[0,1,0]
    v_pk_fma_f32 v[30:31], v[202:203], v[206:207], v[30:31] op_sel:[0,1,0] op_sel_hi:[1,1,1] neg_lo:[0,1,0] neg_hi:[0,1,0]
    v_pk_mul_f32 v[24:25], v[24:25], v[194:195] op_sel:[0,1] op_sel_hi:[1,1]
    v_pk_mul_f32 v[26:27], v[26:27], v[194:195] op_sel:[0,1] op_sel_hi:[1,1]
    v_pk_mul_f32 v[28:29], v[28:29], v[194:195] op_sel:[0,1] op_sel_hi:[1,1]
    v_pk_mul_f32 v[30:31], v[30:31], v[194:195] op_sel:[0,1] op_sel_hi:[1,1]
    v_cvt_pk_bf16_f32 v24, v24, v25
    v_cvt_pk_bf16_f32 v25, v26, v27
    v_cvt_pk_bf16_f32 v26, v28, v29
    v_cvt_pk_bf16_f32 v27, v30, v31
    ds_write_b128 v247, v[88:91] offset:6400
    ds_write_b128 v248, v[24:27] offset:2304
    s_lshl_b32 s30, s25, 8
    s_lshl_b32 s31, s24, 4
    s_add_u32 s30, s30, s31
    s_lshl_b32 s31, s34, 3
    s_add_u32 s30, s30, s31
    s_lshl_b32 s31, s35, 2
    s_add_u32 s30, s30, s31
    s_add_u32 s30, s30, s26
    s_add_u32 s30, s30, 0xdc1000
    v_mov_b32 v154, 0
    s_mov_b64 exec, 1
    s_waitcnt vmcnt(0)
    buffer_store_dword v154, v154, s[20:23], s30 offen sc1
    s_mov_b64 exec, -1
    v_readfirstlane_b32 s73, v250
    v_readfirstlane_b32 s77, v251
    s_lshr_b32 s39, s73, 5
    s_lshl_b32 s34, s24, 2
    s_sub_u32 s39, s39, s34
    s_add_u32 s39, s39, 8
    s_cmp_lt_u32 s39, 12
    s_cselect_b32 s100, 1, 0
    s_cmp_lg_u32 s26, 0
    s_cbranch_scc1 sk_1
    v_permlane32_swap_b32 v208, v210
    v_permlane32_swap_b32 v209, v211
    v_permlane32_swap_b32 v212, v214
    v_permlane32_swap_b32 v213, v215
    v_permlane32_swap_b32 v216, v218
    v_permlane32_swap_b32 v217, v219
    v_permlane32_swap_b32 v220, v222
    v_permlane32_swap_b32 v221, v223
sk_1:
    v_mov_b32 v20, 0xffff
    v_mov_b32 v21, 0xffff0000
    v_cndmask_b32 v22, 0, v20, s[40:41]
    v_cndmask_b32 v23, 0, v21, s[42:43]
    v_or_b32 v12, v22, v23
    v_cndmask_b32 v22, 0, v20, s[44:45]
    v_cndmask_b32 v23, 0, v21, s[46:47]
    v_or_b32 v13, v22, v23
    v_cndmask_b32 v22, 0, v20, s[48:49]
    v_cndmask_b32 v23, 0, v21, s[50:51]
    v_or_b32 v14, v22, v23
    v_cndmask_b32 v22, 0, v20, s[52:53]
    v_cndmask_b32 v23, 0, v21, s[54:55]
    v_or_b32 v15, v22, v23
    v_cndmask_b32 v22, 0, v20, s[56:57]
    v_cndmask_b32 v23, 0, v21, s[58:59]
    v_or_b32 v16, v22, v23
    v_cndmask_b32 v22, 0, v20, s[60:61]
    v_cndmask_b32 v23, 0, v21, s[62:63]
    v_or_b32 v17, v22, v23
    v_cndmask_b32 v22, 0, v20, s[64:65]
    v_cndmask_b32 v23, 0, v21, s[66:67]
    v_or_b32 v18, v22, v23
    v_cndmask_b32 v22, 0, v20, s[68:69]
    v_cndmask_b32 v23, 0, v21, s[70:71]
    v_or_b32 v19, v22, v23
    s_lshl_b32 s34, s28, 12
    s_add_u32 s34, s34, 65536
    v_add_u32 v20, s34, v253
    s_lshl_b32 s34, s3, 11
    s_add_u32 s34, s34, 49152
    v_add_u32 v3, s34, v253
    v_mov_b32 v24, 0
    v_mov_b32 v25, 0
    v_mov_b32 v26, 0
    v_mov_b32 v27, 0
    v_mov_b32 v28, 0
    v_mov_b32 v29, 0
    v_mov_b32 v30, 0
    v_mov_b32 v31, 0
    v_mov_b32 v32, 0
    v_mov_b32 v33, 0
    v_mov_b32 v34, 0
    v_mov_b32 v35, 0
    v_mov_b32 v36, 0
    v_mov_b32 v37, 0
    v_mov_b32 v38, 0
    v_mov_b32 v39, 0
    s_waitcnt lgkmcnt(0)
    s_barrier
    s_cmp_eq_u32 s100, 0
    s_cbranch_scc1 sk_2
    s_barrier
    s_lshr_b32 s34, s73, 5
    s_cmp_lg_u32 s34, s99
    s_cbranch_scc1 sk_3
    s_and_b32 s32, s73, 31
    v_and_b32 v0, 31, v252
    v_cmp_eq_u32 vcc, s32, v0
    v_lshrrev_b32 v0, 5, v252
    v_lshlrev_b32 v0, 4, v0
    s_lshl_b32 s34, s98, 7
    s_add_u32 s34, s34, 0xdc4000
    s_mov_b64 exec, vcc
    buffer_load_dwordx4 v[208:211], v0, s[20:23], s34 offen offset:0 sc1
    buffer_load_dwordx4 v[212:215], v0, s[20:23], s34 offen offset:32 sc1
    buffer_load_dwordx4 v[216:219], v0, s[20:23], s34 offen offset:64 sc1
    buffer_load_dwordx4 v[220:223], v0, s[20:23], s34 offen offset:96 sc1
    v_mov_b32 v240, 1.0
    v_mov_b32 v241, 0
    s_mov_b64 exec, -1
sk_3:
sk_2:
    ds_read_b128 v[4:7], v3
    ds_read_b128 v[8:11], v3 offset:1024
    ds_read_b128 v[104:107], v20 offset:32768
    ds_read_b128 v[108:111], v20 offset:33792
    ds_read_b128 v[112:115], v20 offset:28672
    ds_read_b128 v[116:119], v20 offset:29696
    s_waitcnt lgkmcnt(2)
    v_mfma_f32_32x32x16_bf16 v[40:55], v[104:107], v[4:7], 0
    v_mfma_f32_32x32x16_bf16 v[40:55], v[108:111], v[8:11], v[40:55]
    ds_read_b128 v[104:107], v20 offset:24576
    ds_read_b128 v[108:111], v20 offset:25600
    s_cmp_eq_u32 s99, 0
    s_cbranch_scc0 ng_4
    v_mov_b32 v24, 0xf149f2ca
    v_mov_b32 v25, 0xf149f2ca
    v_mov_b32 v26, 0xf149f2ca
    v_mov_b32 v27, 0xf149f2ca
    v_mov_b32 v28, 0xf149f2ca
    v_mov_b32 v29, 0xf149f2ca
    v_mov_b32 v30, 0xf149f2ca
    v_mov_b32 v31, 0xf149f2ca
    v_mov_b32 v32, 0xf149f2ca
    v_mov_b32 v33, 0xf149f2ca
    v_mov_b32 v34, 0xf149f2ca
    v_mov_b32 v35, 0xf149f2ca
    v_mov_b32 v36, 0xf149f2ca
    v_mov_b32 v37, 0xf149f2ca
    v_mov_b32 v38, 0xf149f2ca
    v_mov_b32 v39, 0xf149f2ca
ng_4:
    s_waitcnt lgkmcnt(2)
    s_nop 0
    v_mfma_f32_32x32x16_bf16 v[72:87], v[112:115], v[4:7], v[24:39]
    v_mfma_f32_32x32x16_bf16 v[72:87], v[116:119], v[8:11], v[72:87]
    ds_read_b128 v[112:115], v20 offset:20480
    ds_read_b128 v[116:119], v20 offset:21504
    s_cmp_eq_u32 s99, 1
    s_cbranch_scc0 ng_5
    s_nop 1
    v_mov_b32 v24, 0xf149f2ca
    v_mov_b32 v25, 0xf149f2ca
    v_mov_b32 v26, 0xf149f2ca
    v_mov_b32 v27, 0xf149f2ca
    v_mov_b32 v28, 0xf149f2ca
    v_mov_b32 v29, 0xf149f2ca
    v_mov_b32 v30, 0xf149f2ca
    v_mov_b32 v31, 0xf149f2ca
    v_mov_b32 v32, 0xf149f2ca
    v_mov_b32 v33, 0xf149f2ca
    v_mov_b32 v34, 0xf149f2ca
    v_mov_b32 v35, 0xf149f2ca
    v_mov_b32 v36, 0xf149f2ca
    v_mov_b32 v37, 0xf149f2ca
    v_mov_b32 v38, 0xf149f2ca
    v_mov_b32 v39, 0xf149f2ca
ng_5:
    s_waitcnt lgkmcnt(2)
    s_nop 0
    v_mfma_f32_32x32x16_bf16 v[56:71], v[104:107], v[4:7], v[24:39]
    v_mfma_f32_32x32x16_bf16 v[56:71], v[108:111], v[8:11], v[56:71]
    s_nop 3
    v_max_f32 v21, v72, v73
    v_max3_f32 v21, v21, v74, v75
    v_max3_f32 v21, v21, v76, v77
    v_max3_f32 v21, v21, v78, v79
    v_max3_f32 v21, v21, v80, v81
    v_max3_f32 v21, v21, v82, v83
    v_max3_f32 v21, v21, v84, v85
    v_max3_f32 v21, v21, v86, v87
    ds_read_b128 v[104:107], v20 offset:16384
    ds_read_b128 v[108:111], v20 offset:17408
    s_cmp_eq_u32 s99, 2
    s_cbranch_scc0 ng_6
    v_mov_b32 v24, 0xf149f2ca
    v_mov_b32 v25, 0xf149f2ca
    v_mov_b32 v26, 0xf149f2ca
    v_mov_b32 v27, 0xf149f2ca
    v_mov_b32 v28, 0xf149f2ca
    v_mov_b32 v29, 0xf149f2ca
    v_mov_b32 v30, 0xf149f2ca
    v_mov_b32 v31, 0xf149f2ca
    v_mov_b32 v32, 0xf149f2ca
    v_mov_b32 v33, 0xf149f2ca
    v_mov_b32 v34, 0xf149f2ca
    v_mov_b32 v35, 0xf149f2ca
    v_mov_b32 v36, 0xf149f2ca
    v_mov_b32 v37, 0xf149f2ca
    v_mov_b32 v38, 0xf149f2ca
    v_mov_b32 v39, 0xf149f2ca
ng_6:
    s_waitcnt lgkmcnt(2)
    s_nop 0
    v_mfma_f32_32x32x16_bf16 v[72:87], v[112:115], v[4:7], v[24:39]
    v_mfma_f32_32x32x16_bf16 v[72:87], v[116:119], v[8:11], v[72:87]
    v_max3_f32 v21, v21, v56, v57
    v_max3_f32 v21, v21, v58, v59
    v_max3_f32 v21, v21, v60, v61
    v_max3_f32 v21, v21, v62, v63
    v_max3_f32 v21, v21, v64, v65
    v_max3_f32 v21, v21, v66, v67
    v_max3_f32 v21, v21, v68, v69
    v_max3_f32 v21, v21, v70, v71
    ds_read_b128 v[112:115], v20 offset:12288
    ds_read_b128 v[116:119], v20 offset:13312
    s_cmp_eq_u32 s99, 3
    s_cbranch_scc0 ng_7
    v_mov_b32 v24, 0xf149f2ca
    v_mov_b32 v25, 0xf149f2ca
    v_mov_b32 v26, 0xf149f2ca
    v_mov_b32 v27, 0xf149f2ca
    v_mov_b32 v28, 0xf149f2ca
    v_mov_b32 v29, 0xf149f2ca
    v_mov_b32 v30, 0xf149f2ca
    v_mov_b32 v31, 0xf149f2ca
    v_mov_b32 v32, 0xf149f2ca
    v_mov_b32 v33, 0xf149f2ca
    v_mov_b32 v34, 0xf149f2ca
    v_mov_b32 v35, 0xf149f2ca
    v_mov_b32 v36, 0xf149f2ca
    v_mov_b32 v37, 0xf149f2ca
    v_mov_b32 v38, 0xf149f2ca
    v_mov_b32 v39, 0xf149f2ca
ng_7:
    s_waitcnt lgkmcnt(2)
    s_nop 0
    v_mfma_f32_32x32x16_bf16 v[56:71], v[104:107], v[4:7], v[24:39]
    v_mfma_f32_32x32x16_bf16 v[56:71], v[108:111], v[8:11], v[56:71]
    v_max3_f32 v21, v21, v72, v73
    v_max3_f32 v21, v21, v74, v75
    v_max3_f32 v21, v21, v76, v77
    v_max3_f32 v21, v21, v78, v79
    v_max3_f32 v21, v21, v80, v81
    v_max3_f32 v21, v21, v82, v83
    v_max3_f32 v21, v21, v84, v85
    v_max3_f32 v21, v21, v86, v87
    ds_read_b128 v[104:107], v20 offset:8192
    ds_read_b128 v[108:111], v20 offset:9216
    s_cmp_eq_u32 s99, 4
    s_cbranch_scc0 ng_8
    v_mov_b32 v24, 0xf149f2ca
    v_mov_b32 v25, 0xf149f2ca
    v_mov_b32 v26, 0xf149f2ca
    v_mov_b32 v27, 0xf149f2ca
    v_mov_b32 v28, 0xf149f2ca
    v_mov_b32 v29, 0xf149f2ca
    v_mov_b32 v30, 0xf149f2ca
    v_mov_b32 v31, 0xf149f2ca
    v_mov_b32 v32, 0xf149f2ca
    v_mov_b32 v33, 0xf149f2ca
    v_mov_b32 v34, 0xf149f2ca
    v_mov_b32 v35, 0xf149f2ca
    v_mov_b32 v36, 0xf149f2ca
    v_mov_b32 v37, 0xf149f2ca
    v_mov_b32 v38, 0xf149f2ca
    v_mov_b32 v39, 0xf149f2ca
ng_8:
    s_waitcnt lgkmcnt(2)
    s_nop 0
    v_mfma_f32_32x32x16_bf16 v[72:87], v[112:115], v[4:7], v[24:39]
    v_mfma_f32_32x32x16_bf16 v[72:87], v[116:119], v[8:11], v[72:87]
    v_max3_f32 v21, v21, v56, v57
    v_max3_f32 v21, v21, v58, v59
    v_max3_f32 v21, v21, v60, v61
    v_max3_f32 v21, v21, v62, v63
    v_max3_f32 v21, v21, v64, v65
    v_max3_f32 v21, v21, v66, v67
    v_max3_f32 v21, v21, v68, v69
    v_max3_f32 v21, v21, v70, v71
    s_barrier
    s_add_u32 s96, s25, 0
    s_and_b32 s96, s96, 15
    s_lshl_b32 s96, s96, 17
    s_add_u32 m0, s101, 0
    s_nop 0
    buffer_load_dwordx4 v243, s[8:11], s96 offen lds
    ds_read_b128 v[112:115], v20 offset:4096
    ds_read_b128 v[116:119], v20 offset:5120
    s_cmp_eq_u32 s99, 5
    s_cbranch_scc0 ng_9
    v_mov_b32 v24, 0xf149f2ca
    v_mov_b32 v25, 0xf149f2ca
    v_mov_b32 v26, 0xf149f2ca
    v_mov_b32 v27, 0xf149f2ca
    v_mov_b32 v28, 0xf149f2ca
    v_mov_b32 v29, 0xf149f2ca
    v_mov_b32 v30, 0xf149f2ca
    v_mov_b32 v31, 0xf149f2ca
    v_mov_b32 v32, 0xf149f2ca
    v_mov_b32 v33, 0xf149f2ca
    v_mov_b32 v34, 0xf149f2ca
    v_mov_b32 v35, 0xf149f2ca
    v_mov_b32 v36, 0xf149f2ca
    v_mov_b32 v37, 0xf149f2ca
    v_mov_b32 v38, 0xf149f2ca
    v_mov_b32 v39, 0xf149f2ca
ng_9:
    s_waitcnt lgkmcnt(2)
    s_nop 0
    v_mfma_f32_32x32x16_bf16 v[56:71], v[104:107], v[4:7], v[24:39]
    v_mfma_f32_32x32x16_bf16 v[56:71], v[108:111], v[8:11], v[56:71]
    v_max3_f32 v21, v21, v72, v73
    v_max3_f32 v21, v21, v74, v75
    v_max3_f32 v21, v21, v76, v77
    v_max3_f32 v21, v21, v78, v79
    v_max3_f32 v21, v21, v80, v81
    v_max3_f32 v21, v21, v82, v83
    v_max3_f32 v21, v21, v84, v85
    v_max3_f32 v21, v21, v86, v87
    s_add_u32 s96, s25, 12
    s_and_b32 s96, s96, 15
    s_lshl_b32 s96, s96, 17
    s_add_u32 m0, s101, 49152
    s_nop 0
    buffer_load_dwordx4 v243, s[8:11], s96 offen lds
    ds_read_b128 v[104:107], v20 offset:0
    ds_read_b128 v[108:111], v20 offset:1024
    s_cmp_eq_u32 s99, 6
    s_cbranch_scc0 ng_10
    v_mov_b32 v24, 0xf149f2ca
    v_mov_b32 v25, 0xf149f2ca
    v_mov_b32 v26, 0xf149f2ca
    v_mov_b32 v27, 0xf149f2ca
    v_mov_b32 v28, 0xf149f2ca
    v_mov_b32 v29, 0xf149f2ca
    v_mov_b32 v30, 0xf149f2ca
    v_mov_b32 v31, 0xf149f2ca
    v_mov_b32 v32, 0xf149f2ca
    v_mov_b32 v33, 0xf149f2ca
    v_mov_b32 v34, 0xf149f2ca
    v_mov_b32 v35, 0xf149f2ca
    v_mov_b32 v36, 0xf149f2ca
    v_mov_b32 v37, 0xf149f2ca
    v_mov_b32 v38, 0xf149f2ca
    v_mov_b32 v39, 0xf149f2ca
ng_10:
    s_waitcnt lgkmcnt(2)
    s_nop 0
    v_mfma_f32_32x32x16_bf16 v[72:87], v[112:115], v[4:7], v[24:39]
    v_mfma_f32_32x32x16_bf16 v[72:87], v[116:119], v[8:11], v[72:87]
    v_max3_f32 v21, v21, v56, v57
    v_max3_f32 v21, v21, v58, v59
    v_max3_f32 v21, v21, v60, v61
    v_max3_f32 v21, v21, v62, v63
    v_max3_f32 v21, v21, v64, v65
    v_max3_f32 v21, v21, v66, v67
    v_max3_f32 v21, v21, v68, v69
    v_max3_f32 v21, v21, v70, v71
    s_add_u32 s96, s25, 13
    s_and_b32 s96, s96, 15
    s_lshl_b32 s96, s96, 17
    s_add_u32 m0, s101, 53248
    s_nop 0
    buffer_load_dwordx4 v243, s[8:11], s96 offen lds
    s_cmp_eq_u32 s99, 7
    s_cbranch_scc0 ng_11
    v_mov_b32 v24, 0xf149f2ca
    v_mov_b32 v25, 0xf149f2ca
    v_mov_b32 v26, 0xf149f2ca
    v_mov_b32 v27, 0xf149f2ca
    v_mov_b32 v28, 0xf149f2ca
    v_mov_b32 v29, 0xf149f2ca
    v_mov_b32 v30, 0xf149f2ca
    v_mov_b32 v31, 0xf149f2ca
    v_mov_b32 v32, 0xf149f2ca
    v_mov_b32 v33, 0xf149f2ca
    v_mov_b32 v34, 0xf149f2ca
    v_mov_b32 v35, 0xf149f2ca
    v_mov_b32 v36, 0xf149f2ca
    v_mov_b32 v37, 0xf149f2ca
    v_mov_b32 v38, 0xf149f2ca
    v_mov_b32 v39, 0xf149f2ca
ng_11:
    s_waitcnt lgkmcnt(0)
    s_nop 0
    v_mfma_f32_32x32x16_bf16 v[56:71], v[104:107], v[4:7], v[24:39]
    v_mfma_f32_32x32x16_bf16 v[56:71], v[108:111], v[8:11], v[56:71]
    v_max3_f32 v21, v21, v72, v73
    v_max3_f32 v21, v21, v74, v75
    v_max3_f32 v21, v21, v76, v77
    v_max3_f32 v21, v21, v78, v79
    v_max3_f32 v21, v21, v80, v81
    v_max3_f32 v21, v21, v82, v83
    v_max3_f32 v21, v21, v84, v85
    v_max3_f32 v21, v21, v86, v87
    s_add_u32 s96, s25, 14
    s_and_b32 s96, s96, 15
    s_lshl_b32 s96, s96, 17
    s_add_u32 m0, s101, 57344
    s_nop 0
    buffer_load_dwordx4 v243, s[8:11], s96 offen lds
    ds_read_b128 v[112:115], v20 offset:28672
    ds_read_b128 v[116:119], v20 offset:29696
    ds_read_b128 v[120:123], v20 offset:34816
    ds_read_b128 v[124:127], v20 offset:35840
    ds_read_b128 v[128:131], v20 offset:2048
    ds_read_b128 v[132:135], v20 offset:3072
    v_cndmask_b32 v40, v56, v40, s[40:41]
    v_cndmask_b32 v41, v57, v41, s[42:43]
    v_cndmask_b32 v42, v58, v42, s[44:45]
    v_cndmask_b32 v43, v59, v43, s[46:47]
    v_cndmask_b32 v44, v60, v44, s[48:49]
    v_cndmask_b32 v45, v61, v45, s[50:51]
    v_cndmask_b32 v46, v62, v46, s[52:53]
    v_cndmask_b32 v47, v63, v47, s[54:55]
    v_cndmask_b32 v48, v64, v48, s[56:57]
    v_cndmask_b32 v49, v65, v49, s[58:59]
    v_cndmask_b32 v50, v66, v50, s[60:61]
    v_cndmask_b32 v51, v67, v51, s[62:63]
    v_cndmask_b32 v52, v68, v52, s[64:65]
    v_cndmask_b32 v53, v69, v53, s[66:67]
    v_cndmask_b32 v54, v70, v54, s[68:69]
    v_cndmask_b32 v55, v71, v55, s[70:71]
    v_max3_f32 v21, v21, v40, v41
    v_max3_f32 v21, v21, v42, v43
    v_max3_f32 v21, v21, v44, v45
    v_max3_f32 v21, v21, v46, v47
    v_max3_f32 v21, v21, v48, v49
    v_max3_f32 v21, v21, v50, v51
    v_max3_f32 v21, v21, v52, v53
    v_max3_f32 v21, v21, v54, v55
    v_mov_b32 v152, v21
    s_nop 1
    v_permlane32_swap_b32 v21, v152
    v_max_f32 v21, v21, v152
    v_sub_f32 v24, 0, v21
    v_sub_f32 v25, 0, v21
    v_sub_f32 v26, 0, v21
    v_sub_f32 v27, 0, v21
    v_sub_f32 v28, 0, v21
    v_sub_f32 v29, 0, v21
    v_sub_f32 v30, 0, v21
    v_sub_f32 v31, 0, v21
    v_sub_f32 v32, 0, v21
    v_sub_f32 v33, 0, v21
    v_sub_f32 v34, 0, v21
    v_sub_f32 v35, 0, v21
    v_sub_f32 v36, 0, v21
    v_sub_f32 v37, 0, v21
    v_sub_f32 v38, 0, v21
    v_sub_f32 v39, 0, v21
    s_cmp_eq_u32 s99, 0
    s_cbranch_scc0 ng_12
    v_mov_b32 v24, 0xf149f2ca
    v_mov_b32 v25, 0xf149f2ca
    v_mov_b32 v26, 0xf149f2ca
    v_mov_b32 v27, 0xf149f2ca
    v_mov_b32 v28, 0xf149f2ca
    v_mov_b32 v29, 0xf149f2ca
    v_mov_b32 v30, 0xf149f2ca
    v_mov_b32 v31, 0xf149f2ca
    v_mov_b32 v32, 0xf149f2ca
    v_mov_b32 v33, 0xf149f2ca
    v_mov_b32 v34, 0xf149f2ca
    v_mov_b32 v35, 0xf149f2ca
    v_mov_b32 v36, 0xf149f2ca
    v_mov_b32 v37, 0xf149f2ca
    v_mov_b32 v38, 0xf149f2ca
    v_mov_b32 v39, 0xf149f2ca
ng_12:
    s_waitcnt lgkmcnt(4)
    s_nop 0
    v_mfma_f32_32x32x16_bf16 v[72:87], v[112:115], v[4:7], v[24:39]
    v_mfma_f32_32x32x16_bf16 v[72:87], v[116:119], v[8:11], v[72:87]
    ds_read_b128 v[104:107], v20 offset:24576
    ds_read_b128 v[108:111], v20 offset:25600
    v_sub_f32 v40, v40, v21
    v_sub_f32 v41, v41, v21
    v_sub_f32 v42, v42, v21
    v_sub_f32 v43, v43, v21
    v_sub_f32 v44, v44, v21
    v_sub_f32 v45, v45, v21
    v_sub_f32 v46, v46, v21
    v_sub_f32 v47, v47, v21
    v_sub_f32 v48, v48, v21
    v_sub_f32 v49, v49, v21
    v_sub_f32 v50, v50, v21
    v_sub_f32 v51, v51, v21
    v_sub_f32 v52, v52, v21
    v_sub_f32 v53, v53, v21
    v_sub_f32 v54, v54, v21
    v_sub_f32 v55, v55, v21
    v_exp_f32 v40, v40
    v_exp_f32 v41, v41
    v_exp_f32 v42, v42
    v_exp_f32 v43, v43
    v_exp_f32 v44, v44
    v_exp_f32 v45, v45
    v_exp_f32 v46, v46
    v_exp_f32 v47, v47
    v_exp_f32 v48, v48
    v_exp_f32 v49, v49
    v_exp_f32 v50, v50
    v_exp_f32 v51, v51
    v_exp_f32 v52, v52
    v_exp_f32 v53, v53
    v_exp_f32 v54, v54
    v_exp_f32 v55, v55
    v_add_f32 v22, v40, v41
    v_add_f32 v23, v42, v43
    v_add_f32 v22, v22, v44
    v_add_f32 v23, v23, v45
    v_add_f32 v22, v22, v46
    v_add_f32 v23, v23, v47
    v_add_f32 v22, v22, v48
    v_add_f32 v23, v23, v49
    v_add_f32 v22, v22, v50
    v_add_f32 v23, v23, v51
    v_add_f32 v22, v22, v52
    v_add_f32 v23, v23, v53
    v_add_f32 v22, v22, v54
    v_add_f32 v23, v23, v55
    v_cvt_pk_bf16_f32 v144, v40, v41
    v_cvt_pk_bf16_f32 v145, v42, v43
    v_cvt_pk_bf16_f32 v146, v44, v45
    v_cvt_pk_bf16_f32 v147, v46, v47
    v_cvt_pk_bf16_f32 v148, v48, v49
    v_cvt_pk_bf16_f32 v149, v50, v51
    v_cvt_pk_bf16_f32 v150, v52, v53
    v_cvt_pk_bf16_f32 v151, v54, v55
    v_and_b32 v136, v144, v12
    v_and_b32 v137, v145, v13
    v_and_b32 v138, v146, v14
    v_and_b32 v139, v147, v15
    v_and_b32 v140, v148, v16
    v_and_b32 v141, v149, v17
    v_and_b32 v142, v150, v18
    v_and_b32 v143, v151, v19
    v_xor_b32 v144, v144, v136
    v_xor_b32 v145, v145, v137
    v_xor_b32 v146, v146, v138
    v_xor_b32 v147, v147, v139
    v_xor_b32 v148, v148, v140
    v_xor_b32 v149, v149, v141
    v_xor_b32 v150, v150, v142
    v_xor_b32 v151, v151, v143
    s_waitcnt lgkmcnt(2)
    v_mfma_f32_32x32x16_bf16 v[88:103], v[120:123], v[136:139], 0
    v_mfma_f32_32x32x16_bf16 v[88:103], v[124:127], v[140:143], v[88:103]
    v_mfma_f32_32x32x16_bf16 v[88:103], v[128:131], v[144:147], v[88:103]
    v_mfma_f32_32x32x16_bf16 v[88:103], v[132:135], v[148:151], v[88:103]
    s_add_u32 s96, s25, 15
    s_and_b32 s96, s96, 15
    s_lshl_b32 s96, s96, 17
    s_add_u32 m0, s101, 61440
    s_nop 0
    buffer_load_dwordx4 v243, s[8:11], s96 offen lds
    ds_read_b128 v[128:131], v20 offset:30720
    ds_read_b128 v[132:135], v20 offset:31744
    s_cmp_eq_u32 s99, 1
    s_cbranch_scc0 ng_13
    v_mov_b32 v24, 0xf149f2ca
    v_mov_b32 v25, 0xf149f2ca
    v_mov_b32 v26, 0xf149f2ca
    v_mov_b32 v27, 0xf149f2ca
    v_mov_b32 v28, 0xf149f2ca
    v_mov_b32 v29, 0xf149f2ca
    v_mov_b32 v30, 0xf149f2ca
    v_mov_b32 v31, 0xf149f2ca
    v_mov_b32 v32, 0xf149f2ca
    v_mov_b32 v33, 0xf149f2ca
    v_mov_b32 v34, 0xf149f2ca
    v_mov_b32 v35, 0xf149f2ca
    v_mov_b32 v36, 0xf149f2ca
    v_mov_b32 v37, 0xf149f2ca
    v_mov_b32 v38, 0xf149f2ca
    v_mov_b32 v39, 0xf149f2ca
ng_13:
    s_waitcnt lgkmcnt(2)
    s_nop 0
    v_mfma_f32_32x32x16_bf16 v[56:71], v[104:107], v[4:7], v[24:39]
    v_mfma_f32_32x32x16_bf16 v[56:71], v[108:111], v[8:11], v[56:71]
    ds_read_b128 v[112:115], v20 offset:20480
    ds_read_b128 v[116:119], v20 offset:21504
    v_exp_f32 v72, v72
    v_exp_f32 v73, v73
    v_exp_f32 v74, v74
    v_exp_f32 v75, v75
    v_exp_f32 v76, v76
    v_exp_f32 v77, v77
    v_exp_f32 v78, v78
    v_exp_f32 v79, v79
    v_exp_f32 v80, v80
    v_exp_f32 v81, v81
    v_exp_f32 v82, v82
    v_exp_f32 v83, v83
    v_exp_f32 v84, v84
    v_exp_f32 v85, v85
    v_exp_f32 v86, v86
    v_exp_f32 v87, v87
    v_add_f32 v22, v22, v72
    v_add_f32 v23, v23, v73
    v_add_f32 v22, v22, v74
    v_add_f32 v23, v23, v75
    v_add_f32 v22, v22, v76
    v_add_f32 v23, v23, v77
    v_add_f32 v22, v22, v78
    v_add_f32 v23, v23, v79
    v_add_f32 v22, v22, v80
    v_add_f32 v23, v23, v81
    v_add_f32 v22, v22, v82
    v_add_f32 v23, v23, v83
    v_add_f32 v22, v22, v84
    v_add_f32 v23, v23, v85
    v_add_f32 v22, v22, v86
    v_add_f32 v23, v23, v87
    v_cvt_pk_bf16_f32 v144, v72, v73
    v_cvt_pk_bf16_f32 v145, v74, v75
    v_cvt_pk_bf16_f32 v146, v76, v77
    v_cvt_pk_bf16_f32 v147, v78, v79
    v_cvt_pk_bf16_f32 v148, v80, v81
    v_cvt_pk_bf16_f32 v149, v82, v83
    v_cvt_pk_bf16_f32 v150, v84, v85
    v_cvt_pk_bf16_f32 v151, v86, v87
    s_waitcnt lgkmcnt(2)
    v_mfma_f32_32x32x16_bf16 v[88:103], v[128:131], v[144:147], v[88:103]
    v_mfma_f32_32x32x16_bf16 v[88:103], v[132:135], v[148:151], v[88:103]
    ds_read_b128 v[120:123], v20 offset:26624
    ds_read_b128 v[124:127], v20 offset:27648
    s_cmp_eq_u32 s99, 2
    s_cbranch_scc0 ng_14
    v_mov_b32 v24, 0xf149f2ca
    v_mov_b32 v25, 0xf149f2ca
    v_mov_b32 v26, 0xf149f2ca
    v_mov_b32 v27, 0xf149f2ca
    v_mov_b32 v28, 0xf149f2ca
    v_mov_b32 v29, 0xf149f2ca
    v_mov_b32 v30, 0xf149f2ca
    v_mov_b32 v31, 0xf149f2ca
    v_mov_b32 v32, 0xf149f2ca
    v_mov_b32 v33, 0xf149f2ca
    v_mov_b32 v34, 0xf149f2ca
    v_mov_b32 v35, 0xf149f2ca
    v_mov_b32 v36, 0xf149f2ca
    v_mov_b32 v37, 0xf149f2ca
    v_mov_b32 v38, 0xf149f2ca
    v_mov_b32 v39, 0xf149f2ca
ng_14:
    s_waitcnt lgkmcnt(2)
    s_nop 0
    v_mfma_f32_32x32x16_bf16 v[72:87], v[112:115], v[4:7], v[24:39]
    v_mfma_f32_32x32x16_bf16 v[72:87], v[116:119], v[8:11], v[72:87]
    ds_read_b128 v[104:107], v20 offset:16384
    ds_read_b128 v[108:111], v20 offset:17408
    v_exp_f32 v56, v56
    v_exp_f32 v57, v57
    v_exp_f32 v58, v58
    v_exp_f32 v59, v59
    v_exp_f32 v60, v60
    v_exp_f32 v61, v61
    v_exp_f32 v62, v62
    v_exp_f32 v63, v63
    v_exp_f32 v64, v64
    v_exp_f32 v65, v65
    v_exp_f32 v66, v66
    v_exp_f32 v67, v67
    v_exp_f32 v68, v68
    v_exp_f32 v69, v69
    v_exp_f32 v70, v70
    v_exp_f32 v71, v71
    v_add_f32 v22, v22, v56
    v_add_f32 v23, v23, v57
    v_add_f32 v22, v22, v58
    v_add_f32 v23, v23, v59
    v_add_f32 v22, v22, v60
    v_add_f32 v23, v23, v61
    v_add_f32 v22, v22, v62
    v_add_f32 v23, v23, v63
    v_add_f32 v22, v22, v64
    v_add_f32 v23, v23, v65
    v_add_f32 v22, v22, v66
    v_add_f32 v23, v23, v67
    v_add_f32 v22, v22, v68
    v_add_f32 v23, v23, v69
    v_add_f32 v22, v22, v70
    v_add_f32 v23, v23, v71
    v_cvt_pk_bf16_f32 v136, v56, v57
    v_cvt_pk_bf16_f32 v137, v58, v59
    v_cvt_pk_bf16_f32 v138, v60, v61
    v_cvt_pk_bf16_f32 v139, v62, v63
    v_cvt_pk_bf16_f32 v140, v64, v65
    v_cvt_pk_bf16_f32 v141, v66, v67
    v_cvt_pk_bf16_f32 v142, v68, v69
    v_cvt_pk_bf16_f32 v143, v70, v71
    s_waitcnt lgkmcnt(2)
    v_mfma_f32_32x32x16_bf16 v[88:103], v[120:123], v[136:139], v[88:103]
    v_mfma_f32_32x32x16_bf16 v[88:103], v[124:127], v[140:143], v[88:103]
    ds_read_b128 v[128:131], v20 offset:22528
    ds_read_b128 v[132:135], v20 offset:23552
    s_cmp_eq_u32 s99, 3
    s_cbranch_scc0 ng_15
    v_mov_b32 v24, 0xf149f2ca
    v_mov_b32 v25, 0xf149f2ca
    v_mov_b32 v26, 0xf149f2ca
    v_mov_b32 v27, 0xf149f2ca
    v_mov_b32 v28, 0xf149f2ca
    v_mov_b32 v29, 0xf149f2ca
    v_mov_b32 v30, 0xf149f2ca
    v_mov_b32 v31, 0xf149f2ca
    v_mov_b32 v32, 0xf149f2ca
    v_mov_b32 v33, 0xf149f2ca
    v_mov_b32 v34, 0xf149f2ca
    v_mov_b32 v35, 0xf149f2ca
    v_mov_b32 v36, 0xf149f2ca
    v_mov_b32 v37, 0xf149f2ca
    v_mov_b32 v38, 0xf149f2ca
    v_mov_b32 v39, 0xf149f2ca
ng_15:
    s_waitcnt lgkmcnt(2)
    s_nop 0
    v_mfma_f32_32x32x16_bf16 v[56:71], v[104:107], v[4:7], v[24:39]
    v_mfma_f32_32x32x16_bf16 v[56:71], v[108:111], v[8:11], v[56:71]
    ds_read_b128 v[112:115], v20 offset:12288
    ds_read_b128 v[116:119], v20 offset:13312
    v_exp_f32 v72, v72
    v_exp_f32 v73, v73
    v_exp_f32 v74, v74
    v_exp_f32 v75, v75
    v_exp_f32 v76, v76
    v_exp_f32 v77, v77
    v_exp_f32 v78, v78
    v_exp_f32 v79, v79
    v_exp_f32 v80, v80
    v_exp_f32 v81, v81
    v_exp_f32 v82, v82
    v_exp_f32 v83, v83
    v_exp_f32 v84, v84
    v_exp_f32 v85, v85
    v_exp_f32 v86, v86
    v_exp_f32 v87, v87
    v_add_f32 v22, v22, v72
    v_add_f32 v23, v23, v73
    v_add_f32 v22, v22, v74
    v_add_f32 v23, v23, v75
    v_add_f32 v22, v22, v76
    v_add_f32 v23, v23, v77
    v_add_f32 v22, v22, v78
    v_add_f32 v23, v23, v79
    v_add_f32 v22, v22, v80
    v_add_f32 v23, v23, v81
    v_add_f32 v22, v22, v82
    v_add_f32 v23, v23, v83
    v_add_f32 v22, v22, v84
    v_add_f32 v23, v23, v85
    v_add_f32 v22, v22, v86
    v_add_f32 v23, v23, v87
    v_cvt_pk_bf16_f32 v144, v72, v73
    v_cvt_pk_bf16_f32 v145, v74, v75
    v_cvt_pk_bf16_f32 v146, v76, v77
    v_cvt_pk_bf16_f32 v147, v78, v79
    v_cvt_pk_bf16_f32 v148, v80, v81
    v_cvt_pk_bf16_f32 v149, v82, v83
    v_cvt_pk_bf16_f32 v150, v84, v85
    v_cvt_pk_bf16_f32 v151, v86, v87
    s_waitcnt lgkmcnt(2)
    v_mfma_f32_32x32x16_bf16 v[88:103], v[128:131], v[144:147], v[88:103]
    v_mfma_f32_32x32x16_bf16 v[88:103], v[132:135], v[148:151], v[88:103]
    ds_read_b128 v[120:123], v20 offset:18432
    ds_read_b128 v[124:127], v20 offset:19456
    s_cmp_eq_u32 s99, 4
    s_cbranch_scc0 ng_16
    v_mov_b32 v24, 0xf149f2ca
    v_mov_b32 v25, 0xf149f2ca
    v_mov_b32 v26, 0xf149f2ca
    v_mov_b32 v27, 0xf149f2ca
    v_mov_b32 v28, 0xf149f2ca
    v_mov_b32 v29, 0xf149f2ca
    v_mov_b32 v30, 0xf149f2ca
    v_mov_b32 v31, 0xf149f2ca
    v_mov_b32 v32, 0xf149f2ca
    v_mov_b32 v33, 0xf149f2ca
    v_mov_b32 v34, 0xf149f2ca
    v_mov_b32 v35, 0xf149f2ca
    v_mov_b32 v36, 0xf149f2ca
    v_mov_b32 v37, 0xf149f2ca
    v_mov_b32 v38, 0xf149f2ca
    v_mov_b32 v39, 0xf149f2ca
ng_16:
    s_waitcnt lgkmcnt(2)
    s_nop 0
    v_mfma_f32_32x32x16_bf16 v[72:87], v[112:115], v[4:7], v[24:39]
    v_mfma_f32_32x32x16_bf16 v[72:87], v[116:119], v[8:11], v[72:87]
    ds_read_b128 v[104:107], v20 offset:8192
    ds_read_b128 v[108:111], v20 offset:9216
    v_exp_f32 v56, v56
    v_exp_f32 v57, v57
    v_exp_f32 v58, v58
    v_exp_f32 v59, v59
    v_exp_f32 v60, v60
    v_exp_f32 v61, v61
    v_exp_f32 v62, v62
    v_exp_f32 v63, v63
    v_exp_f32 v64, v64
    v_exp_f32 v65, v65
    v_exp_f32 v66, v66
    v_exp_f32 v67, v67
    v_exp_f32 v68, v68
    v_exp_f32 v69, v69
    v_exp_f32 v70, v70
    v_exp_f32 v71, v71
    v_add_f32 v22, v22, v56
    v_add_f32 v23, v23, v57
    v_add_f32 v22, v22, v58
    v_add_f32 v23, v23, v59
    v_add_f32 v22, v22, v60
    v_add_f32 v23, v23, v61
    v_add_f32 v22, v22, v62
    v_add_f32 v23, v23, v63
    v_add_f32 v22, v22, v64
    v_add_f32 v23, v23, v65
    v_add_f32 v22, v22, v66
    v_add_f32 v23, v23, v67
    v_add_f32 v22, v22, v68
    v_add_f32 v23, v23, v69
    v_add_f32 v22, v22, v70
    v_add_f32 v23, v23, v71
    v_cvt_pk_bf16_f32 v136, v56, v57
    v_cvt_pk_bf16_f32 v137, v58, v59
    v_cvt_pk_bf16_f32 v138, v60, v61
    v_cvt_pk_bf16_f32 v139, v62, v63
    v_cvt_pk_bf16_f32 v140, v64, v65
    v_cvt_pk_bf16_f32 v141, v66, v67
    v_cvt_pk_bf16_f32 v142, v68, v69
    v_cvt_pk_bf16_f32 v143, v70, v71
    s_waitcnt lgkmcnt(2)
    v_mfma_f32_32x32x16_bf16 v[88:103], v[120:123], v[136:139], v[88:103]
    v_mfma_f32_32x32x16_bf16 v[88:103], v[124:127], v[140:143], v[88:103]
    ds_read_b128 v[128:131], v20 offset:14336
    ds_read_b128 v[132:135], v20 offset:15360
    s_cmp_eq_u32 s99, 5
    s_cbranch_scc0 ng_17
    v_mov_b32 v24, 0xf149f2ca
    v_mov_b32 v25, 0xf149f2ca
    v_mov_b32 v26, 0xf149f2ca
    v_mov_b32 v27, 0xf149f2ca
    v_mov_b32 v28, 0xf149f2ca
    v_mov_b32 v29, 0xf149f2ca
    v_mov_b32 v30, 0xf149f2ca
    v_mov_b32 v31, 0xf149f2ca
    v_mov_b32 v32, 0xf149f2ca
    v_mov_b32 v33, 0xf149f2ca
    v_mov_b32 v34, 0xf149f2ca
    v_mov_b32 v35, 0xf149f2ca
    v_mov_b32 v36, 0xf149f2ca
    v_mov_b32 v37, 0xf149f2ca
    v_mov_b32 v38, 0xf149f2ca
    v_mov_b32 v39, 0xf149f2ca
ng_17:
    s_waitcnt lgkmcnt(2)
    s_nop 0
    v_mfma_f32_32x32x16_bf16 v[56:71], v[104:107], v[4:7], v[24:39]
    v_mfma_f32_32x32x16_bf16 v[56:71], v[108:111], v[8:11], v[56:71]
    ds_read_b128 v[112:115], v20 offset:4096
    ds_read_b128 v[116:119], v20 offset:5120
    v_exp_f32 v72, v72
    v_exp_f32 v73, v73
    v_exp_f32 v74, v74
    v_exp_f32 v75, v75
    v_exp_f32 v76, v76
    v_exp_f32 v77, v77
    v_exp_f32 v78, v78
    v_exp_f32 v79, v79
    v_exp_f32 v80, v80
    v_exp_f32 v81, v81
    v_exp_f32 v82, v82
    v_exp_f32 v83, v83
    v_exp_f32 v84, v84
    v_exp_f32 v85, v85
    v_exp_f32 v86, v86
    v_exp_f32 v87, v87
    v_add_f32 v22, v22, v72
    v_add_f32 v23, v23, v73
    v_add_f32 v22, v22, v74
    v_add_f32 v23, v23, v75
    v_add_f32 v22, v22, v76
    v_add_f32 v23, v23, v77
    v_add_f32 v22, v22, v78
    v_add_f32 v23, v23, v79
    v_add_f32 v22, v22, v80
    v_add_f32 v23, v23, v81
    v_add_f32 v22, v22, v82
    v_add_f32 v23, v23, v83
    v_add_f32 v22, v22, v84
    v_add_f32 v23, v23, v85
    v_add_f32 v22, v22, v86
    v_add_f32 v23, v23, v87
    v_cvt_pk_bf16_f32 v144, v72, v73
    v_cvt_pk_bf16_f32 v145, v74, v75
    v_cvt_pk_bf16_f32 v146, v76, v77
    v_cvt_pk_bf16_f32 v147, v78, v79
    v_cvt_pk_bf16_f32 v148, v80, v81
    v_cvt_pk_bf16_f32 v149, v82, v83
    v_cvt_pk_bf16_f32 v150, v84, v85
    v_cvt_pk_bf16_f32 v151, v86, v87
    s_waitcnt lgkmcnt(2)
    v_mfma_f32_32x32x16_bf16 v[88:103], v[128:131], v[144:147], v[88:103]
    v_mfma_f32_32x32x16_bf16 v[88:103], v[132:135], v[148:151], v[88:103]
    ds_read_b128 v[120:123], v20 offset:10240
    ds_read_b128 v[124:127], v20 offset:11264
    s_cmp_eq_u32 s99, 6
    s_cbranch_scc0 ng_18
    v_mov_b32 v24, 0xf149f2ca
    v_mov_b32 v25, 0xf149f2ca
    v_mov_b32 v26, 0xf149f2ca
    v_mov_b32 v27, 0xf149f2ca
    v_mov_b32 v28, 0xf149f2ca
    v_mov_b32 v29, 0xf149f2ca
    v_mov_b32 v30, 0xf149f2ca
    v_mov_b32 v31, 0xf149f2ca
    v_mov_b32 v32, 0xf149f2ca
    v_mov_b32 v33, 0xf149f2ca
    v_mov_b32 v34, 0xf149f2ca
    v_mov_b32 v35, 0xf149f2ca
    v_mov_b32 v36, 0xf149f2ca
    v_mov_b32 v37, 0xf149f2ca
    v_mov_b32 v38, 0xf149f2ca
    v_mov_b32 v39, 0xf149f2ca
ng_18:
    s_waitcnt lgkmcnt(2)
    s_nop 0
    v_mfma_f32_32x32x16_bf16 v[72:87], v[112:115], v[4:7], v[24:39]
    v_mfma_f32_32x32x16_bf16 v[72:87], v[116:119], v[8:11], v[72:87]
    v_exp_f32 v56, v56
    v_exp_f32 v57, v57
    v_exp_f32 v58, v58
    v_exp_f32 v59, v59
    v_exp_f32 v60, v60
    v_exp_f32 v61, v61
    v_exp_f32 v62, v62
    v_exp_f32 v63, v63
    v_exp_f32 v64, v64
    v_exp_f32 v65, v65
    v_exp_f32 v66, v66
    v_exp_f32 v67, v67
    v_exp_f32 v68, v68
    v_exp_f32 v69, v69
    v_exp_f32 v70, v70
    v_exp_f32 v71, v71
    v_add_f32 v22, v22, v56
    v_add_f32 v23, v23, v57
    v_add_f32 v22, v22, v58
    v_add_f32 v23, v23, v59
    v_add_f32 v22, v22, v60
    v_add_f32 v23, v23, v61
    v_add_f32 v22, v22, v62
    v_add_f32 v23, v23, v63
    v_add_f32 v22, v22, v64
    v_add_f32 v23, v23, v65
    v_add_f32 v22, v22, v66
    v_add_f32 v23, v23, v67
    v_add_f32 v22, v22, v68
    v_add_f32 v23, v23, v69
    v_add_f32 v22, v22, v70
    v_add_f32 v23, v23, v71
    v_cvt_pk_bf16_f32 v136, v56, v57
    v_cvt_pk_bf16_f32 v137, v58, v59
    v_cvt_pk_bf16_f32 v138, v60, v61
    v_cvt_pk_bf16_f32 v139, v62, v63
    v_cvt_pk_bf16_f32 v140, v64, v65
    v_cvt_pk_bf16_f32 v141, v66, v67
    v_cvt_pk_bf16_f32 v142, v68, v69
    v_cvt_pk_bf16_f32 v143, v70, v71
    s_waitcnt lgkmcnt(0)
    v_mfma_f32_32x32x16_bf16 v[88:103], v[120:123], v[136:139], v[88:103]
    v_mfma_f32_32x32x16_bf16 v[88:103], v[124:127], v[140:143], v[88:103]
    ds_read_b128 v[128:131], v20 offset:6144
    ds_read_b128 v[132:135], v20 offset:7168
    v_exp_f32 v72, v72
    v_exp_f32 v73, v73
    v_exp_f32 v74, v74
    v_exp_f32 v75, v75
    v_exp_f32 v76, v76
    v_exp_f32 v77, v77
    v_exp_f32 v78, v78
    v_exp_f32 v79, v79
    v_exp_f32 v80, v80
    v_exp_f32 v81, v81
    v_exp_f32 v82, v82
    v_exp_f32 v83, v83
    v_exp_f32 v84, v84
    v_exp_f32 v85, v85
    v_exp_f32 v86, v86
    v_exp_f32 v87, v87
    v_add_f32 v22, v22, v72
    v_add_f32 v23, v23, v73
    v_add_f32 v22, v22, v74
    v_add_f32 v23, v23, v75
    v_add_f32 v22, v22, v76
    v_add_f32 v23, v23, v77
    v_add_f32 v22, v22, v78
    v_add_f32 v23, v23, v79
    v_add_f32 v22, v22, v80
    v_add_f32 v23, v23, v81
    v_add_f32 v22, v22, v82
    v_add_f32 v23, v23, v83
    v_add_f32 v22, v22, v84
    v_add_f32 v23, v23, v85
    v_add_f32 v22, v22, v86
    v_add_f32 v23, v23, v87
    v_cvt_pk_bf16_f32 v144, v72, v73
    v_cvt_pk_bf16_f32 v145, v74, v75
    v_cvt_pk_bf16_f32 v146, v76, v77
    v_cvt_pk_bf16_f32 v147, v78, v79
    v_cvt_pk_bf16_f32 v148, v80, v81
    v_cvt_pk_bf16_f32 v149, v82, v83
    v_cvt_pk_bf16_f32 v150, v84, v85
    v_cvt_pk_bf16_f32 v151, v86, v87
    s_waitcnt lgkmcnt(0)
    v_mfma_f32_32x32x16_bf16 v[88:103], v[128:131], v[144:147], v[88:103]
    v_mfma_f32_32x32x16_bf16 v[88:103], v[132:135], v[148:151], v[88:103]
    v_add_f32 v22, v22, v23
    v_mov_b32 v152, v22
    s_nop 1
    v_permlane32_swap_b32 v22, v152
    v_add_f32 v22, v22, v152
    v_rcp_f32 v22, v22
    s_lshl_b32 s36, s99, 16
    s_add_u32 s36, s36, s26
    s_add_u32 s36, s36, 0x800000
    s_lshl_b32 s33, s25, 11
    s_add_u32 s33, s33, s36
    s_lshl_b32 s30, s24, 9
    s_lshl_b32 s31, s3, 6
    s_add_u32 s30, s30, s31
    s_add_u32 s30, s30, s26
    s_add_u32 s30, s30, 0xdc2000
    s_lshl_b32 s31, s25, 2
    s_add_u32 s31, s31, s30
    v_pk_mul_f32 v[88:89], v[88:89], v[22:23] op_sel_hi:[1,0]
    v_pk_mul_f32 v[90:91], v[90:91], v[22:23] op_sel_hi:[1,0]
    v_pk_mul_f32 v[92:93], v[92:93], v[22:23] op_sel_hi:[1,0]
    v_pk_mul_f32 v[94:95], v[94:95], v[22:23] op_sel_hi:[1,0]
    v_pk_mul_f32 v[96:97], v[96:97], v[22:23] op_sel_hi:[1,0]
    v_pk_mul_f32 v[98:99], v[98:99], v[22:23] op_sel_hi:[1,0]
    v_pk_mul_f32 v[100:101], v[100:101], v[22:23] op_sel_hi:[1,0]
    v_pk_mul_f32 v[102:103], v[102:103], v[22:23] op_sel_hi:[1,0]
    v_cvt_pk_bf16_f32 v88, v88, v89
    v_cvt_pk_bf16_f32 v89, v90, v91
    v_cvt_pk_bf16_f32 v90, v92, v93
    v_cvt_pk_bf16_f32 v91, v94, v95
    v_cvt_pk_bf16_f32 v92, v96, v97
    v_cvt_pk_bf16_f32 v93, v98, v99
    v_cvt_pk_bf16_f32 v94, v100, v101
    v_cvt_pk_bf16_f32 v95, v102, v103
    s_cmp_lg_u32 s77, 0
    s_cbranch_scc1 lc_19
    buffer_store_dwordx4 v[88:91], v253, s[20:23], s33 offen sc1
    buffer_store_dwordx4 v[92:95], v253, s[20:23], s33 offen offset:1024 sc1
    s_branch lc_20
lc_19:
    buffer_store_dwordx4 v[88:91], v253, s[20:23], s33 offen
    buffer_store_dwordx4 v[92:95], v253, s[20:23], s33 offen offset:1024
lc_20:
    v_bfe_u32 v33, v252, 2, 2
    v_lshrrev_b32 v32, 5, v252
    v_lshl_add_u32 v34, v32, 3, v33
    v_lshlrev_b32 v34, 7, v34
    v_lshrrev_b32 v33, 1, v33
    v_lshl_add_u32 v34, v33, 6, v34
    v_bfe_u32 v33, v252, 4, 1
    v_lshl_add_u32 v34, v33, 5, v34
    v_and_b32 v33, 3, v252
    v_lshl_add_u32 v56, v33, 3, v34
    v_xor_b32 v57, 64, v56
    v_add_u32 v58, 0x10000, v56
    v_add_u32 v59, 0x10000, v57
    v_and_b32 v60, 15, v252
    v_lshlrev_b32 v60, 2, v60
    s_waitcnt vmcnt(2)
    v_lshlrev_b32 v0, 16, v208
    v_and_b32 v1, 0xffff0000, v208
    v_lshlrev_b32 v2, 16, v209
    v_and_b32 v3, 0xffff0000, v209
    v_lshlrev_b32 v4, 16, v210
    v_and_b32 v5, 0xffff0000, v210
    v_lshlrev_b32 v6, 16, v211
    v_and_b32 v7, 0xffff0000, v211
    v_lshlrev_b32 v8, 16, v212
    v_and_b32 v9, 0xffff0000, v212
    v_lshlrev_b32 v10, 16, v213
    v_and_b32 v11, 0xffff0000, v213
    v_lshlrev_b32 v12, 16, v214
    v_and_b32 v13, 0xffff0000, v214
    v_lshlrev_b32 v14, 16, v215
    v_and_b32 v15, 0xffff0000, v215
    v_lshlrev_b32 v16, 16, v216
    v_and_b32 v17, 0xffff0000, v216
    v_lshlrev_b32 v18, 16, v217
    v_and_b32 v19, 0xffff0000, v217
    v_lshlrev_b32 v20, 16, v218
    v_and_b32 v21, 0xffff0000, v218
    v_lshlrev_b32 v22, 16, v219
    v_and_b32 v23, 0xffff0000, v219
    v_lshlrev_b32 v24, 16, v220
    v_and_b32 v25, 0xffff0000, v220
    v_lshlrev_b32 v26, 16, v221
    v_and_b32 v27, 0xffff0000, v221
    v_lshlrev_b32 v28, 16, v222
    v_and_b32 v29, 0xffff0000, v222
    v_lshlrev_b32 v30, 16, v223
    v_and_b32 v31, 0xffff0000, v223
    v_pk_fma_f32 v[0:1], v[0:1], v[240:241], v[240:241] op_sel:[0,0,1] op_sel_hi:[1,0,1]
    v_pk_fma_f32 v[2:3], v[2:3], v[240:241], v[240:241] op_sel:[0,0,1] op_sel_hi:[1,0,1]
    v_pk_fma_f32 v[4:5], v[4:5], v[240:241], v[240:241] op_sel:[0,0,1] op_sel_hi:[1,0,1]
    v_pk_fma_f32 v[6:7], v[6:7], v[240:241], v[240:241] op_sel:[0,0,1] op_sel_hi:[1,0,1]
    v_pk_fma_f32 v[8:9], v[8:9], v[240:241], v[240:241] op_sel:[0,0,1] op_sel_hi:[1,0,1]
    v_pk_fma_f32 v[10:11], v[10:11], v[240:241], v[240:241] op_sel:[0,0,1] op_sel_hi:[1,0,1]
    v_pk_fma_f32 v[12:13], v[12:13], v[240:241], v[240:241] op_sel:[0,0,1] op_sel_hi:[1,0,1]
    v_pk_fma_f32 v[14:15], v[14:15], v[240:241], v[240:241] op_sel:[0,0,1] op_sel_hi:[1,0,1]
    v_pk_fma_f32 v[16:17], v[16:17], v[240:241], v[240:241] op_sel:[0,0,1] op_sel_hi:[1,0,1]
    v_pk_fma_f32 v[18:19], v[18:19], v[240:241], v[240:241] op_sel:[0,0,1] op_sel_hi:[1,0,1]
    v_pk_fma_f32 v[20:21], v[20:21], v[240:241], v[240:241] op_sel:[0,0,1] op_sel_hi:[1,0,1]
    v_pk_fma_f32 v[22:23], v[22:23], v[240:241], v[240:241] op_sel:[0,0,1] op_sel_hi:[1,0,1]
    v_pk_fma_f32 v[24:25], v[24:25], v[240:241], v[240:241] op_sel:[0,0,1] op_sel_hi:[1,0,1]
    v_pk_fma_f32 v[26:27], v[26:27], v[240:241], v[240:241] op_sel:[0,0,1] op_sel_hi:[1,0,1]
    v_pk_fma_f32 v[28:29], v[28:29], v[240:241], v[240:241] op_sel:[0,0,1] op_sel_hi:[1,0,1]
    v_pk_fma_f32 v[30:31], v[30:31], v[240:241], v[240:241] op_sel:[0,0,1] op_sel_hi:[1,0,1]
    v_mov_b32 v154, 0
    s_mov_b64 exec, 1
    s_waitcnt vmcnt(0)
    s_cmp_lg_u32 s77, 0
    s_cbranch_scc1 lc_21
    buffer_store_dword v154, v154, s[20:23], s31 offen sc1
    s_branch lc_22
lc_21:
    buffer_store_dword v154, v154, s[20:23], s31 offen
lc_22:
    s_mov_b64 exec, -1
    s_barrier
    s_add_u32 s96, s25, 0
    s_and_b32 s96, s96, 15
    s_lshl_b32 s96, s96, 17
    s_add_u32 s96, s96, 65536
    s_add_u32 m0, s101, 65536
    s_nop 0
    buffer_load_dwordx4 v243, s[8:11], s96 offen lds
    s_add_u32 s96, s25, 1
    s_and_b32 s96, s96, 15
    s_lshl_b32 s96, s96, 17
    s_add_u32 s96, s96, 65536
    s_add_u32 m0, s101, 69632
    s_nop 0
    buffer_load_dwordx4 v243, s[8:11], s96 offen lds
    s_add_u32 s96, s25, 2
    s_and_b32 s96, s96, 15
    s_lshl_b32 s96, s96, 17
    s_add_u32 s96, s96, 65536
    s_add_u32 m0, s101, 73728
    s_nop 0
    buffer_load_dwordx4 v243, s[8:11], s96 offen lds
    s_add_u32 s96, s25, 3
    s_and_b32 s96, s96, 15
    s_lshl_b32 s96, s96, 17
    s_add_u32 s96, s96, 65536
    s_add_u32 m0, s101, 77824
    s_nop 0
    buffer_load_dwordx4 v243, s[8:11], s96 offen lds
    s_add_u32 s96, s25, 4
    s_and_b32 s96, s96, 15
    s_lshl_b32 s96, s96, 17
    s_add_u32 s96, s96, 65536
    s_add_u32 m0, s101, 81920
    s_nop 0
    buffer_load_dwordx4 v243, s[8:11], s96 offen lds
    s_add_u32 s96, s25, 5
    s_and_b32 s96, s96, 15
    s_lshl_b32 s96, s96, 17
    s_add_u32 s96, s96, 65536
    s_add_u32 m0, s101, 86016
    s_nop 0
    buffer_load_dwordx4 v243, s[8:11], s96 offen lds
    s_add_u32 s96, s25, 6
    s_and_b32 s96, s96, 15
    s_lshl_b32 s96, s96, 17
    s_add_u32 s96, s96, 65536
    s_add_u32 m0, s101, 90112
    s_nop 0
    buffer_load_dwordx4 v243, s[8:11], s96 offen lds
    s_add_u32 s96, s25, 7
    s_and_b32 s96, s96, 15
    s_lshl_b32 s96, s96, 17
    s_add_u32 s96, s96, 65536
    s_add_u32 m0, s101, 94208
    s_nop 0
    buffer_load_dwordx4 v243, s[8:11], s96 offen lds
    s_add_u32 s96, s25, 8
    s_and_b32 s96, s96, 15
    s_lshl_b32 s96, s96, 17
    s_add_u32 s96, s96, 65536
    s_add_u32 m0, s101, 98304
    s_nop 0
    buffer_load_dwordx4 v243, s[8:11], s96 offen lds
    s_add_u32 s96, s25, 9
    s_and_b32 s96, s96, 15
    s_lshl_b32 s96, s96, 17
    s_add_u32 s96, s96, 65536
    s_add_u32 m0, s101, 102400
    s_nop 0
    buffer_load_dwordx4 v243, s[8:11], s96 offen lds
    s_add_u32 s96, s25, 10
    s_and_b32 s96, s96, 15
    s_lshl_b32 s96, s96, 17
    s_add_u32 s96, s96, 65536
    s_add_u32 m0, s101, 106496
    s_nop 0
    buffer_load_dwordx4 v243, s[8:11], s96 offen lds
    s_add_u32 s96, s25, 11
    s_and_b32 s96, s96, 15
    s_lshl_b32 s96, s96, 17
    s_add_u32 s96, s96, 65536
    s_add_u32 m0, s101, 110592
    s_nop 0
    buffer_load_dwordx4 v243, s[8:11], s96 offen lds
    v_bfe_u32 v100, v252, 4, 1
    v_lshlrev_b32 v100, 11, v100
    v_lshrrev_b32 v101, 5, v252
    v_lshl_add_u32 v100, v101, 8, v100
    v_and_b32 v101, 15, v252
    v_lshl_add_u32 v100, v101, 4, v100
    s_lshl_b32 s34, s28, 12
    s_add_u32 s34, s34, 147456
    v_add_u32 v101, s34, v100
    s_lshl_b32 s37, s25, 11
    ds_read_b64_tr_b16 v[32:33], v56 offset:0
    ds_read_b64_tr_b16 v[34:35], v56 offset:512
    ds_read_b64_tr_b16 v[36:37], v57 offset:0
    ds_read_b64_tr_b16 v[38:39], v57 offset:512
    ds_read_b64_tr_b16 v[40:41], v56 offset:2048
    ds_read_b64_tr_b16 v[42:43], v56 offset:2560
    ds_read_b64_tr_b16 v[44:45], v57 offset:2048
    ds_read_b64_tr_b16 v[46:47], v57 offset:2560
    s_mov_b32 s78, s27
pl_23:
    buffer_load_dword v61, v60, s[20:23], s30 offen offset:0 sc1
    s_waitcnt vmcnt(0)
pc_24:
    v_cmp_eq_u32 vcc, -1, v61
    s_cbranch_vccz pd_25
    s_sub_u32 s78, s78, 1
    s_cmp_lg_u32 s78, 0
    s_cbranch_scc1 pl_23
    s_mov_b32 s27, 1
pd_25:
    s_add_u32 s38, s36, s37
    buffer_load_dwordx4 v[104:107], v253, s[20:23], s38 offen offset:0 sc1
    s_add_u32 s37, s37, 2048
    s_and_b32 s37, s37, 0x7800
    buffer_load_dwordx4 v[108:111], v253, s[20:23], s38 offen offset:1024 sc1
    s_add_u32 s38, s36, s37
    buffer_load_dwordx4 v[112:115], v253, s[20:23], s38 offen offset:0 sc1
    s_add_u32 s37, s37, 2048
    s_and_b32 s37, s37, 0x7800
    buffer_load_dwordx4 v[116:119], v253, s[20:23], s38 offen offset:1024 sc1
    s_add_u32 s38, s36, s37
    buffer_load_dwordx4 v[120:123], v253, s[20:23], s38 offen offset:0 sc1
    s_add_u32 s37, s37, 2048
    s_and_b32 s37, s37, 0x7800
    buffer_load_dwordx4 v[124:127], v253, s[20:23], s38 offen offset:1024 sc1
    s_add_u32 s38, s36, s37
    buffer_load_dwordx4 v[128:131], v253, s[20:23], s38 offen offset:0 sc1
    s_add_u32 s37, s37, 2048
    s_and_b32 s37, s37, 0x7800
    buffer_load_dwordx4 v[132:135], v253, s[20:23], s38 offen offset:1024 sc1
    s_waitcnt vmcnt(7) lgkmcnt(4)
    v_mfma_f32_32x32x16_bf16 v[0:15], v[32:35], v[104:107], v[0:15]
    s_add_u32 s38, s36, s37
    buffer_load_dwordx4 v[136:139], v253, s[20:23], s38 offen offset:0 sc1
    ds_read_b64_tr_b16 v[48:49], v56 offset:4096
    ds_read_b64_tr_b16 v[50:51], v56 offset:4608
    v_mfma_f32_32x32x16_bf16 v[16:31], v[36:39], v[104:107], v[16:31]
    ds_read_b64_tr_b16 v[52:53], v57 offset:4096
    ds_read_b64_tr_b16 v[54:55], v57 offset:4608
    s_waitcnt vmcnt(7) lgkmcnt(4)
    v_mfma_f32_32x32x16_bf16 v[0:15], v[40:43], v[108:111], v[0:15]
    s_add_u32 s37, s37, 2048
    s_and_b32 s37, s37, 0x7800
    buffer_load_dwordx4 v[104:107], v253, s[20:23], s38 offen offset:1024 sc1
    ds_read_b64_tr_b16 v[32:33], v56 offset:6144
    ds_read_b64_tr_b16 v[34:35], v56 offset:6656
    v_mfma_f32_32x32x16_bf16 v[16:31], v[44:47], v[108:111], v[16:31]
    ds_read_b64_tr_b16 v[36:37], v57 offset:6144
    ds_read_b64_tr_b16 v[38:39], v57 offset:6656
    s_waitcnt vmcnt(7) lgkmcnt(4)
    v_mfma_f32_32x32x16_bf16 v[0:15], v[48:51], v[112:115], v[0:15]
    s_add_u32 s38, s36, s37
    buffer_load_dwordx4 v[108:111], v253, s[20:23], s38 offen offset:0 sc1
    ds_read_b64_tr_b16 v[40:41], v56 offset:8192
    ds_read_b64_tr_b16 v[42:43], v56 offset:8704
    v_mfma_f32_32x32x16_bf16 v[16:31], v[52:55], v[112:115], v[16:31]
    ds_read_b64_tr_b16 v[44:45], v57 offset:8192
    ds_read_b64_tr_b16 v[46:47], v57 offset:8704
    s_waitcnt vmcnt(7) lgkmcnt(4)
    v_mfma_f32_32x32x16_bf16 v[0:15], v[32:35], v[116:119], v[0:15]
    s_add_u32 s37, s37, 2048
    s_and_b32 s37, s37, 0x7800
    buffer_load_dwordx4 v[112:115], v253, s[20:23], s38 offen offset:1024 sc1
    ds_read_b64_tr_b16 v[48:49], v56 offset:10240
    ds_read_b64_tr_b16 v[50:51], v56 offset:10752
    v_mfma_f32_32x32x16_bf16 v[16:31], v[36:39], v[116:119], v[16:31]
    ds_read_b64_tr_b16 v[52:53], v57 offset:10240
    ds_read_b64_tr_b16 v[54:55], v57 offset:10752
    s_waitcnt vmcnt(7) lgkmcnt(4)
    v_mfma_f32_32x32x16_bf16 v[0:15], v[40:43], v[120:123], v[0:15]
    s_add_u32 s38, s36, s37
    buffer_load_dwordx4 v[116:119], v253, s[20:23], s38 offen offset:0 sc1
    ds_read_b64_tr_b16 v[32:33], v56 offset:12288
    ds_read_b64_tr_b16 v[34:35], v56 offset:12800
    v_mfma_f32_32x32x16_bf16 v[16:31], v[44:47], v[120:123], v[16:31]
    ds_read_b64_tr_b16 v[36:37], v57 offset:12288
    ds_read_b64_tr_b16 v[38:39], v57 offset:12800
    s_waitcnt vmcnt(7) lgkmcnt(4)
    v_mfma_f32_32x32x16_bf16 v[0:15], v[48:51], v[124:127], v[0:15]
    s_add_u32 s37, s37, 2048
    s_and_b32 s37, s37, 0x7800
    buffer_load_dwordx4 v[120:123], v253, s[20:23], s38 offen offset:1024 sc1
    ds_read_b64_tr_b16 v[40:41], v56 offset:14336
    ds_read_b64_tr_b16 v[42:43], v56 offset:14848
    v_mfma_f32_32x32x16_bf16 v[16:31], v[52:55], v[124:127], v[16:31]
    ds_read_b64_tr_b16 v[44:45], v57 offset:14336
    ds_read_b64_tr_b16 v[46:47], v57 offset:14848
    s_waitcnt vmcnt(7) lgkmcnt(4)
    v_mfma_f32_32x32x16_bf16 v[0:15], v[32:35], v[128:131], v[0:15]
    s_add_u32 s38, s36, s37
    buffer_load_dwordx4 v[124:127], v253, s[20:23], s38 offen offset:0 sc1
    ds_read_b64_tr_b16 v[48:49], v56 offset:16384
    ds_read_b64_tr_b16 v[50:51], v56 offset:16896
    v_mfma_f32_32x32x16_bf16 v[16:31], v[36:39], v[128:131], v[16:31]
    ds_read_b64_tr_b16 v[52:53], v57 offset:16384
    ds_read_b64_tr_b16 v[54:55], v57 offset:16896
    s_waitcnt vmcnt(7) lgkmcnt(4)
    v_mfma_f32_32x32x16_bf16 v[0:15], v[40:43], v[132:135], v[0:15]
    s_add_u32 s37, s37, 2048
    s_and_b32 s37, s37, 0x7800
    buffer_load_dwordx4 v[128:131], v253, s[20:23], s38 offen offset:1024 sc1
    ds_read_b64_tr_b16 v[32:33], v56 offset:18432
    ds_read_b64_tr_b16 v[34:35], v56 offset:18944
    v_mfma_f32_32x32x16_bf16 v[16:31], v[44:47], v[132:135], v[16:31]
    ds_read_b64_tr_b16 v[36:37], v57 offset:18432
    ds_read_b64_tr_b16 v[38:39], v57 offset:18944
    s_waitcnt vmcnt(7) lgkmcnt(4)
    v_mfma_f32_32x32x16_bf16 v[0:15], v[48:51], v[136:139], v[0:15]
    s_add_u32 s38, s36, s37
    buffer_load_dwordx4 v[132:135], v253, s[20:23], s38 offen offset:0 sc1
    ds_read_b64_tr_b16 v[40:41], v56 offset:20480
    ds_read_b64_tr_b16 v[42:43], v56 offset:20992
    v_mfma_f32_32x32x16_bf16 v[16:31], v[52:55], v[136:139], v[16:31]
    ds_read_b64_tr_b16 v[44:45], v57 offset:20480
    ds_read_b64_tr_b16 v[46:47], v57 offset:20992
    s_waitcnt vmcnt(7) lgkmcnt(4)
    v_mfma_f32_32x32x16_bf16 v[0:15], v[32:35], v[104:107], v[0:15]
    s_add_u32 s37, s37, 2048
    s_and_b32 s37, s37, 0x7800
    buffer_load_dwordx4 v[136:139], v253, s[20:23], s38 offen offset:1024 sc1
    ds_read_b64_tr_b16 v[48:49], v56 offset:22528
    ds_read_b64_tr_b16 v[50:51], v56 offset:23040
    v_mfma_f32_32x32x16_bf16 v[16:31], v[36:39], v[104:107], v[16:31]
    ds_read_b64_tr_b16 v[52:53], v57 offset:22528
    ds_read_b64_tr_b16 v[54:55], v57 offset:23040
    s_waitcnt vmcnt(7) lgkmcnt(4)
    v_mfma_f32_32x32x16_bf16 v[0:15], v[40:43], v[108:111], v[0:15]
    s_add_u32 s38, s36, s37
    buffer_load_dwordx4 v[104:107], v253, s[20:23], s38 offen offset:0 sc1
    ds_read_b64_tr_b16 v[32:33], v56 offset:24576
    ds_read_b64_tr_b16 v[34:35], v56 offset:25088
    v_mfma_f32_32x32x16_bf16 v[16:31], v[44:47], v[108:111], v[16:31]
    ds_read_b64_tr_b16 v[36:37], v57 offset:24576
    ds_read_b64_tr_b16 v[38:39], v57 offset:25088
    s_waitcnt vmcnt(7) lgkmcnt(4)
    v_mfma_f32_32x32x16_bf16 v[0:15], v[48:51], v[112:115], v[0:15]
    s_add_u32 s37, s37, 2048
    s_and_b32 s37, s37, 0x7800
    buffer_load_dwordx4 v[108:111], v253, s[20:23], s38 offen offset:1024 sc1
    ds_read_b64_tr_b16 v[40:41], v56 offset:26624
    ds_read_b64_tr_b16 v[42:43], v56 offset:27136
    v_mfma_f32_32x32x16_bf16 v[16:31], v[52:55], v[112:115], v[16:31]
    ds_read_b64_tr_b16 v[44:45], v57 offset:26624
    ds_read_b64_tr_b16 v[46:47], v57 offset:27136
    s_waitcnt vmcnt(7) lgkmcnt(4)
    v_mfma_f32_32x32x16_bf16 v[0:15], v[32:35], v[116:119], v[0:15]
    s_add_u32 s38, s36, s37
    buffer_load_dwordx4 v[112:115], v253, s[20:23], s38 offen offset:0 sc1
    ds_read_b64_tr_b16 v[48:49], v56 offset:28672
    ds_read_b64_tr_b16 v[50:51], v56 offset:29184
    v_mfma_f32_32x32x16_bf16 v[16:31], v[36:39], v[116:119], v[16:31]
    ds_read_b64_tr_b16 v[52:53], v57 offset:28672
    ds_read_b64_tr_b16 v[54:55], v57 offset:29184
    s_waitcnt vmcnt(7) lgkmcnt(4)
    v_mfma_f32_32x32x16_bf16 v[0:15], v[40:43], v[120:123], v[0:15]
    s_add_u32 s37, s37, 2048
    s_and_b32 s37, s37, 0x7800
    buffer_load_dwordx4 v[116:119], v253, s[20:23], s38 offen offset:1024 sc1
    ds_read_b64_tr_b16 v[32:33], v56 offset:30720
    ds_read_b64_tr_b16 v[34:35], v56 offset:31232
    v_mfma_f32_32x32x16_bf16 v[16:31], v[44:47], v[120:123], v[16:31]
    ds_read_b64_tr_b16 v[36:37], v57 offset:30720
    ds_read_b64_tr_b16 v[38:39], v57 offset:31232
    s_waitcnt vmcnt(7) lgkmcnt(4)
    v_mfma_f32_32x32x16_bf16 v[0:15], v[48:51], v[124:127], v[0:15]
    s_add_u32 s38, s36, s37
    buffer_load_dwordx4 v[120:123], v253, s[20:23], s38 offen offset:0 sc1
    ds_read_b64_tr_b16 v[40:41], v56 offset:32768
    ds_read_b64_tr_b16 v[42:43], v56 offset:33280
    v_mfma_f32_32x32x16_bf16 v[16:31], v[52:55], v[124:127], v[16:31]
    ds_read_b64_tr_b16 v[44:45], v57 offset:32768
    ds_read_b64_tr_b16 v[46:47], v57 offset:33280
    s_waitcnt vmcnt(7) lgkmcnt(4)
    v_mfma_f32_32x32x16_bf16 v[0:15], v[32:35], v[128:131], v[0:15]
    s_add_u32 s37, s37, 2048
    s_and_b32 s37, s37, 0x7800
    buffer_load_dwordx4 v[124:127], v253, s[20:23], s38 offen offset:1024 sc1
    ds_read_b64_tr_b16 v[48:49], v56 offset:34816
    ds_read_b64_tr_b16 v[50:51], v56 offset:35328
    v_mfma_f32_32x32x16_bf16 v[16:31], v[36:39], v[128:131], v[16:31]
    ds_read_b64_tr_b16 v[52:53], v57 offset:34816
    ds_read_b64_tr_b16 v[54:55], v57 offset:35328
    s_waitcnt vmcnt(7) lgkmcnt(4)
    v_mfma_f32_32x32x16_bf16 v[0:15], v[40:43], v[132:135], v[0:15]
    s_add_u32 s38, s36, s37
    buffer_load_dwordx4 v[128:131], v253, s[20:23], s38 offen offset:0 sc1
    ds_read_b64_tr_b16 v[32:33], v56 offset:36864
    ds_read_b64_tr_b16 v[34:35], v56 offset:37376
    v_mfma_f32_32x32x16_bf16 v[16:31], v[44:47], v[132:135], v[16:31]
    ds_read_b64_tr_b16 v[36:37], v57 offset:36864
    ds_read_b64_tr_b16 v[38:39], v57 offset:37376
    s_waitcnt vmcnt(7) lgkmcnt(4)
    v_mfma_f32_32x32x16_bf16 v[0:15], v[48:51], v[136:139], v[0:15]
    s_add_u32 s37, s37, 2048
    s_and_b32 s37, s37, 0x7800
    buffer_load_dwordx4 v[132:135], v253, s[20:23], s38 offen offset:1024 sc1
    ds_read_b64_tr_b16 v[40:41], v56 offset:38912
    ds_read_b64_tr_b16 v[42:43], v56 offset:39424
    v_mfma_f32_32x32x16_bf16 v[16:31], v[52:55], v[136:139], v[16:31]
    ds_read_b64_tr_b16 v[44:45], v57 offset:38912
    ds_read_b64_tr_b16 v[46:47], v57 offset:39424
    s_waitcnt vmcnt(7) lgkmcnt(4)
    v_mfma_f32_32x32x16_bf16 v[0:15], v[32:35], v[104:107], v[0:15]
    s_add_u32 s38, s36, s37
    buffer_load_dwordx4 v[136:139], v253, s[20:23], s38 offen offset:0 sc1
    ds_read_b64_tr_b16 v[48:49], v56 offset:40960
    ds_read_b64_tr_b16 v[50:51], v56 offset:41472
    v_mfma_f32_32x32x16_bf16 v[16:31], v[36:39], v[104:107], v[16:31]
    ds_read_b64_tr_b16 v[52:53], v57 offset:40960
    ds_read_b64_tr_b16 v[54:55], v57 offset:41472
    s_waitcnt vmcnt(7) lgkmcnt(4)
    v_mfma_f32_32x32x16_bf16 v[0:15], v[40:43], v[108:111], v[0:15]
    s_add_u32 s37, s37, 2048
    s_and_b32 s37, s37, 0x7800
    buffer_load_dwordx4 v[104:107], v253, s[20:23], s38 offen offset:1024 sc1
    ds_read_b64_tr_b16 v[32:33], v56 offset:43008
    ds_read_b64_tr_b16 v[34:35], v56 offset:43520
    v_mfma_f32_32x32x16_bf16 v[16:31], v[44:47], v[108:111], v[16:31]
    ds_read_b64_tr_b16 v[36:37], v57 offset:43008
    ds_read_b64_tr_b16 v[38:39], v57 offset:43520
    s_waitcnt vmcnt(7) lgkmcnt(4)
    v_mfma_f32_32x32x16_bf16 v[0:15], v[48:51], v[112:115], v[0:15]
    buffer_load_dword v61, v60, s[20:23], s30 offen offset:256 sc1
    s_add_u32 s38, s36, s37
    buffer_load_dwordx4 v[108:111], v253, s[20:23], s38 offen offset:0 sc1
    ds_read_b64_tr_b16 v[40:41], v56 offset:45056
    ds_read_b64_tr_b16 v[42:43], v56 offset:45568
    v_mfma_f32_32x32x16_bf16 v[16:31], v[52:55], v[112:115], v[16:31]
    ds_read_b64_tr_b16 v[44:45], v57 offset:45056
    ds_read_b64_tr_b16 v[46:47], v57 offset:45568
    s_waitcnt vmcnt(8) lgkmcnt(4)
    v_mfma_f32_32x32x16_bf16 v[0:15], v[32:35], v[116:119], v[0:15]
    s_add_u32 s37, s37, 2048
    s_and_b32 s37, s37, 0x7800
    buffer_load_dwordx4 v[112:115], v253, s[20:23], s38 offen offset:1024 sc1
    ds_read_b64_tr_b16 v[48:49], v56 offset:47104
    ds_read_b64_tr_b16 v[50:51], v56 offset:47616
    v_mfma_f32_32x32x16_bf16 v[16:31], v[36:39], v[116:119], v[16:31]
    ds_read_b64_tr_b16 v[52:53], v57 offset:47104
    ds_read_b64_tr_b16 v[54:55], v57 offset:47616
    s_waitcnt vmcnt(8) lgkmcnt(4)
    v_mfma_f32_32x32x16_bf16 v[0:15], v[40:43], v[120:123], v[0:15]
    s_add_u32 s38, s36, s37
    buffer_load_dwordx4 v[116:119], v253, s[20:23], s38 offen offset:0 sc1
    ds_read_b64_tr_b16 v[32:33], v56 offset:49152
    ds_read_b64_tr_b16 v[34:35], v56 offset:49664
    v_mfma_f32_32x32x16_bf16 v[16:31], v[44:47], v[120:123], v[16:31]
    ds_read_b64_tr_b16 v[36:37], v57 offset:49152
    ds_read_b64_tr_b16 v[38:39], v57 offset:49664
    s_waitcnt vmcnt(8) lgkmcnt(4)
    v_mfma_f32_32x32x16_bf16 v[0:15], v[48:51], v[124:127], v[0:15]
    s_add_u32 s37, s37, 2048
    s_and_b32 s37, s37, 0x7800
    buffer_load_dwordx4 v[120:123], v253, s[20:23], s38 offen offset:1024 sc1
    ds_read_b64_tr_b16 v[40:41], v56 offset:51200
    ds_read_b64_tr_b16 v[42:43], v56 offset:51712
    v_mfma_f32_32x32x16_bf16 v[16:31], v[52:55], v[124:127], v[16:31]
    ds_read_b64_tr_b16 v[44:45], v57 offset:51200
    ds_read_b64_tr_b16 v[46:47], v57 offset:51712
    s_waitcnt vmcnt(8) lgkmcnt(4)
    v_mfma_f32_32x32x16_bf16 v[0:15], v[32:35], v[128:131], v[0:15]
    s_mov_b32 s78, s27
    s_waitcnt vmcnt(4)
    s_branch pc_27
pl_26:
    buffer_load_dword v61, v60, s[20:23], s30 offen offset:256 sc1
    s_waitcnt vmcnt(0)
pc_27:
    v_cmp_eq_u32 vcc, -1, v61
    s_cbranch_vccz pd_28
    s_sub_u32 s78, s78, 1
    s_cmp_lg_u32 s78, 0
    s_cbranch_scc1 pl_26
    s_mov_b32 s27, 1
pd_28:
    s_add_u32 s36, s36, 32768
    s_add_u32 s38, s36, s37
    buffer_load_dwordx4 v[124:127], v253, s[20:23], s38 offen offset:0 sc1
    ds_read_b64_tr_b16 v[48:49], v56 offset:53248
    ds_read_b64_tr_b16 v[50:51], v56 offset:53760
    v_mfma_f32_32x32x16_bf16 v[16:31], v[36:39], v[128:131], v[16:31]
    ds_read_b64_tr_b16 v[52:53], v57 offset:53248
    ds_read_b64_tr_b16 v[54:55], v57 offset:53760
    s_waitcnt vmcnt(8) lgkmcnt(4)
    v_mfma_f32_32x32x16_bf16 v[0:15], v[40:43], v[132:135], v[0:15]
    s_add_u32 s37, s37, 2048
    s_and_b32 s37, s37, 0x7800
    buffer_load_dwordx4 v[128:131], v253, s[20:23], s38 offen offset:1024 sc1
    ds_read_b64_tr_b16 v[32:33], v56 offset:55296
    ds_read_b64_tr_b16 v[34:35], v56 offset:55808
    v_mfma_f32_32x32x16_bf16 v[16:31], v[44:47], v[132:135], v[16:31]
    ds_read_b64_tr_b16 v[36:37], v57 offset:55296
    ds_read_b64_tr_b16 v[38:39], v57 offset:55808
    s_waitcnt vmcnt(8) lgkmcnt(4)
    v_mfma_f32_32x32x16_bf16 v[0:15], v[48:51], v[136:139], v[0:15]
    s_add_u32 s38, s36, s37
    buffer_load_dwordx4 v[132:135], v253, s[20:23], s38 offen offset:0 sc1
    ds_read_b64_tr_b16 v[40:41], v56 offset:57344
    ds_read_b64_tr_b16 v[42:43], v56 offset:57856
    v_mfma_f32_32x32x16_bf16 v[16:31], v[52:55], v[136:139], v[16:31]
    ds_read_b64_tr_b16 v[44:45], v57 offset:57344
    ds_read_b64_tr_b16 v[46:47], v57 offset:57856
    s_waitcnt vmcnt(8) lgkmcnt(4)
    v_mfma_f32_32x32x16_bf16 v[0:15], v[32:35], v[104:107], v[0:15]
    s_add_u32 s37, s37, 2048
    s_and_b32 s37, s37, 0x7800
    buffer_load_dwordx4 v[136:139], v253, s[20:23], s38 offen offset:1024 sc1
    ds_read_b64_tr_b16 v[48:49], v56 offset:59392
    ds_read_b64_tr_b16 v[50:51], v56 offset:59904
    v_mfma_f32_32x32x16_bf16 v[16:31], v[36:39], v[104:107], v[16:31]
    ds_read_b64_tr_b16 v[52:53], v57 offset:59392
    ds_read_b64_tr_b16 v[54:55], v57 offset:59904
    s_waitcnt vmcnt(7) lgkmcnt(4)
    v_mfma_f32_32x32x16_bf16 v[0:15], v[40:43], v[108:111], v[0:15]
    s_add_u32 s38, s36, s37
    buffer_load_dwordx4 v[104:107], v253, s[20:23], s38 offen offset:0 sc1
    ds_read_b64_tr_b16 v[32:33], v56 offset:61440
    ds_read_b64_tr_b16 v[34:35], v56 offset:61952
    v_mfma_f32_32x32x16_bf16 v[16:31], v[44:47], v[108:111], v[16:31]
    ds_read_b64_tr_b16 v[36:37], v57 offset:61440
    ds_read_b64_tr_b16 v[38:39], v57 offset:61952
    s_waitcnt vmcnt(7) lgkmcnt(4)
    v_mfma_f32_32x32x16_bf16 v[0:15], v[48:51], v[112:115], v[0:15]
    s_add_u32 s37, s37, 2048
    s_and_b32 s37, s37, 0x7800
    buffer_load_dwordx4 v[108:111], v253, s[20:23], s38 offen offset:1024 sc1
    ds_read_b64_tr_b16 v[40:41], v56 offset:63488
    ds_read_b64_tr_b16 v[42:43], v56 offset:64000
    v_mfma_f32_32x32x16_bf16 v[16:31], v[52:55], v[112:115], v[16:31]
    ds_read_b64_tr_b16 v[44:45], v57 offset:63488
    ds_read_b64_tr_b16 v[46:47], v57 offset:64000
    s_barrier
    s_waitcnt vmcnt(7) lgkmcnt(4)
    v_mfma_f32_32x32x16_bf16 v[0:15], v[32:35], v[116:119], v[0:15]
    s_add_u32 s38, s36, s37
    buffer_load_dwordx4 v[112:115], v253, s[20:23], s38 offen offset:0 sc1
    ds_read_b64_tr_b16 v[48:49], v58 offset:0
    ds_read_b64_tr_b16 v[50:51], v58 offset:512
    v_mfma_f32_32x32x16_bf16 v[16:31], v[36:39], v[116:119], v[16:31]
    ds_read_b64_tr_b16 v[52:53], v59 offset:0
    ds_read_b64_tr_b16 v[54:55], v59 offset:512
    s_waitcnt vmcnt(7) lgkmcnt(4)
    v_mfma_f32_32x32x16_bf16 v[0:15], v[40:43], v[120:123], v[0:15]
    s_add_u32 s37, s37, 2048
    s_and_b32 s37, s37, 0x7800
    buffer_load_dwordx4 v[116:119], v253, s[20:23], s38 offen offset:1024 sc1
    ds_read_b64_tr_b16 v[32:33], v58 offset:2048
    ds_read_b64_tr_b16 v[34:35], v58 offset:2560
    v_mfma_f32_32x32x16_bf16 v[16:31], v[44:47], v[120:123], v[16:31]
    ds_read_b64_tr_b16 v[36:37], v59 offset:2048
    ds_read_b64_tr_b16 v[38:39], v59 offset:2560
    s_waitcnt vmcnt(7) lgkmcnt(4)
    v_mfma_f32_32x32x16_bf16 v[0:15], v[48:51], v[124:127], v[0:15]
    s_add_u32 s38, s36, s37
    buffer_load_dwordx4 v[120:123], v253, s[20:23], s38 offen offset:0 sc1
    ds_read_b64_tr_b16 v[40:41], v58 offset:4096
    ds_read_b64_tr_b16 v[42:43], v58 offset:4608
    v_mfma_f32_32x32x16_bf16 v[16:31], v[52:55], v[124:127], v[16:31]
    ds_read_b64_tr_b16 v[44:45], v59 offset:4096
    ds_read_b64_tr_b16 v[46:47], v59 offset:4608
    s_waitcnt vmcnt(7) lgkmcnt(4)
    v_mfma_f32_32x32x16_bf16 v[0:15], v[32:35], v[128:131], v[0:15]
    s_add_u32 s37, s37, 2048
    s_and_b32 s37, s37, 0x7800
    buffer_load_dwordx4 v[124:127], v253, s[20:23], s38 offen offset:1024 sc1
    ds_read_b64_tr_b16 v[48:49], v58 offset:6144
    ds_read_b64_tr_b16 v[50:51], v58 offset:6656
    v_mfma_f32_32x32x16_bf16 v[16:31], v[36:39], v[128:131], v[16:31]
    ds_read_b64_tr_b16 v[52:53], v59 offset:6144
    ds_read_b64_tr_b16 v[54:55], v59 offset:6656
    s_waitcnt vmcnt(7) lgkmcnt(4)
    v_mfma_f32_32x32x16_bf16 v[0:15], v[40:43], v[132:135], v[0:15]
    s_add_u32 s38, s36, s37
    buffer_load_dwordx4 v[128:131], v253, s[20:23], s38 offen offset:0 sc1
    ds_read_b64_tr_b16 v[32:33], v58 offset:8192
    ds_read_b64_tr_b16 v[34:35], v58 offset:8704
    v_mfma_f32_32x32x16_bf16 v[16:31], v[44:47], v[132:135], v[16:31]
    ds_read_b64_tr_b16 v[36:37], v59 offset:8192
    ds_read_b64_tr_b16 v[38:39], v59 offset:8704
    s_waitcnt vmcnt(7) lgkmcnt(4)
    v_mfma_f32_32x32x16_bf16 v[0:15], v[48:51], v[136:139], v[0:15]
    s_add_u32 s37, s37, 2048
    s_and_b32 s37, s37, 0x7800
    buffer_load_dwordx4 v[132:135], v253, s[20:23], s38 offen offset:1024 sc1
    ds_read_b64_tr_b16 v[40:41], v58 offset:10240
    ds_read_b64_tr_b16 v[42:43], v58 offset:10752
    v_mfma_f32_32x32x16_bf16 v[16:31], v[52:55], v[136:139], v[16:31]
    ds_read_b64_tr_b16 v[44:45], v59 offset:10240
    ds_read_b64_tr_b16 v[46:47], v59 offset:10752
    s_waitcnt vmcnt(7) lgkmcnt(4)
    v_mfma_f32_32x32x16_bf16 v[0:15], v[32:35], v[104:107], v[0:15]
    s_add_u32 s38, s36, s37
    buffer_load_dwordx4 v[136:139], v253, s[20:23], s38 offen offset:0 sc1
    ds_read_b64_tr_b16 v[48:49], v58 offset:12288
    ds_read_b64_tr_b16 v[50:51], v58 offset:12800
    v_mfma_f32_32x32x16_bf16 v[16:31], v[36:39], v[104:107], v[16:31]
    ds_read_b64_tr_b16 v[52:53], v59 offset:12288
    ds_read_b64_tr_b16 v[54:55], v59 offset:12800
    s_waitcnt vmcnt(7) lgkmcnt(4)
    v_mfma_f32_32x32x16_bf16 v[0:15], v[40:43], v[108:111], v[0:15]
    s_add_u32 s37, s37, 2048
    s_and_b32 s37, s37, 0x7800
    buffer_load_dwordx4 v[104:107], v253, s[20:23], s38 offen offset:1024 sc1
    ds_read_b64_tr_b16 v[32:33], v58 offset:14336
    ds_read_b64_tr_b16 v[34:35], v58 offset:14848
    v_mfma_f32_32x32x16_bf16 v[16:31], v[44:47], v[108:111], v[16:31]
    ds_read_b64_tr_b16 v[36:37], v59 offset:14336
    ds_read_b64_tr_b16 v[38:39], v59 offset:14848
    s_waitcnt vmcnt(7) lgkmcnt(4)
    v_mfma_f32_32x32x16_bf16 v[0:15], v[48:51], v[112:115], v[0:15]
    s_add_u32 s38, s36, s37
    buffer_load_dwordx4 v[108:111], v253, s[20:23], s38 offen offset:0 sc1
    ds_read_b64_tr_b16 v[40:41], v58 offset:16384
    ds_read_b64_tr_b16 v[42:43], v58 offset:16896
    v_mfma_f32_32x32x16_bf16 v[16:31], v[52:55], v[112:115], v[16:31]
    ds_read_b64_tr_b16 v[44:45], v59 offset:16384
    ds_read_b64_tr_b16 v[46:47], v59 offset:16896
    s_waitcnt vmcnt(7) lgkmcnt(4)
    v_mfma_f32_32x32x16_bf16 v[0:15], v[32:35], v[116:119], v[0:15]
    s_add_u32 s37, s37, 2048
    s_and_b32 s37, s37, 0x7800
    buffer_load_dwordx4 v[112:115], v253, s[20:23], s38 offen offset:1024 sc1
    ds_read_b64_tr_b16 v[48:49], v58 offset:18432
    ds_read_b64_tr_b16 v[50:51], v58 offset:18944
    v_mfma_f32_32x32x16_bf16 v[16:31], v[36:39], v[116:119], v[16:31]
    ds_read_b64_tr_b16 v[52:53], v59 offset:18432
    ds_read_b64_tr_b16 v[54:55], v59 offset:18944
    s_waitcnt vmcnt(7) lgkmcnt(4)
    v_mfma_f32_32x32x16_bf16 v[0:15], v[40:43], v[120:123], v[0:15]
    s_add_u32 s38, s36, s37
    buffer_load_dwordx4 v[116:119], v253, s[20:23], s38 offen offset:0 sc1
    ds_read_b64_tr_b16 v[32:33], v58 offset:20480
    ds_read_b64_tr_b16 v[34:35], v58 offset:20992
    v_mfma_f32_32x32x16_bf16 v[16:31], v[44:47], v[120:123], v[16:31]
    ds_read_b64_tr_b16 v[36:37], v59 offset:20480
    ds_read_b64_tr_b16 v[38:39], v59 offset:20992
    s_waitcnt vmcnt(7) lgkmcnt(4)
    v_mfma_f32_32x32x16_bf16 v[0:15], v[48:51], v[124:127], v[0:15]
    s_add_u32 s37, s37, 2048
    s_and_b32 s37, s37, 0x7800
    buffer_load_dwordx4 v[120:123], v253, s[20:23], s38 offen offset:1024 sc1
    ds_read_b64_tr_b16 v[40:41], v58 offset:22528
    ds_read_b64_tr_b16 v[42:43], v58 offset:23040
    v_mfma_f32_32x32x16_bf16 v[16:31], v[52:55], v[124:127], v[16:31]
    ds_read_b64_tr_b16 v[44:45], v59 offset:22528
    ds_read_b64_tr_b16 v[46:47], v59 offset:23040
    s_waitcnt vmcnt(7) lgkmcnt(4)
    v_mfma_f32_32x32x16_bf16 v[0:15], v[32:35], v[128:131], v[0:15]
    s_add_u32 s38, s36, s37
    buffer_load_dwordx4 v[124:127], v253, s[20:23], s38 offen offset:0 sc1
    ds_read_b64_tr_b16 v[48:49], v58 offset:24576
    ds_read_b64_tr_b16 v[50:51], v58 offset:25088
    v_mfma_f32_32x32x16_bf16 v[16:31], v[36:39], v[128:131], v[16:31]
    ds_read_b64_tr_b16 v[52:53], v59 offset:24576
    ds_read_b64_tr_b16 v[54:55], v59 offset:25088
    s_waitcnt vmcnt(7) lgkmcnt(4)
    v_mfma_f32_32x32x16_bf16 v[0:15], v[40:43], v[132:135], v[0:15]
    s_add_u32 s37, s37, 2048
    s_and_b32 s37, s37, 0x7800
    buffer_load_dwordx4 v[128:131], v253, s[20:23], s38 offen offset:1024 sc1
    ds_read_b64_tr_b16 v[32:33], v58 offset:26624
    ds_read_b64_tr_b16 v[34:35], v58 offset:27136
    v_mfma_f32_32x32x16_bf16 v[16:31], v[44:47], v[132:135], v[16:31]
    ds_read_b64_tr_b16 v[36:37], v59 offset:26624
    ds_read_b64_tr_b16 v[38:39], v59 offset:27136
    s_waitcnt vmcnt(7) lgkmcnt(4)
    v_mfma_f32_32x32x16_bf16 v[0:15], v[48:51], v[136:139], v[0:15]
    s_add_u32 s38, s36, s37
    buffer_load_dwordx4 v[132:135], v253, s[20:23], s38 offen offset:0 sc1
    ds_read_b64_tr_b16 v[40:41], v58 offset:28672
    ds_read_b64_tr_b16 v[42:43], v58 offset:29184
    v_mfma_f32_32x32x16_bf16 v[16:31], v[52:55], v[136:139], v[16:31]
    ds_read_b64_tr_b16 v[44:45], v59 offset:28672
    ds_read_b64_tr_b16 v[46:47], v59 offset:29184
    s_waitcnt vmcnt(7) lgkmcnt(4)
    v_mfma_f32_32x32x16_bf16 v[0:15], v[32:35], v[104:107], v[0:15]
    s_add_u32 s37, s37, 2048
    s_and_b32 s37, s37, 0x7800
    buffer_load_dwordx4 v[136:139], v253, s[20:23], s38 offen offset:1024 sc1
    ds_read_b64_tr_b16 v[48:49], v58 offset:30720
    ds_read_b64_tr_b16 v[50:51], v58 offset:31232
    v_mfma_f32_32x32x16_bf16 v[16:31], v[36:39], v[104:107], v[16:31]
    ds_read_b64_tr_b16 v[52:53], v59 offset:30720
    ds_read_b64_tr_b16 v[54:55], v59 offset:31232
    s_waitcnt vmcnt(7) lgkmcnt(4)
    v_mfma_f32_32x32x16_bf16 v[0:15], v[40:43], v[108:111], v[0:15]
    s_add_u32 s38, s36, s37
    buffer_load_dwordx4 v[104:107], v253, s[20:23], s38 offen offset:0 sc1
    ds_read_b64_tr_b16 v[32:33], v58 offset:32768
    ds_read_b64_tr_b16 v[34:35], v58 offset:33280
    v_mfma_f32_32x32x16_bf16 v[16:31], v[44:47], v[108:111], v[16:31]
    ds_read_b64_tr_b16 v[36:37], v59 offset:32768
    ds_read_b64_tr_b16 v[38:39], v59 offset:33280
    s_waitcnt vmcnt(7) lgkmcnt(4)
    v_mfma_f32_32x32x16_bf16 v[0:15], v[48:51], v[112:115], v[0:15]
    s_add_u32 s37, s37, 2048
    s_and_b32 s37, s37, 0x7800
    buffer_load_dwordx4 v[108:111], v253, s[20:23], s38 offen offset:1024 sc1
    ds_read_b64_tr_b16 v[40:41], v58 offset:34816
    ds_read_b64_tr_b16 v[42:43], v58 offset:35328
    v_mfma_f32_32x32x16_bf16 v[16:31], v[52:55], v[112:115], v[16:31]
    ds_read_b64_tr_b16 v[44:45], v59 offset:34816
    ds_read_b64_tr_b16 v[46:47], v59 offset:35328
    s_waitcnt vmcnt(7) lgkmcnt(4)
    v_mfma_f32_32x32x16_bf16 v[0:15], v[32:35], v[116:119], v[0:15]
    s_add_u32 s38, s36, s37
    buffer_load_dwordx4 v[112:115], v253, s[20:23], s38 offen offset:0 sc1
    ds_read_b64_tr_b16 v[48:49], v58 offset:36864
    ds_read_b64_tr_b16 v[50:51], v58 offset:37376
    v_mfma_f32_32x32x16_bf16 v[16:31], v[36:39], v[116:119], v[16:31]
    ds_read_b64_tr_b16 v[52:53], v59 offset:36864
    ds_read_b64_tr_b16 v[54:55], v59 offset:37376
    s_waitcnt vmcnt(7) lgkmcnt(4)
    v_mfma_f32_32x32x16_bf16 v[0:15], v[40:43], v[120:123], v[0:15]
    s_add_u32 s37, s37, 2048
    s_and_b32 s37, s37, 0x7800
    buffer_load_dwordx4 v[116:119], v253, s[20:23], s38 offen offset:1024 sc1
    ds_read_b64_tr_b16 v[32:33], v58 offset:38912
    ds_read_b64_tr_b16 v[34:35], v58 offset:39424
    v_mfma_f32_32x32x16_bf16 v[16:31], v[44:47], v[120:123], v[16:31]
    ds_read_b64_tr_b16 v[36:37], v59 offset:38912
    ds_read_b64_tr_b16 v[38:39], v59 offset:39424
    s_waitcnt vmcnt(7) lgkmcnt(4)
    v_mfma_f32_32x32x16_bf16 v[0:15], v[48:51], v[124:127], v[0:15]
    s_add_u32 s38, s36, s37
    buffer_load_dwordx4 v[120:123], v253, s[20:23], s38 offen offset:0 sc1
    ds_read_b64_tr_b16 v[40:41], v58 offset:40960
    ds_read_b64_tr_b16 v[42:43], v58 offset:41472
    v_mfma_f32_32x32x16_bf16 v[16:31], v[52:55], v[124:127], v[16:31]
    ds_read_b64_tr_b16 v[44:45], v59 offset:40960
    ds_read_b64_tr_b16 v[46:47], v59 offset:41472
    s_waitcnt vmcnt(7) lgkmcnt(4)
    v_mfma_f32_32x32x16_bf16 v[0:15], v[32:35], v[128:131], v[0:15]
    s_add_u32 s37, s37, 2048
    s_and_b32 s37, s37, 0x7800
    buffer_load_dwordx4 v[124:127], v253, s[20:23], s38 offen offset:1024 sc1
    ds_read_b64_tr_b16 v[48:49], v58 offset:43008
    ds_read_b64_tr_b16 v[50:51], v58 offset:43520
    v_mfma_f32_32x32x16_bf16 v[16:31], v[36:39], v[128:131], v[16:31]
    ds_read_b64_tr_b16 v[52:53], v59 offset:43008
    ds_read_b64_tr_b16 v[54:55], v59 offset:43520
    s_waitcnt vmcnt(7) lgkmcnt(4)
    v_mfma_f32_32x32x16_bf16 v[0:15], v[40:43], v[132:135], v[0:15]
    s_add_u32 s38, s36, s37
    buffer_load_dwordx4 v[128:131], v253, s[20:23], s38 offen offset:0 sc1
    ds_read_b64_tr_b16 v[32:33], v58 offset:45056
    ds_read_b64_tr_b16 v[34:35], v58 offset:45568
    v_mfma_f32_32x32x16_bf16 v[16:31], v[44:47], v[132:135], v[16:31]
    ds_read_b64_tr_b16 v[36:37], v59 offset:45056
    ds_read_b64_tr_b16 v[38:39], v59 offset:45568
    s_waitcnt vmcnt(7) lgkmcnt(4)
    v_mfma_f32_32x32x16_bf16 v[0:15], v[48:51], v[136:139], v[0:15]
    s_add_u32 s37, s37, 2048
    s_and_b32 s37, s37, 0x7800
    buffer_load_dwordx4 v[132:135], v253, s[20:23], s38 offen offset:1024 sc1
    ds_read_b64_tr_b16 v[40:41], v58 offset:47104
    ds_read_b64_tr_b16 v[42:43], v58 offset:47616
    v_mfma_f32_32x32x16_bf16 v[16:31], v[52:55], v[136:139], v[16:31]
    ds_read_b64_tr_b16 v[44:45], v59 offset:47104
    ds_read_b64_tr_b16 v[46:47], v59 offset:47616
    s_barrier
    s_waitcnt vmcnt(7) lgkmcnt(4)
    v_mfma_f32_32x32x16_bf16 v[0:15], v[32:35], v[104:107], v[0:15]
    s_add_u32 s38, s36, s37
    buffer_load_dwordx4 v[136:139], v253, s[20:23], s38 offen offset:0 sc1
    ds_read_b64_tr_b16 v[48:49], v58 offset:49152
    ds_read_b64_tr_b16 v[50:51], v58 offset:49664
    v_mfma_f32_32x32x16_bf16 v[16:31], v[36:39], v[104:107], v[16:31]
    ds_read_b64_tr_b16 v[52:53], v59 offset:49152
    ds_read_b64_tr_b16 v[54:55], v59 offset:49664
    s_waitcnt vmcnt(7) lgkmcnt(4)
    v_mfma_f32_32x32x16_bf16 v[0:15], v[40:43], v[108:111], v[0:15]
    s_add_u32 s37, s37, 2048
    s_and_b32 s37, s37, 0x7800
    buffer_load_dwordx4 v[104:107], v253, s[20:23], s38 offen offset:1024 sc1
    ds_read_b64_tr_b16 v[32:33], v58 offset:51200
    ds_read_b64_tr_b16 v[34:35], v58 offset:51712
    v_mfma_f32_32x32x16_bf16 v[16:31], v[44:47], v[108:111], v[16:31]
    ds_read_b64_tr_b16 v[36:37], v59 offset:51200
    ds_read_b64_tr_b16 v[38:39], v59 offset:51712
    s_waitcnt vmcnt(7) lgkmcnt(4)
    v_mfma_f32_32x32x16_bf16 v[0:15], v[48:51], v[112:115], v[0:15]
    ds_read_b64_tr_b16 v[40:41], v58 offset:53248
    ds_read_b64_tr_b16 v[42:43], v58 offset:53760
    v_mfma_f32_32x32x16_bf16 v[16:31], v[52:55], v[112:115], v[16:31]
    ds_read_b64_tr_b16 v[44:45], v59 offset:53248
    ds_read_b64_tr_b16 v[46:47], v59 offset:53760
    s_waitcnt vmcnt(6) lgkmcnt(4)
    v_mfma_f32_32x32x16_bf16 v[0:15], v[32:35], v[116:119], v[0:15]
    ds_read_b64_tr_b16 v[48:49], v58 offset:55296
    ds_read_b64_tr_b16 v[50:51], v58 offset:55808
    v_mfma_f32_32x32x16_bf16 v[16:31], v[36:39], v[116:119], v[16:31]
    ds_read_b64_tr_b16 v[52:53], v59 offset:55296
    ds_read_b64_tr_b16 v[54:55], v59 offset:55808
    s_waitcnt vmcnt(5) lgkmcnt(4)
    v_mfma_f32_32x32x16_bf16 v[0:15], v[40:43], v[120:123], v[0:15]
    ds_read_b64_tr_b16 v[32:33], v58 offset:57344
    ds_read_b64_tr_b16 v[34:35], v58 offset:57856
    v_mfma_f32_32x32x16_bf16 v[16:31], v[44:47], v[120:123], v[16:31]
    ds_read_b64_tr_b16 v[36:37], v59 offset:57344
    ds_read_b64_tr_b16 v[38:39], v59 offset:57856
    s_waitcnt vmcnt(4) lgkmcnt(4)
    v_mfma_f32_32x32x16_bf16 v[0:15], v[48:51], v[124:127], v[0:15]
    ds_read_b64_tr_b16 v[40:41], v58 offset:59392
    ds_read_b64_tr_b16 v[42:43], v58 offset:59904
    v_mfma_f32_32x32x16_bf16 v[16:31], v[52:55], v[124:127], v[16:31]
    ds_read_b64_tr_b16 v[44:45], v59 offset:59392
    ds_read_b64_tr_b16 v[46:47], v59 offset:59904
    s_waitcnt vmcnt(3) lgkmcnt(4)
    v_mfma_f32_32x32x16_bf16 v[0:15], v[32:35], v[128:131], v[0:15]
    ds_read_b64_tr_b16 v[48:49], v58 offset:61440
    ds_read_b64_tr_b16 v[50:51], v58 offset:61952
    v_mfma_f32_32x32x16_bf16 v[16:31], v[36:39], v[128:131], v[16:31]
    ds_read_b64_tr_b16 v[52:53], v59 offset:61440
    ds_read_b64_tr_b16 v[54:55], v59 offset:61952
    s_waitcnt vmcnt(2) lgkmcnt(4)
    v_mfma_f32_32x32x16_bf16 v[0:15], v[40:43], v[132:135], v[0:15]
    ds_read_b64_tr_b16 v[32:33], v58 offset:63488
    ds_read_b64_tr_b16 v[34:35], v58 offset:64000
    v_mfma_f32_32x32x16_bf16 v[16:31], v[44:47], v[132:135], v[16:31]
    ds_read_b64_tr_b16 v[36:37], v59 offset:63488
    ds_read_b64_tr_b16 v[38:39], v59 offset:64000
    s_waitcnt vmcnt(1) lgkmcnt(4)
    v_mfma_f32_32x32x16_bf16 v[0:15], v[48:51], v[136:139], v[0:15]
    v_mfma_f32_32x32x16_bf16 v[16:31], v[52:55], v[136:139], v[16:31]
    s_waitcnt vmcnt(0) lgkmcnt(0)
    v_mfma_f32_32x32x16_bf16 v[0:15], v[32:35], v[104:107], v[0:15]
    v_mfma_f32_32x32x16_bf16 v[16:31], v[36:39], v[104:107], v[16:31]
    s_lshl_b32 s35, s24, 4
    s_add_u32 s35, s35, s98
    s_lshl_b32 s35, s35, 14
    s_lshl_b32 s34, s3, 12
    s_add_u32 s35, s35, s34
    s_add_u32 s35, s35, 0x2000000
    s_lshl_b32 s30, s99, 13
    s_add_u32 s30, s30, s26
    s_add_u32 s30, s30, 0xc00000
    s_lshl_b32 s31, s98, 9
    s_add_u32 s31, s31, s30
    v_mov_b32 v96, 0
    v_mov_b32 v97, 0
    v_mov_b32 v98, 0
    v_mov_b32 v99, v242
    v_cvt_pk_bf16_f32 v208, v0, v1
    v_cvt_pk_bf16_f32 v209, v2, v3
    v_cvt_pk_bf16_f32 v210, v4, v5
    v_cvt_pk_bf16_f32 v211, v6, v7
    v_cvt_pk_bf16_f32 v212, v8, v9
    v_cvt_pk_bf16_f32 v213, v10, v11
    v_cvt_pk_bf16_f32 v214, v12, v13
    v_cvt_pk_bf16_f32 v215, v14, v15
    v_cvt_pk_bf16_f32 v216, v16, v17
    v_cvt_pk_bf16_f32 v217, v18, v19
    v_cvt_pk_bf16_f32 v218, v20, v21
    v_cvt_pk_bf16_f32 v219, v22, v23
    v_cvt_pk_bf16_f32 v220, v24, v25
    v_cvt_pk_bf16_f32 v221, v26, v27
    v_cvt_pk_bf16_f32 v222, v28, v29
    v_cvt_pk_bf16_f32 v223, v30, v31
    s_cmp_lg_u32 s26, 0
    s_cbranch_scc1 sk_29
    s_cmp_lg_u32 s77, 0
    s_cbranch_scc1 lc_30
    buffer_store_dwordx4 v[208:211], v100, s[20:23], s35 offen offset:0 sc1
    buffer_store_dwordx4 v[212:215], v100, s[20:23], s35 offen offset:512 sc1
    buffer_store_dwordx4 v[216:219], v100, s[20:23], s35 offen offset:1024 sc1
    buffer_store_dwordx4 v[220:223], v100, s[20:23], s35 offen offset:1536 sc1
    s_branch lc_31
lc_30:
    buffer_store_dwordx4 v[208:211], v100, s[20:23], s35 offen offset:0
    buffer_store_dwordx4 v[212:215], v100, s[20:23], s35 offen offset:512
    buffer_store_dwordx4 v[216:219], v100, s[20:23], s35 offen offset:1024
    buffer_store_dwordx4 v[220:223], v100, s[20:23], s35 offen offset:1536
lc_31:
    ds_write_b128 v101, v[208:211] offset:0
    ds_write_b128 v101, v[212:215] offset:512
    ds_write_b128 v101, v[216:219] offset:1024
    ds_write_b128 v101, v[220:223] offset:1536
sk_29:
    v_dot2c_f32_bf16 v96, 0x3f803f80, v208
    v_dot2c_f32_bf16 v97, v208, v208
    v_dot2c_f32_bf16 v98, v224, v208
    v_dot2c_f32_bf16 v96, 0x3f803f80, v209
    v_dot2c_f32_bf16 v97, v209, v209
    v_dot2c_f32_bf16 v98, v225, v209
    v_dot2c_f32_bf16 v96, 0x3f803f80, v210
    v_dot2c_f32_bf16 v97, v210, v210
    v_dot2c_f32_bf16 v98, v226, v210
    v_dot2c_f32_bf16 v96, 0x3f803f80, v211
    v_dot2c_f32_bf16 v97, v211, v211
    v_dot2c_f32_bf16 v98, v227, v211
    v_dot2c_f32_bf16 v96, 0x3f803f80, v212
    v_dot2c_f32_bf16 v97, v212, v212
    v_dot2c_f32_bf16 v98, v228, v212
    v_dot2c_f32_bf16 v96, 0x3f803f80, v213
    v_dot2c_f32_bf16 v97, v213, v213
    v_dot2c_f32_bf16 v98, v229, v213
    v_dot2c_f32_bf16 v96, 0x3f803f80, v214
    v_dot2c_f32_bf16 v97, v214, v214
    v_dot2c_f32_bf16 v98, v230, v214
    v_dot2c_f32_bf16 v96, 0x3f803f80, v215
    v_dot2c_f32_bf16 v97, v215, v215
    v_dot2c_f32_bf16 v98, v231, v215
    v_dot2c_f32_bf16 v96, 0x3f803f80, v216
    v_dot2c_f32_bf16 v97, v216, v216
    v_dot2c_f32_bf16 v98, v232, v216
    v_dot2c_f32_bf16 v96, 0x3f803f80, v217
    v_dot2c_f32_bf16 v97, v217, v217
    v_dot2c_f32_bf16 v98, v233, v217
    v_dot2c_f32_bf16 v96, 0x3f803f80, v218
    v_dot2c_f32_bf16 v97, v218, v218
    v_dot2c_f32_bf16 v98, v234, v218
    v_dot2c_f32_bf16 v96, 0x3f803f80, v219
    v_dot2c_f32_bf16 v97, v219, v219
    v_dot2c_f32_bf16 v98, v235, v219
    v_dot2c_f32_bf16 v96, 0x3f803f80, v220
    v_dot2c_f32_bf16 v97, v220, v220
    v_dot2c_f32_bf16 v98, v236, v220
    v_dot2c_f32_bf16 v96, 0x3f803f80, v221
    v_dot2c_f32_bf16 v97, v221, v221
    v_dot2c_f32_bf16 v98, v237, v221
    v_dot2c_f32_bf16 v96, 0x3f803f80, v222
    v_dot2c_f32_bf16 v97, v222, v222
    v_dot2c_f32_bf16 v98, v238, v222
    v_dot2c_f32_bf16 v96, 0x3f803f80, v223
    v_dot2c_f32_bf16 v97, v223, v223
    v_dot2c_f32_bf16 v98, v239, v223
    s_nop 0
    v_mov_b32 v48, v96
    v_mov_b32 v49, v97
    v_mov_b32 v50, v98
    v_mov_b32 v51, v99
    v_permlane32_swap_b32 v96, v48
    v_permlane32_swap_b32 v97, v49
    v_permlane32_swap_b32 v98, v50
    v_permlane32_swap_b32 v99, v51
    v_add_f32 v96, v96, v48
    v_add_f32 v97, v97, v49
    v_add_f32 v98, v98, v50
    v_add_f32 v99, v99, v51
    s_mov_b32 exec_hi, 0
    s_waitcnt vmcnt(0)
    s_cmp_lg_u32 s77, 0
    s_cbranch_scc1 lc_32
    buffer_store_dwordx4 v[96:99], v253, s[20:23], s31 offen sc1
    s_branch lc_33
lc_32:
    buffer_store_dwordx4 v[96:99], v253, s[20:23], s31 offen
lc_33:
    s_mov_b64 exec, -1
    s_cmp_lg_u32 s26, 0
    s_cbranch_scc1 e_final
    s_mov_b32 s26, 16777216
    s_and_b32 s30, s3, 1
    s_lshl_b32 s30, s30, 13
    v_add_u32 v176, s30, v253
    v_add_u32 v177, 1024, v176
    v_mov_b32 v0, 0
    v_mov_b32 v1, 0
    v_mov_b32 v2, 0
    v_mov_b32 v3, 0
    v_mov_b32 v4, 0
    v_mov_b32 v5, 0
    v_mov_b32 v6, 0
    v_mov_b32 v7, 0
    v_mov_b32 v8, 0
    v_mov_b32 v9, 0
    v_mov_b32 v10, 0
    v_mov_b32 v11, 0
    v_mov_b32 v12, 0
    v_mov_b32 v13, 0
    v_mov_b32 v14, 0
    v_mov_b32 v15, 0
    v_mov_b32 v16, 0
    v_mov_b32 v17, 0
    v_mov_b32 v18, 0
    v_mov_b32 v19, 0
    v_mov_b32 v20, 0
    v_mov_b32 v21, 0
    v_mov_b32 v22, 0
    v_mov_b32 v23, 0
    v_mov_b32 v24, 0
    v_mov_b32 v25, 0
    v_mov_b32 v26, 0
    v_mov_b32 v27, 0
    v_mov_b32 v28, 0
    v_mov_b32 v29, 0
    v_mov_b32 v30, 0
    v_mov_b32 v31, 0
    v_mov_b32 v32, 0
    v_mov_b32 v33, 0
    v_mov_b32 v34, 0
    v_mov_b32 v35, 0
    v_mov_b32 v36, 0
    v_mov_b32 v37, 0
    v_mov_b32 v38, 0
    v_mov_b32 v39, 0
    v_mov_b32 v40, 0
    v_mov_b32 v41, 0
    v_mov_b32 v42, 0
    v_mov_b32 v43, 0
    v_mov_b32 v44, 0
    v_mov_b32 v45, 0
    v_mov_b32 v46, 0
    v_mov_b32 v47, 0
    v_mov_b32 v48, 0
    v_mov_b32 v49, 0
    v_mov_b32 v50, 0
    v_mov_b32 v51, 0
    v_mov_b32 v52, 0
    v_mov_b32 v53, 0
    v_mov_b32 v54, 0
    v_mov_b32 v55, 0
    v_mov_b32 v56, 0
    v_mov_b32 v57, 0
    v_mov_b32 v58, 0
    v_mov_b32 v59, 0
    v_mov_b32 v60, 0
    v_mov_b32 v61, 0
    v_mov_b32 v62, 0
    v_mov_b32 v63, 0
    v_mov_b32 v64, 0
    v_mov_b32 v65, 0
    v_mov_b32 v66, 0
    v_mov_b32 v67, 0
    v_mov_b32 v68, 0
    v_mov_b32 v69, 0
    v_mov_b32 v70, 0
    v_mov_b32 v71, 0
    v_mov_b32 v72, 0
    v_mov_b32 v73, 0
    v_mov_b32 v74, 0
    v_mov_b32 v75, 0
    v_mov_b32 v76, 0
    v_mov_b32 v77, 0
    v_mov_b32 v78, 0
    v_mov_b32 v79, 0
    v_mov_b32 v80, 0
    v_mov_b32 v81, 0
    v_mov_b32 v82, 0
    v_mov_b32 v83, 0
    v_mov_b32 v84, 0
    v_mov_b32 v85, 0
    v_mov_b32 v86, 0
    v_mov_b32 v87, 0
    v_mov_b32 v88, 0
    v_mov_b32 v89, 0
    v_mov_b32 v90, 0
    v_mov_b32 v91, 0
    v_mov_b32 v92, 0
    v_mov_b32 v93, 0
    v_mov_b32 v94, 0
    v_mov_b32 v95, 0
    s_waitcnt lgkmcnt(0)
    s_branch e_q
e_arr:
    s_mov_b64 exec, 1
    buffer_store_byte v249, v189, s[12:15], s72 offen sc1
    s_mov_b64 exec, -1
    s_mov_b32 s88, -1
    s_branch e_arr_ret
e_final:
    s_load_dwordx2 s[12:13], s[0:1], 64
    s_mov_b32 s14, 0x400000
    s_mov_b32 s15, 0x20000
    s_mov_b32 s78, s27
pl_34:
    s_lshl_b32 s30, s99, 13
    s_add_u32 s30, s30, 0x1c00000
    s_add_u32 s31, s30, 4096
    buffer_load_dwordx4 v[64:67], v253, s[20:23], s30 offen offset:0 sc1
    buffer_load_dwordx4 v[68:71], v253, s[20:23], s30 offen offset:1024 sc1
    buffer_load_dwordx4 v[72:75], v253, s[20:23], s30 offen offset:2048 sc1
    buffer_load_dwordx4 v[76:79], v253, s[20:23], s30 offen offset:3072 sc1
    buffer_load_dwordx4 v[80:83], v253, s[20:23], s31 offen offset:0 sc1
    buffer_load_dwordx4 v[84:87], v253, s[20:23], s31 offen offset:1024 sc1
    buffer_load_dwordx4 v[88:91], v253, s[20:23], s31 offen offset:2048 sc1
    buffer_load_dwordx4 v[92:95], v253, s[20:23], s31 offen offset:3072 sc1
    s_waitcnt vmcnt(0)
pc_35:
    v_max3_u32 v48, v64, v65, v66
    v_max3_u32 v48, v48, v67, v68
    v_max3_u32 v48, v48, v69, v70
    v_max3_u32 v48, v48, v71, v72
    v_max3_u32 v48, v48, v73, v74
    v_max3_u32 v48, v48, v75, v76
    v_max3_u32 v48, v48, v77, v78
    v_max3_u32 v48, v48, v79, v80
    v_max3_u32 v48, v48, v81, v82
    v_max3_u32 v48, v48, v83, v84
    v_max3_u32 v48, v48, v85, v86
    v_max3_u32 v48, v48, v87, v88
    v_max3_u32 v48, v48, v89, v90
    v_max3_u32 v48, v48, v91, v92
    v_max3_u32 v48, v48, v93, v94
    v_max_u32 v48, v48, v95
    v_cmp_eq_u32 vcc, -1, v48
    s_cbranch_vccz pd_36
    s_sub_u32 s78, s78, 1
    s_cmp_lg_u32 s78, 0
    s_cbranch_scc1 pl_34
    s_mov_b32 s27, 1
pd_36:
    v_pk_add_f32 v[64:65], v[64:65], v[68:69]
    v_pk_add_f32 v[66:67], v[66:67], v[70:71]
    v_pk_add_f32 v[64:65], v[64:65], v[72:73]
    v_pk_add_f32 v[66:67], v[66:67], v[74:75]
    v_pk_add_f32 v[64:65], v[64:65], v[76:77]
    v_pk_add_f32 v[66:67], v[66:67], v[78:79]
    v_pk_add_f32 v[64:65], v[64:65], v[80:81]
    v_pk_add_f32 v[66:67], v[66:67], v[82:83]
    v_pk_add_f32 v[64:65], v[64:65], v[84:85]
    v_pk_add_f32 v[66:67], v[66:67], v[86:87]
    v_pk_add_f32 v[64:65], v[64:65], v[88:89]
    v_pk_add_f32 v[66:67], v[66:67], v[90:91]
    v_pk_add_f32 v[64:65], v[64:65], v[92:93]
    v_pk_add_f32 v[66:67], v[66:67], v[94:95]
    v_mov_b32 v48, v64
    v_mov_b32 v49, v65
    v_mov_b32 v50, v66
    v_mov_b32 v51, v67
    v_permlane32_swap_b32 v64, v48
    v_permlane32_swap_b32 v65, v49
    v_permlane32_swap_b32 v66, v50
    v_permlane32_swap_b32 v67, v51
    v_add_f32 v64, v64, v48
    v_add_f32 v65, v65, v49
    v_add_f32 v66, v66, v50
    v_add_f32 v67, v67, v51
    v_mul_f32 v54, 0x3a800000, v64
    v_mul_f32 v65, 0x3a800000, v65
    v_fma_f32 v65, -v54, v54, v65
    v_max_f32 v65, 0, v65
    v_add_f32 v55, 0x3727c5ac, v65
    v_rsq_f32 v55, v55
    v_fma_f32 v52, -v54, v67, v66
    v_and_b32 v53, 31, v252
    v_mul_f32 v52, v52, v55
    s_lshl_b32 s32, s99, 5
    v_add_u32 v53, s32, v53
    v_mov_b32 v48, v52
    s_nop 1
    v_max_f32_dpp v48, v48, v48 quad_perm:[1,0,3,2] row_mask:0xf bank_mask:0xf
    s_nop 1
    v_max_f32_dpp v48, v48, v48 quad_perm:[2,3,0,1] row_mask:0xf bank_mask:0xf
    s_nop 1
    v_max_f32_dpp v48, v48, v48 row_half_mirror row_mask:0xf bank_mask:0xf
    s_nop 1
    v_max_f32_dpp v48, v48, v48 row_mirror row_mask:0xf bank_mask:0xf
    v_mov_b32 v49, v48
    s_nop 1
    v_permlane16_swap_b32 v48, v49
    v_max_f32 v48, v48, v49
    v_cmp_eq_f32 vcc, v48, v52
    v_lshrrev_b32 v50, 5, v252
    v_lshlrev_b32 v50, 4, v50
    s_lshl_b32 s32, s99, 11
    s_lshl_b32 s33, s98, 7
    s_add_u32 s32, s32, s33
    s_add_u32 s32, s32, 0x1d60000
    s_lshl_b32 s34, s99, 4
    s_add_u32 s34, s34, 0x1dc0000
    s_ff1_i32_b32 s35, vcc_lo
    s_lshl_b32 s35, 1, s35
    s_cmp_eq_u32 s25, 0
    s_cselect_b32 exec_lo, s35, 0
    s_mov_b32 exec_hi, 0
    buffer_store_dwordx4 v[52:55], v50, s[20:23], s34 offen sc1
    s_mov_b32 exec_lo, s35
    s_mov_b32 exec_hi, s35
    buffer_store_dwordx4 v[208:211], v50, s[20:23], s32 offen offset:0 sc1
    buffer_store_dwordx4 v[212:215], v50, s[20:23], s32 offen offset:32 sc1
    buffer_store_dwordx4 v[216:219], v50, s[20:23], s32 offen offset:64 sc1
    buffer_store_dwordx4 v[220:223], v50, s[20:23], s32 offen offset:96 sc1
    s_mov_b64 exec, -1
    v_add_f32 v240, 1.0, v55
    v_mul_f32 v241, v54, v55
    v_sub_f32 v241, 0, v241
    v_pk_fma_f32 v[0:1], v[0:1], v[240:241], v[240:241] op_sel:[0,0,1] op_sel_hi:[1,0,1]
    v_pk_fma_f32 v[2:3], v[2:3], v[240:241], v[240:241] op_sel:[0,0,1] op_sel_hi:[1,0,1]
    v_pk_fma_f32 v[4:5], v[4:5], v[240:241], v[240:241] op_sel:[0,0,1] op_sel_hi:[1,0,1]
    v_pk_fma_f32 v[6:7], v[6:7], v[240:241], v[240:241] op_sel:[0,0,1] op_sel_hi:[1,0,1]
    v_pk_fma_f32 v[8:9], v[8:9], v[240:241], v[240:241] op_sel:[0,0,1] op_sel_hi:[1,0,1]
    v_pk_fma_f32 v[10:11], v[10:11], v[240:241], v[240:241] op_sel:[0,0,1] op_sel_hi:[1,0,1]
    v_pk_fma_f32 v[12:13], v[12:13], v[240:241], v[240:241] op_sel:[0,0,1] op_sel_hi:[1,0,1]
    v_pk_fma_f32 v[14:15], v[14:15], v[240:241], v[240:241] op_sel:[0,0,1] op_sel_hi:[1,0,1]
    v_pk_fma_f32 v[16:17], v[16:17], v[240:241], v[240:241] op_sel:[0,0,1] op_sel_hi:[1,0,1]
    v_pk_fma_f32 v[18:19], v[18:19], v[240:241], v[240:241] op_sel:[0,0,1] op_sel_hi:[1,0,1]
    v_pk_fma_f32 v[20:21], v[20:21], v[240:241], v[240:241] op_sel:[0,0,1] op_sel_hi:[1,0,1]
    v_pk_fma_f32 v[22:23], v[22:23], v[240:241], v[240:241] op_sel:[0,0,1] op_sel_hi:[1,0,1]
    v_pk_fma_f32 v[24:25], v[24:25], v[240:241], v[240:241] op_sel:[0,0,1] op_sel_hi:[1,0,1]
    v_pk_fma_f32 v[26:27], v[26:27], v[240:241], v[240:241] op_sel:[0,0,1] op_sel_hi:[1,0,1]
    v_pk_fma_f32 v[28:29], v[28:29], v[240:241], v[240:241] op_sel:[0,0,1] op_sel_hi:[1,0,1]
    v_pk_fma_f32 v[30:31], v[30:31], v[240:241], v[240:241] op_sel:[0,0,1] op_sel_hi:[1,0,1]
    v_cvt_pk_bf16_f32 v64, v0, v1
    v_cvt_pk_bf16_f32 v65, v2, v3
    v_cvt_pk_bf16_f32 v66, v4, v5
    v_cvt_pk_bf16_f32 v67, v6, v7
    v_cvt_pk_bf16_f32 v68, v8, v9
    v_cvt_pk_bf16_f32 v69, v10, v11
    v_cvt_pk_bf16_f32 v70, v12, v13
    v_cvt_pk_bf16_f32 v71, v14, v15
    v_cvt_pk_bf16_f32 v72, v16, v17
    v_cvt_pk_bf16_f32 v73, v18, v19
    v_cvt_pk_bf16_f32 v74, v20, v21
    v_cvt_pk_bf16_f32 v75, v22, v23
    v_cvt_pk_bf16_f32 v76, v24, v25
    v_cvt_pk_bf16_f32 v77, v26, v27
    v_cvt_pk_bf16_f32 v78, v28, v29
    v_cvt_pk_bf16_f32 v79, v30, v31
    v_permlane32_swap_b32 v64, v66
    v_permlane32_swap_b32 v65, v67
    v_permlane32_swap_b32 v68, v70
    v_permlane32_swap_b32 v69, v71
    v_permlane32_swap_b32 v72, v74
    v_permlane32_swap_b32 v73, v75
    v_permlane32_swap_b32 v76, v78
    v_permlane32_swap_b32 v77, v79
    v_lshl_add_u32 v50, v53, 11, v50
    s_mov_b32 s79, s26
    s_cmp_lg_u32 s3, 0
    s_cbranch_scc1 sk_38
    s_mov_b32 s78, s27
pl_39:
    s_add_u32 s32, s79, 0xdc0000
    buffer_load_dwordx4 v[0:3], v253, s[20:23], s32 offen sc1
    s_waitcnt vmcnt(0)
pc_40:
    v_max3_u32 v4, v0, v1, v2
    v_max_u32 v4, v4, v3
    v_cmp_eq_u32 vcc, -1, v4
    s_cbranch_vccz pd_41
    s_sub_u32 s78, s78, 1
    s_cmp_lg_u32 s78, 0
    s_cbranch_scc1 pl_39
    s_mov_b32 s27, 1
pd_41:
    v_mov_b32 v4, v0
    s_nop 1
    v_max_f32_dpp v4, v4, v4 quad_perm:[1,0,3,2] row_mask:0xf bank_mask:0xf
    s_nop 1
    v_max_f32_dpp v4, v4, v4 quad_perm:[2,3,0,1] row_mask:0xf bank_mask:0xf
    s_nop 1
    v_max_f32_dpp v4, v4, v4 row_half_mirror row_mask:0xf bank_mask:0xf
    s_nop 1
    v_max_f32_dpp v4, v4, v4 row_mirror row_mask:0xf bank_mask:0xf
    v_mov_b32 v5, v4
    s_nop 1
    v_permlane16_swap_b32 v4, v5
    v_max_f32 v4, v4, v5
    v_mov_b32 v5, v4
    s_nop 1
    v_permlane32_swap_b32 v4, v5
    v_max_f32 v4, v4, v5
    v_cmp_eq_f32 vcc, v4, v0
    s_ff1_i32_b64 s32, vcc
    s_and_b32 s32, s32, 63
    s_lshl_b64 exec, 1, s32
    ds_write_b128 v189, v[0:3] offset:3072
    s_mov_b64 exec, -1
sk_38:
    s_waitcnt lgkmcnt(0)
    s_barrier
    ds_read_b32 v0, v189 offset:3076
    s_waitcnt lgkmcnt(0)
    v_and_b32 v0, 0x7ff, v0
    v_cmp_ne_u32 vcc, v0, v53
    s_mov_b64 exec, vcc
    buffer_store_dwordx4 v[64:67], v50, s[12:15], s33 offen offset:0
    buffer_store_dwordx4 v[68:71], v50, s[12:15], s33 offen offset:32
    buffer_store_dwordx4 v[72:75], v50, s[12:15], s33 offen offset:64
    buffer_store_dwordx4 v[76:79], v50, s[12:15], s33 offen offset:96
    s_mov_b64 exec, -1
    s_branch k_end
l_start:
    v_lshrrev_b32 v21, 3, v252
    v_lshrrev_b32 v20, 4, v252
    v_xor_b32 v20, v20, v252
    v_and_b32 v20, 7, v20
    v_lshlrev_b32 v20, 4, v20
    v_lshl_add_u32 v4, v21, 11, v20
    v_xor_b32 v5, 64, v4
    v_add_u32 v5, 15360, v5
    v_add_u32 v6, 30720, v4
    v_add_u32 v7, 30720, v5
    s_lshl_b32 s84, s99, 16
    s_lshl_b32 s85, s25, 7
    s_lshl_b32 s86, s28, 12
    s_mul_i32 s87, s28, 6144
    v_and_b32 v20, 4, v21
    v_add_u32 v20, v20, v21
    v_mul_u32_u24 v20, 6144, v20
    v_and_b32 v21, 6, v21
    v_xor_b32 v21, v21, v252
    v_and_b32 v21, 7, v21
    v_lshl_add_u32 v20, v21, 4, v20
    s_mul_i32 s32, s28, 3
    s_bfe_u32 s33, s32, 0x10001
    s_mul_i32 s33, s33, 196608
    s_and_b32 s34, s32, 1
    s_mul_i32 s34, s34, 24576
    s_add_u32 s33, s33, s34
    s_lshr_b32 s34, s32, 2
    s_lshl_b32 s34, s34, 11
    s_add_u32 s33, s33, s34
    v_add_u32 v8, s33, v20
    v_add_u32 v9, 97280, v8
    s_add_u32 s32, s32, 1
    s_bfe_u32 s33, s32, 0x10001
    s_mul_i32 s33, s33, 196608
    s_and_b32 s34, s32, 1
    s_mul_i32 s34, s34, 24576
    s_add_u32 s33, s33, s34
    s_lshr_b32 s34, s32, 2
    s_lshl_b32 s34, s34, 11
    s_add_u32 s33, s33, s34
    s_sub_u32 s33, s33, 2048
    v_add_u32 v10, s33, v20
    v_add_u32 v11, 97280, v10
    s_add_u32 s32, s32, 1
    s_bfe_u32 s33, s32, 0x10001
    s_mul_i32 s33, s33, 196608
    s_and_b32 s34, s32, 1
    s_mul_i32 s34, s34, 24576
    s_add_u32 s33, s33, s34
    s_lshr_b32 s34, s32, 2
    s_lshl_b32 s34, s34, 11
    s_add_u32 s33, s33, s34
    v_add_u32 v12, s33, v20
    v_add_u32 v13, 97280, v12
    s_waitcnt lgkmcnt(0)
    s_mov_b64 s[16:17], s[6:7]
    s_mov_b32 s6, 0x400000
    s_mov_b32 s7, 0x20000
    s_add_u32 s96, s94, 0
    s_and_b32 s96, s96, 15
    s_lshl_b32 s97, s96, 7
    s_add_u32 s97, s97, s84
    s_add_u32 m0, s86, 147456
    s_nop 0
    buffer_load_dwordx4 v4, s[4:7], s97 offen offset:0 lds
    buffer_load_dwordx4 v5, s[4:7], s97 offen offset:1024 lds
    buffer_load_dwordx4 v6, s[4:7], s97 offen offset:2048 lds
    buffer_load_dwordx4 v7, s[4:7], s97 offen offset:3072 lds
    s_add_u32 s96, s94, 0
    s_and_b32 s96, s96, 15
    s_mul_i32 s96, s96, 393216
    s_add_u32 s96, s96, s85
    s_add_u32 m0, s87, 40960
    s_nop 0
    buffer_load_dwordx4 v8, s[16:19], s96 offen offset:0 lds
    buffer_load_dwordx4 v9, s[16:19], s96 offen offset:1024 lds
    buffer_load_dwordx4 v10, s[16:19], s96 offen offset:2048 lds
    buffer_load_dwordx4 v11, s[16:19], s96 offen offset:3072 lds
    s_mov_b32 s40, 0xffffffff
    s_mov_b32 s41, 0xfffffff0
    s_mov_b32 s42, 0xfffffffe
    s_mov_b32 s43, 0xffffffe0
    s_mov_b32 s44, 0xfffffffc
    s_mov_b32 s45, 0xffffffc0
    s_mov_b32 s46, 0xfffffff8
    s_mov_b32 s47, 0xffffff80
    s_mov_b32 s48, 0xffff0000
    s_mov_b32 s49, 0xfff00000
    s_mov_b32 s50, 0xfffe0000
    s_mov_b32 s51, 0xffe00000
    s_mov_b32 s52, 0xfffc0000
    s_mov_b32 s53, 0xffc00000
    s_mov_b32 s54, 0xfff80000
    s_mov_b32 s55, 0xff800000
    s_mov_b32 s56, 0xffffff00
    s_mov_b32 s57, 0xfffff000
    s_mov_b32 s58, 0xfffffe00
    s_mov_b32 s59, 0xffffe000
    s_mov_b32 s60, 0xfffffc00
    s_mov_b32 s61, 0xffffc000
    s_mov_b32 s62, 0xfffff800
    s_mov_b32 s63, 0xffff8000
    s_mov_b32 s64, 0xff000000
    s_mov_b32 s65, 0xf0000000
    s_mov_b32 s66, 0xfe000000
    s_mov_b32 s67, 0xe0000000
    s_mov_b32 s68, 0xfc000000
    s_mov_b32 s69, 0xc0000000
    s_mov_b32 s70, 0xf8000000
    s_mov_b32 s71, 0x80000000
    v_bfe_u32 v20, v252, 3, 2
    v_lshrrev_b32 v21, 5, v252
    v_lshl_add_u32 v20, v21, 3, v20
    s_lshr_b32 s32, s28, 1
    s_lshl_b32 s32, s32, 4
    s_and_b32 s33, s28, 1
    s_lshl_b32 s33, s33, 2
    s_add_u32 s32, s32, s33
    v_add_u32 v20, s32, v20
    v_lshlrev_b32 v20, 11, v20
    v_lshrrev_b32 v21, 2, v252
    v_and_b32 v21, 4, v21
    v_xor_b32 v21, v21, v252
    v_and_b32 v21, 7, v21
    v_lshl_add_u32 v20, v21, 4, v20
    s_lshl_b32 s32, s98, 7
    v_add_u32 v14, s32, v20
    v_lshrrev_b32 v20, 2, v252
    v_lshlrev_b32 v20, 2, v20
    v_bfe_u32 v21, v252, 1, 1
    v_add_u32 v20, v20, v21
    v_mul_u32_u24 v20, 28672, v20
    v_and_b32 v21, 1, v252
    v_lshl_add_u32 v20, v21, 4, v20
    s_mul_i32 s30, s28, 1835008
    s_lshl_b32 s31, s29, 5
    s_add_u32 s30, s30, s31
    v_add_u32 v152, s30, v20
    v_lshlrev_b32 v21, 14, v21
    v_lshrrev_b32 v20, 1, v252
    v_lshl_add_u32 v20, v20, 4, v21
    s_lshl_b32 s30, s28, 9
    s_lshl_b32 s31, s29, 15
    s_add_u32 s30, s30, s31
    v_add_u32 v153, s30, v20
    s_getreg_b32 s88, hwreg(HW_REG_XCC_ID, 0, 4)
    s_or_b32 s88, s88, 16
    s_mov_b32 s73, -1
    s_mov_b32 s100, 0
    v_lshlrev_b32 v15, 2, v252
    s_add_u32 m0, s87, 45056
    s_nop 0
    buffer_load_dwordx4 v12, s[16:19], s96 offen offset:0 lds
    buffer_load_dwordx4 v13, s[16:19], s96 offen offset:1024 lds
    s_add_u32 s96, s95, 1
    s_and_b32 s96, s96, 15
    s_lshl_b32 s97, s96, 7
    s_add_u32 s97, s97, s84
    s_add_u32 m0, s86, 131072
    s_nop 0
    buffer_load_dwordx4 v4, s[4:7], s97 offen offset:0 lds
    buffer_load_dwordx4 v5, s[4:7], s97 offen offset:1024 lds
    buffer_load_dwordx4 v6, s[4:7], s97 offen offset:2048 lds
    buffer_load_dwordx4 v7, s[4:7], s97 offen offset:3072 lds
    s_add_u32 s96, s95, 1
    s_and_b32 s96, s96, 15
    s_mul_i32 s96, s96, 393216
    s_add_u32 s96, s96, s85
    s_add_u32 m0, s87, 65536
    s_nop 0
    buffer_load_dwordx4 v8, s[16:19], s96 offen offset:0 lds
    buffer_load_dwordx4 v9, s[16:19], s96 offen offset:1024 lds
    buffer_load_dwordx4 v10, s[16:19], s96 offen offset:2048 lds
    s_waitcnt vmcnt(7)
    s_barrier
    buffer_load_dwordx4 v11, s[16:19], s96 offen offset:3072 lds
    s_add_u32 m0, s87, 69632
    s_nop 0
    buffer_load_dwordx4 v12, s[16:19], s96 offen offset:0 lds
    buffer_load_dwordx4 v13, s[16:19], s96 offen offset:1024 lds
    s_add_u32 s96, s94, 2
    s_and_b32 s96, s96, 15
    s_lshl_b32 s97, s96, 7
    s_add_u32 s97, s97, s84
    s_add_u32 m0, s86, 114688
    s_nop 0
    buffer_load_dwordx4 v4, s[4:7], s97 offen offset:0 lds
    buffer_load_dwordx4 v5, s[4:7], s97 offen offset:1024 lds
    buffer_load_dwordx4 v6, s[4:7], s97 offen offset:2048 lds
    buffer_load_dwordx4 v7, s[4:7], s97 offen offset:3072 lds
    s_add_u32 s96, s94, 2
    s_and_b32 s96, s96, 15
    s_mul_i32 s96, s96, 393216
    s_add_u32 s96, s96, s85
    s_add_u32 m0, s87, 90112
    s_nop 0
    buffer_load_dwordx4 v8, s[16:19], s96 offen offset:0 lds
    buffer_load_dwordx4 v9, s[16:19], s96 offen offset:1024 lds
    buffer_load_dwordx4 v10, s[16:19], s96 offen offset:2048 lds
    buffer_load_dwordx4 v11, s[16:19], s96 offen offset:3072 lds
    s_add_u32 m0, s87, 94208
    s_nop 0
    buffer_load_dwordx4 v12, s[16:19], s96 offen offset:0 lds
    buffer_load_dwordx4 v13, s[16:19], s96 offen offset:1024 lds
    s_waitcnt vmcnt(10) lgkmcnt(0)
    s_barrier
    s_add_u32 s96, s95, 3
    s_and_b32 s96, s96, 15
    s_lshl_b32 s97, s96, 7
    s_add_u32 s97, s97, s84
    s_add_u32 m0, s86, 147456
    s_nop 0
    buffer_load_dwordx4 v4, s[4:7], s97 offen offset:0 lds
    buffer_load_dwordx4 v5, s[4:7], s97 offen offset:1024 lds
    buffer_load_dwordx4 v6, s[4:7], s97 offen offset:2048 lds
    buffer_load_dwordx4 v7, s[4:7], s97 offen offset:3072 lds
    s_add_u32 s96, s95, 3
    s_and_b32 s96, s96, 15
    s_mul_i32 s96, s96, 393216
    s_add_u32 s96, s96, s85
    s_add_u32 m0, s87, 40960
    s_nop 0
    buffer_load_dwordx4 v8, s[16:19], s96 offen offset:0 lds
    buffer_load_dwordx4 v9, s[16:19], s96 offen offset:1024 lds
    v_and_b32 v28, 31, v252
    v_bfe_u32 v29, v28, 1, 3
    v_lshrrev_b32 v30, 5, v252
    v_xor_b32 v29, v29, v30
    v_lshlrev_b32 v29, 4, v29
    v_lshl_add_u32 v28, v28, 7, v29
    s_add_u32 s30, s86, 131072
    v_add_u32 v28, s30, v28
    v_xor_b32 v29, 32, v28
    v_xor_b32 v30, 64, v28
    v_xor_b32 v31, 96, v28
    ds_read_b128 v[32:35], v28
    ds_read_b128 v[36:39], v29
    ds_read_b128 v[40:43], v30
    buffer_load_dwordx4 v10, s[16:19], s96 offen offset:2048 lds
    ds_read_b128 v[44:47], v31
    s_min_u32 s30, s28, 2
    s_lshl_b32 s30, s30, 13
    s_add_u32 s30, s30, 65536
    v_lshrrev_b32 v20, 2, v252
    v_bfe_u32 v21, v20, 1, 2
    v_lshlrev_b32 v20, 7, v20
    v_lshl_add_u32 v20, v21, 5, v20
    v_and_b32 v21, 3, v252
    v_lshl_add_u32 v20, v21, 3, v20
    v_add_u32 v144, s30, v20
    v_xor_b32 v145, 32, v144
    v_xor_b32 v146, 64, v144
    v_xor_b32 v147, 96, v144
    buffer_load_dwordx4 v11, s[16:19], s96 offen offset:3072 lds
    ds_read_b64_tr_b16 v[100:101], v144 offset:0
    ds_read_b64_tr_b16 v[102:103], v144 offset:2048
    ds_read_b64_tr_b16 v[104:105], v144 offset:4096
    ds_read_b64_tr_b16 v[106:107], v144 offset:6144
    ds_read_b64_tr_b16 v[108:109], v145 offset:0
    ds_read_b64_tr_b16 v[110:111], v145 offset:2048
    ds_read_b64_tr_b16 v[112:113], v145 offset:4096
    ds_read_b64_tr_b16 v[114:115], v145 offset:6144
    ds_read_b64_tr_b16 v[116:117], v146 offset:0
    ds_read_b64_tr_b16 v[118:119], v146 offset:2048
    ds_read_b64_tr_b16 v[120:121], v146 offset:4096
    ds_read_b64_tr_b16 v[122:123], v146 offset:6144
    ds_read_b64_tr_b16 v[124:125], v147 offset:0
    ds_read_b64_tr_b16 v[126:127], v147 offset:2048
    s_add_u32 m0, s87, 45056
    s_nop 0
    buffer_load_dwordx4 v12, s[16:19], s96 offen offset:0 lds
    ds_read_b64_tr_b16 v[128:129], v147 offset:4096
    ds_read_b64_tr_b16 v[130:131], v147 offset:6144
    v_mov_b32 v16, -1
    v_mov_b32 v17, -1
    v_mov_b32 v18, -1
    v_mov_b32 v19, -1
    s_lshr_b32 s30, s28, 1
    s_mul_i32 s30, s30, 16777216
    s_and_b32 s31, s28, 1
    s_lshl_b32 s32, s31, 20
    s_lshl_b32 s33, s72, 10
    s_add_u32 s32, s32, s33
    s_add_u32 s32, s32, s30
    s_add_u32 s32, s32, 0xc00000
    buffer_load_dwordx4 v13, s[16:19], s96 offen offset:1024 lds
    buffer_store_dwordx4 v[16:19], v253, s[20:23], s32 offen sc1
    s_add_u32 s32, s32, 262144
    buffer_store_dwordx4 v[16:19], v253, s[20:23], s32 offen sc1
    s_add_u32 s32, s32, 262144
    buffer_store_dwordx4 v[16:19], v253, s[20:23], s32 offen sc1
    s_add_u32 s32, s32, 262144
    s_lshl_b32 s33, s72, 7
    s_add_u32 s33, s33, s30
    s_add_u32 s33, s33, 0xdc0000
    s_cmp_eq_u32 s31, 0
    s_cselect_b32 s32, s32, s33
    s_cselect_b64 exec, -1, 0xff
    buffer_store_dwordx4 v[16:19], v253, s[20:23], s32 offen sc1
    s_mov_b64 exec, -1
    s_waitcnt vmcnt(14) lgkmcnt(0)
    s_barrier
    s_add_u32 s96, s94, 4
    s_and_b32 s96, s96, 15
    s_lshl_b32 s97, s96, 7
    s_add_u32 s97, s97, s84
    s_add_u32 m0, s86, 131072
    s_nop 0
    buffer_load_dwordx4 v4, s[4:7], s97 offen offset:0 lds
    buffer_load_dwordx4 v5, s[4:7], s97 offen offset:1024 lds
    v_mov_b32 v48, 0
    v_mov_b32 v49, 0
    v_mov_b32 v50, 0
    v_mov_b32 v51, 0
    s_lshl_b32 s30, s99, 13
    s_lshl_b32 s31, s25, 9
    s_add_u32 s30, s30, s31
    s_add_u32 s30, s30, 0x2400000
    v_dot2c_f32_bf16 v48, 0x3f803f80, v32
    v_dot2c_f32_bf16 v49, v32, v32
    buffer_load_dwordx4 v6, s[4:7], s97 offen offset:2048 lds
    v_dot2c_f32_bf16 v50, 0x3f803f80, v33
    v_dot2c_f32_bf16 v51, v33, v33
    v_dot2c_f32_bf16 v48, 0x3f803f80, v34
    v_dot2c_f32_bf16 v49, v34, v34
    v_dot2c_f32_bf16 v50, 0x3f803f80, v35
    v_dot2c_f32_bf16 v51, v35, v35
    v_dot2c_f32_bf16 v48, 0x3f803f80, v36
    v_dot2c_f32_bf16 v49, v36, v36
    v_dot2c_f32_bf16 v50, 0x3f803f80, v37
    v_dot2c_f32_bf16 v51, v37, v37
    buffer_load_dwordx4 v7, s[4:7], s97 offen offset:3072 lds
    v_dot2c_f32_bf16 v48, 0x3f803f80, v38
    v_dot2c_f32_bf16 v49, v38, v38
    v_dot2c_f32_bf16 v50, 0x3f803f80, v39
    v_dot2c_f32_bf16 v51, v39, v39
    v_dot2c_f32_bf16 v48, 0x3f803f80, v40
    v_dot2c_f32_bf16 v49, v40, v40
    v_dot2c_f32_bf16 v50, 0x3f803f80, v41
    v_dot2c_f32_bf16 v51, v41, v41
    v_dot2c_f32_bf16 v48, 0x3f803f80, v42
    v_dot2c_f32_bf16 v49, v42, v42
    s_add_u32 s96, s94, 4
    s_and_b32 s96, s96, 15
    s_mul_i32 s96, s96, 393216
    s_add_u32 s96, s96, s85
    s_add_u32 m0, s87, 65536
    s_nop 0
    buffer_load_dwordx4 v8, s[16:19], s96 offen offset:0 lds
    v_dot2c_f32_bf16 v50, 0x3f803f80, v43
    v_dot2c_f32_bf16 v51, v43, v43
    v_dot2c_f32_bf16 v48, 0x3f803f80, v44
    v_dot2c_f32_bf16 v49, v44, v44
    v_dot2c_f32_bf16 v50, 0x3f803f80, v45
    v_dot2c_f32_bf16 v51, v45, v45
    v_dot2c_f32_bf16 v48, 0x3f803f80, v46
    v_dot2c_f32_bf16 v49, v46, v46
    v_dot2c_f32_bf16 v50, 0x3f803f80, v47
    v_dot2c_f32_bf16 v51, v47, v47
    buffer_load_dwordx4 v9, s[16:19], s96 offen offset:1024 lds
    s_nop 1
    v_pk_add_f32 v[48:49], v[48:49], v[50:51]
    v_mov_b32 v50, v48
    v_mov_b32 v51, v49
    s_nop 0
    v_permlane32_swap_b32 v48, v50
    v_permlane32_swap_b32 v49, v51
    v_pk_add_f32 v[48:49], v[48:49], v[50:51]
    s_mov_b32 exec_hi, 0
    buffer_store_dwordx4 v[48:51], v253, s[20:23], s30 offen sc1
    s_mov_b64 exec, -1
    v_mov_b32 v140, 0
    buffer_load_dwordx4 v10, s[16:19], s96 offen offset:2048 lds
    v_mov_b32 v141, 0
    v_mov_b32 v142, 0
    v_mov_b32 v143, 0
    v_dot2c_f32_bf16 v140, 0x3f803f80, v100
    v_dot2c_f32_bf16 v141, 0x3f803f80, v108
    v_dot2c_f32_bf16 v142, 0x3f803f80, v116
    v_dot2c_f32_bf16 v143, 0x3f803f80, v124
    v_dot2c_f32_bf16 v140, 0x3f803f80, v101
    v_dot2c_f32_bf16 v141, 0x3f803f80, v109
    v_dot2c_f32_bf16 v142, 0x3f803f80, v117
    buffer_load_dwordx4 v11, s[16:19], s96 offen offset:3072 lds
    v_dot2c_f32_bf16 v143, 0x3f803f80, v125
    v_dot2c_f32_bf16 v140, 0x3f803f80, v102
    v_dot2c_f32_bf16 v141, 0x3f803f80, v110
    v_dot2c_f32_bf16 v142, 0x3f803f80, v118
    v_dot2c_f32_bf16 v143, 0x3f803f80, v126
    v_dot2c_f32_bf16 v140, 0x3f803f80, v103
    v_dot2c_f32_bf16 v141, 0x3f803f80, v111
    v_dot2c_f32_bf16 v142, 0x3f803f80, v119
    v_dot2c_f32_bf16 v143, 0x3f803f80, v127
    v_dot2c_f32_bf16 v140, 0x3f803f80, v104
    s_add_u32 m0, s87, 69632
    s_nop 0
    buffer_load_dwordx4 v12, s[16:19], s96 offen offset:0 lds
    v_dot2c_f32_bf16 v141, 0x3f803f80, v112
    v_dot2c_f32_bf16 v142, 0x3f803f80, v120
    v_dot2c_f32_bf16 v143, 0x3f803f80, v128
    v_dot2c_f32_bf16 v140, 0x3f803f80, v105
    v_dot2c_f32_bf16 v141, 0x3f803f80, v113
    v_dot2c_f32_bf16 v142, 0x3f803f80, v121
    v_dot2c_f32_bf16 v143, 0x3f803f80, v129
    v_dot2c_f32_bf16 v140, 0x3f803f80, v106
    v_dot2c_f32_bf16 v141, 0x3f803f80, v114
    v_dot2c_f32_bf16 v142, 0x3f803f80, v122
    buffer_load_dwordx4 v13, s[16:19], s96 offen offset:1024 lds
    v_dot2c_f32_bf16 v143, 0x3f803f80, v130
    v_dot2c_f32_bf16 v140, 0x3f803f80, v107
    v_dot2c_f32_bf16 v141, 0x3f803f80, v115
    v_dot2c_f32_bf16 v142, 0x3f803f80, v123
    v_dot2c_f32_bf16 v143, 0x3f803f80, v131
    s_min_u32 s32, s28, 2
    s_lshl_b32 s32, s32, 12
    s_lshl_b32 s33, s25, 14
    s_add_u32 s32, s32, s33
    s_add_u32 s32, s32, 0x2500000
    s_load_dwordx2 s[80:81], s[0:1], 40
    s_cmp_lt_u32 s29, 224
    s_cselect_b32 s82, 0x700000, 0
    s_mov_b32 s83, 0x20000
    s_waitcnt lgkmcnt(0)
    s_xor_b32 s96, s29, 0
    s_and_b32 s97, s96, 2
    s_and_b32 s96, s96, 3
    s_mul_i32 s97, s97, 14336
    s_mul_i32 s96, s96, 14336
    s_add_u32 s96, s96, s97
    buffer_load_dwordx4 v[156:159], v152, s[80:83], s96 offen
    s_lshl_b32 s33, s24, 8
    s_add_u32 s32, s32, s33
    v_lshlrev_b32 v20, 2, v252
    v_permlane32_swap_b32 v140, v142
    v_permlane32_swap_b32 v141, v143
    v_add_f32 v140, v140, v142
    v_add_f32 v141, v141, v143
    s_nop 1
    v_permlane16_swap_b32 v140, v141
    v_add_f32 v140, v140, v141
    buffer_store_dword v140, v20, s[20:23], s32 offen sc1
    s_waitcnt vmcnt(17) lgkmcnt(0)
    s_barrier
    s_add_u32 s96, s95, 5
    s_and_b32 s96, s96, 15
    s_lshl_b32 s97, s96, 7
    s_add_u32 s97, s97, s84
    s_add_u32 m0, s86, 114688
    s_nop 0
    buffer_load_dwordx4 v4, s[4:7], s97 offen offset:0 lds
    buffer_load_dwordx4 v5, s[4:7], s97 offen offset:1024 lds
    buffer_load_dwordx4 v6, s[4:7], s97 offen offset:2048 lds
    buffer_load_dwordx4 v7, s[4:7], s97 offen offset:3072 lds
    s_add_u32 s96, s95, 5
    s_and_b32 s96, s96, 15
    s_mul_i32 s96, s96, 393216
    s_add_u32 s96, s96, s85
    s_add_u32 m0, s87, 90112
    s_nop 0
    buffer_load_dwordx4 v8, s[16:19], s96 offen offset:0 lds
    buffer_load_dwordx4 v9, s[16:19], s96 offen offset:1024 lds
    buffer_load_dwordx4 v10, s[16:19], s96 offen offset:2048 lds
    buffer_load_dwordx4 v11, s[16:19], s96 offen offset:3072 lds
    s_add_u32 m0, s87, 94208
    s_nop 0
    buffer_load_dwordx4 v12, s[16:19], s96 offen offset:0 lds
    buffer_load_dwordx4 v13, s[16:19], s96 offen offset:1024 lds
    s_add_u32 s96, s25, 1
    s_and_b32 s96, s96, 15
    s_lshl_b32 s96, s96, 17
    s_add_u32 m0, s101, 4096
    s_nop 0
    buffer_load_dwordx4 v14, s[8:11], s96 offen lds
    s_xor_b32 s96, s29, 0
    s_and_b32 s97, s96, 2
    s_and_b32 s96, s96, 3
    s_mul_i32 s97, s97, 14336
    s_mul_i32 s96, s96, 14336
    s_add_u32 s96, s96, s97
    s_add_u32 s96, s96, 7168
    buffer_load_dwordx4 v[160:163], v152, s[80:83], s96 offen
    s_waitcnt vmcnt(14) lgkmcnt(0)
    s_barrier
    s_add_u32 s96, s94, 6
    s_and_b32 s96, s96, 15
    s_lshl_b32 s97, s96, 7
    s_add_u32 s97, s97, s84
    s_add_u32 m0, s86, 147456
    s_nop 0
    buffer_load_dwordx4 v4, s[4:7], s97 offen offset:0 lds
    buffer_load_dwordx4 v5, s[4:7], s97 offen offset:1024 lds
    buffer_load_dwordx4 v6, s[4:7], s97 offen offset:2048 lds
    buffer_load_dwordx4 v7, s[4:7], s97 offen offset:3072 lds
    s_add_u32 s96, s94, 6
    s_and_b32 s96, s96, 15
    s_mul_i32 s96, s96, 393216
    s_add_u32 s96, s96, s85
    s_add_u32 m0, s87, 40960
    s_nop 0
    buffer_load_dwordx4 v8, s[16:19], s96 offen offset:0 lds
    buffer_load_dwordx4 v9, s[16:19], s96 offen offset:1024 lds
    buffer_load_dwordx4 v10, s[16:19], s96 offen offset:2048 lds
    buffer_load_dwordx4 v11, s[16:19], s96 offen offset:3072 lds
    s_add_u32 m0, s87, 45056
    s_nop 0
    buffer_load_dwordx4 v12, s[16:19], s96 offen offset:0 lds
    buffer_load_dwordx4 v13, s[16:19], s96 offen offset:1024 lds
    s_add_u32 s96, s25, 2
    s_and_b32 s96, s96, 15
    s_lshl_b32 s96, s96, 17
    s_add_u32 m0, s101, 8192
    s_nop 0
    buffer_load_dwordx4 v14, s[8:11], s96 offen lds
    s_xor_b32 s96, s29, 1
    s_and_b32 s97, s96, 2
    s_and_b32 s96, s96, 3
    s_mul_i32 s97, s97, 14336
    s_mul_i32 s96, s96, 14336
    s_add_u32 s96, s96, s97
    buffer_load_dwordx4 v[164:167], v152, s[80:83], s96 offen
    s_waitcnt vmcnt(14) lgkmcnt(0)
    s_barrier
    s_add_u32 s96, s95, 7
    s_and_b32 s96, s96, 15
    s_lshl_b32 s97, s96, 7
    s_add_u32 s97, s97, s84
    s_add_u32 m0, s86, 131072
    s_nop 0
    buffer_load_dwordx4 v4, s[4:7], s97 offen offset:0 lds
    buffer_load_dwordx4 v5, s[4:7], s97 offen offset:1024 lds
    buffer_load_dwordx4 v6, s[4:7], s97 offen offset:2048 lds
    buffer_load_dwordx4 v7, s[4:7], s97 offen offset:3072 lds
    s_add_u32 s96, s95, 7
    s_and_b32 s96, s96, 15
    s_mul_i32 s96, s96, 393216
    s_add_u32 s96, s96, s85
    s_add_u32 m0, s87, 65536
    s_nop 0
    buffer_load_dwordx4 v8, s[16:19], s96 offen offset:0 lds
    buffer_load_dwordx4 v9, s[16:19], s96 offen offset:1024 lds
    buffer_load_dwordx4 v10, s[16:19], s96 offen offset:2048 lds
    buffer_load_dwordx4 v11, s[16:19], s96 offen offset:3072 lds
    s_add_u32 m0, s87, 69632
    s_nop 0
    buffer_load_dwordx4 v12, s[16:19], s96 offen offset:0 lds
    buffer_load_dwordx4 v13, s[16:19], s96 offen offset:1024 lds
    s_add_u32 s96, s25, 3
    s_and_b32 s96, s96, 15
    s_lshl_b32 s96, s96, 17
    s_add_u32 m0, s101, 12288
    s_nop 0
    buffer_load_dwordx4 v14, s[8:11], s96 offen lds
    s_xor_b32 s96, s29, 1
    s_and_b32 s97, s96, 2
    s_and_b32 s96, s96, 3
    s_mul_i32 s97, s97, 14336
    s_mul_i32 s96, s96, 14336
    s_add_u32 s96, s96, s97
    s_add_u32 s96, s96, 7168
    buffer_load_dwordx4 v[168:171], v152, s[80:83], s96 offen
    s_waitcnt vmcnt(14) lgkmcnt(0)
    s_barrier
    s_add_u32 s96, s94, 8
    s_and_b32 s96, s96, 15
    s_lshl_b32 s97, s96, 7
    s_add_u32 s97, s97, s84
    s_add_u32 m0, s86, 114688
    s_nop 0
    buffer_load_dwordx4 v4, s[4:7], s97 offen offset:0 lds
    buffer_load_dwordx4 v5, s[4:7], s97 offen offset:1024 lds
    buffer_load_dwordx4 v6, s[4:7], s97 offen offset:2048 lds
    buffer_load_dwordx4 v7, s[4:7], s97 offen offset:3072 lds
    s_add_u32 s96, s94, 8
    s_and_b32 s96, s96, 15
    s_mul_i32 s96, s96, 393216
    s_add_u32 s96, s96, s85
    s_add_u32 m0, s87, 90112
    s_nop 0
    buffer_load_dwordx4 v8, s[16:19], s96 offen offset:0 lds
    buffer_load_dwordx4 v9, s[16:19], s96 offen offset:1024 lds
    buffer_load_dwordx4 v10, s[16:19], s96 offen offset:2048 lds
    buffer_load_dwordx4 v11, s[16:19], s96 offen offset:3072 lds
    s_add_u32 m0, s87, 94208
    s_nop 0
    buffer_load_dwordx4 v12, s[16:19], s96 offen offset:0 lds
    buffer_load_dwordx4 v13, s[16:19], s96 offen offset:1024 lds
    s_add_u32 s96, s25, 4
    s_and_b32 s96, s96, 15
    s_lshl_b32 s96, s96, 17
    s_add_u32 m0, s101, 16384
    s_nop 0
    buffer_load_dwordx4 v14, s[8:11], s96 offen lds
    s_xor_b32 s96, s29, 2
    s_and_b32 s97, s96, 2
    s_and_b32 s96, s96, 3
    s_mul_i32 s97, s97, 14336
    s_mul_i32 s96, s96, 14336
    s_add_u32 s96, s96, s97
    buffer_load_dwordx4 v[172:175], v152, s[80:83], s96 offen
    s_waitcnt vmcnt(14) lgkmcnt(0)
    s_barrier
    s_add_u32 s96, s95, 9
    s_and_b32 s96, s96, 15
    s_lshl_b32 s97, s96, 7
    s_add_u32 s97, s97, s84
    s_add_u32 m0, s86, 147456
    s_nop 0
    buffer_load_dwordx4 v4, s[4:7], s97 offen offset:0 lds
    buffer_load_dwordx4 v5, s[4:7], s97 offen offset:1024 lds
    buffer_load_dwordx4 v6, s[4:7], s97 offen offset:2048 lds
    buffer_load_dwordx4 v7, s[4:7], s97 offen offset:3072 lds
    s_add_u32 s96, s95, 9
    s_and_b32 s96, s96, 15
    s_mul_i32 s96, s96, 393216
    s_add_u32 s96, s96, s85
    s_add_u32 m0, s87, 40960
    s_nop 0
    buffer_load_dwordx4 v8, s[16:19], s96 offen offset:0 lds
    buffer_load_dwordx4 v9, s[16:19], s96 offen offset:1024 lds
    buffer_load_dwordx4 v10, s[16:19], s96 offen offset:2048 lds
    buffer_load_dwordx4 v11, s[16:19], s96 offen offset:3072 lds
    s_add_u32 m0, s87, 45056
    s_nop 0
    buffer_load_dwordx4 v12, s[16:19], s96 offen offset:0 lds
    buffer_load_dwordx4 v13, s[16:19], s96 offen offset:1024 lds
    s_add_u32 s96, s25, 5
    s_and_b32 s96, s96, 15
    s_lshl_b32 s96, s96, 17
    s_add_u32 m0, s101, 20480
    s_nop 0
    buffer_load_dwordx4 v14, s[8:11], s96 offen lds
    s_xor_b32 s96, s29, 2
    s_and_b32 s97, s96, 2
    s_and_b32 s96, s96, 3
    s_mul_i32 s97, s97, 14336
    s_mul_i32 s96, s96, 14336
    s_add_u32 s96, s96, s97
    s_add_u32 s96, s96, 7168
    buffer_load_dwordx4 v[176:179], v152, s[80:83], s96 offen
    s_waitcnt vmcnt(14) lgkmcnt(0)
    s_barrier
    s_add_u32 s96, s94, 10
    s_and_b32 s96, s96, 15
    s_lshl_b32 s97, s96, 7
    s_add_u32 s97, s97, s84
    s_add_u32 m0, s86, 131072
    s_nop 0
    buffer_load_dwordx4 v4, s[4:7], s97 offen offset:0 lds
    buffer_load_dwordx4 v5, s[4:7], s97 offen offset:1024 lds
    buffer_load_dwordx4 v6, s[4:7], s97 offen offset:2048 lds
    buffer_load_dwordx4 v7, s[4:7], s97 offen offset:3072 lds
    s_add_u32 s96, s94, 10
    s_and_b32 s96, s96, 15
    s_mul_i32 s96, s96, 393216
    s_add_u32 s96, s96, s85
    s_add_u32 m0, s87, 65536
    s_nop 0
    buffer_load_dwordx4 v8, s[16:19], s96 offen offset:0 lds
    buffer_load_dwordx4 v9, s[16:19], s96 offen offset:1024 lds
    buffer_load_dwordx4 v10, s[16:19], s96 offen offset:2048 lds
    buffer_load_dwordx4 v11, s[16:19], s96 offen offset:3072 lds
    s_add_u32 m0, s87, 69632
    s_nop 0
    buffer_load_dwordx4 v12, s[16:19], s96 offen offset:0 lds
    buffer_load_dwordx4 v13, s[16:19], s96 offen offset:1024 lds
    s_add_u32 s96, s25, 6
    s_and_b32 s96, s96, 15
    s_lshl_b32 s96, s96, 17
    s_add_u32 m0, s101, 24576
    s_nop 0
    buffer_load_dwordx4 v14, s[8:11], s96 offen lds
    s_xor_b32 s96, s29, 3
    s_and_b32 s97, s96, 2
    s_and_b32 s96, s96, 3
    s_mul_i32 s97, s97, 14336
    s_mul_i32 s96, s96, 14336
    s_add_u32 s96, s96, s97
    buffer_load_dwordx4 v[180:183], v152, s[80:83], s96 offen
    s_waitcnt vmcnt(14) lgkmcnt(0)
    s_barrier
    s_add_u32 s96, s95, 11
    s_and_b32 s96, s96, 15
    s_lshl_b32 s97, s96, 7
    s_add_u32 s97, s97, s84
    s_add_u32 m0, s86, 114688
    s_nop 0
    buffer_load_dwordx4 v4, s[4:7], s97 offen offset:0 lds
    buffer_load_dwordx4 v5, s[4:7], s97 offen offset:1024 lds
    buffer_load_dwordx4 v6, s[4:7], s97 offen offset:2048 lds
    buffer_load_dwordx4 v7, s[4:7], s97 offen offset:3072 lds
    s_add_u32 s96, s95, 11
    s_and_b32 s96, s96, 15
    s_mul_i32 s96, s96, 393216
    s_add_u32 s96, s96, s85
    s_add_u32 m0, s87, 90112
    s_nop 0
    buffer_load_dwordx4 v8, s[16:19], s96 offen offset:0 lds
    buffer_load_dwordx4 v9, s[16:19], s96 offen offset:1024 lds
    buffer_load_dwordx4 v10, s[16:19], s96 offen offset:2048 lds
    buffer_load_dwordx4 v11, s[16:19], s96 offen offset:3072 lds
    s_add_u32 m0, s87, 94208
    s_nop 0
    buffer_load_dwordx4 v12, s[16:19], s96 offen offset:0 lds
    buffer_load_dwordx4 v13, s[16:19], s96 offen offset:1024 lds
    s_add_u32 s96, s25, 7
    s_and_b32 s96, s96, 15
    s_lshl_b32 s96, s96, 17
    s_add_u32 m0, s101, 28672
    s_nop 0
    buffer_load_dwordx4 v14, s[8:11], s96 offen lds
    s_xor_b32 s96, s29, 3
    s_and_b32 s97, s96, 2
    s_and_b32 s96, s96, 3
    s_mul_i32 s97, s97, 14336
    s_mul_i32 s96, s96, 14336
    s_add_u32 s96, s96, s97
    s_add_u32 s96, s96, 7168
    buffer_load_dwordx4 v[184:187], v152, s[80:83], s96 offen
    s_waitcnt vmcnt(14) lgkmcnt(0)
    s_barrier
    s_add_u32 s96, s94, 12
    s_and_b32 s96, s96, 15
    s_lshl_b32 s97, s96, 7
    s_add_u32 s97, s97, s84
    s_add_u32 m0, s86, 147456
    s_nop 0
    buffer_load_dwordx4 v4, s[4:7], s97 offen offset:0 lds
    buffer_load_dwordx4 v5, s[4:7], s97 offen offset:1024 lds
    buffer_load_dwordx4 v6, s[4:7], s97 offen offset:2048 lds
    buffer_load_dwordx4 v7, s[4:7], s97 offen offset:3072 lds
    s_add_u32 s96, s94, 12
    s_and_b32 s96, s96, 15
    s_mul_i32 s96, s96, 393216
    s_add_u32 s96, s96, s85
    s_add_u32 m0, s87, 40960
    s_nop 0
    buffer_load_dwordx4 v8, s[16:19], s96 offen offset:0 lds
    buffer_load_dwordx4 v9, s[16:19], s96 offen offset:1024 lds
    buffer_load_dwordx4 v10, s[16:19], s96 offen offset:2048 lds
    buffer_load_dwordx4 v11, s[16:19], s96 offen offset:3072 lds
    s_add_u32 m0, s87, 45056
    s_nop 0
    buffer_load_dwordx4 v12, s[16:19], s96 offen offset:0 lds
    buffer_load_dwordx4 v13, s[16:19], s96 offen offset:1024 lds
    s_add_u32 s96, s25, 8
    s_and_b32 s96, s96, 15
    s_lshl_b32 s96, s96, 17
    s_add_u32 m0, s101, 32768
    s_nop 0
    buffer_load_dwordx4 v14, s[8:11], s96 offen lds
    s_load_dwordx2 s[80:81], s[0:1], 48
    s_cmp_lt_u32 s29, 224
    s_cselect_b32 s82, 0x700000, 0
    s_mov_b32 s83, 0x20000
    s_waitcnt lgkmcnt(0)
    s_xor_b32 s96, s29, 0
    s_and_b32 s97, s96, 2
    s_and_b32 s96, s96, 3
    s_mul_i32 s97, s97, 14336
    s_mul_i32 s96, s96, 14336
    s_add_u32 s96, s96, s97
    buffer_load_dwordx4 v[188:191], v152, s[80:83], s96 offen
    s_waitcnt vmcnt(14) lgkmcnt(0)
    s_barrier
    s_add_u32 s96, s95, 13
    s_and_b32 s96, s96, 15
    s_lshl_b32 s97, s96, 7
    s_add_u32 s97, s97, s84
    s_add_u32 m0, s86, 131072
    s_nop 0
    buffer_load_dwordx4 v4, s[4:7], s97 offen offset:0 lds
    buffer_load_dwordx4 v5, s[4:7], s97 offen offset:1024 lds
    buffer_load_dwordx4 v6, s[4:7], s97 offen offset:2048 lds
    buffer_load_dwordx4 v7, s[4:7], s97 offen offset:3072 lds
    s_add_u32 s96, s95, 13
    s_and_b32 s96, s96, 15
    s_mul_i32 s96, s96, 393216
    s_add_u32 s96, s96, s85
    s_add_u32 m0, s87, 65536
    s_nop 0
    buffer_load_dwordx4 v8, s[16:19], s96 offen offset:0 lds
    buffer_load_dwordx4 v9, s[16:19], s96 offen offset:1024 lds
    buffer_load_dwordx4 v10, s[16:19], s96 offen offset:2048 lds
    buffer_load_dwordx4 v11, s[16:19], s96 offen offset:3072 lds
    s_add_u32 m0, s87, 69632
    s_nop 0
    buffer_load_dwordx4 v12, s[16:19], s96 offen offset:0 lds
    buffer_load_dwordx4 v13, s[16:19], s96 offen offset:1024 lds
    s_add_u32 s96, s25, 9
    s_and_b32 s96, s96, 15
    s_lshl_b32 s96, s96, 17
    s_add_u32 m0, s101, 36864
    s_nop 0
    buffer_load_dwordx4 v14, s[8:11], s96 offen lds
    s_xor_b32 s96, s29, 0
    s_and_b32 s97, s96, 2
    s_and_b32 s96, s96, 3
    s_mul_i32 s97, s97, 14336
    s_mul_i32 s96, s96, 14336
    s_add_u32 s96, s96, s97
    s_add_u32 s96, s96, 7168
    buffer_load_dwordx4 v[192:195], v152, s[80:83], s96 offen
    s_waitcnt vmcnt(14) lgkmcnt(0)
    s_barrier
    buffer_load_dword v16, v15, s[12:15], 0 offen sc1
    s_add_u32 s96, s94, 14
    s_and_b32 s96, s96, 15
    s_lshl_b32 s97, s96, 7
    s_add_u32 s97, s97, s84
    s_add_u32 m0, s86, 114688
    s_nop 0
    buffer_load_dwordx4 v4, s[4:7], s97 offen offset:0 lds
    buffer_load_dwordx4 v5, s[4:7], s97 offen offset:1024 lds
    buffer_load_dwordx4 v6, s[4:7], s97 offen offset:2048 lds
    buffer_load_dwordx4 v7, s[4:7], s97 offen offset:3072 lds
    s_add_u32 s96, s94, 14
    s_and_b32 s96, s96, 15
    s_mul_i32 s96, s96, 393216
    s_add_u32 s96, s96, s85
    s_add_u32 m0, s87, 90112
    s_nop 0
    buffer_load_dwordx4 v8, s[16:19], s96 offen offset:0 lds
    buffer_load_dwordx4 v9, s[16:19], s96 offen offset:1024 lds
    buffer_load_dwordx4 v10, s[16:19], s96 offen offset:2048 lds
    buffer_load_dwordx4 v11, s[16:19], s96 offen offset:3072 lds
    s_add_u32 m0, s87, 94208
    s_nop 0
    buffer_load_dwordx4 v12, s[16:19], s96 offen offset:0 lds
    buffer_load_dwordx4 v13, s[16:19], s96 offen offset:1024 lds
    s_xor_b32 s96, s29, 1
    s_and_b32 s97, s96, 2
    s_and_b32 s96, s96, 3
    s_mul_i32 s97, s97, 14336
    s_mul_i32 s96, s96, 14336
    s_add_u32 s96, s96, s97
    buffer_load_dwordx4 v[196:199], v152, s[80:83], s96 offen
    s_waitcnt vmcnt(14) lgkmcnt(0)
    s_barrier
    s_add_u32 s96, s95, 15
    s_and_b32 s96, s96, 15
    s_lshl_b32 s97, s96, 7
    s_add_u32 s97, s97, s84
    s_add_u32 m0, s86, 147456
    s_nop 0
    buffer_load_dwordx4 v4, s[4:7], s97 offen offset:0 lds
    buffer_load_dwordx4 v5, s[4:7], s97 offen offset:1024 lds
    buffer_load_dwordx4 v6, s[4:7], s97 offen offset:2048 lds
    buffer_load_dwordx4 v7, s[4:7], s97 offen offset:3072 lds
    s_add_u32 s96, s95, 15
    s_and_b32 s96, s96, 15
    s_mul_i32 s96, s96, 393216
    s_add_u32 s96, s96, s85
    s_add_u32 m0, s87, 40960
    s_nop 0
    buffer_load_dwordx4 v8, s[16:19], s96 offen offset:0 lds
    buffer_load_dwordx4 v9, s[16:19], s96 offen offset:1024 lds
    buffer_load_dwordx4 v10, s[16:19], s96 offen offset:2048 lds
    buffer_load_dwordx4 v11, s[16:19], s96 offen offset:3072 lds
    s_add_u32 m0, s87, 45056
    s_nop 0
    buffer_load_dwordx4 v12, s[16:19], s96 offen offset:0 lds
    buffer_load_dwordx4 v13, s[16:19], s96 offen offset:1024 lds
    s_mov_b32 s78, s27
    s_waitcnt vmcnt(21)
    s_branch pc_43
pl_42:
    buffer_load_dword v16, v15, s[12:15], 0 offen sc1
    s_waitcnt vmcnt(0)
pc_43:
    v_and_b32 v17, 0x10101010, v16
    v_cmp_ne_u32 vcc, 0x10101010, v17
    s_cbranch_vccz pd_44
    s_sub_u32 s78, s78, 1
    s_cmp_lg_u32 s78, 0
    s_cbranch_scc1 pl_42
    s_mov_b32 s27, 1
pd_44:
    s_lshl_b32 s30, s99, 13
    s_add_u32 s30, s30, 0x2400000
    s_add_u32 s31, s30, 4096
    buffer_load_dwordx4 v[64:67], v253, s[20:23], s30 offen offset:0 sc1
    buffer_load_dwordx4 v[68:71], v253, s[20:23], s30 offen offset:1024 sc1
    buffer_load_dwordx4 v[72:75], v253, s[20:23], s30 offen offset:2048 sc1
    buffer_load_dwordx4 v[76:79], v253, s[20:23], s30 offen offset:3072 sc1
    s_xor_b32 s96, s29, 1
    s_and_b32 s97, s96, 2
    s_and_b32 s96, s96, 3
    s_mul_i32 s97, s97, 14336
    s_mul_i32 s96, s96, 14336
    s_add_u32 s96, s96, s97
    s_add_u32 s96, s96, 7168
    buffer_load_dwordx4 v[200:203], v152, s[80:83], s96 offen
    buffer_load_dwordx4 v[80:83], v253, s[20:23], s31 offen offset:0 sc1
    buffer_load_dwordx4 v[84:87], v253, s[20:23], s31 offen offset:1024 sc1
    buffer_load_dwordx4 v[88:91], v253, s[20:23], s31 offen offset:2048 sc1
    buffer_load_dwordx4 v[92:95], v253, s[20:23], s31 offen offset:3072 sc1
    s_min_u32 s32, s28, 2
    s_lshl_b32 s32, s32, 12
    s_lshl_b32 s33, s25, 14
    s_add_u32 s32, s32, s33
    s_add_u32 s32, s32, 0x2500000
    buffer_load_dwordx4 v[32:35], v253, s[20:23], s32 offen offset:0 sc1
    buffer_load_dwordx4 v[36:39], v253, s[20:23], s32 offen offset:1024 sc1
    buffer_load_dwordx4 v[40:43], v253, s[20:23], s32 offen offset:2048 sc1
    buffer_load_dwordx4 v[44:47], v253, s[20:23], s32 offen offset:3072 sc1
    s_mul_i32 s30, s88, 0x01010101
    v_cmp_eq_u32 vcc, s30, v16
    s_lshl_b32 s31, s24, 2
    s_lshr_b64 s[30:31], vcc, s31
    s_and_b32 s30, s30, 15
    s_cmp_eq_u32 s30, 15
    s_cselect_b32 s77, 1, 0
    v_mov_b32 v20, s73
    v_mov_b32 v21, s77
    v_mov_b32 v19, 0
    ds_write_b64 v19, v[20:21] offset:3072
    s_waitcnt vmcnt(24) lgkmcnt(0)
    s_barrier
    s_load_dwordx2 s[12:13], s[0:1], 56
    s_cmp_lt_u32 s29, 224
    s_cselect_b32 s14, 0x700000, 0
    s_mov_b32 s15, 0x20000
    s_waitcnt lgkmcnt(0)
    s_mov_b32 s96, 0
    buffer_load_dwordx4 v[220:223], v153, s[12:15], s96 offen
    s_mov_b32 s96, 2048
    buffer_load_dwordx4 v[224:227], v153, s[12:15], s96 offen
    s_waitcnt vmcnt(2)
    v_pk_add_f32 v[64:65], v[64:65], v[68:69]
    v_pk_add_f32 v[64:65], v[64:65], v[72:73]
    s_mov_b32 s96, 4096
    buffer_load_dwordx4 v[228:231], v153, s[12:15], s96 offen
    v_pk_add_f32 v[64:65], v[64:65], v[76:77]
    v_pk_add_f32 v[64:65], v[64:65], v[80:81]
    v_pk_add_f32 v[64:65], v[64:65], v[84:85]
    s_mov_b32 s96, 6144
    buffer_load_dwordx4 v[232:235], v153, s[12:15], s96 offen
    v_pk_add_f32 v[64:65], v[64:65], v[88:89]
    v_pk_add_f32 v[64:65], v[64:65], v[92:93]
    v_mov_b32 v48, v64
    s_mov_b32 s96, 8192
    buffer_load_dwordx4 v[236:239], v153, s[12:15], s96 offen
    v_mov_b32 v49, v65
    v_permlane32_swap_b32 v64, v48
    s_nop 0
    v_permlane32_swap_b32 v65, v49
    s_mov_b32 s96, 10240
    buffer_load_dwordx4 v[240:243], v153, s[12:15], s96 offen
    v_add_f32 v64, v64, v48
    v_add_f32 v65, v65, v49
    s_mov_b32 s96, 12288
    buffer_load_dwordx4 v[244:247], v153, s[12:15], s96 offen
    v_mul_f32 v54, 0x3a800000, v64
    v_mul_f32 v65, 0x3a800000, v65
    v_fma_f32 v65, -v54, v54, v65
    s_mov_b32 s96, 14336
    buffer_load_dwordx4 v[248:251], v153, s[12:15], s96 offen
    v_max_f32 v65, 0, v65
    v_add_f32 v55, 0x3727c5ac, v65
    v_rsq_f32 v55, v55
    s_xor_b32 s96, s29, 2
    s_and_b32 s97, s96, 2
    s_and_b32 s96, s96, 3
    s_mul_i32 s97, s97, 14336
    s_mul_i32 s96, s96, 14336
    s_add_u32 s96, s96, s97
    buffer_load_dwordx4 v[204:207], v152, s[80:83], s96 offen
    v_pk_add_f32 v[32:33], v[32:33], v[36:37]
    v_pk_add_f32 v[34:35], v[34:35], v[38:39]
    v_pk_add_f32 v[32:33], v[32:33], v[40:41]
    s_xor_b32 s96, s29, 2
    s_and_b32 s97, s96, 2
    s_and_b32 s96, s96, 3
    s_mul_i32 s97, s97, 14336
    s_mul_i32 s96, s96, 14336
    s_add_u32 s96, s96, s97
    s_add_u32 s96, s96, 7168
    buffer_load_dwordx4 v[208:211], v152, s[80:83], s96 offen
    v_pk_add_f32 v[34:35], v[34:35], v[42:43]
    v_pk_add_f32 v[32:33], v[32:33], v[44:45]
    s_waitcnt vmcnt(23) lgkmcnt(0)
    s_barrier
    s_xor_b32 s96, s29, 3
    s_and_b32 s97, s96, 2
    s_and_b32 s96, s96, 3
    s_mul_i32 s97, s97, 14336
    s_mul_i32 s96, s96, 14336
    s_add_u32 s96, s96, s97
    buffer_load_dwordx4 v[212:215], v152, s[80:83], s96 offen
    s_xor_b32 s96, s29, 3
    s_and_b32 s97, s96, 2
    s_and_b32 s96, s96, 3
    s_mul_i32 s97, s97, 14336
    s_mul_i32 s96, s96, 14336
    s_add_u32 s96, s96, s97
    s_add_u32 s96, s96, 7168
    buffer_load_dwordx4 v[216:219], v152, s[80:83], s96 offen
    v_pk_add_f32 v[34:35], v[34:35], v[46:47]
    s_nop 1
    v_permlane32_swap_b32 v32, v34
    v_permlane32_swap_b32 v33, v35
    v_add_f32 v32, v32, v34
    v_add_f32 v33, v33, v35
    s_nop 1
    v_permlane16_swap_b32 v32, v33
    v_add_f32 v32, v32, v33
    v_mov_b32 v2, v32
    v_cmp_gt_u32 vcc, 32, v252
    v_and_b32 v48, 31, v252
    v_lshrrev_b32 v49, 5, v252
    v_lshlrev_b32 v49, 9, v49
    v_lshl_add_u32 v48, v48, 2, v49
    s_lshl_b32 s32, s28, 7
    v_add_u32 v48, s32, v48
    v_cndmask_b32 v49, v54, v55, vcc
    v_cndmask_b32 v50, 0, 1.0, vcc
    ds_write_b32 v48, v49 offset:0
    ds_write_b32 v48, v50 offset:2048
    v_and_b32 v48, 15, v252
    v_lshrrev_b32 v51, 4, v252
    v_lshl_add_u32 v48, v48, 2, v51
    s_min_u32 s32, s28, 2
    s_lshl_b32 s32, s32, 8
    v_lshl_add_u32 v48, v48, 2, s32
    ds_write_b32 v48, v2 offset:1024
    s_waitcnt lgkmcnt(0)
    s_barrier
l_att:
    s_add_u32 s96, s25, 10
    s_and_b32 s96, s96, 15
    s_lshl_b32 s96, s96, 17
    s_add_u32 m0, s101, 40960
    s_nop 0
    buffer_load_dwordx4 v14, s[8:11], s96 offen lds
    s_add_u32 s96, s25, 11
    s_and_b32 s96, s96, 15
    s_lshl_b32 s96, s96, 17
    s_add_u32 m0, s101, 45056
    s_nop 0
    buffer_load_dwordx4 v14, s[8:11], s96 offen lds
    v_mov_b32 v20, 0xffff
    v_mov_b32 v21, 0xffff0000
    v_cndmask_b32 v22, 0, v20, s[40:41]
    v_cndmask_b32 v23, 0, v21, s[42:43]
    v_or_b32 v12, v22, v23
    v_cndmask_b32 v22, 0, v20, s[44:45]
    v_cndmask_b32 v23, 0, v21, s[46:47]
    v_or_b32 v13, v22, v23
    v_cndmask_b32 v22, 0, v20, s[48:49]
    v_cndmask_b32 v23, 0, v21, s[50:51]
    v_or_b32 v14, v22, v23
    v_cndmask_b32 v22, 0, v20, s[52:53]
    v_cndmask_b32 v23, 0, v21, s[54:55]
    v_or_b32 v15, v22, v23
    v_cndmask_b32 v22, 0, v20, s[56:57]
    v_cndmask_b32 v23, 0, v21, s[58:59]
    v_or_b32 v16, v22, v23
    v_cndmask_b32 v22, 0, v20, s[60:61]
    v_cndmask_b32 v23, 0, v21, s[62:63]
    v_or_b32 v17, v22, v23
    v_cndmask_b32 v22, 0, v20, s[64:65]
    v_cndmask_b32 v23, 0, v21, s[66:67]
    v_or_b32 v18, v22, v23
    v_cndmask_b32 v22, 0, v20, s[68:69]
    v_cndmask_b32 v23, 0, v21, s[70:71]
    v_or_b32 v19, v22, v23
    s_lshl_b32 s34, s28, 12
    s_add_u32 s34, s34, 114688
    v_add_u32 v20, s34, v253
    s_lshl_b32 s34, s3, 11
    s_add_u32 s34, s34, 49152
    v_add_u32 v3, s34, v253
    v_mov_b32 v24, 0
    v_mov_b32 v25, 0
    v_mov_b32 v26, 0
    v_mov_b32 v27, 0
    v_mov_b32 v28, 0
    v_mov_b32 v29, 0
    v_mov_b32 v30, 0
    v_mov_b32 v31, 0
    v_mov_b32 v32, 0
    v_mov_b32 v33, 0
    v_mov_b32 v34, 0
    v_mov_b32 v35, 0
    v_mov_b32 v36, 0
    v_mov_b32 v37, 0
    v_mov_b32 v38, 0
    v_mov_b32 v39, 0
    s_lshr_b32 s33, s28, 1
    s_add_u32 s33, s33, s24
    s_sub_u32 s33, s33, 2
    s_cmp_lt_i32 s33, 0
    s_cbranch_scc1 sk_45
    s_and_b32 s34, s28, 1
    s_lshl_b32 s35, s25, 7
    s_lshl_b32 s30, s33, 2
    s_add_u32 s35, s35, s30
    s_lshl_b32 s30, s34, 1
    s_add_u32 s35, s35, s30
    s_lshl_b32 s35, s35, 12
    s_add_u32 s35, s35, s26
    s_lshl_b32 s30, s25, 8
    s_lshl_b32 s31, s33, 4
    s_add_u32 s30, s30, s31
    s_lshl_b32 s31, s34, 3
    s_add_u32 s30, s30, s31
    s_add_u32 s30, s30, s26
    s_add_u32 s30, s30, 0xdc1000
    v_mov_b32 v40, 0
    s_mov_b32 s78, s27
pl_46:
    buffer_load_dwordx2 v[42:43], v40, s[20:23], s30 offen sc1
    s_waitcnt vmcnt(0)
pc_47:
    v_max_u32 v41, v42, v43
    v_cmp_eq_u32 vcc, -1, v41
    s_cbranch_vccz pd_48
    s_sub_u32 s78, s78, 1
    s_cmp_lg_u32 s78, 0
    s_cbranch_scc1 pl_46
    s_mov_b32 s27, 1
pd_48:
    s_lshl_b32 s30, s28, 13
    s_add_u32 m0, s30, 65536
    s_add_u32 s31, s35, 0
    buffer_load_dwordx4 v253, s[20:23], s31 offen offset:0 sc1 lds
    buffer_load_dwordx4 v253, s[20:23], s31 offen offset:1024 sc1 lds
    s_add_u32 m0, s30, 69632
    s_add_u32 s31, s35, 4096
    buffer_load_dwordx4 v253, s[20:23], s31 offen offset:0 sc1 lds
    buffer_load_dwordx4 v253, s[20:23], s31 offen offset:1024 sc1 lds
    s_add_u32 m0, s30, 65536
    s_add_u32 s31, s35, 0
    buffer_load_dwordx4 v253, s[20:23], s31 offen offset:2048 sc1 lds
    buffer_load_dwordx4 v253, s[20:23], s31 offen offset:3072 sc1 lds
    s_add_u32 m0, s30, 69632
    s_add_u32 s31, s35, 4096
    buffer_load_dwordx4 v253, s[20:23], s31 offen offset:2048 sc1 lds
    buffer_load_dwordx4 v253, s[20:23], s31 offen offset:3072 sc1 lds
    s_add_u32 m0, s30, 114688
    s_add_u32 s31, s35, 262144
    buffer_load_dwordx4 v253, s[20:23], s31 offen offset:0 sc1 lds
    buffer_load_dwordx4 v253, s[20:23], s31 offen offset:1024 sc1 lds
    s_add_u32 m0, s30, 118784
    s_add_u32 s31, s35, 266240
    buffer_load_dwordx4 v253, s[20:23], s31 offen offset:0 sc1 lds
    buffer_load_dwordx4 v253, s[20:23], s31 offen offset:1024 sc1 lds
    s_add_u32 m0, s30, 114688
    s_add_u32 s31, s35, 262144
    buffer_load_dwordx4 v253, s[20:23], s31 offen offset:2048 sc1 lds
    buffer_load_dwordx4 v253, s[20:23], s31 offen offset:3072 sc1 lds
    s_add_u32 m0, s30, 118784
    s_add_u32 s31, s35, 266240
    buffer_load_dwordx4 v253, s[20:23], s31 offen offset:2048 sc1 lds
    buffer_load_dwordx4 v253, s[20:23], s31 offen offset:3072 sc1 lds
    s_waitcnt vmcnt(12)
sk_45:
    s_cmp_eq_u32 s100, 0
    s_cbranch_scc1 sk_49
    s_waitcnt vmcnt(0)
sk_49:
    s_barrier
    s_cmp_eq_u32 s100, 0
    s_cbranch_scc1 sk_50
    s_cmp_lg_u32 s38, 0
    s_cselect_b64 exec, -1, 0
    ds_write_b16 v0, v1
    s_mov_b64 exec, -1
    s_waitcnt lgkmcnt(0)
    s_barrier
sk_50:
    ds_read_b128 v[4:7], v3
    ds_read_b128 v[8:11], v3 offset:1024
    s_waitcnt vmcnt(0) lgkmcnt(0)
    s_barrier
    ds_read_b128 v[104:107], v20 offset:32768
    ds_read_b128 v[108:111], v20 offset:33792
    ds_read_b128 v[112:115], v20 offset:28672
    ds_read_b128 v[116:119], v20 offset:29696
    s_waitcnt lgkmcnt(2)
    v_mfma_f32_32x32x16_bf16 v[40:55], v[104:107], v[4:7], 0
    v_mfma_f32_32x32x16_bf16 v[40:55], v[108:111], v[8:11], v[40:55]
    ds_read_b128 v[104:107], v20 offset:24576
    ds_read_b128 v[108:111], v20 offset:25600
    s_cmp_eq_u32 s99, 0
    s_cbranch_scc0 ng_51
    v_mov_b32 v24, 0xf149f2ca
    v_mov_b32 v25, 0xf149f2ca
    v_mov_b32 v26, 0xf149f2ca
    v_mov_b32 v27, 0xf149f2ca
    v_mov_b32 v28, 0xf149f2ca
    v_mov_b32 v29, 0xf149f2ca
    v_mov_b32 v30, 0xf149f2ca
    v_mov_b32 v31, 0xf149f2ca
    v_mov_b32 v32, 0xf149f2ca
    v_mov_b32 v33, 0xf149f2ca
    v_mov_b32 v34, 0xf149f2ca
    v_mov_b32 v35, 0xf149f2ca
    v_mov_b32 v36, 0xf149f2ca
    v_mov_b32 v37, 0xf149f2ca
    v_mov_b32 v38, 0xf149f2ca
    v_mov_b32 v39, 0xf149f2ca
ng_51:
    s_waitcnt lgkmcnt(2)
    s_nop 0
    v_mfma_f32_32x32x16_bf16 v[72:87], v[112:115], v[4:7], v[24:39]
    v_mfma_f32_32x32x16_bf16 v[72:87], v[116:119], v[8:11], v[72:87]
    ds_read_b128 v[112:115], v20 offset:20480
    ds_read_b128 v[116:119], v20 offset:21504
    s_cmp_eq_u32 s99, 1
    s_cbranch_scc0 ng_52
    s_nop 1
    v_mov_b32 v24, 0xf149f2ca
    v_mov_b32 v25, 0xf149f2ca
    v_mov_b32 v26, 0xf149f2ca
    v_mov_b32 v27, 0xf149f2ca
    v_mov_b32 v28, 0xf149f2ca
    v_mov_b32 v29, 0xf149f2ca
    v_mov_b32 v30, 0xf149f2ca
    v_mov_b32 v31, 0xf149f2ca
    v_mov_b32 v32, 0xf149f2ca
    v_mov_b32 v33, 0xf149f2ca
    v_mov_b32 v34, 0xf149f2ca
    v_mov_b32 v35, 0xf149f2ca
    v_mov_b32 v36, 0xf149f2ca
    v_mov_b32 v37, 0xf149f2ca
    v_mov_b32 v38, 0xf149f2ca
    v_mov_b32 v39, 0xf149f2ca
ng_52:
    s_waitcnt lgkmcnt(2)
    s_nop 0
    v_mfma_f32_32x32x16_bf16 v[56:71], v[104:107], v[4:7], v[24:39]
    v_mfma_f32_32x32x16_bf16 v[56:71], v[108:111], v[8:11], v[56:71]
    s_nop 3
    v_max_f32 v21, v72, v73
    v_max3_f32 v21, v21, v74, v75
    v_max3_f32 v21, v21, v76, v77
    v_max3_f32 v21, v21, v78, v79
    v_max3_f32 v21, v21, v80, v81
    v_max3_f32 v21, v21, v82, v83
    v_max3_f32 v21, v21, v84, v85
    v_max3_f32 v21, v21, v86, v87
    ds_read_b128 v[104:107], v20 offset:16384
    ds_read_b128 v[108:111], v20 offset:17408
    s_cmp_eq_u32 s99, 2
    s_cbranch_scc0 ng_53
    v_mov_b32 v24, 0xf149f2ca
    v_mov_b32 v25, 0xf149f2ca
    v_mov_b32 v26, 0xf149f2ca
    v_mov_b32 v27, 0xf149f2ca
    v_mov_b32 v28, 0xf149f2ca
    v_mov_b32 v29, 0xf149f2ca
    v_mov_b32 v30, 0xf149f2ca
    v_mov_b32 v31, 0xf149f2ca
    v_mov_b32 v32, 0xf149f2ca
    v_mov_b32 v33, 0xf149f2ca
    v_mov_b32 v34, 0xf149f2ca
    v_mov_b32 v35, 0xf149f2ca
    v_mov_b32 v36, 0xf149f2ca
    v_mov_b32 v37, 0xf149f2ca
    v_mov_b32 v38, 0xf149f2ca
    v_mov_b32 v39, 0xf149f2ca
ng_53:
    s_waitcnt lgkmcnt(2)
    s_nop 0
    v_mfma_f32_32x32x16_bf16 v[72:87], v[112:115], v[4:7], v[24:39]
    v_mfma_f32_32x32x16_bf16 v[72:87], v[116:119], v[8:11], v[72:87]
    v_max3_f32 v21, v21, v56, v57
    v_max3_f32 v21, v21, v58, v59
    v_max3_f32 v21, v21, v60, v61
    v_max3_f32 v21, v21, v62, v63
    v_max3_f32 v21, v21, v64, v65
    v_max3_f32 v21, v21, v66, v67
    v_max3_f32 v21, v21, v68, v69
    v_max3_f32 v21, v21, v70, v71
    ds_read_b128 v[112:115], v20 offset:12288
    ds_read_b128 v[116:119], v20 offset:13312
    s_cmp_eq_u32 s99, 3
    s_cbranch_scc0 ng_54
    v_mov_b32 v24, 0xf149f2ca
    v_mov_b32 v25, 0xf149f2ca
    v_mov_b32 v26, 0xf149f2ca
    v_mov_b32 v27, 0xf149f2ca
    v_mov_b32 v28, 0xf149f2ca
    v_mov_b32 v29, 0xf149f2ca
    v_mov_b32 v30, 0xf149f2ca
    v_mov_b32 v31, 0xf149f2ca
    v_mov_b32 v32, 0xf149f2ca
    v_mov_b32 v33, 0xf149f2ca
    v_mov_b32 v34, 0xf149f2ca
    v_mov_b32 v35, 0xf149f2ca
    v_mov_b32 v36, 0xf149f2ca
    v_mov_b32 v37, 0xf149f2ca
    v_mov_b32 v38, 0xf149f2ca
    v_mov_b32 v39, 0xf149f2ca
ng_54:
    s_waitcnt lgkmcnt(2)
    s_nop 0
    v_mfma_f32_32x32x16_bf16 v[56:71], v[104:107], v[4:7], v[24:39]
    v_mfma_f32_32x32x16_bf16 v[56:71], v[108:111], v[8:11], v[56:71]
    v_max3_f32 v21, v21, v72, v73
    v_max3_f32 v21, v21, v74, v75
    v_max3_f32 v21, v21, v76, v77
    v_max3_f32 v21, v21, v78, v79
    v_max3_f32 v21, v21, v80, v81
    v_max3_f32 v21, v21, v82, v83
    v_max3_f32 v21, v21, v84, v85
    v_max3_f32 v21, v21, v86, v87
    ds_read_b128 v[104:107], v20 offset:8192
    ds_read_b128 v[108:111], v20 offset:9216
    s_cmp_eq_u32 s99, 4
    s_cbranch_scc0 ng_55
    v_mov_b32 v24, 0xf149f2ca
    v_mov_b32 v25, 0xf149f2ca
    v_mov_b32 v26, 0xf149f2ca
    v_mov_b32 v27, 0xf149f2ca
    v_mov_b32 v28, 0xf149f2ca
    v_mov_b32 v29, 0xf149f2ca
    v_mov_b32 v30, 0xf149f2ca
    v_mov_b32 v31, 0xf149f2ca
    v_mov_b32 v32, 0xf149f2ca
    v_mov_b32 v33, 0xf149f2ca
    v_mov_b32 v34, 0xf149f2ca
    v_mov_b32 v35, 0xf149f2ca
    v_mov_b32 v36, 0xf149f2ca
    v_mov_b32 v37, 0xf149f2ca
    v_mov_b32 v38, 0xf149f2ca
    v_mov_b32 v39, 0xf149f2ca
ng_55:
    s_waitcnt lgkmcnt(2)
    s_nop 0
    v_mfma_f32_32x32x16_bf16 v[72:87], v[112:115], v[4:7], v[24:39]
    v_mfma_f32_32x32x16_bf16 v[72:87], v[116:119], v[8:11], v[72:87]
    v_max3_f32 v21, v21, v56, v57
    v_max3_f32 v21, v21, v58, v59
    v_max3_f32 v21, v21, v60, v61
    v_max3_f32 v21, v21, v62, v63
    v_max3_f32 v21, v21, v64, v65
    v_max3_f32 v21, v21, v66, v67
    v_max3_f32 v21, v21, v68, v69
    v_max3_f32 v21, v21, v70, v71
    ds_read_b128 v[112:115], v20 offset:4096
    ds_read_b128 v[116:119], v20 offset:5120
    s_cmp_eq_u32 s99, 5
    s_cbranch_scc0 ng_56
    v_mov_b32 v24, 0xf149f2ca
    v_mov_b32 v25, 0xf149f2ca
    v_mov_b32 v26, 0xf149f2ca
    v_mov_b32 v27, 0xf149f2ca
    v_mov_b32 v28, 0xf149f2ca
    v_mov_b32 v29, 0xf149f2ca
    v_mov_b32 v30, 0xf149f2ca
    v_mov_b32 v31, 0xf149f2ca
    v_mov_b32 v32, 0xf149f2ca
    v_mov_b32 v33, 0xf149f2ca
    v_mov_b32 v34, 0xf149f2ca
    v_mov_b32 v35, 0xf149f2ca
    v_mov_b32 v36, 0xf149f2ca
    v_mov_b32 v37, 0xf149f2ca
    v_mov_b32 v38, 0xf149f2ca
    v_mov_b32 v39, 0xf149f2ca
ng_56:
    s_waitcnt lgkmcnt(2)
    s_nop 0
    v_mfma_f32_32x32x16_bf16 v[56:71], v[104:107], v[4:7], v[24:39]
    v_mfma_f32_32x32x16_bf16 v[56:71], v[108:111], v[8:11], v[56:71]
    v_max3_f32 v21, v21, v72, v73
    v_max3_f32 v21, v21, v74, v75
    v_max3_f32 v21, v21, v76, v77
    v_max3_f32 v21, v21, v78, v79
    v_max3_f32 v21, v21, v80, v81
    v_max3_f32 v21, v21, v82, v83
    v_max3_f32 v21, v21, v84, v85
    v_max3_f32 v21, v21, v86, v87
    ds_read_b128 v[104:107], v20 offset:0
    ds_read_b128 v[108:111], v20 offset:1024
    s_cmp_eq_u32 s99, 6
    s_cbranch_scc0 ng_57
    v_mov_b32 v24, 0xf149f2ca
    v_mov_b32 v25, 0xf149f2ca
    v_mov_b32 v26, 0xf149f2ca
    v_mov_b32 v27, 0xf149f2ca
    v_mov_b32 v28, 0xf149f2ca
    v_mov_b32 v29, 0xf149f2ca
    v_mov_b32 v30, 0xf149f2ca
    v_mov_b32 v31, 0xf149f2ca
    v_mov_b32 v32, 0xf149f2ca
    v_mov_b32 v33, 0xf149f2ca
    v_mov_b32 v34, 0xf149f2ca
    v_mov_b32 v35, 0xf149f2ca
    v_mov_b32 v36, 0xf149f2ca
    v_mov_b32 v37, 0xf149f2ca
    v_mov_b32 v38, 0xf149f2ca
    v_mov_b32 v39, 0xf149f2ca
ng_57:
    s_waitcnt lgkmcnt(2)
    s_nop 0
    v_mfma_f32_32x32x16_bf16 v[72:87], v[112:115], v[4:7], v[24:39]
    v_mfma_f32_32x32x16_bf16 v[72:87], v[116:119], v[8:11], v[72:87]
    v_max3_f32 v21, v21, v56, v57
    v_max3_f32 v21, v21, v58, v59
    v_max3_f32 v21, v21, v60, v61
    v_max3_f32 v21, v21, v62, v63
    v_max3_f32 v21, v21, v64, v65
    v_max3_f32 v21, v21, v66, v67
    v_max3_f32 v21, v21, v68, v69
    v_max3_f32 v21, v21, v70, v71
    s_cmp_eq_u32 s99, 7
    s_cbranch_scc0 ng_58
    v_mov_b32 v24, 0xf149f2ca
    v_mov_b32 v25, 0xf149f2ca
    v_mov_b32 v26, 0xf149f2ca
    v_mov_b32 v27, 0xf149f2ca
    v_mov_b32 v28, 0xf149f2ca
    v_mov_b32 v29, 0xf149f2ca
    v_mov_b32 v30, 0xf149f2ca
    v_mov_b32 v31, 0xf149f2ca
    v_mov_b32 v32, 0xf149f2ca
    v_mov_b32 v33, 0xf149f2ca
    v_mov_b32 v34, 0xf149f2ca
    v_mov_b32 v35, 0xf149f2ca
    v_mov_b32 v36, 0xf149f2ca
    v_mov_b32 v37, 0xf149f2ca
    v_mov_b32 v38, 0xf149f2ca
    v_mov_b32 v39, 0xf149f2ca
ng_58:
    s_waitcnt lgkmcnt(0)
    s_nop 0
    v_mfma_f32_32x32x16_bf16 v[56:71], v[104:107], v[4:7], v[24:39]
    v_mfma_f32_32x32x16_bf16 v[56:71], v[108:111], v[8:11], v[56:71]
    v_max3_f32 v21, v21, v72, v73
    v_max3_f32 v21, v21, v74, v75
    v_max3_f32 v21, v21, v76, v77
    v_max3_f32 v21, v21, v78, v79
    v_max3_f32 v21, v21, v80, v81
    v_max3_f32 v21, v21, v82, v83
    v_max3_f32 v21, v21, v84, v85
    v_max3_f32 v21, v21, v86, v87
    ds_read_b128 v[112:115], v20 offset:28672
    ds_read_b128 v[116:119], v20 offset:29696
    ds_read_b128 v[120:123], v20 offset:34816
    ds_read_b128 v[124:127], v20 offset:35840
    ds_read_b128 v[128:131], v20 offset:2048
    ds_read_b128 v[132:135], v20 offset:3072
    v_cndmask_b32 v40, v56, v40, s[40:41]
    v_cndmask_b32 v41, v57, v41, s[42:43]
    v_cndmask_b32 v42, v58, v42, s[44:45]
    v_cndmask_b32 v43, v59, v43, s[46:47]
    v_cndmask_b32 v44, v60, v44, s[48:49]
    v_cndmask_b32 v45, v61, v45, s[50:51]
    v_cndmask_b32 v46, v62, v46, s[52:53]
    v_cndmask_b32 v47, v63, v47, s[54:55]
    v_cndmask_b32 v48, v64, v48, s[56:57]
    v_cndmask_b32 v49, v65, v49, s[58:59]
    v_cndmask_b32 v50, v66, v50, s[60:61]
    v_cndmask_b32 v51, v67, v51, s[62:63]
    v_cndmask_b32 v52, v68, v52, s[64:65]
    v_cndmask_b32 v53, v69, v53, s[66:67]
    v_cndmask_b32 v54, v70, v54, s[68:69]
    v_cndmask_b32 v55, v71, v55, s[70:71]
    v_max3_f32 v21, v21, v40, v41
    v_max3_f32 v21, v21, v42, v43
    v_max3_f32 v21, v21, v44, v45
    v_max3_f32 v21, v21, v46, v47
    v_max3_f32 v21, v21, v48, v49
    v_max3_f32 v21, v21, v50, v51
    v_max3_f32 v21, v21, v52, v53
    v_max3_f32 v21, v21, v54, v55
    v_mov_b32 v152, v21
    s_nop 1
    v_permlane32_swap_b32 v21, v152
    v_max_f32 v21, v21, v152
    v_sub_f32 v24, 0, v21
    v_sub_f32 v25, 0, v21
    v_sub_f32 v26, 0, v21
    v_sub_f32 v27, 0, v21
    v_sub_f32 v28, 0, v21
    v_sub_f32 v29, 0, v21
    v_sub_f32 v30, 0, v21
    v_sub_f32 v31, 0, v21
    v_sub_f32 v32, 0, v21
    v_sub_f32 v33, 0, v21
    v_sub_f32 v34, 0, v21
    v_sub_f32 v35, 0, v21
    v_sub_f32 v36, 0, v21
    v_sub_f32 v37, 0, v21
    v_sub_f32 v38, 0, v21
    v_sub_f32 v39, 0, v21
    s_cmp_eq_u32 s99, 0
    s_cbranch_scc0 ng_59
    v_mov_b32 v24, 0xf149f2ca
    v_mov_b32 v25, 0xf149f2ca
    v_mov_b32 v26, 0xf149f2ca
    v_mov_b32 v27, 0xf149f2ca
    v_mov_b32 v28, 0xf149f2ca
    v_mov_b32 v29, 0xf149f2ca
    v_mov_b32 v30, 0xf149f2ca
    v_mov_b32 v31, 0xf149f2ca
    v_mov_b32 v32, 0xf149f2ca
    v_mov_b32 v33, 0xf149f2ca
    v_mov_b32 v34, 0xf149f2ca
    v_mov_b32 v35, 0xf149f2ca
    v_mov_b32 v36, 0xf149f2ca
    v_mov_b32 v37, 0xf149f2ca
    v_mov_b32 v38, 0xf149f2ca
    v_mov_b32 v39, 0xf149f2ca
ng_59:
    s_waitcnt lgkmcnt(4)
    s_nop 0
    v_mfma_f32_32x32x16_bf16 v[72:87], v[112:115], v[4:7], v[24:39]
    v_mfma_f32_32x32x16_bf16 v[72:87], v[116:119], v[8:11], v[72:87]
    ds_read_b128 v[104:107], v20 offset:24576
    ds_read_b128 v[108:111], v20 offset:25600
    v_sub_f32 v40, v40, v21
    v_sub_f32 v41, v41, v21
    v_sub_f32 v42, v42, v21
    v_sub_f32 v43, v43, v21
    v_sub_f32 v44, v44, v21
    v_sub_f32 v45, v45, v21
    v_sub_f32 v46, v46, v21
    v_sub_f32 v47, v47, v21
    v_sub_f32 v48, v48, v21
    v_sub_f32 v49, v49, v21
    v_sub_f32 v50, v50, v21
    v_sub_f32 v51, v51, v21
    v_sub_f32 v52, v52, v21
    v_sub_f32 v53, v53, v21
    v_sub_f32 v54, v54, v21
    v_sub_f32 v55, v55, v21
    v_exp_f32 v40, v40
    v_exp_f32 v41, v41
    v_exp_f32 v42, v42
    v_exp_f32 v43, v43
    v_exp_f32 v44, v44
    v_exp_f32 v45, v45
    v_exp_f32 v46, v46
    v_exp_f32 v47, v47
    v_exp_f32 v48, v48
    v_exp_f32 v49, v49
    v_exp_f32 v50, v50
    v_exp_f32 v51, v51
    v_exp_f32 v52, v52
    v_exp_f32 v53, v53
    v_exp_f32 v54, v54
    v_exp_f32 v55, v55
    v_add_f32 v22, v40, v41
    v_add_f32 v23, v42, v43
    v_add_f32 v22, v22, v44
    v_add_f32 v23, v23, v45
    v_add_f32 v22, v22, v46
    v_add_f32 v23, v23, v47
    v_add_f32 v22, v22, v48
    v_add_f32 v23, v23, v49
    v_add_f32 v22, v22, v50
    v_add_f32 v23, v23, v51
    v_add_f32 v22, v22, v52
    v_add_f32 v23, v23, v53
    v_add_f32 v22, v22, v54
    v_add_f32 v23, v23, v55
    v_cvt_pk_bf16_f32 v144, v40, v41
    v_cvt_pk_bf16_f32 v145, v42, v43
    v_cvt_pk_bf16_f32 v146, v44, v45
    v_cvt_pk_bf16_f32 v147, v46, v47
    v_cvt_pk_bf16_f32 v148, v48, v49
    v_cvt_pk_bf16_f32 v149, v50, v51
    v_cvt_pk_bf16_f32 v150, v52, v53
    v_cvt_pk_bf16_f32 v151, v54, v55
    v_and_b32 v136, v144, v12
    v_and_b32 v137, v145, v13
    v_and_b32 v138, v146, v14
    v_and_b32 v139, v147, v15
    v_and_b32 v140, v148, v16
    v_and_b32 v141, v149, v17
    v_and_b32 v142, v150, v18
    v_and_b32 v143, v151, v19
    v_xor_b32 v144, v144, v136
    v_xor_b32 v145, v145, v137
    v_xor_b32 v146, v146, v138
    v_xor_b32 v147, v147, v139
    v_xor_b32 v148, v148, v140
    v_xor_b32 v149, v149, v141
    v_xor_b32 v150, v150, v142
    v_xor_b32 v151, v151, v143
    s_waitcnt lgkmcnt(2)
    v_mfma_f32_32x32x16_bf16 v[88:103], v[120:123], v[136:139], 0
    v_mfma_f32_32x32x16_bf16 v[88:103], v[124:127], v[140:143], v[88:103]
    v_mfma_f32_32x32x16_bf16 v[88:103], v[128:131], v[144:147], v[88:103]
    v_mfma_f32_32x32x16_bf16 v[88:103], v[132:135], v[148:151], v[88:103]
    ds_read_b128 v[128:131], v20 offset:30720
    ds_read_b128 v[132:135], v20 offset:31744
    s_cmp_eq_u32 s99, 1
    s_cbranch_scc0 ng_60
    v_mov_b32 v24, 0xf149f2ca
    v_mov_b32 v25, 0xf149f2ca
    v_mov_b32 v26, 0xf149f2ca
    v_mov_b32 v27, 0xf149f2ca
    v_mov_b32 v28, 0xf149f2ca
    v_mov_b32 v29, 0xf149f2ca
    v_mov_b32 v30, 0xf149f2ca
    v_mov_b32 v31, 0xf149f2ca
    v_mov_b32 v32, 0xf149f2ca
    v_mov_b32 v33, 0xf149f2ca
    v_mov_b32 v34, 0xf149f2ca
    v_mov_b32 v35, 0xf149f2ca
    v_mov_b32 v36, 0xf149f2ca
    v_mov_b32 v37, 0xf149f2ca
    v_mov_b32 v38, 0xf149f2ca
    v_mov_b32 v39, 0xf149f2ca
ng_60:
    s_waitcnt lgkmcnt(2)
    s_nop 0
    v_mfma_f32_32x32x16_bf16 v[56:71], v[104:107], v[4:7], v[24:39]
    v_mfma_f32_32x32x16_bf16 v[56:71], v[108:111], v[8:11], v[56:71]
    ds_read_b128 v[112:115], v20 offset:20480
    ds_read_b128 v[116:119], v20 offset:21504
    v_exp_f32 v72, v72
    v_exp_f32 v73, v73
    v_exp_f32 v74, v74
    v_exp_f32 v75, v75
    v_exp_f32 v76, v76
    v_exp_f32 v77, v77
    v_exp_f32 v78, v78
    v_exp_f32 v79, v79
    v_exp_f32 v80, v80
    v_exp_f32 v81, v81
    v_exp_f32 v82, v82
    v_exp_f32 v83, v83
    v_exp_f32 v84, v84
    v_exp_f32 v85, v85
    v_exp_f32 v86, v86
    v_exp_f32 v87, v87
    v_add_f32 v22, v22, v72
    v_add_f32 v23, v23, v73
    v_add_f32 v22, v22, v74
    v_add_f32 v23, v23, v75
    v_add_f32 v22, v22, v76
    v_add_f32 v23, v23, v77
    v_add_f32 v22, v22, v78
    v_add_f32 v23, v23, v79
    v_add_f32 v22, v22, v80
    v_add_f32 v23, v23, v81
    v_add_f32 v22, v22, v82
    v_add_f32 v23, v23, v83
    v_add_f32 v22, v22, v84
    v_add_f32 v23, v23, v85
    v_add_f32 v22, v22, v86
    v_add_f32 v23, v23, v87
    v_cvt_pk_bf16_f32 v144, v72, v73
    v_cvt_pk_bf16_f32 v145, v74, v75
    v_cvt_pk_bf16_f32 v146, v76, v77
    v_cvt_pk_bf16_f32 v147, v78, v79
    v_cvt_pk_bf16_f32 v148, v80, v81
    v_cvt_pk_bf16_f32 v149, v82, v83
    v_cvt_pk_bf16_f32 v150, v84, v85
    v_cvt_pk_bf16_f32 v151, v86, v87
    s_waitcnt lgkmcnt(2)
    v_mfma_f32_32x32x16_bf16 v[88:103], v[128:131], v[144:147], v[88:103]
    v_mfma_f32_32x32x16_bf16 v[88:103], v[132:135], v[148:151], v[88:103]
    ds_read_b128 v[120:123], v20 offset:26624
    ds_read_b128 v[124:127], v20 offset:27648
    s_cmp_eq_u32 s99, 2
    s_cbranch_scc0 ng_61
    v_mov_b32 v24, 0xf149f2ca
    v_mov_b32 v25, 0xf149f2ca
    v_mov_b32 v26, 0xf149f2ca
    v_mov_b32 v27, 0xf149f2ca
    v_mov_b32 v28, 0xf149f2ca
    v_mov_b32 v29, 0xf149f2ca
    v_mov_b32 v30, 0xf149f2ca
    v_mov_b32 v31, 0xf149f2ca
    v_mov_b32 v32, 0xf149f2ca
    v_mov_b32 v33, 0xf149f2ca
    v_mov_b32 v34, 0xf149f2ca
    v_mov_b32 v35, 0xf149f2ca
    v_mov_b32 v36, 0xf149f2ca
    v_mov_b32 v37, 0xf149f2ca
    v_mov_b32 v38, 0xf149f2ca
    v_mov_b32 v39, 0xf149f2ca
ng_61:
    s_waitcnt lgkmcnt(2)
    s_nop 0
    v_mfma_f32_32x32x16_bf16 v[72:87], v[112:115], v[4:7], v[24:39]
    v_mfma_f32_32x32x16_bf16 v[72:87], v[116:119], v[8:11], v[72:87]
    ds_read_b128 v[104:107], v20 offset:16384
    ds_read_b128 v[108:111], v20 offset:17408
    v_exp_f32 v56, v56
    v_exp_f32 v57, v57
    v_exp_f32 v58, v58
    v_exp_f32 v59, v59
    v_exp_f32 v60, v60
    v_exp_f32 v61, v61
    v_exp_f32 v62, v62
    v_exp_f32 v63, v63
    v_exp_f32 v64, v64
    v_exp_f32 v65, v65
    v_exp_f32 v66, v66
    v_exp_f32 v67, v67
    v_exp_f32 v68, v68
    v_exp_f32 v69, v69
    v_exp_f32 v70, v70
    v_exp_f32 v71, v71
    v_add_f32 v22, v22, v56
    v_add_f32 v23, v23, v57
    v_add_f32 v22, v22, v58
    v_add_f32 v23, v23, v59
    v_add_f32 v22, v22, v60
    v_add_f32 v23, v23, v61
    v_add_f32 v22, v22, v62
    v_add_f32 v23, v23, v63
    v_add_f32 v22, v22, v64
    v_add_f32 v23, v23, v65
    v_add_f32 v22, v22, v66
    v_add_f32 v23, v23, v67
    v_add_f32 v22, v22, v68
    v_add_f32 v23, v23, v69
    v_add_f32 v22, v22, v70
    v_add_f32 v23, v23, v71
    v_cvt_pk_bf16_f32 v136, v56, v57
    v_cvt_pk_bf16_f32 v137, v58, v59
    v_cvt_pk_bf16_f32 v138, v60, v61
    v_cvt_pk_bf16_f32 v139, v62, v63
    v_cvt_pk_bf16_f32 v140, v64, v65
    v_cvt_pk_bf16_f32 v141, v66, v67
    v_cvt_pk_bf16_f32 v142, v68, v69
    v_cvt_pk_bf16_f32 v143, v70, v71
    s_waitcnt lgkmcnt(2)
    v_mfma_f32_32x32x16_bf16 v[88:103], v[120:123], v[136:139], v[88:103]
    v_mfma_f32_32x32x16_bf16 v[88:103], v[124:127], v[140:143], v[88:103]
    ds_read_b128 v[128:131], v20 offset:22528
    ds_read_b128 v[132:135], v20 offset:23552
    s_cmp_eq_u32 s99, 3
    s_cbranch_scc0 ng_62
    v_mov_b32 v24, 0xf149f2ca
    v_mov_b32 v25, 0xf149f2ca
    v_mov_b32 v26, 0xf149f2ca
    v_mov_b32 v27, 0xf149f2ca
    v_mov_b32 v28, 0xf149f2ca
    v_mov_b32 v29, 0xf149f2ca
    v_mov_b32 v30, 0xf149f2ca
    v_mov_b32 v31, 0xf149f2ca
    v_mov_b32 v32, 0xf149f2ca
    v_mov_b32 v33, 0xf149f2ca
    v_mov_b32 v34, 0xf149f2ca
    v_mov_b32 v35, 0xf149f2ca
    v_mov_b32 v36, 0xf149f2ca
    v_mov_b32 v37, 0xf149f2ca
    v_mov_b32 v38, 0xf149f2ca
    v_mov_b32 v39, 0xf149f2ca
ng_62:
    s_waitcnt lgkmcnt(2)
    s_nop 0
    v_mfma_f32_32x32x16_bf16 v[56:71], v[104:107], v[4:7], v[24:39]
    v_mfma_f32_32x32x16_bf16 v[56:71], v[108:111], v[8:11], v[56:71]
    ds_read_b128 v[112:115], v20 offset:12288
    ds_read_b128 v[116:119], v20 offset:13312
    v_exp_f32 v72, v72
    v_exp_f32 v73, v73
    v_exp_f32 v74, v74
    v_exp_f32 v75, v75
    v_exp_f32 v76, v76
    v_exp_f32 v77, v77
    v_exp_f32 v78, v78
    v_exp_f32 v79, v79
    v_exp_f32 v80, v80
    v_exp_f32 v81, v81
    v_exp_f32 v82, v82
    v_exp_f32 v83, v83
    v_exp_f32 v84, v84
    v_exp_f32 v85, v85
    v_exp_f32 v86, v86
    v_exp_f32 v87, v87
    v_add_f32 v22, v22, v72
    v_add_f32 v23, v23, v73
    v_add_f32 v22, v22, v74
    v_add_f32 v23, v23, v75
    v_add_f32 v22, v22, v76
    v_add_f32 v23, v23, v77
    v_add_f32 v22, v22, v78
    v_add_f32 v23, v23, v79
    v_add_f32 v22, v22, v80
    v_add_f32 v23, v23, v81
    v_add_f32 v22, v22, v82
    v_add_f32 v23, v23, v83
    v_add_f32 v22, v22, v84
    v_add_f32 v23, v23, v85
    v_add_f32 v22, v22, v86
    v_add_f32 v23, v23, v87
    v_cvt_pk_bf16_f32 v144, v72, v73
    v_cvt_pk_bf16_f32 v145, v74, v75
    v_cvt_pk_bf16_f32 v146, v76, v77
    v_cvt_pk_bf16_f32 v147, v78, v79
    v_cvt_pk_bf16_f32 v148, v80, v81
    v_cvt_pk_bf16_f32 v149, v82, v83
    v_cvt_pk_bf16_f32 v150, v84, v85
    v_cvt_pk_bf16_f32 v151, v86, v87
    s_waitcnt lgkmcnt(2)
    v_mfma_f32_32x32x16_bf16 v[88:103], v[128:131], v[144:147], v[88:103]
    v_mfma_f32_32x32x16_bf16 v[88:103], v[132:135], v[148:151], v[88:103]
    ds_read_b128 v[120:123], v20 offset:18432
    ds_read_b128 v[124:127], v20 offset:19456
    s_cmp_eq_u32 s99, 4
    s_cbranch_scc0 ng_63
    v_mov_b32 v24, 0xf149f2ca
    v_mov_b32 v25, 0xf149f2ca
    v_mov_b32 v26, 0xf149f2ca
    v_mov_b32 v27, 0xf149f2ca
    v_mov_b32 v28, 0xf149f2ca
    v_mov_b32 v29, 0xf149f2ca
    v_mov_b32 v30, 0xf149f2ca
    v_mov_b32 v31, 0xf149f2ca
    v_mov_b32 v32, 0xf149f2ca
    v_mov_b32 v33, 0xf149f2ca
    v_mov_b32 v34, 0xf149f2ca
    v_mov_b32 v35, 0xf149f2ca
    v_mov_b32 v36, 0xf149f2ca
    v_mov_b32 v37, 0xf149f2ca
    v_mov_b32 v38, 0xf149f2ca
    v_mov_b32 v39, 0xf149f2ca
ng_63:
    s_waitcnt lgkmcnt(2)
    s_nop 0
    v_mfma_f32_32x32x16_bf16 v[72:87], v[112:115], v[4:7], v[24:39]
    v_mfma_f32_32x32x16_bf16 v[72:87], v[116:119], v[8:11], v[72:87]
    ds_read_b128 v[104:107], v20 offset:8192
    ds_read_b128 v[108:111], v20 offset:9216
    v_exp_f32 v56, v56
    v_exp_f32 v57, v57
    v_exp_f32 v58, v58
    v_exp_f32 v59, v59
    v_exp_f32 v60, v60
    v_exp_f32 v61, v61
    v_exp_f32 v62, v62
    v_exp_f32 v63, v63
    v_exp_f32 v64, v64
    v_exp_f32 v65, v65
    v_exp_f32 v66, v66
    v_exp_f32 v67, v67
    v_exp_f32 v68, v68
    v_exp_f32 v69, v69
    v_exp_f32 v70, v70
    v_exp_f32 v71, v71
    v_add_f32 v22, v22, v56
    v_add_f32 v23, v23, v57
    v_add_f32 v22, v22, v58
    v_add_f32 v23, v23, v59
    v_add_f32 v22, v22, v60
    v_add_f32 v23, v23, v61
    v_add_f32 v22, v22, v62
    v_add_f32 v23, v23, v63
    v_add_f32 v22, v22, v64
    v_add_f32 v23, v23, v65
    v_add_f32 v22, v22, v66
    v_add_f32 v23, v23, v67
    v_add_f32 v22, v22, v68
    v_add_f32 v23, v23, v69
    v_add_f32 v22, v22, v70
    v_add_f32 v23, v23, v71
    v_cvt_pk_bf16_f32 v136, v56, v57
    v_cvt_pk_bf16_f32 v137, v58, v59
    v_cvt_pk_bf16_f32 v138, v60, v61
    v_cvt_pk_bf16_f32 v139, v62, v63
    v_cvt_pk_bf16_f32 v140, v64, v65
    v_cvt_pk_bf16_f32 v141, v66, v67
    v_cvt_pk_bf16_f32 v142, v68, v69
    v_cvt_pk_bf16_f32 v143, v70, v71
    s_waitcnt lgkmcnt(2)
    v_mfma_f32_32x32x16_bf16 v[88:103], v[120:123], v[136:139], v[88:103]
    v_mfma_f32_32x32x16_bf16 v[88:103], v[124:127], v[140:143], v[88:103]
    s_barrier
    ds_read_b128 v[128:131], v20 offset:14336
    ds_read_b128 v[132:135], v20 offset:15360
    s_cmp_eq_u32 s99, 5
    s_cbranch_scc0 ng_64
    v_mov_b32 v24, 0xf149f2ca
    v_mov_b32 v25, 0xf149f2ca
    v_mov_b32 v26, 0xf149f2ca
    v_mov_b32 v27, 0xf149f2ca
    v_mov_b32 v28, 0xf149f2ca
    v_mov_b32 v29, 0xf149f2ca
    v_mov_b32 v30, 0xf149f2ca
    v_mov_b32 v31, 0xf149f2ca
    v_mov_b32 v32, 0xf149f2ca
    v_mov_b32 v33, 0xf149f2ca
    v_mov_b32 v34, 0xf149f2ca
    v_mov_b32 v35, 0xf149f2ca
    v_mov_b32 v36, 0xf149f2ca
    v_mov_b32 v37, 0xf149f2ca
    v_mov_b32 v38, 0xf149f2ca
    v_mov_b32 v39, 0xf149f2ca
ng_64:
    s_waitcnt lgkmcnt(2)
    s_nop 0
    v_mfma_f32_32x32x16_bf16 v[56:71], v[104:107], v[4:7], v[24:39]
    v_mfma_f32_32x32x16_bf16 v[56:71], v[108:111], v[8:11], v[56:71]
    ds_read_b128 v[112:115], v20 offset:4096
    ds_read_b128 v[116:119], v20 offset:5120
    v_exp_f32 v72, v72
    v_exp_f32 v73, v73
    v_exp_f32 v74, v74
    v_exp_f32 v75, v75
    v_exp_f32 v76, v76
    v_exp_f32 v77, v77
    v_exp_f32 v78, v78
    v_exp_f32 v79, v79
    v_exp_f32 v80, v80
    v_exp_f32 v81, v81
    v_exp_f32 v82, v82
    v_exp_f32 v83, v83
    v_exp_f32 v84, v84
    v_exp_f32 v85, v85
    v_exp_f32 v86, v86
    v_exp_f32 v87, v87
    v_add_f32 v22, v22, v72
    v_add_f32 v23, v23, v73
    v_add_f32 v22, v22, v74
    v_add_f32 v23, v23, v75
    v_add_f32 v22, v22, v76
    v_add_f32 v23, v23, v77
    v_add_f32 v22, v22, v78
    v_add_f32 v23, v23, v79
    v_add_f32 v22, v22, v80
    v_add_f32 v23, v23, v81
    v_add_f32 v22, v22, v82
    v_add_f32 v23, v23, v83
    v_add_f32 v22, v22, v84
    v_add_f32 v23, v23, v85
    v_add_f32 v22, v22, v86
    v_add_f32 v23, v23, v87
    v_cvt_pk_bf16_f32 v144, v72, v73
    v_cvt_pk_bf16_f32 v145, v74, v75
    v_cvt_pk_bf16_f32 v146, v76, v77
    v_cvt_pk_bf16_f32 v147, v78, v79
    v_cvt_pk_bf16_f32 v148, v80, v81
    v_cvt_pk_bf16_f32 v149, v82, v83
    v_cvt_pk_bf16_f32 v150, v84, v85
    v_cvt_pk_bf16_f32 v151, v86, v87
    s_waitcnt lgkmcnt(2)
    v_mfma_f32_32x32x16_bf16 v[88:103], v[128:131], v[144:147], v[88:103]
    v_mfma_f32_32x32x16_bf16 v[88:103], v[132:135], v[148:151], v[88:103]
    ds_read_b128 v[120:123], v20 offset:10240
    ds_read_b128 v[124:127], v20 offset:11264
    s_cmp_eq_u32 s99, 6
    s_cbranch_scc0 ng_65
    v_mov_b32 v24, 0xf149f2ca
    v_mov_b32 v25, 0xf149f2ca
    v_mov_b32 v26, 0xf149f2ca
    v_mov_b32 v27, 0xf149f2ca
    v_mov_b32 v28, 0xf149f2ca
    v_mov_b32 v29, 0xf149f2ca
    v_mov_b32 v30, 0xf149f2ca
    v_mov_b32 v31, 0xf149f2ca
    v_mov_b32 v32, 0xf149f2ca
    v_mov_b32 v33, 0xf149f2ca
    v_mov_b32 v34, 0xf149f2ca
    v_mov_b32 v35, 0xf149f2ca
    v_mov_b32 v36, 0xf149f2ca
    v_mov_b32 v37, 0xf149f2ca
    v_mov_b32 v38, 0xf149f2ca
    v_mov_b32 v39, 0xf149f2ca
ng_65:
    s_waitcnt lgkmcnt(2)
    s_nop 0
    v_mfma_f32_32x32x16_bf16 v[72:87], v[112:115], v[4:7], v[24:39]
    v_mfma_f32_32x32x16_bf16 v[72:87], v[116:119], v[8:11], v[72:87]
    v_exp_f32 v56, v56
    v_exp_f32 v57, v57
    v_exp_f32 v58, v58
    v_exp_f32 v59, v59
    v_exp_f32 v60, v60
    v_exp_f32 v61, v61
    v_exp_f32 v62, v62
    v_exp_f32 v63, v63
    v_exp_f32 v64, v64
    v_exp_f32 v65, v65
    v_exp_f32 v66, v66
    v_exp_f32 v67, v67
    v_exp_f32 v68, v68
    v_exp_f32 v69, v69
    v_exp_f32 v70, v70
    v_exp_f32 v71, v71
    v_add_f32 v22, v22, v56
    v_add_f32 v23, v23, v57
    v_add_f32 v22, v22, v58
    v_add_f32 v23, v23, v59
    v_add_f32 v22, v22, v60
    v_add_f32 v23, v23, v61
    v_add_f32 v22, v22, v62
    v_add_f32 v23, v23, v63
    v_add_f32 v22, v22, v64
    v_add_f32 v23, v23, v65
    v_add_f32 v22, v22, v66
    v_add_f32 v23, v23, v67
    v_add_f32 v22, v22, v68
    v_add_f32 v23, v23, v69
    v_add_f32 v22, v22, v70
    v_add_f32 v23, v23, v71
    v_cvt_pk_bf16_f32 v136, v56, v57
    v_cvt_pk_bf16_f32 v137, v58, v59
    v_cvt_pk_bf16_f32 v138, v60, v61
    v_cvt_pk_bf16_f32 v139, v62, v63
    v_cvt_pk_bf16_f32 v140, v64, v65
    v_cvt_pk_bf16_f32 v141, v66, v67
    v_cvt_pk_bf16_f32 v142, v68, v69
    v_cvt_pk_bf16_f32 v143, v70, v71
    s_waitcnt lgkmcnt(0)
    v_mfma_f32_32x32x16_bf16 v[88:103], v[120:123], v[136:139], v[88:103]
    v_mfma_f32_32x32x16_bf16 v[88:103], v[124:127], v[140:143], v[88:103]
    ds_read_b128 v[128:131], v20 offset:6144
    ds_read_b128 v[132:135], v20 offset:7168
    v_exp_f32 v72, v72
    v_exp_f32 v73, v73
    v_exp_f32 v74, v74
    v_exp_f32 v75, v75
    v_exp_f32 v76, v76
    v_exp_f32 v77, v77
    v_exp_f32 v78, v78
    v_exp_f32 v79, v79
    v_exp_f32 v80, v80
    v_exp_f32 v81, v81
    v_exp_f32 v82, v82
    v_exp_f32 v83, v83
    v_exp_f32 v84, v84
    v_exp_f32 v85, v85
    v_exp_f32 v86, v86
    v_exp_f32 v87, v87
    v_add_f32 v22, v22, v72
    v_add_f32 v23, v23, v73
    v_add_f32 v22, v22, v74
    v_add_f32 v23, v23, v75
    v_add_f32 v22, v22, v76
    v_add_f32 v23, v23, v77
    v_add_f32 v22, v22, v78
    v_add_f32 v23, v23, v79
    v_add_f32 v22, v22, v80
    v_add_f32 v23, v23, v81
    v_add_f32 v22, v22, v82
    v_add_f32 v23, v23, v83
    v_add_f32 v22, v22, v84
    v_add_f32 v23, v23, v85
    v_add_f32 v22, v22, v86
    v_add_f32 v23, v23, v87
    v_cvt_pk_bf16_f32 v144, v72, v73
    v_cvt_pk_bf16_f32 v145, v74, v75
    v_cvt_pk_bf16_f32 v146, v76, v77
    v_cvt_pk_bf16_f32 v147, v78, v79
    v_cvt_pk_bf16_f32 v148, v80, v81
    v_cvt_pk_bf16_f32 v149, v82, v83
    v_cvt_pk_bf16_f32 v150, v84, v85
    v_cvt_pk_bf16_f32 v151, v86, v87
    s_waitcnt lgkmcnt(0)
    v_mfma_f32_32x32x16_bf16 v[88:103], v[128:131], v[144:147], v[88:103]
    v_mfma_f32_32x32x16_bf16 v[88:103], v[132:135], v[148:151], v[88:103]
    v_add_f32 v22, v22, v23
    v_mov_b32 v152, v22
    s_nop 1
    v_permlane32_swap_b32 v22, v152
    v_add_f32 v22, v22, v152
    v_rcp_f32 v22, v22
    s_lshl_b32 s36, s99, 16
    s_add_u32 s36, s36, s26
    s_add_u32 s36, s36, 0x808000
    s_lshl_b32 s33, s25, 11
    s_add_u32 s33, s33, s36
    s_lshl_b32 s30, s24, 9
    s_lshl_b32 s31, s3, 6
    s_add_u32 s30, s30, s31
    s_add_u32 s30, s30, s26
    s_add_u32 s30, s30, 0xdc2000
    s_lshl_b32 s31, s25, 2
    s_add_u32 s31, s31, s30
    v_pk_mul_f32 v[88:89], v[88:89], v[22:23] op_sel_hi:[1,0]
    v_pk_mul_f32 v[90:91], v[90:91], v[22:23] op_sel_hi:[1,0]
    v_pk_mul_f32 v[92:93], v[92:93], v[22:23] op_sel_hi:[1,0]
    v_pk_mul_f32 v[94:95], v[94:95], v[22:23] op_sel_hi:[1,0]
    v_pk_mul_f32 v[96:97], v[96:97], v[22:23] op_sel_hi:[1,0]
    v_pk_mul_f32 v[98:99], v[98:99], v[22:23] op_sel_hi:[1,0]
    v_pk_mul_f32 v[100:101], v[100:101], v[22:23] op_sel_hi:[1,0]
    v_pk_mul_f32 v[102:103], v[102:103], v[22:23] op_sel_hi:[1,0]
    v_cvt_pk_bf16_f32 v88, v88, v89
    v_cvt_pk_bf16_f32 v89, v90, v91
    v_cvt_pk_bf16_f32 v90, v92, v93
    v_cvt_pk_bf16_f32 v91, v94, v95
    v_cvt_pk_bf16_f32 v92, v96, v97
    v_cvt_pk_bf16_f32 v93, v98, v99
    v_cvt_pk_bf16_f32 v94, v100, v101
    v_cvt_pk_bf16_f32 v95, v102, v103
    s_cmp_lg_u32 s77, 0
    s_cbranch_scc1 lc_66
    buffer_store_dwordx4 v[88:91], v253, s[20:23], s33 offen sc1
    buffer_store_dwordx4 v[92:95], v253, s[20:23], s33 offen offset:1024 sc1
    s_branch lc_67
lc_66:
    buffer_store_dwordx4 v[88:91], v253, s[20:23], s33 offen
    buffer_store_dwordx4 v[92:95], v253, s[20:23], s33 offen offset:1024
lc_67:
    v_mov_b32 v154, 0
    s_mov_b64 exec, 1
    s_waitcnt vmcnt(0)
    s_cmp_lg_u32 s77, 0
    s_cbranch_scc1 lc_68
    buffer_store_dword v154, v154, s[20:23], s31 offen sc1
    s_branch lc_69
lc_68:
    buffer_store_dword v154, v154, s[20:23], s31 offen
lc_69:
    s_mov_b64 exec, -1
    v_bfe_u32 v20, v252, 3, 2
    v_lshrrev_b32 v21, 5, v252
    v_lshl_add_u32 v20, v21, 3, v20
    s_lshr_b32 s32, s28, 1
    s_lshl_b32 s32, s32, 4
    s_and_b32 s33, s28, 1
    s_lshl_b32 s33, s33, 2
    s_add_u32 s32, s32, s33
    v_add_u32 v20, s32, v20
    v_lshlrev_b32 v20, 11, v20
    v_lshrrev_b32 v21, 2, v252
    v_and_b32 v21, 4, v21
    v_xor_b32 v21, v21, v252
    v_and_b32 v21, 7, v21
    v_lshl_add_u32 v20, v21, 4, v20
    s_lshl_b32 s32, s98, 7
    v_add_u32 v14, s32, v20
    s_lshl_b32 s32, s28, 9
    s_sub_u32 s34, s29, 224
    s_lshl_b32 s34, s34, 1
    s_add_u32 s89, s34, s28
    s_and_b32 s35, s28, 1
    s_add_u32 s34, s34, s35
    s_lshl_b32 s34, s34, 5
    v_lshrrev_b32 v22, 1, v252
    v_and_b32 v23, 1, v252
    s_cmp_lt_u32 s29, 224
    s_cselect_b32 s32, s32, s34
    s_cselect_b64 vcc, -1, 0
    v_cndmask_b32 v22, v23, v22, vcc
    v_lshl_add_u32 v22, v22, 4, s32
    s_mov_b32 s79, s26
    s_cmp_lg_u32 s26, 0
    s_cbranch_scc1 sk_70
    s_mov_b32 s30, 0x05040100
    s_mov_b32 s31, 0x07060302
    v_perm_b32 v155, v160, v156, s30
    v_perm_b32 v160, v160, v156, s31
    v_perm_b32 v156, v161, v157, s30
    v_perm_b32 v161, v161, v157, s31
    v_perm_b32 v157, v162, v158, s30
    v_perm_b32 v162, v162, v158, s31
    v_perm_b32 v158, v163, v159, s30
    v_perm_b32 v163, v163, v159, s31
    v_perm_b32 v159, v168, v164, s30
    v_perm_b32 v168, v168, v164, s31
    v_perm_b32 v164, v169, v165, s30
    v_perm_b32 v169, v169, v165, s31
    v_perm_b32 v165, v170, v166, s30
    v_perm_b32 v170, v170, v166, s31
    v_perm_b32 v166, v171, v167, s30
    v_perm_b32 v171, v171, v167, s31
    v_perm_b32 v167, v176, v172, s30
    v_perm_b32 v176, v176, v172, s31
    v_perm_b32 v172, v177, v173, s30
    v_perm_b32 v177, v177, v173, s31
    v_perm_b32 v173, v178, v174, s30
    v_perm_b32 v178, v178, v174, s31
    v_perm_b32 v174, v179, v175, s30
    v_perm_b32 v179, v179, v175, s31
    v_perm_b32 v175, v184, v180, s30
    v_perm_b32 v184, v184, v180, s31
    v_perm_b32 v180, v185, v181, s30
    v_perm_b32 v185, v185, v181, s31
    v_perm_b32 v181, v186, v182, s30
    v_perm_b32 v186, v186, v182, s31
    v_perm_b32 v182, v187, v183, s30
    v_perm_b32 v187, v187, v183, s31
    v_perm_b32 v183, v192, v188, s30
    v_perm_b32 v192, v192, v188, s31
    v_perm_b32 v188, v193, v189, s30
    v_perm_b32 v193, v193, v189, s31
    v_perm_b32 v189, v194, v190, s30
    v_perm_b32 v194, v194, v190, s31
    v_perm_b32 v190, v195, v191, s30
    v_perm_b32 v195, v195, v191, s31
    v_perm_b32 v191, v200, v196, s30
    v_perm_b32 v200, v200, v196, s31
    v_perm_b32 v196, v201, v197, s30
    v_perm_b32 v201, v201, v197, s31
    v_perm_b32 v197, v202, v198, s30
    v_perm_b32 v202, v202, v198, s31
    v_perm_b32 v198, v203, v199, s30
    v_perm_b32 v203, v203, v199, s31
    v_perm_b32 v199, v208, v204, s30
    v_perm_b32 v208, v208, v204, s31
    v_perm_b32 v204, v209, v205, s30
    v_perm_b32 v209, v209, v205, s31
    v_perm_b32 v205, v210, v206, s30
    v_perm_b32 v210, v210, v206, s31
    v_perm_b32 v206, v211, v207, s30
    v_perm_b32 v211, v211, v207, s31
    v_perm_b32 v207, v216, v212, s30
    v_perm_b32 v216, v216, v212, s31
    v_perm_b32 v212, v217, v213, s30
    v_perm_b32 v217, v217, v213, s31
    v_perm_b32 v213, v218, v214, s30
    v_perm_b32 v218, v218, v214, s31
    v_perm_b32 v214, v219, v215, s30
    v_perm_b32 v219, v219, v215, s31
    v_perm_b32 v215, v224, v220, s30
    v_perm_b32 v224, v224, v220, s31
    v_perm_b32 v220, v225, v221, s30
    v_perm_b32 v225, v225, v221, s31
    v_perm_b32 v221, v226, v222, s30
    v_perm_b32 v226, v226, v222, s31
    v_perm_b32 v222, v227, v223, s30
    v_perm_b32 v227, v227, v223, s31
    v_perm_b32 v223, v232, v228, s30
    v_perm_b32 v232, v232, v228, s31
    v_perm_b32 v228, v233, v229, s30
    v_perm_b32 v233, v233, v229, s31
    v_perm_b32 v229, v234, v230, s30
    v_perm_b32 v234, v234, v230, s31
    v_perm_b32 v230, v235, v231, s30
    v_perm_b32 v235, v235, v231, s31
    v_perm_b32 v231, v240, v236, s30
    v_perm_b32 v240, v240, v236, s31
    v_perm_b32 v236, v241, v237, s30
    v_perm_b32 v241, v241, v237, s31
    v_perm_b32 v237, v242, v238, s30
    v_perm_b32 v242, v242, v238, s31
    v_perm_b32 v238, v243, v239, s30
    v_perm_b32 v243, v243, v239, s31
    v_perm_b32 v239, v248, v244, s30
    v_perm_b32 v248, v248, v244, s31
    v_perm_b32 v244, v249, v245, s30
    v_perm_b32 v249, v249, v245, s31
    v_perm_b32 v245, v250, v246, s30
    v_perm_b32 v250, v250, v246, s31
    v_perm_b32 v246, v251, v247, s30
    v_perm_b32 v251, v251, v247, s31
    v_lshrrev_b32 v21, 3, v252
    s_lshl_b32 s84, s24, 18
    s_add_u32 s84, s84, s86
    s_add_u32 s84, s84, 0x2000000
    v_mul_u32_u24 v20, 6144, v21
    v_and_b32 v21, 6, v21
    v_xor_b32 v21, v21, v252
    v_and_b32 v21, 7, v21
    v_lshl_add_u32 v20, v21, 4, v20
    s_mul_i32 s32, s28, 3
    s_bfe_u32 s33, s32, 0x10001
    s_mul_i32 s33, s33, 196608
    s_and_b32 s34, s32, 1
    s_mul_i32 s34, s34, 49152
    s_add_u32 s33, s33, s34
    s_lshr_b32 s34, s32, 2
    s_lshl_b32 s34, s34, 11
    s_add_u32 s33, s33, s34
    v_add_u32 v8, s33, v20
    v_add_u32 v9, 97280, v8
    s_add_u32 s32, s32, 1
    s_bfe_u32 s33, s32, 0x10001
    s_mul_i32 s33, s33, 196608
    s_and_b32 s34, s32, 1
    s_mul_i32 s34, s34, 49152
    s_add_u32 s33, s33, s34
    s_lshr_b32 s34, s32, 2
    s_lshl_b32 s34, s34, 11
    s_add_u32 s33, s33, s34
    s_sub_u32 s33, s33, 2048
    v_add_u32 v10, s33, v20
    v_add_u32 v11, 97280, v10
    s_add_u32 s32, s32, 1
    s_bfe_u32 s33, s32, 0x10001
    s_mul_i32 s33, s33, 196608
    s_and_b32 s34, s32, 1
    s_mul_i32 s34, s34, 49152
    s_add_u32 s33, s33, s34
    s_lshr_b32 s34, s32, 2
    s_lshl_b32 s34, s34, 11
    s_add_u32 s33, s33, s34
    v_add_u32 v12, s33, v20
    v_add_u32 v13, 97280, v12
    s_sub_u32 s30, s95, 1
    s_sub_u32 s95, s94, 3
    s_mov_b32 s94, s30
    v_bfe_u32 v116, v252, 4, 1
    v_lshlrev_b32 v116, 11, v116
    v_lshrrev_b32 v117, 5, v252
    v_lshl_add_u32 v116, v117, 8, v116
    v_and_b32 v117, 15, v252
    v_lshl_add_u32 v116, v117, 4, v116
    s_lshl_b32 s34, s28, 12
    s_add_u32 s34, s34, 147456
    v_add_u32 v117, s34, v116
    v_and_b32 v16, 15, v252
    v_lshlrev_b32 v16, 9, v16
    s_load_dwordx2 s[12:13], s[0:1], 64
    s_mov_b32 s14, 0x400000
    s_mov_b32 s15, 0x20000
    s_waitcnt lgkmcnt(0)
sk_70:
    s_barrier
    s_add_u32 s96, s25, 12
    s_and_b32 s96, s96, 15
    s_lshl_b32 s96, s96, 17
    s_add_u32 s96, s96, 65536
    s_add_u32 m0, s101, 114688
    s_nop 0
    buffer_load_dwordx4 v14, s[8:11], s96 offen lds
    s_add_u32 s96, s25, 13
    s_and_b32 s96, s96, 15
    s_lshl_b32 s96, s96, 17
    s_add_u32 s96, s96, 65536
    s_add_u32 m0, s101, 118784
    s_nop 0
    buffer_load_dwordx4 v14, s[8:11], s96 offen lds
    s_add_u32 s96, s25, 14
    s_and_b32 s96, s96, 15
    s_lshl_b32 s96, s96, 17
    s_add_u32 s96, s96, 65536
    s_add_u32 m0, s101, 122880
    s_nop 0
    buffer_load_dwordx4 v14, s[8:11], s96 offen lds
    s_add_u32 s96, s25, 15
    s_and_b32 s96, s96, 15
    s_lshl_b32 s96, s96, 17
    s_add_u32 s96, s96, 65536
    s_add_u32 m0, s101, 126976
    s_nop 0
    buffer_load_dwordx4 v14, s[8:11], s96 offen lds
    s_waitcnt vmcnt(0)
    s_barrier
    s_cmp_lg_u32 s26, 0
    s_cbranch_scc1 l_tail
    s_mov_b32 s26, 16777216
    s_add_u32 s96, s94, 0
    s_and_b32 s96, s96, 15
    s_mul_i32 s96, s96, 393216
    s_add_u32 s96, s96, s85
    s_add_u32 m0, s87, 40960
    s_nop 0
    buffer_load_dwordx4 v8, s[16:19], s96 offen offset:0 lds
    buffer_load_dwordx4 v9, s[16:19], s96 offen offset:1024 lds
    buffer_load_dwordx4 v10, s[16:19], s96 offen offset:2048 lds
    buffer_load_dwordx4 v11, s[16:19], s96 offen offset:3072 lds
    s_add_u32 m0, s87, 45056
    s_nop 0
    buffer_load_dwordx4 v12, s[16:19], s96 offen offset:0 lds
    buffer_load_dwordx4 v13, s[16:19], s96 offen offset:1024 lds
    s_add_u32 s96, s95, 1
    s_and_b32 s96, s96, 15
    s_mul_i32 s96, s96, 393216
    s_add_u32 s96, s96, s85
    s_add_u32 m0, s87, 65536
    s_nop 0
    buffer_load_dwordx4 v8, s[16:19], s96 offen offset:0 lds
    buffer_load_dwordx4 v9, s[16:19], s96 offen offset:1024 lds
    buffer_load_dwordx4 v10, s[16:19], s96 offen offset:2048 lds
    buffer_load_dwordx4 v11, s[16:19], s96 offen offset:3072 lds
    s_add_u32 m0, s87, 69632
    s_nop 0
    buffer_load_dwordx4 v12, s[16:19], s96 offen offset:0 lds
    buffer_load_dwordx4 v13, s[16:19], s96 offen offset:1024 lds
    s_lshl_b32 s30, s99, 13
    s_add_u32 s30, s30, 0xc00000
    s_waitcnt vmcnt(6)
    s_barrier
    s_add_u32 s96, s94, 2
    s_and_b32 s96, s96, 15
    s_mul_i32 s96, s96, 393216
    s_add_u32 s96, s96, s85
    s_add_u32 m0, s87, 90112
    s_nop 0
    buffer_load_dwordx4 v8, s[16:19], s96 offen offset:0 lds
    buffer_load_dwordx4 v9, s[16:19], s96 offen offset:1024 lds
    buffer_load_dwordx4 v10, s[16:19], s96 offen offset:2048 lds
    buffer_load_dwordx4 v11, s[16:19], s96 offen offset:3072 lds
    s_add_u32 m0, s87, 94208
    s_nop 0
    buffer_load_dwordx4 v12, s[16:19], s96 offen offset:0 lds
    buffer_load_dwordx4 v13, s[16:19], s96 offen offset:1024 lds
    ds_read_b128 v[100:103], v117 offset:0
    ds_read_b128 v[104:107], v117 offset:512
    ds_read_b128 v[108:111], v117 offset:1024
    ds_read_b128 v[112:115], v117 offset:1536
    s_mov_b32 s78, s27
pl_71:
    buffer_load_dword v17, v16, s[20:23], s30 offen sc1
    s_waitcnt vmcnt(0)
pc_72:
    v_cmp_eq_u32 vcc, -1, v17
    s_cbranch_vccz pd_73
    s_sub_u32 s78, s78, 1
    s_cmp_lg_u32 s78, 0
    s_cbranch_scc1 pl_71
    s_mov_b32 s27, 1
pd_73:
    s_add_u32 s96, s95, 1
    s_and_b32 s96, s96, 15
    s_lshl_b32 s97, s96, 14
    s_add_u32 s97, s97, s84
    s_add_u32 m0, s86, 131072
    s_nop 0
    buffer_load_dwordx4 v253, s[20:23], s97 offen offset:0 sc1 lds
    buffer_load_dwordx4 v253, s[20:23], s97 offen offset:1024 sc1 lds
    buffer_load_dwordx4 v253, s[20:23], s97 offen offset:2048 sc1 lds
    buffer_load_dwordx4 v253, s[20:23], s97 offen offset:3072 sc1 lds
    s_lshl_b32 s30, s99, 13
    s_add_u32 s30, s30, 0xc00000
    s_add_u32 s31, s30, 4096
    buffer_load_dwordx4 v[64:67], v253, s[20:23], s30 offen offset:0 sc1
    buffer_load_dwordx4 v[68:71], v253, s[20:23], s30 offen offset:1024 sc1
    buffer_load_dwordx4 v[72:75], v253, s[20:23], s30 offen offset:2048 sc1
    buffer_load_dwordx4 v[76:79], v253, s[20:23], s30 offen offset:3072 sc1
    buffer_load_dwordx4 v[80:83], v253, s[20:23], s31 offen offset:0 sc1
    buffer_load_dwordx4 v[84:87], v253, s[20:23], s31 offen offset:1024 sc1
    buffer_load_dwordx4 v[88:91], v253, s[20:23], s31 offen offset:2048 sc1
    buffer_load_dwordx4 v[92:95], v253, s[20:23], s31 offen offset:3072 sc1
    s_waitcnt vmcnt(8) lgkmcnt(0)
    s_barrier
    s_add_u32 s96, s94, 2
    s_and_b32 s96, s96, 15
    s_lshl_b32 s97, s96, 14
    s_add_u32 s97, s97, s84
    s_add_u32 m0, s86, 114688
    s_nop 0
    buffer_load_dwordx4 v253, s[20:23], s97 offen offset:0 sc1 lds
    buffer_load_dwordx4 v253, s[20:23], s97 offen offset:1024 sc1 lds
    buffer_load_dwordx4 v253, s[20:23], s97 offen offset:2048 sc1 lds
    buffer_load_dwordx4 v253, s[20:23], s97 offen offset:3072 sc1 lds
    s_mov_b32 s78, s27
    s_waitcnt vmcnt(4)
    s_branch pc_75
pl_74:
    s_lshl_b32 s30, s99, 13
    s_add_u32 s30, s30, 0xc00000
    s_add_u32 s31, s30, 4096
    buffer_load_dwordx4 v[64:67], v253, s[20:23], s30 offen offset:0 sc1
    buffer_load_dwordx4 v[68:71], v253, s[20:23], s30 offen offset:1024 sc1
    buffer_load_dwordx4 v[72:75], v253, s[20:23], s30 offen offset:2048 sc1
    buffer_load_dwordx4 v[76:79], v253, s[20:23], s30 offen offset:3072 sc1
    buffer_load_dwordx4 v[80:83], v253, s[20:23], s31 offen offset:0 sc1
    buffer_load_dwordx4 v[84:87], v253, s[20:23], s31 offen offset:1024 sc1
    buffer_load_dwordx4 v[88:91], v253, s[20:23], s31 offen offset:2048 sc1
    buffer_load_dwordx4 v[92:95], v253, s[20:23], s31 offen offset:3072 sc1
    s_waitcnt vmcnt(0)
pc_75:
    v_max3_u32 v48, v64, v65, v66
    v_max3_u32 v48, v48, v67, v68
    v_max3_u32 v48, v48, v69, v70
    v_max3_u32 v48, v48, v71, v72
    v_max3_u32 v48, v48, v73, v74
    v_max3_u32 v48, v48, v75, v76
    v_max3_u32 v48, v48, v77, v78
    v_max3_u32 v48, v48, v79, v80
    v_max3_u32 v48, v48, v81, v82
    v_max3_u32 v48, v48, v83, v84
    v_max3_u32 v48, v48, v85, v86
    v_max3_u32 v48, v48, v87, v88
    v_max3_u32 v48, v48, v89, v90
    v_max3_u32 v48, v48, v91, v92
    v_max3_u32 v48, v48, v93, v94
    v_max_u32 v48, v48, v95
    v_cmp_eq_u32 vcc, -1, v48
    s_cbranch_vccz pd_76
    s_sub_u32 s78, s78, 1
    s_cmp_lg_u32 s78, 0
    s_cbranch_scc1 pl_74
    s_mov_b32 s27, 1
pd_76:
    s_add_u32 s96, s95, 3
    s_and_b32 s96, s96, 15
    s_lshl_b32 s97, s96, 14
    s_add_u32 s97, s97, s84
    s_add_u32 m0, s86, 147456
    s_nop 0
    buffer_load_dwordx4 v253, s[20:23], s97 offen offset:0 sc1 lds
    buffer_load_dwordx4 v253, s[20:23], s97 offen offset:1024 sc1 lds
    buffer_load_dwordx4 v253, s[20:23], s97 offen offset:2048 sc1 lds
    v_pk_add_f32 v[64:65], v[64:65], v[68:69]
    v_pk_add_f32 v[66:67], v[66:67], v[70:71]
    v_pk_add_f32 v[64:65], v[64:65], v[72:73]
    v_pk_add_f32 v[66:67], v[66:67], v[74:75]
    v_pk_add_f32 v[64:65], v[64:65], v[76:77]
    v_pk_add_f32 v[66:67], v[66:67], v[78:79]
    v_pk_add_f32 v[64:65], v[64:65], v[80:81]
    v_pk_add_f32 v[66:67], v[66:67], v[82:83]
    buffer_load_dwordx4 v253, s[20:23], s97 offen offset:3072 sc1 lds
    v_pk_add_f32 v[64:65], v[64:65], v[84:85]
    v_pk_add_f32 v[66:67], v[66:67], v[86:87]
    v_pk_add_f32 v[64:65], v[64:65], v[88:89]
    v_pk_add_f32 v[66:67], v[66:67], v[90:91]
    v_pk_add_f32 v[64:65], v[64:65], v[92:93]
    v_pk_add_f32 v[66:67], v[66:67], v[94:95]
    v_mov_b32 v48, v64
    v_mov_b32 v49, v65
    v_mov_b32 v50, v66
    v_mov_b32 v51, v67
    v_permlane32_swap_b32 v64, v48
    v_permlane32_swap_b32 v65, v49
    v_permlane32_swap_b32 v66, v50
    s_add_u32 s96, s95, 3
    s_and_b32 s96, s96, 15
    s_mul_i32 s96, s96, 393216
    s_add_u32 s96, s96, s85
    s_add_u32 m0, s87, 40960
    s_nop 0
    buffer_load_dwordx4 v8, s[16:19], s96 offen offset:0 lds
    v_permlane32_swap_b32 v67, v51
    v_add_f32 v64, v64, v48
    v_add_f32 v65, v65, v49
    v_add_f32 v66, v66, v50
    v_add_f32 v67, v67, v51
    v_mul_f32 v54, 0x3a800000, v64
    v_mul_f32 v65, 0x3a800000, v65
    v_fma_f32 v65, -v54, v54, v65
    v_max_f32 v65, 0, v65
    v_add_f32 v55, 0x3727c5ac, v65
    v_rsq_f32 v55, v55
    v_fma_f32 v52, -v54, v67, v66
    buffer_load_dwordx4 v9, s[16:19], s96 offen offset:1024 lds
    v_and_b32 v53, 31, v252
    v_mul_f32 v52, v52, v55
    s_lshl_b32 s32, s99, 5
    v_add_u32 v53, s32, v53
    v_mov_b32 v48, v52
    s_nop 1
    v_max_f32_dpp v48, v48, v48 quad_perm:[1,0,3,2] row_mask:0xf bank_mask:0xf
    s_nop 1
    v_max_f32_dpp v48, v48, v48 quad_perm:[2,3,0,1] row_mask:0xf bank_mask:0xf
    s_nop 1
    v_max_f32_dpp v48, v48, v48 row_half_mirror row_mask:0xf bank_mask:0xf
    s_nop 1
    v_max_f32_dpp v48, v48, v48 row_mirror row_mask:0xf bank_mask:0xf
    v_mov_b32 v49, v48
    s_nop 1
    v_permlane16_swap_b32 v48, v49
    v_max_f32 v48, v48, v49
    v_cmp_eq_f32 vcc, v48, v52
    buffer_load_dwordx4 v10, s[16:19], s96 offen offset:2048 lds
    v_lshrrev_b32 v50, 5, v252
    v_lshlrev_b32 v50, 4, v50
    s_lshl_b32 s32, s99, 11
    s_lshl_b32 s33, s98, 7
    s_add_u32 s32, s32, s33
    s_add_u32 s32, s32, 0xd60000
    s_lshl_b32 s34, s99, 4
    s_add_u32 s34, s34, 0xdc0000
    s_ff1_i32_b32 s35, vcc_lo
    s_lshl_b32 s35, 1, s35
    s_cmp_eq_u32 s25, 0
    s_cselect_b32 exec_lo, s35, 0
    s_mov_b32 exec_hi, 0
    buffer_store_dwordx4 v[52:55], v50, s[20:23], s34 offen sc1
    s_mov_b32 exec_lo, s35
    s_mov_b32 exec_hi, s35
    buffer_store_dwordx4 v[100:103], v50, s[20:23], s32 offen offset:0 sc1
    buffer_store_dwordx4 v[104:107], v50, s[20:23], s32 offen offset:32 sc1
    buffer_store_dwordx4 v[108:111], v50, s[20:23], s32 offen offset:64 sc1
    buffer_store_dwordx4 v[112:115], v50, s[20:23], s32 offen offset:96 sc1
    s_mov_b64 exec, -1
    buffer_load_dwordx4 v11, s[16:19], s96 offen offset:3072 lds
    v_add_f32 v56, 1.0, v55
    v_mul_f32 v57, v54, v55
    s_add_u32 m0, s87, 45056
    s_nop 0
    buffer_load_dwordx4 v12, s[16:19], s96 offen offset:0 lds
    v_mul_f32 v58, v56, v56
    v_sub_f32 v57, 0, v57
    v_mul_f32 v58, v58, v65
    v_add_f32 v58, 0x3727c5ac, v58
    v_rsq_f32 v58, v58
    s_nop 0
    v_mul_f32 v58, v58, v56
    v_cmp_gt_u32 vcc, 32, v252
    v_and_b32 v48, 31, v252
    v_lshrrev_b32 v49, 5, v252
    v_lshlrev_b32 v49, 9, v49
    v_lshl_add_u32 v48, v48, 2, v49
    s_lshl_b32 s32, s28, 7
    buffer_load_dwordx4 v13, s[16:19], s96 offen offset:1024 lds
    v_add_u32 v48, s32, v48
    v_cndmask_b32 v49, v54, v58, vcc
    v_cndmask_b32 v50, v57, v56, vcc
    ds_write_b32 v48, v49 offset:0
    ds_write_b32 v48, v50 offset:2048
    v_and_b32 v48, 15, v252
    v_lshrrev_b32 v51, 4, v252
    v_lshl_add_u32 v48, v48, 2, v51
    s_min_u32 s32, s28, 2
    s_lshl_b32 s32, s32, 8
    v_lshl_add_u32 v48, v48, 2, s32
    ds_write_b32 v48, v2 offset:1024
    s_waitcnt vmcnt(14) lgkmcnt(0)
    s_barrier
    s_add_u32 s96, s94, 4
    s_and_b32 s96, s96, 15
    s_lshl_b32 s97, s96, 14
    s_add_u32 s97, s97, s84
    s_add_u32 m0, s86, 131072
    s_nop 0
    buffer_load_dwordx4 v253, s[20:23], s97 offen offset:0 sc1 lds
    buffer_load_dwordx4 v253, s[20:23], s97 offen offset:1024 sc1 lds
    buffer_load_dwordx4 v253, s[20:23], s97 offen offset:2048 sc1 lds
    buffer_load_dwordx4 v253, s[20:23], s97 offen offset:3072 sc1 lds
    s_add_u32 s96, s94, 4
    s_and_b32 s96, s96, 15
    s_mul_i32 s96, s96, 393216
    s_add_u32 s96, s96, s85
    s_add_u32 m0, s87, 65536
    s_nop 0
    buffer_load_dwordx4 v8, s[16:19], s96 offen offset:0 lds
    buffer_load_dwordx4 v9, s[16:19], s96 offen offset:1024 lds
    buffer_load_dwordx4 v10, s[16:19], s96 offen offset:2048 lds
    buffer_load_dwordx4 v11, s[16:19], s96 offen offset:3072 lds
    s_add_u32 m0, s87, 69632
    s_nop 0
    buffer_load_dwordx4 v12, s[16:19], s96 offen offset:0 lds
    buffer_load_dwordx4 v13, s[16:19], s96 offen offset:1024 lds
    s_waitcnt vmcnt(10) lgkmcnt(0)
    s_barrier
    s_add_u32 s96, s95, 5
    s_and_b32 s96, s96, 15
    s_lshl_b32 s97, s96, 14
    s_add_u32 s97, s97, s84
    s_add_u32 m0, s86, 114688
    s_nop 0
    buffer_load_dwordx4 v253, s[20:23], s97 offen offset:0 sc1 lds
    buffer_load_dwordx4 v253, s[20:23], s97 offen offset:1024 sc1 lds
    buffer_load_dwordx4 v253, s[20:23], s97 offen offset:2048 sc1 lds
    buffer_load_dwordx4 v253, s[20:23], s97 offen offset:3072 sc1 lds
    s_add_u32 s96, s95, 5
    s_and_b32 s96, s96, 15
    s_mul_i32 s96, s96, 393216
    s_add_u32 s96, s96, s85
    s_add_u32 m0, s87, 90112
    s_nop 0
    buffer_load_dwordx4 v8, s[16:19], s96 offen offset:0 lds
    buffer_load_dwordx4 v9, s[16:19], s96 offen offset:1024 lds
    buffer_load_dwordx4 v10, s[16:19], s96 offen offset:2048 lds
    buffer_load_dwordx4 v11, s[16:19], s96 offen offset:3072 lds
    s_add_u32 m0, s87, 94208
    s_nop 0
    buffer_load_dwordx4 v12, s[16:19], s96 offen offset:0 lds
    buffer_load_dwordx4 v13, s[16:19], s96 offen offset:1024 lds
    s_waitcnt vmcnt(10) lgkmcnt(0)
    s_barrier
    s_add_u32 s32, s79, 0xdc0000
    s_add_u32 s96, s94, 6
    s_and_b32 s96, s96, 15
    s_lshl_b32 s97, s96, 14
    s_add_u32 s97, s97, s84
    s_add_u32 m0, s86, 147456
    s_nop 0
    buffer_load_dwordx4 v253, s[20:23], s97 offen offset:0 sc1 lds
    buffer_load_dwordx4 v253, s[20:23], s97 offen offset:1024 sc1 lds
    buffer_load_dwordx4 v253, s[20:23], s97 offen offset:2048 sc1 lds
    buffer_load_dwordx4 v253, s[20:23], s97 offen offset:3072 sc1 lds
    s_add_u32 s96, s94, 6
    s_and_b32 s96, s96, 15
    s_mul_i32 s96, s96, 393216
    s_add_u32 s96, s96, s85
    s_add_u32 m0, s87, 40960
    s_nop 0
    buffer_load_dwordx4 v8, s[16:19], s96 offen offset:0 lds
    buffer_load_dwordx4 v[16:19], v253, s[20:23], s32 offen sc1
    buffer_load_dwordx4 v9, s[16:19], s96 offen offset:1024 lds
    buffer_load_dwordx4 v10, s[16:19], s96 offen offset:2048 lds
    buffer_load_dwordx4 v11, s[16:19], s96 offen offset:3072 lds
    s_add_u32 m0, s87, 45056
    s_nop 0
    buffer_load_dwordx4 v12, s[16:19], s96 offen offset:0 lds
    buffer_load_dwordx4 v13, s[16:19], s96 offen offset:1024 lds
    s_waitcnt vmcnt(11) lgkmcnt(0)
    s_barrier
    s_mov_b32 s78, s27
    s_waitcnt vmcnt(5)
    s_branch pc_79
pl_78:
    s_add_u32 s32, s79, 0xdc0000
    buffer_load_dwordx4 v[16:19], v253, s[20:23], s32 offen sc1
    s_waitcnt vmcnt(0)
pc_79:
    v_max3_u32 v20, v16, v17, v18
    v_max_u32 v20, v20, v19
    v_cmp_eq_u32 vcc, -1, v20
    s_cbranch_vccz pd_80
    s_sub_u32 s78, s78, 1
    s_cmp_lg_u32 s78, 0
    s_cbranch_scc1 pl_78
    s_mov_b32 s27, 1
pd_80:
    s_add_u32 s96, s95, 7
    s_and_b32 s96, s96, 15
    s_lshl_b32 s97, s96, 14
    s_add_u32 s97, s97, s84
    s_add_u32 m0, s86, 131072
    s_nop 0
    buffer_load_dwordx4 v253, s[20:23], s97 offen offset:0 sc1 lds
    buffer_load_dwordx4 v253, s[20:23], s97 offen offset:1024 sc1 lds
    buffer_load_dwordx4 v253, s[20:23], s97 offen offset:2048 sc1 lds
    v_mov_b32 v20, v16
    buffer_load_dwordx4 v253, s[20:23], s97 offen offset:3072 sc1 lds
    s_nop 0
    v_max_f32_dpp v20, v20, v20 quad_perm:[1,0,3,2] row_mask:0xf bank_mask:0xf
    s_nop 1
    v_max_f32_dpp v20, v20, v20 quad_perm:[2,3,0,1] row_mask:0xf bank_mask:0xf
    s_nop 1
    v_max_f32_dpp v20, v20, v20 row_half_mirror row_mask:0xf bank_mask:0xf
    s_nop 1
    v_max_f32_dpp v20, v20, v20 row_mirror row_mask:0xf bank_mask:0xf
    v_mov_b32 v21, v20
    s_add_u32 s96, s95, 7
    s_and_b32 s96, s96, 15
    s_mul_i32 s96, s96, 393216
    s_add_u32 s96, s96, s85
    s_add_u32 m0, s87, 65536
    s_nop 0
    buffer_load_dwordx4 v8, s[16:19], s96 offen offset:0 lds
    v_permlane16_swap_b32 v20, v21
    v_max_f32 v20, v20, v21
    v_mov_b32 v21, v20
    s_nop 1
    v_permlane32_swap_b32 v20, v21
    buffer_load_dwordx4 v9, s[16:19], s96 offen offset:1024 lds
    v_max_f32 v20, v20, v21
    v_cmp_eq_f32 vcc, v20, v16
    s_ff1_i32_b64 s32, vcc
    s_and_b32 s32, s32, 63
    v_readlane_b32 s74, v16, s32
    buffer_load_dwordx4 v10, s[16:19], s96 offen offset:2048 lds
    v_readlane_b32 s73, v17, s32
    v_readlane_b32 s75, v18, s32
    v_readlane_b32 s76, v19, s32
    s_and_b32 s73, s73, 2047
    s_lshr_b32 s33, s73, 5
    buffer_load_dwordx4 v11, s[16:19], s96 offen offset:3072 lds
    s_lshl_b32 s33, s33, 11
    s_add_u32 s33, s33, s79
    s_add_u32 s33, s33, 0xd60000
    buffer_load_dwordx4 v[24:27], v22, s[20:23], s33 offen sc1
    v_mov_b32 v20, s73
    s_add_u32 m0, s87, 69632
    s_nop 0
    buffer_load_dwordx4 v12, s[16:19], s96 offen offset:0 lds
    v_mov_b32 v21, s77
    v_mov_b32 v19, 0
    ds_write_b64 v19, v[20:21] offset:3072
    s_lshr_b32 s39, s73, 5
    s_lshl_b32 s34, s24, 2
    buffer_load_dwordx4 v13, s[16:19], s96 offen offset:1024 lds
    s_sub_u32 s39, s39, s34
    s_add_u32 s39, s39, 8
    s_cmp_lt_u32 s39, 12
    s_cselect_b32 s100, 1, 0
    s_waitcnt vmcnt(11) lgkmcnt(0)
    s_barrier
    s_add_u32 s96, s94, 8
    s_and_b32 s96, s96, 15
    s_lshl_b32 s97, s96, 14
    s_add_u32 s97, s97, s84
    s_add_u32 m0, s86, 114688
    s_nop 0
    buffer_load_dwordx4 v253, s[20:23], s97 offen offset:0 sc1 lds
    buffer_load_dwordx4 v253, s[20:23], s97 offen offset:1024 sc1 lds
    s_mov_b32 s78, s27
    s_waitcnt vmcnt(4)
    s_branch pc_82
pl_81:
    s_lshr_b32 s33, s73, 5
    s_lshl_b32 s33, s33, 11
    s_add_u32 s33, s33, s79
    s_add_u32 s33, s33, 0xd60000
    buffer_load_dwordx4 v[24:27], v22, s[20:23], s33 offen sc1
    s_waitcnt vmcnt(0)
pc_82:
    v_max3_u32 v30, v24, v25, v26
    v_max_u32 v30, v30, v27
    v_cmp_eq_u32 vcc, -1, v30
    s_cbranch_vccz pd_83
    s_sub_u32 s78, s78, 1
    s_cmp_lg_u32 s78, 0
    s_cbranch_scc1 pl_81
    s_mov_b32 s27, 1
pd_83:
    buffer_load_dwordx4 v253, s[20:23], s97 offen offset:2048 sc1 lds
    v_and_b32 v30, 2, v252
    v_cmp_eq_u32 vcc, 2, v30
    v_mov_b32 v28, s76
    v_mul_f32 v29, s75, v28
    v_add_f32 v28, 1.0, v28
    v_cndmask_b32 v30, v24, v26, vcc
    v_cndmask_b32 v31, v25, v27, vcc
    v_lshlrev_b32 v92, 16, v30
    v_and_b32 v93, 0xffff0000, v30
    v_lshlrev_b32 v94, 16, v31
    v_and_b32 v95, 0xffff0000, v31
    v_fma_f32 v92, v92, v28, -v29
    v_fma_f32 v93, v93, v28, -v29
    v_fma_f32 v94, v94, v28, -v29
    v_fma_f32 v95, v95, v28, -v29
    v_mov_b32 v96, 0xbfb8aa3b
    v_mul_f32 v96, s74, v96
    v_exp_f32 v96, v96
    s_nop 0
    v_add_f32 v96, 1.0, v96
    v_rcp_f32 v96, v96
    buffer_load_dwordx4 v253, s[20:23], s97 offen offset:3072 sc1 lds
    v_mov_b32 v28, s76
    v_mul_f32 v29, s75, v28
    v_lshlrev_b32 v30, 16, v24
    v_and_b32 v31, 0xffff0000, v24
    v_fma_f32 v30, v30, v28, -v29
    v_fma_f32 v31, v31, v28, -v29
    v_cvt_pk_bf16_f32 v24, v30, v31
    v_lshlrev_b32 v30, 16, v25
    v_and_b32 v31, 0xffff0000, v25
    v_fma_f32 v30, v30, v28, -v29
    v_fma_f32 v31, v31, v28, -v29
    v_cvt_pk_bf16_f32 v25, v30, v31
    v_lshlrev_b32 v30, 16, v26
    v_and_b32 v31, 0xffff0000, v26
    v_fma_f32 v30, v30, v28, -v29
    v_fma_f32 v31, v31, v28, -v29
    v_cvt_pk_bf16_f32 v26, v30, v31
    v_lshlrev_b32 v30, 16, v27
    v_and_b32 v31, 0xffff0000, v27
    v_fma_f32 v30, v30, v28, -v29
    v_fma_f32 v31, v31, v28, -v29
    s_add_u32 s96, s94, 8
    s_and_b32 s96, s96, 15
    s_mul_i32 s96, s96, 393216
    s_add_u32 s96, s96, s85
    s_add_u32 m0, s87, 90112
    s_nop 0
    buffer_load_dwordx4 v8, s[16:19], s96 offen offset:0 lds
    v_cvt_pk_bf16_f32 v27, v30, v31
    s_bitcmp0_b32 s29, 0
    s_cbranch_scc1 sk_84
    v_swap_b32 v24, v25
    v_swap_b32 v26, v27
sk_84:
    s_bitcmp0_b32 s29, 1
    s_cbranch_scc1 sk_85
    v_swap_b32 v24, v26
    v_swap_b32 v25, v27
sk_85:
    v_dot2_f32_bf16 v32, v155, v24, 0
    v_dot2_f32_bf16 v33, v160, v24, 0
    v_dot2_f32_bf16 v34, v156, v24, 0
    v_dot2_f32_bf16 v35, v161, v24, 0
    v_dot2_f32_bf16 v36, v157, v24, 0
    v_dot2_f32_bf16 v37, v162, v24, 0
    buffer_load_dwordx4 v9, s[16:19], s96 offen offset:1024 lds
    v_dot2_f32_bf16 v38, v158, v24, 0
    v_dot2_f32_bf16 v39, v163, v24, 0
    v_dot2_f32_bf16 v40, v183, v24, 0
    v_dot2_f32_bf16 v41, v192, v24, 0
    v_dot2_f32_bf16 v42, v188, v24, 0
    v_dot2_f32_bf16 v43, v193, v24, 0
    v_dot2_f32_bf16 v44, v189, v24, 0
    v_dot2_f32_bf16 v45, v194, v24, 0
    v_dot2_f32_bf16 v46, v190, v24, 0
    v_dot2_f32_bf16 v47, v195, v24, 0
    v_dot2_f32_bf16 v32, v159, v25, v32
    v_dot2_f32_bf16 v33, v168, v25, v33
    v_dot2_f32_bf16 v34, v164, v25, v34
    v_dot2_f32_bf16 v35, v169, v25, v35
    v_dot2_f32_bf16 v36, v165, v25, v36
    v_dot2_f32_bf16 v37, v170, v25, v37
    v_dot2_f32_bf16 v38, v166, v25, v38
    v_dot2_f32_bf16 v39, v171, v25, v39
    v_dot2_f32_bf16 v40, v191, v25, v40
    v_dot2_f32_bf16 v41, v200, v25, v41
    v_dot2_f32_bf16 v42, v196, v25, v42
    buffer_load_dwordx4 v10, s[16:19], s96 offen offset:2048 lds
    v_dot2_f32_bf16 v43, v201, v25, v43
    v_dot2_f32_bf16 v44, v197, v25, v44
    v_dot2_f32_bf16 v45, v202, v25, v45
    v_dot2_f32_bf16 v46, v198, v25, v46
    v_dot2_f32_bf16 v47, v203, v25, v47
    v_dot2_f32_bf16 v32, v167, v26, v32
    v_dot2_f32_bf16 v33, v176, v26, v33
    v_dot2_f32_bf16 v34, v172, v26, v34
    v_dot2_f32_bf16 v35, v177, v26, v35
    v_dot2_f32_bf16 v36, v173, v26, v36
    v_dot2_f32_bf16 v37, v178, v26, v37
    v_dot2_f32_bf16 v38, v174, v26, v38
    v_dot2_f32_bf16 v39, v179, v26, v39
    v_dot2_f32_bf16 v40, v199, v26, v40
    v_dot2_f32_bf16 v41, v208, v26, v41
    v_dot2_f32_bf16 v42, v204, v26, v42
    v_dot2_f32_bf16 v43, v209, v26, v43
    v_dot2_f32_bf16 v44, v205, v26, v44
    v_dot2_f32_bf16 v45, v210, v26, v45
    v_dot2_f32_bf16 v46, v206, v26, v46
    v_dot2_f32_bf16 v47, v211, v26, v47
    buffer_load_dwordx4 v11, s[16:19], s96 offen offset:3072 lds
    v_dot2_f32_bf16 v32, v175, v27, v32
    v_dot2_f32_bf16 v33, v184, v27, v33
    v_dot2_f32_bf16 v34, v180, v27, v34
    v_dot2_f32_bf16 v35, v185, v27, v35
    v_dot2_f32_bf16 v36, v181, v27, v36
    v_dot2_f32_bf16 v37, v186, v27, v37
    v_dot2_f32_bf16 v38, v182, v27, v38
    v_dot2_f32_bf16 v39, v187, v27, v39
    v_dot2_f32_bf16 v40, v207, v27, v40
    v_dot2_f32_bf16 v41, v216, v27, v41
    v_dot2_f32_bf16 v42, v212, v27, v42
    v_dot2_f32_bf16 v43, v217, v27, v43
    v_dot2_f32_bf16 v44, v213, v27, v44
    v_dot2_f32_bf16 v45, v218, v27, v45
    v_dot2_f32_bf16 v46, v214, v27, v46
    v_dot2_f32_bf16 v47, v219, v27, v47
    v_lshrrev_b32 v31, 5, v252
    v_lshlrev_b32 v30, 6, v31
    v_permlane32_swap_b32 v32, v40
    v_permlane32_swap_b32 v33, v41
    v_permlane32_swap_b32 v34, v42
    s_add_u32 m0, s87, 94208
    s_nop 0
    buffer_load_dwordx4 v12, s[16:19], s96 offen offset:0 lds
    v_permlane32_swap_b32 v35, v43
    v_permlane32_swap_b32 v36, v44
    v_permlane32_swap_b32 v37, v45
    v_permlane32_swap_b32 v38, v46
    v_permlane32_swap_b32 v39, v47
    v_add_f32 v32, v32, v40
    v_add_f32 v33, v33, v41
    v_add_f32 v34, v34, v42
    v_add_f32 v35, v35, v43
    v_add_f32 v36, v36, v44
    v_add_f32 v37, v37, v45
    v_add_f32 v38, v38, v46
    v_add_f32 v39, v39, v47
    v_and_b32 v31, 1, v252
    v_lshl_add_u32 v30, v31, 5, v30
    v_permlane16_swap_b32 v32, v36
    v_permlane16_swap_b32 v33, v37
    v_permlane16_swap_b32 v34, v38
    v_permlane16_swap_b32 v35, v39
    v_add_f32 v32, v32, v36
    v_add_f32 v33, v33, v37
    buffer_load_dwordx4 v13, s[16:19], s96 offen offset:1024 lds
    v_add_f32 v34, v34, v38
    v_add_f32 v35, v35, v39
    v_and_b32 v31, 16, v252
    s_lshl_b32 s32, s28, 7
    v_add3_u32 v30, v31, v30, s32
    v_add_f32_dpp v32, v32, v32 quad_perm:[2,3,0,1] row_mask:0xf bank_mask:0xf
    v_add_f32_dpp v33, v33, v33 quad_perm:[2,3,0,1] row_mask:0xf bank_mask:0xf
    v_add_f32_dpp v34, v34, v34 quad_perm:[2,3,0,1] row_mask:0xf bank_mask:0xf
    v_add_f32_dpp v35, v35, v35 quad_perm:[2,3,0,1] row_mask:0xf bank_mask:0xf
    v_add_f32_dpp v32, v32, v32 row_ror:4 row_mask:0xf bank_mask:0xf
    v_add_f32_dpp v33, v33, v33 row_ror:4 row_mask:0xf bank_mask:0xf
    v_add_f32_dpp v34, v34, v34 row_ror:4 row_mask:0xf bank_mask:0xf
    v_add_f32_dpp v35, v35, v35 row_ror:4 row_mask:0xf bank_mask:0xf
    v_add_f32_dpp v32, v32, v32 row_ror:8 row_mask:0xf bank_mask:0xf
    v_add_f32_dpp v33, v33, v33 row_ror:8 row_mask:0xf bank_mask:0xf
    v_add_f32_dpp v34, v34, v34 row_ror:8 row_mask:0xf bank_mask:0xf
    v_add_f32_dpp v35, v35, v35 row_ror:8 row_mask:0xf bank_mask:0xf
    s_mov_b32 exec_lo, 0x00030003
    s_mov_b32 exec_hi, 0x00030003
    ds_write_b128 v30, v[32:35] offset:3328
    s_mov_b64 exec, -1
    s_waitcnt vmcnt(10) lgkmcnt(0)
    s_barrier
    s_add_u32 s96, s95, 9
    s_and_b32 s96, s96, 15
    s_lshl_b32 s97, s96, 14
    s_add_u32 s97, s97, s84
    s_add_u32 m0, s86, 147456
    s_nop 0
    buffer_load_dwordx4 v253, s[20:23], s97 offen offset:0 sc1 lds
    buffer_load_dwordx4 v253, s[20:23], s97 offen offset:1024 sc1 lds
    v_and_b32 v30, 1, v252
    v_bfe_u32 v31, v252, 1, 3
    v_lshl_add_u32 v30, v30, 3, v31
    v_lshlrev_b32 v30, 2, v30
    v_add_u32 v30, 3328, v30
    ds_read2_b32 v[32:33], v30 offset0:0 offset1:16
    ds_read2_b32 v[34:35], v30 offset0:32 offset1:48
    ds_read2_b32 v[36:37], v30 offset0:64 offset1:80
    ds_read2_b32 v[38:39], v30 offset0:96 offset1:112
    v_lshrrev_b32 v30, 2, v252
    buffer_load_dwordx4 v253, s[20:23], s97 offen offset:2048 sc1 lds
    v_mul_u32_u24 v30, 14336, v30
    v_and_b32 v31, 3, v252
    v_lshl_add_u32 v30, v31, 4, v30
    v_and_b32 v31, 1, v252
    v_cmp_eq_u32 vcc, 1, v31
    s_mul_i32 s32, s28, 229376
    s_lshl_b32 s33, s29, 6
    s_add_u32 s32, s32, s33
    s_add_u32 s32, s32, s79
    s_add_u32 s32, s32, 0xc80000
    buffer_load_dwordx4 v253, s[20:23], s97 offen offset:3072 sc1 lds
    s_waitcnt lgkmcnt(0)
    v_pk_add_f32 v[32:33], v[32:33], v[34:35]
    v_pk_add_f32 v[36:37], v[36:37], v[38:39]
    v_pk_add_f32 v[32:33], v[32:33], v[36:37]
    v_mul_f32 v34, 0xbfb8aa3b, v32
    v_exp_f32 v34, v34
    v_mul_f32 v32, v32, v33
    v_add_f32 v34, 1.0, v34
    v_rcp_f32 v34, v34
    s_add_u32 s96, s95, 9
    s_and_b32 s96, s96, 15
    s_mul_i32 s96, s96, 393216
    s_add_u32 s96, s96, s85
    s_add_u32 m0, s87, 40960
    s_nop 0
    buffer_load_dwordx4 v8, s[16:19], s96 offen offset:0 lds
    v_mul_f32 v32, v32, v34
    s_nop 1
    v_mov_b32_dpp v33, v32 quad_perm:[2,3,2,3] row_mask:0xf bank_mask:0xf
    v_cvt_pk_bf16_f32 v32, v32, v33
    ds_swizzle_b32 v36, v32 offset:0x1
    ds_swizzle_b32 v37, v32 offset:0x81
    ds_swizzle_b32 v38, v32 offset:0x101
    ds_swizzle_b32 v39, v32 offset:0x181
    s_waitcnt lgkmcnt(0)
    v_dot2_f32_bf16 v40, v215, v36, 0
    v_dot2_f32_bf16 v41, v224, v36, 0
    buffer_load_dwordx4 v9, s[16:19], s96 offen offset:1024 lds
    v_dot2_f32_bf16 v42, v220, v36, 0
    v_dot2_f32_bf16 v43, v225, v36, 0
    v_dot2_f32_bf16 v44, v221, v36, 0
    v_dot2_f32_bf16 v45, v226, v36, 0
    v_dot2_f32_bf16 v46, v222, v36, 0
    v_dot2_f32_bf16 v47, v227, v36, 0
    v_dot2_f32_bf16 v40, v223, v37, v40
    v_dot2_f32_bf16 v41, v232, v37, v41
    v_dot2_f32_bf16 v42, v228, v37, v42
    v_dot2_f32_bf16 v43, v233, v37, v43
    buffer_load_dwordx4 v10, s[16:19], s96 offen offset:2048 lds
    v_dot2_f32_bf16 v44, v229, v37, v44
    v_dot2_f32_bf16 v45, v234, v37, v45
    v_dot2_f32_bf16 v46, v230, v37, v46
    v_dot2_f32_bf16 v47, v235, v37, v47
    v_dot2_f32_bf16 v40, v231, v38, v40
    v_dot2_f32_bf16 v41, v240, v38, v41
    v_dot2_f32_bf16 v42, v236, v38, v42
    v_dot2_f32_bf16 v43, v241, v38, v43
    v_dot2_f32_bf16 v44, v237, v38, v44
    buffer_load_dwordx4 v11, s[16:19], s96 offen offset:3072 lds
    v_dot2_f32_bf16 v45, v242, v38, v45
    v_dot2_f32_bf16 v46, v238, v38, v46
    v_dot2_f32_bf16 v47, v243, v38, v47
    v_dot2_f32_bf16 v40, v239, v39, v40
    v_dot2_f32_bf16 v41, v248, v39, v41
    v_dot2_f32_bf16 v42, v244, v39, v42
    v_dot2_f32_bf16 v43, v249, v39, v43
    v_dot2_f32_bf16 v44, v245, v39, v44
    v_dot2_f32_bf16 v45, v250, v39, v45
    v_dot2_f32_bf16 v46, v246, v39, v46
    s_add_u32 m0, s87, 45056
    s_nop 0
    buffer_load_dwordx4 v12, s[16:19], s96 offen offset:0 lds
    v_dot2_f32_bf16 v47, v251, v39, v47
    v_add_f32_dpp v40, v40, v40 quad_perm:[1,0,3,2] row_mask:0xf bank_mask:0xf
    v_add_f32_dpp v41, v41, v41 quad_perm:[1,0,3,2] row_mask:0xf bank_mask:0xf
    v_add_f32_dpp v42, v42, v42 quad_perm:[1,0,3,2] row_mask:0xf bank_mask:0xf
    v_add_f32_dpp v43, v43, v43 quad_perm:[1,0,3,2] row_mask:0xf bank_mask:0xf
    v_add_f32_dpp v44, v44, v44 quad_perm:[1,0,3,2] row_mask:0xf bank_mask:0xf
    v_add_f32_dpp v45, v45, v45 quad_perm:[1,0,3,2] row_mask:0xf bank_mask:0xf
    v_add_f32_dpp v46, v46, v46 quad_perm:[1,0,3,2] row_mask:0xf bank_mask:0xf
    v_add_f32_dpp v47, v47, v47 quad_perm:[1,0,3,2] row_mask:0xf bank_mask:0xf
    v_cndmask_b32 v40, v40, v44, vcc
    buffer_load_dwordx4 v13, s[16:19], s96 offen offset:1024 lds
    v_cndmask_b32 v41, v41, v45, vcc
    v_cndmask_b32 v42, v42, v46, vcc
    v_cndmask_b32 v43, v43, v47, vcc
    s_cmp_lt_u32 s29, 224
    s_cselect_b64 exec, -1, 0
    buffer_store_dwordx4 v[40:43], v30, s[20:23], s32 offen sc1
    s_mov_b64 exec, -1
    s_waitcnt vmcnt(10) lgkmcnt(0)
    s_barrier
    s_add_u32 s96, s94, 10
    s_and_b32 s96, s96, 15
    s_lshl_b32 s97, s96, 14
    s_add_u32 s97, s97, s84
    s_add_u32 m0, s86, 131072
    s_nop 0
    buffer_load_dwordx4 v253, s[20:23], s97 offen offset:0 sc1 lds
    buffer_load_dwordx4 v253, s[20:23], s97 offen offset:1024 sc1 lds
    buffer_load_dwordx4 v253, s[20:23], s97 offen offset:2048 sc1 lds
    buffer_load_dwordx4 v253, s[20:23], s97 offen offset:3072 sc1 lds
    s_add_u32 s96, s94, 10
    s_and_b32 s96, s96, 15
    s_mul_i32 s96, s96, 393216
    s_add_u32 s96, s96, s85
    s_add_u32 m0, s87, 65536
    s_nop 0
    buffer_load_dwordx4 v8, s[16:19], s96 offen offset:0 lds
    buffer_load_dwordx4 v9, s[16:19], s96 offen offset:1024 lds
    buffer_load_dwordx4 v10, s[16:19], s96 offen offset:2048 lds
    buffer_load_dwordx4 v11, s[16:19], s96 offen offset:3072 lds
    s_add_u32 m0, s87, 69632
    s_nop 0
    buffer_load_dwordx4 v12, s[16:19], s96 offen offset:0 lds
    buffer_load_dwordx4 v13, s[16:19], s96 offen offset:1024 lds
    s_waitcnt vmcnt(10) lgkmcnt(0)
    s_barrier
    s_cmp_lt_u32 s29, 224
    s_cbranch_scc1 sk_87
    s_cmp_ge_u32 s28, 2
    s_cbranch_scc1 sk_87
    s_mul_i32 s32, s89, 14336
    s_add_u32 s32, s32, s79
    s_add_u32 s32, s32, 0xc80000
    buffer_load_dwordx4 v[32:35], v253, s[20:23], s32 offen offset:0 sc1
    buffer_load_dwordx4 v[36:39], v253, s[20:23], s32 offen offset:1024 sc1
    buffer_load_dwordx4 v[40:43], v253, s[20:23], s32 offen offset:2048 sc1
    buffer_load_dwordx4 v[44:47], v253, s[20:23], s32 offen offset:3072 sc1
    s_add_u32 s32, s32, 4096
    buffer_load_dwordx4 v[48:51], v253, s[20:23], s32 offen offset:0 sc1
    buffer_load_dwordx4 v[52:55], v253, s[20:23], s32 offen offset:1024 sc1
    buffer_load_dwordx4 v[56:59], v253, s[20:23], s32 offen offset:2048 sc1
    buffer_load_dwordx4 v[60:63], v253, s[20:23], s32 offen offset:3072 sc1
    s_add_u32 s32, s32, 4096
    buffer_load_dwordx4 v[64:67], v253, s[20:23], s32 offen offset:0 sc1
    buffer_load_dwordx4 v[68:71], v253, s[20:23], s32 offen offset:1024 sc1
    buffer_load_dwordx4 v[72:75], v253, s[20:23], s32 offen offset:2048 sc1
    buffer_load_dwordx4 v[76:79], v253, s[20:23], s32 offen offset:3072 sc1
    s_add_u32 s32, s32, 4096
    buffer_load_dwordx4 v[80:83], v253, s[20:23], s32 offen offset:0 sc1
    buffer_load_dwordx4 v[84:87], v253, s[20:23], s32 offen offset:1024 sc1
sk_87:
    s_add_u32 s96, s95, 11
    s_and_b32 s96, s96, 15
    s_lshl_b32 s97, s96, 14
    s_add_u32 s97, s97, s84
    s_add_u32 m0, s86, 114688
    s_nop 0
    buffer_load_dwordx4 v253, s[20:23], s97 offen offset:0 sc1 lds
    buffer_load_dwordx4 v253, s[20:23], s97 offen offset:1024 sc1 lds
    buffer_load_dwordx4 v253, s[20:23], s97 offen offset:2048 sc1 lds
    buffer_load_dwordx4 v253, s[20:23], s97 offen offset:3072 sc1 lds
    s_add_u32 s96, s95, 11
    s_and_b32 s96, s96, 15
    s_mul_i32 s96, s96, 393216
    s_add_u32 s96, s96, s85
    s_add_u32 m0, s87, 90112
    s_nop 0
    buffer_load_dwordx4 v8, s[16:19], s96 offen offset:0 lds
    buffer_load_dwordx4 v9, s[16:19], s96 offen offset:1024 lds
    buffer_load_dwordx4 v10, s[16:19], s96 offen offset:2048 lds
    buffer_load_dwordx4 v11, s[16:19], s96 offen offset:3072 lds
    s_add_u32 m0, s87, 94208
    s_nop 0
    buffer_load_dwordx4 v12, s[16:19], s96 offen offset:0 lds
    buffer_load_dwordx4 v13, s[16:19], s96 offen offset:1024 lds
    s_waitcnt vmcnt(10) lgkmcnt(0)
    s_barrier
    s_add_u32 s96, s94, 12
    s_and_b32 s96, s96, 15
    s_lshl_b32 s97, s96, 14
    s_add_u32 s97, s97, s84
    s_add_u32 m0, s86, 147456
    s_nop 0
    buffer_load_dwordx4 v253, s[20:23], s97 offen offset:0 sc1 lds
    buffer_load_dwordx4 v253, s[20:23], s97 offen offset:1024 sc1 lds
    buffer_load_dwordx4 v253, s[20:23], s97 offen offset:2048 sc1 lds
    buffer_load_dwordx4 v253, s[20:23], s97 offen offset:3072 sc1 lds
    s_add_u32 s96, s94, 12
    s_and_b32 s96, s96, 15
    s_mul_i32 s96, s96, 393216
    s_add_u32 s96, s96, s85
    s_add_u32 m0, s87, 40960
    s_nop 0
    buffer_load_dwordx4 v8, s[16:19], s96 offen offset:0 lds
    buffer_load_dwordx4 v9, s[16:19], s96 offen offset:1024 lds
    buffer_load_dwordx4 v10, s[16:19], s96 offen offset:2048 lds
    buffer_load_dwordx4 v11, s[16:19], s96 offen offset:3072 lds
    s_add_u32 m0, s87, 45056
    s_nop 0
    buffer_load_dwordx4 v12, s[16:19], s96 offen offset:0 lds
    buffer_load_dwordx4 v13, s[16:19], s96 offen offset:1024 lds
    s_cmp_lt_u32 s29, 224
    s_cbranch_scc1 sk_88
    s_cmp_ge_u32 s28, 2
    s_cbranch_scc1 sk_88
    s_mov_b32 s78, s27
    s_waitcnt vmcnt(20)
    s_branch pc_90
pl_89:
    s_mul_i32 s32, s89, 14336
    s_add_u32 s32, s32, s79
    s_add_u32 s32, s32, 0xc80000
    buffer_load_dwordx4 v[32:35], v253, s[20:23], s32 offen offset:0 sc1
    buffer_load_dwordx4 v[36:39], v253, s[20:23], s32 offen offset:1024 sc1
    buffer_load_dwordx4 v[40:43], v253, s[20:23], s32 offen offset:2048 sc1
    buffer_load_dwordx4 v[44:47], v253, s[20:23], s32 offen offset:3072 sc1
    s_add_u32 s32, s32, 4096
    buffer_load_dwordx4 v[48:51], v253, s[20:23], s32 offen offset:0 sc1
    buffer_load_dwordx4 v[52:55], v253, s[20:23], s32 offen offset:1024 sc1
    buffer_load_dwordx4 v[56:59], v253, s[20:23], s32 offen offset:2048 sc1
    buffer_load_dwordx4 v[60:63], v253, s[20:23], s32 offen offset:3072 sc1
    s_add_u32 s32, s32, 4096
    buffer_load_dwordx4 v[64:67], v253, s[20:23], s32 offen offset:0 sc1
    buffer_load_dwordx4 v[68:71], v253, s[20:23], s32 offen offset:1024 sc1
    buffer_load_dwordx4 v[72:75], v253, s[20:23], s32 offen offset:2048 sc1
    buffer_load_dwordx4 v[76:79], v253, s[20:23], s32 offen offset:3072 sc1
    s_add_u32 s32, s32, 4096
    buffer_load_dwordx4 v[80:83], v253, s[20:23], s32 offen offset:0 sc1
    buffer_load_dwordx4 v[84:87], v253, s[20:23], s32 offen offset:1024 sc1
    s_waitcnt vmcnt(0)
pc_90:
    v_max3_u32 v30, v32, v33, v34
    v_max3_u32 v30, v30, v35, v36
    v_max3_u32 v30, v30, v37, v38
    v_max3_u32 v30, v30, v39, v40
    v_max3_u32 v30, v30, v41, v42
    v_max3_u32 v30, v30, v43, v44
    v_max3_u32 v30, v30, v45, v46
    v_max3_u32 v30, v30, v47, v48
    v_max3_u32 v30, v30, v49, v50
    v_max3_u32 v30, v30, v51, v52
    v_max3_u32 v30, v30, v53, v54
    v_max3_u32 v30, v30, v55, v56
    v_max3_u32 v30, v30, v57, v58
    v_max3_u32 v30, v30, v59, v60
    v_max3_u32 v30, v30, v61, v62
    v_max3_u32 v30, v30, v63, v64
    v_max3_u32 v30, v30, v65, v66
    v_max3_u32 v30, v30, v67, v68
    v_max3_u32 v30, v30, v69, v70
    v_max3_u32 v30, v30, v71, v72
    v_max3_u32 v30, v30, v73, v74
    v_max3_u32 v30, v30, v75, v76
    v_max3_u32 v30, v30, v77, v78
    v_max3_u32 v30, v30, v79, v80
    v_max3_u32 v30, v30, v81, v82
    v_max3_u32 v30, v30, v83, v84
    v_max3_u32 v30, v30, v85, v86
    v_max_u32 v30, v30, v87
    v_cmp_eq_u32 vcc, -1, v30
    s_cbranch_vccz pd_91
    s_sub_u32 s78, s78, 1
    s_cmp_lg_u32 s78, 0
    s_cbranch_scc1 pl_89
    s_mov_b32 s27, 1
pd_91:
    v_pk_add_f32 v[32:33], v[32:33], v[36:37]
    v_pk_add_f32 v[34:35], v[34:35], v[38:39]
    v_pk_add_f32 v[32:33], v[32:33], v[40:41]
    v_pk_add_f32 v[34:35], v[34:35], v[42:43]
    v_pk_add_f32 v[32:33], v[32:33], v[44:45]
    v_pk_add_f32 v[34:35], v[34:35], v[46:47]
    v_pk_add_f32 v[32:33], v[32:33], v[48:49]
    v_pk_add_f32 v[34:35], v[34:35], v[50:51]
    v_pk_add_f32 v[32:33], v[32:33], v[52:53]
    v_pk_add_f32 v[34:35], v[34:35], v[54:55]
    v_pk_add_f32 v[32:33], v[32:33], v[56:57]
    v_pk_add_f32 v[34:35], v[34:35], v[58:59]
    v_pk_add_f32 v[32:33], v[32:33], v[60:61]
    v_pk_add_f32 v[34:35], v[34:35], v[62:63]
    v_pk_add_f32 v[32:33], v[32:33], v[64:65]
    v_pk_add_f32 v[34:35], v[34:35], v[66:67]
    v_pk_add_f32 v[32:33], v[32:33], v[68:69]
    v_pk_add_f32 v[34:35], v[34:35], v[70:71]
    v_pk_add_f32 v[32:33], v[32:33], v[72:73]
    v_pk_add_f32 v[34:35], v[34:35], v[74:75]
    v_pk_add_f32 v[32:33], v[32:33], v[76:77]
    v_pk_add_f32 v[34:35], v[34:35], v[78:79]
    v_pk_add_f32 v[32:33], v[32:33], v[80:81]
    v_pk_add_f32 v[34:35], v[34:35], v[82:83]
    v_pk_add_f32 v[32:33], v[32:33], v[84:85]
    v_pk_add_f32 v[34:35], v[34:35], v[86:87]
    s_nop 0
    v_add_f32_dpp v32, v32, v32 row_ror:4 row_mask:0xf bank_mask:0xf
    v_add_f32_dpp v33, v33, v33 row_ror:4 row_mask:0xf bank_mask:0xf
    v_add_f32_dpp v34, v34, v34 row_ror:4 row_mask:0xf bank_mask:0xf
    v_add_f32_dpp v35, v35, v35 row_ror:4 row_mask:0xf bank_mask:0xf
    v_add_f32_dpp v32, v32, v32 row_ror:8 row_mask:0xf bank_mask:0xf
    v_add_f32_dpp v33, v33, v33 row_ror:8 row_mask:0xf bank_mask:0xf
    v_add_f32_dpp v34, v34, v34 row_ror:8 row_mask:0xf bank_mask:0xf
    v_add_f32_dpp v35, v35, v35 row_ror:8 row_mask:0xf bank_mask:0xf
    v_mov_b32 v36, v32
    v_mov_b32 v37, v33
    v_mov_b32 v38, v34
    v_mov_b32 v39, v35
    v_permlane16_swap_b32 v32, v36
    v_permlane16_swap_b32 v33, v37
    v_permlane16_swap_b32 v34, v38
    v_permlane16_swap_b32 v35, v39
    v_add_f32 v32, v32, v36
    v_add_f32 v33, v33, v37
    v_add_f32 v34, v34, v38
    v_add_f32 v35, v35, v39
    v_mov_b32 v36, v32
    v_mov_b32 v37, v33
    v_mov_b32 v38, v34
    v_mov_b32 v39, v35
    v_permlane32_swap_b32 v32, v36
    v_permlane32_swap_b32 v33, v37
    v_permlane32_swap_b32 v34, v38
    v_permlane32_swap_b32 v35, v39
    v_add_f32 v32, v32, v36
    v_add_f32 v33, v33, v37
    v_add_f32 v34, v34, v38
    v_add_f32 v35, v35, v39
    v_fma_f32 v32, v32, v96, v92
    v_fma_f32 v33, v33, v96, v93
    v_fma_f32 v34, v34, v96, v94
    v_fma_f32 v35, v35, v96, v95
    v_cvt_pk_bf16_f32 v32, v32, v33
    v_cvt_pk_bf16_f32 v33, v34, v35
    s_lshl_b32 s32, s89, 5
    s_add_u32 s32, s32, 0xdc4000
    v_and_b32 v30, 1, v252
    v_bfe_u32 v31, v252, 1, 1
    v_lshlrev_b32 v30, 4, v30
    v_lshl_add_u32 v30, v31, 3, v30
    s_mov_b64 exec, 15
    buffer_store_dwordx2 v[32:33], v30, s[20:23], s32 offen sc1
    s_mov_b64 exec, -1
sk_88:
    s_waitcnt vmcnt(10) lgkmcnt(0)
    s_barrier
    s_add_u32 s96, s95, 13
    s_and_b32 s96, s96, 15
    s_lshl_b32 s97, s96, 14
    s_add_u32 s97, s97, s84
    s_add_u32 m0, s86, 131072
    s_nop 0
    buffer_load_dwordx4 v253, s[20:23], s97 offen offset:0 sc1 lds
    buffer_load_dwordx4 v253, s[20:23], s97 offen offset:1024 sc1 lds
    buffer_load_dwordx4 v253, s[20:23], s97 offen offset:2048 sc1 lds
    buffer_load_dwordx4 v253, s[20:23], s97 offen offset:3072 sc1 lds
    s_add_u32 s96, s95, 13
    s_and_b32 s96, s96, 15
    s_mul_i32 s96, s96, 393216
    s_add_u32 s96, s96, s85
    s_add_u32 m0, s87, 65536
    s_nop 0
    buffer_load_dwordx4 v8, s[16:19], s96 offen offset:0 lds
    buffer_load_dwordx4 v9, s[16:19], s96 offen offset:1024 lds
    buffer_load_dwordx4 v10, s[16:19], s96 offen offset:2048 lds
    buffer_load_dwordx4 v11, s[16:19], s96 offen offset:3072 lds
    s_add_u32 m0, s87, 69632
    s_nop 0
    buffer_load_dwordx4 v12, s[16:19], s96 offen offset:0 lds
    buffer_load_dwordx4 v13, s[16:19], s96 offen offset:1024 lds
    s_waitcnt vmcnt(10) lgkmcnt(0)
    s_barrier
    s_add_u32 s35, s94, 12
    s_and_b32 s35, s35, 15
    s_lshl_b32 s35, s35, 7
    s_add_u32 s35, s35, 0xdc4000
    s_add_u32 s96, s94, 14
    s_and_b32 s96, s96, 15
    s_lshl_b32 s97, s96, 14
    s_add_u32 s97, s97, s84
    s_add_u32 m0, s86, 114688
    s_nop 0
    buffer_load_dwordx4 v253, s[20:23], s97 offen offset:0 sc1 lds
    v_and_b32 v19, 48, v252
    buffer_load_dwordx4 v[132:135], v19, s[20:23], s35 offen offset:0 sc1
    buffer_load_dwordx4 v[136:139], v19, s[20:23], s35 offen offset:64 sc1
    buffer_load_dwordx4 v253, s[20:23], s97 offen offset:1024 sc1 lds
    s_min_u32 s30, s28, 2
    s_lshl_b32 s30, s30, 13
    s_add_u32 s30, s30, 40960
    buffer_load_dwordx4 v253, s[20:23], s97 offen offset:2048 sc1 lds
    v_lshrrev_b32 v20, 2, v252
    v_bfe_u32 v21, v20, 1, 2
    v_lshlrev_b32 v20, 7, v20
    v_lshl_add_u32 v20, v21, 5, v20
    buffer_load_dwordx4 v253, s[20:23], s97 offen offset:3072 sc1 lds
    v_and_b32 v21, 3, v252
    v_lshl_add_u32 v20, v21, 3, v20
    v_add_u32 v144, s30, v20
    s_add_u32 s96, s94, 14
    s_and_b32 s96, s96, 15
    s_mul_i32 s96, s96, 393216
    s_add_u32 s96, s96, s85
    s_add_u32 m0, s87, 90112
    s_nop 0
    buffer_load_dwordx4 v8, s[16:19], s96 offen offset:0 lds
    v_xor_b32 v145, 32, v144
    v_xor_b32 v146, 64, v144
    v_xor_b32 v147, 96, v144
    buffer_load_dwordx4 v9, s[16:19], s96 offen offset:1024 lds
    ds_read_b64_tr_b16 v[100:101], v144 offset:0
    ds_read_b64_tr_b16 v[102:103], v144 offset:2048
    ds_read_b64_tr_b16 v[104:105], v144 offset:4096
    buffer_load_dwordx4 v10, s[16:19], s96 offen offset:2048 lds
    ds_read_b64_tr_b16 v[106:107], v144 offset:6144
    ds_read_b64_tr_b16 v[108:109], v145 offset:0
    ds_read_b64_tr_b16 v[110:111], v145 offset:2048
    ds_read_b64_tr_b16 v[112:113], v145 offset:4096
    buffer_load_dwordx4 v11, s[16:19], s96 offen offset:3072 lds
    ds_read_b64_tr_b16 v[114:115], v145 offset:6144
    ds_read_b64_tr_b16 v[116:117], v146 offset:0
    ds_read_b64_tr_b16 v[118:119], v146 offset:2048
    s_add_u32 m0, s87, 94208
    s_nop 0
    buffer_load_dwordx4 v12, s[16:19], s96 offen offset:0 lds
    ds_read_b64_tr_b16 v[120:121], v146 offset:4096
    ds_read_b64_tr_b16 v[122:123], v146 offset:6144
    ds_read_b64_tr_b16 v[124:125], v147 offset:0
    buffer_load_dwordx4 v13, s[16:19], s96 offen offset:1024 lds
    ds_read_b64_tr_b16 v[126:127], v147 offset:2048
    ds_read_b64_tr_b16 v[128:129], v147 offset:4096
    ds_read_b64_tr_b16 v[130:131], v147 offset:6144
    s_waitcnt vmcnt(12) lgkmcnt(0)
    s_barrier
    s_add_u32 s96, s95, 15
    s_and_b32 s96, s96, 15
    s_lshl_b32 s97, s96, 14
    s_add_u32 s97, s97, s84
    s_add_u32 m0, s86, 147456
    s_nop 0
    buffer_load_dwordx4 v253, s[20:23], s97 offen offset:0 sc1 lds
    buffer_load_dwordx4 v253, s[20:23], s97 offen offset:1024 sc1 lds
    s_mov_b32 s78, s27
    s_waitcnt vmcnt(11)
    s_branch pc_93
pl_92:
    buffer_load_dwordx4 v[132:135], v19, s[20:23], s35 offen offset:0 sc1
    buffer_load_dwordx4 v[136:139], v19, s[20:23], s35 offen offset:64 sc1
    s_waitcnt vmcnt(0)
pc_93:
    v_max3_u32 v30, v132, v133, v134
    v_max3_u32 v30, v30, v135, v136
    v_max3_u32 v30, v30, v137, v138
    v_max_u32 v30, v30, v139
    v_cmp_eq_u32 vcc, -1, v30
    s_cbranch_vccz pd_94
    s_sub_u32 s78, s78, 1
    s_cmp_lg_u32 s78, 0
    s_cbranch_scc1 pl_92
    s_mov_b32 s27, 1
pd_94:
    buffer_load_dwordx4 v253, s[20:23], s97 offen offset:2048 sc1 lds
    buffer_load_dwordx4 v253, s[20:23], s97 offen offset:3072 sc1 lds
    v_mov_b32 v140, 0
    v_mov_b32 v141, 0
    v_mov_b32 v142, 0
    s_add_u32 s96, s95, 15
    s_and_b32 s96, s96, 15
    s_mul_i32 s96, s96, 393216
    s_add_u32 s96, s96, s85
    s_add_u32 m0, s87, 40960
    s_nop 0
    buffer_load_dwordx4 v8, s[16:19], s96 offen offset:0 lds
    v_mov_b32 v143, 0
    v_dot2c_f32_bf16 v140, v132, v100
    v_dot2c_f32_bf16 v141, v132, v108
    v_dot2c_f32_bf16 v142, v132, v116
    v_dot2c_f32_bf16 v143, v132, v124
    v_dot2c_f32_bf16 v140, v133, v101
    v_dot2c_f32_bf16 v141, v133, v109
    v_dot2c_f32_bf16 v142, v133, v117
    buffer_load_dwordx4 v9, s[16:19], s96 offen offset:1024 lds
    v_dot2c_f32_bf16 v143, v133, v125
    v_dot2c_f32_bf16 v140, v134, v102
    v_dot2c_f32_bf16 v141, v134, v110
    v_dot2c_f32_bf16 v142, v134, v118
    v_dot2c_f32_bf16 v143, v134, v126
    v_dot2c_f32_bf16 v140, v135, v103
    v_dot2c_f32_bf16 v141, v135, v111
    v_dot2c_f32_bf16 v142, v135, v119
    buffer_load_dwordx4 v10, s[16:19], s96 offen offset:2048 lds
    v_dot2c_f32_bf16 v143, v135, v127
    v_dot2c_f32_bf16 v140, v136, v104
    v_dot2c_f32_bf16 v141, v136, v112
    v_dot2c_f32_bf16 v142, v136, v120
    v_dot2c_f32_bf16 v143, v136, v128
    v_dot2c_f32_bf16 v140, v137, v105
    v_dot2c_f32_bf16 v141, v137, v113
    v_dot2c_f32_bf16 v142, v137, v121
    buffer_load_dwordx4 v11, s[16:19], s96 offen offset:3072 lds
    v_dot2c_f32_bf16 v143, v137, v129
    v_dot2c_f32_bf16 v140, v138, v106
    v_dot2c_f32_bf16 v141, v138, v114
    v_dot2c_f32_bf16 v142, v138, v122
    v_dot2c_f32_bf16 v143, v138, v130
    v_dot2c_f32_bf16 v140, v139, v107
    v_dot2c_f32_bf16 v141, v139, v115
    v_dot2c_f32_bf16 v142, v139, v123
    s_add_u32 m0, s87, 45056
    s_nop 0
    buffer_load_dwordx4 v12, s[16:19], s96 offen offset:0 lds
    v_dot2c_f32_bf16 v143, v139, v131
    s_min_u32 s32, s28, 2
    s_lshl_b32 s32, s32, 12
    s_lshl_b32 s33, s25, 14
    s_add_u32 s32, s32, s33
    s_add_u32 s32, s32, 0x1d80000
    s_lshl_b32 s33, s24, 8
    s_add_u32 s32, s32, s33
    buffer_load_dwordx4 v13, s[16:19], s96 offen offset:1024 lds
    v_lshlrev_b32 v20, 2, v252
    v_permlane32_swap_b32 v140, v142
    v_permlane32_swap_b32 v141, v143
    v_add_f32 v140, v140, v142
    v_add_f32 v141, v141, v143
    s_nop 1
    v_permlane16_swap_b32 v140, v141
    v_add_f32 v140, v140, v141
    buffer_store_dword v140, v20, s[20:23], s32 offen sc1
    s_waitcnt vmcnt(11) lgkmcnt(0)
    s_barrier
    s_waitcnt vmcnt(1) lgkmcnt(0)
    s_barrier
    s_cmp_eq_u32 s100, 0
    s_cbranch_scc1 sk_95
    s_min_u32 s32, s28, 2
    s_lshl_b32 s32, s32, 12
    s_lshl_b32 s33, s25, 14
    s_add_u32 s32, s32, s33
    s_add_u32 s32, s32, 0x1d80000
    buffer_load_dwordx4 v[32:35], v253, s[20:23], s32 offen offset:0 sc1
    buffer_load_dwordx4 v[36:39], v253, s[20:23], s32 offen offset:1024 sc1
    buffer_load_dwordx4 v[40:43], v253, s[20:23], s32 offen offset:2048 sc1
    buffer_load_dwordx4 v[44:47], v253, s[20:23], s32 offen offset:3072 sc1
    s_mov_b32 s32, 0xdc4000
    buffer_load_dwordx4 v[48:51], v253, s[20:23], s32 offen offset:0 sc1
    buffer_load_dwordx4 v[52:55], v253, s[20:23], s32 offen offset:1024 sc1
    v_and_b32 v20, 7, v252
    v_lshrrev_b32 v21, 4, v252
    v_lshl_add_u32 v21, v20, 2, v21
    s_and_b32 s34, s73, 31
    s_and_b32 s32, s34, 7
    s_and_b32 s33, s34, 8
    s_lshl_b32 s33, s33, 1
    s_add_u32 s32, s32, s33
    s_lshr_b32 s33, s34, 4
    s_lshl_b32 s33, s33, 3
    s_add_u32 s32, s32, s33
    s_cmp_eq_u32 s28, 1
    s_cselect_b32 s34, s32, s34
    v_mov_b32 v20, s34
    s_cmp_ge_u32 s28, 2
    s_cselect_b64 vcc, -1, 0
    s_cselect_b32 s32, 2048, 0
    v_cndmask_b32 v30, v20, v21, vcc
    v_cndmask_b32 v31, v21, v20, vcc
    v_lshlrev_b32 v0, 4, v30
    v_bfe_u32 v20, v31, 2, 2
    v_lshl_add_u32 v0, v20, 9, v0
    v_lshrrev_b32 v20, 4, v31
    v_lshl_add_u32 v0, v20, 3, v0
    v_and_b32 v20, 3, v31
    v_lshl_add_u32 v0, v20, 1, v0
    s_lshl_b32 s33, s39, 12
    s_add_u32 s33, s33, s32
    s_add_u32 s33, s33, 65536
    s_lshl_b32 s34, s39, 11
    s_add_u32 s34, s34, 32768
    s_cmp_ge_u32 s39, 8
    s_cselect_b32 s38, 1, 0
    s_movk_i32 s32, 8192
    s_cmp_eq_u32 s28, 0
    s_cselect_b32 s33, s34, s33
    s_cselect_b32 s32, s32, 49152
    s_cselect_b32 s38, s38, 1
    s_cselect_b32 s37, 0x3e8293ee, 1.0
    v_bfe_u32 v20, v252, 3, 1
    v_mul_u32_u24 v20, s32, v20
    v_add3_u32 v0, v0, v20, s33
sk_95:
    s_waitcnt lgkmcnt(0)
    s_barrier
    s_cmp_eq_u32 s100, 0
    s_cbranch_scc1 sk_96
    s_mov_b32 s78, s27
    s_waitcnt vmcnt(0)
    s_branch pc_98
pl_97:
    s_min_u32 s32, s28, 2
    s_lshl_b32 s32, s32, 12
    s_lshl_b32 s33, s25, 14
    s_add_u32 s32, s32, s33
    s_add_u32 s32, s32, 0x1d80000
    buffer_load_dwordx4 v[32:35], v253, s[20:23], s32 offen offset:0 sc1
    buffer_load_dwordx4 v[36:39], v253, s[20:23], s32 offen offset:1024 sc1
    buffer_load_dwordx4 v[40:43], v253, s[20:23], s32 offen offset:2048 sc1
    buffer_load_dwordx4 v[44:47], v253, s[20:23], s32 offen offset:3072 sc1
    s_mov_b32 s32, 0xdc4000
    buffer_load_dwordx4 v[48:51], v253, s[20:23], s32 offen offset:0 sc1
    buffer_load_dwordx4 v[52:55], v253, s[20:23], s32 offen offset:1024 sc1
    s_waitcnt vmcnt(0)
pc_98:
    v_max3_u32 v30, v32, v33, v34
    v_max3_u32 v30, v30, v35, v36
    v_max3_u32 v30, v30, v37, v38
    v_max3_u32 v30, v30, v39, v40
    v_max3_u32 v30, v30, v41, v42
    v_max3_u32 v30, v30, v43, v44
    v_max3_u32 v30, v30, v45, v46
    v_max3_u32 v30, v30, v47, v48
    v_max3_u32 v30, v30, v49, v50
    v_max3_u32 v30, v30, v51, v52
    v_max3_u32 v30, v30, v53, v54
    v_max_u32 v30, v30, v55
    v_cmp_eq_u32 vcc, -1, v30
    s_cbranch_vccz pd_99
    s_sub_u32 s78, s78, 1
    s_cmp_lg_u32 s78, 0
    s_cbranch_scc1 pl_97
    s_mov_b32 s27, 1
pd_99:
    v_mov_b32 v28, 0
    v_mov_b32 v29, 0
    v_dot2c_f32_bf16 v28, 0x3f803f80, v48
    v_dot2c_f32_bf16 v29, v48, v48
    v_dot2c_f32_bf16 v28, 0x3f803f80, v49
    v_dot2c_f32_bf16 v29, v49, v49
    v_dot2c_f32_bf16 v28, 0x3f803f80, v50
    v_dot2c_f32_bf16 v29, v50, v50
    v_dot2c_f32_bf16 v28, 0x3f803f80, v51
    v_dot2c_f32_bf16 v29, v51, v51
    v_dot2c_f32_bf16 v28, 0x3f803f80, v52
    v_dot2c_f32_bf16 v29, v52, v52
    v_dot2c_f32_bf16 v28, 0x3f803f80, v53
    v_dot2c_f32_bf16 v29, v53, v53
    v_dot2c_f32_bf16 v28, 0x3f803f80, v54
    v_dot2c_f32_bf16 v29, v54, v54
    v_dot2c_f32_bf16 v28, 0x3f803f80, v55
    v_dot2c_f32_bf16 v29, v55, v55
    v_pk_add_f32 v[32:33], v[32:33], v[36:37]
    v_pk_add_f32 v[34:35], v[34:35], v[38:39]
    v_pk_add_f32 v[32:33], v[32:33], v[40:41]
    v_pk_add_f32 v[34:35], v[34:35], v[42:43]
    v_pk_add_f32 v[32:33], v[32:33], v[44:45]
    v_pk_add_f32 v[34:35], v[34:35], v[46:47]
    s_nop 1
    v_permlane32_swap_b32 v32, v34
    v_permlane32_swap_b32 v33, v35
    v_add_f32 v32, v32, v34
    v_add_f32 v33, v33, v35
    s_nop 1
    v_permlane16_swap_b32 v32, v33
    v_add_f32 v32, v32, v33
    v_add_f32_dpp v28, v28, v28 quad_perm:[1,0,3,2] row_mask:0xf bank_mask:0xf
    s_nop 1
    v_add_f32_dpp v28, v28, v28 quad_perm:[2,3,0,1] row_mask:0xf bank_mask:0xf
    s_nop 1
    v_add_f32_dpp v28, v28, v28 row_half_mirror row_mask:0xf bank_mask:0xf
    s_nop 1
    v_add_f32_dpp v28, v28, v28 row_mirror row_mask:0xf bank_mask:0xf
    v_mov_b32 v30, v28
    s_nop 1
    v_permlane16_swap_b32 v28, v30
    v_add_f32 v28, v28, v30
    v_mov_b32 v30, v28
    s_nop 1
    v_permlane32_swap_b32 v28, v30
    v_add_f32 v28, v28, v30
    v_add_f32_dpp v29, v29, v29 quad_perm:[1,0,3,2] row_mask:0xf bank_mask:0xf
    s_nop 1
    v_add_f32_dpp v29, v29, v29 quad_perm:[2,3,0,1] row_mask:0xf bank_mask:0xf
    s_nop 1
    v_add_f32_dpp v29, v29, v29 row_half_mirror row_mask:0xf bank_mask:0xf
    s_nop 1
    v_add_f32_dpp v29, v29, v29 row_mirror row_mask:0xf bank_mask:0xf
    v_mov_b32 v30, v29
    s_nop 1
    v_permlane16_swap_b32 v29, v30
    v_add_f32 v29, v29, v30
    v_mov_b32 v30, v29
    s_nop 1
    v_permlane32_swap_b32 v29, v30
    v_add_f32 v29, v29, v30
    v_mul_f32 v28, 0x3a800000, v28
    v_mul_f32 v29, 0x3a800000, v29
    v_fma_f32 v29, -v28, v28, v29
    v_max_f32 v29, 0, v29
    v_add_f32 v29, 0x3727c5ac, v29
    v_rsq_f32 v29, v29
    v_fma_f32 v32, -v28, v2, v32
    v_mul_f32 v29, s37, v29
    v_mul_f32 v32, v32, v29
    v_cvt_pk_bf16_f32 v1, v32, v32
sk_96:
    s_branch l_att
l_tail:
    v_mov_b32 v20, 0
    s_barrier
    ds_read_b128 v[16:19], v20 offset:3072
    s_waitcnt lgkmcnt(0)
    v_readlane_b32 s74, v16, 0
    v_readlane_b32 s73, v17, 0
    v_readlane_b32 s75, v18, 0
    v_readlane_b32 s76, v19, 0
    s_and_b32 s73, s73, 2047
    s_mov_b32 s78, s27
pl_100:
    s_lshr_b32 s33, s73, 5
    s_lshl_b32 s33, s33, 11
    s_add_u32 s33, s33, s79
    s_add_u32 s33, s33, 0xd60000
    buffer_load_dwordx4 v[24:27], v22, s[20:23], s33 offen sc1
    s_waitcnt vmcnt(0)
pc_101:
    v_max3_u32 v30, v24, v25, v26
    v_max_u32 v30, v30, v27
    v_cmp_eq_u32 vcc, -1, v30
    s_cbranch_vccz pd_102
    s_sub_u32 s78, s78, 1
    s_cmp_lg_u32 s78, 0
    s_cbranch_scc1 pl_100
    s_mov_b32 s27, 1
pd_102:
    s_cmp_ge_u32 s29, 224
    s_cbranch_scc1 l_tred
    v_mov_b32 v28, s76
    v_mul_f32 v29, s75, v28
    v_lshlrev_b32 v30, 16, v24
    v_and_b32 v31, 0xffff0000, v24
    v_fma_f32 v30, v30, v28, -v29
    v_fma_f32 v31, v31, v28, -v29
    v_cvt_pk_bf16_f32 v24, v30, v31
    v_lshlrev_b32 v30, 16, v25
    v_and_b32 v31, 0xffff0000, v25
    v_fma_f32 v30, v30, v28, -v29
    v_fma_f32 v31, v31, v28, -v29
    v_cvt_pk_bf16_f32 v25, v30, v31
    v_lshlrev_b32 v30, 16, v26
    v_and_b32 v31, 0xffff0000, v26
    v_fma_f32 v30, v30, v28, -v29
    v_fma_f32 v31, v31, v28, -v29
    v_cvt_pk_bf16_f32 v26, v30, v31
    v_lshlrev_b32 v30, 16, v27
    v_and_b32 v31, 0xffff0000, v27
    v_fma_f32 v30, v30, v28, -v29
    v_fma_f32 v31, v31, v28, -v29
    v_cvt_pk_bf16_f32 v27, v30, v31
    s_bitcmp0_b32 s29, 0
    s_cbranch_scc1 sk_103
    v_swap_b32 v24, v25
    v_swap_b32 v26, v27
sk_103:
    s_bitcmp0_b32 s29, 1
    s_cbranch_scc1 sk_104
    v_swap_b32 v24, v26
    v_swap_b32 v25, v27
sk_104:
    v_dot2_f32_bf16 v32, v155, v24, 0
    v_dot2_f32_bf16 v33, v160, v24, 0
    v_dot2_f32_bf16 v34, v156, v24, 0
    v_dot2_f32_bf16 v35, v161, v24, 0
    v_dot2_f32_bf16 v36, v157, v24, 0
    v_dot2_f32_bf16 v37, v162, v24, 0
    v_dot2_f32_bf16 v38, v158, v24, 0
    v_dot2_f32_bf16 v39, v163, v24, 0
    v_dot2_f32_bf16 v40, v183, v24, 0
    v_dot2_f32_bf16 v41, v192, v24, 0
    v_dot2_f32_bf16 v42, v188, v24, 0
    v_dot2_f32_bf16 v43, v193, v24, 0
    v_dot2_f32_bf16 v44, v189, v24, 0
    v_dot2_f32_bf16 v45, v194, v24, 0
    v_dot2_f32_bf16 v46, v190, v24, 0
    v_dot2_f32_bf16 v47, v195, v24, 0
    v_dot2_f32_bf16 v32, v159, v25, v32
    v_dot2_f32_bf16 v33, v168, v25, v33
    v_dot2_f32_bf16 v34, v164, v25, v34
    v_dot2_f32_bf16 v35, v169, v25, v35
    v_dot2_f32_bf16 v36, v165, v25, v36
    v_dot2_f32_bf16 v37, v170, v25, v37
    v_dot2_f32_bf16 v38, v166, v25, v38
    v_dot2_f32_bf16 v39, v171, v25, v39
    v_dot2_f32_bf16 v40, v191, v25, v40
    v_dot2_f32_bf16 v41, v200, v25, v41
    v_dot2_f32_bf16 v42, v196, v25, v42
    v_dot2_f32_bf16 v43, v201, v25, v43
    v_dot2_f32_bf16 v44, v197, v25, v44
    v_dot2_f32_bf16 v45, v202, v25, v45
    v_dot2_f32_bf16 v46, v198, v25, v46
    v_dot2_f32_bf16 v47, v203, v25, v47
    v_dot2_f32_bf16 v32, v167, v26, v32
    v_dot2_f32_bf16 v33, v176, v26, v33
    v_dot2_f32_bf16 v34, v172, v26, v34
    v_dot2_f32_bf16 v35, v177, v26, v35
    v_dot2_f32_bf16 v36, v173, v26, v36
    v_dot2_f32_bf16 v37, v178, v26, v37
    v_dot2_f32_bf16 v38, v174, v26, v38
    v_dot2_f32_bf16 v39, v179, v26, v39
    v_dot2_f32_bf16 v40, v199, v26, v40
    v_dot2_f32_bf16 v41, v208, v26, v41
    v_dot2_f32_bf16 v42, v204, v26, v42
    v_dot2_f32_bf16 v43, v209, v26, v43
    v_dot2_f32_bf16 v44, v205, v26, v44
    v_dot2_f32_bf16 v45, v210, v26, v45
    v_dot2_f32_bf16 v46, v206, v26, v46
    v_dot2_f32_bf16 v47, v211, v26, v47
    v_dot2_f32_bf16 v32, v175, v27, v32
    v_dot2_f32_bf16 v33, v184, v27, v33
    v_dot2_f32_bf16 v34, v180, v27, v34
    v_dot2_f32_bf16 v35, v185, v27, v35
    v_dot2_f32_bf16 v36, v181, v27, v36
    v_dot2_f32_bf16 v37, v186, v27, v37
    v_dot2_f32_bf16 v38, v182, v27, v38
    v_dot2_f32_bf16 v39, v187, v27, v39
    v_dot2_f32_bf16 v40, v207, v27, v40
    v_dot2_f32_bf16 v41, v216, v27, v41
    v_dot2_f32_bf16 v42, v212, v27, v42
    v_dot2_f32_bf16 v43, v217, v27, v43
    v_dot2_f32_bf16 v44, v213, v27, v44
    v_dot2_f32_bf16 v45, v218, v27, v45
    v_dot2_f32_bf16 v46, v214, v27, v46
    v_dot2_f32_bf16 v47, v219, v27, v47
    v_lshrrev_b32 v31, 5, v252
    v_lshlrev_b32 v30, 6, v31
    v_permlane32_swap_b32 v32, v40
    v_permlane32_swap_b32 v33, v41
    v_permlane32_swap_b32 v34, v42
    v_permlane32_swap_b32 v35, v43
    v_permlane32_swap_b32 v36, v44
    v_permlane32_swap_b32 v37, v45
    v_permlane32_swap_b32 v38, v46
    v_permlane32_swap_b32 v39, v47
    v_add_f32 v32, v32, v40
    v_add_f32 v33, v33, v41
    v_add_f32 v34, v34, v42
    v_add_f32 v35, v35, v43
    v_add_f32 v36, v36, v44
    v_add_f32 v37, v37, v45
    v_add_f32 v38, v38, v46
    v_add_f32 v39, v39, v47
    v_and_b32 v31, 1, v252
    v_lshl_add_u32 v30, v31, 5, v30
    v_permlane16_swap_b32 v32, v36
    v_permlane16_swap_b32 v33, v37
    v_permlane16_swap_b32 v34, v38
    v_permlane16_swap_b32 v35, v39
    v_add_f32 v32, v32, v36
    v_add_f32 v33, v33, v37
    v_add_f32 v34, v34, v38
    v_add_f32 v35, v35, v39
    v_and_b32 v31, 16, v252
    s_lshl_b32 s32, s28, 7
    v_add3_u32 v30, v31, v30, s32
    v_add_f32_dpp v32, v32, v32 quad_perm:[2,3,0,1] row_mask:0xf bank_mask:0xf
    v_add_f32_dpp v33, v33, v33 quad_perm:[2,3,0,1] row_mask:0xf bank_mask:0xf
    v_add_f32_dpp v34, v34, v34 quad_perm:[2,3,0,1] row_mask:0xf bank_mask:0xf
    v_add_f32_dpp v35, v35, v35 quad_perm:[2,3,0,1] row_mask:0xf bank_mask:0xf
    v_add_f32_dpp v32, v32, v32 row_ror:4 row_mask:0xf bank_mask:0xf
    v_add_f32_dpp v33, v33, v33 row_ror:4 row_mask:0xf bank_mask:0xf
    v_add_f32_dpp v34, v34, v34 row_ror:4 row_mask:0xf bank_mask:0xf
    v_add_f32_dpp v35, v35, v35 row_ror:4 row_mask:0xf bank_mask:0xf
    v_add_f32_dpp v32, v32, v32 row_ror:8 row_mask:0xf bank_mask:0xf
    v_add_f32_dpp v33, v33, v33 row_ror:8 row_mask:0xf bank_mask:0xf
    v_add_f32_dpp v34, v34, v34 row_ror:8 row_mask:0xf bank_mask:0xf
    v_add_f32_dpp v35, v35, v35 row_ror:8 row_mask:0xf bank_mask:0xf
    s_mov_b32 exec_lo, 0x00030003
    s_mov_b32 exec_hi, 0x00030003
    ds_write_b128 v30, v[32:35] offset:3328
    s_mov_b64 exec, -1
    s_waitcnt lgkmcnt(0)
    s_barrier
    v_and_b32 v30, 1, v252
    v_bfe_u32 v31, v252, 1, 3
    v_lshl_add_u32 v30, v30, 3, v31
    v_lshlrev_b32 v30, 2, v30
    v_add_u32 v30, 3328, v30
    ds_read2_b32 v[32:33], v30 offset0:0 offset1:16
    ds_read2_b32 v[34:35], v30 offset0:32 offset1:48
    ds_read2_b32 v[36:37], v30 offset0:64 offset1:80
    ds_read2_b32 v[38:39], v30 offset0:96 offset1:112
    v_lshrrev_b32 v30, 2, v252
    v_mul_u32_u24 v30, 14336, v30
    v_and_b32 v31, 3, v252
    v_lshl_add_u32 v30, v31, 4, v30
    v_and_b32 v31, 1, v252
    v_cmp_eq_u32 vcc, 1, v31
    s_mul_i32 s32, s28, 229376
    s_lshl_b32 s33, s29, 6
    s_add_u32 s32, s32, s33
    s_add_u32 s32, s32, s79
    s_add_u32 s32, s32, 0xc80000
    s_waitcnt lgkmcnt(0)
    v_pk_add_f32 v[32:33], v[32:33], v[34:35]
    v_pk_add_f32 v[36:37], v[36:37], v[38:39]
    v_pk_add_f32 v[32:33], v[32:33], v[36:37]
    v_mul_f32 v34, 0xbfb8aa3b, v32
    v_exp_f32 v34, v34
    v_mul_f32 v32, v32, v33
    v_add_f32 v34, 1.0, v34
    v_rcp_f32 v34, v34
    s_nop 0
    v_mul_f32 v32, v32, v34
    s_nop 1
    v_mov_b32_dpp v33, v32 quad_perm:[2,3,2,3] row_mask:0xf bank_mask:0xf
    v_cvt_pk_bf16_f32 v32, v32, v33
    ds_swizzle_b32 v36, v32 offset:0x1
    ds_swizzle_b32 v37, v32 offset:0x81
    ds_swizzle_b32 v38, v32 offset:0x101
    ds_swizzle_b32 v39, v32 offset:0x181
    s_waitcnt lgkmcnt(0)
    v_dot2_f32_bf16 v40, v215, v36, 0
    v_dot2_f32_bf16 v41, v224, v36, 0
    v_dot2_f32_bf16 v42, v220, v36, 0
    v_dot2_f32_bf16 v43, v225, v36, 0
    v_dot2_f32_bf16 v44, v221, v36, 0
    v_dot2_f32_bf16 v45, v226, v36, 0
    v_dot2_f32_bf16 v46, v222, v36, 0
    v_dot2_f32_bf16 v47, v227, v36, 0
    v_dot2_f32_bf16 v40, v223, v37, v40
    v_dot2_f32_bf16 v41, v232, v37, v41
    v_dot2_f32_bf16 v42, v228, v37, v42
    v_dot2_f32_bf16 v43, v233, v37, v43
    v_dot2_f32_bf16 v44, v229, v37, v44
    v_dot2_f32_bf16 v45, v234, v37, v45
    v_dot2_f32_bf16 v46, v230, v37, v46
    v_dot2_f32_bf16 v47, v235, v37, v47
    v_dot2_f32_bf16 v40, v231, v38, v40
    v_dot2_f32_bf16 v41, v240, v38, v41
    v_dot2_f32_bf16 v42, v236, v38, v42
    v_dot2_f32_bf16 v43, v241, v38, v43
    v_dot2_f32_bf16 v44, v237, v38, v44
    v_dot2_f32_bf16 v45, v242, v38, v45
    v_dot2_f32_bf16 v46, v238, v38, v46
    v_dot2_f32_bf16 v47, v243, v38, v47
    v_dot2_f32_bf16 v40, v239, v39, v40
    v_dot2_f32_bf16 v41, v248, v39, v41
    v_dot2_f32_bf16 v42, v244, v39, v42
    v_dot2_f32_bf16 v43, v249, v39, v43
    v_dot2_f32_bf16 v44, v245, v39, v44
    v_dot2_f32_bf16 v45, v250, v39, v45
    v_dot2_f32_bf16 v46, v246, v39, v46
    v_dot2_f32_bf16 v47, v251, v39, v47
    v_add_f32_dpp v40, v40, v40 quad_perm:[1,0,3,2] row_mask:0xf bank_mask:0xf
    v_add_f32_dpp v41, v41, v41 quad_perm:[1,0,3,2] row_mask:0xf bank_mask:0xf
    v_add_f32_dpp v42, v42, v42 quad_perm:[1,0,3,2] row_mask:0xf bank_mask:0xf
    v_add_f32_dpp v43, v43, v43 quad_perm:[1,0,3,2] row_mask:0xf bank_mask:0xf
    v_add_f32_dpp v44, v44, v44 quad_perm:[1,0,3,2] row_mask:0xf bank_mask:0xf
    v_add_f32_dpp v45, v45, v45 quad_perm:[1,0,3,2] row_mask:0xf bank_mask:0xf
    v_add_f32_dpp v46, v46, v46 quad_perm:[1,0,3,2] row_mask:0xf bank_mask:0xf
    v_add_f32_dpp v47, v47, v47 quad_perm:[1,0,3,2] row_mask:0xf bank_mask:0xf
    v_cndmask_b32 v40, v40, v44, vcc
    v_cndmask_b32 v41, v41, v45, vcc
    v_cndmask_b32 v42, v42, v46, vcc
    v_cndmask_b32 v43, v43, v47, vcc
    s_cmp_lt_u32 s29, 224
    s_cselect_b64 exec, -1, 0
    buffer_store_dwordx4 v[40:43], v30, s[20:23], s32 offen sc1
    s_mov_b64 exec, -1
    s_branch k_end
l_tred:
    s_cmp_ge_u32 s28, 2
    s_cbranch_scc1 k_end
    v_and_b32 v30, 2, v252
    v_cmp_eq_u32 vcc, 2, v30
    v_mov_b32 v28, s76
    v_mul_f32 v29, s75, v28
    v_add_f32 v28, 1.0, v28
    v_cndmask_b32 v30, v24, v26, vcc
    v_cndmask_b32 v31, v25, v27, vcc
    v_lshlrev_b32 v92, 16, v30
    v_and_b32 v93, 0xffff0000, v30
    v_lshlrev_b32 v94, 16, v31
    v_and_b32 v95, 0xffff0000, v31
    v_fma_f32 v92, v92, v28, -v29
    v_fma_f32 v93, v93, v28, -v29
    v_fma_f32 v94, v94, v28, -v29
    v_fma_f32 v95, v95, v28, -v29
    v_mov_b32 v96, 0xbfb8aa3b
    v_mul_f32 v96, s74, v96
    v_exp_f32 v96, v96
    s_nop 0
    v_add_f32 v96, 1.0, v96
    v_rcp_f32 v96, v96
    s_mov_b32 s78, s27
pl_106:
    s_mul_i32 s32, s89, 14336
    s_add_u32 s32, s32, s79
    s_add_u32 s32, s32, 0xc80000
    buffer_load_dwordx4 v[32:35], v253, s[20:23], s32 offen offset:0 sc1
    buffer_load_dwordx4 v[36:39], v253, s[20:23], s32 offen offset:1024 sc1
    buffer_load_dwordx4 v[40:43], v253, s[20:23], s32 offen offset:2048 sc1
    buffer_load_dwordx4 v[44:47], v253, s[20:23], s32 offen offset:3072 sc1
    s_add_u32 s32, s32, 4096
    buffer_load_dwordx4 v[48:51], v253, s[20:23], s32 offen offset:0 sc1
    buffer_load_dwordx4 v[52:55], v253, s[20:23], s32 offen offset:1024 sc1
    buffer_load_dwordx4 v[56:59], v253, s[20:23], s32 offen offset:2048 sc1
    buffer_load_dwordx4 v[60:63], v253, s[20:23], s32 offen offset:3072 sc1
    s_add_u32 s32, s32, 4096
    buffer_load_dwordx4 v[64:67], v253, s[20:23], s32 offen offset:0 sc1
    buffer_load_dwordx4 v[68:71], v253, s[20:23], s32 offen offset:1024 sc1
    buffer_load_dwordx4 v[72:75], v253, s[20:23], s32 offen offset:2048 sc1
    buffer_load_dwordx4 v[76:79], v253, s[20:23], s32 offen offset:3072 sc1
    s_add_u32 s32, s32, 4096
    buffer_load_dwordx4 v[80:83], v253, s[20:23], s32 offen offset:0 sc1
    buffer_load_dwordx4 v[84:87], v253, s[20:23], s32 offen offset:1024 sc1
    s_waitcnt vmcnt(0)
pc_107:
    v_max3_u32 v30, v32, v33, v34
    v_max3_u32 v30, v30, v35, v36
    v_max3_u32 v30, v30, v37, v38
    v_max3_u32 v30, v30, v39, v40
    v_max3_u32 v30, v30, v41, v42
    v_max3_u32 v30, v30, v43, v44
    v_max3_u32 v30, v30, v45, v46
    v_max3_u32 v30, v30, v47, v48
    v_max3_u32 v30, v30, v49, v50
    v_max3_u32 v30, v30, v51, v52
    v_max3_u32 v30, v30, v53, v54
    v_max3_u32 v30, v30, v55, v56
    v_max3_u32 v30, v30, v57, v58
    v_max3_u32 v30, v30, v59, v60
    v_max3_u32 v30, v30, v61, v62
    v_max3_u32 v30, v30, v63, v64
    v_max3_u32 v30, v30, v65, v66
    v_max3_u32 v30, v30, v67, v68
    v_max3_u32 v30, v30, v69, v70
    v_max3_u32 v30, v30, v71, v72
    v_max3_u32 v30, v30, v73, v74
    v_max3_u32 v30, v30, v75, v76
    v_max3_u32 v30, v30, v77, v78
    v_max3_u32 v30, v30, v79, v80
    v_max3_u32 v30, v30, v81, v82
    v_max3_u32 v30, v30, v83, v84
    v_max3_u32 v30, v30, v85, v86
    v_max_u32 v30, v30, v87
    v_cmp_eq_u32 vcc, -1, v30
    s_cbranch_vccz pd_108
    s_sub_u32 s78, s78, 1
    s_cmp_lg_u32 s78, 0
    s_cbranch_scc1 pl_106
    s_mov_b32 s27, 1
pd_108:
    v_pk_add_f32 v[32:33], v[32:33], v[36:37]
    v_pk_add_f32 v[34:35], v[34:35], v[38:39]
    v_pk_add_f32 v[32:33], v[32:33], v[40:41]
    v_pk_add_f32 v[34:35], v[34:35], v[42:43]
    v_pk_add_f32 v[32:33], v[32:33], v[44:45]
    v_pk_add_f32 v[34:35], v[34:35], v[46:47]
    v_pk_add_f32 v[32:33], v[32:33], v[48:49]
    v_pk_add_f32 v[34:35], v[34:35], v[50:51]
    v_pk_add_f32 v[32:33], v[32:33], v[52:53]
    v_pk_add_f32 v[34:35], v[34:35], v[54:55]
    v_pk_add_f32 v[32:33], v[32:33], v[56:57]
    v_pk_add_f32 v[34:35], v[34:35], v[58:59]
    v_pk_add_f32 v[32:33], v[32:33], v[60:61]
    v_pk_add_f32 v[34:35], v[34:35], v[62:63]
    v_pk_add_f32 v[32:33], v[32:33], v[64:65]
    v_pk_add_f32 v[34:35], v[34:35], v[66:67]
    v_pk_add_f32 v[32:33], v[32:33], v[68:69]
    v_pk_add_f32 v[34:35], v[34:35], v[70:71]
    v_pk_add_f32 v[32:33], v[32:33], v[72:73]
    v_pk_add_f32 v[34:35], v[34:35], v[74:75]
    v_pk_add_f32 v[32:33], v[32:33], v[76:77]
    v_pk_add_f32 v[34:35], v[34:35], v[78:79]
    v_pk_add_f32 v[32:33], v[32:33], v[80:81]
    v_pk_add_f32 v[34:35], v[34:35], v[82:83]
    v_pk_add_f32 v[32:33], v[32:33], v[84:85]
    v_pk_add_f32 v[34:35], v[34:35], v[86:87]
    s_nop 0
    v_add_f32_dpp v32, v32, v32 row_ror:4 row_mask:0xf bank_mask:0xf
    v_add_f32_dpp v33, v33, v33 row_ror:4 row_mask:0xf bank_mask:0xf
    v_add_f32_dpp v34, v34, v34 row_ror:4 row_mask:0xf bank_mask:0xf
    v_add_f32_dpp v35, v35, v35 row_ror:4 row_mask:0xf bank_mask:0xf
    v_add_f32_dpp v32, v32, v32 row_ror:8 row_mask:0xf bank_mask:0xf
    v_add_f32_dpp v33, v33, v33 row_ror:8 row_mask:0xf bank_mask:0xf
    v_add_f32_dpp v34, v34, v34 row_ror:8 row_mask:0xf bank_mask:0xf
    v_add_f32_dpp v35, v35, v35 row_ror:8 row_mask:0xf bank_mask:0xf
    v_mov_b32 v36, v32
    v_mov_b32 v37, v33
    v_mov_b32 v38, v34
    v_mov_b32 v39, v35
    v_permlane16_swap_b32 v32, v36
    v_permlane16_swap_b32 v33, v37
    v_permlane16_swap_b32 v34, v38
    v_permlane16_swap_b32 v35, v39
    v_add_f32 v32, v32, v36
    v_add_f32 v33, v33, v37
    v_add_f32 v34, v34, v38
    v_add_f32 v35, v35, v39
    v_mov_b32 v36, v32
    v_mov_b32 v37, v33
    v_mov_b32 v38, v34
    v_mov_b32 v39, v35
    v_permlane32_swap_b32 v32, v36
    v_permlane32_swap_b32 v33, v37
    v_permlane32_swap_b32 v34, v38
    v_permlane32_swap_b32 v35, v39
    v_add_f32 v32, v32, v36
    v_add_f32 v33, v33, v37
    v_add_f32 v34, v34, v38
    v_add_f32 v35, v35, v39
    v_fma_f32 v32, v32, v96, v92
    v_fma_f32 v33, v33, v96, v93
    v_fma_f32 v34, v34, v96, v94
    v_fma_f32 v35, v35, v96, v95
    v_cvt_pk_bf16_f32 v32, v32, v33
    v_cvt_pk_bf16_f32 v33, v34, v35
    s_lshl_b32 s32, s73, 11
    s_lshl_b32 s33, s89, 5
    s_add_u32 s32, s32, s33
    v_lshlrev_b32 v30, 3, v252
    s_mov_b64 exec, 15
    buffer_store_dwordx2 v[32:33], v30, s[12:15], s32 offen sc1
    s_mov_b64 exec, -1
k_end:
k_exit:
    s_endpgm
.section .rodata,"a"
.p2align 6
.amdhsa_kernel interleave_layers__sliding_block__moe_arch_mod__prompt_kernel
  .amdhsa_next_free_vgpr 256
  .amdhsa_next_free_sgpr 102
  .amdhsa_accum_offset 256
  .amdhsa_group_segment_fixed_size 0
  .amdhsa_kernarg_size 88
  .amdhsa_user_sgpr_count 2
  .amdhsa_user_sgpr_kernarg_segment_ptr 1
  .amdhsa_system_sgpr_workgroup_id_x 1
.end_amdhsa_kernel
```

```asm
; @launch grid=(256,1,1) block=(512,1,1) lds=163840
.amdgcn_target "amdgcn-amd-amdhsa--gfx950"
.text
.globl interleave_layers__sliding_block__moe_arch_mod__prompt_kernel
.p2align 8
.type interleave_layers__sliding_block__moe_arch_mod__prompt_kernel,@function
interleave_layers__sliding_block__moe_arch_mod__prompt_kernel:
    s_cmp_ge_u32 s2, 256
    s_cbranch_scc1 k_exit
    s_load_dwordx4 s[4:7], s[0:1], 0
    s_load_dwordx2 s[8:9], s[0:1], 16
    s_load_dwordx2 s[20:21], s[0:1], 80
    s_load_dwordx2 s[80:81], s[0:1], 32
    v_lshrrev_b32 v1, 6, v0
    v_and_b32 v252, 63, v0
    v_readfirstlane_b32 s3, v1
    v_lshlrev_b32 v253, 4, v252
    s_and_b32 s30, s2, 7
    s_lshr_b32 s31, s2, 3
    s_and_b32 s32, s31, 1
    s_lshl_b32 s33, s30, 1
    s_add_u32 s24, s33, s32
    s_lshr_b32 s25, s31, 1
    s_add_u32 s33, s33, s25
    s_add_u32 s94, s33, s32
    s_sub_u32 s95, s33, s32
    s_add_u32 s98, s95, 15
    s_and_b32 s98, s98, 15
    s_mul_i32 s29, s30, 28
    s_lshl_b32 s32, s30, 2
    s_add_u32 s32, s32, 196
    s_cmp_lt_u32 s31, 28
    s_cselect_b32 s29, s29, s32
    s_add_u32 s29, s29, s31
    s_lshl_b32 s72, s24, 4
    s_add_u32 s72, s72, s25
    s_mov_b32 s26, 0
    s_mov_b32 s27, 20000
    s_and_b32 s28, s3, 3
    s_lshl_b32 s99, s24, 2
    s_add_u32 s99, s99, s28
    s_lshl_b32 s101, s28, 10
    s_mov_b32 s18, 0x600000
    s_mov_b32 s19, 0x20000
    s_mov_b32 s10, 0x200000
    s_mov_b32 s11, 0x20000
    s_mov_b32 s22, 0x8000000
    s_mov_b32 s23, 0x20000
    s_mov_b32 s82, 0x800
    s_mov_b32 s83, 0x20000
    s_cmp_ge_u32 s3, 4
    s_cbranch_scc1 l_start
    s_waitcnt lgkmcnt(0)
    s_mov_b32 s88, 0xdd8000
    s_load_dword s88, s[20:21], s88
    s_mov_b64 s[16:17], s[6:7]
    s_mov_b32 s6, 0x400000
    s_mov_b32 s7, 0x20000
    s_lshr_b32 s30, s16, 7
    s_sub_u32 s30, 3, s30
    s_and_b32 s30, s30, 7
    s_and_b32 s31, s24, 1
    s_lshl_b32 s31, s31, 3
    s_add_u32 s30, s30, s31
    s_and_b32 s31, s24, 14
    s_add_u32 s84, s31, s30
    s_lshl_b32 s31, s25, 2
    s_add_u32 s31, s31, s28
    s_mul_i32 s31, s31, 6144
    s_lshl_b32 s30, s30, 7
    s_add_u32 s30, s30, s31
    v_min_u32 v190, 2, v252
    v_lshl_add_u32 v190, v190, 11, s30
    s_add_u32 s30, s84, 0
    s_and_b32 s30, s30, 15
    s_mul_i32 s30, s30, 393216
    buffer_load_dword v191, v190, s[16:19], s30 offen
    s_add_u32 s30, s84, 1
    s_and_b32 s30, s30, 15
    s_mul_i32 s30, s30, 393216
    buffer_load_dword v191, v190, s[16:19], s30 offen
    v_lshrrev_b32 v5, 5, v252
    v_lshlrev_b32 v6, 3, v5
    s_lshl_b32 s33, s98, 7
    buffer_load_dwordx2 v[224:225], v6, s[80:83], s33 offen offset:0
    buffer_load_dwordx2 v[226:227], v6, s[80:83], s33 offen offset:16
    buffer_load_dwordx2 v[228:229], v6, s[80:83], s33 offen offset:32
    buffer_load_dwordx2 v[230:231], v6, s[80:83], s33 offen offset:48
    buffer_load_dwordx2 v[232:233], v6, s[80:83], s33 offen offset:64
    buffer_load_dwordx2 v[234:235], v6, s[80:83], s33 offen offset:80
    buffer_load_dwordx2 v[236:237], v6, s[80:83], s33 offen offset:96
    buffer_load_dwordx2 v[238:239], v6, s[80:83], s33 offen offset:112
    s_mov_b32 s40, 0xffffffff
    s_mov_b32 s41, 0xfffffff0
    s_mov_b32 s42, 0xfffffffe
    s_mov_b32 s43, 0xffffffe0
    s_mov_b32 s44, 0xfffffffc
    s_mov_b32 s45, 0xffffffc0
    s_mov_b32 s46, 0xfffffff8
    s_mov_b32 s47, 0xffffff80
    s_mov_b32 s48, 0xffff0000
    s_mov_b32 s49, 0xfff00000
    s_mov_b32 s50, 0xfffe0000
    s_mov_b32 s51, 0xffe00000
    s_mov_b32 s52, 0xfffc0000
    s_mov_b32 s53, 0xffc00000
    s_mov_b32 s54, 0xfff80000
    s_mov_b32 s55, 0xff800000
    s_mov_b32 s56, 0xffffff00
    s_mov_b32 s57, 0xfffff000
    s_mov_b32 s58, 0xfffffe00
    s_mov_b32 s59, 0xffffe000
    s_mov_b32 s60, 0xfffffc00
    s_mov_b32 s61, 0xffffc000
    s_mov_b32 s62, 0xfffff800
    s_mov_b32 s63, 0xffff8000
    s_mov_b32 s64, 0xff000000
    s_mov_b32 s65, 0xf0000000
    s_mov_b32 s66, 0xfe000000
    s_mov_b32 s67, 0xe0000000
    s_mov_b32 s68, 0xfc000000
    s_mov_b32 s69, 0xc0000000
    s_mov_b32 s70, 0xf8000000
    s_mov_b32 s71, 0x80000000
    v_bfe_u32 v20, v252, 3, 2
    v_lshrrev_b32 v21, 5, v252
    v_lshl_add_u32 v20, v21, 3, v20
    s_lshr_b32 s32, s28, 1
    s_lshl_b32 s32, s32, 4
    s_and_b32 s33, s28, 1
    s_lshl_b32 s33, s33, 2
    s_add_u32 s32, s32, s33
    v_add_u32 v20, s32, v20
    v_lshlrev_b32 v20, 11, v20
    v_lshrrev_b32 v21, 2, v252
    v_and_b32 v21, 4, v21
    v_xor_b32 v21, v21, v252
    v_and_b32 v21, 7, v21
    v_lshl_add_u32 v20, v21, 4, v20
    s_lshl_b32 s32, s98, 7
    v_add_u32 v243, s32, v20
    s_and_b32 s34, s3, 1
    s_lshr_b32 s35, s3, 1
    v_and_b32 v4, 15, v252
    v_lshrrev_b32 v7, 4, v252
    v_lshrrev_b32 v6, 1, v4
    v_xor_b32 v6, v6, v7
    v_lshlrev_b32 v6, 4, v6
    v_lshl_add_u32 v6, v4, 7, v6
    s_lshl_b32 s30, s34, 13
    v_add_u32 v176, s30, v6
    v_xor_b32 v177, 64, v176
    s_lshl_b32 s30, s35, 1
    v_lshrrev_b32 v20, 2, v252
    v_bfe_u32 v21, v20, 1, 2
    v_xor_b32 v21, s30, v21
    v_lshlrev_b32 v20, 7, v20
    v_lshl_add_u32 v20, v21, 5, v20
    v_and_b32 v21, 3, v252
    v_lshl_add_u32 v20, v21, 3, v20
    v_add_u32 v178, 40960, v20
    v_xor_b32 v179, 32, v178
    v_and_b32 v8, 31, v252
    v_bfe_u32 v6, v8, 1, 3
    v_xor_b32 v6, v6, v5
    v_lshlrev_b32 v6, 4, v6
    v_lshl_add_u32 v6, v8, 7, v6
    s_lshl_b32 s30, s3, 12
    s_add_u32 s30, s30, 147456
    v_add_u32 v192, s30, v6
    v_xor_b32 v193, 32, v192
    v_xor_b32 v194, 64, v192
    v_xor_b32 v195, 96, v192
    s_lshl_b32 s30, s34, 8
    v_lshl_add_u32 v184, v4, 2, s30
    v_lshl_add_u32 v185, v7, 4, s30
    s_lshl_b32 s30, s35, 7
    v_lshl_add_u32 v186, v7, 4, s30
    s_add_u32 s30, s30, 1536
    v_lshl_add_u32 v187, v4, 2, s30
    s_lshl_b32 s30, s3, 7
    s_add_u32 s30, s30, 2048
    v_lshl_add_u32 v188, v8, 2, s30
    v_mov_b32 v189, 0
    v_lshlrev_b32 v6, 9, v7
    v_lshl_add_u32 v245, v4, 4, v6
    v_and_b32 v9, 8, v4
    v_lshl_add_u32 v244, v9, 4, v245
    s_mul_i32 s30, s35, 49152
    s_lshl_b32 s31, s34, 13
    s_add_u32 s30, s30, s31
    s_add_u32 s30, s30, 98304
    v_add_u32 v246, s30, v244
    v_add_u32 v247, s30, v245
    s_lshl_b32 s30, s3, 12
    s_add_u32 s30, s30, 49152
    v_add_u32 v248, s30, v245
    s_getreg_b32 s30, hwreg(HW_REG_XCC_ID, 0, 4)
    v_mov_b32 v251, s30
    s_lshl_b32 s30, s25, 4
    s_add_u32 s30, s30, s24
    s_sub_u32 s30, s30, s72
    s_add_u32 s30, s30, 512
    v_mul_u32_u24 v249, s30, v252
    v_add_u32 v249, s72, v249
    v_lshlrev_b32 v249, 3, v249
    s_cmp_eq_u32 s3, 0
    s_cselect_b32 s89, 10, -1
    v_mov_b32 v242, 0
    v_mov_b32 v0, 0
    v_mov_b32 v1, 0
    v_mov_b32 v2, 0
    v_mov_b32 v3, 0
    v_mov_b32 v4, 0
    v_mov_b32 v5, 0
    v_mov_b32 v6, 0
    v_mov_b32 v7, 0
    v_mov_b32 v8, 0
    v_mov_b32 v9, 0
    v_mov_b32 v10, 0
    v_mov_b32 v11, 0
    v_mov_b32 v12, 0
    v_mov_b32 v13, 0
    v_mov_b32 v14, 0
    v_mov_b32 v15, 0
    v_mov_b32 v16, 0
    v_mov_b32 v17, 0
    v_mov_b32 v18, 0
    v_mov_b32 v19, 0
    v_mov_b32 v20, 0
    v_mov_b32 v21, 0
    v_mov_b32 v22, 0
    v_mov_b32 v23, 0
    v_mov_b32 v24, 0
    v_mov_b32 v25, 0
    v_mov_b32 v26, 0
    v_mov_b32 v27, 0
    v_mov_b32 v28, 0
    v_mov_b32 v29, 0
    v_mov_b32 v30, 0
    v_mov_b32 v31, 0
    v_mov_b32 v32, 0
    v_mov_b32 v33, 0
    v_mov_b32 v34, 0
    v_mov_b32 v35, 0
    v_mov_b32 v36, 0
    v_mov_b32 v37, 0
    v_mov_b32 v38, 0
    v_mov_b32 v39, 0
    v_mov_b32 v40, 0
    v_mov_b32 v41, 0
    v_mov_b32 v42, 0
    v_mov_b32 v43, 0
    v_mov_b32 v44, 0
    v_mov_b32 v45, 0
    v_mov_b32 v46, 0
    v_mov_b32 v47, 0
    v_mov_b32 v48, 0
    v_mov_b32 v49, 0
    v_mov_b32 v50, 0
    v_mov_b32 v51, 0
    v_mov_b32 v52, 0
    v_mov_b32 v53, 0
    v_mov_b32 v54, 0
    v_mov_b32 v55, 0
    v_mov_b32 v56, 0
    v_mov_b32 v57, 0
    v_mov_b32 v58, 0
    v_mov_b32 v59, 0
    v_mov_b32 v60, 0
    v_mov_b32 v61, 0
    v_mov_b32 v62, 0
    v_mov_b32 v63, 0
    v_mov_b32 v64, 0
    v_mov_b32 v65, 0
    v_mov_b32 v66, 0
    v_mov_b32 v67, 0
    v_mov_b32 v68, 0
    v_mov_b32 v69, 0
    v_mov_b32 v70, 0
    v_mov_b32 v71, 0
    v_mov_b32 v72, 0
    v_mov_b32 v73, 0
    v_mov_b32 v74, 0
    v_mov_b32 v75, 0
    v_mov_b32 v76, 0
    v_mov_b32 v77, 0
    v_mov_b32 v78, 0
    v_mov_b32 v79, 0
    v_mov_b32 v80, 0
    v_mov_b32 v81, 0
    v_mov_b32 v82, 0
    v_mov_b32 v83, 0
    v_mov_b32 v84, 0
    v_mov_b32 v85, 0
    v_mov_b32 v86, 0
    v_mov_b32 v87, 0
    v_mov_b32 v88, 0
    v_mov_b32 v89, 0
    v_mov_b32 v90, 0
    v_mov_b32 v91, 0
    v_mov_b32 v92, 0
    v_mov_b32 v93, 0
    v_mov_b32 v94, 0
    v_mov_b32 v95, 0
    s_waitcnt vmcnt(0) lgkmcnt(0)
    s_add_u32 s88, s88, 0x9e3779b9
    v_mov_b32 v250, s88
    v_dot2c_f32_bf16 v242, 0x3f803f80, v224
    v_dot2c_f32_bf16 v242, 0x3f803f80, v225
    v_dot2c_f32_bf16 v242, 0x3f803f80, v226
    v_dot2c_f32_bf16 v242, 0x3f803f80, v227
    v_dot2c_f32_bf16 v242, 0x3f803f80, v228
    v_dot2c_f32_bf16 v242, 0x3f803f80, v229
    v_dot2c_f32_bf16 v242, 0x3f803f80, v230
    v_dot2c_f32_bf16 v242, 0x3f803f80, v231
    v_dot2c_f32_bf16 v242, 0x3f803f80, v232
    v_dot2c_f32_bf16 v242, 0x3f803f80, v233
    v_dot2c_f32_bf16 v242, 0x3f803f80, v234
    v_dot2c_f32_bf16 v242, 0x3f803f80, v235
    v_dot2c_f32_bf16 v242, 0x3f803f80, v236
    v_dot2c_f32_bf16 v242, 0x3f803f80, v237
    v_dot2c_f32_bf16 v242, 0x3f803f80, v238
    v_dot2c_f32_bf16 v242, 0x3f803f80, v239
    s_add_u32 s30, s84, 2
    s_and_b32 s30, s30, 15
    s_mul_i32 s30, s30, 393216
    buffer_load_dword v191, v190, s[16:19], s30 offen
    s_add_u32 s30, s84, 3
    s_and_b32 s30, s30, 15
    s_mul_i32 s30, s30, 393216
    buffer_load_dword v191, v190, s[16:19], s30 offen
    s_add_u32 s30, s84, 4
    s_and_b32 s30, s30, 15
    s_mul_i32 s30, s30, 393216
    buffer_load_dword v191, v190, s[16:19], s30 offen
    s_add_u32 s30, s84, 5
    s_and_b32 s30, s30, 15
    s_mul_i32 s30, s30, 393216
    buffer_load_dword v191, v190, s[16:19], s30 offen
    s_setprio 1
e_q:
    s_mov_b32 s31, 0
    s_mov_b32 s32, 147456
    s_mov_b32 s36, 15
    v_add_u32 v180, s32, v176
    v_mov_b32 v182, v178
    v_add_u32 v181, s32, v177
    v_mov_b32 v183, v179
    s_barrier
    ds_read_b128 v[96:99], v180 offset:0
    ds_read_b64_tr_b16 v[112:113], v182 offset:0
    ds_read_b64_tr_b16 v[114:115], v182 offset:2048
    ds_read_b128 v[100:103], v180 offset:2048
    ds_read_b128 v[104:107], v180 offset:4096
    ds_read_b128 v[108:111], v180 offset:6144
    ds_read_b64_tr_b16 v[116:117], v183 offset:0
    ds_read_b64_tr_b16 v[118:119], v183 offset:2048
    ds_read_b64_tr_b16 v[120:121], v182 offset:8192
    ds_read_b64_tr_b16 v[122:123], v182 offset:10240
    ds_read_b64_tr_b16 v[124:125], v183 offset:8192
    ds_read_b64_tr_b16 v[126:127], v183 offset:10240
    ds_read_b64_tr_b16 v[128:129], v182 offset:16384
    ds_read_b64_tr_b16 v[130:131], v182 offset:18432
    ds_read_b64_tr_b16 v[132:133], v183 offset:16384
    ds_read_b64_tr_b16 v[134:135], v183 offset:18432
    s_add_u32 s85, s84, 5
e_loop:
    s_waitcnt lgkmcnt(0)
    v_mfma_f32_16x16x32_bf16 v[0:3], v[112:115], v[96:99], v[0:3]
    ds_read_b128 v[136:139], v181 offset:0
    v_mfma_f32_16x16x32_bf16 v[8:11], v[112:115], v[100:103], v[8:11]
    ds_read_b64_tr_b16 v[152:153], v182 offset:4096
    v_mfma_f32_16x16x32_bf16 v[16:19], v[112:115], v[104:107], v[16:19]
    ds_read_b64_tr_b16 v[154:155], v182 offset:6144
    v_mfma_f32_16x16x32_bf16 v[24:27], v[112:115], v[108:111], v[24:27]
    ds_read_b128 v[140:143], v181 offset:2048
    v_mfma_f32_16x16x32_bf16 v[28:31], v[116:119], v[108:111], v[28:31]
    ds_read_b128 v[144:147], v181 offset:4096
    v_mfma_f32_16x16x32_bf16 v[20:23], v[116:119], v[104:107], v[20:23]
    ds_read_b128 v[148:151], v181 offset:6144
    v_mfma_f32_16x16x32_bf16 v[12:15], v[116:119], v[100:103], v[12:15]
    ds_read_b64_tr_b16 v[156:157], v183 offset:4096
    v_mfma_f32_16x16x32_bf16 v[4:7], v[116:119], v[96:99], v[4:7]
    ds_read_b64_tr_b16 v[158:159], v183 offset:6144
    v_mfma_f32_16x16x32_bf16 v[32:35], v[120:123], v[96:99], v[32:35]
    ds_read_b64_tr_b16 v[160:161], v182 offset:12288
    v_mfma_f32_16x16x32_bf16 v[40:43], v[120:123], v[100:103], v[40:43]
    ds_read_b64_tr_b16 v[162:163], v182 offset:14336
    v_mfma_f32_16x16x32_bf16 v[48:51], v[120:123], v[104:107], v[48:51]
    ds_read_b64_tr_b16 v[164:165], v183 offset:12288
    v_mfma_f32_16x16x32_bf16 v[56:59], v[120:123], v[108:111], v[56:59]
    ds_read_b64_tr_b16 v[166:167], v183 offset:14336
    v_mfma_f32_16x16x32_bf16 v[60:63], v[124:127], v[108:111], v[60:63]
    ds_read_b64_tr_b16 v[168:169], v182 offset:20480
    v_mfma_f32_16x16x32_bf16 v[52:55], v[124:127], v[104:107], v[52:55]
    ds_read_b64_tr_b16 v[170:171], v182 offset:22528
    v_mfma_f32_16x16x32_bf16 v[44:47], v[124:127], v[100:103], v[44:47]
    ds_read_b64_tr_b16 v[172:173], v183 offset:20480
    v_mfma_f32_16x16x32_bf16 v[36:39], v[124:127], v[96:99], v[36:39]
    ds_read_b64_tr_b16 v[174:175], v183 offset:22528
    v_mfma_f32_16x16x32_bf16 v[64:67], v[96:99], v[128:131], v[64:67]
    s_cmp_eq_u32 s36, s89
    s_cbranch_scc1 e_arr
e_arr_ret:
    v_mfma_f32_16x16x32_bf16 v[68:71], v[100:103], v[128:131], v[68:71]
    s_add_u32 s31, s31, 24576
    s_sub_u32 s32, s32, 16384
    v_mfma_f32_16x16x32_bf16 v[72:75], v[104:107], v[128:131], v[72:75]
    s_cmp_ge_u32 s31, 73728
    s_cselect_b32 s31, 0, s31
    s_cselect_b32 s32, 147456, s32
    v_mfma_f32_16x16x32_bf16 v[76:79], v[108:111], v[128:131], v[76:79]
    v_add_u32 v182, s31, v178
    v_add_u32 v180, s32, v176
    v_mfma_f32_16x16x32_bf16 v[92:95], v[108:111], v[132:135], v[92:95]
    v_add_u32 v183, s31, v179
    v_add_u32 v181, s32, v177
    v_mfma_f32_16x16x32_bf16 v[88:91], v[104:107], v[132:135], v[88:91]
    s_add_u32 s85, s85, 1
    s_and_b32 s30, s85, 15
    v_mfma_f32_16x16x32_bf16 v[84:87], v[100:103], v[132:135], v[84:87]
    s_mul_i32 s30, s30, 393216
    s_cmp_ge_u32 s36, 6
    v_mfma_f32_16x16x32_bf16 v[80:83], v[96:99], v[132:135], v[80:83]
    s_waitcnt lgkmcnt(0)
    v_mfma_f32_16x16x32_bf16 v[0:3], v[152:155], v[136:139], v[0:3]
    s_barrier
    ds_read_b128 v[96:99], v180 offset:0
    v_mfma_f32_16x16x32_bf16 v[8:11], v[152:155], v[140:143], v[8:11]
    ds_read_b64_tr_b16 v[112:113], v182 offset:0
    v_mfma_f32_16x16x32_bf16 v[16:19], v[152:155], v[144:147], v[16:19]
    ds_read_b64_tr_b16 v[114:115], v182 offset:2048
    v_mfma_f32_16x16x32_bf16 v[24:27], v[152:155], v[148:151], v[24:27]
    ds_read_b128 v[100:103], v180 offset:2048
    v_mfma_f32_16x16x32_bf16 v[28:31], v[156:159], v[148:151], v[28:31]
    ds_read_b128 v[104:107], v180 offset:4096
    v_mfma_f32_16x16x32_bf16 v[20:23], v[156:159], v[144:147], v[20:23]
    ds_read_b128 v[108:111], v180 offset:6144
    v_mfma_f32_16x16x32_bf16 v[12:15], v[156:159], v[140:143], v[12:15]
    ds_read_b64_tr_b16 v[116:117], v183 offset:0
    v_mfma_f32_16x16x32_bf16 v[4:7], v[156:159], v[136:139], v[4:7]
    ds_read_b64_tr_b16 v[118:119], v183 offset:2048
    v_mfma_f32_16x16x32_bf16 v[32:35], v[160:163], v[136:139], v[32:35]
    ds_read_b64_tr_b16 v[120:121], v182 offset:8192
    v_mfma_f32_16x16x32_bf16 v[40:43], v[160:163], v[140:143], v[40:43]
    ds_read_b64_tr_b16 v[122:123], v182 offset:10240
    v_mfma_f32_16x16x32_bf16 v[48:51], v[160:163], v[144:147], v[48:51]
    ds_read_b64_tr_b16 v[124:125], v183 offset:8192
    v_mfma_f32_16x16x32_bf16 v[56:59], v[160:163], v[148:151], v[56:59]
    ds_read_b64_tr_b16 v[126:127], v183 offset:10240
    v_mfma_f32_16x16x32_bf16 v[60:63], v[164:167], v[148:151], v[60:63]
    ds_read_b64_tr_b16 v[128:129], v182 offset:16384
    v_mfma_f32_16x16x32_bf16 v[52:55], v[164:167], v[144:147], v[52:55]
    ds_read_b64_tr_b16 v[130:131], v182 offset:18432
    v_mfma_f32_16x16x32_bf16 v[44:47], v[164:167], v[140:143], v[44:47]
    ds_read_b64_tr_b16 v[132:133], v183 offset:16384
    v_mfma_f32_16x16x32_bf16 v[36:39], v[164:167], v[136:139], v[36:39]
    ds_read_b64_tr_b16 v[134:135], v183 offset:18432
    v_mfma_f32_16x16x32_bf16 v[64:67], v[136:139], v[168:171], v[64:67]
    s_cselect_b64 exec, 7, 0
    buffer_load_dword v191, v190, s[16:19], s30 offen
    s_mov_b64 exec, -1
    v_mfma_f32_16x16x32_bf16 v[68:71], v[140:143], v[168:171], v[68:71]
    s_sub_u32 s36, s36, 1
    s_cmp_eq_u32 s36, 0
    v_mfma_f32_16x16x32_bf16 v[72:75], v[144:147], v[168:171], v[72:75]
    v_mfma_f32_16x16x32_bf16 v[76:79], v[148:151], v[168:171], v[76:79]
    v_mfma_f32_16x16x32_bf16 v[92:95], v[148:151], v[172:175], v[92:95]
    v_mfma_f32_16x16x32_bf16 v[88:91], v[144:147], v[172:175], v[88:91]
    v_mfma_f32_16x16x32_bf16 v[84:87], v[140:143], v[172:175], v[84:87]
    v_mfma_f32_16x16x32_bf16 v[80:83], v[136:139], v[172:175], v[80:83]
    s_cbranch_scc0 e_loop
    s_waitcnt lgkmcnt(0)
    v_mfma_f32_16x16x32_bf16 v[0:3], v[112:115], v[96:99], v[0:3]
    ds_read_b128 v[136:139], v181 offset:0
    v_mfma_f32_16x16x32_bf16 v[8:11], v[112:115], v[100:103], v[8:11]
    ds_read_b64_tr_b16 v[152:153], v182 offset:4096
    v_mfma_f32_16x16x32_bf16 v[16:19], v[112:115], v[104:107], v[16:19]
    ds_read_b64_tr_b16 v[154:155], v182 offset:6144
    v_mfma_f32_16x16x32_bf16 v[24:27], v[112:115], v[108:111], v[24:27]
    ds_read_b128 v[140:143], v181 offset:2048
    v_mfma_f32_16x16x32_bf16 v[28:31], v[116:119], v[108:111], v[28:31]
    ds_read_b128 v[144:147], v181 offset:4096
    v_mfma_f32_16x16x32_bf16 v[20:23], v[116:119], v[104:107], v[20:23]
    ds_read_b128 v[148:151], v181 offset:6144
    v_mfma_f32_16x16x32_bf16 v[12:15], v[116:119], v[100:103], v[12:15]
    ds_read_b64_tr_b16 v[156:157], v183 offset:4096
    v_mfma_f32_16x16x32_bf16 v[4:7], v[116:119], v[96:99], v[4:7]
    ds_read_b64_tr_b16 v[158:159], v183 offset:6144
    v_mfma_f32_16x16x32_bf16 v[32:35], v[120:123], v[96:99], v[32:35]
    ds_read_b64_tr_b16 v[160:161], v182 offset:12288
    v_mfma_f32_16x16x32_bf16 v[40:43], v[120:123], v[100:103], v[40:43]
    ds_read_b64_tr_b16 v[162:163], v182 offset:14336
    v_mfma_f32_16x16x32_bf16 v[48:51], v[120:123], v[104:107], v[48:51]
    ds_read_b64_tr_b16 v[164:165], v183 offset:12288
    v_mfma_f32_16x16x32_bf16 v[56:59], v[120:123], v[108:111], v[56:59]
    ds_read_b64_tr_b16 v[166:167], v183 offset:14336
    v_mfma_f32_16x16x32_bf16 v[60:63], v[124:127], v[108:111], v[60:63]
    ds_read_b64_tr_b16 v[168:169], v182 offset:20480
    v_mfma_f32_16x16x32_bf16 v[52:55], v[124:127], v[104:107], v[52:55]
    ds_read_b64_tr_b16 v[170:171], v182 offset:22528
    v_mfma_f32_16x16x32_bf16 v[44:47], v[124:127], v[100:103], v[44:47]
    ds_read_b64_tr_b16 v[172:173], v183 offset:20480
    v_mfma_f32_16x16x32_bf16 v[36:39], v[124:127], v[96:99], v[36:39]
    ds_read_b64_tr_b16 v[174:175], v183 offset:22528
    v_mfma_f32_16x16x32_bf16 v[64:67], v[96:99], v[128:131], v[64:67]
    s_cmp_lg_u32 s26, 0
    s_cbranch_scc1 e_nores
    ds_read_b128 v[208:211], v192
    ds_read_b128 v[212:215], v193
    ds_read_b128 v[216:219], v194
    ds_read_b128 v[220:223], v195
e_nores:
    v_mfma_f32_16x16x32_bf16 v[68:71], v[100:103], v[128:131], v[68:71]
    s_and_b32 s34, s3, 1
    s_lshr_b32 s35, s3, 1
    s_lshl_b32 s30, s25, 1
    v_mfma_f32_16x16x32_bf16 v[72:75], v[104:107], v[128:131], v[72:75]
    s_add_u32 s30, s30, s35
    s_lshl_b32 s30, s30, 6
    s_lshl_b32 s31, s24, 2
    v_mfma_f32_16x16x32_bf16 v[76:79], v[108:111], v[128:131], v[76:79]
    s_add_u32 s30, s30, s31
    s_lshl_b32 s31, s34, 1
    s_add_u32 s30, s30, s31
    v_mfma_f32_16x16x32_bf16 v[92:95], v[108:111], v[132:135], v[92:95]
    s_lshl_b32 s32, s30, 12
    s_add_u32 s32, s32, s26
    s_add_u32 s33, s32, 4096
    v_mfma_f32_16x16x32_bf16 v[88:91], v[104:107], v[132:135], v[88:91]
    v_mfma_f32_16x16x32_bf16 v[84:87], v[100:103], v[132:135], v[84:87]
    v_mfma_f32_16x16x32_bf16 v[80:83], v[96:99], v[132:135], v[80:83]
    s_waitcnt vmcnt(0) lgkmcnt(0)
    v_mfma_f32_16x16x32_bf16 v[32:35], v[160:163], v[136:139], v[32:35]
    s_barrier
    ds_read2_b32 v[204:205], v184 offset0:128 offset1:144
    ds_read_b128 v[128:131], v186 offset:1280
    v_mfma_f32_16x16x32_bf16 v[40:43], v[160:163], v[140:143], v[40:43]
    ds_read_b128 v[132:135], v186 offset:1344
    ds_read2_b32 v[192:193], v184 offset0:0 offset1:16
    v_mfma_f32_16x16x32_bf16 v[48:51], v[160:163], v[144:147], v[48:51]
    ds_read2_b32 v[206:207], v184 offset0:160 offset1:176
    ds_read2_b32 v[194:195], v184 offset0:32 offset1:48
    v_mfma_f32_16x16x32_bf16 v[56:59], v[160:163], v[148:151], v[56:59]
    ds_read2_b32 v[190:191], v187 offset0:0 offset1:16
    ds_read_b128 v[112:115], v185 offset:512
    v_mfma_f32_16x16x32_bf16 v[36:39], v[164:167], v[136:139], v[36:39]
    ds_read_b128 v[96:99], v185 offset:0
    ds_read_b128 v[116:119], v185 offset:576
    v_mfma_f32_16x16x32_bf16 v[44:47], v[164:167], v[140:143], v[44:47]
    ds_read_b128 v[100:103], v185 offset:64
    ds_read_b128 v[120:123], v185 offset:640
    v_mfma_f32_16x16x32_bf16 v[52:55], v[164:167], v[144:147], v[52:55]
    ds_read_b128 v[104:107], v185 offset:128
    ds_read_b128 v[124:127], v185 offset:704
    v_mfma_f32_16x16x32_bf16 v[60:63], v[164:167], v[148:151], v[60:63]
    ds_read_b128 v[108:111], v185 offset:192
    ds_read_b128 v[196:199], v186 offset:1024
    v_mfma_f32_16x16x32_bf16 v[64:67], v[136:139], v[168:171], v[64:67]
    ds_read_b128 v[200:203], v186 offset:1088
    ds_read2_b32 v[240:241], v188 offset0:0 offset1:128
    v_mfma_f32_16x16x32_bf16 v[68:71], v[140:143], v[168:171], v[68:71]
    ds_read_b64 v[250:251], v189 offset:3072
    v_mfma_f32_16x16x32_bf16 v[72:75], v[144:147], v[168:171], v[72:75]
    s_waitcnt lgkmcnt(13)
    v_fma_f32 v32, v128, -v204, v32
    v_fma_f32 v33, v129, -v204, v33
    v_fma_f32 v34, v130, -v204, v34
    v_mfma_f32_16x16x32_bf16 v[76:79], v[148:151], v[168:171], v[76:79]
    v_fma_f32 v35, v131, -v204, v35
    v_fma_f32 v36, v132, -v204, v36
    v_fma_f32 v37, v133, -v204, v37
    v_mfma_f32_16x16x32_bf16 v[80:83], v[136:139], v[172:175], v[80:83]
    v_fma_f32 v38, v134, -v204, v38
    v_fma_f32 v39, v135, -v204, v39
    v_mul_f32 v32, v32, v192
    v_mfma_f32_16x16x32_bf16 v[84:87], v[140:143], v[172:175], v[84:87]
    v_mul_f32 v33, v33, v192
    v_mul_f32 v34, v34, v192
    v_mul_f32 v35, v35, v192
    v_mfma_f32_16x16x32_bf16 v[88:91], v[144:147], v[172:175], v[88:91]
    v_mul_f32 v36, v36, v192
    v_mul_f32 v37, v37, v192
    v_mul_f32 v38, v38, v192
    v_mfma_f32_16x16x32_bf16 v[92:95], v[148:151], v[172:175], v[92:95]
    v_mul_f32 v39, v39, v192
    v_cvt_pk_bf16_f32 v32, v32, v33
    v_cvt_pk_bf16_f32 v33, v34, v35
    v_mfma_f32_16x16x32_bf16 v[0:3], v[152:155], v[136:139], v[0:3]
    v_cvt_pk_bf16_f32 v34, v36, v37
    v_cvt_pk_bf16_f32 v35, v38, v39
    buffer_store_dwordx4 v[32:35], v244, s[20:23], s32 offen offset:0 sc1
    v_mfma_f32_16x16x32_bf16 v[8:11], v[152:155], v[140:143], v[8:11]
    v_fma_f32 v40, v128, -v205, v40
    v_fma_f32 v41, v129, -v205, v41
    v_fma_f32 v42, v130, -v205, v42
    v_mfma_f32_16x16x32_bf16 v[16:19], v[152:155], v[144:147], v[16:19]
    v_fma_f32 v43, v131, -v205, v43
    v_fma_f32 v44, v132, -v205, v44
    v_fma_f32 v45, v133, -v205, v45
    v_mfma_f32_16x16x32_bf16 v[24:27], v[152:155], v[148:151], v[24:27]
    v_fma_f32 v46, v134, -v205, v46
    v_fma_f32 v47, v135, -v205, v47
    v_mul_f32 v40, v40, v193
    v_mfma_f32_16x16x32_bf16 v[4:7], v[156:159], v[136:139], v[4:7]
    v_mul_f32 v41, v41, v193
    v_mul_f32 v42, v42, v193
    v_mul_f32 v43, v43, v193
    v_mfma_f32_16x16x32_bf16 v[12:15], v[156:159], v[140:143], v[12:15]
    v_mul_f32 v44, v44, v193
    v_mul_f32 v45, v45, v193
    v_mul_f32 v46, v46, v193
    v_mfma_f32_16x16x32_bf16 v[20:23], v[156:159], v[144:147], v[20:23]
    v_mul_f32 v47, v47, v193
    v_cvt_pk_bf16_f32 v40, v40, v41
    v_cvt_pk_bf16_f32 v41, v42, v43
    v_mfma_f32_16x16x32_bf16 v[28:31], v[156:159], v[148:151], v[28:31]
    v_cvt_pk_bf16_f32 v42, v44, v45
    v_cvt_pk_bf16_f32 v43, v46, v47
    buffer_store_dwordx4 v[40:43], v244, s[20:23], s32 offen offset:128 sc1
    v_pk_fma_f32 v[48:49], v[128:129], v[206:207], v[48:49] op_sel_hi:[1,0,1] neg_lo:[0,1,0] neg_hi:[0,1,0]
    v_pk_fma_f32 v[50:51], v[130:131], v[206:207], v[50:51] op_sel_hi:[1,0,1] neg_lo:[0,1,0] neg_hi:[0,1,0]
    v_pk_fma_f32 v[52:53], v[132:133], v[206:207], v[52:53] op_sel_hi:[1,0,1] neg_lo:[0,1,0] neg_hi:[0,1,0]
    v_pk_fma_f32 v[54:55], v[134:135], v[206:207], v[54:55] op_sel_hi:[1,0,1] neg_lo:[0,1,0] neg_hi:[0,1,0]
    v_pk_mul_f32 v[48:49], v[48:49], v[194:195] op_sel_hi:[1,0]
    v_pk_mul_f32 v[50:51], v[50:51], v[194:195] op_sel_hi:[1,0]
    v_pk_mul_f32 v[52:53], v[52:53], v[194:195] op_sel_hi:[1,0]
    v_pk_mul_f32 v[54:55], v[54:55], v[194:195] op_sel_hi:[1,0]
    v_cvt_pk_bf16_f32 v48, v48, v49
    v_cvt_pk_bf16_f32 v49, v50, v51
    v_cvt_pk_bf16_f32 v50, v52, v53
    v_cvt_pk_bf16_f32 v51, v54, v55
    buffer_store_dwordx4 v[48:51], v244, s[20:23], s33 offen offset:0 sc1
    v_pk_fma_f32 v[56:57], v[128:129], v[206:207], v[56:57] op_sel:[0,1,0] op_sel_hi:[1,1,1] neg_lo:[0,1,0] neg_hi:[0,1,0]
    v_pk_fma_f32 v[58:59], v[130:131], v[206:207], v[58:59] op_sel:[0,1,0] op_sel_hi:[1,1,1] neg_lo:[0,1,0] neg_hi:[0,1,0]
    v_pk_fma_f32 v[60:61], v[132:133], v[206:207], v[60:61] op_sel:[0,1,0] op_sel_hi:[1,1,1] neg_lo:[0,1,0] neg_hi:[0,1,0]
    v_pk_fma_f32 v[62:63], v[134:135], v[206:207], v[62:63] op_sel:[0,1,0] op_sel_hi:[1,1,1] neg_lo:[0,1,0] neg_hi:[0,1,0]
    v_pk_mul_f32 v[56:57], v[56:57], v[194:195] op_sel:[0,1] op_sel_hi:[1,1]
    v_pk_mul_f32 v[58:59], v[58:59], v[194:195] op_sel:[0,1] op_sel_hi:[1,1]
    v_pk_mul_f32 v[60:61], v[60:61], v[194:195] op_sel:[0,1] op_sel_hi:[1,1]
    v_pk_mul_f32 v[62:63], v[62:63], v[194:195] op_sel:[0,1] op_sel_hi:[1,1]
    v_cvt_pk_bf16_f32 v56, v56, v57
    v_cvt_pk_bf16_f32 v57, v58, v59
    v_cvt_pk_bf16_f32 v58, v60, v61
    v_cvt_pk_bf16_f32 v59, v62, v63
    buffer_store_dwordx4 v[56:59], v244, s[20:23], s33 offen offset:128 sc1
    s_waitcnt lgkmcnt(0)
    v_pk_fma_f32 v[64:65], v[112:113], v[190:191], v[64:65] op_sel_hi:[1,0,1] neg_lo:[0,1,0] neg_hi:[0,1,0]
    v_pk_fma_f32 v[66:67], v[114:115], v[190:191], v[66:67] op_sel_hi:[1,0,1] neg_lo:[0,1,0] neg_hi:[0,1,0]
    v_pk_fma_f32 v[68:69], v[116:117], v[190:191], v[68:69] op_sel_hi:[1,0,1] neg_lo:[0,1,0] neg_hi:[0,1,0]
    v_pk_fma_f32 v[70:71], v[118:119], v[190:191], v[70:71] op_sel_hi:[1,0,1] neg_lo:[0,1,0] neg_hi:[0,1,0]
    v_pk_mul_f32 v[64:65], v[64:65], v[96:97]
    v_pk_mul_f32 v[66:67], v[66:67], v[98:99]
    v_pk_mul_f32 v[68:69], v[68:69], v[100:101]
    v_pk_mul_f32 v[70:71], v[70:71], v[102:103]
    v_cvt_pk_bf16_f32 v64, v64, v65
    v_cvt_pk_bf16_f32 v65, v66, v67
    v_cvt_pk_bf16_f32 v66, v68, v69
    v_cvt_pk_bf16_f32 v67, v70, v71
    buffer_store_dwordx4 v[64:67], v245, s[20:23], s32 offen offset:2048 sc1
    v_pk_fma_f32 v[80:81], v[112:113], v[190:191], v[80:81] op_sel:[0,1,0] op_sel_hi:[1,1,1] neg_lo:[0,1,0] neg_hi:[0,1,0]
    v_pk_fma_f32 v[82:83], v[114:115], v[190:191], v[82:83] op_sel:[0,1,0] op_sel_hi:[1,1,1] neg_lo:[0,1,0] neg_hi:[0,1,0]
    v_pk_fma_f32 v[84:85], v[116:117], v[190:191], v[84:85] op_sel:[0,1,0] op_sel_hi:[1,1,1] neg_lo:[0,1,0] neg_hi:[0,1,0]
    v_pk_fma_f32 v[86:87], v[118:119], v[190:191], v[86:87] op_sel:[0,1,0] op_sel_hi:[1,1,1] neg_lo:[0,1,0] neg_hi:[0,1,0]
    v_pk_mul_f32 v[80:81], v[80:81], v[96:97]
    v_pk_mul_f32 v[82:83], v[82:83], v[98:99]
    v_pk_mul_f32 v[84:85], v[84:85], v[100:101]
    v_pk_mul_f32 v[86:87], v[86:87], v[102:103]
    v_cvt_pk_bf16_f32 v80, v80, v81
    v_cvt_pk_bf16_f32 v81, v82, v83
    v_cvt_pk_bf16_f32 v82, v84, v85
    v_cvt_pk_bf16_f32 v83, v86, v87
    buffer_store_dwordx4 v[80:83], v245, s[20:23], s32 offen offset:2304 sc1
    v_pk_fma_f32 v[72:73], v[120:121], v[190:191], v[72:73] op_sel_hi:[1,0,1] neg_lo:[0,1,0] neg_hi:[0,1,0]
    v_pk_fma_f32 v[74:75], v[122:123], v[190:191], v[74:75] op_sel_hi:[1,0,1] neg_lo:[0,1,0] neg_hi:[0,1,0]
    v_pk_fma_f32 v[76:77], v[124:125], v[190:191], v[76:77] op_sel_hi:[1,0,1] neg_lo:[0,1,0] neg_hi:[0,1,0]
    v_pk_fma_f32 v[78:79], v[126:127], v[190:191], v[78:79] op_sel_hi:[1,0,1] neg_lo:[0,1,0] neg_hi:[0,1,0]
    v_pk_mul_f32 v[72:73], v[72:73], v[104:105]
    v_pk_mul_f32 v[74:75], v[74:75], v[106:107]
    v_pk_mul_f32 v[76:77], v[76:77], v[108:109]
    v_pk_mul_f32 v[78:79], v[78:79], v[110:111]
    v_cvt_pk_bf16_f32 v72, v72, v73
    v_cvt_pk_bf16_f32 v73, v74, v75
    v_cvt_pk_bf16_f32 v74, v76, v77
    v_cvt_pk_bf16_f32 v75, v78, v79
    buffer_store_dwordx4 v[72:75], v245, s[20:23], s33 offen offset:2048 sc1
    v_pk_fma_f32 v[88:89], v[120:121], v[190:191], v[88:89] op_sel:[0,1,0] op_sel_hi:[1,1,1] neg_lo:[0,1,0] neg_hi:[0,1,0]
    v_pk_fma_f32 v[90:91], v[122:123], v[190:191], v[90:91] op_sel:[0,1,0] op_sel_hi:[1,1,1] neg_lo:[0,1,0] neg_hi:[0,1,0]
    v_pk_fma_f32 v[92:93], v[124:125], v[190:191], v[92:93] op_sel:[0,1,0] op_sel_hi:[1,1,1] neg_lo:[0,1,0] neg_hi:[0,1,0]
    v_pk_fma_f32 v[94:95], v[126:127], v[190:191], v[94:95] op_sel:[0,1,0] op_sel_hi:[1,1,1] neg_lo:[0,1,0] neg_hi:[0,1,0]
    v_pk_mul_f32 v[88:89], v[88:89], v[104:105]
    v_pk_mul_f32 v[90:91], v[90:91], v[106:107]
    v_pk_mul_f32 v[92:93], v[92:93], v[108:109]
    v_pk_mul_f32 v[94:95], v[94:95], v[110:111]
    v_cvt_pk_bf16_f32 v88, v88, v89
    v_cvt_pk_bf16_f32 v89, v90, v91
    v_cvt_pk_bf16_f32 v90, v92, v93
    v_cvt_pk_bf16_f32 v91, v94, v95
    buffer_store_dwordx4 v[88:91], v245, s[20:23], s33 offen offset:2304 sc1
    ds_write_b128 v246, v[32:35] offset:0
    v_mul_f32 v192, 0x3e8293ee, v192
    ds_write_b128 v246, v[40:43] offset:128
    v_mul_f32 v193, 0x3e8293ee, v193
    ds_write_b128 v246, v[48:51] offset:4096
    v_mul_f32 v194, 0x3e8293ee, v194
    ds_write_b128 v246, v[56:59] offset:4224
    v_mul_f32 v195, 0x3e8293ee, v195
    v_pk_fma_f32 v[0:1], v[196:197], v[204:205], v[0:1] op_sel_hi:[1,0,1] neg_lo:[0,1,0] neg_hi:[0,1,0]
    v_pk_fma_f32 v[2:3], v[198:199], v[204:205], v[2:3] op_sel_hi:[1,0,1] neg_lo:[0,1,0] neg_hi:[0,1,0]
    v_pk_fma_f32 v[4:5], v[200:201], v[204:205], v[4:5] op_sel_hi:[1,0,1] neg_lo:[0,1,0] neg_hi:[0,1,0]
    v_pk_fma_f32 v[6:7], v[202:203], v[204:205], v[6:7] op_sel_hi:[1,0,1] neg_lo:[0,1,0] neg_hi:[0,1,0]
    v_pk_mul_f32 v[0:1], v[0:1], v[192:193] op_sel_hi:[1,0]
    v_pk_mul_f32 v[2:3], v[2:3], v[192:193] op_sel_hi:[1,0]
    v_pk_mul_f32 v[4:5], v[4:5], v[192:193] op_sel_hi:[1,0]
    v_pk_mul_f32 v[6:7], v[6:7], v[192:193] op_sel_hi:[1,0]
    v_cvt_pk_bf16_f32 v0, v0, v1
    v_cvt_pk_bf16_f32 v1, v2, v3
    v_cvt_pk_bf16_f32 v2, v4, v5
    v_cvt_pk_bf16_f32 v3, v6, v7
    ds_write_b128 v247, v[64:67] offset:2048
    ds_write_b128 v248, v[0:3] offset:0
    v_pk_fma_f32 v[8:9], v[196:197], v[204:205], v[8:9] op_sel:[0,1,0] op_sel_hi:[1,1,1] neg_lo:[0,1,0] neg_hi:[0,1,0]
    v_pk_fma_f32 v[10:11], v[198:199], v[204:205], v[10:11] op_sel:[0,1,0] op_sel_hi:[1,1,1] neg_lo:[0,1,0] neg_hi:[0,1,0]
    v_pk_fma_f32 v[12:13], v[200:201], v[204:205], v[12:13] op_sel:[0,1,0] op_sel_hi:[1,1,1] neg_lo:[0,1,0] neg_hi:[0,1,0]
    v_pk_fma_f32 v[14:15], v[202:203], v[204:205], v[14:15] op_sel:[0,1,0] op_sel_hi:[1,1,1] neg_lo:[0,1,0] neg_hi:[0,1,0]
    v_pk_mul_f32 v[8:9], v[8:9], v[192:193] op_sel:[0,1] op_sel_hi:[1,1]
    v_pk_mul_f32 v[10:11], v[10:11], v[192:193] op_sel:[0,1] op_sel_hi:[1,1]
    v_pk_mul_f32 v[12:13], v[12:13], v[192:193] op_sel:[0,1] op_sel_hi:[1,1]
    v_pk_mul_f32 v[14:15], v[14:15], v[192:193] op_sel:[0,1] op_sel_hi:[1,1]
    v_cvt_pk_bf16_f32 v8, v8, v9
    v_cvt_pk_bf16_f32 v9, v10, v11
    v_cvt_pk_bf16_f32 v10, v12, v13
    v_cvt_pk_bf16_f32 v11, v14, v15
    ds_write_b128 v247, v[80:83] offset:2304
    ds_write_b128 v248, v[8:11] offset:256
    v_pk_fma_f32 v[16:17], v[196:197], v[206:207], v[16:17] op_sel_hi:[1,0,1] neg_lo:[0,1,0] neg_hi:[0,1,0]
    v_pk_fma_f32 v[18:19], v[198:199], v[206:207], v[18:19] op_sel_hi:[1,0,1] neg_lo:[0,1,0] neg_hi:[0,1,0]
    v_pk_fma_f32 v[20:21], v[200:201], v[206:207], v[20:21] op_sel_hi:[1,0,1] neg_lo:[0,1,0] neg_hi:[0,1,0]
    v_pk_fma_f32 v[22:23], v[202:203], v[206:207], v[22:23] op_sel_hi:[1,0,1] neg_lo:[0,1,0] neg_hi:[0,1,0]
    v_pk_mul_f32 v[16:17], v[16:17], v[194:195] op_sel_hi:[1,0]
    v_pk_mul_f32 v[18:19], v[18:19], v[194:195] op_sel_hi:[1,0]
    v_pk_mul_f32 v[20:21], v[20:21], v[194:195] op_sel_hi:[1,0]
    v_pk_mul_f32 v[22:23], v[22:23], v[194:195] op_sel_hi:[1,0]
    v_cvt_pk_bf16_f32 v16, v16, v17
    v_cvt_pk_bf16_f32 v17, v18, v19
    v_cvt_pk_bf16_f32 v18, v20, v21
    v_cvt_pk_bf16_f32 v19, v22, v23
    ds_write_b128 v247, v[72:75] offset:6144
    ds_write_b128 v248, v[16:19] offset:2048
    v_pk_fma_f32 v[24:25], v[196:197], v[206:207], v[24:25] op_sel:[0,1,0] op_sel_hi:[1,1,1] neg_lo:[0,1,0] neg_hi:[0,1,0]
    v_pk_fma_f32 v[26:27], v[198:199], v[206:207], v[26:27] op_sel:[0,1,0] op_sel_hi:[1,1,1] neg_lo:[0,1,0] neg_hi:[0,1,0]
    v_pk_fma_f32 v[28:29], v[200:201], v[206:207], v[28:29] op_sel:[0,1,0] op_sel_hi:[1,1,1] neg_lo:[0,1,0] neg_hi:[0,1,0]
    v_pk_fma_f32 v[30:31], v[202:203], v[206:207], v[30:31] op_sel:[0,1,0] op_sel_hi:[1,1,1] neg_lo:[0,1,0] neg_hi:[0,1,0]
    v_pk_mul_f32 v[24:25], v[24:25], v[194:195] op_sel:[0,1] op_sel_hi:[1,1]
    v_pk_mul_f32 v[26:27], v[26:27], v[194:195] op_sel:[0,1] op_sel_hi:[1,1]
    v_pk_mul_f32 v[28:29], v[28:29], v[194:195] op_sel:[0,1] op_sel_hi:[1,1]
    v_pk_mul_f32 v[30:31], v[30:31], v[194:195] op_sel:[0,1] op_sel_hi:[1,1]
    v_cvt_pk_bf16_f32 v24, v24, v25
    v_cvt_pk_bf16_f32 v25, v26, v27
    v_cvt_pk_bf16_f32 v26, v28, v29
    v_cvt_pk_bf16_f32 v27, v30, v31
    ds_write_b128 v247, v[88:91] offset:6400
    ds_write_b128 v248, v[24:27] offset:2304
    s_lshl_b32 s30, s25, 8
    s_lshl_b32 s31, s24, 4
    s_add_u32 s30, s30, s31
    s_lshl_b32 s31, s34, 3
    s_add_u32 s30, s30, s31
    s_lshl_b32 s31, s35, 2
    s_add_u32 s30, s30, s31
    s_add_u32 s30, s30, s26
    s_add_u32 s30, s30, 0xdd0000
    v_mov_b32 v154, s88
    s_mov_b64 exec, 1
    s_waitcnt vmcnt(0)
    buffer_store_dword v154, v253, s[20:23], s30 offen sc1
    s_mov_b64 exec, -1
    v_readfirstlane_b32 s73, v250
    v_readfirstlane_b32 s77, v251
    s_lshr_b32 s39, s73, 5
    s_lshl_b32 s34, s24, 2
    s_sub_u32 s39, s39, s34
    s_add_u32 s39, s39, 8
    s_cmp_lt_u32 s39, 12
    s_cselect_b32 s100, 1, 0
    s_cmp_lg_u32 s26, 0
    s_cbranch_scc1 sk_1
    v_permlane32_swap_b32 v208, v210
    v_permlane32_swap_b32 v209, v211
    v_permlane32_swap_b32 v212, v214
    v_permlane32_swap_b32 v213, v215
    v_permlane32_swap_b32 v216, v218
    v_permlane32_swap_b32 v217, v219
    v_permlane32_swap_b32 v220, v222
    v_permlane32_swap_b32 v221, v223
sk_1:
    v_mov_b32 v20, 0xffff
    v_mov_b32 v21, 0xffff0000
    v_cndmask_b32 v22, 0, v20, s[40:41]
    v_cndmask_b32 v23, 0, v21, s[42:43]
    v_or_b32 v12, v22, v23
    v_cndmask_b32 v22, 0, v20, s[44:45]
    v_cndmask_b32 v23, 0, v21, s[46:47]
    v_or_b32 v13, v22, v23
    v_cndmask_b32 v22, 0, v20, s[48:49]
    v_cndmask_b32 v23, 0, v21, s[50:51]
    v_or_b32 v14, v22, v23
    v_cndmask_b32 v22, 0, v20, s[52:53]
    v_cndmask_b32 v23, 0, v21, s[54:55]
    v_or_b32 v15, v22, v23
    v_cndmask_b32 v22, 0, v20, s[56:57]
    v_cndmask_b32 v23, 0, v21, s[58:59]
    v_or_b32 v16, v22, v23
    v_cndmask_b32 v22, 0, v20, s[60:61]
    v_cndmask_b32 v23, 0, v21, s[62:63]
    v_or_b32 v17, v22, v23
    v_cndmask_b32 v22, 0, v20, s[64:65]
    v_cndmask_b32 v23, 0, v21, s[66:67]
    v_or_b32 v18, v22, v23
    v_cndmask_b32 v22, 0, v20, s[68:69]
    v_cndmask_b32 v23, 0, v21, s[70:71]
    v_or_b32 v19, v22, v23
    s_lshl_b32 s34, s28, 12
    s_add_u32 s34, s34, 65536
    v_add_u32 v20, s34, v253
    s_lshl_b32 s34, s3, 11
    s_add_u32 s34, s34, 49152
    v_add_u32 v3, s34, v253
    v_mov_b32 v24, 0
    v_mov_b32 v25, 0
    v_mov_b32 v26, 0
    v_mov_b32 v27, 0
    v_mov_b32 v28, 0
    v_mov_b32 v29, 0
    v_mov_b32 v30, 0
    v_mov_b32 v31, 0
    v_mov_b32 v32, 0
    v_mov_b32 v33, 0
    v_mov_b32 v34, 0
    v_mov_b32 v35, 0
    v_mov_b32 v36, 0
    v_mov_b32 v37, 0
    v_mov_b32 v38, 0
    v_mov_b32 v39, 0
    s_waitcnt lgkmcnt(0)
    s_barrier
    s_cmp_eq_u32 s100, 0
    s_cbranch_scc1 sk_2
    s_barrier
    s_lshr_b32 s34, s73, 5
    s_cmp_lg_u32 s34, s99
    s_cbranch_scc1 sk_3
    s_and_b32 s32, s73, 31
    v_and_b32 v0, 31, v252
    v_cmp_eq_u32 vcc, s32, v0
    v_lshrrev_b32 v0, 5, v252
    v_lshlrev_b32 v0, 4, v0
    s_lshl_b32 s34, s98, 7
    s_add_u32 s34, s34, 0xdc4000
    s_mov_b64 exec, vcc
    buffer_load_dwordx4 v[208:211], v0, s[20:23], s34 offen offset:0 sc1
    buffer_load_dwordx4 v[212:215], v0, s[20:23], s34 offen offset:32 sc1
    buffer_load_dwordx4 v[216:219], v0, s[20:23], s34 offen offset:64 sc1
    buffer_load_dwordx4 v[220:223], v0, s[20:23], s34 offen offset:96 sc1
    v_mov_b32 v240, 1.0
    v_mov_b32 v241, 0
    s_mov_b64 exec, -1
sk_3:
sk_2:
    ds_read_b128 v[4:7], v3
    ds_read_b128 v[8:11], v3 offset:1024
    ds_read_b128 v[104:107], v20 offset:32768
    ds_read_b128 v[108:111], v20 offset:33792
    ds_read_b128 v[112:115], v20 offset:28672
    ds_read_b128 v[116:119], v20 offset:29696
    s_waitcnt lgkmcnt(2)
    v_mfma_f32_32x32x16_bf16 v[40:55], v[104:107], v[4:7], 0
    v_mfma_f32_32x32x16_bf16 v[40:55], v[108:111], v[8:11], v[40:55]
    ds_read_b128 v[104:107], v20 offset:24576
    ds_read_b128 v[108:111], v20 offset:25600
    s_cmp_eq_u32 s99, 0
    s_cbranch_scc0 ng_4
    v_mov_b32 v24, 0xf149f2ca
    v_mov_b32 v25, 0xf149f2ca
    v_mov_b32 v26, 0xf149f2ca
    v_mov_b32 v27, 0xf149f2ca
    v_mov_b32 v28, 0xf149f2ca
    v_mov_b32 v29, 0xf149f2ca
    v_mov_b32 v30, 0xf149f2ca
    v_mov_b32 v31, 0xf149f2ca
    v_mov_b32 v32, 0xf149f2ca
    v_mov_b32 v33, 0xf149f2ca
    v_mov_b32 v34, 0xf149f2ca
    v_mov_b32 v35, 0xf149f2ca
    v_mov_b32 v36, 0xf149f2ca
    v_mov_b32 v37, 0xf149f2ca
    v_mov_b32 v38, 0xf149f2ca
    v_mov_b32 v39, 0xf149f2ca
ng_4:
    s_waitcnt lgkmcnt(2)
    s_nop 0
    v_mfma_f32_32x32x16_bf16 v[72:87], v[112:115], v[4:7], v[24:39]
    v_mfma_f32_32x32x16_bf16 v[72:87], v[116:119], v[8:11], v[72:87]
    ds_read_b128 v[112:115], v20 offset:20480
    ds_read_b128 v[116:119], v20 offset:21504
    s_cmp_eq_u32 s99, 1
    s_cbranch_scc0 ng_5
    s_nop 1
    v_mov_b32 v24, 0xf149f2ca
    v_mov_b32 v25, 0xf149f2ca
    v_mov_b32 v26, 0xf149f2ca
    v_mov_b32 v27, 0xf149f2ca
    v_mov_b32 v28, 0xf149f2ca
    v_mov_b32 v29, 0xf149f2ca
    v_mov_b32 v30, 0xf149f2ca
    v_mov_b32 v31, 0xf149f2ca
    v_mov_b32 v32, 0xf149f2ca
    v_mov_b32 v33, 0xf149f2ca
    v_mov_b32 v34, 0xf149f2ca
    v_mov_b32 v35, 0xf149f2ca
    v_mov_b32 v36, 0xf149f2ca
    v_mov_b32 v37, 0xf149f2ca
    v_mov_b32 v38, 0xf149f2ca
    v_mov_b32 v39, 0xf149f2ca
ng_5:
    s_waitcnt lgkmcnt(2)
    s_nop 0
    v_mfma_f32_32x32x16_bf16 v[56:71], v[104:107], v[4:7], v[24:39]
    v_mfma_f32_32x32x16_bf16 v[56:71], v[108:111], v[8:11], v[56:71]
    s_nop 3
    v_max_f32 v21, v72, v73
    v_max3_f32 v21, v21, v74, v75
    v_max3_f32 v21, v21, v76, v77
    v_max3_f32 v21, v21, v78, v79
    v_max3_f32 v21, v21, v80, v81
    v_max3_f32 v21, v21, v82, v83
    v_max3_f32 v21, v21, v84, v85
    v_max3_f32 v21, v21, v86, v87
    ds_read_b128 v[104:107], v20 offset:16384
    ds_read_b128 v[108:111], v20 offset:17408
    s_cmp_eq_u32 s99, 2
    s_cbranch_scc0 ng_6
    v_mov_b32 v24, 0xf149f2ca
    v_mov_b32 v25, 0xf149f2ca
    v_mov_b32 v26, 0xf149f2ca
    v_mov_b32 v27, 0xf149f2ca
    v_mov_b32 v28, 0xf149f2ca
    v_mov_b32 v29, 0xf149f2ca
    v_mov_b32 v30, 0xf149f2ca
    v_mov_b32 v31, 0xf149f2ca
    v_mov_b32 v32, 0xf149f2ca
    v_mov_b32 v33, 0xf149f2ca
    v_mov_b32 v34, 0xf149f2ca
    v_mov_b32 v35, 0xf149f2ca
    v_mov_b32 v36, 0xf149f2ca
    v_mov_b32 v37, 0xf149f2ca
    v_mov_b32 v38, 0xf149f2ca
    v_mov_b32 v39, 0xf149f2ca
ng_6:
    s_waitcnt lgkmcnt(2)
    s_nop 0
    v_mfma_f32_32x32x16_bf16 v[72:87], v[112:115], v[4:7], v[24:39]
    v_mfma_f32_32x32x16_bf16 v[72:87], v[116:119], v[8:11], v[72:87]
    v_max3_f32 v21, v21, v56, v57
    v_max3_f32 v21, v21, v58, v59
    v_max3_f32 v21, v21, v60, v61
    v_max3_f32 v21, v21, v62, v63
    v_max3_f32 v21, v21, v64, v65
    v_max3_f32 v21, v21, v66, v67
    v_max3_f32 v21, v21, v68, v69
    v_max3_f32 v21, v21, v70, v71
    ds_read_b128 v[112:115], v20 offset:12288
    ds_read_b128 v[116:119], v20 offset:13312
    s_cmp_eq_u32 s99, 3
    s_cbranch_scc0 ng_7
    v_mov_b32 v24, 0xf149f2ca
    v_mov_b32 v25, 0xf149f2ca
    v_mov_b32 v26, 0xf149f2ca
    v_mov_b32 v27, 0xf149f2ca
    v_mov_b32 v28, 0xf149f2ca
    v_mov_b32 v29, 0xf149f2ca
    v_mov_b32 v30, 0xf149f2ca
    v_mov_b32 v31, 0xf149f2ca
    v_mov_b32 v32, 0xf149f2ca
    v_mov_b32 v33, 0xf149f2ca
    v_mov_b32 v34, 0xf149f2ca
    v_mov_b32 v35, 0xf149f2ca
    v_mov_b32 v36, 0xf149f2ca
    v_mov_b32 v37, 0xf149f2ca
    v_mov_b32 v38, 0xf149f2ca
    v_mov_b32 v39, 0xf149f2ca
ng_7:
    s_waitcnt lgkmcnt(2)
    s_nop 0
    v_mfma_f32_32x32x16_bf16 v[56:71], v[104:107], v[4:7], v[24:39]
    v_mfma_f32_32x32x16_bf16 v[56:71], v[108:111], v[8:11], v[56:71]
    v_max3_f32 v21, v21, v72, v73
    v_max3_f32 v21, v21, v74, v75
    v_max3_f32 v21, v21, v76, v77
    v_max3_f32 v21, v21, v78, v79
    v_max3_f32 v21, v21, v80, v81
    v_max3_f32 v21, v21, v82, v83
    v_max3_f32 v21, v21, v84, v85
    v_max3_f32 v21, v21, v86, v87
    ds_read_b128 v[104:107], v20 offset:8192
    ds_read_b128 v[108:111], v20 offset:9216
    s_cmp_eq_u32 s99, 4
    s_cbranch_scc0 ng_8
    v_mov_b32 v24, 0xf149f2ca
    v_mov_b32 v25, 0xf149f2ca
    v_mov_b32 v26, 0xf149f2ca
    v_mov_b32 v27, 0xf149f2ca
    v_mov_b32 v28, 0xf149f2ca
    v_mov_b32 v29, 0xf149f2ca
    v_mov_b32 v30, 0xf149f2ca
    v_mov_b32 v31, 0xf149f2ca
    v_mov_b32 v32, 0xf149f2ca
    v_mov_b32 v33, 0xf149f2ca
    v_mov_b32 v34, 0xf149f2ca
    v_mov_b32 v35, 0xf149f2ca
    v_mov_b32 v36, 0xf149f2ca
    v_mov_b32 v37, 0xf149f2ca
    v_mov_b32 v38, 0xf149f2ca
    v_mov_b32 v39, 0xf149f2ca
ng_8:
    s_waitcnt lgkmcnt(2)
    s_nop 0
    v_mfma_f32_32x32x16_bf16 v[72:87], v[112:115], v[4:7], v[24:39]
    v_mfma_f32_32x32x16_bf16 v[72:87], v[116:119], v[8:11], v[72:87]
    v_max3_f32 v21, v21, v56, v57
    v_max3_f32 v21, v21, v58, v59
    v_max3_f32 v21, v21, v60, v61
    v_max3_f32 v21, v21, v62, v63
    v_max3_f32 v21, v21, v64, v65
    v_max3_f32 v21, v21, v66, v67
    v_max3_f32 v21, v21, v68, v69
    v_max3_f32 v21, v21, v70, v71
    s_barrier
    s_add_u32 s96, s25, 0
    s_and_b32 s96, s96, 15
    s_lshl_b32 s96, s96, 17
    s_add_u32 m0, s101, 0
    s_nop 0
    buffer_load_dwordx4 v243, s[8:11], s96 offen lds
    ds_read_b128 v[112:115], v20 offset:4096
    ds_read_b128 v[116:119], v20 offset:5120
    s_cmp_eq_u32 s99, 5
    s_cbranch_scc0 ng_9
    v_mov_b32 v24, 0xf149f2ca
    v_mov_b32 v25, 0xf149f2ca
    v_mov_b32 v26, 0xf149f2ca
    v_mov_b32 v27, 0xf149f2ca
    v_mov_b32 v28, 0xf149f2ca
    v_mov_b32 v29, 0xf149f2ca
    v_mov_b32 v30, 0xf149f2ca
    v_mov_b32 v31, 0xf149f2ca
    v_mov_b32 v32, 0xf149f2ca
    v_mov_b32 v33, 0xf149f2ca
    v_mov_b32 v34, 0xf149f2ca
    v_mov_b32 v35, 0xf149f2ca
    v_mov_b32 v36, 0xf149f2ca
    v_mov_b32 v37, 0xf149f2ca
    v_mov_b32 v38, 0xf149f2ca
    v_mov_b32 v39, 0xf149f2ca
ng_9:
    s_waitcnt lgkmcnt(2)
    s_nop 0
    v_mfma_f32_32x32x16_bf16 v[56:71], v[104:107], v[4:7], v[24:39]
    v_mfma_f32_32x32x16_bf16 v[56:71], v[108:111], v[8:11], v[56:71]
    v_max3_f32 v21, v21, v72, v73
    v_max3_f32 v21, v21, v74, v75
    v_max3_f32 v21, v21, v76, v77
    v_max3_f32 v21, v21, v78, v79
    v_max3_f32 v21, v21, v80, v81
    v_max3_f32 v21, v21, v82, v83
    v_max3_f32 v21, v21, v84, v85
    v_max3_f32 v21, v21, v86, v87
    s_add_u32 s96, s25, 12
    s_and_b32 s96, s96, 15
    s_lshl_b32 s96, s96, 17
    s_add_u32 m0, s101, 49152
    s_nop 0
    buffer_load_dwordx4 v243, s[8:11], s96 offen lds
    ds_read_b128 v[104:107], v20 offset:0
    ds_read_b128 v[108:111], v20 offset:1024
    s_cmp_eq_u32 s99, 6
    s_cbranch_scc0 ng_10
    v_mov_b32 v24, 0xf149f2ca
    v_mov_b32 v25, 0xf149f2ca
    v_mov_b32 v26, 0xf149f2ca
    v_mov_b32 v27, 0xf149f2ca
    v_mov_b32 v28, 0xf149f2ca
    v_mov_b32 v29, 0xf149f2ca
    v_mov_b32 v30, 0xf149f2ca
    v_mov_b32 v31, 0xf149f2ca
    v_mov_b32 v32, 0xf149f2ca
    v_mov_b32 v33, 0xf149f2ca
    v_mov_b32 v34, 0xf149f2ca
    v_mov_b32 v35, 0xf149f2ca
    v_mov_b32 v36, 0xf149f2ca
    v_mov_b32 v37, 0xf149f2ca
    v_mov_b32 v38, 0xf149f2ca
    v_mov_b32 v39, 0xf149f2ca
ng_10:
    s_waitcnt lgkmcnt(2)
    s_nop 0
    v_mfma_f32_32x32x16_bf16 v[72:87], v[112:115], v[4:7], v[24:39]
    v_mfma_f32_32x32x16_bf16 v[72:87], v[116:119], v[8:11], v[72:87]
    v_max3_f32 v21, v21, v56, v57
    v_max3_f32 v21, v21, v58, v59
    v_max3_f32 v21, v21, v60, v61
    v_max3_f32 v21, v21, v62, v63
    v_max3_f32 v21, v21, v64, v65
    v_max3_f32 v21, v21, v66, v67
    v_max3_f32 v21, v21, v68, v69
    v_max3_f32 v21, v21, v70, v71
    s_add_u32 s96, s25, 13
    s_and_b32 s96, s96, 15
    s_lshl_b32 s96, s96, 17
    s_add_u32 m0, s101, 53248
    s_nop 0
    buffer_load_dwordx4 v243, s[8:11], s96 offen lds
    s_cmp_eq_u32 s99, 7
    s_cbranch_scc0 ng_11
    v_mov_b32 v24, 0xf149f2ca
    v_mov_b32 v25, 0xf149f2ca
    v_mov_b32 v26, 0xf149f2ca
    v_mov_b32 v27, 0xf149f2ca
    v_mov_b32 v28, 0xf149f2ca
    v_mov_b32 v29, 0xf149f2ca
    v_mov_b32 v30, 0xf149f2ca
    v_mov_b32 v31, 0xf149f2ca
    v_mov_b32 v32, 0xf149f2ca
    v_mov_b32 v33, 0xf149f2ca
    v_mov_b32 v34, 0xf149f2ca
    v_mov_b32 v35, 0xf149f2ca
    v_mov_b32 v36, 0xf149f2ca
    v_mov_b32 v37, 0xf149f2ca
    v_mov_b32 v38, 0xf149f2ca
    v_mov_b32 v39, 0xf149f2ca
ng_11:
    s_waitcnt lgkmcnt(0)
    s_nop 0
    v_mfma_f32_32x32x16_bf16 v[56:71], v[104:107], v[4:7], v[24:39]
    v_mfma_f32_32x32x16_bf16 v[56:71], v[108:111], v[8:11], v[56:71]
    v_max3_f32 v21, v21, v72, v73
    v_max3_f32 v21, v21, v74, v75
    v_max3_f32 v21, v21, v76, v77
    v_max3_f32 v21, v21, v78, v79
    v_max3_f32 v21, v21, v80, v81
    v_max3_f32 v21, v21, v82, v83
    v_max3_f32 v21, v21, v84, v85
    v_max3_f32 v21, v21, v86, v87
    s_add_u32 s96, s25, 14
    s_and_b32 s96, s96, 15
    s_lshl_b32 s96, s96, 17
    s_add_u32 m0, s101, 57344
    s_nop 0
    buffer_load_dwordx4 v243, s[8:11], s96 offen lds
    ds_read_b128 v[112:115], v20 offset:28672
    ds_read_b128 v[116:119], v20 offset:29696
    ds_read_b128 v[120:123], v20 offset:34816
    ds_read_b128 v[124:127], v20 offset:35840
    ds_read_b128 v[128:131], v20 offset:2048
    ds_read_b128 v[132:135], v20 offset:3072
    v_cndmask_b32 v40, v56, v40, s[40:41]
    v_cndmask_b32 v41, v57, v41, s[42:43]
    v_cndmask_b32 v42, v58, v42, s[44:45]
    v_cndmask_b32 v43, v59, v43, s[46:47]
    v_cndmask_b32 v44, v60, v44, s[48:49]
    v_cndmask_b32 v45, v61, v45, s[50:51]
    v_cndmask_b32 v46, v62, v46, s[52:53]
    v_cndmask_b32 v47, v63, v47, s[54:55]
    v_cndmask_b32 v48, v64, v48, s[56:57]
    v_cndmask_b32 v49, v65, v49, s[58:59]
    v_cndmask_b32 v50, v66, v50, s[60:61]
    v_cndmask_b32 v51, v67, v51, s[62:63]
    v_cndmask_b32 v52, v68, v52, s[64:65]
    v_cndmask_b32 v53, v69, v53, s[66:67]
    v_cndmask_b32 v54, v70, v54, s[68:69]
    v_cndmask_b32 v55, v71, v55, s[70:71]
    v_max3_f32 v21, v21, v40, v41
    v_max3_f32 v21, v21, v42, v43
    v_max3_f32 v21, v21, v44, v45
    v_max3_f32 v21, v21, v46, v47
    v_max3_f32 v21, v21, v48, v49
    v_max3_f32 v21, v21, v50, v51
    v_max3_f32 v21, v21, v52, v53
    v_max3_f32 v21, v21, v54, v55
    v_mov_b32 v152, v21
    s_nop 1
    v_permlane32_swap_b32 v21, v152
    v_max_f32 v21, v21, v152
    v_sub_f32 v24, 0, v21
    v_sub_f32 v25, 0, v21
    v_sub_f32 v26, 0, v21
    v_sub_f32 v27, 0, v21
    v_sub_f32 v28, 0, v21
    v_sub_f32 v29, 0, v21
    v_sub_f32 v30, 0, v21
    v_sub_f32 v31, 0, v21
    v_sub_f32 v32, 0, v21
    v_sub_f32 v33, 0, v21
    v_sub_f32 v34, 0, v21
    v_sub_f32 v35, 0, v21
    v_sub_f32 v36, 0, v21
    v_sub_f32 v37, 0, v21
    v_sub_f32 v38, 0, v21
    v_sub_f32 v39, 0, v21
    s_cmp_eq_u32 s99, 0
    s_cbranch_scc0 ng_12
    v_mov_b32 v24, 0xf149f2ca
    v_mov_b32 v25, 0xf149f2ca
    v_mov_b32 v26, 0xf149f2ca
    v_mov_b32 v27, 0xf149f2ca
    v_mov_b32 v28, 0xf149f2ca
    v_mov_b32 v29, 0xf149f2ca
    v_mov_b32 v30, 0xf149f2ca
    v_mov_b32 v31, 0xf149f2ca
    v_mov_b32 v32, 0xf149f2ca
    v_mov_b32 v33, 0xf149f2ca
    v_mov_b32 v34, 0xf149f2ca
    v_mov_b32 v35, 0xf149f2ca
    v_mov_b32 v36, 0xf149f2ca
    v_mov_b32 v37, 0xf149f2ca
    v_mov_b32 v38, 0xf149f2ca
    v_mov_b32 v39, 0xf149f2ca
ng_12:
    s_waitcnt lgkmcnt(4)
    s_nop 0
    v_mfma_f32_32x32x16_bf16 v[72:87], v[112:115], v[4:7], v[24:39]
    v_mfma_f32_32x32x16_bf16 v[72:87], v[116:119], v[8:11], v[72:87]
    ds_read_b128 v[104:107], v20 offset:24576
    ds_read_b128 v[108:111], v20 offset:25600
    v_sub_f32 v40, v40, v21
    v_sub_f32 v41, v41, v21
    v_sub_f32 v42, v42, v21
    v_sub_f32 v43, v43, v21
    v_sub_f32 v44, v44, v21
    v_sub_f32 v45, v45, v21
    v_sub_f32 v46, v46, v21
    v_sub_f32 v47, v47, v21
    v_sub_f32 v48, v48, v21
    v_sub_f32 v49, v49, v21
    v_sub_f32 v50, v50, v21
    v_sub_f32 v51, v51, v21
    v_sub_f32 v52, v52, v21
    v_sub_f32 v53, v53, v21
    v_sub_f32 v54, v54, v21
    v_sub_f32 v55, v55, v21
    v_exp_f32 v40, v40
    v_exp_f32 v41, v41
    v_exp_f32 v42, v42
    v_exp_f32 v43, v43
    v_exp_f32 v44, v44
    v_exp_f32 v45, v45
    v_exp_f32 v46, v46
    v_exp_f32 v47, v47
    v_exp_f32 v48, v48
    v_exp_f32 v49, v49
    v_exp_f32 v50, v50
    v_exp_f32 v51, v51
    v_exp_f32 v52, v52
    v_exp_f32 v53, v53
    v_exp_f32 v54, v54
    v_exp_f32 v55, v55
    v_add_f32 v22, v40, v41
    v_add_f32 v23, v42, v43
    v_add_f32 v22, v22, v44
    v_add_f32 v23, v23, v45
    v_add_f32 v22, v22, v46
    v_add_f32 v23, v23, v47
    v_add_f32 v22, v22, v48
    v_add_f32 v23, v23, v49
    v_add_f32 v22, v22, v50
    v_add_f32 v23, v23, v51
    v_add_f32 v22, v22, v52
    v_add_f32 v23, v23, v53
    v_add_f32 v22, v22, v54
    v_add_f32 v23, v23, v55
    v_cvt_pk_bf16_f32 v144, v40, v41
    v_cvt_pk_bf16_f32 v145, v42, v43
    v_cvt_pk_bf16_f32 v146, v44, v45
    v_cvt_pk_bf16_f32 v147, v46, v47
    v_cvt_pk_bf16_f32 v148, v48, v49
    v_cvt_pk_bf16_f32 v149, v50, v51
    v_cvt_pk_bf16_f32 v150, v52, v53
    v_cvt_pk_bf16_f32 v151, v54, v55
    v_and_b32 v136, v144, v12
    v_and_b32 v137, v145, v13
    v_and_b32 v138, v146, v14
    v_and_b32 v139, v147, v15
    v_and_b32 v140, v148, v16
    v_and_b32 v141, v149, v17
    v_and_b32 v142, v150, v18
    v_and_b32 v143, v151, v19
    v_xor_b32 v144, v144, v136
    v_xor_b32 v145, v145, v137
    v_xor_b32 v146, v146, v138
    v_xor_b32 v147, v147, v139
    v_xor_b32 v148, v148, v140
    v_xor_b32 v149, v149, v141
    v_xor_b32 v150, v150, v142
    v_xor_b32 v151, v151, v143
    s_waitcnt lgkmcnt(2)
    v_mfma_f32_32x32x16_bf16 v[88:103], v[120:123], v[136:139], 0
    v_mfma_f32_32x32x16_bf16 v[88:103], v[124:127], v[140:143], v[88:103]
    v_mfma_f32_32x32x16_bf16 v[88:103], v[128:131], v[144:147], v[88:103]
    v_mfma_f32_32x32x16_bf16 v[88:103], v[132:135], v[148:151], v[88:103]
    s_add_u32 s96, s25, 15
    s_and_b32 s96, s96, 15
    s_lshl_b32 s96, s96, 17
    s_add_u32 m0, s101, 61440
    s_nop 0
    buffer_load_dwordx4 v243, s[8:11], s96 offen lds
    ds_read_b128 v[128:131], v20 offset:30720
    ds_read_b128 v[132:135], v20 offset:31744
    s_cmp_eq_u32 s99, 1
    s_cbranch_scc0 ng_13
    v_mov_b32 v24, 0xf149f2ca
    v_mov_b32 v25, 0xf149f2ca
    v_mov_b32 v26, 0xf149f2ca
    v_mov_b32 v27, 0xf149f2ca
    v_mov_b32 v28, 0xf149f2ca
    v_mov_b32 v29, 0xf149f2ca
    v_mov_b32 v30, 0xf149f2ca
    v_mov_b32 v31, 0xf149f2ca
    v_mov_b32 v32, 0xf149f2ca
    v_mov_b32 v33, 0xf149f2ca
    v_mov_b32 v34, 0xf149f2ca
    v_mov_b32 v35, 0xf149f2ca
    v_mov_b32 v36, 0xf149f2ca
    v_mov_b32 v37, 0xf149f2ca
    v_mov_b32 v38, 0xf149f2ca
    v_mov_b32 v39, 0xf149f2ca
ng_13:
    s_waitcnt lgkmcnt(2)
    s_nop 0
    v_mfma_f32_32x32x16_bf16 v[56:71], v[104:107], v[4:7], v[24:39]
    v_mfma_f32_32x32x16_bf16 v[56:71], v[108:111], v[8:11], v[56:71]
    ds_read_b128 v[112:115], v20 offset:20480
    ds_read_b128 v[116:119], v20 offset:21504
    v_exp_f32 v72, v72
    v_exp_f32 v73, v73
    v_exp_f32 v74, v74
    v_exp_f32 v75, v75
    v_exp_f32 v76, v76
    v_exp_f32 v77, v77
    v_exp_f32 v78, v78
    v_exp_f32 v79, v79
    v_exp_f32 v80, v80
    v_exp_f32 v81, v81
    v_exp_f32 v82, v82
    v_exp_f32 v83, v83
    v_exp_f32 v84, v84
    v_exp_f32 v85, v85
    v_exp_f32 v86, v86
    v_exp_f32 v87, v87
    v_add_f32 v22, v22, v72
    v_add_f32 v23, v23, v73
    v_add_f32 v22, v22, v74
    v_add_f32 v23, v23, v75
    v_add_f32 v22, v22, v76
    v_add_f32 v23, v23, v77
    v_add_f32 v22, v22, v78
    v_add_f32 v23, v23, v79
    v_add_f32 v22, v22, v80
    v_add_f32 v23, v23, v81
    v_add_f32 v22, v22, v82
    v_add_f32 v23, v23, v83
    v_add_f32 v22, v22, v84
    v_add_f32 v23, v23, v85
    v_add_f32 v22, v22, v86
    v_add_f32 v23, v23, v87
    v_cvt_pk_bf16_f32 v144, v72, v73
    v_cvt_pk_bf16_f32 v145, v74, v75
    v_cvt_pk_bf16_f32 v146, v76, v77
    v_cvt_pk_bf16_f32 v147, v78, v79
    v_cvt_pk_bf16_f32 v148, v80, v81
    v_cvt_pk_bf16_f32 v149, v82, v83
    v_cvt_pk_bf16_f32 v150, v84, v85
    v_cvt_pk_bf16_f32 v151, v86, v87
    s_waitcnt lgkmcnt(2)
    v_mfma_f32_32x32x16_bf16 v[88:103], v[128:131], v[144:147], v[88:103]
    v_mfma_f32_32x32x16_bf16 v[88:103], v[132:135], v[148:151], v[88:103]
    ds_read_b128 v[120:123], v20 offset:26624
    ds_read_b128 v[124:127], v20 offset:27648
    s_cmp_eq_u32 s99, 2
    s_cbranch_scc0 ng_14
    v_mov_b32 v24, 0xf149f2ca
    v_mov_b32 v25, 0xf149f2ca
    v_mov_b32 v26, 0xf149f2ca
    v_mov_b32 v27, 0xf149f2ca
    v_mov_b32 v28, 0xf149f2ca
    v_mov_b32 v29, 0xf149f2ca
    v_mov_b32 v30, 0xf149f2ca
    v_mov_b32 v31, 0xf149f2ca
    v_mov_b32 v32, 0xf149f2ca
    v_mov_b32 v33, 0xf149f2ca
    v_mov_b32 v34, 0xf149f2ca
    v_mov_b32 v35, 0xf149f2ca
    v_mov_b32 v36, 0xf149f2ca
    v_mov_b32 v37, 0xf149f2ca
    v_mov_b32 v38, 0xf149f2ca
    v_mov_b32 v39, 0xf149f2ca
ng_14:
    s_waitcnt lgkmcnt(2)
    s_nop 0
    v_mfma_f32_32x32x16_bf16 v[72:87], v[112:115], v[4:7], v[24:39]
    v_mfma_f32_32x32x16_bf16 v[72:87], v[116:119], v[8:11], v[72:87]
    ds_read_b128 v[104:107], v20 offset:16384
    ds_read_b128 v[108:111], v20 offset:17408
    v_exp_f32 v56, v56
    v_exp_f32 v57, v57
    v_exp_f32 v58, v58
    v_exp_f32 v59, v59
    v_exp_f32 v60, v60
    v_exp_f32 v61, v61
    v_exp_f32 v62, v62
    v_exp_f32 v63, v63
    v_exp_f32 v64, v64
    v_exp_f32 v65, v65
    v_exp_f32 v66, v66
    v_exp_f32 v67, v67
    v_exp_f32 v68, v68
    v_exp_f32 v69, v69
    v_exp_f32 v70, v70
    v_exp_f32 v71, v71
    v_add_f32 v22, v22, v56
    v_add_f32 v23, v23, v57
    v_add_f32 v22, v22, v58
    v_add_f32 v23, v23, v59
    v_add_f32 v22, v22, v60
    v_add_f32 v23, v23, v61
    v_add_f32 v22, v22, v62
    v_add_f32 v23, v23, v63
    v_add_f32 v22, v22, v64
    v_add_f32 v23, v23, v65
    v_add_f32 v22, v22, v66
    v_add_f32 v23, v23, v67
    v_add_f32 v22, v22, v68
    v_add_f32 v23, v23, v69
    v_add_f32 v22, v22, v70
    v_add_f32 v23, v23, v71
    v_cvt_pk_bf16_f32 v136, v56, v57
    v_cvt_pk_bf16_f32 v137, v58, v59
    v_cvt_pk_bf16_f32 v138, v60, v61
    v_cvt_pk_bf16_f32 v139, v62, v63
    v_cvt_pk_bf16_f32 v140, v64, v65
    v_cvt_pk_bf16_f32 v141, v66, v67
    v_cvt_pk_bf16_f32 v142, v68, v69
    v_cvt_pk_bf16_f32 v143, v70, v71
    s_waitcnt lgkmcnt(2)
    v_mfma_f32_32x32x16_bf16 v[88:103], v[120:123], v[136:139], v[88:103]
    v_mfma_f32_32x32x16_bf16 v[88:103], v[124:127], v[140:143], v[88:103]
    ds_read_b128 v[128:131], v20 offset:22528
    ds_read_b128 v[132:135], v20 offset:23552
    s_cmp_eq_u32 s99, 3
    s_cbranch_scc0 ng_15
    v_mov_b32 v24, 0xf149f2ca
    v_mov_b32 v25, 0xf149f2ca
    v_mov_b32 v26, 0xf149f2ca
    v_mov_b32 v27, 0xf149f2ca
    v_mov_b32 v28, 0xf149f2ca
    v_mov_b32 v29, 0xf149f2ca
    v_mov_b32 v30, 0xf149f2ca
    v_mov_b32 v31, 0xf149f2ca
    v_mov_b32 v32, 0xf149f2ca
    v_mov_b32 v33, 0xf149f2ca
    v_mov_b32 v34, 0xf149f2ca
    v_mov_b32 v35, 0xf149f2ca
    v_mov_b32 v36, 0xf149f2ca
    v_mov_b32 v37, 0xf149f2ca
    v_mov_b32 v38, 0xf149f2ca
    v_mov_b32 v39, 0xf149f2ca
ng_15:
    s_waitcnt lgkmcnt(2)
    s_nop 0
    v_mfma_f32_32x32x16_bf16 v[56:71], v[104:107], v[4:7], v[24:39]
    v_mfma_f32_32x32x16_bf16 v[56:71], v[108:111], v[8:11], v[56:71]
    ds_read_b128 v[112:115], v20 offset:12288
    ds_read_b128 v[116:119], v20 offset:13312
    v_exp_f32 v72, v72
    v_exp_f32 v73, v73
    v_exp_f32 v74, v74
    v_exp_f32 v75, v75
    v_exp_f32 v76, v76
    v_exp_f32 v77, v77
    v_exp_f32 v78, v78
    v_exp_f32 v79, v79
    v_exp_f32 v80, v80
    v_exp_f32 v81, v81
    v_exp_f32 v82, v82
    v_exp_f32 v83, v83
    v_exp_f32 v84, v84
    v_exp_f32 v85, v85
    v_exp_f32 v86, v86
    v_exp_f32 v87, v87
    v_add_f32 v22, v22, v72
    v_add_f32 v23, v23, v73
    v_add_f32 v22, v22, v74
    v_add_f32 v23, v23, v75
    v_add_f32 v22, v22, v76
    v_add_f32 v23, v23, v77
    v_add_f32 v22, v22, v78
    v_add_f32 v23, v23, v79
    v_add_f32 v22, v22, v80
    v_add_f32 v23, v23, v81
    v_add_f32 v22, v22, v82
    v_add_f32 v23, v23, v83
    v_add_f32 v22, v22, v84
    v_add_f32 v23, v23, v85
    v_add_f32 v22, v22, v86
    v_add_f32 v23, v23, v87
    v_cvt_pk_bf16_f32 v144, v72, v73
    v_cvt_pk_bf16_f32 v145, v74, v75
    v_cvt_pk_bf16_f32 v146, v76, v77
    v_cvt_pk_bf16_f32 v147, v78, v79
    v_cvt_pk_bf16_f32 v148, v80, v81
    v_cvt_pk_bf16_f32 v149, v82, v83
    v_cvt_pk_bf16_f32 v150, v84, v85
    v_cvt_pk_bf16_f32 v151, v86, v87
    s_waitcnt lgkmcnt(2)
    v_mfma_f32_32x32x16_bf16 v[88:103], v[128:131], v[144:147], v[88:103]
    v_mfma_f32_32x32x16_bf16 v[88:103], v[132:135], v[148:151], v[88:103]
    ds_read_b128 v[120:123], v20 offset:18432
    ds_read_b128 v[124:127], v20 offset:19456
    s_cmp_eq_u32 s99, 4
    s_cbranch_scc0 ng_16
    v_mov_b32 v24, 0xf149f2ca
    v_mov_b32 v25, 0xf149f2ca
    v_mov_b32 v26, 0xf149f2ca
    v_mov_b32 v27, 0xf149f2ca
    v_mov_b32 v28, 0xf149f2ca
    v_mov_b32 v29, 0xf149f2ca
    v_mov_b32 v30, 0xf149f2ca
    v_mov_b32 v31, 0xf149f2ca
    v_mov_b32 v32, 0xf149f2ca
    v_mov_b32 v33, 0xf149f2ca
    v_mov_b32 v34, 0xf149f2ca
    v_mov_b32 v35, 0xf149f2ca
    v_mov_b32 v36, 0xf149f2ca
    v_mov_b32 v37, 0xf149f2ca
    v_mov_b32 v38, 0xf149f2ca
    v_mov_b32 v39, 0xf149f2ca
ng_16:
    s_waitcnt lgkmcnt(2)
    s_nop 0
    v_mfma_f32_32x32x16_bf16 v[72:87], v[112:115], v[4:7], v[24:39]
    v_mfma_f32_32x32x16_bf16 v[72:87], v[116:119], v[8:11], v[72:87]
    ds_read_b128 v[104:107], v20 offset:8192
    ds_read_b128 v[108:111], v20 offset:9216
    v_exp_f32 v56, v56
    v_exp_f32 v57, v57
    v_exp_f32 v58, v58
    v_exp_f32 v59, v59
    v_exp_f32 v60, v60
    v_exp_f32 v61, v61
    v_exp_f32 v62, v62
    v_exp_f32 v63, v63
    v_exp_f32 v64, v64
    v_exp_f32 v65, v65
    v_exp_f32 v66, v66
    v_exp_f32 v67, v67
    v_exp_f32 v68, v68
    v_exp_f32 v69, v69
    v_exp_f32 v70, v70
    v_exp_f32 v71, v71
    v_add_f32 v22, v22, v56
    v_add_f32 v23, v23, v57
    v_add_f32 v22, v22, v58
    v_add_f32 v23, v23, v59
    v_add_f32 v22, v22, v60
    v_add_f32 v23, v23, v61
    v_add_f32 v22, v22, v62
    v_add_f32 v23, v23, v63
    v_add_f32 v22, v22, v64
    v_add_f32 v23, v23, v65
    v_add_f32 v22, v22, v66
    v_add_f32 v23, v23, v67
    v_add_f32 v22, v22, v68
    v_add_f32 v23, v23, v69
    v_add_f32 v22, v22, v70
    v_add_f32 v23, v23, v71
    v_cvt_pk_bf16_f32 v136, v56, v57
    v_cvt_pk_bf16_f32 v137, v58, v59
    v_cvt_pk_bf16_f32 v138, v60, v61
    v_cvt_pk_bf16_f32 v139, v62, v63
    v_cvt_pk_bf16_f32 v140, v64, v65
    v_cvt_pk_bf16_f32 v141, v66, v67
    v_cvt_pk_bf16_f32 v142, v68, v69
    v_cvt_pk_bf16_f32 v143, v70, v71
    s_waitcnt lgkmcnt(2)
    v_mfma_f32_32x32x16_bf16 v[88:103], v[120:123], v[136:139], v[88:103]
    v_mfma_f32_32x32x16_bf16 v[88:103], v[124:127], v[140:143], v[88:103]
    ds_read_b128 v[128:131], v20 offset:14336
    ds_read_b128 v[132:135], v20 offset:15360
    s_cmp_eq_u32 s99, 5
    s_cbranch_scc0 ng_17
    v_mov_b32 v24, 0xf149f2ca
    v_mov_b32 v25, 0xf149f2ca
    v_mov_b32 v26, 0xf149f2ca
    v_mov_b32 v27, 0xf149f2ca
    v_mov_b32 v28, 0xf149f2ca
    v_mov_b32 v29, 0xf149f2ca
    v_mov_b32 v30, 0xf149f2ca
    v_mov_b32 v31, 0xf149f2ca
    v_mov_b32 v32, 0xf149f2ca
    v_mov_b32 v33, 0xf149f2ca
    v_mov_b32 v34, 0xf149f2ca
    v_mov_b32 v35, 0xf149f2ca
    v_mov_b32 v36, 0xf149f2ca
    v_mov_b32 v37, 0xf149f2ca
    v_mov_b32 v38, 0xf149f2ca
    v_mov_b32 v39, 0xf149f2ca
ng_17:
    s_waitcnt lgkmcnt(2)
    s_nop 0
    v_mfma_f32_32x32x16_bf16 v[56:71], v[104:107], v[4:7], v[24:39]
    v_mfma_f32_32x32x16_bf16 v[56:71], v[108:111], v[8:11], v[56:71]
    ds_read_b128 v[112:115], v20 offset:4096
    ds_read_b128 v[116:119], v20 offset:5120
    v_exp_f32 v72, v72
    v_exp_f32 v73, v73
    v_exp_f32 v74, v74
    v_exp_f32 v75, v75
    v_exp_f32 v76, v76
    v_exp_f32 v77, v77
    v_exp_f32 v78, v78
    v_exp_f32 v79, v79
    v_exp_f32 v80, v80
    v_exp_f32 v81, v81
    v_exp_f32 v82, v82
    v_exp_f32 v83, v83
    v_exp_f32 v84, v84
    v_exp_f32 v85, v85
    v_exp_f32 v86, v86
    v_exp_f32 v87, v87
    v_add_f32 v22, v22, v72
    v_add_f32 v23, v23, v73
    v_add_f32 v22, v22, v74
    v_add_f32 v23, v23, v75
    v_add_f32 v22, v22, v76
    v_add_f32 v23, v23, v77
    v_add_f32 v22, v22, v78
    v_add_f32 v23, v23, v79
    v_add_f32 v22, v22, v80
    v_add_f32 v23, v23, v81
    v_add_f32 v22, v22, v82
    v_add_f32 v23, v23, v83
    v_add_f32 v22, v22, v84
    v_add_f32 v23, v23, v85
    v_add_f32 v22, v22, v86
    v_add_f32 v23, v23, v87
    v_cvt_pk_bf16_f32 v144, v72, v73
    v_cvt_pk_bf16_f32 v145, v74, v75
    v_cvt_pk_bf16_f32 v146, v76, v77
    v_cvt_pk_bf16_f32 v147, v78, v79
    v_cvt_pk_bf16_f32 v148, v80, v81
    v_cvt_pk_bf16_f32 v149, v82, v83
    v_cvt_pk_bf16_f32 v150, v84, v85
    v_cvt_pk_bf16_f32 v151, v86, v87
    s_waitcnt lgkmcnt(2)
    v_mfma_f32_32x32x16_bf16 v[88:103], v[128:131], v[144:147], v[88:103]
    v_mfma_f32_32x32x16_bf16 v[88:103], v[132:135], v[148:151], v[88:103]
    ds_read_b128 v[120:123], v20 offset:10240
    ds_read_b128 v[124:127], v20 offset:11264
    s_cmp_eq_u32 s99, 6
    s_cbranch_scc0 ng_18
    v_mov_b32 v24, 0xf149f2ca
    v_mov_b32 v25, 0xf149f2ca
    v_mov_b32 v26, 0xf149f2ca
    v_mov_b32 v27, 0xf149f2ca
    v_mov_b32 v28, 0xf149f2ca
    v_mov_b32 v29, 0xf149f2ca
    v_mov_b32 v30, 0xf149f2ca
    v_mov_b32 v31, 0xf149f2ca
    v_mov_b32 v32, 0xf149f2ca
    v_mov_b32 v33, 0xf149f2ca
    v_mov_b32 v34, 0xf149f2ca
    v_mov_b32 v35, 0xf149f2ca
    v_mov_b32 v36, 0xf149f2ca
    v_mov_b32 v37, 0xf149f2ca
    v_mov_b32 v38, 0xf149f2ca
    v_mov_b32 v39, 0xf149f2ca
ng_18:
    s_waitcnt lgkmcnt(2)
    s_nop 0
    v_mfma_f32_32x32x16_bf16 v[72:87], v[112:115], v[4:7], v[24:39]
    v_mfma_f32_32x32x16_bf16 v[72:87], v[116:119], v[8:11], v[72:87]
    v_exp_f32 v56, v56
    v_exp_f32 v57, v57
    v_exp_f32 v58, v58
    v_exp_f32 v59, v59
    v_exp_f32 v60, v60
    v_exp_f32 v61, v61
    v_exp_f32 v62, v62
    v_exp_f32 v63, v63
    v_exp_f32 v64, v64
    v_exp_f32 v65, v65
    v_exp_f32 v66, v66
    v_exp_f32 v67, v67
    v_exp_f32 v68, v68
    v_exp_f32 v69, v69
    v_exp_f32 v70, v70
    v_exp_f32 v71, v71
    v_add_f32 v22, v22, v56
    v_add_f32 v23, v23, v57
    v_add_f32 v22, v22, v58
    v_add_f32 v23, v23, v59
    v_add_f32 v22, v22, v60
    v_add_f32 v23, v23, v61
    v_add_f32 v22, v22, v62
    v_add_f32 v23, v23, v63
    v_add_f32 v22, v22, v64
    v_add_f32 v23, v23, v65
    v_add_f32 v22, v22, v66
    v_add_f32 v23, v23, v67
    v_add_f32 v22, v22, v68
    v_add_f32 v23, v23, v69
    v_add_f32 v22, v22, v70
    v_add_f32 v23, v23, v71
    v_cvt_pk_bf16_f32 v136, v56, v57
    v_cvt_pk_bf16_f32 v137, v58, v59
    v_cvt_pk_bf16_f32 v138, v60, v61
    v_cvt_pk_bf16_f32 v139, v62, v63
    v_cvt_pk_bf16_f32 v140, v64, v65
    v_cvt_pk_bf16_f32 v141, v66, v67
    v_cvt_pk_bf16_f32 v142, v68, v69
    v_cvt_pk_bf16_f32 v143, v70, v71
    s_waitcnt lgkmcnt(0)
    v_mfma_f32_32x32x16_bf16 v[88:103], v[120:123], v[136:139], v[88:103]
    v_mfma_f32_32x32x16_bf16 v[88:103], v[124:127], v[140:143], v[88:103]
    ds_read_b128 v[128:131], v20 offset:6144
    ds_read_b128 v[132:135], v20 offset:7168
    v_exp_f32 v72, v72
    v_exp_f32 v73, v73
    v_exp_f32 v74, v74
    v_exp_f32 v75, v75
    v_exp_f32 v76, v76
    v_exp_f32 v77, v77
    v_exp_f32 v78, v78
    v_exp_f32 v79, v79
    v_exp_f32 v80, v80
    v_exp_f32 v81, v81
    v_exp_f32 v82, v82
    v_exp_f32 v83, v83
    v_exp_f32 v84, v84
    v_exp_f32 v85, v85
    v_exp_f32 v86, v86
    v_exp_f32 v87, v87
    v_add_f32 v22, v22, v72
    v_add_f32 v23, v23, v73
    v_add_f32 v22, v22, v74
    v_add_f32 v23, v23, v75
    v_add_f32 v22, v22, v76
    v_add_f32 v23, v23, v77
    v_add_f32 v22, v22, v78
    v_add_f32 v23, v23, v79
    v_add_f32 v22, v22, v80
    v_add_f32 v23, v23, v81
    v_add_f32 v22, v22, v82
    v_add_f32 v23, v23, v83
    v_add_f32 v22, v22, v84
    v_add_f32 v23, v23, v85
    v_add_f32 v22, v22, v86
    v_add_f32 v23, v23, v87
    v_cvt_pk_bf16_f32 v144, v72, v73
    v_cvt_pk_bf16_f32 v145, v74, v75
    v_cvt_pk_bf16_f32 v146, v76, v77
    v_cvt_pk_bf16_f32 v147, v78, v79
    v_cvt_pk_bf16_f32 v148, v80, v81
    v_cvt_pk_bf16_f32 v149, v82, v83
    v_cvt_pk_bf16_f32 v150, v84, v85
    v_cvt_pk_bf16_f32 v151, v86, v87
    s_waitcnt lgkmcnt(0)
    v_mfma_f32_32x32x16_bf16 v[88:103], v[128:131], v[144:147], v[88:103]
    v_mfma_f32_32x32x16_bf16 v[88:103], v[132:135], v[148:151], v[88:103]
    v_add_f32 v22, v22, v23
    v_mov_b32 v152, v22
    s_nop 1
    v_permlane32_swap_b32 v22, v152
    v_add_f32 v22, v22, v152
    v_rcp_f32 v22, v22
    s_lshl_b32 s36, s99, 16
    s_add_u32 s36, s36, s26
    s_add_u32 s36, s36, 0x800000
    s_lshl_b32 s33, s25, 11
    s_add_u32 s33, s33, s36
    s_lshl_b32 s30, s24, 9
    s_lshl_b32 s31, s3, 6
    s_add_u32 s30, s30, s31
    s_add_u32 s30, s30, s26
    s_add_u32 s30, s30, 0xdd2000
    s_lshl_b32 s31, s25, 2
    s_add_u32 s31, s31, s30
    v_pk_mul_f32 v[88:89], v[88:89], v[22:23] op_sel_hi:[1,0]
    v_pk_mul_f32 v[90:91], v[90:91], v[22:23] op_sel_hi:[1,0]
    v_pk_mul_f32 v[92:93], v[92:93], v[22:23] op_sel_hi:[1,0]
    v_pk_mul_f32 v[94:95], v[94:95], v[22:23] op_sel_hi:[1,0]
    v_pk_mul_f32 v[96:97], v[96:97], v[22:23] op_sel_hi:[1,0]
    v_pk_mul_f32 v[98:99], v[98:99], v[22:23] op_sel_hi:[1,0]
    v_pk_mul_f32 v[100:101], v[100:101], v[22:23] op_sel_hi:[1,0]
    v_pk_mul_f32 v[102:103], v[102:103], v[22:23] op_sel_hi:[1,0]
    v_cvt_pk_bf16_f32 v88, v88, v89
    v_cvt_pk_bf16_f32 v89, v90, v91
    v_cvt_pk_bf16_f32 v90, v92, v93
    v_cvt_pk_bf16_f32 v91, v94, v95
    v_cvt_pk_bf16_f32 v92, v96, v97
    v_cvt_pk_bf16_f32 v93, v98, v99
    v_cvt_pk_bf16_f32 v94, v100, v101
    v_cvt_pk_bf16_f32 v95, v102, v103
    s_cmp_lg_u32 s77, 0
    s_cbranch_scc1 lc_19
    buffer_store_dwordx4 v[88:91], v253, s[20:23], s33 offen sc1
    buffer_store_dwordx4 v[92:95], v253, s[20:23], s33 offen offset:1024 sc1
    s_branch lc_20
lc_19:
    buffer_store_dwordx4 v[88:91], v253, s[20:23], s33 offen
    buffer_store_dwordx4 v[92:95], v253, s[20:23], s33 offen offset:1024
lc_20:
    v_bfe_u32 v33, v252, 2, 2
    v_lshrrev_b32 v32, 5, v252
    v_lshl_add_u32 v34, v32, 3, v33
    v_lshlrev_b32 v34, 7, v34
    v_lshrrev_b32 v33, 1, v33
    v_lshl_add_u32 v34, v33, 6, v34
    v_bfe_u32 v33, v252, 4, 1
    v_lshl_add_u32 v34, v33, 5, v34
    v_and_b32 v33, 3, v252
    v_lshl_add_u32 v56, v33, 3, v34
    v_xor_b32 v57, 64, v56
    v_add_u32 v58, 0x10000, v56
    v_add_u32 v59, 0x10000, v57
    v_and_b32 v60, 15, v252
    v_lshlrev_b32 v60, 2, v60
    s_waitcnt vmcnt(2)
    v_lshlrev_b32 v0, 16, v208
    v_and_b32 v1, 0xffff0000, v208
    v_lshlrev_b32 v2, 16, v209
    v_and_b32 v3, 0xffff0000, v209
    v_lshlrev_b32 v4, 16, v210
    v_and_b32 v5, 0xffff0000, v210
    v_lshlrev_b32 v6, 16, v211
    v_and_b32 v7, 0xffff0000, v211
    v_lshlrev_b32 v8, 16, v212
    v_and_b32 v9, 0xffff0000, v212
    v_lshlrev_b32 v10, 16, v213
    v_and_b32 v11, 0xffff0000, v213
    v_lshlrev_b32 v12, 16, v214
    v_and_b32 v13, 0xffff0000, v214
    v_lshlrev_b32 v14, 16, v215
    v_and_b32 v15, 0xffff0000, v215
    v_lshlrev_b32 v16, 16, v216
    v_and_b32 v17, 0xffff0000, v216
    v_lshlrev_b32 v18, 16, v217
    v_and_b32 v19, 0xffff0000, v217
    v_lshlrev_b32 v20, 16, v218
    v_and_b32 v21, 0xffff0000, v218
    v_lshlrev_b32 v22, 16, v219
    v_and_b32 v23, 0xffff0000, v219
    v_lshlrev_b32 v24, 16, v220
    v_and_b32 v25, 0xffff0000, v220
    v_lshlrev_b32 v26, 16, v221
    v_and_b32 v27, 0xffff0000, v221
    v_lshlrev_b32 v28, 16, v222
    v_and_b32 v29, 0xffff0000, v222
    v_lshlrev_b32 v30, 16, v223
    v_and_b32 v31, 0xffff0000, v223
    v_pk_fma_f32 v[0:1], v[0:1], v[240:241], v[240:241] op_sel:[0,0,1] op_sel_hi:[1,0,1]
    v_pk_fma_f32 v[2:3], v[2:3], v[240:241], v[240:241] op_sel:[0,0,1] op_sel_hi:[1,0,1]
    v_pk_fma_f32 v[4:5], v[4:5], v[240:241], v[240:241] op_sel:[0,0,1] op_sel_hi:[1,0,1]
    v_pk_fma_f32 v[6:7], v[6:7], v[240:241], v[240:241] op_sel:[0,0,1] op_sel_hi:[1,0,1]
    v_pk_fma_f32 v[8:9], v[8:9], v[240:241], v[240:241] op_sel:[0,0,1] op_sel_hi:[1,0,1]
    v_pk_fma_f32 v[10:11], v[10:11], v[240:241], v[240:241] op_sel:[0,0,1] op_sel_hi:[1,0,1]
    v_pk_fma_f32 v[12:13], v[12:13], v[240:241], v[240:241] op_sel:[0,0,1] op_sel_hi:[1,0,1]
    v_pk_fma_f32 v[14:15], v[14:15], v[240:241], v[240:241] op_sel:[0,0,1] op_sel_hi:[1,0,1]
    v_pk_fma_f32 v[16:17], v[16:17], v[240:241], v[240:241] op_sel:[0,0,1] op_sel_hi:[1,0,1]
    v_pk_fma_f32 v[18:19], v[18:19], v[240:241], v[240:241] op_sel:[0,0,1] op_sel_hi:[1,0,1]
    v_pk_fma_f32 v[20:21], v[20:21], v[240:241], v[240:241] op_sel:[0,0,1] op_sel_hi:[1,0,1]
    v_pk_fma_f32 v[22:23], v[22:23], v[240:241], v[240:241] op_sel:[0,0,1] op_sel_hi:[1,0,1]
    v_pk_fma_f32 v[24:25], v[24:25], v[240:241], v[240:241] op_sel:[0,0,1] op_sel_hi:[1,0,1]
    v_pk_fma_f32 v[26:27], v[26:27], v[240:241], v[240:241] op_sel:[0,0,1] op_sel_hi:[1,0,1]
    v_pk_fma_f32 v[28:29], v[28:29], v[240:241], v[240:241] op_sel:[0,0,1] op_sel_hi:[1,0,1]
    v_pk_fma_f32 v[30:31], v[30:31], v[240:241], v[240:241] op_sel:[0,0,1] op_sel_hi:[1,0,1]
    v_mov_b32 v154, s88
    s_mov_b64 exec, 1
    s_waitcnt vmcnt(0)
    s_cmp_lg_u32 s77, 0
    s_cbranch_scc1 lc_21
    buffer_store_dword v154, v253, s[20:23], s31 offen sc1
    s_branch lc_22
lc_21:
    buffer_store_dword v154, v253, s[20:23], s31 offen
lc_22:
    s_mov_b64 exec, -1
    s_barrier
    s_add_u32 s96, s25, 0
    s_and_b32 s96, s96, 15
    s_lshl_b32 s96, s96, 17
    s_add_u32 s96, s96, 65536
    s_add_u32 m0, s101, 65536
    s_nop 0
    buffer_load_dwordx4 v243, s[8:11], s96 offen lds
    s_add_u32 s96, s25, 1
    s_and_b32 s96, s96, 15
    s_lshl_b32 s96, s96, 17
    s_add_u32 s96, s96, 65536
    s_add_u32 m0, s101, 69632
    s_nop 0
    buffer_load_dwordx4 v243, s[8:11], s96 offen lds
    s_add_u32 s96, s25, 2
    s_and_b32 s96, s96, 15
    s_lshl_b32 s96, s96, 17
    s_add_u32 s96, s96, 65536
    s_add_u32 m0, s101, 73728
    s_nop 0
    buffer_load_dwordx4 v243, s[8:11], s96 offen lds
    s_add_u32 s96, s25, 3
    s_and_b32 s96, s96, 15
    s_lshl_b32 s96, s96, 17
    s_add_u32 s96, s96, 65536
    s_add_u32 m0, s101, 77824
    s_nop 0
    buffer_load_dwordx4 v243, s[8:11], s96 offen lds
    s_add_u32 s96, s25, 4
    s_and_b32 s96, s96, 15
    s_lshl_b32 s96, s96, 17
    s_add_u32 s96, s96, 65536
    s_add_u32 m0, s101, 81920
    s_nop 0
    buffer_load_dwordx4 v243, s[8:11], s96 offen lds
    s_add_u32 s96, s25, 5
    s_and_b32 s96, s96, 15
    s_lshl_b32 s96, s96, 17
    s_add_u32 s96, s96, 65536
    s_add_u32 m0, s101, 86016
    s_nop 0
    buffer_load_dwordx4 v243, s[8:11], s96 offen lds
    s_add_u32 s96, s25, 6
    s_and_b32 s96, s96, 15
    s_lshl_b32 s96, s96, 17
    s_add_u32 s96, s96, 65536
    s_add_u32 m0, s101, 90112
    s_nop 0
    buffer_load_dwordx4 v243, s[8:11], s96 offen lds
    s_add_u32 s96, s25, 7
    s_and_b32 s96, s96, 15
    s_lshl_b32 s96, s96, 17
    s_add_u32 s96, s96, 65536
    s_add_u32 m0, s101, 94208
    s_nop 0
    buffer_load_dwordx4 v243, s[8:11], s96 offen lds
    s_add_u32 s96, s25, 8
    s_and_b32 s96, s96, 15
    s_lshl_b32 s96, s96, 17
    s_add_u32 s96, s96, 65536
    s_add_u32 m0, s101, 98304
    s_nop 0
    buffer_load_dwordx4 v243, s[8:11], s96 offen lds
    s_add_u32 s96, s25, 9
    s_and_b32 s96, s96, 15
    s_lshl_b32 s96, s96, 17
    s_add_u32 s96, s96, 65536
    s_add_u32 m0, s101, 102400
    s_nop 0
    buffer_load_dwordx4 v243, s[8:11], s96 offen lds
    s_add_u32 s96, s25, 10
    s_and_b32 s96, s96, 15
    s_lshl_b32 s96, s96, 17
    s_add_u32 s96, s96, 65536
    s_add_u32 m0, s101, 106496
    s_nop 0
    buffer_load_dwordx4 v243, s[8:11], s96 offen lds
    s_add_u32 s96, s25, 11
    s_and_b32 s96, s96, 15
    s_lshl_b32 s96, s96, 17
    s_add_u32 s96, s96, 65536
    s_add_u32 m0, s101, 110592
    s_nop 0
    buffer_load_dwordx4 v243, s[8:11], s96 offen lds
    v_bfe_u32 v100, v252, 4, 1
    v_lshlrev_b32 v100, 11, v100
    v_lshrrev_b32 v101, 5, v252
    v_lshl_add_u32 v100, v101, 8, v100
    v_and_b32 v101, 15, v252
    v_lshl_add_u32 v100, v101, 4, v100
    s_lshl_b32 s34, s28, 12
    s_add_u32 s34, s34, 147456
    v_add_u32 v101, s34, v100
    s_lshl_b32 s37, s25, 11
    ds_read_b64_tr_b16 v[32:33], v56 offset:0
    ds_read_b64_tr_b16 v[34:35], v56 offset:512
    ds_read_b64_tr_b16 v[36:37], v57 offset:0
    ds_read_b64_tr_b16 v[38:39], v57 offset:512
    ds_read_b64_tr_b16 v[40:41], v56 offset:2048
    ds_read_b64_tr_b16 v[42:43], v56 offset:2560
    ds_read_b64_tr_b16 v[44:45], v57 offset:2048
    ds_read_b64_tr_b16 v[46:47], v57 offset:2560
    s_mov_b32 s78, s27
pl_23:
    buffer_load_dword v61, v60, s[20:23], s30 offen offset:0 sc1
    s_waitcnt vmcnt(0)
pc_24:
    v_cmp_ne_u32 vcc, s88, v61
    s_cbranch_vccz pd_25
    s_sub_u32 s78, s78, 1
    s_cmp_lg_u32 s78, 0
    s_cbranch_scc1 pl_23
    s_mov_b32 s27, 1
pd_25:
    s_add_u32 s38, s36, s37
    buffer_load_dwordx4 v[104:107], v253, s[20:23], s38 offen offset:0 sc1
    s_add_u32 s37, s37, 2048
    s_and_b32 s37, s37, 0x7800
    buffer_load_dwordx4 v[108:111], v253, s[20:23], s38 offen offset:1024 sc1
    s_add_u32 s38, s36, s37
    buffer_load_dwordx4 v[112:115], v253, s[20:23], s38 offen offset:0 sc1
    s_add_u32 s37, s37, 2048
    s_and_b32 s37, s37, 0x7800
    buffer_load_dwordx4 v[116:119], v253, s[20:23], s38 offen offset:1024 sc1
    s_add_u32 s38, s36, s37
    buffer_load_dwordx4 v[120:123], v253, s[20:23], s38 offen offset:0 sc1
    s_add_u32 s37, s37, 2048
    s_and_b32 s37, s37, 0x7800
    buffer_load_dwordx4 v[124:127], v253, s[20:23], s38 offen offset:1024 sc1
    s_add_u32 s38, s36, s37
    buffer_load_dwordx4 v[128:131], v253, s[20:23], s38 offen offset:0 sc1
    s_add_u32 s37, s37, 2048
    s_and_b32 s37, s37, 0x7800
    buffer_load_dwordx4 v[132:135], v253, s[20:23], s38 offen offset:1024 sc1
    s_waitcnt vmcnt(7) lgkmcnt(4)
    v_mfma_f32_32x32x16_bf16 v[0:15], v[32:35], v[104:107], v[0:15]
    s_add_u32 s38, s36, s37
    buffer_load_dwordx4 v[136:139], v253, s[20:23], s38 offen offset:0 sc1
    ds_read_b64_tr_b16 v[48:49], v56 offset:4096
    ds_read_b64_tr_b16 v[50:51], v56 offset:4608
    v_mfma_f32_32x32x16_bf16 v[16:31], v[36:39], v[104:107], v[16:31]
    ds_read_b64_tr_b16 v[52:53], v57 offset:4096
    ds_read_b64_tr_b16 v[54:55], v57 offset:4608
    s_waitcnt vmcnt(7) lgkmcnt(4)
    v_mfma_f32_32x32x16_bf16 v[0:15], v[40:43], v[108:111], v[0:15]
    s_add_u32 s37, s37, 2048
    s_and_b32 s37, s37, 0x7800
    buffer_load_dwordx4 v[104:107], v253, s[20:23], s38 offen offset:1024 sc1
    ds_read_b64_tr_b16 v[32:33], v56 offset:6144
    ds_read_b64_tr_b16 v[34:35], v56 offset:6656
    v_mfma_f32_32x32x16_bf16 v[16:31], v[44:47], v[108:111], v[16:31]
    ds_read_b64_tr_b16 v[36:37], v57 offset:6144
    ds_read_b64_tr_b16 v[38:39], v57 offset:6656
    s_waitcnt vmcnt(7) lgkmcnt(4)
    v_mfma_f32_32x32x16_bf16 v[0:15], v[48:51], v[112:115], v[0:15]
    s_add_u32 s38, s36, s37
    buffer_load_dwordx4 v[108:111], v253, s[20:23], s38 offen offset:0 sc1
    ds_read_b64_tr_b16 v[40:41], v56 offset:8192
    ds_read_b64_tr_b16 v[42:43], v56 offset:8704
    v_mfma_f32_32x32x16_bf16 v[16:31], v[52:55], v[112:115], v[16:31]
    ds_read_b64_tr_b16 v[44:45], v57 offset:8192
    ds_read_b64_tr_b16 v[46:47], v57 offset:8704
    s_waitcnt vmcnt(7) lgkmcnt(4)
    v_mfma_f32_32x32x16_bf16 v[0:15], v[32:35], v[116:119], v[0:15]
    s_add_u32 s37, s37, 2048
    s_and_b32 s37, s37, 0x7800
    buffer_load_dwordx4 v[112:115], v253, s[20:23], s38 offen offset:1024 sc1
    ds_read_b64_tr_b16 v[48:49], v56 offset:10240
    ds_read_b64_tr_b16 v[50:51], v56 offset:10752
    v_mfma_f32_32x32x16_bf16 v[16:31], v[36:39], v[116:119], v[16:31]
    ds_read_b64_tr_b16 v[52:53], v57 offset:10240
    ds_read_b64_tr_b16 v[54:55], v57 offset:10752
    s_waitcnt vmcnt(7) lgkmcnt(4)
    v_mfma_f32_32x32x16_bf16 v[0:15], v[40:43], v[120:123], v[0:15]
    s_add_u32 s38, s36, s37
    buffer_load_dwordx4 v[116:119], v253, s[20:23], s38 offen offset:0 sc1
    ds_read_b64_tr_b16 v[32:33], v56 offset:12288
    ds_read_b64_tr_b16 v[34:35], v56 offset:12800
    v_mfma_f32_32x32x16_bf16 v[16:31], v[44:47], v[120:123], v[16:31]
    ds_read_b64_tr_b16 v[36:37], v57 offset:12288
    ds_read_b64_tr_b16 v[38:39], v57 offset:12800
    s_waitcnt vmcnt(7) lgkmcnt(4)
    v_mfma_f32_32x32x16_bf16 v[0:15], v[48:51], v[124:127], v[0:15]
    s_add_u32 s37, s37, 2048
    s_and_b32 s37, s37, 0x7800
    buffer_load_dwordx4 v[120:123], v253, s[20:23], s38 offen offset:1024 sc1
    ds_read_b64_tr_b16 v[40:41], v56 offset:14336
    ds_read_b64_tr_b16 v[42:43], v56 offset:14848
    v_mfma_f32_32x32x16_bf16 v[16:31], v[52:55], v[124:127], v[16:31]
    ds_read_b64_tr_b16 v[44:45], v57 offset:14336
    ds_read_b64_tr_b16 v[46:47], v57 offset:14848
    s_waitcnt vmcnt(7) lgkmcnt(4)
    v_mfma_f32_32x32x16_bf16 v[0:15], v[32:35], v[128:131], v[0:15]
    s_add_u32 s38, s36, s37
    buffer_load_dwordx4 v[124:127], v253, s[20:23], s38 offen offset:0 sc1
    ds_read_b64_tr_b16 v[48:49], v56 offset:16384
    ds_read_b64_tr_b16 v[50:51], v56 offset:16896
    v_mfma_f32_32x32x16_bf16 v[16:31], v[36:39], v[128:131], v[16:31]
    ds_read_b64_tr_b16 v[52:53], v57 offset:16384
    ds_read_b64_tr_b16 v[54:55], v57 offset:16896
    s_waitcnt vmcnt(7) lgkmcnt(4)
    v_mfma_f32_32x32x16_bf16 v[0:15], v[40:43], v[132:135], v[0:15]
    s_add_u32 s37, s37, 2048
    s_and_b32 s37, s37, 0x7800
    buffer_load_dwordx4 v[128:131], v253, s[20:23], s38 offen offset:1024 sc1
    ds_read_b64_tr_b16 v[32:33], v56 offset:18432
    ds_read_b64_tr_b16 v[34:35], v56 offset:18944
    v_mfma_f32_32x32x16_bf16 v[16:31], v[44:47], v[132:135], v[16:31]
    ds_read_b64_tr_b16 v[36:37], v57 offset:18432
    ds_read_b64_tr_b16 v[38:39], v57 offset:18944
    s_waitcnt vmcnt(7) lgkmcnt(4)
    v_mfma_f32_32x32x16_bf16 v[0:15], v[48:51], v[136:139], v[0:15]
    s_add_u32 s38, s36, s37
    buffer_load_dwordx4 v[132:135], v253, s[20:23], s38 offen offset:0 sc1
    ds_read_b64_tr_b16 v[40:41], v56 offset:20480
    ds_read_b64_tr_b16 v[42:43], v56 offset:20992
    v_mfma_f32_32x32x16_bf16 v[16:31], v[52:55], v[136:139], v[16:31]
    ds_read_b64_tr_b16 v[44:45], v57 offset:20480
    ds_read_b64_tr_b16 v[46:47], v57 offset:20992
    s_waitcnt vmcnt(7) lgkmcnt(4)
    v_mfma_f32_32x32x16_bf16 v[0:15], v[32:35], v[104:107], v[0:15]
    s_add_u32 s37, s37, 2048
    s_and_b32 s37, s37, 0x7800
    buffer_load_dwordx4 v[136:139], v253, s[20:23], s38 offen offset:1024 sc1
    ds_read_b64_tr_b16 v[48:49], v56 offset:22528
    ds_read_b64_tr_b16 v[50:51], v56 offset:23040
    v_mfma_f32_32x32x16_bf16 v[16:31], v[36:39], v[104:107], v[16:31]
    ds_read_b64_tr_b16 v[52:53], v57 offset:22528
    ds_read_b64_tr_b16 v[54:55], v57 offset:23040
    s_waitcnt vmcnt(7) lgkmcnt(4)
    v_mfma_f32_32x32x16_bf16 v[0:15], v[40:43], v[108:111], v[0:15]
    s_add_u32 s38, s36, s37
    buffer_load_dwordx4 v[104:107], v253, s[20:23], s38 offen offset:0 sc1
    ds_read_b64_tr_b16 v[32:33], v56 offset:24576
    ds_read_b64_tr_b16 v[34:35], v56 offset:25088
    v_mfma_f32_32x32x16_bf16 v[16:31], v[44:47], v[108:111], v[16:31]
    ds_read_b64_tr_b16 v[36:37], v57 offset:24576
    ds_read_b64_tr_b16 v[38:39], v57 offset:25088
    s_waitcnt vmcnt(7) lgkmcnt(4)
    v_mfma_f32_32x32x16_bf16 v[0:15], v[48:51], v[112:115], v[0:15]
    s_add_u32 s37, s37, 2048
    s_and_b32 s37, s37, 0x7800
    buffer_load_dwordx4 v[108:111], v253, s[20:23], s38 offen offset:1024 sc1
    ds_read_b64_tr_b16 v[40:41], v56 offset:26624
    ds_read_b64_tr_b16 v[42:43], v56 offset:27136
    v_mfma_f32_32x32x16_bf16 v[16:31], v[52:55], v[112:115], v[16:31]
    ds_read_b64_tr_b16 v[44:45], v57 offset:26624
    ds_read_b64_tr_b16 v[46:47], v57 offset:27136
    s_waitcnt vmcnt(7) lgkmcnt(4)
    v_mfma_f32_32x32x16_bf16 v[0:15], v[32:35], v[116:119], v[0:15]
    s_add_u32 s38, s36, s37
    buffer_load_dwordx4 v[112:115], v253, s[20:23], s38 offen offset:0 sc1
    ds_read_b64_tr_b16 v[48:49], v56 offset:28672
    ds_read_b64_tr_b16 v[50:51], v56 offset:29184
    v_mfma_f32_32x32x16_bf16 v[16:31], v[36:39], v[116:119], v[16:31]
    ds_read_b64_tr_b16 v[52:53], v57 offset:28672
    ds_read_b64_tr_b16 v[54:55], v57 offset:29184
    s_waitcnt vmcnt(7) lgkmcnt(4)
    v_mfma_f32_32x32x16_bf16 v[0:15], v[40:43], v[120:123], v[0:15]
    s_add_u32 s37, s37, 2048
    s_and_b32 s37, s37, 0x7800
    buffer_load_dwordx4 v[116:119], v253, s[20:23], s38 offen offset:1024 sc1
    ds_read_b64_tr_b16 v[32:33], v56 offset:30720
    ds_read_b64_tr_b16 v[34:35], v56 offset:31232
    v_mfma_f32_32x32x16_bf16 v[16:31], v[44:47], v[120:123], v[16:31]
    ds_read_b64_tr_b16 v[36:37], v57 offset:30720
    ds_read_b64_tr_b16 v[38:39], v57 offset:31232
    s_waitcnt vmcnt(7) lgkmcnt(4)
    v_mfma_f32_32x32x16_bf16 v[0:15], v[48:51], v[124:127], v[0:15]
    s_add_u32 s38, s36, s37
    buffer_load_dwordx4 v[120:123], v253, s[20:23], s38 offen offset:0 sc1
    ds_read_b64_tr_b16 v[40:41], v56 offset:32768
    ds_read_b64_tr_b16 v[42:43], v56 offset:33280
    v_mfma_f32_32x32x16_bf16 v[16:31], v[52:55], v[124:127], v[16:31]
    ds_read_b64_tr_b16 v[44:45], v57 offset:32768
    ds_read_b64_tr_b16 v[46:47], v57 offset:33280
    s_waitcnt vmcnt(7) lgkmcnt(4)
    v_mfma_f32_32x32x16_bf16 v[0:15], v[32:35], v[128:131], v[0:15]
    s_add_u32 s37, s37, 2048
    s_and_b32 s37, s37, 0x7800
    buffer_load_dwordx4 v[124:127], v253, s[20:23], s38 offen offset:1024 sc1
    ds_read_b64_tr_b16 v[48:49], v56 offset:34816
    ds_read_b64_tr_b16 v[50:51], v56 offset:35328
    v_mfma_f32_32x32x16_bf16 v[16:31], v[36:39], v[128:131], v[16:31]
    ds_read_b64_tr_b16 v[52:53], v57 offset:34816
    ds_read_b64_tr_b16 v[54:55], v57 offset:35328
    s_waitcnt vmcnt(7) lgkmcnt(4)
    v_mfma_f32_32x32x16_bf16 v[0:15], v[40:43], v[132:135], v[0:15]
    s_add_u32 s38, s36, s37
    buffer_load_dwordx4 v[128:131], v253, s[20:23], s38 offen offset:0 sc1
    ds_read_b64_tr_b16 v[32:33], v56 offset:36864
    ds_read_b64_tr_b16 v[34:35], v56 offset:37376
    v_mfma_f32_32x32x16_bf16 v[16:31], v[44:47], v[132:135], v[16:31]
    ds_read_b64_tr_b16 v[36:37], v57 offset:36864
    ds_read_b64_tr_b16 v[38:39], v57 offset:37376
    s_waitcnt vmcnt(7) lgkmcnt(4)
    v_mfma_f32_32x32x16_bf16 v[0:15], v[48:51], v[136:139], v[0:15]
    s_add_u32 s37, s37, 2048
    s_and_b32 s37, s37, 0x7800
    buffer_load_dwordx4 v[132:135], v253, s[20:23], s38 offen offset:1024 sc1
    ds_read_b64_tr_b16 v[40:41], v56 offset:38912
    ds_read_b64_tr_b16 v[42:43], v56 offset:39424
    v_mfma_f32_32x32x16_bf16 v[16:31], v[52:55], v[136:139], v[16:31]
    ds_read_b64_tr_b16 v[44:45], v57 offset:38912
    ds_read_b64_tr_b16 v[46:47], v57 offset:39424
    s_waitcnt vmcnt(7) lgkmcnt(4)
    v_mfma_f32_32x32x16_bf16 v[0:15], v[32:35], v[104:107], v[0:15]
    s_add_u32 s38, s36, s37
    buffer_load_dwordx4 v[136:139], v253, s[20:23], s38 offen offset:0 sc1
    ds_read_b64_tr_b16 v[48:49], v56 offset:40960
    ds_read_b64_tr_b16 v[50:51], v56 offset:41472
    v_mfma_f32_32x32x16_bf16 v[16:31], v[36:39], v[104:107], v[16:31]
    ds_read_b64_tr_b16 v[52:53], v57 offset:40960
    ds_read_b64_tr_b16 v[54:55], v57 offset:41472
    s_waitcnt vmcnt(7) lgkmcnt(4)
    v_mfma_f32_32x32x16_bf16 v[0:15], v[40:43], v[108:111], v[0:15]
    s_add_u32 s37, s37, 2048
    s_and_b32 s37, s37, 0x7800
    buffer_load_dwordx4 v[104:107], v253, s[20:23], s38 offen offset:1024 sc1
    ds_read_b64_tr_b16 v[32:33], v56 offset:43008
    ds_read_b64_tr_b16 v[34:35], v56 offset:43520
    v_mfma_f32_32x32x16_bf16 v[16:31], v[44:47], v[108:111], v[16:31]
    ds_read_b64_tr_b16 v[36:37], v57 offset:43008
    ds_read_b64_tr_b16 v[38:39], v57 offset:43520
    s_waitcnt vmcnt(7) lgkmcnt(4)
    v_mfma_f32_32x32x16_bf16 v[0:15], v[48:51], v[112:115], v[0:15]
    buffer_load_dword v61, v60, s[20:23], s30 offen offset:256 sc1
    s_add_u32 s38, s36, s37
    buffer_load_dwordx4 v[108:111], v253, s[20:23], s38 offen offset:0 sc1
    ds_read_b64_tr_b16 v[40:41], v56 offset:45056
    ds_read_b64_tr_b16 v[42:43], v56 offset:45568
    v_mfma_f32_32x32x16_bf16 v[16:31], v[52:55], v[112:115], v[16:31]
    ds_read_b64_tr_b16 v[44:45], v57 offset:45056
    ds_read_b64_tr_b16 v[46:47], v57 offset:45568
    s_waitcnt vmcnt(8) lgkmcnt(4)
    v_mfma_f32_32x32x16_bf16 v[0:15], v[32:35], v[116:119], v[0:15]
    s_add_u32 s37, s37, 2048
    s_and_b32 s37, s37, 0x7800
    buffer_load_dwordx4 v[112:115], v253, s[20:23], s38 offen offset:1024 sc1
    ds_read_b64_tr_b16 v[48:49], v56 offset:47104
    ds_read_b64_tr_b16 v[50:51], v56 offset:47616
    v_mfma_f32_32x32x16_bf16 v[16:31], v[36:39], v[116:119], v[16:31]
    ds_read_b64_tr_b16 v[52:53], v57 offset:47104
    ds_read_b64_tr_b16 v[54:55], v57 offset:47616
    s_waitcnt vmcnt(8) lgkmcnt(4)
    v_mfma_f32_32x32x16_bf16 v[0:15], v[40:43], v[120:123], v[0:15]
    s_add_u32 s38, s36, s37
    buffer_load_dwordx4 v[116:119], v253, s[20:23], s38 offen offset:0 sc1
    ds_read_b64_tr_b16 v[32:33], v56 offset:49152
    ds_read_b64_tr_b16 v[34:35], v56 offset:49664
    v_mfma_f32_32x32x16_bf16 v[16:31], v[44:47], v[120:123], v[16:31]
    ds_read_b64_tr_b16 v[36:37], v57 offset:49152
    ds_read_b64_tr_b16 v[38:39], v57 offset:49664
    s_waitcnt vmcnt(8) lgkmcnt(4)
    v_mfma_f32_32x32x16_bf16 v[0:15], v[48:51], v[124:127], v[0:15]
    s_add_u32 s37, s37, 2048
    s_and_b32 s37, s37, 0x7800
    buffer_load_dwordx4 v[120:123], v253, s[20:23], s38 offen offset:1024 sc1
    ds_read_b64_tr_b16 v[40:41], v56 offset:51200
    ds_read_b64_tr_b16 v[42:43], v56 offset:51712
    v_mfma_f32_32x32x16_bf16 v[16:31], v[52:55], v[124:127], v[16:31]
    ds_read_b64_tr_b16 v[44:45], v57 offset:51200
    ds_read_b64_tr_b16 v[46:47], v57 offset:51712
    s_waitcnt vmcnt(8) lgkmcnt(4)
    v_mfma_f32_32x32x16_bf16 v[0:15], v[32:35], v[128:131], v[0:15]
    s_mov_b32 s78, s27
    s_waitcnt vmcnt(4)
    s_branch pc_27
pl_26:
    buffer_load_dword v61, v60, s[20:23], s30 offen offset:256 sc1
    s_waitcnt vmcnt(0)
pc_27:
    v_cmp_ne_u32 vcc, s88, v61
    s_cbranch_vccz pd_28
    s_sub_u32 s78, s78, 1
    s_cmp_lg_u32 s78, 0
    s_cbranch_scc1 pl_26
    s_mov_b32 s27, 1
pd_28:
    s_add_u32 s36, s36, 32768
    s_add_u32 s38, s36, s37
    buffer_load_dwordx4 v[124:127], v253, s[20:23], s38 offen offset:0 sc1
    ds_read_b64_tr_b16 v[48:49], v56 offset:53248
    ds_read_b64_tr_b16 v[50:51], v56 offset:53760
    v_mfma_f32_32x32x16_bf16 v[16:31], v[36:39], v[128:131], v[16:31]
    ds_read_b64_tr_b16 v[52:53], v57 offset:53248
    ds_read_b64_tr_b16 v[54:55], v57 offset:53760
    s_waitcnt vmcnt(8) lgkmcnt(4)
    v_mfma_f32_32x32x16_bf16 v[0:15], v[40:43], v[132:135], v[0:15]
    s_add_u32 s37, s37, 2048
    s_and_b32 s37, s37, 0x7800
    buffer_load_dwordx4 v[128:131], v253, s[20:23], s38 offen offset:1024 sc1
    ds_read_b64_tr_b16 v[32:33], v56 offset:55296
    ds_read_b64_tr_b16 v[34:35], v56 offset:55808
    v_mfma_f32_32x32x16_bf16 v[16:31], v[44:47], v[132:135], v[16:31]
    ds_read_b64_tr_b16 v[36:37], v57 offset:55296
    ds_read_b64_tr_b16 v[38:39], v57 offset:55808
    s_waitcnt vmcnt(8) lgkmcnt(4)
    v_mfma_f32_32x32x16_bf16 v[0:15], v[48:51], v[136:139], v[0:15]
    s_add_u32 s38, s36, s37
    buffer_load_dwordx4 v[132:135], v253, s[20:23], s38 offen offset:0 sc1
    ds_read_b64_tr_b16 v[40:41], v56 offset:57344
    ds_read_b64_tr_b16 v[42:43], v56 offset:57856
    v_mfma_f32_32x32x16_bf16 v[16:31], v[52:55], v[136:139], v[16:31]
    ds_read_b64_tr_b16 v[44:45], v57 offset:57344
    ds_read_b64_tr_b16 v[46:47], v57 offset:57856
    s_waitcnt vmcnt(8) lgkmcnt(4)
    v_mfma_f32_32x32x16_bf16 v[0:15], v[32:35], v[104:107], v[0:15]
    s_add_u32 s37, s37, 2048
    s_and_b32 s37, s37, 0x7800
    buffer_load_dwordx4 v[136:139], v253, s[20:23], s38 offen offset:1024 sc1
    ds_read_b64_tr_b16 v[48:49], v56 offset:59392
    ds_read_b64_tr_b16 v[50:51], v56 offset:59904
    v_mfma_f32_32x32x16_bf16 v[16:31], v[36:39], v[104:107], v[16:31]
    ds_read_b64_tr_b16 v[52:53], v57 offset:59392
    ds_read_b64_tr_b16 v[54:55], v57 offset:59904
    s_waitcnt vmcnt(7) lgkmcnt(4)
    v_mfma_f32_32x32x16_bf16 v[0:15], v[40:43], v[108:111], v[0:15]
    s_add_u32 s38, s36, s37
    buffer_load_dwordx4 v[104:107], v253, s[20:23], s38 offen offset:0 sc1
    ds_read_b64_tr_b16 v[32:33], v56 offset:61440
    ds_read_b64_tr_b16 v[34:35], v56 offset:61952
    v_mfma_f32_32x32x16_bf16 v[16:31], v[44:47], v[108:111], v[16:31]
    ds_read_b64_tr_b16 v[36:37], v57 offset:61440
    ds_read_b64_tr_b16 v[38:39], v57 offset:61952
    s_waitcnt vmcnt(7) lgkmcnt(4)
    v_mfma_f32_32x32x16_bf16 v[0:15], v[48:51], v[112:115], v[0:15]
    s_add_u32 s37, s37, 2048
    s_and_b32 s37, s37, 0x7800
    buffer_load_dwordx4 v[108:111], v253, s[20:23], s38 offen offset:1024 sc1
    ds_read_b64_tr_b16 v[40:41], v56 offset:63488
    ds_read_b64_tr_b16 v[42:43], v56 offset:64000
    v_mfma_f32_32x32x16_bf16 v[16:31], v[52:55], v[112:115], v[16:31]
    ds_read_b64_tr_b16 v[44:45], v57 offset:63488
    ds_read_b64_tr_b16 v[46:47], v57 offset:64000
    s_barrier
    s_waitcnt vmcnt(7) lgkmcnt(4)
    v_mfma_f32_32x32x16_bf16 v[0:15], v[32:35], v[116:119], v[0:15]
    s_add_u32 s38, s36, s37
    buffer_load_dwordx4 v[112:115], v253, s[20:23], s38 offen offset:0 sc1
    ds_read_b64_tr_b16 v[48:49], v58 offset:0
    ds_read_b64_tr_b16 v[50:51], v58 offset:512
    v_mfma_f32_32x32x16_bf16 v[16:31], v[36:39], v[116:119], v[16:31]
    ds_read_b64_tr_b16 v[52:53], v59 offset:0
    ds_read_b64_tr_b16 v[54:55], v59 offset:512
    s_waitcnt vmcnt(7) lgkmcnt(4)
    v_mfma_f32_32x32x16_bf16 v[0:15], v[40:43], v[120:123], v[0:15]
    s_add_u32 s37, s37, 2048
    s_and_b32 s37, s37, 0x7800
    buffer_load_dwordx4 v[116:119], v253, s[20:23], s38 offen offset:1024 sc1
    ds_read_b64_tr_b16 v[32:33], v58 offset:2048
    ds_read_b64_tr_b16 v[34:35], v58 offset:2560
    v_mfma_f32_32x32x16_bf16 v[16:31], v[44:47], v[120:123], v[16:31]
    ds_read_b64_tr_b16 v[36:37], v59 offset:2048
    ds_read_b64_tr_b16 v[38:39], v59 offset:2560
    s_waitcnt vmcnt(7) lgkmcnt(4)
    v_mfma_f32_32x32x16_bf16 v[0:15], v[48:51], v[124:127], v[0:15]
    s_add_u32 s38, s36, s37
    buffer_load_dwordx4 v[120:123], v253, s[20:23], s38 offen offset:0 sc1
    ds_read_b64_tr_b16 v[40:41], v58 offset:4096
    ds_read_b64_tr_b16 v[42:43], v58 offset:4608
    v_mfma_f32_32x32x16_bf16 v[16:31], v[52:55], v[124:127], v[16:31]
    ds_read_b64_tr_b16 v[44:45], v59 offset:4096
    ds_read_b64_tr_b16 v[46:47], v59 offset:4608
    s_waitcnt vmcnt(7) lgkmcnt(4)
    v_mfma_f32_32x32x16_bf16 v[0:15], v[32:35], v[128:131], v[0:15]
    s_add_u32 s37, s37, 2048
    s_and_b32 s37, s37, 0x7800
    buffer_load_dwordx4 v[124:127], v253, s[20:23], s38 offen offset:1024 sc1
    ds_read_b64_tr_b16 v[48:49], v58 offset:6144
    ds_read_b64_tr_b16 v[50:51], v58 offset:6656
    v_mfma_f32_32x32x16_bf16 v[16:31], v[36:39], v[128:131], v[16:31]
    ds_read_b64_tr_b16 v[52:53], v59 offset:6144
    ds_read_b64_tr_b16 v[54:55], v59 offset:6656
    s_waitcnt vmcnt(7) lgkmcnt(4)
    v_mfma_f32_32x32x16_bf16 v[0:15], v[40:43], v[132:135], v[0:15]
    s_add_u32 s38, s36, s37
    buffer_load_dwordx4 v[128:131], v253, s[20:23], s38 offen offset:0 sc1
    ds_read_b64_tr_b16 v[32:33], v58 offset:8192
    ds_read_b64_tr_b16 v[34:35], v58 offset:8704
    v_mfma_f32_32x32x16_bf16 v[16:31], v[44:47], v[132:135], v[16:31]
    ds_read_b64_tr_b16 v[36:37], v59 offset:8192
    ds_read_b64_tr_b16 v[38:39], v59 offset:8704
    s_waitcnt vmcnt(7) lgkmcnt(4)
    v_mfma_f32_32x32x16_bf16 v[0:15], v[48:51], v[136:139], v[0:15]
    s_add_u32 s37, s37, 2048
    s_and_b32 s37, s37, 0x7800
    buffer_load_dwordx4 v[132:135], v253, s[20:23], s38 offen offset:1024 sc1
    ds_read_b64_tr_b16 v[40:41], v58 offset:10240
    ds_read_b64_tr_b16 v[42:43], v58 offset:10752
    v_mfma_f32_32x32x16_bf16 v[16:31], v[52:55], v[136:139], v[16:31]
    ds_read_b64_tr_b16 v[44:45], v59 offset:10240
    ds_read_b64_tr_b16 v[46:47], v59 offset:10752
    s_waitcnt vmcnt(7) lgkmcnt(4)
    v_mfma_f32_32x32x16_bf16 v[0:15], v[32:35], v[104:107], v[0:15]
    s_add_u32 s38, s36, s37
    buffer_load_dwordx4 v[136:139], v253, s[20:23], s38 offen offset:0 sc1
    ds_read_b64_tr_b16 v[48:49], v58 offset:12288
    ds_read_b64_tr_b16 v[50:51], v58 offset:12800
    v_mfma_f32_32x32x16_bf16 v[16:31], v[36:39], v[104:107], v[16:31]
    ds_read_b64_tr_b16 v[52:53], v59 offset:12288
    ds_read_b64_tr_b16 v[54:55], v59 offset:12800
    s_waitcnt vmcnt(7) lgkmcnt(4)
    v_mfma_f32_32x32x16_bf16 v[0:15], v[40:43], v[108:111], v[0:15]
    s_add_u32 s37, s37, 2048
    s_and_b32 s37, s37, 0x7800
    buffer_load_dwordx4 v[104:107], v253, s[20:23], s38 offen offset:1024 sc1
    ds_read_b64_tr_b16 v[32:33], v58 offset:14336
    ds_read_b64_tr_b16 v[34:35], v58 offset:14848
    v_mfma_f32_32x32x16_bf16 v[16:31], v[44:47], v[108:111], v[16:31]
    ds_read_b64_tr_b16 v[36:37], v59 offset:14336
    ds_read_b64_tr_b16 v[38:39], v59 offset:14848
    s_waitcnt vmcnt(7) lgkmcnt(4)
    v_mfma_f32_32x32x16_bf16 v[0:15], v[48:51], v[112:115], v[0:15]
    s_add_u32 s38, s36, s37
    buffer_load_dwordx4 v[108:111], v253, s[20:23], s38 offen offset:0 sc1
    ds_read_b64_tr_b16 v[40:41], v58 offset:16384
    ds_read_b64_tr_b16 v[42:43], v58 offset:16896
    v_mfma_f32_32x32x16_bf16 v[16:31], v[52:55], v[112:115], v[16:31]
    ds_read_b64_tr_b16 v[44:45], v59 offset:16384
    ds_read_b64_tr_b16 v[46:47], v59 offset:16896
    s_waitcnt vmcnt(7) lgkmcnt(4)
    v_mfma_f32_32x32x16_bf16 v[0:15], v[32:35], v[116:119], v[0:15]
    s_add_u32 s37, s37, 2048
    s_and_b32 s37, s37, 0x7800
    buffer_load_dwordx4 v[112:115], v253, s[20:23], s38 offen offset:1024 sc1
    ds_read_b64_tr_b16 v[48:49], v58 offset:18432
    ds_read_b64_tr_b16 v[50:51], v58 offset:18944
    v_mfma_f32_32x32x16_bf16 v[16:31], v[36:39], v[116:119], v[16:31]
    ds_read_b64_tr_b16 v[52:53], v59 offset:18432
    ds_read_b64_tr_b16 v[54:55], v59 offset:18944
    s_waitcnt vmcnt(7) lgkmcnt(4)
    v_mfma_f32_32x32x16_bf16 v[0:15], v[40:43], v[120:123], v[0:15]
    s_add_u32 s38, s36, s37
    buffer_load_dwordx4 v[116:119], v253, s[20:23], s38 offen offset:0 sc1
    ds_read_b64_tr_b16 v[32:33], v58 offset:20480
    ds_read_b64_tr_b16 v[34:35], v58 offset:20992
    v_mfma_f32_32x32x16_bf16 v[16:31], v[44:47], v[120:123], v[16:31]
    ds_read_b64_tr_b16 v[36:37], v59 offset:20480
    ds_read_b64_tr_b16 v[38:39], v59 offset:20992
    s_waitcnt vmcnt(7) lgkmcnt(4)
    v_mfma_f32_32x32x16_bf16 v[0:15], v[48:51], v[124:127], v[0:15]
    s_add_u32 s37, s37, 2048
    s_and_b32 s37, s37, 0x7800
    buffer_load_dwordx4 v[120:123], v253, s[20:23], s38 offen offset:1024 sc1
    ds_read_b64_tr_b16 v[40:41], v58 offset:22528
    ds_read_b64_tr_b16 v[42:43], v58 offset:23040
    v_mfma_f32_32x32x16_bf16 v[16:31], v[52:55], v[124:127], v[16:31]
    ds_read_b64_tr_b16 v[44:45], v59 offset:22528
    ds_read_b64_tr_b16 v[46:47], v59 offset:23040
    s_waitcnt vmcnt(7) lgkmcnt(4)
    v_mfma_f32_32x32x16_bf16 v[0:15], v[32:35], v[128:131], v[0:15]
    s_add_u32 s38, s36, s37
    buffer_load_dwordx4 v[124:127], v253, s[20:23], s38 offen offset:0 sc1
    ds_read_b64_tr_b16 v[48:49], v58 offset:24576
    ds_read_b64_tr_b16 v[50:51], v58 offset:25088
    v_mfma_f32_32x32x16_bf16 v[16:31], v[36:39], v[128:131], v[16:31]
    ds_read_b64_tr_b16 v[52:53], v59 offset:24576
    ds_read_b64_tr_b16 v[54:55], v59 offset:25088
    s_waitcnt vmcnt(7) lgkmcnt(4)
    v_mfma_f32_32x32x16_bf16 v[0:15], v[40:43], v[132:135], v[0:15]
    s_add_u32 s37, s37, 2048
    s_and_b32 s37, s37, 0x7800
    buffer_load_dwordx4 v[128:131], v253, s[20:23], s38 offen offset:1024 sc1
    ds_read_b64_tr_b16 v[32:33], v58 offset:26624
    ds_read_b64_tr_b16 v[34:35], v58 offset:27136
    v_mfma_f32_32x32x16_bf16 v[16:31], v[44:47], v[132:135], v[16:31]
    ds_read_b64_tr_b16 v[36:37], v59 offset:26624
    ds_read_b64_tr_b16 v[38:39], v59 offset:27136
    s_waitcnt vmcnt(7) lgkmcnt(4)
    v_mfma_f32_32x32x16_bf16 v[0:15], v[48:51], v[136:139], v[0:15]
    s_add_u32 s38, s36, s37
    buffer_load_dwordx4 v[132:135], v253, s[20:23], s38 offen offset:0 sc1
    ds_read_b64_tr_b16 v[40:41], v58 offset:28672
    ds_read_b64_tr_b16 v[42:43], v58 offset:29184
    v_mfma_f32_32x32x16_bf16 v[16:31], v[52:55], v[136:139], v[16:31]
    ds_read_b64_tr_b16 v[44:45], v59 offset:28672
    ds_read_b64_tr_b16 v[46:47], v59 offset:29184
    s_waitcnt vmcnt(7) lgkmcnt(4)
    v_mfma_f32_32x32x16_bf16 v[0:15], v[32:35], v[104:107], v[0:15]
    s_add_u32 s37, s37, 2048
    s_and_b32 s37, s37, 0x7800
    buffer_load_dwordx4 v[136:139], v253, s[20:23], s38 offen offset:1024 sc1
    ds_read_b64_tr_b16 v[48:49], v58 offset:30720
    ds_read_b64_tr_b16 v[50:51], v58 offset:31232
    v_mfma_f32_32x32x16_bf16 v[16:31], v[36:39], v[104:107], v[16:31]
    ds_read_b64_tr_b16 v[52:53], v59 offset:30720
    ds_read_b64_tr_b16 v[54:55], v59 offset:31232
    s_waitcnt vmcnt(7) lgkmcnt(4)
    v_mfma_f32_32x32x16_bf16 v[0:15], v[40:43], v[108:111], v[0:15]
    s_add_u32 s38, s36, s37
    buffer_load_dwordx4 v[104:107], v253, s[20:23], s38 offen offset:0 sc1
    ds_read_b64_tr_b16 v[32:33], v58 offset:32768
    ds_read_b64_tr_b16 v[34:35], v58 offset:33280
    v_mfma_f32_32x32x16_bf16 v[16:31], v[44:47], v[108:111], v[16:31]
    ds_read_b64_tr_b16 v[36:37], v59 offset:32768
    ds_read_b64_tr_b16 v[38:39], v59 offset:33280
    s_waitcnt vmcnt(7) lgkmcnt(4)
    v_mfma_f32_32x32x16_bf16 v[0:15], v[48:51], v[112:115], v[0:15]
    s_add_u32 s37, s37, 2048
    s_and_b32 s37, s37, 0x7800
    buffer_load_dwordx4 v[108:111], v253, s[20:23], s38 offen offset:1024 sc1
    ds_read_b64_tr_b16 v[40:41], v58 offset:34816
    ds_read_b64_tr_b16 v[42:43], v58 offset:35328
    v_mfma_f32_32x32x16_bf16 v[16:31], v[52:55], v[112:115], v[16:31]
    ds_read_b64_tr_b16 v[44:45], v59 offset:34816
    ds_read_b64_tr_b16 v[46:47], v59 offset:35328
    s_waitcnt vmcnt(7) lgkmcnt(4)
    v_mfma_f32_32x32x16_bf16 v[0:15], v[32:35], v[116:119], v[0:15]
    s_add_u32 s38, s36, s37
    buffer_load_dwordx4 v[112:115], v253, s[20:23], s38 offen offset:0 sc1
    ds_read_b64_tr_b16 v[48:49], v58 offset:36864
    ds_read_b64_tr_b16 v[50:51], v58 offset:37376
    v_mfma_f32_32x32x16_bf16 v[16:31], v[36:39], v[116:119], v[16:31]
    ds_read_b64_tr_b16 v[52:53], v59 offset:36864
    ds_read_b64_tr_b16 v[54:55], v59 offset:37376
    s_waitcnt vmcnt(7) lgkmcnt(4)
    v_mfma_f32_32x32x16_bf16 v[0:15], v[40:43], v[120:123], v[0:15]
    s_add_u32 s37, s37, 2048
    s_and_b32 s37, s37, 0x7800
    buffer_load_dwordx4 v[116:119], v253, s[20:23], s38 offen offset:1024 sc1
    ds_read_b64_tr_b16 v[32:33], v58 offset:38912
    ds_read_b64_tr_b16 v[34:35], v58 offset:39424
    v_mfma_f32_32x32x16_bf16 v[16:31], v[44:47], v[120:123], v[16:31]
    ds_read_b64_tr_b16 v[36:37], v59 offset:38912
    ds_read_b64_tr_b16 v[38:39], v59 offset:39424
    s_waitcnt vmcnt(7) lgkmcnt(4)
    v_mfma_f32_32x32x16_bf16 v[0:15], v[48:51], v[124:127], v[0:15]
    s_add_u32 s38, s36, s37
    buffer_load_dwordx4 v[120:123], v253, s[20:23], s38 offen offset:0 sc1
    ds_read_b64_tr_b16 v[40:41], v58 offset:40960
    ds_read_b64_tr_b16 v[42:43], v58 offset:41472
    v_mfma_f32_32x32x16_bf16 v[16:31], v[52:55], v[124:127], v[16:31]
    ds_read_b64_tr_b16 v[44:45], v59 offset:40960
    ds_read_b64_tr_b16 v[46:47], v59 offset:41472
    s_waitcnt vmcnt(7) lgkmcnt(4)
    v_mfma_f32_32x32x16_bf16 v[0:15], v[32:35], v[128:131], v[0:15]
    s_add_u32 s37, s37, 2048
    s_and_b32 s37, s37, 0x7800
    buffer_load_dwordx4 v[124:127], v253, s[20:23], s38 offen offset:1024 sc1
    ds_read_b64_tr_b16 v[48:49], v58 offset:43008
    ds_read_b64_tr_b16 v[50:51], v58 offset:43520
    v_mfma_f32_32x32x16_bf16 v[16:31], v[36:39], v[128:131], v[16:31]
    ds_read_b64_tr_b16 v[52:53], v59 offset:43008
    ds_read_b64_tr_b16 v[54:55], v59 offset:43520
    s_waitcnt vmcnt(7) lgkmcnt(4)
    v_mfma_f32_32x32x16_bf16 v[0:15], v[40:43], v[132:135], v[0:15]
    s_add_u32 s38, s36, s37
    buffer_load_dwordx4 v[128:131], v253, s[20:23], s38 offen offset:0 sc1
    ds_read_b64_tr_b16 v[32:33], v58 offset:45056
    ds_read_b64_tr_b16 v[34:35], v58 offset:45568
    v_mfma_f32_32x32x16_bf16 v[16:31], v[44:47], v[132:135], v[16:31]
    ds_read_b64_tr_b16 v[36:37], v59 offset:45056
    ds_read_b64_tr_b16 v[38:39], v59 offset:45568
    s_waitcnt vmcnt(7) lgkmcnt(4)
    v_mfma_f32_32x32x16_bf16 v[0:15], v[48:51], v[136:139], v[0:15]
    s_add_u32 s37, s37, 2048
    s_and_b32 s37, s37, 0x7800
    buffer_load_dwordx4 v[132:135], v253, s[20:23], s38 offen offset:1024 sc1
    ds_read_b64_tr_b16 v[40:41], v58 offset:47104
    ds_read_b64_tr_b16 v[42:43], v58 offset:47616
    v_mfma_f32_32x32x16_bf16 v[16:31], v[52:55], v[136:139], v[16:31]
    ds_read_b64_tr_b16 v[44:45], v59 offset:47104
    ds_read_b64_tr_b16 v[46:47], v59 offset:47616
    s_barrier
    s_waitcnt vmcnt(7) lgkmcnt(4)
    v_mfma_f32_32x32x16_bf16 v[0:15], v[32:35], v[104:107], v[0:15]
    s_add_u32 s38, s36, s37
    buffer_load_dwordx4 v[136:139], v253, s[20:23], s38 offen offset:0 sc1
    ds_read_b64_tr_b16 v[48:49], v58 offset:49152
    ds_read_b64_tr_b16 v[50:51], v58 offset:49664
    v_mfma_f32_32x32x16_bf16 v[16:31], v[36:39], v[104:107], v[16:31]
    ds_read_b64_tr_b16 v[52:53], v59 offset:49152
    ds_read_b64_tr_b16 v[54:55], v59 offset:49664
    s_waitcnt vmcnt(7) lgkmcnt(4)
    v_mfma_f32_32x32x16_bf16 v[0:15], v[40:43], v[108:111], v[0:15]
    s_add_u32 s37, s37, 2048
    s_and_b32 s37, s37, 0x7800
    buffer_load_dwordx4 v[104:107], v253, s[20:23], s38 offen offset:1024 sc1
    ds_read_b64_tr_b16 v[32:33], v58 offset:51200
    ds_read_b64_tr_b16 v[34:35], v58 offset:51712
    v_mfma_f32_32x32x16_bf16 v[16:31], v[44:47], v[108:111], v[16:31]
    ds_read_b64_tr_b16 v[36:37], v59 offset:51200
    ds_read_b64_tr_b16 v[38:39], v59 offset:51712
    s_waitcnt vmcnt(7) lgkmcnt(4)
    v_mfma_f32_32x32x16_bf16 v[0:15], v[48:51], v[112:115], v[0:15]
    ds_read_b64_tr_b16 v[40:41], v58 offset:53248
    ds_read_b64_tr_b16 v[42:43], v58 offset:53760
    v_mfma_f32_32x32x16_bf16 v[16:31], v[52:55], v[112:115], v[16:31]
    ds_read_b64_tr_b16 v[44:45], v59 offset:53248
    ds_read_b64_tr_b16 v[46:47], v59 offset:53760
    s_waitcnt vmcnt(6) lgkmcnt(4)
    v_mfma_f32_32x32x16_bf16 v[0:15], v[32:35], v[116:119], v[0:15]
    ds_read_b64_tr_b16 v[48:49], v58 offset:55296
    ds_read_b64_tr_b16 v[50:51], v58 offset:55808
    v_mfma_f32_32x32x16_bf16 v[16:31], v[36:39], v[116:119], v[16:31]
    ds_read_b64_tr_b16 v[52:53], v59 offset:55296
    ds_read_b64_tr_b16 v[54:55], v59 offset:55808
    s_waitcnt vmcnt(5) lgkmcnt(4)
    v_mfma_f32_32x32x16_bf16 v[0:15], v[40:43], v[120:123], v[0:15]
    ds_read_b64_tr_b16 v[32:33], v58 offset:57344
    ds_read_b64_tr_b16 v[34:35], v58 offset:57856
    v_mfma_f32_32x32x16_bf16 v[16:31], v[44:47], v[120:123], v[16:31]
    ds_read_b64_tr_b16 v[36:37], v59 offset:57344
    ds_read_b64_tr_b16 v[38:39], v59 offset:57856
    s_waitcnt vmcnt(4) lgkmcnt(4)
    v_mfma_f32_32x32x16_bf16 v[0:15], v[48:51], v[124:127], v[0:15]
    ds_read_b64_tr_b16 v[40:41], v58 offset:59392
    ds_read_b64_tr_b16 v[42:43], v58 offset:59904
    v_mfma_f32_32x32x16_bf16 v[16:31], v[52:55], v[124:127], v[16:31]
    ds_read_b64_tr_b16 v[44:45], v59 offset:59392
    ds_read_b64_tr_b16 v[46:47], v59 offset:59904
    s_waitcnt vmcnt(3) lgkmcnt(4)
    v_mfma_f32_32x32x16_bf16 v[0:15], v[32:35], v[128:131], v[0:15]
    ds_read_b64_tr_b16 v[48:49], v58 offset:61440
    ds_read_b64_tr_b16 v[50:51], v58 offset:61952
    v_mfma_f32_32x32x16_bf16 v[16:31], v[36:39], v[128:131], v[16:31]
    ds_read_b64_tr_b16 v[52:53], v59 offset:61440
    ds_read_b64_tr_b16 v[54:55], v59 offset:61952
    s_waitcnt vmcnt(2) lgkmcnt(4)
    v_mfma_f32_32x32x16_bf16 v[0:15], v[40:43], v[132:135], v[0:15]
    ds_read_b64_tr_b16 v[32:33], v58 offset:63488
    ds_read_b64_tr_b16 v[34:35], v58 offset:64000
    v_mfma_f32_32x32x16_bf16 v[16:31], v[44:47], v[132:135], v[16:31]
    ds_read_b64_tr_b16 v[36:37], v59 offset:63488
    ds_read_b64_tr_b16 v[38:39], v59 offset:64000
    s_waitcnt vmcnt(1) lgkmcnt(4)
    v_mfma_f32_32x32x16_bf16 v[0:15], v[48:51], v[136:139], v[0:15]
    v_mfma_f32_32x32x16_bf16 v[16:31], v[52:55], v[136:139], v[16:31]
    s_waitcnt vmcnt(0) lgkmcnt(0)
    v_mfma_f32_32x32x16_bf16 v[0:15], v[32:35], v[104:107], v[0:15]
    v_mfma_f32_32x32x16_bf16 v[16:31], v[36:39], v[104:107], v[16:31]
    s_lshl_b32 s35, s24, 4
    s_add_u32 s35, s35, s98
    s_lshl_b32 s35, s35, 14
    s_lshl_b32 s34, s3, 12
    s_add_u32 s35, s35, s34
    s_add_u32 s35, s35, 0x2000000
    s_lshl_b32 s30, s99, 13
    s_add_u32 s30, s30, s26
    s_add_u32 s30, s30, 0xc00000
    s_lshl_b32 s31, s98, 9
    s_add_u32 s31, s31, s30
    v_mov_b32 v96, 0
    v_mov_b32 v97, 0
    v_mov_b32 v98, 0
    v_mov_b32 v99, v242
    v_cvt_pk_bf16_f32 v208, v0, v1
    v_cvt_pk_bf16_f32 v209, v2, v3
    v_cvt_pk_bf16_f32 v210, v4, v5
    v_cvt_pk_bf16_f32 v211, v6, v7
    v_cvt_pk_bf16_f32 v212, v8, v9
    v_cvt_pk_bf16_f32 v213, v10, v11
    v_cvt_pk_bf16_f32 v214, v12, v13
    v_cvt_pk_bf16_f32 v215, v14, v15
    v_cvt_pk_bf16_f32 v216, v16, v17
    v_cvt_pk_bf16_f32 v217, v18, v19
    v_cvt_pk_bf16_f32 v218, v20, v21
    v_cvt_pk_bf16_f32 v219, v22, v23
    v_cvt_pk_bf16_f32 v220, v24, v25
    v_cvt_pk_bf16_f32 v221, v26, v27
    v_cvt_pk_bf16_f32 v222, v28, v29
    v_cvt_pk_bf16_f32 v223, v30, v31
    s_cmp_lg_u32 s26, 0
    s_cbranch_scc1 sk_29
    s_cmp_lg_u32 s77, 0
    s_cbranch_scc1 lc_30
    buffer_store_dwordx4 v[208:211], v100, s[20:23], s35 offen offset:0 sc1
    buffer_store_dwordx4 v[212:215], v100, s[20:23], s35 offen offset:512 sc1
    buffer_store_dwordx4 v[216:219], v100, s[20:23], s35 offen offset:1024 sc1
    buffer_store_dwordx4 v[220:223], v100, s[20:23], s35 offen offset:1536 sc1
    s_branch lc_31
lc_30:
    buffer_store_dwordx4 v[208:211], v100, s[20:23], s35 offen offset:0
    buffer_store_dwordx4 v[212:215], v100, s[20:23], s35 offen offset:512
    buffer_store_dwordx4 v[216:219], v100, s[20:23], s35 offen offset:1024
    buffer_store_dwordx4 v[220:223], v100, s[20:23], s35 offen offset:1536
lc_31:
    ds_write_b128 v101, v[208:211] offset:0
    ds_write_b128 v101, v[212:215] offset:512
    ds_write_b128 v101, v[216:219] offset:1024
    ds_write_b128 v101, v[220:223] offset:1536
sk_29:
    v_dot2c_f32_bf16 v96, 0x3f803f80, v208
    v_dot2c_f32_bf16 v97, v208, v208
    v_dot2c_f32_bf16 v98, v224, v208
    v_dot2c_f32_bf16 v96, 0x3f803f80, v209
    v_dot2c_f32_bf16 v97, v209, v209
    v_dot2c_f32_bf16 v98, v225, v209
    v_dot2c_f32_bf16 v96, 0x3f803f80, v210
    v_dot2c_f32_bf16 v97, v210, v210
    v_dot2c_f32_bf16 v98, v226, v210
    v_dot2c_f32_bf16 v96, 0x3f803f80, v211
    v_dot2c_f32_bf16 v97, v211, v211
    v_dot2c_f32_bf16 v98, v227, v211
    v_dot2c_f32_bf16 v96, 0x3f803f80, v212
    v_dot2c_f32_bf16 v97, v212, v212
    v_dot2c_f32_bf16 v98, v228, v212
    v_dot2c_f32_bf16 v96, 0x3f803f80, v213
    v_dot2c_f32_bf16 v97, v213, v213
    v_dot2c_f32_bf16 v98, v229, v213
    v_dot2c_f32_bf16 v96, 0x3f803f80, v214
    v_dot2c_f32_bf16 v97, v214, v214
    v_dot2c_f32_bf16 v98, v230, v214
    v_dot2c_f32_bf16 v96, 0x3f803f80, v215
    v_dot2c_f32_bf16 v97, v215, v215
    v_dot2c_f32_bf16 v98, v231, v215
    v_dot2c_f32_bf16 v96, 0x3f803f80, v216
    v_dot2c_f32_bf16 v97, v216, v216
    v_dot2c_f32_bf16 v98, v232, v216
    v_dot2c_f32_bf16 v96, 0x3f803f80, v217
    v_dot2c_f32_bf16 v97, v217, v217
    v_dot2c_f32_bf16 v98, v233, v217
    v_dot2c_f32_bf16 v96, 0x3f803f80, v218
    v_dot2c_f32_bf16 v97, v218, v218
    v_dot2c_f32_bf16 v98, v234, v218
    v_dot2c_f32_bf16 v96, 0x3f803f80, v219
    v_dot2c_f32_bf16 v97, v219, v219
    v_dot2c_f32_bf16 v98, v235, v219
    v_dot2c_f32_bf16 v96, 0x3f803f80, v220
    v_dot2c_f32_bf16 v97, v220, v220
    v_dot2c_f32_bf16 v98, v236, v220
    v_dot2c_f32_bf16 v96, 0x3f803f80, v221
    v_dot2c_f32_bf16 v97, v221, v221
    v_dot2c_f32_bf16 v98, v237, v221
    v_dot2c_f32_bf16 v96, 0x3f803f80, v222
    v_dot2c_f32_bf16 v97, v222, v222
    v_dot2c_f32_bf16 v98, v238, v222
    v_dot2c_f32_bf16 v96, 0x3f803f80, v223
    v_dot2c_f32_bf16 v97, v223, v223
    v_dot2c_f32_bf16 v98, v239, v223
    s_nop 0
    v_mov_b32 v48, v96
    v_mov_b32 v49, v97
    v_mov_b32 v50, v98
    v_mov_b32 v51, v99
    v_permlane32_swap_b32 v96, v48
    v_permlane32_swap_b32 v97, v49
    v_permlane32_swap_b32 v98, v50
    v_permlane32_swap_b32 v99, v51
    v_add_f32 v96, v96, v48
    v_add_f32 v97, v97, v49
    v_add_f32 v98, v98, v50
    v_add_f32 v99, v99, v51
    s_mov_b32 exec_hi, 0
    s_waitcnt vmcnt(0)
    s_cmp_lg_u32 s77, 0
    s_cbranch_scc1 lc_32
    buffer_store_dwordx4 v[96:99], v253, s[20:23], s31 offen sc1
    s_branch lc_33
lc_32:
    buffer_store_dwordx4 v[96:99], v253, s[20:23], s31 offen
lc_33:
    s_mov_b64 exec, -1
    s_cmp_lg_u32 s26, 0
    s_cbranch_scc1 e_final
    s_mov_b32 s26, 16777216
    s_and_b32 s30, s3, 1
    s_lshl_b32 s30, s30, 13
    v_add_u32 v176, s30, v253
    v_add_u32 v177, 1024, v176
    s_lshr_b32 s30, s16, 7
    s_sub_u32 s30, 3, s30
    s_and_b32 s30, s30, 7
    s_and_b32 s31, s24, 1
    s_lshl_b32 s31, s31, 3
    s_add_u32 s30, s30, s31
    s_and_b32 s31, s24, 14
    s_add_u32 s84, s31, s30
    s_lshl_b32 s31, s25, 2
    s_add_u32 s31, s31, s28
    s_mul_i32 s31, s31, 6144
    s_lshl_b32 s30, s30, 7
    s_add_u32 s30, s30, s31
    v_min_u32 v190, 2, v252
    v_lshl_add_u32 v190, v190, 11, s30
    s_add_u32 s84, s84, 14
    v_mov_b32 v0, 0
    v_mov_b32 v1, 0
    v_mov_b32 v2, 0
    v_mov_b32 v3, 0
    v_mov_b32 v4, 0
    v_mov_b32 v5, 0
    v_mov_b32 v6, 0
    v_mov_b32 v7, 0
    v_mov_b32 v8, 0
    v_mov_b32 v9, 0
    v_mov_b32 v10, 0
    v_mov_b32 v11, 0
    v_mov_b32 v12, 0
    v_mov_b32 v13, 0
    v_mov_b32 v14, 0
    v_mov_b32 v15, 0
    v_mov_b32 v16, 0
    v_mov_b32 v17, 0
    v_mov_b32 v18, 0
    v_mov_b32 v19, 0
    v_mov_b32 v20, 0
    v_mov_b32 v21, 0
    v_mov_b32 v22, 0
    v_mov_b32 v23, 0
    v_mov_b32 v24, 0
    v_mov_b32 v25, 0
    v_mov_b32 v26, 0
    v_mov_b32 v27, 0
    v_mov_b32 v28, 0
    v_mov_b32 v29, 0
    v_mov_b32 v30, 0
    v_mov_b32 v31, 0
    v_mov_b32 v32, 0
    v_mov_b32 v33, 0
    v_mov_b32 v34, 0
    v_mov_b32 v35, 0
    v_mov_b32 v36, 0
    v_mov_b32 v37, 0
    v_mov_b32 v38, 0
    v_mov_b32 v39, 0
    v_mov_b32 v40, 0
    v_mov_b32 v41, 0
    v_mov_b32 v42, 0
    v_mov_b32 v43, 0
    v_mov_b32 v44, 0
    v_mov_b32 v45, 0
    v_mov_b32 v46, 0
    v_mov_b32 v47, 0
    v_mov_b32 v48, 0
    v_mov_b32 v49, 0
    v_mov_b32 v50, 0
    v_mov_b32 v51, 0
    v_mov_b32 v52, 0
    v_mov_b32 v53, 0
    v_mov_b32 v54, 0
    v_mov_b32 v55, 0
    v_mov_b32 v56, 0
    v_mov_b32 v57, 0
    v_mov_b32 v58, 0
    v_mov_b32 v59, 0
    v_mov_b32 v60, 0
    v_mov_b32 v61, 0
    v_mov_b32 v62, 0
    v_mov_b32 v63, 0
    v_mov_b32 v64, 0
    v_mov_b32 v65, 0
    v_mov_b32 v66, 0
    v_mov_b32 v67, 0
    v_mov_b32 v68, 0
    v_mov_b32 v69, 0
    v_mov_b32 v70, 0
    v_mov_b32 v71, 0
    v_mov_b32 v72, 0
    v_mov_b32 v73, 0
    v_mov_b32 v74, 0
    v_mov_b32 v75, 0
    v_mov_b32 v76, 0
    v_mov_b32 v77, 0
    v_mov_b32 v78, 0
    v_mov_b32 v79, 0
    v_mov_b32 v80, 0
    v_mov_b32 v81, 0
    v_mov_b32 v82, 0
    v_mov_b32 v83, 0
    v_mov_b32 v84, 0
    v_mov_b32 v85, 0
    v_mov_b32 v86, 0
    v_mov_b32 v87, 0
    v_mov_b32 v88, 0
    v_mov_b32 v89, 0
    v_mov_b32 v90, 0
    v_mov_b32 v91, 0
    v_mov_b32 v92, 0
    v_mov_b32 v93, 0
    v_mov_b32 v94, 0
    v_mov_b32 v95, 0
    s_waitcnt lgkmcnt(0)
    s_branch e_q
e_arr:
    s_mov_b64 exec, 3
    s_mov_b32 s89, 0xdd9000
    buffer_store_dwordx2 v[250:251], v249, s[20:23], s89 offen sc1
    s_mov_b64 exec, -1
    s_branch e_arr_ret
e_final:
    s_load_dwordx2 s[12:13], s[0:1], 64
    s_mov_b32 s14, 0x400000
    s_mov_b32 s15, 0x20000
    s_mov_b32 s78, s27
pl_34:
    s_lshl_b32 s30, s99, 13
    s_add_u32 s30, s30, 0x1c00000
    s_add_u32 s31, s30, 4096
    buffer_load_dwordx4 v[64:67], v253, s[20:23], s30 offen offset:0 sc1
    buffer_load_dwordx4 v[68:71], v253, s[20:23], s30 offen offset:1024 sc1
    buffer_load_dwordx4 v[72:75], v253, s[20:23], s30 offen offset:2048 sc1
    buffer_load_dwordx4 v[76:79], v253, s[20:23], s30 offen offset:3072 sc1
    buffer_load_dwordx4 v[80:83], v253, s[20:23], s31 offen offset:0 sc1
    buffer_load_dwordx4 v[84:87], v253, s[20:23], s31 offen offset:1024 sc1
    buffer_load_dwordx4 v[88:91], v253, s[20:23], s31 offen offset:2048 sc1
    buffer_load_dwordx4 v[92:95], v253, s[20:23], s31 offen offset:3072 sc1
    s_waitcnt vmcnt(0)
pc_35:
    v_max3_u32 v48, v64, v65, v66
    v_max3_u32 v48, v48, v67, v68
    v_max3_u32 v48, v48, v69, v70
    v_max3_u32 v48, v48, v71, v72
    v_max3_u32 v48, v48, v73, v74
    v_max3_u32 v48, v48, v75, v76
    v_max3_u32 v48, v48, v77, v78
    v_max3_u32 v48, v48, v79, v80
    v_max3_u32 v48, v48, v81, v82
    v_max3_u32 v48, v48, v83, v84
    v_max3_u32 v48, v48, v85, v86
    v_max3_u32 v48, v48, v87, v88
    v_max3_u32 v48, v48, v89, v90
    v_max3_u32 v48, v48, v91, v92
    v_max3_u32 v48, v48, v93, v94
    v_max_u32 v48, v48, v95
    v_cmp_eq_u32 vcc, -1, v48
    s_cbranch_vccz pd_36
    s_sub_u32 s78, s78, 1
    s_cmp_lg_u32 s78, 0
    s_cbranch_scc1 pl_34
    s_mov_b32 s27, 1
pd_36:
    v_pk_add_f32 v[64:65], v[64:65], v[68:69]
    v_pk_add_f32 v[66:67], v[66:67], v[70:71]
    v_pk_add_f32 v[64:65], v[64:65], v[72:73]
    v_pk_add_f32 v[66:67], v[66:67], v[74:75]
    v_pk_add_f32 v[64:65], v[64:65], v[76:77]
    v_pk_add_f32 v[66:67], v[66:67], v[78:79]
    v_pk_add_f32 v[64:65], v[64:65], v[80:81]
    v_pk_add_f32 v[66:67], v[66:67], v[82:83]
    v_pk_add_f32 v[64:65], v[64:65], v[84:85]
    v_pk_add_f32 v[66:67], v[66:67], v[86:87]
    v_pk_add_f32 v[64:65], v[64:65], v[88:89]
    v_pk_add_f32 v[66:67], v[66:67], v[90:91]
    v_pk_add_f32 v[64:65], v[64:65], v[92:93]
    v_pk_add_f32 v[66:67], v[66:67], v[94:95]
    v_mov_b32 v48, v64
    v_mov_b32 v49, v65
    v_mov_b32 v50, v66
    v_mov_b32 v51, v67
    v_permlane32_swap_b32 v64, v48
    v_permlane32_swap_b32 v65, v49
    v_permlane32_swap_b32 v66, v50
    v_permlane32_swap_b32 v67, v51
    v_add_f32 v64, v64, v48
    v_add_f32 v65, v65, v49
    v_add_f32 v66, v66, v50
    v_add_f32 v67, v67, v51
    v_mul_f32 v54, 0x3a800000, v64
    v_mul_f32 v65, 0x3a800000, v65
    v_fma_f32 v65, -v54, v54, v65
    v_max_f32 v65, 0, v65
    v_add_f32 v55, 0x3727c5ac, v65
    v_rsq_f32 v55, v55
    v_fma_f32 v52, -v54, v67, v66
    v_and_b32 v53, 31, v252
    v_mul_f32 v52, v52, v55
    s_lshl_b32 s32, s99, 5
    v_add_u32 v53, s32, v53
    v_mov_b32 v48, v52
    s_nop 1
    v_max_f32_dpp v48, v48, v48 quad_perm:[1,0,3,2] row_mask:0xf bank_mask:0xf
    s_nop 1
    v_max_f32_dpp v48, v48, v48 quad_perm:[2,3,0,1] row_mask:0xf bank_mask:0xf
    s_nop 1
    v_max_f32_dpp v48, v48, v48 row_half_mirror row_mask:0xf bank_mask:0xf
    s_nop 1
    v_max_f32_dpp v48, v48, v48 row_mirror row_mask:0xf bank_mask:0xf
    v_mov_b32 v49, v48
    s_nop 1
    v_permlane16_swap_b32 v48, v49
    v_max_f32 v48, v48, v49
    v_cmp_eq_f32 vcc, v48, v52
    v_lshrrev_b32 v50, 5, v252
    v_lshlrev_b32 v50, 4, v50
    s_lshl_b32 s32, s99, 11
    s_lshl_b32 s33, s98, 7
    s_add_u32 s32, s32, s33
    s_add_u32 s32, s32, 0x1d60000
    s_lshl_b32 s34, s99, 4
    s_add_u32 s34, s34, 0x1dc0000
    s_ff1_i32_b32 s35, vcc_lo
    s_lshl_b32 s35, 1, s35
    s_cmp_eq_u32 s25, 0
    s_cselect_b32 exec_lo, s35, 0
    s_mov_b32 exec_hi, 0
    buffer_store_dwordx4 v[52:55], v50, s[20:23], s34 offen sc1
    s_mov_b32 exec_lo, s35
    s_mov_b32 exec_hi, s35
    buffer_store_dwordx4 v[208:211], v50, s[20:23], s32 offen offset:0 sc1
    buffer_store_dwordx4 v[212:215], v50, s[20:23], s32 offen offset:32 sc1
    buffer_store_dwordx4 v[216:219], v50, s[20:23], s32 offen offset:64 sc1
    buffer_store_dwordx4 v[220:223], v50, s[20:23], s32 offen offset:96 sc1
    s_mov_b64 exec, -1
    v_add_f32 v240, 1.0, v55
    v_mul_f32 v241, v54, v55
    v_sub_f32 v241, 0, v241
    v_pk_fma_f32 v[0:1], v[0:1], v[240:241], v[240:241] op_sel:[0,0,1] op_sel_hi:[1,0,1]
    v_pk_fma_f32 v[2:3], v[2:3], v[240:241], v[240:241] op_sel:[0,0,1] op_sel_hi:[1,0,1]
    v_pk_fma_f32 v[4:5], v[4:5], v[240:241], v[240:241] op_sel:[0,0,1] op_sel_hi:[1,0,1]
    v_pk_fma_f32 v[6:7], v[6:7], v[240:241], v[240:241] op_sel:[0,0,1] op_sel_hi:[1,0,1]
    v_pk_fma_f32 v[8:9], v[8:9], v[240:241], v[240:241] op_sel:[0,0,1] op_sel_hi:[1,0,1]
    v_pk_fma_f32 v[10:11], v[10:11], v[240:241], v[240:241] op_sel:[0,0,1] op_sel_hi:[1,0,1]
    v_pk_fma_f32 v[12:13], v[12:13], v[240:241], v[240:241] op_sel:[0,0,1] op_sel_hi:[1,0,1]
    v_pk_fma_f32 v[14:15], v[14:15], v[240:241], v[240:241] op_sel:[0,0,1] op_sel_hi:[1,0,1]
    v_pk_fma_f32 v[16:17], v[16:17], v[240:241], v[240:241] op_sel:[0,0,1] op_sel_hi:[1,0,1]
    v_pk_fma_f32 v[18:19], v[18:19], v[240:241], v[240:241] op_sel:[0,0,1] op_sel_hi:[1,0,1]
    v_pk_fma_f32 v[20:21], v[20:21], v[240:241], v[240:241] op_sel:[0,0,1] op_sel_hi:[1,0,1]
    v_pk_fma_f32 v[22:23], v[22:23], v[240:241], v[240:241] op_sel:[0,0,1] op_sel_hi:[1,0,1]
    v_pk_fma_f32 v[24:25], v[24:25], v[240:241], v[240:241] op_sel:[0,0,1] op_sel_hi:[1,0,1]
    v_pk_fma_f32 v[26:27], v[26:27], v[240:241], v[240:241] op_sel:[0,0,1] op_sel_hi:[1,0,1]
    v_pk_fma_f32 v[28:29], v[28:29], v[240:241], v[240:241] op_sel:[0,0,1] op_sel_hi:[1,0,1]
    v_pk_fma_f32 v[30:31], v[30:31], v[240:241], v[240:241] op_sel:[0,0,1] op_sel_hi:[1,0,1]
    v_cvt_pk_bf16_f32 v64, v0, v1
    v_cvt_pk_bf16_f32 v65, v2, v3
    v_cvt_pk_bf16_f32 v66, v4, v5
    v_cvt_pk_bf16_f32 v67, v6, v7
    v_cvt_pk_bf16_f32 v68, v8, v9
    v_cvt_pk_bf16_f32 v69, v10, v11
    v_cvt_pk_bf16_f32 v70, v12, v13
    v_cvt_pk_bf16_f32 v71, v14, v15
    v_cvt_pk_bf16_f32 v72, v16, v17
    v_cvt_pk_bf16_f32 v73, v18, v19
    v_cvt_pk_bf16_f32 v74, v20, v21
    v_cvt_pk_bf16_f32 v75, v22, v23
    v_cvt_pk_bf16_f32 v76, v24, v25
    v_cvt_pk_bf16_f32 v77, v26, v27
    v_cvt_pk_bf16_f32 v78, v28, v29
    v_cvt_pk_bf16_f32 v79, v30, v31
    v_permlane32_swap_b32 v64, v66
    v_permlane32_swap_b32 v65, v67
    v_permlane32_swap_b32 v68, v70
    v_permlane32_swap_b32 v69, v71
    v_permlane32_swap_b32 v72, v74
    v_permlane32_swap_b32 v73, v75
    v_permlane32_swap_b32 v76, v78
    v_permlane32_swap_b32 v77, v79
    v_lshl_add_u32 v50, v53, 11, v50
    s_mov_b32 s79, s26
    s_cmp_lg_u32 s3, 0
    s_cbranch_scc1 sk_38
    s_mov_b32 s78, s27
pl_39:
    s_add_u32 s32, s79, 0xdc0000
    buffer_load_dwordx4 v[0:3], v253, s[20:23], s32 offen sc1
    s_waitcnt vmcnt(0)
pc_40:
    v_max3_u32 v4, v0, v1, v2
    v_max_u32 v4, v4, v3
    v_cmp_eq_u32 vcc, -1, v4
    s_cbranch_vccz pd_41
    s_sub_u32 s78, s78, 1
    s_cmp_lg_u32 s78, 0
    s_cbranch_scc1 pl_39
    s_mov_b32 s27, 1
pd_41:
    v_mov_b32 v4, v0
    s_nop 1
    v_max_f32_dpp v4, v4, v4 quad_perm:[1,0,3,2] row_mask:0xf bank_mask:0xf
    s_nop 1
    v_max_f32_dpp v4, v4, v4 quad_perm:[2,3,0,1] row_mask:0xf bank_mask:0xf
    s_nop 1
    v_max_f32_dpp v4, v4, v4 row_half_mirror row_mask:0xf bank_mask:0xf
    s_nop 1
    v_max_f32_dpp v4, v4, v4 row_mirror row_mask:0xf bank_mask:0xf
    v_mov_b32 v5, v4
    s_nop 1
    v_permlane16_swap_b32 v4, v5
    v_max_f32 v4, v4, v5
    v_mov_b32 v5, v4
    s_nop 1
    v_permlane32_swap_b32 v4, v5
    v_max_f32 v4, v4, v5
    v_cmp_eq_f32 vcc, v4, v0
    s_ff1_i32_b64 s32, vcc
    s_and_b32 s32, s32, 63
    s_lshl_b64 exec, 1, s32
    ds_write_b128 v189, v[0:3] offset:3072
    s_mov_b64 exec, -1
sk_38:
    s_waitcnt lgkmcnt(0)
    s_barrier
    ds_read_b32 v0, v189 offset:3076
    s_waitcnt lgkmcnt(0)
    v_and_b32 v0, 0x7ff, v0
    v_cmp_ne_u32 vcc, v0, v53
    s_mov_b64 exec, vcc
    buffer_store_dwordx4 v[64:67], v50, s[12:15], s33 offen offset:0
    buffer_store_dwordx4 v[68:71], v50, s[12:15], s33 offen offset:32
    buffer_store_dwordx4 v[72:75], v50, s[12:15], s33 offen offset:64
    buffer_store_dwordx4 v[76:79], v50, s[12:15], s33 offen offset:96
    s_mov_b64 exec, -1
    s_branch k_end
l_start:
    v_lshrrev_b32 v21, 3, v252
    v_lshrrev_b32 v20, 4, v252
    v_xor_b32 v20, v20, v252
    v_and_b32 v20, 7, v20
    v_lshlrev_b32 v20, 4, v20
    v_lshl_add_u32 v4, v21, 11, v20
    v_xor_b32 v5, 64, v4
    v_add_u32 v5, 15360, v5
    v_add_u32 v6, 30720, v4
    v_add_u32 v7, 30720, v5
    s_lshl_b32 s84, s99, 16
    s_lshl_b32 s85, s25, 7
    s_lshl_b32 s86, s28, 12
    s_mul_i32 s87, s28, 6144
    v_and_b32 v20, 4, v21
    v_add_u32 v20, v20, v21
    v_mul_u32_u24 v20, 6144, v20
    v_and_b32 v21, 6, v21
    v_xor_b32 v21, v21, v252
    v_and_b32 v21, 7, v21
    v_lshl_add_u32 v20, v21, 4, v20
    s_mul_i32 s32, s28, 3
    s_bfe_u32 s33, s32, 0x10001
    s_mul_i32 s33, s33, 196608
    s_and_b32 s34, s32, 1
    s_mul_i32 s34, s34, 24576
    s_add_u32 s33, s33, s34
    s_lshr_b32 s34, s32, 2
    s_lshl_b32 s34, s34, 11
    s_add_u32 s33, s33, s34
    v_add_u32 v8, s33, v20
    v_add_u32 v9, 97280, v8
    s_add_u32 s32, s32, 1
    s_bfe_u32 s33, s32, 0x10001
    s_mul_i32 s33, s33, 196608
    s_and_b32 s34, s32, 1
    s_mul_i32 s34, s34, 24576
    s_add_u32 s33, s33, s34
    s_lshr_b32 s34, s32, 2
    s_lshl_b32 s34, s34, 11
    s_add_u32 s33, s33, s34
    s_sub_u32 s33, s33, 2048
    v_add_u32 v10, s33, v20
    v_add_u32 v11, 97280, v10
    s_add_u32 s32, s32, 1
    s_bfe_u32 s33, s32, 0x10001
    s_mul_i32 s33, s33, 196608
    s_and_b32 s34, s32, 1
    s_mul_i32 s34, s34, 24576
    s_add_u32 s33, s33, s34
    s_lshr_b32 s34, s32, 2
    s_lshl_b32 s34, s34, 11
    s_add_u32 s33, s33, s34
    v_add_u32 v12, s33, v20
    v_add_u32 v13, 97280, v12
    s_waitcnt lgkmcnt(0)
    s_mov_b32 s88, 0xdd8000
    s_load_dword s88, s[20:21], s88
    s_mov_b64 s[16:17], s[6:7]
    s_mov_b32 s6, 0x400000
    s_mov_b32 s7, 0x20000
    s_add_u32 s96, s94, 0
    s_and_b32 s96, s96, 15
    s_lshl_b32 s97, s96, 7
    s_add_u32 s97, s97, s84
    s_add_u32 m0, s86, 147456
    s_nop 0
    buffer_load_dwordx4 v4, s[4:7], s97 offen offset:0 lds
    buffer_load_dwordx4 v5, s[4:7], s97 offen offset:1024 lds
    buffer_load_dwordx4 v6, s[4:7], s97 offen offset:2048 lds
    buffer_load_dwordx4 v7, s[4:7], s97 offen offset:3072 lds
    s_add_u32 s96, s94, 0
    s_and_b32 s96, s96, 15
    s_mul_i32 s96, s96, 393216
    s_add_u32 s96, s96, s85
    s_add_u32 m0, s87, 40960
    s_nop 0
    buffer_load_dwordx4 v8, s[16:19], s96 offen offset:0 lds
    buffer_load_dwordx4 v9, s[16:19], s96 offen offset:1024 lds
    buffer_load_dwordx4 v10, s[16:19], s96 offen offset:2048 lds
    buffer_load_dwordx4 v11, s[16:19], s96 offen offset:3072 lds
    s_mov_b32 s40, 0xffffffff
    s_mov_b32 s41, 0xfffffff0
    s_mov_b32 s42, 0xfffffffe
    s_mov_b32 s43, 0xffffffe0
    s_mov_b32 s44, 0xfffffffc
    s_mov_b32 s45, 0xffffffc0
    s_mov_b32 s46, 0xfffffff8
    s_mov_b32 s47, 0xffffff80
    s_mov_b32 s48, 0xffff0000
    s_mov_b32 s49, 0xfff00000
    s_mov_b32 s50, 0xfffe0000
    s_mov_b32 s51, 0xffe00000
    s_mov_b32 s52, 0xfffc0000
    s_mov_b32 s53, 0xffc00000
    s_mov_b32 s54, 0xfff80000
    s_mov_b32 s55, 0xff800000
    s_mov_b32 s56, 0xffffff00
    s_mov_b32 s57, 0xfffff000
    s_mov_b32 s58, 0xfffffe00
    s_mov_b32 s59, 0xffffe000
    s_mov_b32 s60, 0xfffffc00
    s_mov_b32 s61, 0xffffc000
    s_mov_b32 s62, 0xfffff800
    s_mov_b32 s63, 0xffff8000
    s_mov_b32 s64, 0xff000000
    s_mov_b32 s65, 0xf0000000
    s_mov_b32 s66, 0xfe000000
    s_mov_b32 s67, 0xe0000000
    s_mov_b32 s68, 0xfc000000
    s_mov_b32 s69, 0xc0000000
    s_mov_b32 s70, 0xf8000000
    s_mov_b32 s71, 0x80000000
    v_bfe_u32 v20, v252, 3, 2
    v_lshrrev_b32 v21, 5, v252
    v_lshl_add_u32 v20, v21, 3, v20
    s_lshr_b32 s32, s28, 1
    s_lshl_b32 s32, s32, 4
    s_and_b32 s33, s28, 1
    s_lshl_b32 s33, s33, 2
    s_add_u32 s32, s32, s33
    v_add_u32 v20, s32, v20
    v_lshlrev_b32 v20, 11, v20
    v_lshrrev_b32 v21, 2, v252
    v_and_b32 v21, 4, v21
    v_xor_b32 v21, v21, v252
    v_and_b32 v21, 7, v21
    v_lshl_add_u32 v20, v21, 4, v20
    s_lshl_b32 s32, s98, 7
    v_add_u32 v14, s32, v20
    v_lshrrev_b32 v20, 2, v252
    v_lshlrev_b32 v20, 2, v20
    v_bfe_u32 v21, v252, 1, 1
    v_add_u32 v20, v20, v21
    v_mul_u32_u24 v20, 28672, v20
    v_and_b32 v21, 1, v252
    v_lshl_add_u32 v20, v21, 4, v20
    s_mul_i32 s30, s28, 1835008
    s_lshl_b32 s31, s29, 5
    s_add_u32 s30, s30, s31
    v_add_u32 v155, s30, v20
    v_lshlrev_b32 v21, 14, v21
    v_lshrrev_b32 v20, 1, v252
    v_lshl_add_u32 v20, v20, 4, v21
    s_lshl_b32 s30, s28, 9
    s_lshl_b32 s31, s29, 15
    s_add_u32 s30, s30, s31
    v_add_u32 v153, s30, v20
    s_load_dwordx2 s[80:81], s[0:1], 40
    s_cmp_lt_u32 s29, 224
    s_cselect_b32 s82, 0x700000, 0
    s_mov_b32 s83, 0x20000
    s_load_dwordx2 s[12:13], s[0:1], 56
    s_cmp_lt_u32 s29, 224
    s_cselect_b32 s14, 0x700000, 0
    s_mov_b32 s15, 0x20000
    s_mov_b32 s73, -1
    s_mov_b32 s100, 0
    s_sub_u32 s30, s25, s24
    s_add_u32 s30, s30, 31
    v_and_b32 v15, 16, v252
    v_mul_u32_u24 v15, s30, v15
    v_and_b32 v20, 31, v252
    v_add_lshl_u32 v15, v15, v20, 3
    s_lshl_b32 s30, s24, 7
    s_add_u32 s30, s30, 0xdd9000
    v_add_u32 v15, s30, v15
    s_add_u32 m0, s87, 45056
    s_nop 0
    buffer_load_dwordx4 v12, s[16:19], s96 offen offset:0 lds
    buffer_load_dwordx4 v13, s[16:19], s96 offen offset:1024 lds
    s_add_u32 s96, s95, 1
    s_and_b32 s96, s96, 15
    s_lshl_b32 s97, s96, 7
    s_add_u32 s97, s97, s84
    s_add_u32 m0, s86, 131072
    s_nop 0
    buffer_load_dwordx4 v4, s[4:7], s97 offen offset:0 lds
    buffer_load_dwordx4 v5, s[4:7], s97 offen offset:1024 lds
    buffer_load_dwordx4 v6, s[4:7], s97 offen offset:2048 lds
    buffer_load_dwordx4 v7, s[4:7], s97 offen offset:3072 lds
    s_add_u32 s96, s95, 1
    s_and_b32 s96, s96, 15
    s_mul_i32 s96, s96, 393216
    s_add_u32 s96, s96, s85
    s_add_u32 m0, s87, 65536
    s_nop 0
    buffer_load_dwordx4 v8, s[16:19], s96 offen offset:0 lds
    buffer_load_dwordx4 v9, s[16:19], s96 offen offset:1024 lds
    buffer_load_dwordx4 v10, s[16:19], s96 offen offset:2048 lds
    s_waitcnt vmcnt(7) lgkmcnt(0)
    s_add_u32 s88, s88, 0x9e3779b9
    s_barrier
    buffer_load_dwordx4 v11, s[16:19], s96 offen offset:3072 lds
    s_add_u32 m0, s87, 69632
    s_nop 0
    buffer_load_dwordx4 v12, s[16:19], s96 offen offset:0 lds
    buffer_load_dwordx4 v13, s[16:19], s96 offen offset:1024 lds
    s_add_u32 s96, s94, 2
    s_and_b32 s96, s96, 15
    s_lshl_b32 s97, s96, 7
    s_add_u32 s97, s97, s84
    s_add_u32 m0, s86, 114688
    s_nop 0
    buffer_load_dwordx4 v4, s[4:7], s97 offen offset:0 lds
    buffer_load_dwordx4 v5, s[4:7], s97 offen offset:1024 lds
    buffer_load_dwordx4 v6, s[4:7], s97 offen offset:2048 lds
    buffer_load_dwordx4 v7, s[4:7], s97 offen offset:3072 lds
    s_add_u32 s96, s94, 2
    s_and_b32 s96, s96, 15
    s_mul_i32 s96, s96, 393216
    s_add_u32 s96, s96, s85
    s_add_u32 m0, s87, 90112
    s_nop 0
    buffer_load_dwordx4 v8, s[16:19], s96 offen offset:0 lds
    buffer_load_dwordx4 v9, s[16:19], s96 offen offset:1024 lds
    buffer_load_dwordx4 v10, s[16:19], s96 offen offset:2048 lds
    buffer_load_dwordx4 v11, s[16:19], s96 offen offset:3072 lds
    s_add_u32 m0, s87, 94208
    s_nop 0
    buffer_load_dwordx4 v12, s[16:19], s96 offen offset:0 lds
    buffer_load_dwordx4 v13, s[16:19], s96 offen offset:1024 lds
    s_waitcnt vmcnt(10) lgkmcnt(0)
    s_barrier
    s_add_u32 s96, s95, 3
    s_and_b32 s96, s96, 15
    s_lshl_b32 s97, s96, 7
    s_add_u32 s97, s97, s84
    s_add_u32 m0, s86, 147456
    s_nop 0
    buffer_load_dwordx4 v4, s[4:7], s97 offen offset:0 lds
    buffer_load_dwordx4 v5, s[4:7], s97 offen offset:1024 lds
    buffer_load_dwordx4 v6, s[4:7], s97 offen offset:2048 lds
    buffer_load_dwordx4 v7, s[4:7], s97 offen offset:3072 lds
    s_add_u32 s96, s95, 3
    s_and_b32 s96, s96, 15
    s_mul_i32 s96, s96, 393216
    s_add_u32 s96, s96, s85
    s_add_u32 m0, s87, 40960
    s_nop 0
    buffer_load_dwordx4 v8, s[16:19], s96 offen offset:0 lds
    buffer_load_dwordx4 v9, s[16:19], s96 offen offset:1024 lds
    v_and_b32 v28, 31, v252
    v_bfe_u32 v29, v28, 1, 3
    v_lshrrev_b32 v30, 5, v252
    v_xor_b32 v29, v29, v30
    v_lshlrev_b32 v29, 4, v29
    v_lshl_add_u32 v28, v28, 7, v29
    s_add_u32 s30, s86, 131072
    v_add_u32 v28, s30, v28
    v_xor_b32 v29, 32, v28
    v_xor_b32 v30, 64, v28
    v_xor_b32 v31, 96, v28
    ds_read_b128 v[32:35], v28
    ds_read_b128 v[36:39], v29
    ds_read_b128 v[40:43], v30
    buffer_load_dwordx4 v10, s[16:19], s96 offen offset:2048 lds
    ds_read_b128 v[44:47], v31
    s_min_u32 s30, s28, 2
    s_lshl_b32 s30, s30, 13
    s_add_u32 s30, s30, 65536
    v_lshrrev_b32 v20, 2, v252
    v_bfe_u32 v21, v20, 1, 2
    v_lshlrev_b32 v20, 7, v20
    v_lshl_add_u32 v20, v21, 5, v20
    v_and_b32 v21, 3, v252
    v_lshl_add_u32 v20, v21, 3, v20
    v_add_u32 v144, s30, v20
    v_xor_b32 v145, 32, v144
    v_xor_b32 v146, 64, v144
    v_xor_b32 v147, 96, v144
    buffer_load_dwordx4 v11, s[16:19], s96 offen offset:3072 lds
    ds_read_b64_tr_b16 v[100:101], v144 offset:0
    ds_read_b64_tr_b16 v[102:103], v144 offset:2048
    ds_read_b64_tr_b16 v[104:105], v144 offset:4096
    ds_read_b64_tr_b16 v[106:107], v144 offset:6144
    ds_read_b64_tr_b16 v[108:109], v145 offset:0
    ds_read_b64_tr_b16 v[110:111], v145 offset:2048
    ds_read_b64_tr_b16 v[112:113], v145 offset:4096
    ds_read_b64_tr_b16 v[114:115], v145 offset:6144
    ds_read_b64_tr_b16 v[116:117], v146 offset:0
    ds_read_b64_tr_b16 v[118:119], v146 offset:2048
    ds_read_b64_tr_b16 v[120:121], v146 offset:4096
    ds_read_b64_tr_b16 v[122:123], v146 offset:6144
    ds_read_b64_tr_b16 v[124:125], v147 offset:0
    ds_read_b64_tr_b16 v[126:127], v147 offset:2048
    s_add_u32 m0, s87, 45056
    s_nop 0
    buffer_load_dwordx4 v12, s[16:19], s96 offen offset:0 lds
    ds_read_b64_tr_b16 v[128:129], v147 offset:4096
    ds_read_b64_tr_b16 v[130:131], v147 offset:6144
    v_mov_b32 v16, -1
    v_mov_b32 v17, -1
    v_mov_b32 v18, -1
    v_mov_b32 v19, -1
    s_lshr_b32 s30, s28, 1
    s_mul_i32 s30, s30, 16777216
    s_and_b32 s31, s28, 1
    s_lshl_b32 s32, s31, 20
    s_lshl_b32 s33, s72, 10
    s_add_u32 s32, s32, s33
    s_add_u32 s32, s32, s30
    s_add_u32 s32, s32, 0xc00000
    buffer_load_dwordx4 v13, s[16:19], s96 offen offset:1024 lds
    buffer_store_dwordx4 v[16:19], v253, s[20:23], s32 offen sc1
    s_add_u32 s32, s32, 262144
    buffer_store_dwordx4 v[16:19], v253, s[20:23], s32 offen sc1
    s_add_u32 s32, s32, 262144
    buffer_store_dwordx4 v[16:19], v253, s[20:23], s32 offen sc1
    s_add_u32 s32, s32, 262144
    s_lshl_b32 s33, s72, 7
    s_add_u32 s33, s33, s30
    s_add_u32 s33, s33, 0xdc0000
    s_cmp_eq_u32 s31, 0
    s_cselect_b32 s32, s32, s33
    s_cselect_b64 exec, -1, 0xff
    buffer_store_dwordx4 v[16:19], v253, s[20:23], s32 offen sc1
    s_mov_b64 exec, -1
    s_waitcnt vmcnt(14) lgkmcnt(0)
    s_barrier
    s_add_u32 s96, s94, 4
    s_and_b32 s96, s96, 15
    s_lshl_b32 s97, s96, 7
    s_add_u32 s97, s97, s84
    s_add_u32 m0, s86, 131072
    s_nop 0
    buffer_load_dwordx4 v4, s[4:7], s97 offen offset:0 lds
    buffer_load_dwordx4 v5, s[4:7], s97 offen offset:1024 lds
    v_mov_b32 v48, 0
    v_mov_b32 v49, 0
    v_mov_b32 v50, 0
    v_mov_b32 v51, 0
    s_lshl_b32 s30, s99, 12
    s_lshl_b32 s31, s25, 8
    s_add_u32 s30, s30, s31
    s_add_u32 s30, s30, 0x2400000
    v_lshlrev_b32 v28, 3, v252
    v_dot2c_f32_bf16 v48, 0x3f803f80, v32
    v_dot2c_f32_bf16 v49, v32, v32
    v_dot2c_f32_bf16 v50, 0x3f803f80, v33
    buffer_load_dwordx4 v6, s[4:7], s97 offen offset:2048 lds
    v_dot2c_f32_bf16 v51, v33, v33
    v_dot2c_f32_bf16 v48, 0x3f803f80, v34
    v_dot2c_f32_bf16 v49, v34, v34
    v_dot2c_f32_bf16 v50, 0x3f803f80, v35
    v_dot2c_f32_bf16 v51, v35, v35
    v_dot2c_f32_bf16 v48, 0x3f803f80, v36
    v_dot2c_f32_bf16 v49, v36, v36
    v_dot2c_f32_bf16 v50, 0x3f803f80, v37
    v_dot2c_f32_bf16 v51, v37, v37
    v_dot2c_f32_bf16 v48, 0x3f803f80, v38
    v_dot2c_f32_bf16 v49, v38, v38
    buffer_load_dwordx4 v7, s[4:7], s97 offen offset:3072 lds
    v_dot2c_f32_bf16 v50, 0x3f803f80, v39
    v_dot2c_f32_bf16 v51, v39, v39
    v_dot2c_f32_bf16 v48, 0x3f803f80, v40
    v_dot2c_f32_bf16 v49, v40, v40
    v_dot2c_f32_bf16 v50, 0x3f803f80, v41
    v_dot2c_f32_bf16 v51, v41, v41
    v_dot2c_f32_bf16 v48, 0x3f803f80, v42
    v_dot2c_f32_bf16 v49, v42, v42
    v_dot2c_f32_bf16 v50, 0x3f803f80, v43
    v_dot2c_f32_bf16 v51, v43, v43
    v_dot2c_f32_bf16 v48, 0x3f803f80, v44
    s_add_u32 s96, s94, 4
    s_and_b32 s96, s96, 15
    s_mul_i32 s96, s96, 393216
    s_add_u32 s96, s96, s85
    s_add_u32 m0, s87, 65536
    s_nop 0
    buffer_load_dwordx4 v8, s[16:19], s96 offen offset:0 lds
    v_dot2c_f32_bf16 v49, v44, v44
    v_dot2c_f32_bf16 v50, 0x3f803f80, v45
    v_dot2c_f32_bf16 v51, v45, v45
    v_dot2c_f32_bf16 v48, 0x3f803f80, v46
    v_dot2c_f32_bf16 v49, v46, v46
    v_dot2c_f32_bf16 v50, 0x3f803f80, v47
    v_dot2c_f32_bf16 v51, v47, v47
    s_nop 2
    v_pk_add_f32 v[48:49], v[48:49], v[50:51]
    v_mov_b32 v50, v48
    v_mov_b32 v51, v49
    s_nop 0
    v_permlane32_swap_b32 v48, v50
    buffer_load_dwordx4 v9, s[16:19], s96 offen offset:1024 lds
    v_permlane32_swap_b32 v49, v51
    v_pk_add_f32 v[48:49], v[48:49], v[50:51]
    s_mov_b32 exec_hi, 0
    buffer_store_dwordx2 v[48:49], v28, s[20:23], s30 offen sc1
    s_mov_b64 exec, -1
    v_mov_b32 v140, 0
    v_mov_b32 v141, 0
    v_mov_b32 v142, 0
    v_mov_b32 v143, 0
    v_dot2c_f32_bf16 v140, 0x3f803f80, v100
    v_dot2c_f32_bf16 v141, 0x3f803f80, v108
    v_dot2c_f32_bf16 v142, 0x3f803f80, v116
    buffer_load_dwordx4 v10, s[16:19], s96 offen offset:2048 lds
    v_dot2c_f32_bf16 v143, 0x3f803f80, v124
    v_dot2c_f32_bf16 v140, 0x3f803f80, v101
    v_dot2c_f32_bf16 v141, 0x3f803f80, v109
    v_dot2c_f32_bf16 v142, 0x3f803f80, v117
    v_dot2c_f32_bf16 v143, 0x3f803f80, v125
    v_dot2c_f32_bf16 v140, 0x3f803f80, v102
    v_dot2c_f32_bf16 v141, 0x3f803f80, v110
    v_dot2c_f32_bf16 v142, 0x3f803f80, v118
    v_dot2c_f32_bf16 v143, 0x3f803f80, v126
    v_dot2c_f32_bf16 v140, 0x3f803f80, v103
    v_dot2c_f32_bf16 v141, 0x3f803f80, v111
    buffer_load_dwordx4 v11, s[16:19], s96 offen offset:3072 lds
    v_dot2c_f32_bf16 v142, 0x3f803f80, v119
    v_dot2c_f32_bf16 v143, 0x3f803f80, v127
    v_dot2c_f32_bf16 v140, 0x3f803f80, v104
    v_dot2c_f32_bf16 v141, 0x3f803f80, v112
    v_dot2c_f32_bf16 v142, 0x3f803f80, v120
    v_dot2c_f32_bf16 v143, 0x3f803f80, v128
    v_dot2c_f32_bf16 v140, 0x3f803f80, v105
    v_dot2c_f32_bf16 v141, 0x3f803f80, v113
    v_dot2c_f32_bf16 v142, 0x3f803f80, v121
    v_dot2c_f32_bf16 v143, 0x3f803f80, v129
    v_dot2c_f32_bf16 v140, 0x3f803f80, v106
    s_add_u32 m0, s87, 69632
    s_nop 0
    buffer_load_dwordx4 v12, s[16:19], s96 offen offset:0 lds
    v_dot2c_f32_bf16 v141, 0x3f803f80, v114
    v_dot2c_f32_bf16 v142, 0x3f803f80, v122
    v_dot2c_f32_bf16 v143, 0x3f803f80, v130
    v_dot2c_f32_bf16 v140, 0x3f803f80, v107
    v_dot2c_f32_bf16 v141, 0x3f803f80, v115
    v_dot2c_f32_bf16 v142, 0x3f803f80, v123
    v_dot2c_f32_bf16 v143, 0x3f803f80, v131
    s_min_u32 s32, s28, 2
    s_lshl_b32 s32, s32, 12
    s_lshl_b32 s33, s25, 14
    s_add_u32 s32, s32, s33
    buffer_load_dwordx4 v13, s[16:19], s96 offen offset:1024 lds
    s_add_u32 s32, s32, 0x2500000
    s_lshl_b32 s33, s24, 8
    s_add_u32 s32, s32, s33
    v_lshlrev_b32 v20, 2, v252
    v_permlane32_swap_b32 v140, v142
    v_permlane32_swap_b32 v141, v143
    v_add_f32 v140, v140, v142
    v_add_f32 v141, v141, v143
    s_nop 1
    v_permlane16_swap_b32 v140, v141
    v_add_f32 v140, v140, v141
    buffer_store_dword v140, v20, s[20:23], s32 offen sc1
    s_waitcnt vmcnt(16) lgkmcnt(0)
    s_barrier
    s_add_u32 s96, s95, 5
    s_and_b32 s96, s96, 15
    s_lshl_b32 s97, s96, 7
    s_add_u32 s97, s97, s84
    s_add_u32 m0, s86, 114688
    s_nop 0
    buffer_load_dwordx4 v4, s[4:7], s97 offen offset:0 lds
    buffer_load_dwordx4 v5, s[4:7], s97 offen offset:1024 lds
    buffer_load_dwordx4 v6, s[4:7], s97 offen offset:2048 lds
    buffer_load_dwordx4 v7, s[4:7], s97 offen offset:3072 lds
    s_add_u32 s96, s95, 5
    s_and_b32 s96, s96, 15
    s_mul_i32 s96, s96, 393216
    s_add_u32 s96, s96, s85
    s_add_u32 m0, s87, 90112
    s_nop 0
    buffer_load_dwordx4 v8, s[16:19], s96 offen offset:0 lds
    buffer_load_dwordx4 v9, s[16:19], s96 offen offset:1024 lds
    buffer_load_dwordx4 v10, s[16:19], s96 offen offset:2048 lds
    buffer_load_dwordx4 v11, s[16:19], s96 offen offset:3072 lds
    s_add_u32 m0, s87, 94208
    s_nop 0
    buffer_load_dwordx4 v12, s[16:19], s96 offen offset:0 lds
    buffer_load_dwordx4 v13, s[16:19], s96 offen offset:1024 lds
    s_waitcnt vmcnt(11) lgkmcnt(0)
    s_barrier
    s_add_u32 s96, s94, 6
    s_and_b32 s96, s96, 15
    s_lshl_b32 s97, s96, 7
    s_add_u32 s97, s97, s84
    s_add_u32 m0, s86, 147456
    s_nop 0
    buffer_load_dwordx4 v4, s[4:7], s97 offen offset:0 lds
    buffer_load_dwordx4 v5, s[4:7], s97 offen offset:1024 lds
    buffer_load_dwordx4 v6, s[4:7], s97 offen offset:2048 lds
    buffer_load_dwordx4 v7, s[4:7], s97 offen offset:3072 lds
    s_add_u32 s96, s94, 6
    s_and_b32 s96, s96, 15
    s_mul_i32 s96, s96, 393216
    s_add_u32 s96, s96, s85
    s_add_u32 m0, s87, 40960
    s_nop 0
    buffer_load_dwordx4 v8, s[16:19], s96 offen offset:0 lds
    buffer_load_dwordx4 v9, s[16:19], s96 offen offset:1024 lds
    buffer_load_dwordx4 v10, s[16:19], s96 offen offset:2048 lds
    buffer_load_dwordx4 v11, s[16:19], s96 offen offset:3072 lds
    s_add_u32 m0, s87, 45056
    s_nop 0
    buffer_load_dwordx4 v12, s[16:19], s96 offen offset:0 lds
    buffer_load_dwordx4 v13, s[16:19], s96 offen offset:1024 lds
    s_waitcnt vmcnt(10) lgkmcnt(0)
    s_barrier
    s_add_u32 s96, s95, 7
    s_and_b32 s96, s96, 15
    s_lshl_b32 s97, s96, 7
    s_add_u32 s97, s97, s84
    s_add_u32 m0, s86, 131072
    s_nop 0
    buffer_load_dwordx4 v4, s[4:7], s97 offen offset:0 lds
    buffer_load_dwordx4 v5, s[4:7], s97 offen offset:1024 lds
    buffer_load_dwordx4 v6, s[4:7], s97 offen offset:2048 lds
    buffer_load_dwordx4 v7, s[4:7], s97 offen offset:3072 lds
    s_add_u32 s96, s95, 7
    s_and_b32 s96, s96, 15
    s_mul_i32 s96, s96, 393216
    s_add_u32 s96, s96, s85
    s_add_u32 m0, s87, 65536
    s_nop 0
    buffer_load_dwordx4 v8, s[16:19], s96 offen offset:0 lds
    buffer_load_dwordx4 v9, s[16:19], s96 offen offset:1024 lds
    buffer_load_dwordx4 v10, s[16:19], s96 offen offset:2048 lds
    buffer_load_dwordx4 v11, s[16:19], s96 offen offset:3072 lds
    s_add_u32 m0, s87, 69632
    s_nop 0
    buffer_load_dwordx4 v12, s[16:19], s96 offen offset:0 lds
    buffer_load_dwordx4 v13, s[16:19], s96 offen offset:1024 lds
    s_waitcnt vmcnt(10) lgkmcnt(0)
    s_barrier
    s_add_u32 s96, s94, 8
    s_and_b32 s96, s96, 15
    s_lshl_b32 s97, s96, 7
    s_add_u32 s97, s97, s84
    s_add_u32 m0, s86, 114688
    s_nop 0
    buffer_load_dwordx4 v4, s[4:7], s97 offen offset:0 lds
    buffer_load_dwordx4 v5, s[4:7], s97 offen offset:1024 lds
    buffer_load_dwordx4 v6, s[4:7], s97 offen offset:2048 lds
    buffer_load_dwordx4 v7, s[4:7], s97 offen offset:3072 lds
    s_add_u32 s96, s94, 8
    s_and_b32 s96, s96, 15
    s_mul_i32 s96, s96, 393216
    s_add_u32 s96, s96, s85
    s_add_u32 m0, s87, 90112
    s_nop 0
    buffer_load_dwordx4 v8, s[16:19], s96 offen offset:0 lds
    buffer_load_dwordx4 v9, s[16:19], s96 offen offset:1024 lds
    buffer_load_dwordx4 v10, s[16:19], s96 offen offset:2048 lds
    buffer_load_dwordx4 v11, s[16:19], s96 offen offset:3072 lds
    s_add_u32 m0, s87, 94208
    s_nop 0
    buffer_load_dwordx4 v12, s[16:19], s96 offen offset:0 lds
    buffer_load_dwordx4 v13, s[16:19], s96 offen offset:1024 lds
    s_waitcnt vmcnt(10) lgkmcnt(0)
    s_barrier
    s_add_u32 s96, s95, 9
    s_and_b32 s96, s96, 15
    s_lshl_b32 s97, s96, 7
    s_add_u32 s97, s97, s84
    s_add_u32 m0, s86, 147456
    s_nop 0
    buffer_load_dwordx4 v4, s[4:7], s97 offen offset:0 lds
    buffer_load_dwordx4 v5, s[4:7], s97 offen offset:1024 lds
    buffer_load_dwordx4 v6, s[4:7], s97 offen offset:2048 lds
    buffer_load_dwordx4 v7, s[4:7], s97 offen offset:3072 lds
    s_add_u32 s96, s95, 9
    s_and_b32 s96, s96, 15
    s_mul_i32 s96, s96, 393216
    s_add_u32 s96, s96, s85
    s_add_u32 m0, s87, 40960
    s_nop 0
    buffer_load_dwordx4 v8, s[16:19], s96 offen offset:0 lds
    buffer_load_dwordx4 v9, s[16:19], s96 offen offset:1024 lds
    buffer_load_dwordx4 v10, s[16:19], s96 offen offset:2048 lds
    buffer_load_dwordx4 v11, s[16:19], s96 offen offset:3072 lds
    s_add_u32 m0, s87, 45056
    s_nop 0
    buffer_load_dwordx4 v12, s[16:19], s96 offen offset:0 lds
    buffer_load_dwordx4 v13, s[16:19], s96 offen offset:1024 lds
    s_waitcnt vmcnt(10) lgkmcnt(0)
    s_barrier
    s_add_u32 s96, s94, 10
    s_and_b32 s96, s96, 15
    s_lshl_b32 s97, s96, 7
    s_add_u32 s97, s97, s84
    s_add_u32 m0, s86, 131072
    s_nop 0
    buffer_load_dwordx4 v4, s[4:7], s97 offen offset:0 lds
    buffer_load_dwordx4 v5, s[4:7], s97 offen offset:1024 lds
    buffer_load_dwordx4 v6, s[4:7], s97 offen offset:2048 lds
    buffer_load_dwordx4 v7, s[4:7], s97 offen offset:3072 lds
    s_add_u32 s96, s94, 10
    s_and_b32 s96, s96, 15
    s_mul_i32 s96, s96, 393216
    s_add_u32 s96, s96, s85
    s_add_u32 m0, s87, 65536
    s_nop 0
    buffer_load_dwordx4 v8, s[16:19], s96 offen offset:0 lds
    buffer_load_dwordx4 v9, s[16:19], s96 offen offset:1024 lds
    buffer_load_dwordx4 v10, s[16:19], s96 offen offset:2048 lds
    buffer_load_dwordx4 v11, s[16:19], s96 offen offset:3072 lds
    s_add_u32 m0, s87, 69632
    s_nop 0
    buffer_load_dwordx4 v12, s[16:19], s96 offen offset:0 lds
    buffer_load_dwordx4 v13, s[16:19], s96 offen offset:1024 lds
    s_waitcnt vmcnt(10) lgkmcnt(0)
    s_barrier
    s_add_u32 s96, s95, 11
    s_and_b32 s96, s96, 15
    s_lshl_b32 s97, s96, 7
    s_add_u32 s97, s97, s84
    s_add_u32 m0, s86, 114688
    s_nop 0
    buffer_load_dwordx4 v4, s[4:7], s97 offen offset:0 lds
    buffer_load_dwordx4 v5, s[4:7], s97 offen offset:1024 lds
    buffer_load_dwordx4 v6, s[4:7], s97 offen offset:2048 lds
    buffer_load_dwordx4 v7, s[4:7], s97 offen offset:3072 lds
    s_add_u32 s96, s95, 11
    s_and_b32 s96, s96, 15
    s_mul_i32 s96, s96, 393216
    s_add_u32 s96, s96, s85
    s_add_u32 m0, s87, 90112
    s_nop 0
    buffer_load_dwordx4 v8, s[16:19], s96 offen offset:0 lds
    buffer_load_dwordx4 v9, s[16:19], s96 offen offset:1024 lds
    buffer_load_dwordx4 v10, s[16:19], s96 offen offset:2048 lds
    buffer_load_dwordx4 v11, s[16:19], s96 offen offset:3072 lds
    s_add_u32 m0, s87, 94208
    s_nop 0
    buffer_load_dwordx4 v12, s[16:19], s96 offen offset:0 lds
    buffer_load_dwordx4 v13, s[16:19], s96 offen offset:1024 lds
    s_waitcnt vmcnt(10) lgkmcnt(0)
    s_barrier
    s_add_u32 s96, s94, 12
    s_and_b32 s96, s96, 15
    s_lshl_b32 s97, s96, 7
    s_add_u32 s97, s97, s84
    s_add_u32 m0, s86, 147456
    s_nop 0
    buffer_load_dwordx4 v4, s[4:7], s97 offen offset:0 lds
    buffer_load_dwordx4 v5, s[4:7], s97 offen offset:1024 lds
    buffer_load_dwordx4 v6, s[4:7], s97 offen offset:2048 lds
    buffer_load_dwordx4 v7, s[4:7], s97 offen offset:3072 lds
    s_add_u32 s96, s94, 12
    s_and_b32 s96, s96, 15
    s_mul_i32 s96, s96, 393216
    s_add_u32 s96, s96, s85
    s_add_u32 m0, s87, 40960
    s_nop 0
    buffer_load_dwordx4 v8, s[16:19], s96 offen offset:0 lds
    buffer_load_dwordx4 v9, s[16:19], s96 offen offset:1024 lds
    buffer_load_dwordx4 v10, s[16:19], s96 offen offset:2048 lds
    buffer_load_dwordx4 v11, s[16:19], s96 offen offset:3072 lds
    s_add_u32 m0, s87, 45056
    s_nop 0
    buffer_load_dwordx4 v12, s[16:19], s96 offen offset:0 lds
    buffer_load_dwordx4 v13, s[16:19], s96 offen offset:1024 lds
    s_waitcnt vmcnt(10) lgkmcnt(0)
    s_barrier
    buffer_load_dwordx2 v[16:17], v15, s[20:23], 0 offen sc1
    s_add_u32 s96, s95, 13
    s_and_b32 s96, s96, 15
    s_lshl_b32 s97, s96, 7
    s_add_u32 s97, s97, s84
    s_add_u32 m0, s86, 131072
    s_nop 0
    buffer_load_dwordx4 v4, s[4:7], s97 offen offset:0 lds
    buffer_load_dwordx4 v5, s[4:7], s97 offen offset:1024 lds
    buffer_load_dwordx4 v6, s[4:7], s97 offen offset:2048 lds
    buffer_load_dwordx4 v7, s[4:7], s97 offen offset:3072 lds
    s_add_u32 s96, s95, 13
    s_and_b32 s96, s96, 15
    s_mul_i32 s96, s96, 393216
    s_add_u32 s96, s96, s85
    s_add_u32 m0, s87, 65536
    s_nop 0
    buffer_load_dwordx4 v8, s[16:19], s96 offen offset:0 lds
    buffer_load_dwordx4 v9, s[16:19], s96 offen offset:1024 lds
    buffer_load_dwordx4 v10, s[16:19], s96 offen offset:2048 lds
    buffer_load_dwordx4 v11, s[16:19], s96 offen offset:3072 lds
    s_add_u32 m0, s87, 69632
    s_nop 0
    buffer_load_dwordx4 v12, s[16:19], s96 offen offset:0 lds
    buffer_load_dwordx4 v13, s[16:19], s96 offen offset:1024 lds
    s_waitcnt vmcnt(11) lgkmcnt(0)
    s_barrier
    s_add_u32 s96, s94, 14
    s_and_b32 s96, s96, 15
    s_lshl_b32 s97, s96, 7
    s_add_u32 s97, s97, s84
    s_add_u32 m0, s86, 114688
    s_nop 0
    buffer_load_dwordx4 v4, s[4:7], s97 offen offset:0 lds
    buffer_load_dwordx4 v5, s[4:7], s97 offen offset:1024 lds
    buffer_load_dwordx4 v6, s[4:7], s97 offen offset:2048 lds
    buffer_load_dwordx4 v7, s[4:7], s97 offen offset:3072 lds
    s_add_u32 s96, s94, 14
    s_and_b32 s96, s96, 15
    s_mul_i32 s96, s96, 393216
    s_add_u32 s96, s96, s85
    s_add_u32 m0, s87, 90112
    s_nop 0
    buffer_load_dwordx4 v8, s[16:19], s96 offen offset:0 lds
    buffer_load_dwordx4 v9, s[16:19], s96 offen offset:1024 lds
    buffer_load_dwordx4 v10, s[16:19], s96 offen offset:2048 lds
    buffer_load_dwordx4 v11, s[16:19], s96 offen offset:3072 lds
    s_add_u32 m0, s87, 94208
    s_nop 0
    buffer_load_dwordx4 v12, s[16:19], s96 offen offset:0 lds
    buffer_load_dwordx4 v13, s[16:19], s96 offen offset:1024 lds
    s_mov_b32 s78, s27
    s_waitcnt vmcnt(20)
    s_branch pc_43
pl_42:
    buffer_load_dwordx2 v[16:17], v15, s[20:23], 0 offen sc1
    s_waitcnt vmcnt(0)
pc_43:
    v_cmp_ne_u32 vcc, s88, v16
    s_cbranch_vccz pd_44
    s_sub_u32 s78, s78, 1
    s_cmp_lg_u32 s78, 0
    s_cbranch_scc1 pl_42
    s_mov_b32 s27, 1
pd_44:
    s_getreg_b32 s30, hwreg(HW_REG_XCC_ID, 0, 4)
    v_cmp_ne_u32 vcc, s30, v17
    s_and_b32 s30, vcc_lo, 0xffff
    s_cselect_b32 s77, 0, 1
    v_mov_b32 v20, s73
    v_mov_b32 v21, s77
    v_mov_b32 v19, 0
    ds_write_b64 v19, v[20:21] offset:3072
    s_waitcnt vmcnt(10) lgkmcnt(0)
    s_barrier
    s_add_u32 s96, s95, 15
    s_and_b32 s96, s96, 15
    s_lshl_b32 s97, s96, 7
    s_add_u32 s97, s97, s84
    s_add_u32 m0, s86, 147456
    s_nop 0
    buffer_load_dwordx4 v4, s[4:7], s97 offen offset:0 lds
    buffer_load_dwordx4 v5, s[4:7], s97 offen offset:1024 lds
    buffer_load_dwordx4 v6, s[4:7], s97 offen offset:2048 lds
    buffer_load_dwordx4 v7, s[4:7], s97 offen offset:3072 lds
    s_add_u32 s96, s95, 15
    s_and_b32 s96, s96, 15
    s_mul_i32 s96, s96, 393216
    s_add_u32 s96, s96, s85
    s_add_u32 m0, s87, 40960
    s_nop 0
    buffer_load_dwordx4 v8, s[16:19], s96 offen offset:0 lds
    buffer_load_dwordx4 v9, s[16:19], s96 offen offset:1024 lds
    buffer_load_dwordx4 v10, s[16:19], s96 offen offset:2048 lds
    buffer_load_dwordx4 v11, s[16:19], s96 offen offset:3072 lds
    s_add_u32 m0, s87, 45056
    s_nop 0
    buffer_load_dwordx4 v12, s[16:19], s96 offen offset:0 lds
    buffer_load_dwordx4 v13, s[16:19], s96 offen offset:1024 lds
    s_waitcnt vmcnt(10) lgkmcnt(0)
    s_barrier
    s_load_dwordx2 s[4:5], s[0:1], 48
    s_cmp_lt_u32 s29, 224
    s_cselect_b32 s6, 0x700000, 0
    s_mov_b32 s7, 0x20000
    s_lshl_b32 s30, s99, 12
    s_add_u32 s30, s30, 0x2400000
    buffer_load_dwordx4 v[64:67], v253, s[20:23], s30 offen offset:0 sc1
    buffer_load_dwordx4 v[68:71], v253, s[20:23], s30 offen offset:1024 sc1
    buffer_load_dwordx4 v[72:75], v253, s[20:23], s30 offen offset:2048 sc1
    buffer_load_dwordx4 v[76:79], v253, s[20:23], s30 offen offset:3072 sc1
    s_min_u32 s32, s28, 2
    s_lshl_b32 s32, s32, 12
    s_lshl_b32 s33, s25, 14
    s_add_u32 s32, s32, s33
    s_add_u32 s32, s32, 0x2500000
    buffer_load_dwordx4 v[32:35], v253, s[20:23], s32 offen offset:0 sc1
    buffer_load_dwordx4 v[36:39], v253, s[20:23], s32 offen offset:1024 sc1
    buffer_load_dwordx4 v[40:43], v253, s[20:23], s32 offen offset:2048 sc1
    buffer_load_dwordx4 v[44:47], v253, s[20:23], s32 offen offset:3072 sc1
    s_add_u32 s96, s25, 1
    s_and_b32 s96, s96, 15
    s_lshl_b32 s96, s96, 17
    s_add_u32 m0, s101, 4096
    s_nop 0
    buffer_load_dwordx4 v14, s[8:11], s96 offen lds
    s_add_u32 s96, s25, 2
    s_and_b32 s96, s96, 15
    s_lshl_b32 s96, s96, 17
    s_add_u32 m0, s101, 8192
    s_nop 0
    buffer_load_dwordx4 v14, s[8:11], s96 offen lds
    s_add_u32 s96, s25, 3
    s_and_b32 s96, s96, 15
    s_lshl_b32 s96, s96, 17
    s_add_u32 m0, s101, 12288
    s_nop 0
    buffer_load_dwordx4 v14, s[8:11], s96 offen lds
    s_waitcnt vmcnt(11) lgkmcnt(0)
    s_barrier
    s_waitcnt vmcnt(3)
    v_pk_add_f32 v[64:65], v[64:65], v[68:69]
    v_pk_add_f32 v[66:67], v[66:67], v[70:71]
    v_pk_add_f32 v[64:65], v[64:65], v[72:73]
    v_pk_add_f32 v[66:67], v[66:67], v[74:75]
    v_pk_add_f32 v[64:65], v[64:65], v[76:77]
    v_pk_add_f32 v[66:67], v[66:67], v[78:79]
    s_nop 1
    v_permlane32_swap_b32 v64, v66
    v_permlane32_swap_b32 v65, v67
    v_pk_add_f32 v[64:65], v[64:65], v[66:67]
    v_mov_b32 v48, v64
    v_mov_b32 v49, v65
    s_nop 0
    v_permlane16_swap_b32 v64, v48
    v_permlane16_swap_b32 v65, v49
    v_add_f32 v64, v64, v48
    v_add_f32 v65, v65, v49
    v_mul_f32 v54, 0x3a800000, v64
    v_mul_f32 v65, 0x3a800000, v65
    v_fma_f32 v65, -v54, v54, v65
    v_max_f32 v65, 0, v65
    v_add_f32 v55, 0x3727c5ac, v65
    v_rsq_f32 v55, v55
    v_pk_add_f32 v[32:33], v[32:33], v[36:37]
    v_pk_add_f32 v[34:35], v[34:35], v[38:39]
    v_pk_add_f32 v[32:33], v[32:33], v[40:41]
    v_pk_add_f32 v[34:35], v[34:35], v[42:43]
    v_pk_add_f32 v[32:33], v[32:33], v[44:45]
    v_pk_add_f32 v[34:35], v[34:35], v[46:47]
    s_nop 1
    v_permlane32_swap_b32 v32, v34
    v_permlane32_swap_b32 v33, v35
    v_add_f32 v32, v32, v34
    v_add_f32 v33, v33, v35
    s_nop 1
    v_permlane16_swap_b32 v32, v33
    v_add_f32 v32, v32, v33
    v_mov_b32 v2, v32
    v_and_b32 v48, 15, v252
    v_lshrrev_b32 v49, 5, v252
    v_lshl_add_u32 v48, v48, 1, v49
    v_bfe_u32 v49, v252, 4, 1
    v_cmp_eq_u32 vcc, 0, v49
    v_lshlrev_b32 v49, 9, v49
    v_lshl_add_u32 v48, v48, 2, v49
    s_lshl_b32 s32, s28, 7
    v_add_u32 v48, s32, v48
    v_cndmask_b32 v49, v54, v55, vcc
    v_cndmask_b32 v50, 0, 1.0, vcc
    ds_write_b32 v48, v49 offset:0
    ds_write_b32 v48, v50 offset:2048
    v_and_b32 v48, 15, v252
    v_lshrrev_b32 v51, 4, v252
    v_lshl_add_u32 v48, v48, 2, v51
    s_min_u32 s32, s28, 2
    s_lshl_b32 s32, s32, 8
    v_lshl_add_u32 v48, v48, 2, s32
    ds_write_b32 v48, v2 offset:1024
    s_xor_b32 s96, s29, 0
    s_and_b32 s97, s96, 2
    s_and_b32 s96, s96, 3
    s_mul_i32 s97, s97, 14336
    s_mul_i32 s96, s96, 14336
    s_add_u32 s96, s96, s97
    buffer_load_dwordx4 v[156:159], v155, s[80:83], s96 offen
    s_xor_b32 s96, s29, 0
    s_and_b32 s97, s96, 2
    s_and_b32 s96, s96, 3
    s_mul_i32 s97, s97, 14336
    s_mul_i32 s96, s96, 14336
    s_add_u32 s96, s96, s97
    s_add_u32 s96, s96, 7168
    buffer_load_dwordx4 v[160:163], v155, s[80:83], s96 offen
    s_waitcnt lgkmcnt(0)
    s_barrier
    s_xor_b32 s96, s29, 0
    s_and_b32 s97, s96, 2
    s_and_b32 s96, s96, 3
    s_mul_i32 s97, s97, 14336
    s_mul_i32 s96, s96, 14336
    s_add_u32 s96, s96, s97
    buffer_load_dwordx4 v[188:191], v155, s[4:7], s96 offen
    s_xor_b32 s96, s29, 0
    s_and_b32 s97, s96, 2
    s_and_b32 s96, s96, 3
    s_mul_i32 s97, s97, 14336
    s_mul_i32 s96, s96, 14336
    s_add_u32 s96, s96, s97
    s_add_u32 s96, s96, 7168
    buffer_load_dwordx4 v[192:195], v155, s[4:7], s96 offen
l_att:
    s_add_u32 s96, s25, 10
    s_and_b32 s96, s96, 15
    s_lshl_b32 s96, s96, 17
    s_add_u32 m0, s101, 40960
    s_nop 0
    buffer_load_dwordx4 v14, s[8:11], s96 offen lds
    s_add_u32 s96, s25, 11
    s_and_b32 s96, s96, 15
    s_lshl_b32 s96, s96, 17
    s_add_u32 m0, s101, 45056
    s_nop 0
    buffer_load_dwordx4 v14, s[8:11], s96 offen lds
    s_cmp_lg_u32 s26, 0
    s_cbranch_scc1 sk_45
    s_mov_b32 s96, 0
    buffer_load_dwordx4 v[220:223], v153, s[12:15], s96 offen
    s_mov_b32 s96, 2048
    buffer_load_dwordx4 v[224:227], v153, s[12:15], s96 offen
    s_mov_b32 s96, 4096
    buffer_load_dwordx4 v[228:231], v153, s[12:15], s96 offen
    s_mov_b32 s96, 6144
    buffer_load_dwordx4 v[232:235], v153, s[12:15], s96 offen
    s_mov_b32 s96, 8192
    buffer_load_dwordx4 v[236:239], v153, s[12:15], s96 offen
    s_mov_b32 s96, 10240
    buffer_load_dwordx4 v[240:243], v153, s[12:15], s96 offen
    s_mov_b32 s96, 12288
    buffer_load_dwordx4 v[244:247], v153, s[12:15], s96 offen
    s_mov_b32 s96, 14336
    buffer_load_dwordx4 v[248:251], v153, s[12:15], s96 offen
    s_add_u32 s96, s25, 4
    s_and_b32 s96, s96, 15
    s_lshl_b32 s96, s96, 17
    s_add_u32 m0, s101, 16384
    s_nop 0
    buffer_load_dwordx4 v14, s[8:11], s96 offen lds
    s_add_u32 s96, s25, 5
    s_and_b32 s96, s96, 15
    s_lshl_b32 s96, s96, 17
    s_add_u32 m0, s101, 20480
    s_nop 0
    buffer_load_dwordx4 v14, s[8:11], s96 offen lds
    s_add_u32 s96, s25, 6
    s_and_b32 s96, s96, 15
    s_lshl_b32 s96, s96, 17
    s_add_u32 m0, s101, 24576
    s_nop 0
    buffer_load_dwordx4 v14, s[8:11], s96 offen lds
    s_add_u32 s96, s25, 7
    s_and_b32 s96, s96, 15
    s_lshl_b32 s96, s96, 17
    s_add_u32 m0, s101, 28672
    s_nop 0
    buffer_load_dwordx4 v14, s[8:11], s96 offen lds
    s_add_u32 s96, s25, 8
    s_and_b32 s96, s96, 15
    s_lshl_b32 s96, s96, 17
    s_add_u32 m0, s101, 32768
    s_nop 0
    buffer_load_dwordx4 v14, s[8:11], s96 offen lds
    s_add_u32 s96, s25, 9
    s_and_b32 s96, s96, 15
    s_lshl_b32 s96, s96, 17
    s_add_u32 m0, s101, 36864
    s_nop 0
    buffer_load_dwordx4 v14, s[8:11], s96 offen lds
sk_45:
    v_mov_b32 v20, 0xffff
    v_mov_b32 v21, 0xffff0000
    v_cndmask_b32 v22, 0, v20, s[40:41]
    v_cndmask_b32 v23, 0, v21, s[42:43]
    v_or_b32 v12, v22, v23
    v_cndmask_b32 v22, 0, v20, s[44:45]
    v_cndmask_b32 v23, 0, v21, s[46:47]
    v_or_b32 v13, v22, v23
    v_cndmask_b32 v22, 0, v20, s[48:49]
    v_cndmask_b32 v23, 0, v21, s[50:51]
    v_or_b32 v14, v22, v23
    v_cndmask_b32 v22, 0, v20, s[52:53]
    v_cndmask_b32 v23, 0, v21, s[54:55]
    v_or_b32 v15, v22, v23
    v_cndmask_b32 v22, 0, v20, s[56:57]
    v_cndmask_b32 v23, 0, v21, s[58:59]
    v_or_b32 v16, v22, v23
    v_cndmask_b32 v22, 0, v20, s[60:61]
    v_cndmask_b32 v23, 0, v21, s[62:63]
    v_or_b32 v17, v22, v23
    v_cndmask_b32 v22, 0, v20, s[64:65]
    v_cndmask_b32 v23, 0, v21, s[66:67]
    v_or_b32 v18, v22, v23
    v_cndmask_b32 v22, 0, v20, s[68:69]
    v_cndmask_b32 v23, 0, v21, s[70:71]
    v_or_b32 v19, v22, v23
    s_lshl_b32 s34, s28, 12
    s_add_u32 s34, s34, 114688
    v_add_u32 v20, s34, v253
    s_lshl_b32 s34, s3, 11
    s_add_u32 s34, s34, 49152
    v_add_u32 v3, s34, v253
    v_mov_b32 v24, 0
    v_mov_b32 v25, 0
    v_mov_b32 v26, 0
    v_mov_b32 v27, 0
    v_mov_b32 v28, 0
    v_mov_b32 v29, 0
    v_mov_b32 v30, 0
    v_mov_b32 v31, 0
    v_mov_b32 v32, 0
    v_mov_b32 v33, 0
    v_mov_b32 v34, 0
    v_mov_b32 v35, 0
    v_mov_b32 v36, 0
    v_mov_b32 v37, 0
    v_mov_b32 v38, 0
    v_mov_b32 v39, 0
    s_lshr_b32 s33, s28, 1
    s_add_u32 s33, s33, s24
    s_sub_u32 s33, s33, 2
    s_cmp_lt_i32 s33, 0
    s_cbranch_scc1 sk_46
    s_and_b32 s34, s28, 1
    s_lshl_b32 s35, s25, 7
    s_lshl_b32 s30, s33, 2
    s_add_u32 s35, s35, s30
    s_lshl_b32 s30, s34, 1
    s_add_u32 s35, s35, s30
    s_lshl_b32 s35, s35, 12
    s_add_u32 s35, s35, s26
    s_lshl_b32 s30, s25, 8
    s_lshl_b32 s31, s33, 4
    s_add_u32 s30, s30, s31
    s_lshl_b32 s31, s34, 3
    s_add_u32 s30, s30, s31
    s_add_u32 s30, s30, s26
    s_add_u32 s30, s30, 0xdd0000
    v_and_b32 v40, 4, v252
    s_mov_b32 s78, s27
pl_47:
    buffer_load_dword v42, v40, s[20:23], s30 offen sc1
    s_waitcnt vmcnt(0)
pc_48:
    v_cmp_ne_u32 vcc, s88, v42
    s_cbranch_vccz pd_49
    s_sub_u32 s78, s78, 1
    s_cmp_lg_u32 s78, 0
    s_cbranch_scc1 pl_47
    s_mov_b32 s27, 1
pd_49:
    s_lshl_b32 s30, s28, 13
    s_add_u32 m0, s30, 65536
    s_add_u32 s31, s35, 0
    buffer_load_dwordx4 v253, s[20:23], s31 offen offset:0 sc1 lds
    buffer_load_dwordx4 v253, s[20:23], s31 offen offset:1024 sc1 lds
    s_add_u32 m0, s30, 69632
    s_add_u32 s31, s35, 4096
    buffer_load_dwordx4 v253, s[20:23], s31 offen offset:0 sc1 lds
    buffer_load_dwordx4 v253, s[20:23], s31 offen offset:1024 sc1 lds
    s_add_u32 m0, s30, 65536
    s_add_u32 s31, s35, 0
    buffer_load_dwordx4 v253, s[20:23], s31 offen offset:2048 sc1 lds
    buffer_load_dwordx4 v253, s[20:23], s31 offen offset:3072 sc1 lds
    s_add_u32 m0, s30, 69632
    s_add_u32 s31, s35, 4096
    buffer_load_dwordx4 v253, s[20:23], s31 offen offset:2048 sc1 lds
    buffer_load_dwordx4 v253, s[20:23], s31 offen offset:3072 sc1 lds
    s_add_u32 m0, s30, 114688
    s_add_u32 s31, s35, 262144
    buffer_load_dwordx4 v253, s[20:23], s31 offen offset:0 sc1 lds
    buffer_load_dwordx4 v253, s[20:23], s31 offen offset:1024 sc1 lds
    s_add_u32 m0, s30, 118784
    s_add_u32 s31, s35, 266240
    buffer_load_dwordx4 v253, s[20:23], s31 offen offset:0 sc1 lds
    buffer_load_dwordx4 v253, s[20:23], s31 offen offset:1024 sc1 lds
    s_add_u32 m0, s30, 114688
    s_add_u32 s31, s35, 262144
    buffer_load_dwordx4 v253, s[20:23], s31 offen offset:2048 sc1 lds
    buffer_load_dwordx4 v253, s[20:23], s31 offen offset:3072 sc1 lds
    s_add_u32 m0, s30, 118784
    s_add_u32 s31, s35, 266240
    buffer_load_dwordx4 v253, s[20:23], s31 offen offset:2048 sc1 lds
    buffer_load_dwordx4 v253, s[20:23], s31 offen offset:3072 sc1 lds
    s_waitcnt vmcnt(12)
sk_46:
    s_cmp_eq_u32 s100, 0
    s_cbranch_scc1 sk_50
    s_waitcnt vmcnt(0)
sk_50:
    s_barrier
    s_cmp_eq_u32 s100, 0
    s_cbranch_scc1 sk_51
    s_cmp_lg_u32 s38, 0
    s_cselect_b64 exec, -1, 0
    ds_write_b16 v0, v1
    s_mov_b64 exec, -1
    s_waitcnt lgkmcnt(0)
    s_barrier
sk_51:
    ds_read_b128 v[4:7], v3
    ds_read_b128 v[8:11], v3 offset:1024
    s_waitcnt vmcnt(0) lgkmcnt(0)
    s_barrier
    ds_read_b128 v[104:107], v20 offset:32768
    ds_read_b128 v[108:111], v20 offset:33792
    ds_read_b128 v[112:115], v20 offset:28672
    ds_read_b128 v[116:119], v20 offset:29696
    s_waitcnt lgkmcnt(2)
    v_mfma_f32_32x32x16_bf16 v[40:55], v[104:107], v[4:7], 0
    v_mfma_f32_32x32x16_bf16 v[40:55], v[108:111], v[8:11], v[40:55]
    s_cmp_lg_u32 s26, 0
    s_cbranch_scc1 sk_52
    s_xor_b32 s96, s29, 1
    s_and_b32 s97, s96, 2
    s_and_b32 s96, s96, 3
    s_mul_i32 s97, s97, 14336
    s_mul_i32 s96, s96, 14336
    s_add_u32 s96, s96, s97
    buffer_load_dwordx4 v[164:167], v155, s[80:83], s96 offen
sk_52:
    ds_read_b128 v[104:107], v20 offset:24576
    ds_read_b128 v[108:111], v20 offset:25600
    s_cmp_eq_u32 s99, 0
    s_cbranch_scc0 ng_53
    v_mov_b32 v24, 0xf149f2ca
    v_mov_b32 v25, 0xf149f2ca
    v_mov_b32 v26, 0xf149f2ca
    v_mov_b32 v27, 0xf149f2ca
    v_mov_b32 v28, 0xf149f2ca
    v_mov_b32 v29, 0xf149f2ca
    v_mov_b32 v30, 0xf149f2ca
    v_mov_b32 v31, 0xf149f2ca
    v_mov_b32 v32, 0xf149f2ca
    v_mov_b32 v33, 0xf149f2ca
    v_mov_b32 v34, 0xf149f2ca
    v_mov_b32 v35, 0xf149f2ca
    v_mov_b32 v36, 0xf149f2ca
    v_mov_b32 v37, 0xf149f2ca
    v_mov_b32 v38, 0xf149f2ca
    v_mov_b32 v39, 0xf149f2ca
ng_53:
    s_waitcnt lgkmcnt(2)
    s_nop 0
    v_mfma_f32_32x32x16_bf16 v[72:87], v[112:115], v[4:7], v[24:39]
    v_mfma_f32_32x32x16_bf16 v[72:87], v[116:119], v[8:11], v[72:87]
    s_cmp_lg_u32 s26, 0
    s_cbranch_scc1 sk_54
    s_xor_b32 s96, s29, 1
    s_and_b32 s97, s96, 2
    s_and_b32 s96, s96, 3
    s_mul_i32 s97, s97, 14336
    s_mul_i32 s96, s96, 14336
    s_add_u32 s96, s96, s97
    s_add_u32 s96, s96, 7168
    buffer_load_dwordx4 v[168:171], v155, s[80:83], s96 offen
sk_54:
    ds_read_b128 v[112:115], v20 offset:20480
    ds_read_b128 v[116:119], v20 offset:21504
    s_cmp_eq_u32 s99, 1
    s_cbranch_scc0 ng_55
    v_mov_b32 v24, 0xf149f2ca
    v_mov_b32 v25, 0xf149f2ca
    v_mov_b32 v26, 0xf149f2ca
    v_mov_b32 v27, 0xf149f2ca
    v_mov_b32 v28, 0xf149f2ca
    v_mov_b32 v29, 0xf149f2ca
    v_mov_b32 v30, 0xf149f2ca
    v_mov_b32 v31, 0xf149f2ca
    v_mov_b32 v32, 0xf149f2ca
    v_mov_b32 v33, 0xf149f2ca
    v_mov_b32 v34, 0xf149f2ca
    v_mov_b32 v35, 0xf149f2ca
    v_mov_b32 v36, 0xf149f2ca
    v_mov_b32 v37, 0xf149f2ca
    v_mov_b32 v38, 0xf149f2ca
    v_mov_b32 v39, 0xf149f2ca
ng_55:
    s_waitcnt lgkmcnt(2)
    s_nop 0
    v_mfma_f32_32x32x16_bf16 v[56:71], v[104:107], v[4:7], v[24:39]
    v_mfma_f32_32x32x16_bf16 v[56:71], v[108:111], v[8:11], v[56:71]
    s_nop 1
    v_max_f32 v21, v72, v73
    v_max3_f32 v21, v21, v74, v75
    v_max3_f32 v21, v21, v76, v77
    v_max3_f32 v21, v21, v78, v79
    v_max3_f32 v21, v21, v80, v81
    v_max3_f32 v21, v21, v82, v83
    v_max3_f32 v21, v21, v84, v85
    v_max3_f32 v21, v21, v86, v87
    s_cmp_lg_u32 s26, 0
    s_cbranch_scc1 sk_56
    s_xor_b32 s96, s29, 2
    s_and_b32 s97, s96, 2
    s_and_b32 s96, s96, 3
    s_mul_i32 s97, s97, 14336
    s_mul_i32 s96, s96, 14336
    s_add_u32 s96, s96, s97
    buffer_load_dwordx4 v[172:175], v155, s[80:83], s96 offen
sk_56:
    ds_read_b128 v[104:107], v20 offset:16384
    ds_read_b128 v[108:111], v20 offset:17408
    s_cmp_eq_u32 s99, 2
    s_cbranch_scc0 ng_57
    v_mov_b32 v24, 0xf149f2ca
    v_mov_b32 v25, 0xf149f2ca
    v_mov_b32 v26, 0xf149f2ca
    v_mov_b32 v27, 0xf149f2ca
    v_mov_b32 v28, 0xf149f2ca
    v_mov_b32 v29, 0xf149f2ca
    v_mov_b32 v30, 0xf149f2ca
    v_mov_b32 v31, 0xf149f2ca
    v_mov_b32 v32, 0xf149f2ca
    v_mov_b32 v33, 0xf149f2ca
    v_mov_b32 v34, 0xf149f2ca
    v_mov_b32 v35, 0xf149f2ca
    v_mov_b32 v36, 0xf149f2ca
    v_mov_b32 v37, 0xf149f2ca
    v_mov_b32 v38, 0xf149f2ca
    v_mov_b32 v39, 0xf149f2ca
ng_57:
    s_waitcnt lgkmcnt(2)
    s_nop 0
    v_mfma_f32_32x32x16_bf16 v[72:87], v[112:115], v[4:7], v[24:39]
    v_mfma_f32_32x32x16_bf16 v[72:87], v[116:119], v[8:11], v[72:87]
    v_max3_f32 v21, v21, v56, v57
    v_max3_f32 v21, v21, v58, v59
    v_max3_f32 v21, v21, v60, v61
    v_max3_f32 v21, v21, v62, v63
    v_max3_f32 v21, v21, v64, v65
    v_max3_f32 v21, v21, v66, v67
    v_max3_f32 v21, v21, v68, v69
    v_max3_f32 v21, v21, v70, v71
    s_cmp_lg_u32 s26, 0
    s_cbranch_scc1 sk_58
    s_xor_b32 s96, s29, 2
    s_and_b32 s97, s96, 2
    s_and_b32 s96, s96, 3
    s_mul_i32 s97, s97, 14336
    s_mul_i32 s96, s96, 14336
    s_add_u32 s96, s96, s97
    s_add_u32 s96, s96, 7168
    buffer_load_dwordx4 v[176:179], v155, s[80:83], s96 offen
sk_58:
    ds_read_b128 v[112:115], v20 offset:12288
    ds_read_b128 v[116:119], v20 offset:13312
    s_cmp_eq_u32 s99, 3
    s_cbranch_scc0 ng_59
    v_mov_b32 v24, 0xf149f2ca
    v_mov_b32 v25, 0xf149f2ca
    v_mov_b32 v26, 0xf149f2ca
    v_mov_b32 v27, 0xf149f2ca
    v_mov_b32 v28, 0xf149f2ca
    v_mov_b32 v29, 0xf149f2ca
    v_mov_b32 v30, 0xf149f2ca
    v_mov_b32 v31, 0xf149f2ca
    v_mov_b32 v32, 0xf149f2ca
    v_mov_b32 v33, 0xf149f2ca
    v_mov_b32 v34, 0xf149f2ca
    v_mov_b32 v35, 0xf149f2ca
    v_mov_b32 v36, 0xf149f2ca
    v_mov_b32 v37, 0xf149f2ca
    v_mov_b32 v38, 0xf149f2ca
    v_mov_b32 v39, 0xf149f2ca
ng_59:
    s_waitcnt lgkmcnt(2)
    s_nop 0
    v_mfma_f32_32x32x16_bf16 v[56:71], v[104:107], v[4:7], v[24:39]
    v_mfma_f32_32x32x16_bf16 v[56:71], v[108:111], v[8:11], v[56:71]
    v_max3_f32 v21, v21, v72, v73
    v_max3_f32 v21, v21, v74, v75
    v_max3_f32 v21, v21, v76, v77
    v_max3_f32 v21, v21, v78, v79
    v_max3_f32 v21, v21, v80, v81
    v_max3_f32 v21, v21, v82, v83
    v_max3_f32 v21, v21, v84, v85
    v_max3_f32 v21, v21, v86, v87
    s_cmp_lg_u32 s26, 0
    s_cbranch_scc1 sk_60
    s_xor_b32 s96, s29, 3
    s_and_b32 s97, s96, 2
    s_and_b32 s96, s96, 3
    s_mul_i32 s97, s97, 14336
    s_mul_i32 s96, s96, 14336
    s_add_u32 s96, s96, s97
    buffer_load_dwordx4 v[180:183], v155, s[80:83], s96 offen
sk_60:
    ds_read_b128 v[104:107], v20 offset:8192
    ds_read_b128 v[108:111], v20 offset:9216
    s_cmp_eq_u32 s99, 4
    s_cbranch_scc0 ng_61
    v_mov_b32 v24, 0xf149f2ca
    v_mov_b32 v25, 0xf149f2ca
    v_mov_b32 v26, 0xf149f2ca
    v_mov_b32 v27, 0xf149f2ca
    v_mov_b32 v28, 0xf149f2ca
    v_mov_b32 v29, 0xf149f2ca
    v_mov_b32 v30, 0xf149f2ca
    v_mov_b32 v31, 0xf149f2ca
    v_mov_b32 v32, 0xf149f2ca
    v_mov_b32 v33, 0xf149f2ca
    v_mov_b32 v34, 0xf149f2ca
    v_mov_b32 v35, 0xf149f2ca
    v_mov_b32 v36, 0xf149f2ca
    v_mov_b32 v37, 0xf149f2ca
    v_mov_b32 v38, 0xf149f2ca
    v_mov_b32 v39, 0xf149f2ca
ng_61:
    s_waitcnt lgkmcnt(2)
    s_nop 0
    v_mfma_f32_32x32x16_bf16 v[72:87], v[112:115], v[4:7], v[24:39]
    v_mfma_f32_32x32x16_bf16 v[72:87], v[116:119], v[8:11], v[72:87]
    v_max3_f32 v21, v21, v56, v57
    v_max3_f32 v21, v21, v58, v59
    v_max3_f32 v21, v21, v60, v61
    v_max3_f32 v21, v21, v62, v63
    v_max3_f32 v21, v21, v64, v65
    v_max3_f32 v21, v21, v66, v67
    v_max3_f32 v21, v21, v68, v69
    v_max3_f32 v21, v21, v70, v71
    s_cmp_lg_u32 s26, 0
    s_cbranch_scc1 sk_62
    s_xor_b32 s96, s29, 3
    s_and_b32 s97, s96, 2
    s_and_b32 s96, s96, 3
    s_mul_i32 s97, s97, 14336
    s_mul_i32 s96, s96, 14336
    s_add_u32 s96, s96, s97
    s_add_u32 s96, s96, 7168
    buffer_load_dwordx4 v[184:187], v155, s[80:83], s96 offen
sk_62:
    ds_read_b128 v[112:115], v20 offset:4096
    ds_read_b128 v[116:119], v20 offset:5120
    s_cmp_eq_u32 s99, 5
    s_cbranch_scc0 ng_63
    v_mov_b32 v24, 0xf149f2ca
    v_mov_b32 v25, 0xf149f2ca
    v_mov_b32 v26, 0xf149f2ca
    v_mov_b32 v27, 0xf149f2ca
    v_mov_b32 v28, 0xf149f2ca
    v_mov_b32 v29, 0xf149f2ca
    v_mov_b32 v30, 0xf149f2ca
    v_mov_b32 v31, 0xf149f2ca
    v_mov_b32 v32, 0xf149f2ca
    v_mov_b32 v33, 0xf149f2ca
    v_mov_b32 v34, 0xf149f2ca
    v_mov_b32 v35, 0xf149f2ca
    v_mov_b32 v36, 0xf149f2ca
    v_mov_b32 v37, 0xf149f2ca
    v_mov_b32 v38, 0xf149f2ca
    v_mov_b32 v39, 0xf149f2ca
ng_63:
    s_waitcnt lgkmcnt(2)
    s_nop 0
    v_mfma_f32_32x32x16_bf16 v[56:71], v[104:107], v[4:7], v[24:39]
    v_mfma_f32_32x32x16_bf16 v[56:71], v[108:111], v[8:11], v[56:71]
    v_max3_f32 v21, v21, v72, v73
    v_max3_f32 v21, v21, v74, v75
    v_max3_f32 v21, v21, v76, v77
    v_max3_f32 v21, v21, v78, v79
    v_max3_f32 v21, v21, v80, v81
    v_max3_f32 v21, v21, v82, v83
    v_max3_f32 v21, v21, v84, v85
    v_max3_f32 v21, v21, v86, v87
    s_cmp_lg_u32 s26, 0
    s_cbranch_scc1 sk_64
    s_xor_b32 s96, s29, 1
    s_and_b32 s97, s96, 2
    s_and_b32 s96, s96, 3
    s_mul_i32 s97, s97, 14336
    s_mul_i32 s96, s96, 14336
    s_add_u32 s96, s96, s97
    buffer_load_dwordx4 v[196:199], v155, s[4:7], s96 offen
sk_64:
    ds_read_b128 v[104:107], v20 offset:0
    ds_read_b128 v[108:111], v20 offset:1024
    s_cmp_eq_u32 s99, 6
    s_cbranch_scc0 ng_65
    v_mov_b32 v24, 0xf149f2ca
    v_mov_b32 v25, 0xf149f2ca
    v_mov_b32 v26, 0xf149f2ca
    v_mov_b32 v27, 0xf149f2ca
    v_mov_b32 v28, 0xf149f2ca
    v_mov_b32 v29, 0xf149f2ca
    v_mov_b32 v30, 0xf149f2ca
    v_mov_b32 v31, 0xf149f2ca
    v_mov_b32 v32, 0xf149f2ca
    v_mov_b32 v33, 0xf149f2ca
    v_mov_b32 v34, 0xf149f2ca
    v_mov_b32 v35, 0xf149f2ca
    v_mov_b32 v36, 0xf149f2ca
    v_mov_b32 v37, 0xf149f2ca
    v_mov_b32 v38, 0xf149f2ca
    v_mov_b32 v39, 0xf149f2ca
ng_65:
    s_waitcnt lgkmcnt(2)
    s_nop 0
    v_mfma_f32_32x32x16_bf16 v[72:87], v[112:115], v[4:7], v[24:39]
    v_mfma_f32_32x32x16_bf16 v[72:87], v[116:119], v[8:11], v[72:87]
    v_max3_f32 v21, v21, v56, v57
    v_max3_f32 v21, v21, v58, v59
    v_max3_f32 v21, v21, v60, v61
    v_max3_f32 v21, v21, v62, v63
    v_max3_f32 v21, v21, v64, v65
    v_max3_f32 v21, v21, v66, v67
    v_max3_f32 v21, v21, v68, v69
    v_max3_f32 v21, v21, v70, v71
    s_cmp_lg_u32 s26, 0
    s_cbranch_scc1 sk_66
    s_xor_b32 s96, s29, 1
    s_and_b32 s97, s96, 2
    s_and_b32 s96, s96, 3
    s_mul_i32 s97, s97, 14336
    s_mul_i32 s96, s96, 14336
    s_add_u32 s96, s96, s97
    s_add_u32 s96, s96, 7168
    buffer_load_dwordx4 v[200:203], v155, s[4:7], s96 offen
sk_66:
    s_cmp_eq_u32 s99, 7
    s_cbranch_scc0 ng_67
    v_mov_b32 v24, 0xf149f2ca
    v_mov_b32 v25, 0xf149f2ca
    v_mov_b32 v26, 0xf149f2ca
    v_mov_b32 v27, 0xf149f2ca
    v_mov_b32 v28, 0xf149f2ca
    v_mov_b32 v29, 0xf149f2ca
    v_mov_b32 v30, 0xf149f2ca
    v_mov_b32 v31, 0xf149f2ca
    v_mov_b32 v32, 0xf149f2ca
    v_mov_b32 v33, 0xf149f2ca
    v_mov_b32 v34, 0xf149f2ca
    v_mov_b32 v35, 0xf149f2ca
    v_mov_b32 v36, 0xf149f2ca
    v_mov_b32 v37, 0xf149f2ca
    v_mov_b32 v38, 0xf149f2ca
    v_mov_b32 v39, 0xf149f2ca
ng_67:
    s_waitcnt lgkmcnt(0)
    s_nop 0
    v_mfma_f32_32x32x16_bf16 v[56:71], v[104:107], v[4:7], v[24:39]
    v_mfma_f32_32x32x16_bf16 v[56:71], v[108:111], v[8:11], v[56:71]
    v_max3_f32 v21, v21, v72, v73
    v_max3_f32 v21, v21, v74, v75
    v_max3_f32 v21, v21, v76, v77
    v_max3_f32 v21, v21, v78, v79
    v_max3_f32 v21, v21, v80, v81
    v_max3_f32 v21, v21, v82, v83
    v_max3_f32 v21, v21, v84, v85
    v_max3_f32 v21, v21, v86, v87
    s_cmp_lg_u32 s26, 0
    s_cbranch_scc1 sk_68
    s_xor_b32 s96, s29, 2
    s_and_b32 s97, s96, 2
    s_and_b32 s96, s96, 3
    s_mul_i32 s97, s97, 14336
    s_mul_i32 s96, s96, 14336
    s_add_u32 s96, s96, s97
    buffer_load_dwordx4 v[204:207], v155, s[4:7], s96 offen
sk_68:
    ds_read_b128 v[112:115], v20 offset:28672
    ds_read_b128 v[116:119], v20 offset:29696
    ds_read_b128 v[120:123], v20 offset:34816
    ds_read_b128 v[124:127], v20 offset:35840
    ds_read_b128 v[128:131], v20 offset:2048
    ds_read_b128 v[132:135], v20 offset:3072
    v_cndmask_b32 v40, v56, v40, s[40:41]
    v_cndmask_b32 v41, v57, v41, s[42:43]
    v_cndmask_b32 v42, v58, v42, s[44:45]
    v_cndmask_b32 v43, v59, v43, s[46:47]
    v_cndmask_b32 v44, v60, v44, s[48:49]
    v_cndmask_b32 v45, v61, v45, s[50:51]
    v_cndmask_b32 v46, v62, v46, s[52:53]
    v_cndmask_b32 v47, v63, v47, s[54:55]
    v_cndmask_b32 v48, v64, v48, s[56:57]
    v_cndmask_b32 v49, v65, v49, s[58:59]
    v_cndmask_b32 v50, v66, v50, s[60:61]
    v_cndmask_b32 v51, v67, v51, s[62:63]
    v_cndmask_b32 v52, v68, v52, s[64:65]
    v_cndmask_b32 v53, v69, v53, s[66:67]
    v_cndmask_b32 v54, v70, v54, s[68:69]
    v_cndmask_b32 v55, v71, v55, s[70:71]
    v_max3_f32 v21, v21, v40, v41
    v_max3_f32 v21, v21, v42, v43
    v_max3_f32 v21, v21, v44, v45
    v_max3_f32 v21, v21, v46, v47
    v_max3_f32 v21, v21, v48, v49
    v_max3_f32 v21, v21, v50, v51
    v_max3_f32 v21, v21, v52, v53
    v_max3_f32 v21, v21, v54, v55
    v_mov_b32 v152, v21
    s_nop 1
    v_permlane32_swap_b32 v21, v152
    v_max_f32 v21, v21, v152
    v_sub_f32 v24, 0, v21
    v_sub_f32 v25, 0, v21
    v_sub_f32 v26, 0, v21
    v_sub_f32 v27, 0, v21
    v_sub_f32 v28, 0, v21
    v_sub_f32 v29, 0, v21
    v_sub_f32 v30, 0, v21
    v_sub_f32 v31, 0, v21
    v_sub_f32 v32, 0, v21
    v_sub_f32 v33, 0, v21
    v_sub_f32 v34, 0, v21
    v_sub_f32 v35, 0, v21
    v_sub_f32 v36, 0, v21
    v_sub_f32 v37, 0, v21
    v_sub_f32 v38, 0, v21
    v_sub_f32 v39, 0, v21
    s_cmp_eq_u32 s99, 0
    s_cbranch_scc0 ng_69
    v_mov_b32 v24, 0xf149f2ca
    v_mov_b32 v25, 0xf149f2ca
    v_mov_b32 v26, 0xf149f2ca
    v_mov_b32 v27, 0xf149f2ca
    v_mov_b32 v28, 0xf149f2ca
    v_mov_b32 v29, 0xf149f2ca
    v_mov_b32 v30, 0xf149f2ca
    v_mov_b32 v31, 0xf149f2ca
    v_mov_b32 v32, 0xf149f2ca
    v_mov_b32 v33, 0xf149f2ca
    v_mov_b32 v34, 0xf149f2ca
    v_mov_b32 v35, 0xf149f2ca
    v_mov_b32 v36, 0xf149f2ca
    v_mov_b32 v37, 0xf149f2ca
    v_mov_b32 v38, 0xf149f2ca
    v_mov_b32 v39, 0xf149f2ca
ng_69:
    s_waitcnt lgkmcnt(4)
    s_nop 0
    v_mfma_f32_32x32x16_bf16 v[72:87], v[112:115], v[4:7], v[24:39]
    v_mfma_f32_32x32x16_bf16 v[72:87], v[116:119], v[8:11], v[72:87]
    ds_read_b128 v[104:107], v20 offset:24576
    ds_read_b128 v[108:111], v20 offset:25600
    v_sub_f32 v40, v40, v21
    v_sub_f32 v41, v41, v21
    v_sub_f32 v42, v42, v21
    v_sub_f32 v43, v43, v21
    v_sub_f32 v44, v44, v21
    v_sub_f32 v45, v45, v21
    v_sub_f32 v46, v46, v21
    v_sub_f32 v47, v47, v21
    v_sub_f32 v48, v48, v21
    v_sub_f32 v49, v49, v21
    v_sub_f32 v50, v50, v21
    v_sub_f32 v51, v51, v21
    v_sub_f32 v52, v52, v21
    v_sub_f32 v53, v53, v21
    v_sub_f32 v54, v54, v21
    v_sub_f32 v55, v55, v21
    v_exp_f32 v40, v40
    v_exp_f32 v41, v41
    v_exp_f32 v42, v42
    v_exp_f32 v43, v43
    v_exp_f32 v44, v44
    v_exp_f32 v45, v45
    v_exp_f32 v46, v46
    v_exp_f32 v47, v47
    v_exp_f32 v48, v48
    v_exp_f32 v49, v49
    v_exp_f32 v50, v50
    v_exp_f32 v51, v51
    v_exp_f32 v52, v52
    v_exp_f32 v53, v53
    v_exp_f32 v54, v54
    v_exp_f32 v55, v55
    v_add_f32 v22, v40, v41
    v_add_f32 v23, v42, v43
    v_add_f32 v22, v22, v44
    v_add_f32 v23, v23, v45
    v_add_f32 v22, v22, v46
    v_add_f32 v23, v23, v47
    v_add_f32 v22, v22, v48
    v_add_f32 v23, v23, v49
    v_add_f32 v22, v22, v50
    v_add_f32 v23, v23, v51
    v_add_f32 v22, v22, v52
    v_add_f32 v23, v23, v53
    v_add_f32 v22, v22, v54
    v_add_f32 v23, v23, v55
    v_cvt_pk_bf16_f32 v144, v40, v41
    v_cvt_pk_bf16_f32 v145, v42, v43
    v_cvt_pk_bf16_f32 v146, v44, v45
    v_cvt_pk_bf16_f32 v147, v46, v47
    v_cvt_pk_bf16_f32 v148, v48, v49
    v_cvt_pk_bf16_f32 v149, v50, v51
    v_cvt_pk_bf16_f32 v150, v52, v53
    v_cvt_pk_bf16_f32 v151, v54, v55
    v_and_b32 v136, v144, v12
    v_and_b32 v137, v145, v13
    v_and_b32 v138, v146, v14
    v_and_b32 v139, v147, v15
    v_and_b32 v140, v148, v16
    v_and_b32 v141, v149, v17
    v_and_b32 v142, v150, v18
    v_and_b32 v143, v151, v19
    v_xor_b32 v144, v144, v136
    v_xor_b32 v145, v145, v137
    v_xor_b32 v146, v146, v138
    v_xor_b32 v147, v147, v139
    v_xor_b32 v148, v148, v140
    v_xor_b32 v149, v149, v141
    v_xor_b32 v150, v150, v142
    v_xor_b32 v151, v151, v143
    s_waitcnt lgkmcnt(2)
    v_mfma_f32_32x32x16_bf16 v[88:103], v[120:123], v[136:139], 0
    v_mfma_f32_32x32x16_bf16 v[88:103], v[124:127], v[140:143], v[88:103]
    v_mfma_f32_32x32x16_bf16 v[88:103], v[128:131], v[144:147], v[88:103]
    v_mfma_f32_32x32x16_bf16 v[88:103], v[132:135], v[148:151], v[88:103]
    s_cmp_lg_u32 s26, 0
    s_cbranch_scc1 sk_70
    s_xor_b32 s96, s29, 2
    s_and_b32 s97, s96, 2
    s_and_b32 s96, s96, 3
    s_mul_i32 s97, s97, 14336
    s_mul_i32 s96, s96, 14336
    s_add_u32 s96, s96, s97
    s_add_u32 s96, s96, 7168
    buffer_load_dwordx4 v[208:211], v155, s[4:7], s96 offen
sk_70:
    ds_read_b128 v[128:131], v20 offset:30720
    ds_read_b128 v[132:135], v20 offset:31744
    s_cmp_eq_u32 s99, 1
    s_cbranch_scc0 ng_71
    v_mov_b32 v24, 0xf149f2ca
    v_mov_b32 v25, 0xf149f2ca
    v_mov_b32 v26, 0xf149f2ca
    v_mov_b32 v27, 0xf149f2ca
    v_mov_b32 v28, 0xf149f2ca
    v_mov_b32 v29, 0xf149f2ca
    v_mov_b32 v30, 0xf149f2ca
    v_mov_b32 v31, 0xf149f2ca
    v_mov_b32 v32, 0xf149f2ca
    v_mov_b32 v33, 0xf149f2ca
    v_mov_b32 v34, 0xf149f2ca
    v_mov_b32 v35, 0xf149f2ca
    v_mov_b32 v36, 0xf149f2ca
    v_mov_b32 v37, 0xf149f2ca
    v_mov_b32 v38, 0xf149f2ca
    v_mov_b32 v39, 0xf149f2ca
ng_71:
    s_waitcnt lgkmcnt(2)
    s_nop 0
    v_mfma_f32_32x32x16_bf16 v[56:71], v[104:107], v[4:7], v[24:39]
    v_mfma_f32_32x32x16_bf16 v[56:71], v[108:111], v[8:11], v[56:71]
    ds_read_b128 v[112:115], v20 offset:20480
    ds_read_b128 v[116:119], v20 offset:21504
    v_exp_f32 v72, v72
    v_exp_f32 v73, v73
    v_exp_f32 v74, v74
    v_exp_f32 v75, v75
    v_exp_f32 v76, v76
    v_exp_f32 v77, v77
    v_exp_f32 v78, v78
    v_exp_f32 v79, v79
    v_exp_f32 v80, v80
    v_exp_f32 v81, v81
    v_exp_f32 v82, v82
    v_exp_f32 v83, v83
    v_exp_f32 v84, v84
    v_exp_f32 v85, v85
    v_exp_f32 v86, v86
    v_exp_f32 v87, v87
    v_add_f32 v22, v22, v72
    v_add_f32 v23, v23, v73
    v_add_f32 v22, v22, v74
    v_add_f32 v23, v23, v75
    v_add_f32 v22, v22, v76
    v_add_f32 v23, v23, v77
    v_add_f32 v22, v22, v78
    v_add_f32 v23, v23, v79
    v_add_f32 v22, v22, v80
    v_add_f32 v23, v23, v81
    v_add_f32 v22, v22, v82
    v_add_f32 v23, v23, v83
    v_add_f32 v22, v22, v84
    v_add_f32 v23, v23, v85
    v_add_f32 v22, v22, v86
    v_add_f32 v23, v23, v87
    v_cvt_pk_bf16_f32 v144, v72, v73
    v_cvt_pk_bf16_f32 v145, v74, v75
    v_cvt_pk_bf16_f32 v146, v76, v77
    v_cvt_pk_bf16_f32 v147, v78, v79
    v_cvt_pk_bf16_f32 v148, v80, v81
    v_cvt_pk_bf16_f32 v149, v82, v83
    v_cvt_pk_bf16_f32 v150, v84, v85
    v_cvt_pk_bf16_f32 v151, v86, v87
    s_waitcnt lgkmcnt(2)
    v_mfma_f32_32x32x16_bf16 v[88:103], v[128:131], v[144:147], v[88:103]
    v_mfma_f32_32x32x16_bf16 v[88:103], v[132:135], v[148:151], v[88:103]
    s_cmp_lg_u32 s26, 0
    s_cbranch_scc1 sk_72
    s_xor_b32 s96, s29, 3
    s_and_b32 s97, s96, 2
    s_and_b32 s96, s96, 3
    s_mul_i32 s97, s97, 14336
    s_mul_i32 s96, s96, 14336
    s_add_u32 s96, s96, s97
    buffer_load_dwordx4 v[212:215], v155, s[4:7], s96 offen
sk_72:
    ds_read_b128 v[120:123], v20 offset:26624
    ds_read_b128 v[124:127], v20 offset:27648
    s_cmp_eq_u32 s99, 2
    s_cbranch_scc0 ng_73
    v_mov_b32 v24, 0xf149f2ca
    v_mov_b32 v25, 0xf149f2ca
    v_mov_b32 v26, 0xf149f2ca
    v_mov_b32 v27, 0xf149f2ca
    v_mov_b32 v28, 0xf149f2ca
    v_mov_b32 v29, 0xf149f2ca
    v_mov_b32 v30, 0xf149f2ca
    v_mov_b32 v31, 0xf149f2ca
    v_mov_b32 v32, 0xf149f2ca
    v_mov_b32 v33, 0xf149f2ca
    v_mov_b32 v34, 0xf149f2ca
    v_mov_b32 v35, 0xf149f2ca
    v_mov_b32 v36, 0xf149f2ca
    v_mov_b32 v37, 0xf149f2ca
    v_mov_b32 v38, 0xf149f2ca
    v_mov_b32 v39, 0xf149f2ca
ng_73:
    s_waitcnt lgkmcnt(2)
    s_nop 0
    v_mfma_f32_32x32x16_bf16 v[72:87], v[112:115], v[4:7], v[24:39]
    v_mfma_f32_32x32x16_bf16 v[72:87], v[116:119], v[8:11], v[72:87]
    ds_read_b128 v[104:107], v20 offset:16384
    ds_read_b128 v[108:111], v20 offset:17408
    v_exp_f32 v56, v56
    v_exp_f32 v57, v57
    v_exp_f32 v58, v58
    v_exp_f32 v59, v59
    v_exp_f32 v60, v60
    v_exp_f32 v61, v61
    v_exp_f32 v62, v62
    v_exp_f32 v63, v63
    v_exp_f32 v64, v64
    v_exp_f32 v65, v65
    v_exp_f32 v66, v66
    v_exp_f32 v67, v67
    v_exp_f32 v68, v68
    v_exp_f32 v69, v69
    v_exp_f32 v70, v70
    v_exp_f32 v71, v71
    v_add_f32 v22, v22, v56
    v_add_f32 v23, v23, v57
    v_add_f32 v22, v22, v58
    v_add_f32 v23, v23, v59
    v_add_f32 v22, v22, v60
    v_add_f32 v23, v23, v61
    v_add_f32 v22, v22, v62
    v_add_f32 v23, v23, v63
    v_add_f32 v22, v22, v64
    v_add_f32 v23, v23, v65
    v_add_f32 v22, v22, v66
    v_add_f32 v23, v23, v67
    v_add_f32 v22, v22, v68
    v_add_f32 v23, v23, v69
    v_add_f32 v22, v22, v70
    v_add_f32 v23, v23, v71
    v_cvt_pk_bf16_f32 v136, v56, v57
    v_cvt_pk_bf16_f32 v137, v58, v59
    v_cvt_pk_bf16_f32 v138, v60, v61
    v_cvt_pk_bf16_f32 v139, v62, v63
    v_cvt_pk_bf16_f32 v140, v64, v65
    v_cvt_pk_bf16_f32 v141, v66, v67
    v_cvt_pk_bf16_f32 v142, v68, v69
    v_cvt_pk_bf16_f32 v143, v70, v71
    s_waitcnt lgkmcnt(2)
    v_mfma_f32_32x32x16_bf16 v[88:103], v[120:123], v[136:139], v[88:103]
    v_mfma_f32_32x32x16_bf16 v[88:103], v[124:127], v[140:143], v[88:103]
    s_cmp_lg_u32 s26, 0
    s_cbranch_scc1 sk_74
    s_xor_b32 s96, s29, 3
    s_and_b32 s97, s96, 2
    s_and_b32 s96, s96, 3
    s_mul_i32 s97, s97, 14336
    s_mul_i32 s96, s96, 14336
    s_add_u32 s96, s96, s97
    s_add_u32 s96, s96, 7168
    buffer_load_dwordx4 v[216:219], v155, s[4:7], s96 offen
sk_74:
    ds_read_b128 v[128:131], v20 offset:22528
    ds_read_b128 v[132:135], v20 offset:23552
    s_cmp_eq_u32 s99, 3
    s_cbranch_scc0 ng_75
    v_mov_b32 v24, 0xf149f2ca
    v_mov_b32 v25, 0xf149f2ca
    v_mov_b32 v26, 0xf149f2ca
    v_mov_b32 v27, 0xf149f2ca
    v_mov_b32 v28, 0xf149f2ca
    v_mov_b32 v29, 0xf149f2ca
    v_mov_b32 v30, 0xf149f2ca
    v_mov_b32 v31, 0xf149f2ca
    v_mov_b32 v32, 0xf149f2ca
    v_mov_b32 v33, 0xf149f2ca
    v_mov_b32 v34, 0xf149f2ca
    v_mov_b32 v35, 0xf149f2ca
    v_mov_b32 v36, 0xf149f2ca
    v_mov_b32 v37, 0xf149f2ca
    v_mov_b32 v38, 0xf149f2ca
    v_mov_b32 v39, 0xf149f2ca
ng_75:
    s_waitcnt lgkmcnt(2)
    s_nop 0
    v_mfma_f32_32x32x16_bf16 v[56:71], v[104:107], v[4:7], v[24:39]
    v_mfma_f32_32x32x16_bf16 v[56:71], v[108:111], v[8:11], v[56:71]
    ds_read_b128 v[112:115], v20 offset:12288
    ds_read_b128 v[116:119], v20 offset:13312
    v_exp_f32 v72, v72
    v_exp_f32 v73, v73
    v_exp_f32 v74, v74
    v_exp_f32 v75, v75
    v_exp_f32 v76, v76
    v_exp_f32 v77, v77
    v_exp_f32 v78, v78
    v_exp_f32 v79, v79
    v_exp_f32 v80, v80
    v_exp_f32 v81, v81
    v_exp_f32 v82, v82
    v_exp_f32 v83, v83
    v_exp_f32 v84, v84
    v_exp_f32 v85, v85
    v_exp_f32 v86, v86
    v_exp_f32 v87, v87
    v_add_f32 v22, v22, v72
    v_add_f32 v23, v23, v73
    v_add_f32 v22, v22, v74
    v_add_f32 v23, v23, v75
    v_add_f32 v22, v22, v76
    v_add_f32 v23, v23, v77
    v_add_f32 v22, v22, v78
    v_add_f32 v23, v23, v79
    v_add_f32 v22, v22, v80
    v_add_f32 v23, v23, v81
    v_add_f32 v22, v22, v82
    v_add_f32 v23, v23, v83
    v_add_f32 v22, v22, v84
    v_add_f32 v23, v23, v85
    v_add_f32 v22, v22, v86
    v_add_f32 v23, v23, v87
    v_cvt_pk_bf16_f32 v144, v72, v73
    v_cvt_pk_bf16_f32 v145, v74, v75
    v_cvt_pk_bf16_f32 v146, v76, v77
    v_cvt_pk_bf16_f32 v147, v78, v79
    v_cvt_pk_bf16_f32 v148, v80, v81
    v_cvt_pk_bf16_f32 v149, v82, v83
    v_cvt_pk_bf16_f32 v150, v84, v85
    v_cvt_pk_bf16_f32 v151, v86, v87
    s_waitcnt lgkmcnt(2)
    v_mfma_f32_32x32x16_bf16 v[88:103], v[128:131], v[144:147], v[88:103]
    v_mfma_f32_32x32x16_bf16 v[88:103], v[132:135], v[148:151], v[88:103]
    ds_read_b128 v[120:123], v20 offset:18432
    ds_read_b128 v[124:127], v20 offset:19456
    s_cmp_eq_u32 s99, 4
    s_cbranch_scc0 ng_76
    v_mov_b32 v24, 0xf149f2ca
    v_mov_b32 v25, 0xf149f2ca
    v_mov_b32 v26, 0xf149f2ca
    v_mov_b32 v27, 0xf149f2ca
    v_mov_b32 v28, 0xf149f2ca
    v_mov_b32 v29, 0xf149f2ca
    v_mov_b32 v30, 0xf149f2ca
    v_mov_b32 v31, 0xf149f2ca
    v_mov_b32 v32, 0xf149f2ca
    v_mov_b32 v33, 0xf149f2ca
    v_mov_b32 v34, 0xf149f2ca
    v_mov_b32 v35, 0xf149f2ca
    v_mov_b32 v36, 0xf149f2ca
    v_mov_b32 v37, 0xf149f2ca
    v_mov_b32 v38, 0xf149f2ca
    v_mov_b32 v39, 0xf149f2ca
ng_76:
    s_waitcnt lgkmcnt(2)
    s_nop 0
    v_mfma_f32_32x32x16_bf16 v[72:87], v[112:115], v[4:7], v[24:39]
    v_mfma_f32_32x32x16_bf16 v[72:87], v[116:119], v[8:11], v[72:87]
    ds_read_b128 v[104:107], v20 offset:8192
    ds_read_b128 v[108:111], v20 offset:9216
    v_exp_f32 v56, v56
    v_exp_f32 v57, v57
    v_exp_f32 v58, v58
    v_exp_f32 v59, v59
    v_exp_f32 v60, v60
    v_exp_f32 v61, v61
    v_exp_f32 v62, v62
    v_exp_f32 v63, v63
    v_exp_f32 v64, v64
    v_exp_f32 v65, v65
    v_exp_f32 v66, v66
    v_exp_f32 v67, v67
    v_exp_f32 v68, v68
    v_exp_f32 v69, v69
    v_exp_f32 v70, v70
    v_exp_f32 v71, v71
    v_add_f32 v22, v22, v56
    v_add_f32 v23, v23, v57
    v_add_f32 v22, v22, v58
    v_add_f32 v23, v23, v59
    v_add_f32 v22, v22, v60
    v_add_f32 v23, v23, v61
    v_add_f32 v22, v22, v62
    v_add_f32 v23, v23, v63
    v_add_f32 v22, v22, v64
    v_add_f32 v23, v23, v65
    v_add_f32 v22, v22, v66
    v_add_f32 v23, v23, v67
    v_add_f32 v22, v22, v68
    v_add_f32 v23, v23, v69
    v_add_f32 v22, v22, v70
    v_add_f32 v23, v23, v71
    v_cvt_pk_bf16_f32 v136, v56, v57
    v_cvt_pk_bf16_f32 v137, v58, v59
    v_cvt_pk_bf16_f32 v138, v60, v61
    v_cvt_pk_bf16_f32 v139, v62, v63
    v_cvt_pk_bf16_f32 v140, v64, v65
    v_cvt_pk_bf16_f32 v141, v66, v67
    v_cvt_pk_bf16_f32 v142, v68, v69
    v_cvt_pk_bf16_f32 v143, v70, v71
    s_waitcnt lgkmcnt(2)
    v_mfma_f32_32x32x16_bf16 v[88:103], v[120:123], v[136:139], v[88:103]
    v_mfma_f32_32x32x16_bf16 v[88:103], v[124:127], v[140:143], v[88:103]
    s_barrier
    ds_read_b128 v[128:131], v20 offset:14336
    ds_read_b128 v[132:135], v20 offset:15360
    s_cmp_eq_u32 s99, 5
    s_cbranch_scc0 ng_77
    v_mov_b32 v24, 0xf149f2ca
    v_mov_b32 v25, 0xf149f2ca
    v_mov_b32 v26, 0xf149f2ca
    v_mov_b32 v27, 0xf149f2ca
    v_mov_b32 v28, 0xf149f2ca
    v_mov_b32 v29, 0xf149f2ca
    v_mov_b32 v30, 0xf149f2ca
    v_mov_b32 v31, 0xf149f2ca
    v_mov_b32 v32, 0xf149f2ca
    v_mov_b32 v33, 0xf149f2ca
    v_mov_b32 v34, 0xf149f2ca
    v_mov_b32 v35, 0xf149f2ca
    v_mov_b32 v36, 0xf149f2ca
    v_mov_b32 v37, 0xf149f2ca
    v_mov_b32 v38, 0xf149f2ca
    v_mov_b32 v39, 0xf149f2ca
ng_77:
    s_waitcnt lgkmcnt(2)
    s_nop 0
    v_mfma_f32_32x32x16_bf16 v[56:71], v[104:107], v[4:7], v[24:39]
    v_mfma_f32_32x32x16_bf16 v[56:71], v[108:111], v[8:11], v[56:71]
    ds_read_b128 v[112:115], v20 offset:4096
    ds_read_b128 v[116:119], v20 offset:5120
    v_exp_f32 v72, v72
    v_exp_f32 v73, v73
    v_exp_f32 v74, v74
    v_exp_f32 v75, v75
    v_exp_f32 v76, v76
    v_exp_f32 v77, v77
    v_exp_f32 v78, v78
    v_exp_f32 v79, v79
    v_exp_f32 v80, v80
    v_exp_f32 v81, v81
    v_exp_f32 v82, v82
    v_exp_f32 v83, v83
    v_exp_f32 v84, v84
    v_exp_f32 v85, v85
    v_exp_f32 v86, v86
    v_exp_f32 v87, v87
    v_add_f32 v22, v22, v72
    v_add_f32 v23, v23, v73
    v_add_f32 v22, v22, v74
    v_add_f32 v23, v23, v75
    v_add_f32 v22, v22, v76
    v_add_f32 v23, v23, v77
    v_add_f32 v22, v22, v78
    v_add_f32 v23, v23, v79
    v_add_f32 v22, v22, v80
    v_add_f32 v23, v23, v81
    v_add_f32 v22, v22, v82
    v_add_f32 v23, v23, v83
    v_add_f32 v22, v22, v84
    v_add_f32 v23, v23, v85
    v_add_f32 v22, v22, v86
    v_add_f32 v23, v23, v87
    v_cvt_pk_bf16_f32 v144, v72, v73
    v_cvt_pk_bf16_f32 v145, v74, v75
    v_cvt_pk_bf16_f32 v146, v76, v77
    v_cvt_pk_bf16_f32 v147, v78, v79
    v_cvt_pk_bf16_f32 v148, v80, v81
    v_cvt_pk_bf16_f32 v149, v82, v83
    v_cvt_pk_bf16_f32 v150, v84, v85
    v_cvt_pk_bf16_f32 v151, v86, v87
    s_waitcnt lgkmcnt(2)
    v_mfma_f32_32x32x16_bf16 v[88:103], v[128:131], v[144:147], v[88:103]
    v_mfma_f32_32x32x16_bf16 v[88:103], v[132:135], v[148:151], v[88:103]
    ds_read_b128 v[120:123], v20 offset:10240
    ds_read_b128 v[124:127], v20 offset:11264
    s_cmp_eq_u32 s99, 6
    s_cbranch_scc0 ng_78
    v_mov_b32 v24, 0xf149f2ca
    v_mov_b32 v25, 0xf149f2ca
    v_mov_b32 v26, 0xf149f2ca
    v_mov_b32 v27, 0xf149f2ca
    v_mov_b32 v28, 0xf149f2ca
    v_mov_b32 v29, 0xf149f2ca
    v_mov_b32 v30, 0xf149f2ca
    v_mov_b32 v31, 0xf149f2ca
    v_mov_b32 v32, 0xf149f2ca
    v_mov_b32 v33, 0xf149f2ca
    v_mov_b32 v34, 0xf149f2ca
    v_mov_b32 v35, 0xf149f2ca
    v_mov_b32 v36, 0xf149f2ca
    v_mov_b32 v37, 0xf149f2ca
    v_mov_b32 v38, 0xf149f2ca
    v_mov_b32 v39, 0xf149f2ca
ng_78:
    s_waitcnt lgkmcnt(2)
    s_nop 0
    v_mfma_f32_32x32x16_bf16 v[72:87], v[112:115], v[4:7], v[24:39]
    v_mfma_f32_32x32x16_bf16 v[72:87], v[116:119], v[8:11], v[72:87]
    v_exp_f32 v56, v56
    v_exp_f32 v57, v57
    v_exp_f32 v58, v58
    v_exp_f32 v59, v59
    v_exp_f32 v60, v60
    v_exp_f32 v61, v61
    v_exp_f32 v62, v62
    v_exp_f32 v63, v63
    v_exp_f32 v64, v64
    v_exp_f32 v65, v65
    v_exp_f32 v66, v66
    v_exp_f32 v67, v67
    v_exp_f32 v68, v68
    v_exp_f32 v69, v69
    v_exp_f32 v70, v70
    v_exp_f32 v71, v71
    v_add_f32 v22, v22, v56
    v_add_f32 v23, v23, v57
    v_add_f32 v22, v22, v58
    v_add_f32 v23, v23, v59
    v_add_f32 v22, v22, v60
    v_add_f32 v23, v23, v61
    v_add_f32 v22, v22, v62
    v_add_f32 v23, v23, v63
    v_add_f32 v22, v22, v64
    v_add_f32 v23, v23, v65
    v_add_f32 v22, v22, v66
    v_add_f32 v23, v23, v67
    v_add_f32 v22, v22, v68
    v_add_f32 v23, v23, v69
    v_add_f32 v22, v22, v70
    v_add_f32 v23, v23, v71
    v_cvt_pk_bf16_f32 v136, v56, v57
    v_cvt_pk_bf16_f32 v137, v58, v59
    v_cvt_pk_bf16_f32 v138, v60, v61
    v_cvt_pk_bf16_f32 v139, v62, v63
    v_cvt_pk_bf16_f32 v140, v64, v65
    v_cvt_pk_bf16_f32 v141, v66, v67
    v_cvt_pk_bf16_f32 v142, v68, v69
    v_cvt_pk_bf16_f32 v143, v70, v71
    s_waitcnt lgkmcnt(0)
    v_mfma_f32_32x32x16_bf16 v[88:103], v[120:123], v[136:139], v[88:103]
    v_mfma_f32_32x32x16_bf16 v[88:103], v[124:127], v[140:143], v[88:103]
    ds_read_b128 v[128:131], v20 offset:6144
    ds_read_b128 v[132:135], v20 offset:7168
    v_exp_f32 v72, v72
    v_exp_f32 v73, v73
    v_exp_f32 v74, v74
    v_exp_f32 v75, v75
    v_exp_f32 v76, v76
    v_exp_f32 v77, v77
    v_exp_f32 v78, v78
    v_exp_f32 v79, v79
    v_exp_f32 v80, v80
    v_exp_f32 v81, v81
    v_exp_f32 v82, v82
    v_exp_f32 v83, v83
    v_exp_f32 v84, v84
    v_exp_f32 v85, v85
    v_exp_f32 v86, v86
    v_exp_f32 v87, v87
    v_add_f32 v22, v22, v72
    v_add_f32 v23, v23, v73
    v_add_f32 v22, v22, v74
    v_add_f32 v23, v23, v75
    v_add_f32 v22, v22, v76
    v_add_f32 v23, v23, v77
    v_add_f32 v22, v22, v78
    v_add_f32 v23, v23, v79
    v_add_f32 v22, v22, v80
    v_add_f32 v23, v23, v81
    v_add_f32 v22, v22, v82
    v_add_f32 v23, v23, v83
    v_add_f32 v22, v22, v84
    v_add_f32 v23, v23, v85
    v_add_f32 v22, v22, v86
    v_add_f32 v23, v23, v87
    v_cvt_pk_bf16_f32 v144, v72, v73
    v_cvt_pk_bf16_f32 v145, v74, v75
    v_cvt_pk_bf16_f32 v146, v76, v77
    v_cvt_pk_bf16_f32 v147, v78, v79
    v_cvt_pk_bf16_f32 v148, v80, v81
    v_cvt_pk_bf16_f32 v149, v82, v83
    v_cvt_pk_bf16_f32 v150, v84, v85
    v_cvt_pk_bf16_f32 v151, v86, v87
    s_waitcnt lgkmcnt(0)
    v_mfma_f32_32x32x16_bf16 v[88:103], v[128:131], v[144:147], v[88:103]
    v_mfma_f32_32x32x16_bf16 v[88:103], v[132:135], v[148:151], v[88:103]
    v_add_f32 v22, v22, v23
    v_mov_b32 v152, v22
    s_nop 1
    v_permlane32_swap_b32 v22, v152
    v_add_f32 v22, v22, v152
    v_rcp_f32 v22, v22
    s_lshl_b32 s36, s99, 16
    s_add_u32 s36, s36, s26
    s_add_u32 s36, s36, 0x808000
    s_lshl_b32 s33, s25, 11
    s_add_u32 s33, s33, s36
    s_lshl_b32 s30, s24, 9
    s_lshl_b32 s31, s3, 6
    s_add_u32 s30, s30, s31
    s_add_u32 s30, s30, s26
    s_add_u32 s30, s30, 0xdd2000
    s_lshl_b32 s31, s25, 2
    s_add_u32 s31, s31, s30
    v_pk_mul_f32 v[88:89], v[88:89], v[22:23] op_sel_hi:[1,0]
    v_pk_mul_f32 v[90:91], v[90:91], v[22:23] op_sel_hi:[1,0]
    v_pk_mul_f32 v[92:93], v[92:93], v[22:23] op_sel_hi:[1,0]
    v_pk_mul_f32 v[94:95], v[94:95], v[22:23] op_sel_hi:[1,0]
    v_pk_mul_f32 v[96:97], v[96:97], v[22:23] op_sel_hi:[1,0]
    v_pk_mul_f32 v[98:99], v[98:99], v[22:23] op_sel_hi:[1,0]
    v_pk_mul_f32 v[100:101], v[100:101], v[22:23] op_sel_hi:[1,0]
    v_pk_mul_f32 v[102:103], v[102:103], v[22:23] op_sel_hi:[1,0]
    v_cvt_pk_bf16_f32 v88, v88, v89
    v_cvt_pk_bf16_f32 v89, v90, v91
    v_cvt_pk_bf16_f32 v90, v92, v93
    v_cvt_pk_bf16_f32 v91, v94, v95
    v_cvt_pk_bf16_f32 v92, v96, v97
    v_cvt_pk_bf16_f32 v93, v98, v99
    v_cvt_pk_bf16_f32 v94, v100, v101
    v_cvt_pk_bf16_f32 v95, v102, v103
    s_cmp_lg_u32 s77, 0
    s_cbranch_scc1 lc_79
    buffer_store_dwordx4 v[88:91], v253, s[20:23], s33 offen sc1
    buffer_store_dwordx4 v[92:95], v253, s[20:23], s33 offen offset:1024 sc1
    s_branch lc_80
lc_79:
    buffer_store_dwordx4 v[88:91], v253, s[20:23], s33 offen
    buffer_store_dwordx4 v[92:95], v253, s[20:23], s33 offen offset:1024
lc_80:
    v_mov_b32 v154, s88
    s_mov_b64 exec, 1
    s_waitcnt vmcnt(0)
    s_cmp_lg_u32 s77, 0
    s_cbranch_scc1 lc_81
    buffer_store_dword v154, v253, s[20:23], s31 offen sc1
    s_branch lc_82
lc_81:
    buffer_store_dword v154, v253, s[20:23], s31 offen
lc_82:
    s_mov_b64 exec, -1
    v_bfe_u32 v20, v252, 3, 2
    v_lshrrev_b32 v21, 5, v252
    v_lshl_add_u32 v20, v21, 3, v20
    s_lshr_b32 s32, s28, 1
    s_lshl_b32 s32, s32, 4
    s_and_b32 s33, s28, 1
    s_lshl_b32 s33, s33, 2
    s_add_u32 s32, s32, s33
    v_add_u32 v20, s32, v20
    v_lshlrev_b32 v20, 11, v20
    v_lshrrev_b32 v21, 2, v252
    v_and_b32 v21, 4, v21
    v_xor_b32 v21, v21, v252
    v_and_b32 v21, 7, v21
    v_lshl_add_u32 v20, v21, 4, v20
    s_lshl_b32 s32, s98, 7
    v_add_u32 v14, s32, v20
    s_lshl_b32 s32, s28, 9
    s_sub_u32 s34, s29, 224
    s_lshl_b32 s34, s34, 1
    s_add_u32 s89, s34, s28
    s_and_b32 s35, s28, 1
    s_add_u32 s34, s34, s35
    s_lshl_b32 s34, s34, 5
    v_lshrrev_b32 v22, 1, v252
    v_and_b32 v23, 1, v252
    s_cmp_lt_u32 s29, 224
    s_cselect_b32 s32, s32, s34
    s_cselect_b64 vcc, -1, 0
    v_cndmask_b32 v22, v23, v22, vcc
    v_lshl_add_u32 v22, v22, 4, s32
    s_mov_b32 s79, s26
    s_cmp_lg_u32 s26, 0
    s_cbranch_scc1 sk_83
    s_lshr_b32 s30, s16, 7
    s_sub_u32 s30, 3, s30
    s_and_b32 s30, s30, 7
    s_and_b32 s31, s24, 1
    s_lshl_b32 s31, s31, 3
    s_add_u32 s30, s30, s31
    s_and_b32 s31, s24, 14
    s_add_u32 s35, s31, s30
    s_lshl_b32 s31, s25, 2
    s_add_u32 s31, s31, s28
    s_mul_i32 s31, s31, 6144
    s_lshl_b32 s30, s30, 7
    s_add_u32 s30, s30, s31
    v_min_u32 v18, 2, v252
    v_lshl_add_u32 v18, v18, 11, s30
    s_add_u32 s30, s35, 14
    s_and_b32 s30, s30, 15
    s_mul_i32 s30, s30, 393216
    buffer_load_dword v19, v18, s[16:19], s30 offen
    s_add_u32 s30, s35, 15
    s_and_b32 s30, s30, 15
    s_mul_i32 s30, s30, 393216
    buffer_load_dword v19, v18, s[16:19], s30 offen
    s_add_u32 s30, s35, 0
    s_and_b32 s30, s30, 15
    s_mul_i32 s30, s30, 393216
    buffer_load_dword v19, v18, s[16:19], s30 offen
    s_add_u32 s30, s35, 1
    s_and_b32 s30, s30, 15
    s_mul_i32 s30, s30, 393216
    buffer_load_dword v19, v18, s[16:19], s30 offen
    s_add_u32 s30, s35, 2
    s_and_b32 s30, s30, 15
    s_mul_i32 s30, s30, 393216
    buffer_load_dword v19, v18, s[16:19], s30 offen
    s_add_u32 s30, s35, 3
    s_and_b32 s30, s30, 15
    s_mul_i32 s30, s30, 393216
    buffer_load_dword v19, v18, s[16:19], s30 offen
    s_mov_b32 s30, 0x05040100
    s_mov_b32 s31, 0x07060302
    v_perm_b32 v155, v160, v156, s30
    v_perm_b32 v160, v160, v156, s31
    v_perm_b32 v156, v161, v157, s30
    v_perm_b32 v161, v161, v157, s31
    v_perm_b32 v157, v162, v158, s30
    v_perm_b32 v162, v162, v158, s31
    v_perm_b32 v158, v163, v159, s30
    v_perm_b32 v163, v163, v159, s31
    v_perm_b32 v159, v168, v164, s30
    v_perm_b32 v168, v168, v164, s31
    v_perm_b32 v164, v169, v165, s30
    v_perm_b32 v169, v169, v165, s31
    v_perm_b32 v165, v170, v166, s30
    v_perm_b32 v170, v170, v166, s31
    v_perm_b32 v166, v171, v167, s30
    v_perm_b32 v171, v171, v167, s31
    v_perm_b32 v167, v176, v172, s30
    v_perm_b32 v176, v176, v172, s31
    v_perm_b32 v172, v177, v173, s30
    v_perm_b32 v177, v177, v173, s31
    v_perm_b32 v173, v178, v174, s30
    v_perm_b32 v178, v178, v174, s31
    v_perm_b32 v174, v179, v175, s30
    v_perm_b32 v179, v179, v175, s31
    v_perm_b32 v175, v184, v180, s30
    v_perm_b32 v184, v184, v180, s31
    v_perm_b32 v180, v185, v181, s30
    v_perm_b32 v185, v185, v181, s31
    v_perm_b32 v181, v186, v182, s30
    v_perm_b32 v186, v186, v182, s31
    v_perm_b32 v182, v187, v183, s30
    v_perm_b32 v187, v187, v183, s31
    v_perm_b32 v183, v192, v188, s30
    v_perm_b32 v192, v192, v188, s31
    v_perm_b32 v188, v193, v189, s30
    v_perm_b32 v193, v193, v189, s31
    v_perm_b32 v189, v194, v190, s30
    v_perm_b32 v194, v194, v190, s31
    v_perm_b32 v190, v195, v191, s30
    v_perm_b32 v195, v195, v191, s31
    v_perm_b32 v191, v200, v196, s30
    v_perm_b32 v200, v200, v196, s31
    v_perm_b32 v196, v201, v197, s30
    v_perm_b32 v201, v201, v197, s31
    v_perm_b32 v197, v202, v198, s30
    v_perm_b32 v202, v202, v198, s31
    v_perm_b32 v198, v203, v199, s30
    v_perm_b32 v203, v203, v199, s31
    v_perm_b32 v199, v208, v204, s30
    v_perm_b32 v208, v208, v204, s31
    v_perm_b32 v204, v209, v205, s30
    v_perm_b32 v209, v209, v205, s31
    v_perm_b32 v205, v210, v206, s30
    v_perm_b32 v210, v210, v206, s31
    v_perm_b32 v206, v211, v207, s30
    v_perm_b32 v211, v211, v207, s31
    v_perm_b32 v207, v216, v212, s30
    v_perm_b32 v216, v216, v212, s31
    v_perm_b32 v212, v217, v213, s30
    v_perm_b32 v217, v217, v213, s31
    v_perm_b32 v213, v218, v214, s30
    v_perm_b32 v218, v218, v214, s31
    v_perm_b32 v214, v219, v215, s30
    v_perm_b32 v219, v219, v215, s31
    v_perm_b32 v215, v224, v220, s30
    v_perm_b32 v224, v224, v220, s31
    v_perm_b32 v220, v225, v221, s30
    v_perm_b32 v225, v225, v221, s31
    v_perm_b32 v221, v226, v222, s30
    v_perm_b32 v226, v226, v222, s31
    v_perm_b32 v222, v227, v223, s30
    v_perm_b32 v227, v227, v223, s31
    v_perm_b32 v223, v232, v228, s30
    v_perm_b32 v232, v232, v228, s31
    v_perm_b32 v228, v233, v229, s30
    v_perm_b32 v233, v233, v229, s31
    v_perm_b32 v229, v234, v230, s30
    v_perm_b32 v234, v234, v230, s31
    v_perm_b32 v230, v235, v231, s30
    v_perm_b32 v235, v235, v231, s31
    v_perm_b32 v231, v240, v236, s30
    v_perm_b32 v240, v240, v236, s31
    v_perm_b32 v236, v241, v237, s30
    v_perm_b32 v241, v241, v237, s31
    v_perm_b32 v237, v242, v238, s30
    v_perm_b32 v242, v242, v238, s31
    v_perm_b32 v238, v243, v239, s30
    v_perm_b32 v243, v243, v239, s31
    v_perm_b32 v239, v248, v244, s30
    v_perm_b32 v248, v248, v244, s31
    v_perm_b32 v244, v249, v245, s30
    v_perm_b32 v249, v249, v245, s31
    v_perm_b32 v245, v250, v246, s30
    v_perm_b32 v250, v250, v246, s31
    v_perm_b32 v246, v251, v247, s30
    v_perm_b32 v251, v251, v247, s31
    v_lshrrev_b32 v21, 3, v252
    s_lshl_b32 s84, s24, 18
    s_add_u32 s84, s84, s86
    s_add_u32 s84, s84, 0x2000000
    v_mul_u32_u24 v20, 6144, v21
    v_and_b32 v21, 6, v21
    v_xor_b32 v21, v21, v252
    v_and_b32 v21, 7, v21
    v_lshl_add_u32 v20, v21, 4, v20
    s_mul_i32 s32, s28, 3
    s_bfe_u32 s33, s32, 0x10001
    s_mul_i32 s33, s33, 196608
    s_and_b32 s34, s32, 1
    s_mul_i32 s34, s34, 49152
    s_add_u32 s33, s33, s34
    s_lshr_b32 s34, s32, 2
    s_lshl_b32 s34, s34, 11
    s_add_u32 s33, s33, s34
    v_add_u32 v8, s33, v20
    v_add_u32 v9, 97280, v8
    s_add_u32 s32, s32, 1
    s_bfe_u32 s33, s32, 0x10001
    s_mul_i32 s33, s33, 196608
    s_and_b32 s34, s32, 1
    s_mul_i32 s34, s34, 49152
    s_add_u32 s33, s33, s34
    s_lshr_b32 s34, s32, 2
    s_lshl_b32 s34, s34, 11
    s_add_u32 s33, s33, s34
    s_sub_u32 s33, s33, 2048
    v_add_u32 v10, s33, v20
    v_add_u32 v11, 97280, v10
    s_add_u32 s32, s32, 1
    s_bfe_u32 s33, s32, 0x10001
    s_mul_i32 s33, s33, 196608
    s_and_b32 s34, s32, 1
    s_mul_i32 s34, s34, 49152
    s_add_u32 s33, s33, s34
    s_lshr_b32 s34, s32, 2
    s_lshl_b32 s34, s34, 11
    s_add_u32 s33, s33, s34
    v_add_u32 v12, s33, v20
    v_add_u32 v13, 97280, v12
    s_sub_u32 s30, s95, 1
    s_sub_u32 s95, s94, 3
    s_mov_b32 s94, s30
    v_bfe_u32 v116, v252, 4, 1
    v_lshlrev_b32 v116, 11, v116
    v_lshrrev_b32 v117, 5, v252
    v_lshl_add_u32 v116, v117, 8, v116
    v_and_b32 v117, 15, v252
    v_lshl_add_u32 v116, v117, 4, v116
    s_lshl_b32 s34, s28, 12
    s_add_u32 s34, s34, 147456
    v_add_u32 v117, s34, v116
    v_and_b32 v16, 15, v252
    v_lshlrev_b32 v16, 9, v16
    s_load_dwordx2 s[12:13], s[0:1], 64
    s_mov_b32 s14, 0x400000
    s_mov_b32 s15, 0x20000
    s_waitcnt lgkmcnt(0)
sk_83:
    s_barrier
    s_add_u32 s96, s25, 12
    s_and_b32 s96, s96, 15
    s_lshl_b32 s96, s96, 17
    s_add_u32 s96, s96, 65536
    s_add_u32 m0, s101, 114688
    s_nop 0
    buffer_load_dwordx4 v14, s[8:11], s96 offen lds
    s_add_u32 s96, s25, 13
    s_and_b32 s96, s96, 15
    s_lshl_b32 s96, s96, 17
    s_add_u32 s96, s96, 65536
    s_add_u32 m0, s101, 118784
    s_nop 0
    buffer_load_dwordx4 v14, s[8:11], s96 offen lds
    s_add_u32 s96, s25, 14
    s_and_b32 s96, s96, 15
    s_lshl_b32 s96, s96, 17
    s_add_u32 s96, s96, 65536
    s_add_u32 m0, s101, 122880
    s_nop 0
    buffer_load_dwordx4 v14, s[8:11], s96 offen lds
    s_add_u32 s96, s25, 15
    s_and_b32 s96, s96, 15
    s_lshl_b32 s96, s96, 17
    s_add_u32 s96, s96, 65536
    s_add_u32 m0, s101, 126976
    s_nop 0
    buffer_load_dwordx4 v14, s[8:11], s96 offen lds
    s_waitcnt vmcnt(0)
    s_barrier
    s_cmp_lg_u32 s26, 0
    s_cbranch_scc1 l_tail
    s_mov_b32 s26, 16777216
    s_add_u32 s96, s94, 0
    s_and_b32 s96, s96, 15
    s_mul_i32 s96, s96, 393216
    s_add_u32 s96, s96, s85
    s_add_u32 m0, s87, 40960
    s_nop 0
    buffer_load_dwordx4 v8, s[16:19], s96 offen offset:0 lds
    buffer_load_dwordx4 v9, s[16:19], s96 offen offset:1024 lds
    buffer_load_dwordx4 v10, s[16:19], s96 offen offset:2048 lds
    buffer_load_dwordx4 v11, s[16:19], s96 offen offset:3072 lds
    s_add_u32 m0, s87, 45056
    s_nop 0
    buffer_load_dwordx4 v12, s[16:19], s96 offen offset:0 lds
    buffer_load_dwordx4 v13, s[16:19], s96 offen offset:1024 lds
    s_add_u32 s96, s95, 1
    s_and_b32 s96, s96, 15
    s_mul_i32 s96, s96, 393216
    s_add_u32 s96, s96, s85
    s_add_u32 m0, s87, 65536
    s_nop 0
    buffer_load_dwordx4 v8, s[16:19], s96 offen offset:0 lds
    buffer_load_dwordx4 v9, s[16:19], s96 offen offset:1024 lds
    buffer_load_dwordx4 v10, s[16:19], s96 offen offset:2048 lds
    buffer_load_dwordx4 v11, s[16:19], s96 offen offset:3072 lds
    s_add_u32 m0, s87, 69632
    s_nop 0
    buffer_load_dwordx4 v12, s[16:19], s96 offen offset:0 lds
    buffer_load_dwordx4 v13, s[16:19], s96 offen offset:1024 lds
    s_lshl_b32 s30, s99, 13
    s_add_u32 s30, s30, 0xc00000
    s_waitcnt vmcnt(6)
    s_barrier
    s_add_u32 s96, s94, 2
    s_and_b32 s96, s96, 15
    s_mul_i32 s96, s96, 393216
    s_add_u32 s96, s96, s85
    s_add_u32 m0, s87, 90112
    s_nop 0
    buffer_load_dwordx4 v8, s[16:19], s96 offen offset:0 lds
    buffer_load_dwordx4 v9, s[16:19], s96 offen offset:1024 lds
    buffer_load_dwordx4 v10, s[16:19], s96 offen offset:2048 lds
    buffer_load_dwordx4 v11, s[16:19], s96 offen offset:3072 lds
    s_add_u32 m0, s87, 94208
    s_nop 0
    buffer_load_dwordx4 v12, s[16:19], s96 offen offset:0 lds
    buffer_load_dwordx4 v13, s[16:19], s96 offen offset:1024 lds
    ds_read_b128 v[100:103], v117 offset:0
    ds_read_b128 v[104:107], v117 offset:512
    ds_read_b128 v[108:111], v117 offset:1024
    ds_read_b128 v[112:115], v117 offset:1536
    s_mov_b32 s78, s27
pl_84:
    buffer_load_dword v17, v16, s[20:23], s30 offen sc1
    s_waitcnt vmcnt(0)
pc_85:
    v_cmp_eq_u32 vcc, -1, v17
    s_cbranch_vccz pd_86
    s_sub_u32 s78, s78, 1
    s_cmp_lg_u32 s78, 0
    s_cbranch_scc1 pl_84
    s_mov_b32 s27, 1
pd_86:
    s_add_u32 s96, s95, 1
    s_and_b32 s96, s96, 15
    s_lshl_b32 s97, s96, 14
    s_add_u32 s97, s97, s84
    s_add_u32 m0, s86, 131072
    s_nop 0
    buffer_load_dwordx4 v253, s[20:23], s97 offen offset:0 sc1 lds
    buffer_load_dwordx4 v253, s[20:23], s97 offen offset:1024 sc1 lds
    buffer_load_dwordx4 v253, s[20:23], s97 offen offset:2048 sc1 lds
    buffer_load_dwordx4 v253, s[20:23], s97 offen offset:3072 sc1 lds
    s_lshl_b32 s30, s99, 13
    s_add_u32 s30, s30, 0xc00000
    s_add_u32 s31, s30, 4096
    buffer_load_dwordx4 v[64:67], v253, s[20:23], s30 offen offset:0 sc1
    buffer_load_dwordx4 v[68:71], v253, s[20:23], s30 offen offset:1024 sc1
    buffer_load_dwordx4 v[72:75], v253, s[20:23], s30 offen offset:2048 sc1
    buffer_load_dwordx4 v[76:79], v253, s[20:23], s30 offen offset:3072 sc1
    buffer_load_dwordx4 v[80:83], v253, s[20:23], s31 offen offset:0 sc1
    buffer_load_dwordx4 v[84:87], v253, s[20:23], s31 offen offset:1024 sc1
    buffer_load_dwordx4 v[88:91], v253, s[20:23], s31 offen offset:2048 sc1
    buffer_load_dwordx4 v[92:95], v253, s[20:23], s31 offen offset:3072 sc1
    s_waitcnt vmcnt(8) lgkmcnt(0)
    s_barrier
    s_add_u32 s96, s94, 2
    s_and_b32 s96, s96, 15
    s_lshl_b32 s97, s96, 14
    s_add_u32 s97, s97, s84
    s_add_u32 m0, s86, 114688
    s_nop 0
    buffer_load_dwordx4 v253, s[20:23], s97 offen offset:0 sc1 lds
    buffer_load_dwordx4 v253, s[20:23], s97 offen offset:1024 sc1 lds
    buffer_load_dwordx4 v253, s[20:23], s97 offen offset:2048 sc1 lds
    buffer_load_dwordx4 v253, s[20:23], s97 offen offset:3072 sc1 lds
    s_mov_b32 s78, s27
    s_waitcnt vmcnt(4)
    s_branch pc_88
pl_87:
    s_lshl_b32 s30, s99, 13
    s_add_u32 s30, s30, 0xc00000
    s_add_u32 s31, s30, 4096
    buffer_load_dwordx4 v[64:67], v253, s[20:23], s30 offen offset:0 sc1
    buffer_load_dwordx4 v[68:71], v253, s[20:23], s30 offen offset:1024 sc1
    buffer_load_dwordx4 v[72:75], v253, s[20:23], s30 offen offset:2048 sc1
    buffer_load_dwordx4 v[76:79], v253, s[20:23], s30 offen offset:3072 sc1
    buffer_load_dwordx4 v[80:83], v253, s[20:23], s31 offen offset:0 sc1
    buffer_load_dwordx4 v[84:87], v253, s[20:23], s31 offen offset:1024 sc1
    buffer_load_dwordx4 v[88:91], v253, s[20:23], s31 offen offset:2048 sc1
    buffer_load_dwordx4 v[92:95], v253, s[20:23], s31 offen offset:3072 sc1
    s_waitcnt vmcnt(0)
pc_88:
    v_max3_u32 v48, v64, v65, v66
    v_max3_u32 v48, v48, v67, v68
    v_max3_u32 v48, v48, v69, v70
    v_max3_u32 v48, v48, v71, v72
    v_max3_u32 v48, v48, v73, v74
    v_max3_u32 v48, v48, v75, v76
    v_max3_u32 v48, v48, v77, v78
    v_max3_u32 v48, v48, v79, v80
    v_max3_u32 v48, v48, v81, v82
    v_max3_u32 v48, v48, v83, v84
    v_max3_u32 v48, v48, v85, v86
    v_max3_u32 v48, v48, v87, v88
    v_max3_u32 v48, v48, v89, v90
    v_max3_u32 v48, v48, v91, v92
    v_max3_u32 v48, v48, v93, v94
    v_max_u32 v48, v48, v95
    v_cmp_eq_u32 vcc, -1, v48
    s_cbranch_vccz pd_89
    s_sub_u32 s78, s78, 1
    s_cmp_lg_u32 s78, 0
    s_cbranch_scc1 pl_87
    s_mov_b32 s27, 1
pd_89:
    s_add_u32 s96, s95, 3
    s_and_b32 s96, s96, 15
    s_lshl_b32 s97, s96, 14
    s_add_u32 s97, s97, s84
    s_add_u32 m0, s86, 147456
    s_nop 0
    buffer_load_dwordx4 v253, s[20:23], s97 offen offset:0 sc1 lds
    buffer_load_dwordx4 v253, s[20:23], s97 offen offset:1024 sc1 lds
    buffer_load_dwordx4 v253, s[20:23], s97 offen offset:2048 sc1 lds
    v_pk_add_f32 v[64:65], v[64:65], v[68:69]
    v_pk_add_f32 v[66:67], v[66:67], v[70:71]
    v_pk_add_f32 v[64:65], v[64:65], v[72:73]
    v_pk_add_f32 v[66:67], v[66:67], v[74:75]
    v_pk_add_f32 v[64:65], v[64:65], v[76:77]
    v_pk_add_f32 v[66:67], v[66:67], v[78:79]
    v_pk_add_f32 v[64:65], v[64:65], v[80:81]
    v_pk_add_f32 v[66:67], v[66:67], v[82:83]
    buffer_load_dwordx4 v253, s[20:23], s97 offen offset:3072 sc1 lds
    v_pk_add_f32 v[64:65], v[64:65], v[84:85]
    v_pk_add_f32 v[66:67], v[66:67], v[86:87]
    v_pk_add_f32 v[64:65], v[64:65], v[88:89]
    v_pk_add_f32 v[66:67], v[66:67], v[90:91]
    v_pk_add_f32 v[64:65], v[64:65], v[92:93]
    v_pk_add_f32 v[66:67], v[66:67], v[94:95]
    v_mov_b32 v48, v64
    v_mov_b32 v49, v65
    v_mov_b32 v50, v66
    v_mov_b32 v51, v67
    v_permlane32_swap_b32 v64, v48
    v_permlane32_swap_b32 v65, v49
    v_permlane32_swap_b32 v66, v50
    s_add_u32 s96, s95, 3
    s_and_b32 s96, s96, 15
    s_mul_i32 s96, s96, 393216
    s_add_u32 s96, s96, s85
    s_add_u32 m0, s87, 40960
    s_nop 0
    buffer_load_dwordx4 v8, s[16:19], s96 offen offset:0 lds
    v_permlane32_swap_b32 v67, v51
    v_add_f32 v64, v64, v48
    v_add_f32 v65, v65, v49
    v_add_f32 v66, v66, v50
    v_add_f32 v67, v67, v51
    v_mul_f32 v54, 0x3a800000, v64
    v_mul_f32 v65, 0x3a800000, v65
    v_fma_f32 v65, -v54, v54, v65
    v_max_f32 v65, 0, v65
    v_add_f32 v55, 0x3727c5ac, v65
    v_rsq_f32 v55, v55
    v_fma_f32 v52, -v54, v67, v66
    buffer_load_dwordx4 v9, s[16:19], s96 offen offset:1024 lds
    v_and_b32 v53, 31, v252
    v_mul_f32 v52, v52, v55
    s_lshl_b32 s32, s99, 5
    v_add_u32 v53, s32, v53
    v_mov_b32 v48, v52
    s_nop 1
    v_max_f32_dpp v48, v48, v48 quad_perm:[1,0,3,2] row_mask:0xf bank_mask:0xf
    s_nop 1
    v_max_f32_dpp v48, v48, v48 quad_perm:[2,3,0,1] row_mask:0xf bank_mask:0xf
    s_nop 1
    v_max_f32_dpp v48, v48, v48 row_half_mirror row_mask:0xf bank_mask:0xf
    s_nop 1
    v_max_f32_dpp v48, v48, v48 row_mirror row_mask:0xf bank_mask:0xf
    v_mov_b32 v49, v48
    s_nop 1
    v_permlane16_swap_b32 v48, v49
    v_max_f32 v48, v48, v49
    v_cmp_eq_f32 vcc, v48, v52
    buffer_load_dwordx4 v10, s[16:19], s96 offen offset:2048 lds
    v_lshrrev_b32 v50, 5, v252
    v_lshlrev_b32 v50, 4, v50
    s_lshl_b32 s32, s99, 11
    s_lshl_b32 s33, s98, 7
    s_add_u32 s32, s32, s33
    s_add_u32 s32, s32, 0xd60000
    s_lshl_b32 s34, s99, 4
    s_add_u32 s34, s34, 0xdc0000
    s_ff1_i32_b32 s35, vcc_lo
    s_lshl_b32 s35, 1, s35
    s_cmp_eq_u32 s25, 0
    s_cselect_b32 exec_lo, s35, 0
    s_mov_b32 exec_hi, 0
    buffer_store_dwordx4 v[52:55], v50, s[20:23], s34 offen sc1
    s_mov_b32 exec_lo, s35
    s_mov_b32 exec_hi, s35
    buffer_store_dwordx4 v[100:103], v50, s[20:23], s32 offen offset:0 sc1
    buffer_store_dwordx4 v[104:107], v50, s[20:23], s32 offen offset:32 sc1
    buffer_store_dwordx4 v[108:111], v50, s[20:23], s32 offen offset:64 sc1
    buffer_store_dwordx4 v[112:115], v50, s[20:23], s32 offen offset:96 sc1
    s_mov_b64 exec, -1
    buffer_load_dwordx4 v11, s[16:19], s96 offen offset:3072 lds
    v_add_f32 v56, 1.0, v55
    v_mul_f32 v57, v54, v55
    s_add_u32 m0, s87, 45056
    s_nop 0
    buffer_load_dwordx4 v12, s[16:19], s96 offen offset:0 lds
    v_mul_f32 v58, v56, v56
    v_sub_f32 v57, 0, v57
    v_mul_f32 v58, v58, v65
    v_add_f32 v58, 0x3727c5ac, v58
    v_rsq_f32 v58, v58
    s_nop 0
    v_mul_f32 v58, v58, v56
    v_and_b32 v48, 31, v252
    v_lshrrev_b32 v49, 5, v252
    v_cmp_eq_u32 vcc, 0, v49
    v_lshlrev_b32 v49, 9, v49
    v_lshl_add_u32 v48, v48, 2, v49
    s_lshl_b32 s32, s28, 7
    buffer_load_dwordx4 v13, s[16:19], s96 offen offset:1024 lds
    v_add_u32 v48, s32, v48
    v_cndmask_b32 v49, v54, v58, vcc
    v_cndmask_b32 v50, v57, v56, vcc
    ds_write_b32 v48, v49 offset:0
    ds_write_b32 v48, v50 offset:2048
    v_and_b32 v48, 15, v252
    v_lshrrev_b32 v51, 4, v252
    v_lshl_add_u32 v48, v48, 2, v51
    s_min_u32 s32, s28, 2
    s_lshl_b32 s32, s32, 8
    v_lshl_add_u32 v48, v48, 2, s32
    ds_write_b32 v48, v2 offset:1024
    s_waitcnt vmcnt(14) lgkmcnt(0)
    s_barrier
    s_add_u32 s96, s94, 4
    s_and_b32 s96, s96, 15
    s_lshl_b32 s97, s96, 14
    s_add_u32 s97, s97, s84
    s_add_u32 m0, s86, 131072
    s_nop 0
    buffer_load_dwordx4 v253, s[20:23], s97 offen offset:0 sc1 lds
    buffer_load_dwordx4 v253, s[20:23], s97 offen offset:1024 sc1 lds
    buffer_load_dwordx4 v253, s[20:23], s97 offen offset:2048 sc1 lds
    buffer_load_dwordx4 v253, s[20:23], s97 offen offset:3072 sc1 lds
    s_add_u32 s96, s94, 4
    s_and_b32 s96, s96, 15
    s_mul_i32 s96, s96, 393216
    s_add_u32 s96, s96, s85
    s_add_u32 m0, s87, 65536
    s_nop 0
    buffer_load_dwordx4 v8, s[16:19], s96 offen offset:0 lds
    buffer_load_dwordx4 v9, s[16:19], s96 offen offset:1024 lds
    buffer_load_dwordx4 v10, s[16:19], s96 offen offset:2048 lds
    buffer_load_dwordx4 v11, s[16:19], s96 offen offset:3072 lds
    s_add_u32 m0, s87, 69632
    s_nop 0
    buffer_load_dwordx4 v12, s[16:19], s96 offen offset:0 lds
    buffer_load_dwordx4 v13, s[16:19], s96 offen offset:1024 lds
    s_waitcnt vmcnt(10) lgkmcnt(0)
    s_barrier
    s_add_u32 s96, s95, 5
    s_and_b32 s96, s96, 15
    s_lshl_b32 s97, s96, 14
    s_add_u32 s97, s97, s84
    s_add_u32 m0, s86, 114688
    s_nop 0
    buffer_load_dwordx4 v253, s[20:23], s97 offen offset:0 sc1 lds
    buffer_load_dwordx4 v253, s[20:23], s97 offen offset:1024 sc1 lds
    buffer_load_dwordx4 v253, s[20:23], s97 offen offset:2048 sc1 lds
    buffer_load_dwordx4 v253, s[20:23], s97 offen offset:3072 sc1 lds
    s_add_u32 s96, s95, 5
    s_and_b32 s96, s96, 15
    s_mul_i32 s96, s96, 393216
    s_add_u32 s96, s96, s85
    s_add_u32 m0, s87, 90112
    s_nop 0
    buffer_load_dwordx4 v8, s[16:19], s96 offen offset:0 lds
    buffer_load_dwordx4 v9, s[16:19], s96 offen offset:1024 lds
    buffer_load_dwordx4 v10, s[16:19], s96 offen offset:2048 lds
    buffer_load_dwordx4 v11, s[16:19], s96 offen offset:3072 lds
    s_add_u32 m0, s87, 94208
    s_nop 0
    buffer_load_dwordx4 v12, s[16:19], s96 offen offset:0 lds
    buffer_load_dwordx4 v13, s[16:19], s96 offen offset:1024 lds
    s_waitcnt vmcnt(10) lgkmcnt(0)
    s_barrier
    s_add_u32 s32, s79, 0xdc0000
    s_add_u32 s96, s94, 6
    s_and_b32 s96, s96, 15
    s_lshl_b32 s97, s96, 14
    s_add_u32 s97, s97, s84
    s_add_u32 m0, s86, 147456
    s_nop 0
    buffer_load_dwordx4 v253, s[20:23], s97 offen offset:0 sc1 lds
    buffer_load_dwordx4 v253, s[20:23], s97 offen offset:1024 sc1 lds
    buffer_load_dwordx4 v253, s[20:23], s97 offen offset:2048 sc1 lds
    buffer_load_dwordx4 v253, s[20:23], s97 offen offset:3072 sc1 lds
    s_add_u32 s96, s94, 6
    s_and_b32 s96, s96, 15
    s_mul_i32 s96, s96, 393216
    s_add_u32 s96, s96, s85
    s_add_u32 m0, s87, 40960
    s_nop 0
    buffer_load_dwordx4 v8, s[16:19], s96 offen offset:0 lds
    buffer_load_dwordx4 v[16:19], v253, s[20:23], s32 offen sc1
    buffer_load_dwordx4 v9, s[16:19], s96 offen offset:1024 lds
    buffer_load_dwordx4 v10, s[16:19], s96 offen offset:2048 lds
    buffer_load_dwordx4 v11, s[16:19], s96 offen offset:3072 lds
    s_add_u32 m0, s87, 45056
    s_nop 0
    buffer_load_dwordx4 v12, s[16:19], s96 offen offset:0 lds
    buffer_load_dwordx4 v13, s[16:19], s96 offen offset:1024 lds
    s_waitcnt vmcnt(11) lgkmcnt(0)
    s_barrier
    s_mov_b32 s78, s27
    s_waitcnt vmcnt(5)
    s_branch pc_92
pl_91:
    s_add_u32 s32, s79, 0xdc0000
    buffer_load_dwordx4 v[16:19], v253, s[20:23], s32 offen sc1
    s_waitcnt vmcnt(0)
pc_92:
    v_max3_u32 v20, v16, v17, v18
    v_max_u32 v20, v20, v19
    v_cmp_eq_u32 vcc, -1, v20
    s_cbranch_vccz pd_93
    s_sub_u32 s78, s78, 1
    s_cmp_lg_u32 s78, 0
    s_cbranch_scc1 pl_91
    s_mov_b32 s27, 1
pd_93:
    s_add_u32 s96, s95, 7
    s_and_b32 s96, s96, 15
    s_lshl_b32 s97, s96, 14
    s_add_u32 s97, s97, s84
    s_add_u32 m0, s86, 131072
    s_nop 0
    buffer_load_dwordx4 v253, s[20:23], s97 offen offset:0 sc1 lds
    buffer_load_dwordx4 v253, s[20:23], s97 offen offset:1024 sc1 lds
    buffer_load_dwordx4 v253, s[20:23], s97 offen offset:2048 sc1 lds
    v_mov_b32 v20, v16
    buffer_load_dwordx4 v253, s[20:23], s97 offen offset:3072 sc1 lds
    s_nop 0
    v_max_f32_dpp v20, v20, v20 quad_perm:[1,0,3,2] row_mask:0xf bank_mask:0xf
    s_nop 1
    v_max_f32_dpp v20, v20, v20 quad_perm:[2,3,0,1] row_mask:0xf bank_mask:0xf
    s_nop 1
    v_max_f32_dpp v20, v20, v20 row_half_mirror row_mask:0xf bank_mask:0xf
    s_nop 1
    v_max_f32_dpp v20, v20, v20 row_mirror row_mask:0xf bank_mask:0xf
    v_mov_b32 v21, v20
    s_add_u32 s96, s95, 7
    s_and_b32 s96, s96, 15
    s_mul_i32 s96, s96, 393216
    s_add_u32 s96, s96, s85
    s_add_u32 m0, s87, 65536
    s_nop 0
    buffer_load_dwordx4 v8, s[16:19], s96 offen offset:0 lds
    v_permlane16_swap_b32 v20, v21
    v_max_f32 v20, v20, v21
    v_mov_b32 v21, v20
    s_nop 1
    v_permlane32_swap_b32 v20, v21
    buffer_load_dwordx4 v9, s[16:19], s96 offen offset:1024 lds
    v_max_f32 v20, v20, v21
    v_cmp_eq_f32 vcc, v20, v16
    s_ff1_i32_b64 s32, vcc
    s_and_b32 s32, s32, 63
    v_readlane_b32 s74, v16, s32
    buffer_load_dwordx4 v10, s[16:19], s96 offen offset:2048 lds
    v_readlane_b32 s73, v17, s32
    v_readlane_b32 s75, v18, s32
    v_readlane_b32 s76, v19, s32
    s_and_b32 s73, s73, 2047
    s_lshr_b32 s33, s73, 5
    buffer_load_dwordx4 v11, s[16:19], s96 offen offset:3072 lds
    s_lshl_b32 s33, s33, 11
    s_add_u32 s33, s33, s79
    s_add_u32 s33, s33, 0xd60000
    buffer_load_dwordx4 v[24:27], v22, s[20:23], s33 offen sc1
    v_mov_b32 v20, s73
    s_add_u32 m0, s87, 69632
    s_nop 0
    buffer_load_dwordx4 v12, s[16:19], s96 offen offset:0 lds
    v_mov_b32 v21, s77
    v_mov_b32 v19, 0
    ds_write_b64 v19, v[20:21] offset:3072
    s_lshr_b32 s39, s73, 5
    s_lshl_b32 s34, s24, 2
    buffer_load_dwordx4 v13, s[16:19], s96 offen offset:1024 lds
    s_sub_u32 s39, s39, s34
    s_add_u32 s39, s39, 8
    s_cmp_lt_u32 s39, 12
    s_cselect_b32 s100, 1, 0
    s_waitcnt vmcnt(11) lgkmcnt(0)
    s_barrier
    s_add_u32 s96, s94, 8
    s_and_b32 s96, s96, 15
    s_lshl_b32 s97, s96, 14
    s_add_u32 s97, s97, s84
    s_add_u32 m0, s86, 114688
    s_nop 0
    buffer_load_dwordx4 v253, s[20:23], s97 offen offset:0 sc1 lds
    buffer_load_dwordx4 v253, s[20:23], s97 offen offset:1024 sc1 lds
    s_mov_b32 s78, s27
    s_waitcnt vmcnt(4)
    s_branch pc_95
pl_94:
    s_lshr_b32 s33, s73, 5
    s_lshl_b32 s33, s33, 11
    s_add_u32 s33, s33, s79
    s_add_u32 s33, s33, 0xd60000
    buffer_load_dwordx4 v[24:27], v22, s[20:23], s33 offen sc1
    s_waitcnt vmcnt(0)
pc_95:
    v_max3_u32 v30, v24, v25, v26
    v_max_u32 v30, v30, v27
    v_cmp_eq_u32 vcc, -1, v30
    s_cbranch_vccz pd_96
    s_sub_u32 s78, s78, 1
    s_cmp_lg_u32 s78, 0
    s_cbranch_scc1 pl_94
    s_mov_b32 s27, 1
pd_96:
    buffer_load_dwordx4 v253, s[20:23], s97 offen offset:2048 sc1 lds
    v_and_b32 v30, 2, v252
    v_cmp_eq_u32 vcc, 2, v30
    v_mov_b32 v28, s76
    v_mul_f32 v29, s75, v28
    v_add_f32 v28, 1.0, v28
    v_cndmask_b32 v30, v24, v26, vcc
    v_cndmask_b32 v31, v25, v27, vcc
    v_lshlrev_b32 v92, 16, v30
    v_and_b32 v93, 0xffff0000, v30
    v_lshlrev_b32 v94, 16, v31
    v_and_b32 v95, 0xffff0000, v31
    v_fma_f32 v92, v92, v28, -v29
    v_fma_f32 v93, v93, v28, -v29
    v_fma_f32 v94, v94, v28, -v29
    v_fma_f32 v95, v95, v28, -v29
    v_mov_b32 v96, 0xbfb8aa3b
    v_mul_f32 v96, s74, v96
    v_exp_f32 v96, v96
    s_nop 0
    v_add_f32 v96, 1.0, v96
    v_rcp_f32 v96, v96
    buffer_load_dwordx4 v253, s[20:23], s97 offen offset:3072 sc1 lds
    v_mov_b32 v28, s76
    v_mul_f32 v29, s75, v28
    v_lshlrev_b32 v30, 16, v24
    v_and_b32 v31, 0xffff0000, v24
    v_fma_f32 v30, v30, v28, -v29
    v_fma_f32 v31, v31, v28, -v29
    v_cvt_pk_bf16_f32 v24, v30, v31
    v_lshlrev_b32 v30, 16, v25
    v_and_b32 v31, 0xffff0000, v25
    v_fma_f32 v30, v30, v28, -v29
    v_fma_f32 v31, v31, v28, -v29
    v_cvt_pk_bf16_f32 v25, v30, v31
    v_lshlrev_b32 v30, 16, v26
    v_and_b32 v31, 0xffff0000, v26
    v_fma_f32 v30, v30, v28, -v29
    v_fma_f32 v31, v31, v28, -v29
    v_cvt_pk_bf16_f32 v26, v30, v31
    v_lshlrev_b32 v30, 16, v27
    v_and_b32 v31, 0xffff0000, v27
    v_fma_f32 v30, v30, v28, -v29
    v_fma_f32 v31, v31, v28, -v29
    s_add_u32 s96, s94, 8
    s_and_b32 s96, s96, 15
    s_mul_i32 s96, s96, 393216
    s_add_u32 s96, s96, s85
    s_add_u32 m0, s87, 90112
    s_nop 0
    buffer_load_dwordx4 v8, s[16:19], s96 offen offset:0 lds
    v_cvt_pk_bf16_f32 v27, v30, v31
    s_bitcmp0_b32 s29, 0
    s_cbranch_scc1 sk_97
    v_swap_b32 v24, v25
    v_swap_b32 v26, v27
sk_97:
    s_bitcmp0_b32 s29, 1
    s_cbranch_scc1 sk_98
    v_swap_b32 v24, v26
    v_swap_b32 v25, v27
sk_98:
    v_dot2_f32_bf16 v32, v155, v24, 0
    v_dot2_f32_bf16 v33, v160, v24, 0
    v_dot2_f32_bf16 v34, v156, v24, 0
    v_dot2_f32_bf16 v35, v161, v24, 0
    v_dot2_f32_bf16 v36, v157, v24, 0
    v_dot2_f32_bf16 v37, v162, v24, 0
    buffer_load_dwordx4 v9, s[16:19], s96 offen offset:1024 lds
    v_dot2_f32_bf16 v38, v158, v24, 0
    v_dot2_f32_bf16 v39, v163, v24, 0
    v_dot2_f32_bf16 v40, v183, v24, 0
    v_dot2_f32_bf16 v41, v192, v24, 0
    v_dot2_f32_bf16 v42, v188, v24, 0
    v_dot2_f32_bf16 v43, v193, v24, 0
    v_dot2_f32_bf16 v44, v189, v24, 0
    v_dot2_f32_bf16 v45, v194, v24, 0
    v_dot2_f32_bf16 v46, v190, v24, 0
    v_dot2_f32_bf16 v47, v195, v24, 0
    v_dot2_f32_bf16 v32, v159, v25, v32
    v_dot2_f32_bf16 v33, v168, v25, v33
    v_dot2_f32_bf16 v34, v164, v25, v34
    v_dot2_f32_bf16 v35, v169, v25, v35
    v_dot2_f32_bf16 v36, v165, v25, v36
    v_dot2_f32_bf16 v37, v170, v25, v37
    v_dot2_f32_bf16 v38, v166, v25, v38
    v_dot2_f32_bf16 v39, v171, v25, v39
    v_dot2_f32_bf16 v40, v191, v25, v40
    v_dot2_f32_bf16 v41, v200, v25, v41
    v_dot2_f32_bf16 v42, v196, v25, v42
    buffer_load_dwordx4 v10, s[16:19], s96 offen offset:2048 lds
    v_dot2_f32_bf16 v43, v201, v25, v43
    v_dot2_f32_bf16 v44, v197, v25, v44
    v_dot2_f32_bf16 v45, v202, v25, v45
    v_dot2_f32_bf16 v46, v198, v25, v46
    v_dot2_f32_bf16 v47, v203, v25, v47
    v_dot2_f32_bf16 v32, v167, v26, v32
    v_dot2_f32_bf16 v33, v176, v26, v33
    v_dot2_f32_bf16 v34, v172, v26, v34
    v_dot2_f32_bf16 v35, v177, v26, v35
    v_dot2_f32_bf16 v36, v173, v26, v36
    v_dot2_f32_bf16 v37, v178, v26, v37
    v_dot2_f32_bf16 v38, v174, v26, v38
    v_dot2_f32_bf16 v39, v179, v26, v39
    v_dot2_f32_bf16 v40, v199, v26, v40
    v_dot2_f32_bf16 v41, v208, v26, v41
    v_dot2_f32_bf16 v42, v204, v26, v42
    v_dot2_f32_bf16 v43, v209, v26, v43
    v_dot2_f32_bf16 v44, v205, v26, v44
    v_dot2_f32_bf16 v45, v210, v26, v45
    v_dot2_f32_bf16 v46, v206, v26, v46
    v_dot2_f32_bf16 v47, v211, v26, v47
    buffer_load_dwordx4 v11, s[16:19], s96 offen offset:3072 lds
    v_dot2_f32_bf16 v32, v175, v27, v32
    v_dot2_f32_bf16 v33, v184, v27, v33
    v_dot2_f32_bf16 v34, v180, v27, v34
    v_dot2_f32_bf16 v35, v185, v27, v35
    v_dot2_f32_bf16 v36, v181, v27, v36
    v_dot2_f32_bf16 v37, v186, v27, v37
    v_dot2_f32_bf16 v38, v182, v27, v38
    v_dot2_f32_bf16 v39, v187, v27, v39
    v_dot2_f32_bf16 v40, v207, v27, v40
    v_dot2_f32_bf16 v41, v216, v27, v41
    v_dot2_f32_bf16 v42, v212, v27, v42
    v_dot2_f32_bf16 v43, v217, v27, v43
    v_dot2_f32_bf16 v44, v213, v27, v44
    v_dot2_f32_bf16 v45, v218, v27, v45
    v_dot2_f32_bf16 v46, v214, v27, v46
    v_dot2_f32_bf16 v47, v219, v27, v47
    v_lshrrev_b32 v31, 5, v252
    v_lshlrev_b32 v30, 6, v31
    v_permlane32_swap_b32 v32, v40
    v_permlane32_swap_b32 v33, v41
    v_permlane32_swap_b32 v34, v42
    s_add_u32 m0, s87, 94208
    s_nop 0
    buffer_load_dwordx4 v12, s[16:19], s96 offen offset:0 lds
    v_permlane32_swap_b32 v35, v43
    v_permlane32_swap_b32 v36, v44
    v_permlane32_swap_b32 v37, v45
    v_permlane32_swap_b32 v38, v46
    v_permlane32_swap_b32 v39, v47
    v_add_f32 v32, v32, v40
    v_add_f32 v33, v33, v41
    v_add_f32 v34, v34, v42
    v_add_f32 v35, v35, v43
    v_add_f32 v36, v36, v44
    v_add_f32 v37, v37, v45
    v_add_f32 v38, v38, v46
    v_add_f32 v39, v39, v47
    v_and_b32 v31, 1, v252
    v_lshl_add_u32 v30, v31, 5, v30
    v_permlane16_swap_b32 v32, v36
    v_permlane16_swap_b32 v33, v37
    v_permlane16_swap_b32 v34, v38
    v_permlane16_swap_b32 v35, v39
    v_add_f32 v32, v32, v36
    v_add_f32 v33, v33, v37
    buffer_load_dwordx4 v13, s[16:19], s96 offen offset:1024 lds
    v_add_f32 v34, v34, v38
    v_add_f32 v35, v35, v39
    v_and_b32 v31, 16, v252
    s_lshl_b32 s32, s28, 7
    v_add3_u32 v30, v31, v30, s32
    v_add_f32_dpp v32, v32, v32 quad_perm:[2,3,0,1] row_mask:0xf bank_mask:0xf
    v_add_f32_dpp v33, v33, v33 quad_perm:[2,3,0,1] row_mask:0xf bank_mask:0xf
    v_add_f32_dpp v34, v34, v34 quad_perm:[2,3,0,1] row_mask:0xf bank_mask:0xf
    v_add_f32_dpp v35, v35, v35 quad_perm:[2,3,0,1] row_mask:0xf bank_mask:0xf
    v_add_f32_dpp v32, v32, v32 row_ror:4 row_mask:0xf bank_mask:0xf
    v_add_f32_dpp v33, v33, v33 row_ror:4 row_mask:0xf bank_mask:0xf
    v_add_f32_dpp v34, v34, v34 row_ror:4 row_mask:0xf bank_mask:0xf
    v_add_f32_dpp v35, v35, v35 row_ror:4 row_mask:0xf bank_mask:0xf
    v_add_f32_dpp v32, v32, v32 row_ror:8 row_mask:0xf bank_mask:0xf
    v_add_f32_dpp v33, v33, v33 row_ror:8 row_mask:0xf bank_mask:0xf
    v_add_f32_dpp v34, v34, v34 row_ror:8 row_mask:0xf bank_mask:0xf
    v_add_f32_dpp v35, v35, v35 row_ror:8 row_mask:0xf bank_mask:0xf
    s_mov_b32 exec_lo, 0x00030003
    s_mov_b32 exec_hi, 0x00030003
    ds_write_b128 v30, v[32:35] offset:3328
    s_mov_b64 exec, -1
    s_waitcnt vmcnt(10) lgkmcnt(0)
    s_barrier
    s_add_u32 s96, s95, 9
    s_and_b32 s96, s96, 15
    s_lshl_b32 s97, s96, 14
    s_add_u32 s97, s97, s84
    s_add_u32 m0, s86, 147456
    s_nop 0
    buffer_load_dwordx4 v253, s[20:23], s97 offen offset:0 sc1 lds
    buffer_load_dwordx4 v253, s[20:23], s97 offen offset:1024 sc1 lds
    v_and_b32 v30, 1, v252
    v_bfe_u32 v31, v252, 1, 3
    v_lshl_add_u32 v30, v30, 3, v31
    v_lshlrev_b32 v30, 2, v30
    v_add_u32 v30, 3328, v30
    ds_read2_b32 v[32:33], v30 offset0:0 offset1:16
    ds_read2_b32 v[34:35], v30 offset0:32 offset1:48
    ds_read2_b32 v[36:37], v30 offset0:64 offset1:80
    ds_read2_b32 v[38:39], v30 offset0:96 offset1:112
    v_lshrrev_b32 v30, 2, v252
    buffer_load_dwordx4 v253, s[20:23], s97 offen offset:2048 sc1 lds
    v_mul_u32_u24 v30, 14336, v30
    v_and_b32 v31, 3, v252
    v_lshl_add_u32 v30, v31, 4, v30
    v_and_b32 v31, 1, v252
    v_cmp_eq_u32 vcc, 1, v31
    s_mul_i32 s32, s28, 229376
    s_lshl_b32 s33, s29, 6
    s_add_u32 s32, s32, s33
    s_add_u32 s32, s32, s79
    s_add_u32 s32, s32, 0xc80000
    buffer_load_dwordx4 v253, s[20:23], s97 offen offset:3072 sc1 lds
    s_waitcnt lgkmcnt(0)
    v_pk_add_f32 v[32:33], v[32:33], v[34:35]
    v_pk_add_f32 v[36:37], v[36:37], v[38:39]
    v_pk_add_f32 v[32:33], v[32:33], v[36:37]
    v_mul_f32 v34, 0xbfb8aa3b, v32
    v_exp_f32 v34, v34
    v_mul_f32 v32, v32, v33
    v_add_f32 v34, 1.0, v34
    v_rcp_f32 v34, v34
    s_add_u32 s96, s95, 9
    s_and_b32 s96, s96, 15
    s_mul_i32 s96, s96, 393216
    s_add_u32 s96, s96, s85
    s_add_u32 m0, s87, 40960
    s_nop 0
    buffer_load_dwordx4 v8, s[16:19], s96 offen offset:0 lds
    v_mul_f32 v32, v32, v34
    s_nop 1
    v_mov_b32_dpp v33, v32 quad_perm:[2,3,2,3] row_mask:0xf bank_mask:0xf
    v_cvt_pk_bf16_f32 v32, v32, v33
    ds_swizzle_b32 v36, v32 offset:0x1
    ds_swizzle_b32 v37, v32 offset:0x81
    ds_swizzle_b32 v38, v32 offset:0x101
    ds_swizzle_b32 v39, v32 offset:0x181
    s_waitcnt lgkmcnt(0)
    v_dot2_f32_bf16 v40, v215, v36, 0
    v_dot2_f32_bf16 v41, v224, v36, 0
    buffer_load_dwordx4 v9, s[16:19], s96 offen offset:1024 lds
    v_dot2_f32_bf16 v42, v220, v36, 0
    v_dot2_f32_bf16 v43, v225, v36, 0
    v_dot2_f32_bf16 v44, v221, v36, 0
    v_dot2_f32_bf16 v45, v226, v36, 0
    v_dot2_f32_bf16 v46, v222, v36, 0
    v_dot2_f32_bf16 v47, v227, v36, 0
    v_dot2_f32_bf16 v40, v223, v37, v40
    v_dot2_f32_bf16 v41, v232, v37, v41
    v_dot2_f32_bf16 v42, v228, v37, v42
    v_dot2_f32_bf16 v43, v233, v37, v43
    buffer_load_dwordx4 v10, s[16:19], s96 offen offset:2048 lds
    v_dot2_f32_bf16 v44, v229, v37, v44
    v_dot2_f32_bf16 v45, v234, v37, v45
    v_dot2_f32_bf16 v46, v230, v37, v46
    v_dot2_f32_bf16 v47, v235, v37, v47
    v_dot2_f32_bf16 v40, v231, v38, v40
    v_dot2_f32_bf16 v41, v240, v38, v41
    v_dot2_f32_bf16 v42, v236, v38, v42
    v_dot2_f32_bf16 v43, v241, v38, v43
    v_dot2_f32_bf16 v44, v237, v38, v44
    buffer_load_dwordx4 v11, s[16:19], s96 offen offset:3072 lds
    v_dot2_f32_bf16 v45, v242, v38, v45
    v_dot2_f32_bf16 v46, v238, v38, v46
    v_dot2_f32_bf16 v47, v243, v38, v47
    v_dot2_f32_bf16 v40, v239, v39, v40
    v_dot2_f32_bf16 v41, v248, v39, v41
    v_dot2_f32_bf16 v42, v244, v39, v42
    v_dot2_f32_bf16 v43, v249, v39, v43
    v_dot2_f32_bf16 v44, v245, v39, v44
    v_dot2_f32_bf16 v45, v250, v39, v45
    v_dot2_f32_bf16 v46, v246, v39, v46
    s_add_u32 m0, s87, 45056
    s_nop 0
    buffer_load_dwordx4 v12, s[16:19], s96 offen offset:0 lds
    v_dot2_f32_bf16 v47, v251, v39, v47
    v_add_f32_dpp v40, v40, v40 quad_perm:[1,0,3,2] row_mask:0xf bank_mask:0xf
    v_add_f32_dpp v41, v41, v41 quad_perm:[1,0,3,2] row_mask:0xf bank_mask:0xf
    v_add_f32_dpp v42, v42, v42 quad_perm:[1,0,3,2] row_mask:0xf bank_mask:0xf
    v_add_f32_dpp v43, v43, v43 quad_perm:[1,0,3,2] row_mask:0xf bank_mask:0xf
    v_add_f32_dpp v44, v44, v44 quad_perm:[1,0,3,2] row_mask:0xf bank_mask:0xf
    v_add_f32_dpp v45, v45, v45 quad_perm:[1,0,3,2] row_mask:0xf bank_mask:0xf
    v_add_f32_dpp v46, v46, v46 quad_perm:[1,0,3,2] row_mask:0xf bank_mask:0xf
    v_add_f32_dpp v47, v47, v47 quad_perm:[1,0,3,2] row_mask:0xf bank_mask:0xf
    v_cndmask_b32 v40, v40, v44, vcc
    buffer_load_dwordx4 v13, s[16:19], s96 offen offset:1024 lds
    v_cndmask_b32 v41, v41, v45, vcc
    v_cndmask_b32 v42, v42, v46, vcc
    v_cndmask_b32 v43, v43, v47, vcc
    s_cmp_lt_u32 s29, 224
    s_cselect_b64 exec, -1, 0
    buffer_store_dwordx4 v[40:43], v30, s[20:23], s32 offen sc1
    s_mov_b64 exec, -1
    s_waitcnt vmcnt(10) lgkmcnt(0)
    s_barrier
    s_add_u32 s96, s94, 10
    s_and_b32 s96, s96, 15
    s_lshl_b32 s97, s96, 14
    s_add_u32 s97, s97, s84
    s_add_u32 m0, s86, 131072
    s_nop 0
    buffer_load_dwordx4 v253, s[20:23], s97 offen offset:0 sc1 lds
    buffer_load_dwordx4 v253, s[20:23], s97 offen offset:1024 sc1 lds
    buffer_load_dwordx4 v253, s[20:23], s97 offen offset:2048 sc1 lds
    buffer_load_dwordx4 v253, s[20:23], s97 offen offset:3072 sc1 lds
    s_add_u32 s96, s94, 10
    s_and_b32 s96, s96, 15
    s_mul_i32 s96, s96, 393216
    s_add_u32 s96, s96, s85
    s_add_u32 m0, s87, 65536
    s_nop 0
    buffer_load_dwordx4 v8, s[16:19], s96 offen offset:0 lds
    buffer_load_dwordx4 v9, s[16:19], s96 offen offset:1024 lds
    buffer_load_dwordx4 v10, s[16:19], s96 offen offset:2048 lds
    buffer_load_dwordx4 v11, s[16:19], s96 offen offset:3072 lds
    s_add_u32 m0, s87, 69632
    s_nop 0
    buffer_load_dwordx4 v12, s[16:19], s96 offen offset:0 lds
    buffer_load_dwordx4 v13, s[16:19], s96 offen offset:1024 lds
    s_waitcnt vmcnt(10) lgkmcnt(0)
    s_barrier
    s_cmp_lt_u32 s29, 224
    s_cbranch_scc1 sk_100
    s_cmp_ge_u32 s28, 2
    s_cbranch_scc1 sk_100
    s_mul_i32 s32, s89, 14336
    s_add_u32 s32, s32, s79
    s_add_u32 s32, s32, 0xc80000
    buffer_load_dwordx4 v[32:35], v253, s[20:23], s32 offen offset:0 sc1
    buffer_load_dwordx4 v[36:39], v253, s[20:23], s32 offen offset:1024 sc1
    buffer_load_dwordx4 v[40:43], v253, s[20:23], s32 offen offset:2048 sc1
    buffer_load_dwordx4 v[44:47], v253, s[20:23], s32 offen offset:3072 sc1
    s_add_u32 s32, s32, 4096
    buffer_load_dwordx4 v[48:51], v253, s[20:23], s32 offen offset:0 sc1
    buffer_load_dwordx4 v[52:55], v253, s[20:23], s32 offen offset:1024 sc1
    buffer_load_dwordx4 v[56:59], v253, s[20:23], s32 offen offset:2048 sc1
    buffer_load_dwordx4 v[60:63], v253, s[20:23], s32 offen offset:3072 sc1
    s_add_u32 s32, s32, 4096
    buffer_load_dwordx4 v[64:67], v253, s[20:23], s32 offen offset:0 sc1
    buffer_load_dwordx4 v[68:71], v253, s[20:23], s32 offen offset:1024 sc1
    buffer_load_dwordx4 v[72:75], v253, s[20:23], s32 offen offset:2048 sc1
    buffer_load_dwordx4 v[76:79], v253, s[20:23], s32 offen offset:3072 sc1
    s_add_u32 s32, s32, 4096
    buffer_load_dwordx4 v[80:83], v253, s[20:23], s32 offen offset:0 sc1
    buffer_load_dwordx4 v[84:87], v253, s[20:23], s32 offen offset:1024 sc1
sk_100:
    s_add_u32 s96, s95, 11
    s_and_b32 s96, s96, 15
    s_lshl_b32 s97, s96, 14
    s_add_u32 s97, s97, s84
    s_add_u32 m0, s86, 114688
    s_nop 0
    buffer_load_dwordx4 v253, s[20:23], s97 offen offset:0 sc1 lds
    buffer_load_dwordx4 v253, s[20:23], s97 offen offset:1024 sc1 lds
    buffer_load_dwordx4 v253, s[20:23], s97 offen offset:2048 sc1 lds
    buffer_load_dwordx4 v253, s[20:23], s97 offen offset:3072 sc1 lds
    s_add_u32 s96, s95, 11
    s_and_b32 s96, s96, 15
    s_mul_i32 s96, s96, 393216
    s_add_u32 s96, s96, s85
    s_add_u32 m0, s87, 90112
    s_nop 0
    buffer_load_dwordx4 v8, s[16:19], s96 offen offset:0 lds
    buffer_load_dwordx4 v9, s[16:19], s96 offen offset:1024 lds
    buffer_load_dwordx4 v10, s[16:19], s96 offen offset:2048 lds
    buffer_load_dwordx4 v11, s[16:19], s96 offen offset:3072 lds
    s_add_u32 m0, s87, 94208
    s_nop 0
    buffer_load_dwordx4 v12, s[16:19], s96 offen offset:0 lds
    buffer_load_dwordx4 v13, s[16:19], s96 offen offset:1024 lds
    s_waitcnt vmcnt(10) lgkmcnt(0)
    s_barrier
    s_add_u32 s96, s94, 12
    s_and_b32 s96, s96, 15
    s_lshl_b32 s97, s96, 14
    s_add_u32 s97, s97, s84
    s_add_u32 m0, s86, 147456
    s_nop 0
    buffer_load_dwordx4 v253, s[20:23], s97 offen offset:0 sc1 lds
    buffer_load_dwordx4 v253, s[20:23], s97 offen offset:1024 sc1 lds
    buffer_load_dwordx4 v253, s[20:23], s97 offen offset:2048 sc1 lds
    buffer_load_dwordx4 v253, s[20:23], s97 offen offset:3072 sc1 lds
    s_add_u32 s96, s94, 12
    s_and_b32 s96, s96, 15
    s_mul_i32 s96, s96, 393216
    s_add_u32 s96, s96, s85
    s_add_u32 m0, s87, 40960
    s_nop 0
    buffer_load_dwordx4 v8, s[16:19], s96 offen offset:0 lds
    buffer_load_dwordx4 v9, s[16:19], s96 offen offset:1024 lds
    buffer_load_dwordx4 v10, s[16:19], s96 offen offset:2048 lds
    buffer_load_dwordx4 v11, s[16:19], s96 offen offset:3072 lds
    s_add_u32 m0, s87, 45056
    s_nop 0
    buffer_load_dwordx4 v12, s[16:19], s96 offen offset:0 lds
    buffer_load_dwordx4 v13, s[16:19], s96 offen offset:1024 lds
    s_cmp_lt_u32 s29, 224
    s_cbranch_scc1 sk_101
    s_cmp_ge_u32 s28, 2
    s_cbranch_scc1 sk_101
    s_mov_b32 s78, s27
    s_waitcnt vmcnt(20)
    s_branch pc_103
pl_102:
    s_mul_i32 s32, s89, 14336
    s_add_u32 s32, s32, s79
    s_add_u32 s32, s32, 0xc80000
    buffer_load_dwordx4 v[32:35], v253, s[20:23], s32 offen offset:0 sc1
    buffer_load_dwordx4 v[36:39], v253, s[20:23], s32 offen offset:1024 sc1
    buffer_load_dwordx4 v[40:43], v253, s[20:23], s32 offen offset:2048 sc1
    buffer_load_dwordx4 v[44:47], v253, s[20:23], s32 offen offset:3072 sc1
    s_add_u32 s32, s32, 4096
    buffer_load_dwordx4 v[48:51], v253, s[20:23], s32 offen offset:0 sc1
    buffer_load_dwordx4 v[52:55], v253, s[20:23], s32 offen offset:1024 sc1
    buffer_load_dwordx4 v[56:59], v253, s[20:23], s32 offen offset:2048 sc1
    buffer_load_dwordx4 v[60:63], v253, s[20:23], s32 offen offset:3072 sc1
    s_add_u32 s32, s32, 4096
    buffer_load_dwordx4 v[64:67], v253, s[20:23], s32 offen offset:0 sc1
    buffer_load_dwordx4 v[68:71], v253, s[20:23], s32 offen offset:1024 sc1
    buffer_load_dwordx4 v[72:75], v253, s[20:23], s32 offen offset:2048 sc1
    buffer_load_dwordx4 v[76:79], v253, s[20:23], s32 offen offset:3072 sc1
    s_add_u32 s32, s32, 4096
    buffer_load_dwordx4 v[80:83], v253, s[20:23], s32 offen offset:0 sc1
    buffer_load_dwordx4 v[84:87], v253, s[20:23], s32 offen offset:1024 sc1
    s_waitcnt vmcnt(0)
pc_103:
    v_max3_u32 v30, v32, v33, v34
    v_max3_u32 v30, v30, v35, v36
    v_max3_u32 v30, v30, v37, v38
    v_max3_u32 v30, v30, v39, v40
    v_max3_u32 v30, v30, v41, v42
    v_max3_u32 v30, v30, v43, v44
    v_max3_u32 v30, v30, v45, v46
    v_max3_u32 v30, v30, v47, v48
    v_max3_u32 v30, v30, v49, v50
    v_max3_u32 v30, v30, v51, v52
    v_max3_u32 v30, v30, v53, v54
    v_max3_u32 v30, v30, v55, v56
    v_max3_u32 v30, v30, v57, v58
    v_max3_u32 v30, v30, v59, v60
    v_max3_u32 v30, v30, v61, v62
    v_max3_u32 v30, v30, v63, v64
    v_max3_u32 v30, v30, v65, v66
    v_max3_u32 v30, v30, v67, v68
    v_max3_u32 v30, v30, v69, v70
    v_max3_u32 v30, v30, v71, v72
    v_max3_u32 v30, v30, v73, v74
    v_max3_u32 v30, v30, v75, v76
    v_max3_u32 v30, v30, v77, v78
    v_max3_u32 v30, v30, v79, v80
    v_max3_u32 v30, v30, v81, v82
    v_max3_u32 v30, v30, v83, v84
    v_max3_u32 v30, v30, v85, v86
    v_max_u32 v30, v30, v87
    v_cmp_eq_u32 vcc, -1, v30
    s_cbranch_vccz pd_104
    s_sub_u32 s78, s78, 1
    s_cmp_lg_u32 s78, 0
    s_cbranch_scc1 pl_102
    s_mov_b32 s27, 1
pd_104:
    v_pk_add_f32 v[32:33], v[32:33], v[36:37]
    v_pk_add_f32 v[34:35], v[34:35], v[38:39]
    v_pk_add_f32 v[32:33], v[32:33], v[40:41]
    v_pk_add_f32 v[34:35], v[34:35], v[42:43]
    v_pk_add_f32 v[32:33], v[32:33], v[44:45]
    v_pk_add_f32 v[34:35], v[34:35], v[46:47]
    v_pk_add_f32 v[32:33], v[32:33], v[48:49]
    v_pk_add_f32 v[34:35], v[34:35], v[50:51]
    v_pk_add_f32 v[32:33], v[32:33], v[52:53]
    v_pk_add_f32 v[34:35], v[34:35], v[54:55]
    v_pk_add_f32 v[32:33], v[32:33], v[56:57]
    v_pk_add_f32 v[34:35], v[34:35], v[58:59]
    v_pk_add_f32 v[32:33], v[32:33], v[60:61]
    v_pk_add_f32 v[34:35], v[34:35], v[62:63]
    v_pk_add_f32 v[32:33], v[32:33], v[64:65]
    v_pk_add_f32 v[34:35], v[34:35], v[66:67]
    v_pk_add_f32 v[32:33], v[32:33], v[68:69]
    v_pk_add_f32 v[34:35], v[34:35], v[70:71]
    v_pk_add_f32 v[32:33], v[32:33], v[72:73]
    v_pk_add_f32 v[34:35], v[34:35], v[74:75]
    v_pk_add_f32 v[32:33], v[32:33], v[76:77]
    v_pk_add_f32 v[34:35], v[34:35], v[78:79]
    v_pk_add_f32 v[32:33], v[32:33], v[80:81]
    v_pk_add_f32 v[34:35], v[34:35], v[82:83]
    v_pk_add_f32 v[32:33], v[32:33], v[84:85]
    v_pk_add_f32 v[34:35], v[34:35], v[86:87]
    s_nop 0
    v_add_f32_dpp v32, v32, v32 row_ror:4 row_mask:0xf bank_mask:0xf
    v_add_f32_dpp v33, v33, v33 row_ror:4 row_mask:0xf bank_mask:0xf
    v_add_f32_dpp v34, v34, v34 row_ror:4 row_mask:0xf bank_mask:0xf
    v_add_f32_dpp v35, v35, v35 row_ror:4 row_mask:0xf bank_mask:0xf
    v_add_f32_dpp v32, v32, v32 row_ror:8 row_mask:0xf bank_mask:0xf
    v_add_f32_dpp v33, v33, v33 row_ror:8 row_mask:0xf bank_mask:0xf
    v_add_f32_dpp v34, v34, v34 row_ror:8 row_mask:0xf bank_mask:0xf
    v_add_f32_dpp v35, v35, v35 row_ror:8 row_mask:0xf bank_mask:0xf
    v_mov_b32 v36, v32
    v_mov_b32 v37, v33
    v_mov_b32 v38, v34
    v_mov_b32 v39, v35
    v_permlane16_swap_b32 v32, v36
    v_permlane16_swap_b32 v33, v37
    v_permlane16_swap_b32 v34, v38
    v_permlane16_swap_b32 v35, v39
    v_add_f32 v32, v32, v36
    v_add_f32 v33, v33, v37
    v_add_f32 v34, v34, v38
    v_add_f32 v35, v35, v39
    v_mov_b32 v36, v32
    v_mov_b32 v37, v33
    v_mov_b32 v38, v34
    v_mov_b32 v39, v35
    v_permlane32_swap_b32 v32, v36
    v_permlane32_swap_b32 v33, v37
    v_permlane32_swap_b32 v34, v38
    v_permlane32_swap_b32 v35, v39
    v_add_f32 v32, v32, v36
    v_add_f32 v33, v33, v37
    v_add_f32 v34, v34, v38
    v_add_f32 v35, v35, v39
    v_fma_f32 v32, v32, v96, v92
    v_fma_f32 v33, v33, v96, v93
    v_fma_f32 v34, v34, v96, v94
    v_fma_f32 v35, v35, v96, v95
    v_cvt_pk_bf16_f32 v32, v32, v33
    v_cvt_pk_bf16_f32 v33, v34, v35
    s_lshl_b32 s32, s89, 5
    s_add_u32 s32, s32, 0xdc4000
    v_and_b32 v30, 1, v252
    v_bfe_u32 v31, v252, 1, 1
    v_lshlrev_b32 v30, 4, v30
    v_lshl_add_u32 v30, v31, 3, v30
    s_mov_b64 exec, 15
    buffer_store_dwordx2 v[32:33], v30, s[20:23], s32 offen sc1
    s_mov_b64 exec, -1
sk_101:
    s_waitcnt vmcnt(10) lgkmcnt(0)
    s_barrier
    s_add_u32 s96, s95, 13
    s_and_b32 s96, s96, 15
    s_lshl_b32 s97, s96, 14
    s_add_u32 s97, s97, s84
    s_add_u32 m0, s86, 131072
    s_nop 0
    buffer_load_dwordx4 v253, s[20:23], s97 offen offset:0 sc1 lds
    buffer_load_dwordx4 v253, s[20:23], s97 offen offset:1024 sc1 lds
    buffer_load_dwordx4 v253, s[20:23], s97 offen offset:2048 sc1 lds
    buffer_load_dwordx4 v253, s[20:23], s97 offen offset:3072 sc1 lds
    s_add_u32 s96, s95, 13
    s_and_b32 s96, s96, 15
    s_mul_i32 s96, s96, 393216
    s_add_u32 s96, s96, s85
    s_add_u32 m0, s87, 65536
    s_nop 0
    buffer_load_dwordx4 v8, s[16:19], s96 offen offset:0 lds
    buffer_load_dwordx4 v9, s[16:19], s96 offen offset:1024 lds
    buffer_load_dwordx4 v10, s[16:19], s96 offen offset:2048 lds
    buffer_load_dwordx4 v11, s[16:19], s96 offen offset:3072 lds
    s_add_u32 m0, s87, 69632
    s_nop 0
    buffer_load_dwordx4 v12, s[16:19], s96 offen offset:0 lds
    buffer_load_dwordx4 v13, s[16:19], s96 offen offset:1024 lds
    s_waitcnt vmcnt(10) lgkmcnt(0)
    s_barrier
    s_add_u32 s35, s94, 12
    s_and_b32 s35, s35, 15
    s_lshl_b32 s35, s35, 7
    s_add_u32 s35, s35, 0xdc4000
    s_add_u32 s96, s94, 14
    s_and_b32 s96, s96, 15
    s_lshl_b32 s97, s96, 14
    s_add_u32 s97, s97, s84
    s_add_u32 m0, s86, 114688
    s_nop 0
    buffer_load_dwordx4 v253, s[20:23], s97 offen offset:0 sc1 lds
    v_and_b32 v19, 48, v252
    buffer_load_dwordx4 v[132:135], v19, s[20:23], s35 offen offset:0 sc1
    buffer_load_dwordx4 v[136:139], v19, s[20:23], s35 offen offset:64 sc1
    buffer_load_dwordx4 v253, s[20:23], s97 offen offset:1024 sc1 lds
    s_min_u32 s30, s28, 2
    s_lshl_b32 s30, s30, 13
    s_add_u32 s30, s30, 40960
    buffer_load_dwordx4 v253, s[20:23], s97 offen offset:2048 sc1 lds
    v_lshrrev_b32 v20, 2, v252
    v_bfe_u32 v21, v20, 1, 2
    v_lshlrev_b32 v20, 7, v20
    v_lshl_add_u32 v20, v21, 5, v20
    buffer_load_dwordx4 v253, s[20:23], s97 offen offset:3072 sc1 lds
    v_and_b32 v21, 3, v252
    v_lshl_add_u32 v20, v21, 3, v20
    v_add_u32 v144, s30, v20
    s_add_u32 s96, s94, 14
    s_and_b32 s96, s96, 15
    s_mul_i32 s96, s96, 393216
    s_add_u32 s96, s96, s85
    s_add_u32 m0, s87, 90112
    s_nop 0
    buffer_load_dwordx4 v8, s[16:19], s96 offen offset:0 lds
    v_xor_b32 v145, 32, v144
    v_xor_b32 v146, 64, v144
    v_xor_b32 v147, 96, v144
    buffer_load_dwordx4 v9, s[16:19], s96 offen offset:1024 lds
    ds_read_b64_tr_b16 v[100:101], v144 offset:0
    ds_read_b64_tr_b16 v[102:103], v144 offset:2048
    ds_read_b64_tr_b16 v[104:105], v144 offset:4096
    buffer_load_dwordx4 v10, s[16:19], s96 offen offset:2048 lds
    ds_read_b64_tr_b16 v[106:107], v144 offset:6144
    ds_read_b64_tr_b16 v[108:109], v145 offset:0
    ds_read_b64_tr_b16 v[110:111], v145 offset:2048
    ds_read_b64_tr_b16 v[112:113], v145 offset:4096
    buffer_load_dwordx4 v11, s[16:19], s96 offen offset:3072 lds
    ds_read_b64_tr_b16 v[114:115], v145 offset:6144
    ds_read_b64_tr_b16 v[116:117], v146 offset:0
    ds_read_b64_tr_b16 v[118:119], v146 offset:2048
    s_add_u32 m0, s87, 94208
    s_nop 0
    buffer_load_dwordx4 v12, s[16:19], s96 offen offset:0 lds
    ds_read_b64_tr_b16 v[120:121], v146 offset:4096
    ds_read_b64_tr_b16 v[122:123], v146 offset:6144
    ds_read_b64_tr_b16 v[124:125], v147 offset:0
    buffer_load_dwordx4 v13, s[16:19], s96 offen offset:1024 lds
    ds_read_b64_tr_b16 v[126:127], v147 offset:2048
    ds_read_b64_tr_b16 v[128:129], v147 offset:4096
    ds_read_b64_tr_b16 v[130:131], v147 offset:6144
    s_waitcnt vmcnt(12) lgkmcnt(0)
    s_barrier
    s_add_u32 s96, s95, 15
    s_and_b32 s96, s96, 15
    s_lshl_b32 s97, s96, 14
    s_add_u32 s97, s97, s84
    s_add_u32 m0, s86, 147456
    s_nop 0
    buffer_load_dwordx4 v253, s[20:23], s97 offen offset:0 sc1 lds
    buffer_load_dwordx4 v253, s[20:23], s97 offen offset:1024 sc1 lds
    s_mov_b32 s78, s27
    s_waitcnt vmcnt(11)
    s_branch pc_106
pl_105:
    buffer_load_dwordx4 v[132:135], v19, s[20:23], s35 offen offset:0 sc1
    buffer_load_dwordx4 v[136:139], v19, s[20:23], s35 offen offset:64 sc1
    s_waitcnt vmcnt(0)
pc_106:
    v_max3_u32 v30, v132, v133, v134
    v_max3_u32 v30, v30, v135, v136
    v_max3_u32 v30, v30, v137, v138
    v_max_u32 v30, v30, v139
    v_cmp_eq_u32 vcc, -1, v30
    s_cbranch_vccz pd_107
    s_sub_u32 s78, s78, 1
    s_cmp_lg_u32 s78, 0
    s_cbranch_scc1 pl_105
    s_mov_b32 s27, 1
pd_107:
    buffer_load_dwordx4 v253, s[20:23], s97 offen offset:2048 sc1 lds
    buffer_load_dwordx4 v253, s[20:23], s97 offen offset:3072 sc1 lds
    v_mov_b32 v140, 0
    v_mov_b32 v141, 0
    v_mov_b32 v142, 0
    s_add_u32 s96, s95, 15
    s_and_b32 s96, s96, 15
    s_mul_i32 s96, s96, 393216
    s_add_u32 s96, s96, s85
    s_add_u32 m0, s87, 40960
    s_nop 0
    buffer_load_dwordx4 v8, s[16:19], s96 offen offset:0 lds
    v_mov_b32 v143, 0
    v_dot2c_f32_bf16 v140, v132, v100
    v_dot2c_f32_bf16 v141, v132, v108
    v_dot2c_f32_bf16 v142, v132, v116
    v_dot2c_f32_bf16 v143, v132, v124
    v_dot2c_f32_bf16 v140, v133, v101
    v_dot2c_f32_bf16 v141, v133, v109
    v_dot2c_f32_bf16 v142, v133, v117
    buffer_load_dwordx4 v9, s[16:19], s96 offen offset:1024 lds
    v_dot2c_f32_bf16 v143, v133, v125
    v_dot2c_f32_bf16 v140, v134, v102
    v_dot2c_f32_bf16 v141, v134, v110
    v_dot2c_f32_bf16 v142, v134, v118
    v_dot2c_f32_bf16 v143, v134, v126
    v_dot2c_f32_bf16 v140, v135, v103
    v_dot2c_f32_bf16 v141, v135, v111
    v_dot2c_f32_bf16 v142, v135, v119
    buffer_load_dwordx4 v10, s[16:19], s96 offen offset:2048 lds
    v_dot2c_f32_bf16 v143, v135, v127
    v_dot2c_f32_bf16 v140, v136, v104
    v_dot2c_f32_bf16 v141, v136, v112
    v_dot2c_f32_bf16 v142, v136, v120
    v_dot2c_f32_bf16 v143, v136, v128
    v_dot2c_f32_bf16 v140, v137, v105
    v_dot2c_f32_bf16 v141, v137, v113
    v_dot2c_f32_bf16 v142, v137, v121
    buffer_load_dwordx4 v11, s[16:19], s96 offen offset:3072 lds
    v_dot2c_f32_bf16 v143, v137, v129
    v_dot2c_f32_bf16 v140, v138, v106
    v_dot2c_f32_bf16 v141, v138, v114
    v_dot2c_f32_bf16 v142, v138, v122
    v_dot2c_f32_bf16 v143, v138, v130
    v_dot2c_f32_bf16 v140, v139, v107
    v_dot2c_f32_bf16 v141, v139, v115
    v_dot2c_f32_bf16 v142, v139, v123
    s_add_u32 m0, s87, 45056
    s_nop 0
    buffer_load_dwordx4 v12, s[16:19], s96 offen offset:0 lds
    v_dot2c_f32_bf16 v143, v139, v131
    s_min_u32 s32, s28, 2
    s_lshl_b32 s32, s32, 12
    s_lshl_b32 s33, s25, 14
    s_add_u32 s32, s32, s33
    s_add_u32 s32, s32, 0x1d80000
    s_lshl_b32 s33, s24, 8
    s_add_u32 s32, s32, s33
    buffer_load_dwordx4 v13, s[16:19], s96 offen offset:1024 lds
    v_lshlrev_b32 v20, 2, v252
    v_permlane32_swap_b32 v140, v142
    v_permlane32_swap_b32 v141, v143
    v_add_f32 v140, v140, v142
    v_add_f32 v141, v141, v143
    s_nop 1
    v_permlane16_swap_b32 v140, v141
    v_add_f32 v140, v140, v141
    buffer_store_dword v140, v20, s[20:23], s32 offen sc1
    s_waitcnt vmcnt(11) lgkmcnt(0)
    s_barrier
    s_waitcnt vmcnt(1) lgkmcnt(0)
    s_barrier
    s_cmp_eq_u32 s100, 0
    s_cbranch_scc1 sk_108
    s_min_u32 s32, s28, 2
    s_lshl_b32 s32, s32, 12
    s_lshl_b32 s33, s25, 14
    s_add_u32 s32, s32, s33
    s_add_u32 s32, s32, 0x1d80000
    buffer_load_dwordx4 v[32:35], v253, s[20:23], s32 offen offset:0 sc1
    buffer_load_dwordx4 v[36:39], v253, s[20:23], s32 offen offset:1024 sc1
    buffer_load_dwordx4 v[40:43], v253, s[20:23], s32 offen offset:2048 sc1
    buffer_load_dwordx4 v[44:47], v253, s[20:23], s32 offen offset:3072 sc1
    s_mov_b32 s32, 0xdc4000
    buffer_load_dwordx4 v[48:51], v253, s[20:23], s32 offen offset:0 sc1
    buffer_load_dwordx4 v[52:55], v253, s[20:23], s32 offen offset:1024 sc1
    v_and_b32 v20, 7, v252
    v_lshrrev_b32 v21, 4, v252
    v_lshl_add_u32 v21, v20, 2, v21
    s_and_b32 s34, s73, 31
    s_and_b32 s32, s34, 7
    s_and_b32 s33, s34, 8
    s_lshl_b32 s33, s33, 1
    s_add_u32 s32, s32, s33
    s_lshr_b32 s33, s34, 4
    s_lshl_b32 s33, s33, 3
    s_add_u32 s32, s32, s33
    s_cmp_eq_u32 s28, 1
    s_cselect_b32 s34, s32, s34
    v_mov_b32 v20, s34
    s_cmp_ge_u32 s28, 2
    s_cselect_b64 vcc, -1, 0
    s_cselect_b32 s32, 2048, 0
    v_cndmask_b32 v30, v20, v21, vcc
    v_cndmask_b32 v31, v21, v20, vcc
    v_lshlrev_b32 v0, 4, v30
    v_bfe_u32 v20, v31, 2, 2
    v_lshl_add_u32 v0, v20, 9, v0
    v_lshrrev_b32 v20, 4, v31
    v_lshl_add_u32 v0, v20, 3, v0
    v_and_b32 v20, 3, v31
    v_lshl_add_u32 v0, v20, 1, v0
    s_lshl_b32 s33, s39, 12
    s_add_u32 s33, s33, s32
    s_add_u32 s33, s33, 65536
    s_lshl_b32 s34, s39, 11
    s_add_u32 s34, s34, 32768
    s_cmp_ge_u32 s39, 8
    s_cselect_b32 s38, 1, 0
    s_movk_i32 s32, 8192
    s_cmp_eq_u32 s28, 0
    s_cselect_b32 s33, s34, s33
    s_cselect_b32 s32, s32, 49152
    s_cselect_b32 s38, s38, 1
    s_cselect_b32 s37, 0x3e8293ee, 1.0
    v_bfe_u32 v20, v252, 3, 1
    v_mul_u32_u24 v20, s32, v20
    v_add3_u32 v0, v0, v20, s33
sk_108:
    s_waitcnt lgkmcnt(0)
    s_barrier
    s_cmp_eq_u32 s100, 0
    s_cbranch_scc1 sk_109
    s_mov_b32 s78, s27
    s_waitcnt vmcnt(0)
    s_branch pc_111
pl_110:
    s_min_u32 s32, s28, 2
    s_lshl_b32 s32, s32, 12
    s_lshl_b32 s33, s25, 14
    s_add_u32 s32, s32, s33
    s_add_u32 s32, s32, 0x1d80000
    buffer_load_dwordx4 v[32:35], v253, s[20:23], s32 offen offset:0 sc1
    buffer_load_dwordx4 v[36:39], v253, s[20:23], s32 offen offset:1024 sc1
    buffer_load_dwordx4 v[40:43], v253, s[20:23], s32 offen offset:2048 sc1
    buffer_load_dwordx4 v[44:47], v253, s[20:23], s32 offen offset:3072 sc1
    s_mov_b32 s32, 0xdc4000
    buffer_load_dwordx4 v[48:51], v253, s[20:23], s32 offen offset:0 sc1
    buffer_load_dwordx4 v[52:55], v253, s[20:23], s32 offen offset:1024 sc1
    s_waitcnt vmcnt(0)
pc_111:
    v_max3_u32 v30, v32, v33, v34
    v_max3_u32 v30, v30, v35, v36
    v_max3_u32 v30, v30, v37, v38
    v_max3_u32 v30, v30, v39, v40
    v_max3_u32 v30, v30, v41, v42
    v_max3_u32 v30, v30, v43, v44
    v_max3_u32 v30, v30, v45, v46
    v_max3_u32 v30, v30, v47, v48
    v_max3_u32 v30, v30, v49, v50
    v_max3_u32 v30, v30, v51, v52
    v_max3_u32 v30, v30, v53, v54
    v_max_u32 v30, v30, v55
    v_cmp_eq_u32 vcc, -1, v30
    s_cbranch_vccz pd_112
    s_sub_u32 s78, s78, 1
    s_cmp_lg_u32 s78, 0
    s_cbranch_scc1 pl_110
    s_mov_b32 s27, 1
pd_112:
    v_mov_b32 v28, 0
    v_mov_b32 v29, 0
    v_dot2c_f32_bf16 v28, 0x3f803f80, v48
    v_dot2c_f32_bf16 v29, v48, v48
    v_dot2c_f32_bf16 v28, 0x3f803f80, v49
    v_dot2c_f32_bf16 v29, v49, v49
    v_dot2c_f32_bf16 v28, 0x3f803f80, v50
    v_dot2c_f32_bf16 v29, v50, v50
    v_dot2c_f32_bf16 v28, 0x3f803f80, v51
    v_dot2c_f32_bf16 v29, v51, v51
    v_dot2c_f32_bf16 v28, 0x3f803f80, v52
    v_dot2c_f32_bf16 v29, v52, v52
    v_dot2c_f32_bf16 v28, 0x3f803f80, v53
    v_dot2c_f32_bf16 v29, v53, v53
    v_dot2c_f32_bf16 v28, 0x3f803f80, v54
    v_dot2c_f32_bf16 v29, v54, v54
    v_dot2c_f32_bf16 v28, 0x3f803f80, v55
    v_dot2c_f32_bf16 v29, v55, v55
    v_pk_add_f32 v[32:33], v[32:33], v[36:37]
    v_pk_add_f32 v[34:35], v[34:35], v[38:39]
    v_pk_add_f32 v[32:33], v[32:33], v[40:41]
    v_pk_add_f32 v[34:35], v[34:35], v[42:43]
    v_pk_add_f32 v[32:33], v[32:33], v[44:45]
    v_pk_add_f32 v[34:35], v[34:35], v[46:47]
    s_nop 1
    v_permlane32_swap_b32 v32, v34
    v_permlane32_swap_b32 v33, v35
    v_add_f32 v32, v32, v34
    v_add_f32 v33, v33, v35
    s_nop 1
    v_permlane16_swap_b32 v32, v33
    v_add_f32 v32, v32, v33
    v_add_f32_dpp v28, v28, v28 quad_perm:[1,0,3,2] row_mask:0xf bank_mask:0xf
    s_nop 1
    v_add_f32_dpp v28, v28, v28 quad_perm:[2,3,0,1] row_mask:0xf bank_mask:0xf
    s_nop 1
    v_add_f32_dpp v28, v28, v28 row_half_mirror row_mask:0xf bank_mask:0xf
    s_nop 1
    v_add_f32_dpp v28, v28, v28 row_mirror row_mask:0xf bank_mask:0xf
    v_mov_b32 v30, v28
    s_nop 1
    v_permlane16_swap_b32 v28, v30
    v_add_f32 v28, v28, v30
    v_mov_b32 v30, v28
    s_nop 1
    v_permlane32_swap_b32 v28, v30
    v_add_f32 v28, v28, v30
    v_add_f32_dpp v29, v29, v29 quad_perm:[1,0,3,2] row_mask:0xf bank_mask:0xf
    s_nop 1
    v_add_f32_dpp v29, v29, v29 quad_perm:[2,3,0,1] row_mask:0xf bank_mask:0xf
    s_nop 1
    v_add_f32_dpp v29, v29, v29 row_half_mirror row_mask:0xf bank_mask:0xf
    s_nop 1
    v_add_f32_dpp v29, v29, v29 row_mirror row_mask:0xf bank_mask:0xf
    v_mov_b32 v30, v29
    s_nop 1
    v_permlane16_swap_b32 v29, v30
    v_add_f32 v29, v29, v30
    v_mov_b32 v30, v29
    s_nop 1
    v_permlane32_swap_b32 v29, v30
    v_add_f32 v29, v29, v30
    v_mul_f32 v28, 0x3a800000, v28
    v_mul_f32 v29, 0x3a800000, v29
    v_fma_f32 v29, -v28, v28, v29
    v_max_f32 v29, 0, v29
    v_add_f32 v29, 0x3727c5ac, v29
    v_rsq_f32 v29, v29
    v_fma_f32 v32, -v28, v2, v32
    v_mul_f32 v29, s37, v29
    v_mul_f32 v32, v32, v29
    v_cvt_pk_bf16_f32 v1, v32, v32
sk_109:
    s_branch l_att
l_tail:
    v_mov_b32 v20, 0
    s_or_b32 s34, s72, s28
    s_cmp_lg_u32 s34, 0
    s_cbranch_scc1 sk_113
    s_mov_b32 s34, 0xdd8000
    v_mov_b32 v154, s88
    s_mov_b64 exec, 1
    s_waitcnt vmcnt(0)
    buffer_store_dword v154, v253, s[20:23], s34 offen sc1
    s_mov_b64 exec, -1
sk_113:
    s_barrier
    ds_read_b128 v[16:19], v20 offset:3072
    s_waitcnt lgkmcnt(0)
    v_readlane_b32 s74, v16, 0
    v_readlane_b32 s73, v17, 0
    v_readlane_b32 s75, v18, 0
    v_readlane_b32 s76, v19, 0
    s_and_b32 s73, s73, 2047
    s_mov_b32 s78, s27
pl_114:
    s_lshr_b32 s33, s73, 5
    s_lshl_b32 s33, s33, 11
    s_add_u32 s33, s33, s79
    s_add_u32 s33, s33, 0xd60000
    buffer_load_dwordx4 v[24:27], v22, s[20:23], s33 offen sc1
    s_waitcnt vmcnt(0)
pc_115:
    v_max3_u32 v30, v24, v25, v26
    v_max_u32 v30, v30, v27
    v_cmp_eq_u32 vcc, -1, v30
    s_cbranch_vccz pd_116
    s_sub_u32 s78, s78, 1
    s_cmp_lg_u32 s78, 0
    s_cbranch_scc1 pl_114
    s_mov_b32 s27, 1
pd_116:
    s_cmp_ge_u32 s29, 224
    s_cbranch_scc1 l_tred
    v_mov_b32 v28, s76
    v_mul_f32 v29, s75, v28
    v_lshlrev_b32 v30, 16, v24
    v_and_b32 v31, 0xffff0000, v24
    v_fma_f32 v30, v30, v28, -v29
    v_fma_f32 v31, v31, v28, -v29
    v_cvt_pk_bf16_f32 v24, v30, v31
    v_lshlrev_b32 v30, 16, v25
    v_and_b32 v31, 0xffff0000, v25
    v_fma_f32 v30, v30, v28, -v29
    v_fma_f32 v31, v31, v28, -v29
    v_cvt_pk_bf16_f32 v25, v30, v31
    v_lshlrev_b32 v30, 16, v26
    v_and_b32 v31, 0xffff0000, v26
    v_fma_f32 v30, v30, v28, -v29
    v_fma_f32 v31, v31, v28, -v29
    v_cvt_pk_bf16_f32 v26, v30, v31
    v_lshlrev_b32 v30, 16, v27
    v_and_b32 v31, 0xffff0000, v27
    v_fma_f32 v30, v30, v28, -v29
    v_fma_f32 v31, v31, v28, -v29
    v_cvt_pk_bf16_f32 v27, v30, v31
    s_bitcmp0_b32 s29, 0
    s_cbranch_scc1 sk_117
    v_swap_b32 v24, v25
    v_swap_b32 v26, v27
sk_117:
    s_bitcmp0_b32 s29, 1
    s_cbranch_scc1 sk_118
    v_swap_b32 v24, v26
    v_swap_b32 v25, v27
sk_118:
    v_dot2_f32_bf16 v32, v155, v24, 0
    v_dot2_f32_bf16 v33, v160, v24, 0
    v_dot2_f32_bf16 v34, v156, v24, 0
    v_dot2_f32_bf16 v35, v161, v24, 0
    v_dot2_f32_bf16 v36, v157, v24, 0
    v_dot2_f32_bf16 v37, v162, v24, 0
    v_dot2_f32_bf16 v38, v158, v24, 0
    v_dot2_f32_bf16 v39, v163, v24, 0
    v_dot2_f32_bf16 v40, v183, v24, 0
    v_dot2_f32_bf16 v41, v192, v24, 0
    v_dot2_f32_bf16 v42, v188, v24, 0
    v_dot2_f32_bf16 v43, v193, v24, 0
    v_dot2_f32_bf16 v44, v189, v24, 0
    v_dot2_f32_bf16 v45, v194, v24, 0
    v_dot2_f32_bf16 v46, v190, v24, 0
    v_dot2_f32_bf16 v47, v195, v24, 0
    v_dot2_f32_bf16 v32, v159, v25, v32
    v_dot2_f32_bf16 v33, v168, v25, v33
    v_dot2_f32_bf16 v34, v164, v25, v34
    v_dot2_f32_bf16 v35, v169, v25, v35
    v_dot2_f32_bf16 v36, v165, v25, v36
    v_dot2_f32_bf16 v37, v170, v25, v37
    v_dot2_f32_bf16 v38, v166, v25, v38
    v_dot2_f32_bf16 v39, v171, v25, v39
    v_dot2_f32_bf16 v40, v191, v25, v40
    v_dot2_f32_bf16 v41, v200, v25, v41
    v_dot2_f32_bf16 v42, v196, v25, v42
    v_dot2_f32_bf16 v43, v201, v25, v43
    v_dot2_f32_bf16 v44, v197, v25, v44
    v_dot2_f32_bf16 v45, v202, v25, v45
    v_dot2_f32_bf16 v46, v198, v25, v46
    v_dot2_f32_bf16 v47, v203, v25, v47
    v_dot2_f32_bf16 v32, v167, v26, v32
    v_dot2_f32_bf16 v33, v176, v26, v33
    v_dot2_f32_bf16 v34, v172, v26, v34
    v_dot2_f32_bf16 v35, v177, v26, v35
    v_dot2_f32_bf16 v36, v173, v26, v36
    v_dot2_f32_bf16 v37, v178, v26, v37
    v_dot2_f32_bf16 v38, v174, v26, v38
    v_dot2_f32_bf16 v39, v179, v26, v39
    v_dot2_f32_bf16 v40, v199, v26, v40
    v_dot2_f32_bf16 v41, v208, v26, v41
    v_dot2_f32_bf16 v42, v204, v26, v42
    v_dot2_f32_bf16 v43, v209, v26, v43
    v_dot2_f32_bf16 v44, v205, v26, v44
    v_dot2_f32_bf16 v45, v210, v26, v45
    v_dot2_f32_bf16 v46, v206, v26, v46
    v_dot2_f32_bf16 v47, v211, v26, v47
    v_dot2_f32_bf16 v32, v175, v27, v32
    v_dot2_f32_bf16 v33, v184, v27, v33
    v_dot2_f32_bf16 v34, v180, v27, v34
    v_dot2_f32_bf16 v35, v185, v27, v35
    v_dot2_f32_bf16 v36, v181, v27, v36
    v_dot2_f32_bf16 v37, v186, v27, v37
    v_dot2_f32_bf16 v38, v182, v27, v38
    v_dot2_f32_bf16 v39, v187, v27, v39
    v_dot2_f32_bf16 v40, v207, v27, v40
    v_dot2_f32_bf16 v41, v216, v27, v41
    v_dot2_f32_bf16 v42, v212, v27, v42
    v_dot2_f32_bf16 v43, v217, v27, v43
    v_dot2_f32_bf16 v44, v213, v27, v44
    v_dot2_f32_bf16 v45, v218, v27, v45
    v_dot2_f32_bf16 v46, v214, v27, v46
    v_dot2_f32_bf16 v47, v219, v27, v47
    v_lshrrev_b32 v31, 5, v252
    v_lshlrev_b32 v30, 6, v31
    v_permlane32_swap_b32 v32, v40
    v_permlane32_swap_b32 v33, v41
    v_permlane32_swap_b32 v34, v42
    v_permlane32_swap_b32 v35, v43
    v_permlane32_swap_b32 v36, v44
    v_permlane32_swap_b32 v37, v45
    v_permlane32_swap_b32 v38, v46
    v_permlane32_swap_b32 v39, v47
    v_add_f32 v32, v32, v40
    v_add_f32 v33, v33, v41
    v_add_f32 v34, v34, v42
    v_add_f32 v35, v35, v43
    v_add_f32 v36, v36, v44
    v_add_f32 v37, v37, v45
    v_add_f32 v38, v38, v46
    v_add_f32 v39, v39, v47
    v_and_b32 v31, 1, v252
    v_lshl_add_u32 v30, v31, 5, v30
    v_permlane16_swap_b32 v32, v36
    v_permlane16_swap_b32 v33, v37
    v_permlane16_swap_b32 v34, v38
    v_permlane16_swap_b32 v35, v39
    v_add_f32 v32, v32, v36
    v_add_f32 v33, v33, v37
    v_add_f32 v34, v34, v38
    v_add_f32 v35, v35, v39
    v_and_b32 v31, 16, v252
    s_lshl_b32 s32, s28, 7
    v_add3_u32 v30, v31, v30, s32
    v_add_f32_dpp v32, v32, v32 quad_perm:[2,3,0,1] row_mask:0xf bank_mask:0xf
    v_add_f32_dpp v33, v33, v33 quad_perm:[2,3,0,1] row_mask:0xf bank_mask:0xf
    v_add_f32_dpp v34, v34, v34 quad_perm:[2,3,0,1] row_mask:0xf bank_mask:0xf
    v_add_f32_dpp v35, v35, v35 quad_perm:[2,3,0,1] row_mask:0xf bank_mask:0xf
    v_add_f32_dpp v32, v32, v32 row_ror:4 row_mask:0xf bank_mask:0xf
    v_add_f32_dpp v33, v33, v33 row_ror:4 row_mask:0xf bank_mask:0xf
    v_add_f32_dpp v34, v34, v34 row_ror:4 row_mask:0xf bank_mask:0xf
    v_add_f32_dpp v35, v35, v35 row_ror:4 row_mask:0xf bank_mask:0xf
    v_add_f32_dpp v32, v32, v32 row_ror:8 row_mask:0xf bank_mask:0xf
    v_add_f32_dpp v33, v33, v33 row_ror:8 row_mask:0xf bank_mask:0xf
    v_add_f32_dpp v34, v34, v34 row_ror:8 row_mask:0xf bank_mask:0xf
    v_add_f32_dpp v35, v35, v35 row_ror:8 row_mask:0xf bank_mask:0xf
    s_mov_b32 exec_lo, 0x00030003
    s_mov_b32 exec_hi, 0x00030003
    ds_write_b128 v30, v[32:35] offset:3328
    s_mov_b64 exec, -1
    s_waitcnt lgkmcnt(0)
    s_barrier
    v_and_b32 v30, 1, v252
    v_bfe_u32 v31, v252, 1, 3
    v_lshl_add_u32 v30, v30, 3, v31
    v_lshlrev_b32 v30, 2, v30
    v_add_u32 v30, 3328, v30
    ds_read2_b32 v[32:33], v30 offset0:0 offset1:16
    ds_read2_b32 v[34:35], v30 offset0:32 offset1:48
    ds_read2_b32 v[36:37], v30 offset0:64 offset1:80
    ds_read2_b32 v[38:39], v30 offset0:96 offset1:112
    v_lshrrev_b32 v30, 2, v252
    v_mul_u32_u24 v30, 14336, v30
    v_and_b32 v31, 3, v252
    v_lshl_add_u32 v30, v31, 4, v30
    v_and_b32 v31, 1, v252
    v_cmp_eq_u32 vcc, 1, v31
    s_mul_i32 s32, s28, 229376
    s_lshl_b32 s33, s29, 6
    s_add_u32 s32, s32, s33
    s_add_u32 s32, s32, s79
    s_add_u32 s32, s32, 0xc80000
    s_waitcnt lgkmcnt(0)
    v_pk_add_f32 v[32:33], v[32:33], v[34:35]
    v_pk_add_f32 v[36:37], v[36:37], v[38:39]
    v_pk_add_f32 v[32:33], v[32:33], v[36:37]
    v_mul_f32 v34, 0xbfb8aa3b, v32
    v_exp_f32 v34, v34
    v_mul_f32 v32, v32, v33
    v_add_f32 v34, 1.0, v34
    v_rcp_f32 v34, v34
    s_nop 0
    v_mul_f32 v32, v32, v34
    s_nop 1
    v_mov_b32_dpp v33, v32 quad_perm:[2,3,2,3] row_mask:0xf bank_mask:0xf
    v_cvt_pk_bf16_f32 v32, v32, v33
    ds_swizzle_b32 v36, v32 offset:0x1
    ds_swizzle_b32 v37, v32 offset:0x81
    ds_swizzle_b32 v38, v32 offset:0x101
    ds_swizzle_b32 v39, v32 offset:0x181
    s_waitcnt lgkmcnt(0)
    v_dot2_f32_bf16 v40, v215, v36, 0
    v_dot2_f32_bf16 v41, v224, v36, 0
    v_dot2_f32_bf16 v42, v220, v36, 0
    v_dot2_f32_bf16 v43, v225, v36, 0
    v_dot2_f32_bf16 v44, v221, v36, 0
    v_dot2_f32_bf16 v45, v226, v36, 0
    v_dot2_f32_bf16 v46, v222, v36, 0
    v_dot2_f32_bf16 v47, v227, v36, 0
    v_dot2_f32_bf16 v40, v223, v37, v40
    v_dot2_f32_bf16 v41, v232, v37, v41
    v_dot2_f32_bf16 v42, v228, v37, v42
    v_dot2_f32_bf16 v43, v233, v37, v43
    v_dot2_f32_bf16 v44, v229, v37, v44
    v_dot2_f32_bf16 v45, v234, v37, v45
    v_dot2_f32_bf16 v46, v230, v37, v46
    v_dot2_f32_bf16 v47, v235, v37, v47
    v_dot2_f32_bf16 v40, v231, v38, v40
    v_dot2_f32_bf16 v41, v240, v38, v41
    v_dot2_f32_bf16 v42, v236, v38, v42
    v_dot2_f32_bf16 v43, v241, v38, v43
    v_dot2_f32_bf16 v44, v237, v38, v44
    v_dot2_f32_bf16 v45, v242, v38, v45
    v_dot2_f32_bf16 v46, v238, v38, v46
    v_dot2_f32_bf16 v47, v243, v38, v47
    v_dot2_f32_bf16 v40, v239, v39, v40
    v_dot2_f32_bf16 v41, v248, v39, v41
    v_dot2_f32_bf16 v42, v244, v39, v42
    v_dot2_f32_bf16 v43, v249, v39, v43
    v_dot2_f32_bf16 v44, v245, v39, v44
    v_dot2_f32_bf16 v45, v250, v39, v45
    v_dot2_f32_bf16 v46, v246, v39, v46
    v_dot2_f32_bf16 v47, v251, v39, v47
    v_add_f32_dpp v40, v40, v40 quad_perm:[1,0,3,2] row_mask:0xf bank_mask:0xf
    v_add_f32_dpp v41, v41, v41 quad_perm:[1,0,3,2] row_mask:0xf bank_mask:0xf
    v_add_f32_dpp v42, v42, v42 quad_perm:[1,0,3,2] row_mask:0xf bank_mask:0xf
    v_add_f32_dpp v43, v43, v43 quad_perm:[1,0,3,2] row_mask:0xf bank_mask:0xf
    v_add_f32_dpp v44, v44, v44 quad_perm:[1,0,3,2] row_mask:0xf bank_mask:0xf
    v_add_f32_dpp v45, v45, v45 quad_perm:[1,0,3,2] row_mask:0xf bank_mask:0xf
    v_add_f32_dpp v46, v46, v46 quad_perm:[1,0,3,2] row_mask:0xf bank_mask:0xf
    v_add_f32_dpp v47, v47, v47 quad_perm:[1,0,3,2] row_mask:0xf bank_mask:0xf
    v_cndmask_b32 v40, v40, v44, vcc
    v_cndmask_b32 v41, v41, v45, vcc
    v_cndmask_b32 v42, v42, v46, vcc
    v_cndmask_b32 v43, v43, v47, vcc
    s_cmp_lt_u32 s29, 224
    s_cselect_b64 exec, -1, 0
    buffer_store_dwordx4 v[40:43], v30, s[20:23], s32 offen sc1
    s_mov_b64 exec, -1
    s_branch k_end
l_tred:
    s_cmp_ge_u32 s28, 2
    s_cbranch_scc1 k_end
    v_and_b32 v30, 2, v252
    v_cmp_eq_u32 vcc, 2, v30
    v_mov_b32 v28, s76
    v_mul_f32 v29, s75, v28
    v_add_f32 v28, 1.0, v28
    v_cndmask_b32 v30, v24, v26, vcc
    v_cndmask_b32 v31, v25, v27, vcc
    v_lshlrev_b32 v92, 16, v30
    v_and_b32 v93, 0xffff0000, v30
    v_lshlrev_b32 v94, 16, v31
    v_and_b32 v95, 0xffff0000, v31
    v_fma_f32 v92, v92, v28, -v29
    v_fma_f32 v93, v93, v28, -v29
    v_fma_f32 v94, v94, v28, -v29
    v_fma_f32 v95, v95, v28, -v29
    v_mov_b32 v96, 0xbfb8aa3b
    v_mul_f32 v96, s74, v96
    v_exp_f32 v96, v96
    s_nop 0
    v_add_f32 v96, 1.0, v96
    v_rcp_f32 v96, v96
    s_mov_b32 s78, s27
pl_120:
    s_mul_i32 s32, s89, 14336
    s_add_u32 s32, s32, s79
    s_add_u32 s32, s32, 0xc80000
    buffer_load_dwordx4 v[32:35], v253, s[20:23], s32 offen offset:0 sc1
    buffer_load_dwordx4 v[36:39], v253, s[20:23], s32 offen offset:1024 sc1
    buffer_load_dwordx4 v[40:43], v253, s[20:23], s32 offen offset:2048 sc1
    buffer_load_dwordx4 v[44:47], v253, s[20:23], s32 offen offset:3072 sc1
    s_add_u32 s32, s32, 4096
    buffer_load_dwordx4 v[48:51], v253, s[20:23], s32 offen offset:0 sc1
    buffer_load_dwordx4 v[52:55], v253, s[20:23], s32 offen offset:1024 sc1
    buffer_load_dwordx4 v[56:59], v253, s[20:23], s32 offen offset:2048 sc1
    buffer_load_dwordx4 v[60:63], v253, s[20:23], s32 offen offset:3072 sc1
    s_add_u32 s32, s32, 4096
    buffer_load_dwordx4 v[64:67], v253, s[20:23], s32 offen offset:0 sc1
    buffer_load_dwordx4 v[68:71], v253, s[20:23], s32 offen offset:1024 sc1
    buffer_load_dwordx4 v[72:75], v253, s[20:23], s32 offen offset:2048 sc1
    buffer_load_dwordx4 v[76:79], v253, s[20:23], s32 offen offset:3072 sc1
    s_add_u32 s32, s32, 4096
    buffer_load_dwordx4 v[80:83], v253, s[20:23], s32 offen offset:0 sc1
    buffer_load_dwordx4 v[84:87], v253, s[20:23], s32 offen offset:1024 sc1
    s_waitcnt vmcnt(0)
pc_121:
    v_max3_u32 v30, v32, v33, v34
    v_max3_u32 v30, v30, v35, v36
    v_max3_u32 v30, v30, v37, v38
    v_max3_u32 v30, v30, v39, v40
    v_max3_u32 v30, v30, v41, v42
    v_max3_u32 v30, v30, v43, v44
    v_max3_u32 v30, v30, v45, v46
    v_max3_u32 v30, v30, v47, v48
    v_max3_u32 v30, v30, v49, v50
    v_max3_u32 v30, v30, v51, v52
    v_max3_u32 v30, v30, v53, v54
    v_max3_u32 v30, v30, v55, v56
    v_max3_u32 v30, v30, v57, v58
    v_max3_u32 v30, v30, v59, v60
    v_max3_u32 v30, v30, v61, v62
    v_max3_u32 v30, v30, v63, v64
    v_max3_u32 v30, v30, v65, v66
    v_max3_u32 v30, v30, v67, v68
    v_max3_u32 v30, v30, v69, v70
    v_max3_u32 v30, v30, v71, v72
    v_max3_u32 v30, v30, v73, v74
    v_max3_u32 v30, v30, v75, v76
    v_max3_u32 v30, v30, v77, v78
    v_max3_u32 v30, v30, v79, v80
    v_max3_u32 v30, v30, v81, v82
    v_max3_u32 v30, v30, v83, v84
    v_max3_u32 v30, v30, v85, v86
    v_max_u32 v30, v30, v87
    v_cmp_eq_u32 vcc, -1, v30
    s_cbranch_vccz pd_122
    s_sub_u32 s78, s78, 1
    s_cmp_lg_u32 s78, 0
    s_cbranch_scc1 pl_120
    s_mov_b32 s27, 1
pd_122:
    v_pk_add_f32 v[32:33], v[32:33], v[36:37]
    v_pk_add_f32 v[34:35], v[34:35], v[38:39]
    v_pk_add_f32 v[32:33], v[32:33], v[40:41]
    v_pk_add_f32 v[34:35], v[34:35], v[42:43]
    v_pk_add_f32 v[32:33], v[32:33], v[44:45]
    v_pk_add_f32 v[34:35], v[34:35], v[46:47]
    v_pk_add_f32 v[32:33], v[32:33], v[48:49]
    v_pk_add_f32 v[34:35], v[34:35], v[50:51]
    v_pk_add_f32 v[32:33], v[32:33], v[52:53]
    v_pk_add_f32 v[34:35], v[34:35], v[54:55]
    v_pk_add_f32 v[32:33], v[32:33], v[56:57]
    v_pk_add_f32 v[34:35], v[34:35], v[58:59]
    v_pk_add_f32 v[32:33], v[32:33], v[60:61]
    v_pk_add_f32 v[34:35], v[34:35], v[62:63]
    v_pk_add_f32 v[32:33], v[32:33], v[64:65]
    v_pk_add_f32 v[34:35], v[34:35], v[66:67]
    v_pk_add_f32 v[32:33], v[32:33], v[68:69]
    v_pk_add_f32 v[34:35], v[34:35], v[70:71]
    v_pk_add_f32 v[32:33], v[32:33], v[72:73]
    v_pk_add_f32 v[34:35], v[34:35], v[74:75]
    v_pk_add_f32 v[32:33], v[32:33], v[76:77]
    v_pk_add_f32 v[34:35], v[34:35], v[78:79]
    v_pk_add_f32 v[32:33], v[32:33], v[80:81]
    v_pk_add_f32 v[34:35], v[34:35], v[82:83]
    v_pk_add_f32 v[32:33], v[32:33], v[84:85]
    v_pk_add_f32 v[34:35], v[34:35], v[86:87]
    s_nop 0
    v_add_f32_dpp v32, v32, v32 row_ror:4 row_mask:0xf bank_mask:0xf
    v_add_f32_dpp v33, v33, v33 row_ror:4 row_mask:0xf bank_mask:0xf
    v_add_f32_dpp v34, v34, v34 row_ror:4 row_mask:0xf bank_mask:0xf
    v_add_f32_dpp v35, v35, v35 row_ror:4 row_mask:0xf bank_mask:0xf
    v_add_f32_dpp v32, v32, v32 row_ror:8 row_mask:0xf bank_mask:0xf
    v_add_f32_dpp v33, v33, v33 row_ror:8 row_mask:0xf bank_mask:0xf
    v_add_f32_dpp v34, v34, v34 row_ror:8 row_mask:0xf bank_mask:0xf
    v_add_f32_dpp v35, v35, v35 row_ror:8 row_mask:0xf bank_mask:0xf
    v_mov_b32 v36, v32
    v_mov_b32 v37, v33
    v_mov_b32 v38, v34
    v_mov_b32 v39, v35
    v_permlane16_swap_b32 v32, v36
    v_permlane16_swap_b32 v33, v37
    v_permlane16_swap_b32 v34, v38
    v_permlane16_swap_b32 v35, v39
    v_add_f32 v32, v32, v36
    v_add_f32 v33, v33, v37
    v_add_f32 v34, v34, v38
    v_add_f32 v35, v35, v39
    v_mov_b32 v36, v32
    v_mov_b32 v37, v33
    v_mov_b32 v38, v34
    v_mov_b32 v39, v35
    v_permlane32_swap_b32 v32, v36
    v_permlane32_swap_b32 v33, v37
    v_permlane32_swap_b32 v34, v38
    v_permlane32_swap_b32 v35, v39
    v_add_f32 v32, v32, v36
    v_add_f32 v33, v33, v37
    v_add_f32 v34, v34, v38
    v_add_f32 v35, v35, v39
    v_fma_f32 v32, v32, v96, v92
    v_fma_f32 v33, v33, v96, v93
    v_fma_f32 v34, v34, v96, v94
    v_fma_f32 v35, v35, v96, v95
    v_cvt_pk_bf16_f32 v32, v32, v33
    v_cvt_pk_bf16_f32 v33, v34, v35
    s_lshl_b32 s32, s73, 11
    s_lshl_b32 s33, s89, 5
    s_add_u32 s32, s32, s33
    v_lshlrev_b32 v30, 3, v252
    s_mov_b64 exec, 15
    buffer_store_dwordx2 v[32:33], v30, s[12:15], s32 offen sc1
    s_mov_b64 exec, -1
k_end:
k_exit:
    s_endpgm
.section .rodata,"a"
.p2align 6
.amdhsa_kernel interleave_layers__sliding_block__moe_arch_mod__prompt_kernel
  .amdhsa_next_free_vgpr 256
  .amdhsa_next_free_sgpr 102
  .amdhsa_accum_offset 256
  .amdhsa_group_segment_fixed_size 0
  .amdhsa_kernarg_size 88
  .amdhsa_user_sgpr_count 2
  .amdhsa_user_sgpr_kernarg_segment_ptr 1
  .amdhsa_system_sgpr_workgroup_id_x 1
.end_amdhsa_kernel
```

```asm
; @launch grid=(256,1,1) block=(512,1,1) lds=163840
.amdgcn_target "amdgcn-amd-amdhsa--gfx950"
.text
.globl interleave_layers__sliding_block__moe_arch_mod__prompt_kernel
.p2align 8
.type interleave_layers__sliding_block__moe_arch_mod__prompt_kernel,@function
interleave_layers__sliding_block__moe_arch_mod__prompt_kernel:
    s_cmp_ge_u32 s2, 256
    s_cbranch_scc1 k_exit
    s_load_dwordx4 s[4:7], s[0:1], 0
    s_load_dwordx2 s[8:9], s[0:1], 16
    s_load_dwordx2 s[20:21], s[0:1], 80
    s_load_dwordx2 s[80:81], s[0:1], 32
    v_lshrrev_b32 v1, 6, v0
    v_and_b32 v252, 63, v0
    v_readfirstlane_b32 s3, v1
    v_lshlrev_b32 v253, 4, v252
    s_and_b32 s30, s2, 7
    s_lshr_b32 s31, s2, 3
    s_and_b32 s32, s31, 1
    s_lshl_b32 s33, s30, 1
    s_add_u32 s24, s33, s32
    s_lshr_b32 s25, s31, 1
    s_add_u32 s33, s33, s25
    s_add_u32 s94, s33, s32
    s_sub_u32 s95, s33, s32
    s_add_u32 s98, s95, 15
    s_and_b32 s98, s98, 15
    s_mul_i32 s29, s30, 28
    s_lshl_b32 s32, s30, 2
    s_add_u32 s32, s32, 196
    s_cmp_lt_u32 s31, 28
    s_cselect_b32 s29, s29, s32
    s_add_u32 s29, s29, s31
    s_lshl_b32 s72, s24, 4
    s_add_u32 s72, s72, s25
    s_mov_b32 s26, 0
    s_mov_b32 s27, 20000
    s_and_b32 s28, s3, 3
    s_lshl_b32 s99, s24, 2
    s_add_u32 s99, s99, s28
    s_lshl_b32 s101, s28, 10
    s_mov_b32 s18, 0x600000
    s_mov_b32 s19, 0x20000
    s_mov_b32 s10, 0x200000
    s_mov_b32 s11, 0x20000
    s_mov_b32 s22, 0x8000000
    s_mov_b32 s23, 0x20000
    s_mov_b32 s82, 0x800
    s_mov_b32 s83, 0x20000
    s_cmp_ge_u32 s3, 4
    s_cbranch_scc1 l_start
    s_getpc_b64 s[32:33]
pc_1:
    s_sub_u32 s32, s32, pc_1-interleave_layers__sliding_block__moe_arch_mod__prompt_kernel
    s_subb_u32 s33, s33, 0
    s_lshr_b32 s34, s2, 3
    s_lshl_b32 s34, s34, 2
    s_add_u32 s34, s34, s28
    s_and_b32 s34, s34, 63
    s_lshl_b32 s34, s34, 7
    v_lshl_add_u32 v191, v252, 13, s34
    s_mov_b32 s34, k_exit-interleave_layers__sliding_block__moe_arch_mod__prompt_kernel
    s_mov_b32 s35, 0x20000
    buffer_load_dword v191, v191, s[32:35], 0 offen
    s_waitcnt lgkmcnt(0)
    s_mov_b32 s88, 0xdd8000
    s_load_dword s88, s[20:21], s88
    s_mov_b64 s[16:17], s[6:7]
    s_mov_b32 s6, 0x400000
    s_mov_b32 s7, 0x20000
    s_load_dwordx2 s[12:13], s[0:1], 64
    s_mov_b32 s14, 0x400000
    s_mov_b32 s15, 0x20000
    s_lshr_b32 s30, s16, 7
    s_sub_u32 s30, 3, s30
    s_and_b32 s30, s30, 7
    s_and_b32 s31, s24, 1
    s_lshl_b32 s31, s31, 3
    s_add_u32 s30, s30, s31
    s_and_b32 s31, s24, 14
    s_add_u32 s84, s31, s30
    s_lshl_b32 s31, s25, 2
    s_add_u32 s31, s31, s28
    s_mul_i32 s31, s31, 6144
    s_lshl_b32 s30, s30, 7
    s_add_u32 s30, s30, s31
    v_min_u32 v190, 2, v252
    v_lshl_add_u32 v190, v190, 11, s30
    s_add_u32 s30, s84, 0
    s_and_b32 s30, s30, 15
    s_mul_i32 s30, s30, 393216
    buffer_load_dword v191, v190, s[16:19], s30 offen
    s_add_u32 s30, s84, 1
    s_and_b32 s30, s30, 15
    s_mul_i32 s30, s30, 393216
    buffer_load_dword v191, v190, s[16:19], s30 offen
    v_lshrrev_b32 v5, 5, v252
    v_lshlrev_b32 v6, 3, v5
    s_lshl_b32 s33, s98, 7
    buffer_load_dwordx2 v[224:225], v6, s[80:83], s33 offen offset:0
    buffer_load_dwordx2 v[226:227], v6, s[80:83], s33 offen offset:16
    buffer_load_dwordx2 v[228:229], v6, s[80:83], s33 offen offset:32
    buffer_load_dwordx2 v[230:231], v6, s[80:83], s33 offen offset:48
    buffer_load_dwordx2 v[232:233], v6, s[80:83], s33 offen offset:64
    buffer_load_dwordx2 v[234:235], v6, s[80:83], s33 offen offset:80
    buffer_load_dwordx2 v[236:237], v6, s[80:83], s33 offen offset:96
    buffer_load_dwordx2 v[238:239], v6, s[80:83], s33 offen offset:112
    s_mov_b32 s40, 0xffffffff
    s_mov_b32 s41, 0xfffffff0
    s_mov_b32 s42, 0xfffffffe
    s_mov_b32 s43, 0xffffffe0
    s_mov_b32 s44, 0xfffffffc
    s_mov_b32 s45, 0xffffffc0
    s_mov_b32 s46, 0xfffffff8
    s_mov_b32 s47, 0xffffff80
    s_mov_b32 s48, 0xffff0000
    s_mov_b32 s49, 0xfff00000
    s_mov_b32 s50, 0xfffe0000
    s_mov_b32 s51, 0xffe00000
    s_mov_b32 s52, 0xfffc0000
    s_mov_b32 s53, 0xffc00000
    s_mov_b32 s54, 0xfff80000
    s_mov_b32 s55, 0xff800000
    s_mov_b32 s56, 0xffffff00
    s_mov_b32 s57, 0xfffff000
    s_mov_b32 s58, 0xfffffe00
    s_mov_b32 s59, 0xffffe000
    s_mov_b32 s60, 0xfffffc00
    s_mov_b32 s61, 0xffffc000
    s_mov_b32 s62, 0xfffff800
    s_mov_b32 s63, 0xffff8000
    s_mov_b32 s64, 0xff000000
    s_mov_b32 s65, 0xf0000000
    s_mov_b32 s66, 0xfe000000
    s_mov_b32 s67, 0xe0000000
    s_mov_b32 s68, 0xfc000000
    s_mov_b32 s69, 0xc0000000
    s_mov_b32 s70, 0xf8000000
    s_mov_b32 s71, 0x80000000
    v_bfe_u32 v20, v252, 3, 2
    v_lshrrev_b32 v21, 5, v252
    v_lshl_add_u32 v20, v21, 3, v20
    s_lshr_b32 s32, s28, 1
    s_lshl_b32 s32, s32, 4
    s_and_b32 s33, s28, 1
    s_lshl_b32 s33, s33, 2
    s_add_u32 s32, s32, s33
    v_add_u32 v20, s32, v20
    v_lshlrev_b32 v20, 11, v20
    v_lshrrev_b32 v21, 2, v252
    v_and_b32 v21, 4, v21
    v_xor_b32 v21, v21, v252
    v_and_b32 v21, 7, v21
    v_lshl_add_u32 v20, v21, 4, v20
    s_lshl_b32 s32, s98, 7
    v_add_u32 v243, s32, v20
    s_and_b32 s34, s3, 1
    s_lshr_b32 s35, s3, 1
    v_and_b32 v4, 15, v252
    v_lshrrev_b32 v7, 4, v252
    v_lshrrev_b32 v6, 1, v4
    v_xor_b32 v6, v6, v7
    v_lshlrev_b32 v6, 4, v6
    v_lshl_add_u32 v6, v4, 7, v6
    s_lshl_b32 s30, s34, 13
    v_add_u32 v176, s30, v6
    v_xor_b32 v177, 64, v176
    s_lshl_b32 s30, s35, 1
    v_lshrrev_b32 v20, 2, v252
    v_bfe_u32 v21, v20, 1, 2
    v_xor_b32 v21, s30, v21
    v_lshlrev_b32 v20, 7, v20
    v_lshl_add_u32 v20, v21, 5, v20
    v_and_b32 v21, 3, v252
    v_lshl_add_u32 v20, v21, 3, v20
    v_add_u32 v178, 40960, v20
    v_xor_b32 v179, 32, v178
    v_and_b32 v8, 31, v252
    v_bfe_u32 v6, v8, 1, 3
    v_xor_b32 v6, v6, v5
    v_lshlrev_b32 v6, 4, v6
    v_lshl_add_u32 v6, v8, 7, v6
    s_lshl_b32 s30, s3, 12
    s_add_u32 s30, s30, 147456
    v_add_u32 v192, s30, v6
    v_xor_b32 v193, 32, v192
    v_xor_b32 v194, 64, v192
    v_xor_b32 v195, 96, v192
    s_lshl_b32 s30, s34, 8
    v_lshl_add_u32 v184, v4, 2, s30
    v_lshl_add_u32 v185, v7, 4, s30
    s_lshl_b32 s30, s35, 7
    v_lshl_add_u32 v186, v7, 4, s30
    s_add_u32 s30, s30, 1536
    v_lshl_add_u32 v187, v4, 2, s30
    s_lshl_b32 s30, s3, 7
    s_add_u32 s30, s30, 2048
    v_lshl_add_u32 v188, v8, 2, s30
    v_mov_b32 v189, 0
    v_lshlrev_b32 v6, 9, v7
    v_lshl_add_u32 v245, v4, 4, v6
    v_and_b32 v9, 8, v4
    v_lshl_add_u32 v244, v9, 4, v245
    s_mul_i32 s30, s35, 49152
    s_lshl_b32 s31, s34, 13
    s_add_u32 s30, s30, s31
    s_add_u32 s30, s30, 98304
    v_add_u32 v246, s30, v244
    v_add_u32 v247, s30, v245
    s_lshl_b32 s30, s3, 12
    s_add_u32 s30, s30, 49152
    v_add_u32 v248, s30, v245
    s_getreg_b32 s30, hwreg(HW_REG_XCC_ID, 0, 4)
    v_mov_b32 v251, s30
    s_lshl_b32 s30, s25, 4
    s_add_u32 s30, s30, s24
    s_sub_u32 s30, s30, s72
    s_add_u32 s30, s30, 512
    v_mul_u32_u24 v249, s30, v252
    v_add_u32 v249, s72, v249
    v_lshlrev_b32 v249, 3, v249
    s_cmp_eq_u32 s3, 0
    s_cselect_b32 s89, 10, -1
    v_mov_b32 v242, 0
    v_mov_b32 v0, 0
    v_mov_b32 v1, 0
    v_mov_b32 v2, 0
    v_mov_b32 v3, 0
    v_mov_b32 v4, 0
    v_mov_b32 v5, 0
    v_mov_b32 v6, 0
    v_mov_b32 v7, 0
    v_mov_b32 v8, 0
    v_mov_b32 v9, 0
    v_mov_b32 v10, 0
    v_mov_b32 v11, 0
    v_mov_b32 v12, 0
    v_mov_b32 v13, 0
    v_mov_b32 v14, 0
    v_mov_b32 v15, 0
    v_mov_b32 v16, 0
    v_mov_b32 v17, 0
    v_mov_b32 v18, 0
    v_mov_b32 v19, 0
    v_mov_b32 v20, 0
    v_mov_b32 v21, 0
    v_mov_b32 v22, 0
    v_mov_b32 v23, 0
    v_mov_b32 v24, 0
    v_mov_b32 v25, 0
    v_mov_b32 v26, 0
    v_mov_b32 v27, 0
    v_mov_b32 v28, 0
    v_mov_b32 v29, 0
    v_mov_b32 v30, 0
    v_mov_b32 v31, 0
    v_mov_b32 v32, 0
    v_mov_b32 v33, 0
    v_mov_b32 v34, 0
    v_mov_b32 v35, 0
    v_mov_b32 v36, 0
    v_mov_b32 v37, 0
    v_mov_b32 v38, 0
    v_mov_b32 v39, 0
    v_mov_b32 v40, 0
    v_mov_b32 v41, 0
    v_mov_b32 v42, 0
    v_mov_b32 v43, 0
    v_mov_b32 v44, 0
    v_mov_b32 v45, 0
    v_mov_b32 v46, 0
    v_mov_b32 v47, 0
    v_mov_b32 v48, 0
    v_mov_b32 v49, 0
    v_mov_b32 v50, 0
    v_mov_b32 v51, 0
    v_mov_b32 v52, 0
    v_mov_b32 v53, 0
    v_mov_b32 v54, 0
    v_mov_b32 v55, 0
    v_mov_b32 v56, 0
    v_mov_b32 v57, 0
    v_mov_b32 v58, 0
    v_mov_b32 v59, 0
    v_mov_b32 v60, 0
    v_mov_b32 v61, 0
    v_mov_b32 v62, 0
    v_mov_b32 v63, 0
    v_mov_b32 v64, 0
    v_mov_b32 v65, 0
    v_mov_b32 v66, 0
    v_mov_b32 v67, 0
    v_mov_b32 v68, 0
    v_mov_b32 v69, 0
    v_mov_b32 v70, 0
    v_mov_b32 v71, 0
    v_mov_b32 v72, 0
    v_mov_b32 v73, 0
    v_mov_b32 v74, 0
    v_mov_b32 v75, 0
    v_mov_b32 v76, 0
    v_mov_b32 v77, 0
    v_mov_b32 v78, 0
    v_mov_b32 v79, 0
    v_mov_b32 v80, 0
    v_mov_b32 v81, 0
    v_mov_b32 v82, 0
    v_mov_b32 v83, 0
    v_mov_b32 v84, 0
    v_mov_b32 v85, 0
    v_mov_b32 v86, 0
    v_mov_b32 v87, 0
    v_mov_b32 v88, 0
    v_mov_b32 v89, 0
    v_mov_b32 v90, 0
    v_mov_b32 v91, 0
    v_mov_b32 v92, 0
    v_mov_b32 v93, 0
    v_mov_b32 v94, 0
    v_mov_b32 v95, 0
    s_waitcnt vmcnt(0) lgkmcnt(0)
    s_add_u32 s88, s88, 0x9e3779b9
    v_mov_b32 v250, s88
    v_dot2c_f32_bf16 v242, 0x3f803f80, v224
    v_dot2c_f32_bf16 v242, 0x3f803f80, v225
    v_dot2c_f32_bf16 v242, 0x3f803f80, v226
    v_dot2c_f32_bf16 v242, 0x3f803f80, v227
    v_dot2c_f32_bf16 v242, 0x3f803f80, v228
    v_dot2c_f32_bf16 v242, 0x3f803f80, v229
    v_dot2c_f32_bf16 v242, 0x3f803f80, v230
    v_dot2c_f32_bf16 v242, 0x3f803f80, v231
    v_dot2c_f32_bf16 v242, 0x3f803f80, v232
    v_dot2c_f32_bf16 v242, 0x3f803f80, v233
    v_dot2c_f32_bf16 v242, 0x3f803f80, v234
    v_dot2c_f32_bf16 v242, 0x3f803f80, v235
    v_dot2c_f32_bf16 v242, 0x3f803f80, v236
    v_dot2c_f32_bf16 v242, 0x3f803f80, v237
    v_dot2c_f32_bf16 v242, 0x3f803f80, v238
    v_dot2c_f32_bf16 v242, 0x3f803f80, v239
    s_add_u32 s30, s84, 2
    s_and_b32 s30, s30, 15
    s_mul_i32 s30, s30, 393216
    buffer_load_dword v191, v190, s[16:19], s30 offen
    s_add_u32 s30, s84, 3
    s_and_b32 s30, s30, 15
    s_mul_i32 s30, s30, 393216
    buffer_load_dword v191, v190, s[16:19], s30 offen
    s_add_u32 s30, s84, 4
    s_and_b32 s30, s30, 15
    s_mul_i32 s30, s30, 393216
    buffer_load_dword v191, v190, s[16:19], s30 offen
    s_add_u32 s30, s84, 5
    s_and_b32 s30, s30, 15
    s_mul_i32 s30, s30, 393216
    buffer_load_dword v191, v190, s[16:19], s30 offen
    s_setprio 1
e_q:
    s_mov_b32 s31, 0
    s_mov_b32 s32, 147456
    s_mov_b32 s36, 15
    v_add_u32 v180, s32, v176
    v_mov_b32 v182, v178
    v_add_u32 v181, s32, v177
    v_mov_b32 v183, v179
    s_barrier
    ds_read_b128 v[96:99], v180 offset:0
    ds_read_b64_tr_b16 v[112:113], v182 offset:0
    ds_read_b64_tr_b16 v[114:115], v182 offset:2048
    ds_read_b128 v[100:103], v180 offset:2048
    ds_read_b128 v[104:107], v180 offset:4096
    ds_read_b128 v[108:111], v180 offset:6144
    ds_read_b64_tr_b16 v[116:117], v183 offset:0
    ds_read_b64_tr_b16 v[118:119], v183 offset:2048
    ds_read_b64_tr_b16 v[120:121], v182 offset:8192
    ds_read_b64_tr_b16 v[122:123], v182 offset:10240
    ds_read_b64_tr_b16 v[124:125], v183 offset:8192
    ds_read_b64_tr_b16 v[126:127], v183 offset:10240
    ds_read_b64_tr_b16 v[128:129], v182 offset:16384
    ds_read_b64_tr_b16 v[130:131], v182 offset:18432
    ds_read_b64_tr_b16 v[132:133], v183 offset:16384
    ds_read_b64_tr_b16 v[134:135], v183 offset:18432
    s_add_u32 s85, s84, 5
e_loop:
    s_waitcnt lgkmcnt(0)
    v_mfma_f32_16x16x32_bf16 v[0:3], v[112:115], v[96:99], v[0:3]
    ds_read_b128 v[136:139], v181 offset:0
    v_mfma_f32_16x16x32_bf16 v[8:11], v[112:115], v[100:103], v[8:11]
    ds_read_b64_tr_b16 v[152:153], v182 offset:4096
    v_mfma_f32_16x16x32_bf16 v[16:19], v[112:115], v[104:107], v[16:19]
    ds_read_b64_tr_b16 v[154:155], v182 offset:6144
    v_mfma_f32_16x16x32_bf16 v[24:27], v[112:115], v[108:111], v[24:27]
    ds_read_b128 v[140:143], v181 offset:2048
    v_mfma_f32_16x16x32_bf16 v[28:31], v[116:119], v[108:111], v[28:31]
    ds_read_b128 v[144:147], v181 offset:4096
    v_mfma_f32_16x16x32_bf16 v[20:23], v[116:119], v[104:107], v[20:23]
    ds_read_b128 v[148:151], v181 offset:6144
    v_mfma_f32_16x16x32_bf16 v[12:15], v[116:119], v[100:103], v[12:15]
    ds_read_b64_tr_b16 v[156:157], v183 offset:4096
    v_mfma_f32_16x16x32_bf16 v[4:7], v[116:119], v[96:99], v[4:7]
    ds_read_b64_tr_b16 v[158:159], v183 offset:6144
    v_mfma_f32_16x16x32_bf16 v[32:35], v[120:123], v[96:99], v[32:35]
    ds_read_b64_tr_b16 v[160:161], v182 offset:12288
    v_mfma_f32_16x16x32_bf16 v[40:43], v[120:123], v[100:103], v[40:43]
    ds_read_b64_tr_b16 v[162:163], v182 offset:14336
    v_mfma_f32_16x16x32_bf16 v[48:51], v[120:123], v[104:107], v[48:51]
    ds_read_b64_tr_b16 v[164:165], v183 offset:12288
    v_mfma_f32_16x16x32_bf16 v[56:59], v[120:123], v[108:111], v[56:59]
    ds_read_b64_tr_b16 v[166:167], v183 offset:14336
    v_mfma_f32_16x16x32_bf16 v[60:63], v[124:127], v[108:111], v[60:63]
    ds_read_b64_tr_b16 v[168:169], v182 offset:20480
    v_mfma_f32_16x16x32_bf16 v[52:55], v[124:127], v[104:107], v[52:55]
    ds_read_b64_tr_b16 v[170:171], v182 offset:22528
    v_mfma_f32_16x16x32_bf16 v[44:47], v[124:127], v[100:103], v[44:47]
    ds_read_b64_tr_b16 v[172:173], v183 offset:20480
    v_mfma_f32_16x16x32_bf16 v[36:39], v[124:127], v[96:99], v[36:39]
    ds_read_b64_tr_b16 v[174:175], v183 offset:22528
    v_mfma_f32_16x16x32_bf16 v[64:67], v[96:99], v[128:131], v[64:67]
    s_cmp_eq_u32 s36, s89
    s_cbranch_scc1 e_arr
e_arr_ret:
    v_mfma_f32_16x16x32_bf16 v[68:71], v[100:103], v[128:131], v[68:71]
    s_add_u32 s31, s31, 24576
    s_sub_u32 s32, s32, 16384
    v_mfma_f32_16x16x32_bf16 v[72:75], v[104:107], v[128:131], v[72:75]
    s_cmp_ge_u32 s31, 73728
    s_cselect_b32 s31, 0, s31
    s_cselect_b32 s32, 147456, s32
    v_mfma_f32_16x16x32_bf16 v[76:79], v[108:111], v[128:131], v[76:79]
    v_add_u32 v182, s31, v178
    v_add_u32 v180, s32, v176
    v_mfma_f32_16x16x32_bf16 v[92:95], v[108:111], v[132:135], v[92:95]
    v_add_u32 v183, s31, v179
    v_add_u32 v181, s32, v177
    v_mfma_f32_16x16x32_bf16 v[88:91], v[104:107], v[132:135], v[88:91]
    s_add_u32 s85, s85, 1
    s_and_b32 s30, s85, 15
    v_mfma_f32_16x16x32_bf16 v[84:87], v[100:103], v[132:135], v[84:87]
    s_mul_i32 s30, s30, 393216
    s_cmp_ge_u32 s36, 6
    v_mfma_f32_16x16x32_bf16 v[80:83], v[96:99], v[132:135], v[80:83]
    s_waitcnt lgkmcnt(0)
    v_mfma_f32_16x16x32_bf16 v[0:3], v[152:155], v[136:139], v[0:3]
    s_barrier
    ds_read_b128 v[96:99], v180 offset:0
    v_mfma_f32_16x16x32_bf16 v[8:11], v[152:155], v[140:143], v[8:11]
    ds_read_b64_tr_b16 v[112:113], v182 offset:0
    v_mfma_f32_16x16x32_bf16 v[16:19], v[152:155], v[144:147], v[16:19]
    ds_read_b64_tr_b16 v[114:115], v182 offset:2048
    v_mfma_f32_16x16x32_bf16 v[24:27], v[152:155], v[148:151], v[24:27]
    ds_read_b128 v[100:103], v180 offset:2048
    v_mfma_f32_16x16x32_bf16 v[28:31], v[156:159], v[148:151], v[28:31]
    ds_read_b128 v[104:107], v180 offset:4096
    v_mfma_f32_16x16x32_bf16 v[20:23], v[156:159], v[144:147], v[20:23]
    ds_read_b128 v[108:111], v180 offset:6144
    v_mfma_f32_16x16x32_bf16 v[12:15], v[156:159], v[140:143], v[12:15]
    ds_read_b64_tr_b16 v[116:117], v183 offset:0
    v_mfma_f32_16x16x32_bf16 v[4:7], v[156:159], v[136:139], v[4:7]
    ds_read_b64_tr_b16 v[118:119], v183 offset:2048
    v_mfma_f32_16x16x32_bf16 v[32:35], v[160:163], v[136:139], v[32:35]
    ds_read_b64_tr_b16 v[120:121], v182 offset:8192
    v_mfma_f32_16x16x32_bf16 v[40:43], v[160:163], v[140:143], v[40:43]
    ds_read_b64_tr_b16 v[122:123], v182 offset:10240
    v_mfma_f32_16x16x32_bf16 v[48:51], v[160:163], v[144:147], v[48:51]
    ds_read_b64_tr_b16 v[124:125], v183 offset:8192
    v_mfma_f32_16x16x32_bf16 v[56:59], v[160:163], v[148:151], v[56:59]
    ds_read_b64_tr_b16 v[126:127], v183 offset:10240
    v_mfma_f32_16x16x32_bf16 v[60:63], v[164:167], v[148:151], v[60:63]
    ds_read_b64_tr_b16 v[128:129], v182 offset:16384
    v_mfma_f32_16x16x32_bf16 v[52:55], v[164:167], v[144:147], v[52:55]
    ds_read_b64_tr_b16 v[130:131], v182 offset:18432
    v_mfma_f32_16x16x32_bf16 v[44:47], v[164:167], v[140:143], v[44:47]
    ds_read_b64_tr_b16 v[132:133], v183 offset:16384
    v_mfma_f32_16x16x32_bf16 v[36:39], v[164:167], v[136:139], v[36:39]
    ds_read_b64_tr_b16 v[134:135], v183 offset:18432
    v_mfma_f32_16x16x32_bf16 v[64:67], v[136:139], v[168:171], v[64:67]
    s_cselect_b64 exec, 7, 0
    buffer_load_dword v191, v190, s[16:19], s30 offen
    s_mov_b64 exec, -1
    v_mfma_f32_16x16x32_bf16 v[68:71], v[140:143], v[168:171], v[68:71]
    s_sub_u32 s36, s36, 1
    s_cmp_eq_u32 s36, 0
    v_mfma_f32_16x16x32_bf16 v[72:75], v[144:147], v[168:171], v[72:75]
    v_mfma_f32_16x16x32_bf16 v[76:79], v[148:151], v[168:171], v[76:79]
    v_mfma_f32_16x16x32_bf16 v[92:95], v[148:151], v[172:175], v[92:95]
    v_mfma_f32_16x16x32_bf16 v[88:91], v[144:147], v[172:175], v[88:91]
    v_mfma_f32_16x16x32_bf16 v[84:87], v[140:143], v[172:175], v[84:87]
    v_mfma_f32_16x16x32_bf16 v[80:83], v[136:139], v[172:175], v[80:83]
    s_cbranch_scc0 e_loop
    s_waitcnt lgkmcnt(0)
    v_mfma_f32_16x16x32_bf16 v[0:3], v[112:115], v[96:99], v[0:3]
    ds_read_b128 v[136:139], v181 offset:0
    v_mfma_f32_16x16x32_bf16 v[8:11], v[112:115], v[100:103], v[8:11]
    ds_read_b64_tr_b16 v[152:153], v182 offset:4096
    v_mfma_f32_16x16x32_bf16 v[16:19], v[112:115], v[104:107], v[16:19]
    ds_read_b64_tr_b16 v[154:155], v182 offset:6144
    v_mfma_f32_16x16x32_bf16 v[24:27], v[112:115], v[108:111], v[24:27]
    ds_read_b128 v[140:143], v181 offset:2048
    v_mfma_f32_16x16x32_bf16 v[28:31], v[116:119], v[108:111], v[28:31]
    ds_read_b128 v[144:147], v181 offset:4096
    v_mfma_f32_16x16x32_bf16 v[20:23], v[116:119], v[104:107], v[20:23]
    ds_read_b128 v[148:151], v181 offset:6144
    v_mfma_f32_16x16x32_bf16 v[12:15], v[116:119], v[100:103], v[12:15]
    ds_read_b64_tr_b16 v[156:157], v183 offset:4096
    v_mfma_f32_16x16x32_bf16 v[4:7], v[116:119], v[96:99], v[4:7]
    ds_read_b64_tr_b16 v[158:159], v183 offset:6144
    v_mfma_f32_16x16x32_bf16 v[32:35], v[120:123], v[96:99], v[32:35]
    ds_read_b64_tr_b16 v[160:161], v182 offset:12288
    v_mfma_f32_16x16x32_bf16 v[40:43], v[120:123], v[100:103], v[40:43]
    ds_read_b64_tr_b16 v[162:163], v182 offset:14336
    v_mfma_f32_16x16x32_bf16 v[48:51], v[120:123], v[104:107], v[48:51]
    ds_read_b64_tr_b16 v[164:165], v183 offset:12288
    v_mfma_f32_16x16x32_bf16 v[56:59], v[120:123], v[108:111], v[56:59]
    ds_read_b64_tr_b16 v[166:167], v183 offset:14336
    v_mfma_f32_16x16x32_bf16 v[60:63], v[124:127], v[108:111], v[60:63]
    ds_read_b64_tr_b16 v[168:169], v182 offset:20480
    v_mfma_f32_16x16x32_bf16 v[52:55], v[124:127], v[104:107], v[52:55]
    ds_read_b64_tr_b16 v[170:171], v182 offset:22528
    v_mfma_f32_16x16x32_bf16 v[44:47], v[124:127], v[100:103], v[44:47]
    ds_read_b64_tr_b16 v[172:173], v183 offset:20480
    v_mfma_f32_16x16x32_bf16 v[36:39], v[124:127], v[96:99], v[36:39]
    ds_read_b64_tr_b16 v[174:175], v183 offset:22528
    v_mfma_f32_16x16x32_bf16 v[64:67], v[96:99], v[128:131], v[64:67]
    s_cmp_lg_u32 s26, 0
    s_cbranch_scc1 e_nores
    ds_read_b128 v[208:211], v192
    ds_read_b128 v[212:215], v193
    ds_read_b128 v[216:219], v194
    ds_read_b128 v[220:223], v195
e_nores:
    v_mfma_f32_16x16x32_bf16 v[68:71], v[100:103], v[128:131], v[68:71]
    s_and_b32 s34, s3, 1
    s_lshr_b32 s35, s3, 1
    s_lshl_b32 s30, s25, 1
    v_mfma_f32_16x16x32_bf16 v[72:75], v[104:107], v[128:131], v[72:75]
    s_add_u32 s30, s30, s35
    s_lshl_b32 s30, s30, 6
    s_lshl_b32 s31, s24, 2
    v_mfma_f32_16x16x32_bf16 v[76:79], v[108:111], v[128:131], v[76:79]
    s_add_u32 s30, s30, s31
    s_lshl_b32 s31, s34, 1
    s_add_u32 s30, s30, s31
    v_mfma_f32_16x16x32_bf16 v[92:95], v[108:111], v[132:135], v[92:95]
    s_lshl_b32 s32, s30, 12
    s_add_u32 s32, s32, s26
    s_add_u32 s33, s32, 4096
    v_mfma_f32_16x16x32_bf16 v[88:91], v[104:107], v[132:135], v[88:91]
    v_mfma_f32_16x16x32_bf16 v[84:87], v[100:103], v[132:135], v[84:87]
    v_mfma_f32_16x16x32_bf16 v[80:83], v[96:99], v[132:135], v[80:83]
    s_waitcnt vmcnt(0) lgkmcnt(0)
    v_mfma_f32_16x16x32_bf16 v[32:35], v[160:163], v[136:139], v[32:35]
    s_barrier
    ds_read2_b32 v[204:205], v184 offset0:128 offset1:144
    ds_read_b128 v[128:131], v186 offset:1280
    v_mfma_f32_16x16x32_bf16 v[40:43], v[160:163], v[140:143], v[40:43]
    ds_read_b128 v[132:135], v186 offset:1344
    ds_read2_b32 v[192:193], v184 offset0:0 offset1:16
    v_mfma_f32_16x16x32_bf16 v[48:51], v[160:163], v[144:147], v[48:51]
    ds_read2_b32 v[206:207], v184 offset0:160 offset1:176
    ds_read2_b32 v[194:195], v184 offset0:32 offset1:48
    v_mfma_f32_16x16x32_bf16 v[56:59], v[160:163], v[148:151], v[56:59]
    ds_read2_b32 v[190:191], v187 offset0:0 offset1:16
    ds_read_b128 v[112:115], v185 offset:512
    v_mfma_f32_16x16x32_bf16 v[36:39], v[164:167], v[136:139], v[36:39]
    ds_read_b128 v[96:99], v185 offset:0
    ds_read_b128 v[116:119], v185 offset:576
    v_mfma_f32_16x16x32_bf16 v[44:47], v[164:167], v[140:143], v[44:47]
    ds_read_b128 v[100:103], v185 offset:64
    ds_read_b128 v[120:123], v185 offset:640
    v_mfma_f32_16x16x32_bf16 v[52:55], v[164:167], v[144:147], v[52:55]
    ds_read_b128 v[104:107], v185 offset:128
    ds_read_b128 v[124:127], v185 offset:704
    v_mfma_f32_16x16x32_bf16 v[60:63], v[164:167], v[148:151], v[60:63]
    ds_read_b128 v[108:111], v185 offset:192
    ds_read_b128 v[196:199], v186 offset:1024
    v_mfma_f32_16x16x32_bf16 v[64:67], v[136:139], v[168:171], v[64:67]
    ds_read_b128 v[200:203], v186 offset:1088
    ds_read2_b32 v[240:241], v188 offset0:0 offset1:128
    v_mfma_f32_16x16x32_bf16 v[68:71], v[140:143], v[168:171], v[68:71]
    ds_read_b64 v[250:251], v189 offset:3072
    v_mfma_f32_16x16x32_bf16 v[72:75], v[144:147], v[168:171], v[72:75]
    s_waitcnt lgkmcnt(13)
    v_fma_f32 v32, v128, -v204, v32
    v_fma_f32 v33, v129, -v204, v33
    v_fma_f32 v34, v130, -v204, v34
    v_mfma_f32_16x16x32_bf16 v[76:79], v[148:151], v[168:171], v[76:79]
    v_fma_f32 v35, v131, -v204, v35
    v_fma_f32 v36, v132, -v204, v36
    v_fma_f32 v37, v133, -v204, v37
    v_mfma_f32_16x16x32_bf16 v[80:83], v[136:139], v[172:175], v[80:83]
    v_fma_f32 v38, v134, -v204, v38
    v_fma_f32 v39, v135, -v204, v39
    v_mul_f32 v32, v32, v192
    v_mfma_f32_16x16x32_bf16 v[84:87], v[140:143], v[172:175], v[84:87]
    v_mul_f32 v33, v33, v192
    v_mul_f32 v34, v34, v192
    v_mul_f32 v35, v35, v192
    v_mfma_f32_16x16x32_bf16 v[88:91], v[144:147], v[172:175], v[88:91]
    v_mul_f32 v36, v36, v192
    v_mul_f32 v37, v37, v192
    v_mul_f32 v38, v38, v192
    v_mfma_f32_16x16x32_bf16 v[92:95], v[148:151], v[172:175], v[92:95]
    v_mul_f32 v39, v39, v192
    v_cvt_pk_bf16_f32 v32, v32, v33
    v_cvt_pk_bf16_f32 v33, v34, v35
    v_mfma_f32_16x16x32_bf16 v[0:3], v[152:155], v[136:139], v[0:3]
    v_cvt_pk_bf16_f32 v34, v36, v37
    v_cvt_pk_bf16_f32 v35, v38, v39
    buffer_store_dwordx4 v[32:35], v244, s[20:23], s32 offen offset:0 sc1
    v_mfma_f32_16x16x32_bf16 v[8:11], v[152:155], v[140:143], v[8:11]
    v_fma_f32 v40, v128, -v205, v40
    v_fma_f32 v41, v129, -v205, v41
    v_fma_f32 v42, v130, -v205, v42
    v_mfma_f32_16x16x32_bf16 v[16:19], v[152:155], v[144:147], v[16:19]
    v_fma_f32 v43, v131, -v205, v43
    v_fma_f32 v44, v132, -v205, v44
    v_fma_f32 v45, v133, -v205, v45
    v_mfma_f32_16x16x32_bf16 v[24:27], v[152:155], v[148:151], v[24:27]
    v_fma_f32 v46, v134, -v205, v46
    v_fma_f32 v47, v135, -v205, v47
    v_mul_f32 v40, v40, v193
    v_mfma_f32_16x16x32_bf16 v[4:7], v[156:159], v[136:139], v[4:7]
    v_mul_f32 v41, v41, v193
    v_mul_f32 v42, v42, v193
    v_mul_f32 v43, v43, v193
    v_mfma_f32_16x16x32_bf16 v[12:15], v[156:159], v[140:143], v[12:15]
    v_mul_f32 v44, v44, v193
    v_mul_f32 v45, v45, v193
    v_mul_f32 v46, v46, v193
    v_mfma_f32_16x16x32_bf16 v[20:23], v[156:159], v[144:147], v[20:23]
    v_mul_f32 v47, v47, v193
    v_cvt_pk_bf16_f32 v40, v40, v41
    v_cvt_pk_bf16_f32 v41, v42, v43
    v_mfma_f32_16x16x32_bf16 v[28:31], v[156:159], v[148:151], v[28:31]
    v_cvt_pk_bf16_f32 v42, v44, v45
    v_cvt_pk_bf16_f32 v43, v46, v47
    buffer_store_dwordx4 v[40:43], v244, s[20:23], s32 offen offset:128 sc1
    v_pk_fma_f32 v[48:49], v[128:129], v[206:207], v[48:49] op_sel_hi:[1,0,1] neg_lo:[0,1,0] neg_hi:[0,1,0]
    v_pk_fma_f32 v[50:51], v[130:131], v[206:207], v[50:51] op_sel_hi:[1,0,1] neg_lo:[0,1,0] neg_hi:[0,1,0]
    v_pk_fma_f32 v[52:53], v[132:133], v[206:207], v[52:53] op_sel_hi:[1,0,1] neg_lo:[0,1,0] neg_hi:[0,1,0]
    v_pk_fma_f32 v[54:55], v[134:135], v[206:207], v[54:55] op_sel_hi:[1,0,1] neg_lo:[0,1,0] neg_hi:[0,1,0]
    v_pk_mul_f32 v[48:49], v[48:49], v[194:195] op_sel_hi:[1,0]
    v_pk_mul_f32 v[50:51], v[50:51], v[194:195] op_sel_hi:[1,0]
    v_pk_mul_f32 v[52:53], v[52:53], v[194:195] op_sel_hi:[1,0]
    v_pk_mul_f32 v[54:55], v[54:55], v[194:195] op_sel_hi:[1,0]
    v_cvt_pk_bf16_f32 v48, v48, v49
    v_cvt_pk_bf16_f32 v49, v50, v51
    v_cvt_pk_bf16_f32 v50, v52, v53
    v_cvt_pk_bf16_f32 v51, v54, v55
    buffer_store_dwordx4 v[48:51], v244, s[20:23], s33 offen offset:0 sc1
    v_pk_fma_f32 v[56:57], v[128:129], v[206:207], v[56:57] op_sel:[0,1,0] op_sel_hi:[1,1,1] neg_lo:[0,1,0] neg_hi:[0,1,0]
    v_pk_fma_f32 v[58:59], v[130:131], v[206:207], v[58:59] op_sel:[0,1,0] op_sel_hi:[1,1,1] neg_lo:[0,1,0] neg_hi:[0,1,0]
    v_pk_fma_f32 v[60:61], v[132:133], v[206:207], v[60:61] op_sel:[0,1,0] op_sel_hi:[1,1,1] neg_lo:[0,1,0] neg_hi:[0,1,0]
    v_pk_fma_f32 v[62:63], v[134:135], v[206:207], v[62:63] op_sel:[0,1,0] op_sel_hi:[1,1,1] neg_lo:[0,1,0] neg_hi:[0,1,0]
    v_pk_mul_f32 v[56:57], v[56:57], v[194:195] op_sel:[0,1] op_sel_hi:[1,1]
    v_pk_mul_f32 v[58:59], v[58:59], v[194:195] op_sel:[0,1] op_sel_hi:[1,1]
    v_pk_mul_f32 v[60:61], v[60:61], v[194:195] op_sel:[0,1] op_sel_hi:[1,1]
    v_pk_mul_f32 v[62:63], v[62:63], v[194:195] op_sel:[0,1] op_sel_hi:[1,1]
    v_cvt_pk_bf16_f32 v56, v56, v57
    v_cvt_pk_bf16_f32 v57, v58, v59
    v_cvt_pk_bf16_f32 v58, v60, v61
    v_cvt_pk_bf16_f32 v59, v62, v63
    buffer_store_dwordx4 v[56:59], v244, s[20:23], s33 offen offset:128 sc1
    s_waitcnt lgkmcnt(0)
    v_pk_fma_f32 v[64:65], v[112:113], v[190:191], v[64:65] op_sel_hi:[1,0,1] neg_lo:[0,1,0] neg_hi:[0,1,0]
    v_pk_fma_f32 v[66:67], v[114:115], v[190:191], v[66:67] op_sel_hi:[1,0,1] neg_lo:[0,1,0] neg_hi:[0,1,0]
    v_pk_fma_f32 v[68:69], v[116:117], v[190:191], v[68:69] op_sel_hi:[1,0,1] neg_lo:[0,1,0] neg_hi:[0,1,0]
    v_pk_fma_f32 v[70:71], v[118:119], v[190:191], v[70:71] op_sel_hi:[1,0,1] neg_lo:[0,1,0] neg_hi:[0,1,0]
    v_pk_mul_f32 v[64:65], v[64:65], v[96:97]
    v_pk_mul_f32 v[66:67], v[66:67], v[98:99]
    v_pk_mul_f32 v[68:69], v[68:69], v[100:101]
    v_pk_mul_f32 v[70:71], v[70:71], v[102:103]
    v_cvt_pk_bf16_f32 v64, v64, v65
    v_cvt_pk_bf16_f32 v65, v66, v67
    v_cvt_pk_bf16_f32 v66, v68, v69
    v_cvt_pk_bf16_f32 v67, v70, v71
    buffer_store_dwordx4 v[64:67], v245, s[20:23], s32 offen offset:2048 sc1
    v_pk_fma_f32 v[80:81], v[112:113], v[190:191], v[80:81] op_sel:[0,1,0] op_sel_hi:[1,1,1] neg_lo:[0,1,0] neg_hi:[0,1,0]
    v_pk_fma_f32 v[82:83], v[114:115], v[190:191], v[82:83] op_sel:[0,1,0] op_sel_hi:[1,1,1] neg_lo:[0,1,0] neg_hi:[0,1,0]
    v_pk_fma_f32 v[84:85], v[116:117], v[190:191], v[84:85] op_sel:[0,1,0] op_sel_hi:[1,1,1] neg_lo:[0,1,0] neg_hi:[0,1,0]
    v_pk_fma_f32 v[86:87], v[118:119], v[190:191], v[86:87] op_sel:[0,1,0] op_sel_hi:[1,1,1] neg_lo:[0,1,0] neg_hi:[0,1,0]
    v_pk_mul_f32 v[80:81], v[80:81], v[96:97]
    v_pk_mul_f32 v[82:83], v[82:83], v[98:99]
    v_pk_mul_f32 v[84:85], v[84:85], v[100:101]
    v_pk_mul_f32 v[86:87], v[86:87], v[102:103]
    v_cvt_pk_bf16_f32 v80, v80, v81
    v_cvt_pk_bf16_f32 v81, v82, v83
    v_cvt_pk_bf16_f32 v82, v84, v85
    v_cvt_pk_bf16_f32 v83, v86, v87
    buffer_store_dwordx4 v[80:83], v245, s[20:23], s32 offen offset:2304 sc1
    v_pk_fma_f32 v[72:73], v[120:121], v[190:191], v[72:73] op_sel_hi:[1,0,1] neg_lo:[0,1,0] neg_hi:[0,1,0]
    v_pk_fma_f32 v[74:75], v[122:123], v[190:191], v[74:75] op_sel_hi:[1,0,1] neg_lo:[0,1,0] neg_hi:[0,1,0]
    v_pk_fma_f32 v[76:77], v[124:125], v[190:191], v[76:77] op_sel_hi:[1,0,1] neg_lo:[0,1,0] neg_hi:[0,1,0]
    v_pk_fma_f32 v[78:79], v[126:127], v[190:191], v[78:79] op_sel_hi:[1,0,1] neg_lo:[0,1,0] neg_hi:[0,1,0]
    v_pk_mul_f32 v[72:73], v[72:73], v[104:105]
    v_pk_mul_f32 v[74:75], v[74:75], v[106:107]
    v_pk_mul_f32 v[76:77], v[76:77], v[108:109]
    v_pk_mul_f32 v[78:79], v[78:79], v[110:111]
    v_cvt_pk_bf16_f32 v72, v72, v73
    v_cvt_pk_bf16_f32 v73, v74, v75
    v_cvt_pk_bf16_f32 v74, v76, v77
    v_cvt_pk_bf16_f32 v75, v78, v79
    buffer_store_dwordx4 v[72:75], v245, s[20:23], s33 offen offset:2048 sc1
    v_pk_fma_f32 v[88:89], v[120:121], v[190:191], v[88:89] op_sel:[0,1,0] op_sel_hi:[1,1,1] neg_lo:[0,1,0] neg_hi:[0,1,0]
    v_pk_fma_f32 v[90:91], v[122:123], v[190:191], v[90:91] op_sel:[0,1,0] op_sel_hi:[1,1,1] neg_lo:[0,1,0] neg_hi:[0,1,0]
    v_pk_fma_f32 v[92:93], v[124:125], v[190:191], v[92:93] op_sel:[0,1,0] op_sel_hi:[1,1,1] neg_lo:[0,1,0] neg_hi:[0,1,0]
    v_pk_fma_f32 v[94:95], v[126:127], v[190:191], v[94:95] op_sel:[0,1,0] op_sel_hi:[1,1,1] neg_lo:[0,1,0] neg_hi:[0,1,0]
    v_pk_mul_f32 v[88:89], v[88:89], v[104:105]
    v_pk_mul_f32 v[90:91], v[90:91], v[106:107]
    v_pk_mul_f32 v[92:93], v[92:93], v[108:109]
    v_pk_mul_f32 v[94:95], v[94:95], v[110:111]
    v_cvt_pk_bf16_f32 v88, v88, v89
    v_cvt_pk_bf16_f32 v89, v90, v91
    v_cvt_pk_bf16_f32 v90, v92, v93
    v_cvt_pk_bf16_f32 v91, v94, v95
    buffer_store_dwordx4 v[88:91], v245, s[20:23], s33 offen offset:2304 sc1
    ds_write_b128 v246, v[32:35] offset:0
    v_mul_f32 v192, 0x3e8293ee, v192
    ds_write_b128 v246, v[40:43] offset:128
    v_mul_f32 v193, 0x3e8293ee, v193
    ds_write_b128 v246, v[48:51] offset:4096
    v_mul_f32 v194, 0x3e8293ee, v194
    ds_write_b128 v246, v[56:59] offset:4224
    v_mul_f32 v195, 0x3e8293ee, v195
    v_pk_fma_f32 v[0:1], v[196:197], v[204:205], v[0:1] op_sel_hi:[1,0,1] neg_lo:[0,1,0] neg_hi:[0,1,0]
    v_pk_fma_f32 v[2:3], v[198:199], v[204:205], v[2:3] op_sel_hi:[1,0,1] neg_lo:[0,1,0] neg_hi:[0,1,0]
    v_pk_fma_f32 v[4:5], v[200:201], v[204:205], v[4:5] op_sel_hi:[1,0,1] neg_lo:[0,1,0] neg_hi:[0,1,0]
    v_pk_fma_f32 v[6:7], v[202:203], v[204:205], v[6:7] op_sel_hi:[1,0,1] neg_lo:[0,1,0] neg_hi:[0,1,0]
    v_pk_mul_f32 v[0:1], v[0:1], v[192:193] op_sel_hi:[1,0]
    v_pk_mul_f32 v[2:3], v[2:3], v[192:193] op_sel_hi:[1,0]
    v_pk_mul_f32 v[4:5], v[4:5], v[192:193] op_sel_hi:[1,0]
    v_pk_mul_f32 v[6:7], v[6:7], v[192:193] op_sel_hi:[1,0]
    v_cvt_pk_bf16_f32 v0, v0, v1
    v_cvt_pk_bf16_f32 v1, v2, v3
    v_cvt_pk_bf16_f32 v2, v4, v5
    v_cvt_pk_bf16_f32 v3, v6, v7
    ds_write_b128 v247, v[64:67] offset:2048
    ds_write_b128 v248, v[0:3] offset:0
    v_pk_fma_f32 v[8:9], v[196:197], v[204:205], v[8:9] op_sel:[0,1,0] op_sel_hi:[1,1,1] neg_lo:[0,1,0] neg_hi:[0,1,0]
    v_pk_fma_f32 v[10:11], v[198:199], v[204:205], v[10:11] op_sel:[0,1,0] op_sel_hi:[1,1,1] neg_lo:[0,1,0] neg_hi:[0,1,0]
    v_pk_fma_f32 v[12:13], v[200:201], v[204:205], v[12:13] op_sel:[0,1,0] op_sel_hi:[1,1,1] neg_lo:[0,1,0] neg_hi:[0,1,0]
    v_pk_fma_f32 v[14:15], v[202:203], v[204:205], v[14:15] op_sel:[0,1,0] op_sel_hi:[1,1,1] neg_lo:[0,1,0] neg_hi:[0,1,0]
    v_pk_mul_f32 v[8:9], v[8:9], v[192:193] op_sel:[0,1] op_sel_hi:[1,1]
    v_pk_mul_f32 v[10:11], v[10:11], v[192:193] op_sel:[0,1] op_sel_hi:[1,1]
    v_pk_mul_f32 v[12:13], v[12:13], v[192:193] op_sel:[0,1] op_sel_hi:[1,1]
    v_pk_mul_f32 v[14:15], v[14:15], v[192:193] op_sel:[0,1] op_sel_hi:[1,1]
    v_cvt_pk_bf16_f32 v8, v8, v9
    v_cvt_pk_bf16_f32 v9, v10, v11
    v_cvt_pk_bf16_f32 v10, v12, v13
    v_cvt_pk_bf16_f32 v11, v14, v15
    ds_write_b128 v247, v[80:83] offset:2304
    ds_write_b128 v248, v[8:11] offset:256
    v_pk_fma_f32 v[16:17], v[196:197], v[206:207], v[16:17] op_sel_hi:[1,0,1] neg_lo:[0,1,0] neg_hi:[0,1,0]
    v_pk_fma_f32 v[18:19], v[198:199], v[206:207], v[18:19] op_sel_hi:[1,0,1] neg_lo:[0,1,0] neg_hi:[0,1,0]
    v_pk_fma_f32 v[20:21], v[200:201], v[206:207], v[20:21] op_sel_hi:[1,0,1] neg_lo:[0,1,0] neg_hi:[0,1,0]
    v_pk_fma_f32 v[22:23], v[202:203], v[206:207], v[22:23] op_sel_hi:[1,0,1] neg_lo:[0,1,0] neg_hi:[0,1,0]
    v_pk_mul_f32 v[16:17], v[16:17], v[194:195] op_sel_hi:[1,0]
    v_pk_mul_f32 v[18:19], v[18:19], v[194:195] op_sel_hi:[1,0]
    v_pk_mul_f32 v[20:21], v[20:21], v[194:195] op_sel_hi:[1,0]
    v_pk_mul_f32 v[22:23], v[22:23], v[194:195] op_sel_hi:[1,0]
    v_cvt_pk_bf16_f32 v16, v16, v17
    v_cvt_pk_bf16_f32 v17, v18, v19
    v_cvt_pk_bf16_f32 v18, v20, v21
    v_cvt_pk_bf16_f32 v19, v22, v23
    ds_write_b128 v247, v[72:75] offset:6144
    ds_write_b128 v248, v[16:19] offset:2048
    v_pk_fma_f32 v[24:25], v[196:197], v[206:207], v[24:25] op_sel:[0,1,0] op_sel_hi:[1,1,1] neg_lo:[0,1,0] neg_hi:[0,1,0]
    v_pk_fma_f32 v[26:27], v[198:199], v[206:207], v[26:27] op_sel:[0,1,0] op_sel_hi:[1,1,1] neg_lo:[0,1,0] neg_hi:[0,1,0]
    v_pk_fma_f32 v[28:29], v[200:201], v[206:207], v[28:29] op_sel:[0,1,0] op_sel_hi:[1,1,1] neg_lo:[0,1,0] neg_hi:[0,1,0]
    v_pk_fma_f32 v[30:31], v[202:203], v[206:207], v[30:31] op_sel:[0,1,0] op_sel_hi:[1,1,1] neg_lo:[0,1,0] neg_hi:[0,1,0]
    v_pk_mul_f32 v[24:25], v[24:25], v[194:195] op_sel:[0,1] op_sel_hi:[1,1]
    v_pk_mul_f32 v[26:27], v[26:27], v[194:195] op_sel:[0,1] op_sel_hi:[1,1]
    v_pk_mul_f32 v[28:29], v[28:29], v[194:195] op_sel:[0,1] op_sel_hi:[1,1]
    v_pk_mul_f32 v[30:31], v[30:31], v[194:195] op_sel:[0,1] op_sel_hi:[1,1]
    v_cvt_pk_bf16_f32 v24, v24, v25
    v_cvt_pk_bf16_f32 v25, v26, v27
    v_cvt_pk_bf16_f32 v26, v28, v29
    v_cvt_pk_bf16_f32 v27, v30, v31
    ds_write_b128 v247, v[88:91] offset:6400
    ds_write_b128 v248, v[24:27] offset:2304
    s_lshl_b32 s30, s25, 8
    s_lshl_b32 s31, s24, 4
    s_add_u32 s30, s30, s31
    s_lshl_b32 s31, s34, 3
    s_add_u32 s30, s30, s31
    s_lshl_b32 s31, s35, 2
    s_add_u32 s30, s30, s31
    s_add_u32 s30, s30, s26
    s_add_u32 s30, s30, 0xdd0000
    v_mov_b32 v154, s88
    s_mov_b64 exec, 1
    s_waitcnt vmcnt(0)
    buffer_store_dword v154, v253, s[20:23], s30 offen sc1
    s_mov_b64 exec, -1
    v_readfirstlane_b32 s73, v250
    v_readfirstlane_b32 s77, v251
    s_lshr_b32 s39, s73, 5
    s_lshl_b32 s34, s24, 2
    s_sub_u32 s39, s39, s34
    s_add_u32 s39, s39, 8
    s_cmp_lt_u32 s39, 12
    s_cselect_b32 s100, 1, 0
    s_cmp_lg_u32 s26, 0
    s_cbranch_scc1 sk_2
    v_permlane32_swap_b32 v208, v210
    v_permlane32_swap_b32 v209, v211
    v_permlane32_swap_b32 v212, v214
    v_permlane32_swap_b32 v213, v215
    v_permlane32_swap_b32 v216, v218
    v_permlane32_swap_b32 v217, v219
    v_permlane32_swap_b32 v220, v222
    v_permlane32_swap_b32 v221, v223
sk_2:
    v_mov_b32 v20, 0xffff
    v_mov_b32 v21, 0xffff0000
    v_cndmask_b32 v22, 0, v20, s[40:41]
    v_cndmask_b32 v23, 0, v21, s[42:43]
    v_or_b32 v12, v22, v23
    v_cndmask_b32 v22, 0, v20, s[44:45]
    v_cndmask_b32 v23, 0, v21, s[46:47]
    v_or_b32 v13, v22, v23
    v_cndmask_b32 v22, 0, v20, s[48:49]
    v_cndmask_b32 v23, 0, v21, s[50:51]
    v_or_b32 v14, v22, v23
    v_cndmask_b32 v22, 0, v20, s[52:53]
    v_cndmask_b32 v23, 0, v21, s[54:55]
    v_or_b32 v15, v22, v23
    v_cndmask_b32 v22, 0, v20, s[56:57]
    v_cndmask_b32 v23, 0, v21, s[58:59]
    v_or_b32 v16, v22, v23
    v_cndmask_b32 v22, 0, v20, s[60:61]
    v_cndmask_b32 v23, 0, v21, s[62:63]
    v_or_b32 v17, v22, v23
    v_cndmask_b32 v22, 0, v20, s[64:65]
    v_cndmask_b32 v23, 0, v21, s[66:67]
    v_or_b32 v18, v22, v23
    v_cndmask_b32 v22, 0, v20, s[68:69]
    v_cndmask_b32 v23, 0, v21, s[70:71]
    v_or_b32 v19, v22, v23
    s_lshl_b32 s34, s28, 12
    s_add_u32 s34, s34, 65536
    v_add_u32 v20, s34, v253
    s_lshl_b32 s34, s3, 11
    s_add_u32 s34, s34, 49152
    v_add_u32 v3, s34, v253
    v_mov_b32 v24, 0
    v_mov_b32 v25, 0
    v_mov_b32 v26, 0
    v_mov_b32 v27, 0
    v_mov_b32 v28, 0
    v_mov_b32 v29, 0
    v_mov_b32 v30, 0
    v_mov_b32 v31, 0
    v_mov_b32 v32, 0
    v_mov_b32 v33, 0
    v_mov_b32 v34, 0
    v_mov_b32 v35, 0
    v_mov_b32 v36, 0
    v_mov_b32 v37, 0
    v_mov_b32 v38, 0
    v_mov_b32 v39, 0
    s_waitcnt lgkmcnt(0)
    s_barrier
    s_cmp_eq_u32 s100, 0
    s_cbranch_scc1 sk_3
    s_barrier
    s_lshr_b32 s34, s73, 5
    s_cmp_lg_u32 s34, s99
    s_cbranch_scc1 sk_4
    s_and_b32 s32, s73, 31
    v_and_b32 v0, 31, v252
    v_cmp_eq_u32 vcc, s32, v0
    v_lshrrev_b32 v0, 5, v252
    v_lshlrev_b32 v0, 4, v0
    s_lshl_b32 s34, s98, 7
    s_add_u32 s34, s34, 0xdc4000
    s_mov_b64 exec, vcc
    buffer_load_dwordx4 v[208:211], v0, s[20:23], s34 offen offset:0 sc1
    buffer_load_dwordx4 v[212:215], v0, s[20:23], s34 offen offset:32 sc1
    buffer_load_dwordx4 v[216:219], v0, s[20:23], s34 offen offset:64 sc1
    buffer_load_dwordx4 v[220:223], v0, s[20:23], s34 offen offset:96 sc1
    v_mov_b32 v240, 1.0
    v_mov_b32 v241, 0
    s_mov_b64 exec, -1
sk_4:
sk_3:
    ds_read_b128 v[4:7], v3
    ds_read_b128 v[8:11], v3 offset:1024
    ds_read_b128 v[104:107], v20 offset:32768
    ds_read_b128 v[108:111], v20 offset:33792
    ds_read_b128 v[112:115], v20 offset:28672
    ds_read_b128 v[116:119], v20 offset:29696
    s_waitcnt lgkmcnt(2)
    v_mfma_f32_32x32x16_bf16 v[40:55], v[104:107], v[4:7], 0
    v_mfma_f32_32x32x16_bf16 v[40:55], v[108:111], v[8:11], v[40:55]
    ds_read_b128 v[104:107], v20 offset:24576
    ds_read_b128 v[108:111], v20 offset:25600
    s_cmp_eq_u32 s99, 0
    s_cbranch_scc0 ng_5
    v_mov_b32 v24, 0xf149f2ca
    v_mov_b32 v25, 0xf149f2ca
    v_mov_b32 v26, 0xf149f2ca
    v_mov_b32 v27, 0xf149f2ca
    v_mov_b32 v28, 0xf149f2ca
    v_mov_b32 v29, 0xf149f2ca
    v_mov_b32 v30, 0xf149f2ca
    v_mov_b32 v31, 0xf149f2ca
    v_mov_b32 v32, 0xf149f2ca
    v_mov_b32 v33, 0xf149f2ca
    v_mov_b32 v34, 0xf149f2ca
    v_mov_b32 v35, 0xf149f2ca
    v_mov_b32 v36, 0xf149f2ca
    v_mov_b32 v37, 0xf149f2ca
    v_mov_b32 v38, 0xf149f2ca
    v_mov_b32 v39, 0xf149f2ca
ng_5:
    s_waitcnt lgkmcnt(2)
    s_nop 0
    v_mfma_f32_32x32x16_bf16 v[72:87], v[112:115], v[4:7], v[24:39]
    v_mfma_f32_32x32x16_bf16 v[72:87], v[116:119], v[8:11], v[72:87]
    ds_read_b128 v[112:115], v20 offset:20480
    ds_read_b128 v[116:119], v20 offset:21504
    s_cmp_eq_u32 s99, 1
    s_cbranch_scc0 ng_6
    s_nop 1
    v_mov_b32 v24, 0xf149f2ca
    v_mov_b32 v25, 0xf149f2ca
    v_mov_b32 v26, 0xf149f2ca
    v_mov_b32 v27, 0xf149f2ca
    v_mov_b32 v28, 0xf149f2ca
    v_mov_b32 v29, 0xf149f2ca
    v_mov_b32 v30, 0xf149f2ca
    v_mov_b32 v31, 0xf149f2ca
    v_mov_b32 v32, 0xf149f2ca
    v_mov_b32 v33, 0xf149f2ca
    v_mov_b32 v34, 0xf149f2ca
    v_mov_b32 v35, 0xf149f2ca
    v_mov_b32 v36, 0xf149f2ca
    v_mov_b32 v37, 0xf149f2ca
    v_mov_b32 v38, 0xf149f2ca
    v_mov_b32 v39, 0xf149f2ca
ng_6:
    s_waitcnt lgkmcnt(2)
    s_nop 0
    v_mfma_f32_32x32x16_bf16 v[56:71], v[104:107], v[4:7], v[24:39]
    v_mfma_f32_32x32x16_bf16 v[56:71], v[108:111], v[8:11], v[56:71]
    s_nop 3
    v_max_f32 v21, v72, v73
    v_max3_f32 v21, v21, v74, v75
    v_max3_f32 v21, v21, v76, v77
    v_max3_f32 v21, v21, v78, v79
    v_max3_f32 v21, v21, v80, v81
    v_max3_f32 v21, v21, v82, v83
    v_max3_f32 v21, v21, v84, v85
    v_max3_f32 v21, v21, v86, v87
    ds_read_b128 v[104:107], v20 offset:16384
    ds_read_b128 v[108:111], v20 offset:17408
    s_cmp_eq_u32 s99, 2
    s_cbranch_scc0 ng_7
    v_mov_b32 v24, 0xf149f2ca
    v_mov_b32 v25, 0xf149f2ca
    v_mov_b32 v26, 0xf149f2ca
    v_mov_b32 v27, 0xf149f2ca
    v_mov_b32 v28, 0xf149f2ca
    v_mov_b32 v29, 0xf149f2ca
    v_mov_b32 v30, 0xf149f2ca
    v_mov_b32 v31, 0xf149f2ca
    v_mov_b32 v32, 0xf149f2ca
    v_mov_b32 v33, 0xf149f2ca
    v_mov_b32 v34, 0xf149f2ca
    v_mov_b32 v35, 0xf149f2ca
    v_mov_b32 v36, 0xf149f2ca
    v_mov_b32 v37, 0xf149f2ca
    v_mov_b32 v38, 0xf149f2ca
    v_mov_b32 v39, 0xf149f2ca
ng_7:
    s_waitcnt lgkmcnt(2)
    s_nop 0
    v_mfma_f32_32x32x16_bf16 v[72:87], v[112:115], v[4:7], v[24:39]
    v_mfma_f32_32x32x16_bf16 v[72:87], v[116:119], v[8:11], v[72:87]
    v_max3_f32 v21, v21, v56, v57
    v_max3_f32 v21, v21, v58, v59
    v_max3_f32 v21, v21, v60, v61
    v_max3_f32 v21, v21, v62, v63
    v_max3_f32 v21, v21, v64, v65
    v_max3_f32 v21, v21, v66, v67
    v_max3_f32 v21, v21, v68, v69
    v_max3_f32 v21, v21, v70, v71
    ds_read_b128 v[112:115], v20 offset:12288
    ds_read_b128 v[116:119], v20 offset:13312
    s_cmp_eq_u32 s99, 3
    s_cbranch_scc0 ng_8
    v_mov_b32 v24, 0xf149f2ca
    v_mov_b32 v25, 0xf149f2ca
    v_mov_b32 v26, 0xf149f2ca
    v_mov_b32 v27, 0xf149f2ca
    v_mov_b32 v28, 0xf149f2ca
    v_mov_b32 v29, 0xf149f2ca
    v_mov_b32 v30, 0xf149f2ca
    v_mov_b32 v31, 0xf149f2ca
    v_mov_b32 v32, 0xf149f2ca
    v_mov_b32 v33, 0xf149f2ca
    v_mov_b32 v34, 0xf149f2ca
    v_mov_b32 v35, 0xf149f2ca
    v_mov_b32 v36, 0xf149f2ca
    v_mov_b32 v37, 0xf149f2ca
    v_mov_b32 v38, 0xf149f2ca
    v_mov_b32 v39, 0xf149f2ca
ng_8:
    s_waitcnt lgkmcnt(2)
    s_nop 0
    v_mfma_f32_32x32x16_bf16 v[56:71], v[104:107], v[4:7], v[24:39]
    v_mfma_f32_32x32x16_bf16 v[56:71], v[108:111], v[8:11], v[56:71]
    v_max3_f32 v21, v21, v72, v73
    v_max3_f32 v21, v21, v74, v75
    v_max3_f32 v21, v21, v76, v77
    v_max3_f32 v21, v21, v78, v79
    v_max3_f32 v21, v21, v80, v81
    v_max3_f32 v21, v21, v82, v83
    v_max3_f32 v21, v21, v84, v85
    v_max3_f32 v21, v21, v86, v87
    ds_read_b128 v[104:107], v20 offset:8192
    ds_read_b128 v[108:111], v20 offset:9216
    s_cmp_eq_u32 s99, 4
    s_cbranch_scc0 ng_9
    v_mov_b32 v24, 0xf149f2ca
    v_mov_b32 v25, 0xf149f2ca
    v_mov_b32 v26, 0xf149f2ca
    v_mov_b32 v27, 0xf149f2ca
    v_mov_b32 v28, 0xf149f2ca
    v_mov_b32 v29, 0xf149f2ca
    v_mov_b32 v30, 0xf149f2ca
    v_mov_b32 v31, 0xf149f2ca
    v_mov_b32 v32, 0xf149f2ca
    v_mov_b32 v33, 0xf149f2ca
    v_mov_b32 v34, 0xf149f2ca
    v_mov_b32 v35, 0xf149f2ca
    v_mov_b32 v36, 0xf149f2ca
    v_mov_b32 v37, 0xf149f2ca
    v_mov_b32 v38, 0xf149f2ca
    v_mov_b32 v39, 0xf149f2ca
ng_9:
    s_waitcnt lgkmcnt(2)
    s_nop 0
    v_mfma_f32_32x32x16_bf16 v[72:87], v[112:115], v[4:7], v[24:39]
    v_mfma_f32_32x32x16_bf16 v[72:87], v[116:119], v[8:11], v[72:87]
    v_max3_f32 v21, v21, v56, v57
    v_max3_f32 v21, v21, v58, v59
    v_max3_f32 v21, v21, v60, v61
    v_max3_f32 v21, v21, v62, v63
    v_max3_f32 v21, v21, v64, v65
    v_max3_f32 v21, v21, v66, v67
    v_max3_f32 v21, v21, v68, v69
    v_max3_f32 v21, v21, v70, v71
    s_barrier
    s_add_u32 s96, s25, 0
    s_and_b32 s96, s96, 15
    s_lshl_b32 s96, s96, 17
    s_add_u32 m0, s101, 0
    s_nop 0
    buffer_load_dwordx4 v243, s[8:11], s96 offen lds
    ds_read_b128 v[112:115], v20 offset:4096
    ds_read_b128 v[116:119], v20 offset:5120
    s_cmp_eq_u32 s99, 5
    s_cbranch_scc0 ng_10
    v_mov_b32 v24, 0xf149f2ca
    v_mov_b32 v25, 0xf149f2ca
    v_mov_b32 v26, 0xf149f2ca
    v_mov_b32 v27, 0xf149f2ca
    v_mov_b32 v28, 0xf149f2ca
    v_mov_b32 v29, 0xf149f2ca
    v_mov_b32 v30, 0xf149f2ca
    v_mov_b32 v31, 0xf149f2ca
    v_mov_b32 v32, 0xf149f2ca
    v_mov_b32 v33, 0xf149f2ca
    v_mov_b32 v34, 0xf149f2ca
    v_mov_b32 v35, 0xf149f2ca
    v_mov_b32 v36, 0xf149f2ca
    v_mov_b32 v37, 0xf149f2ca
    v_mov_b32 v38, 0xf149f2ca
    v_mov_b32 v39, 0xf149f2ca
ng_10:
    s_waitcnt lgkmcnt(2)
    s_nop 0
    v_mfma_f32_32x32x16_bf16 v[56:71], v[104:107], v[4:7], v[24:39]
    v_mfma_f32_32x32x16_bf16 v[56:71], v[108:111], v[8:11], v[56:71]
    v_max3_f32 v21, v21, v72, v73
    v_max3_f32 v21, v21, v74, v75
    v_max3_f32 v21, v21, v76, v77
    v_max3_f32 v21, v21, v78, v79
    v_max3_f32 v21, v21, v80, v81
    v_max3_f32 v21, v21, v82, v83
    v_max3_f32 v21, v21, v84, v85
    v_max3_f32 v21, v21, v86, v87
    s_add_u32 s96, s25, 12
    s_and_b32 s96, s96, 15
    s_lshl_b32 s96, s96, 17
    s_add_u32 m0, s101, 49152
    s_nop 0
    buffer_load_dwordx4 v243, s[8:11], s96 offen lds
    ds_read_b128 v[104:107], v20 offset:0
    ds_read_b128 v[108:111], v20 offset:1024
    s_cmp_eq_u32 s99, 6
    s_cbranch_scc0 ng_11
    v_mov_b32 v24, 0xf149f2ca
    v_mov_b32 v25, 0xf149f2ca
    v_mov_b32 v26, 0xf149f2ca
    v_mov_b32 v27, 0xf149f2ca
    v_mov_b32 v28, 0xf149f2ca
    v_mov_b32 v29, 0xf149f2ca
    v_mov_b32 v30, 0xf149f2ca
    v_mov_b32 v31, 0xf149f2ca
    v_mov_b32 v32, 0xf149f2ca
    v_mov_b32 v33, 0xf149f2ca
    v_mov_b32 v34, 0xf149f2ca
    v_mov_b32 v35, 0xf149f2ca
    v_mov_b32 v36, 0xf149f2ca
    v_mov_b32 v37, 0xf149f2ca
    v_mov_b32 v38, 0xf149f2ca
    v_mov_b32 v39, 0xf149f2ca
ng_11:
    s_waitcnt lgkmcnt(2)
    s_nop 0
    v_mfma_f32_32x32x16_bf16 v[72:87], v[112:115], v[4:7], v[24:39]
    v_mfma_f32_32x32x16_bf16 v[72:87], v[116:119], v[8:11], v[72:87]
    v_max3_f32 v21, v21, v56, v57
    v_max3_f32 v21, v21, v58, v59
    v_max3_f32 v21, v21, v60, v61
    v_max3_f32 v21, v21, v62, v63
    v_max3_f32 v21, v21, v64, v65
    v_max3_f32 v21, v21, v66, v67
    v_max3_f32 v21, v21, v68, v69
    v_max3_f32 v21, v21, v70, v71
    s_add_u32 s96, s25, 13
    s_and_b32 s96, s96, 15
    s_lshl_b32 s96, s96, 17
    s_add_u32 m0, s101, 53248
    s_nop 0
    buffer_load_dwordx4 v243, s[8:11], s96 offen lds
    s_cmp_eq_u32 s99, 7
    s_cbranch_scc0 ng_12
    v_mov_b32 v24, 0xf149f2ca
    v_mov_b32 v25, 0xf149f2ca
    v_mov_b32 v26, 0xf149f2ca
    v_mov_b32 v27, 0xf149f2ca
    v_mov_b32 v28, 0xf149f2ca
    v_mov_b32 v29, 0xf149f2ca
    v_mov_b32 v30, 0xf149f2ca
    v_mov_b32 v31, 0xf149f2ca
    v_mov_b32 v32, 0xf149f2ca
    v_mov_b32 v33, 0xf149f2ca
    v_mov_b32 v34, 0xf149f2ca
    v_mov_b32 v35, 0xf149f2ca
    v_mov_b32 v36, 0xf149f2ca
    v_mov_b32 v37, 0xf149f2ca
    v_mov_b32 v38, 0xf149f2ca
    v_mov_b32 v39, 0xf149f2ca
ng_12:
    s_waitcnt lgkmcnt(0)
    s_nop 0
    v_mfma_f32_32x32x16_bf16 v[56:71], v[104:107], v[4:7], v[24:39]
    v_mfma_f32_32x32x16_bf16 v[56:71], v[108:111], v[8:11], v[56:71]
    v_max3_f32 v21, v21, v72, v73
    v_max3_f32 v21, v21, v74, v75
    v_max3_f32 v21, v21, v76, v77
    v_max3_f32 v21, v21, v78, v79
    v_max3_f32 v21, v21, v80, v81
    v_max3_f32 v21, v21, v82, v83
    v_max3_f32 v21, v21, v84, v85
    v_max3_f32 v21, v21, v86, v87
    s_add_u32 s96, s25, 14
    s_and_b32 s96, s96, 15
    s_lshl_b32 s96, s96, 17
    s_add_u32 m0, s101, 57344
    s_nop 0
    buffer_load_dwordx4 v243, s[8:11], s96 offen lds
    ds_read_b128 v[112:115], v20 offset:28672
    ds_read_b128 v[116:119], v20 offset:29696
    ds_read_b128 v[120:123], v20 offset:34816
    ds_read_b128 v[124:127], v20 offset:35840
    ds_read_b128 v[128:131], v20 offset:2048
    ds_read_b128 v[132:135], v20 offset:3072
    v_cndmask_b32 v40, v56, v40, s[40:41]
    v_cndmask_b32 v41, v57, v41, s[42:43]
    v_cndmask_b32 v42, v58, v42, s[44:45]
    v_cndmask_b32 v43, v59, v43, s[46:47]
    v_cndmask_b32 v44, v60, v44, s[48:49]
    v_cndmask_b32 v45, v61, v45, s[50:51]
    v_cndmask_b32 v46, v62, v46, s[52:53]
    v_cndmask_b32 v47, v63, v47, s[54:55]
    v_cndmask_b32 v48, v64, v48, s[56:57]
    v_cndmask_b32 v49, v65, v49, s[58:59]
    v_cndmask_b32 v50, v66, v50, s[60:61]
    v_cndmask_b32 v51, v67, v51, s[62:63]
    v_cndmask_b32 v52, v68, v52, s[64:65]
    v_cndmask_b32 v53, v69, v53, s[66:67]
    v_cndmask_b32 v54, v70, v54, s[68:69]
    v_cndmask_b32 v55, v71, v55, s[70:71]
    v_max3_f32 v21, v21, v40, v41
    v_max3_f32 v21, v21, v42, v43
    v_max3_f32 v21, v21, v44, v45
    v_max3_f32 v21, v21, v46, v47
    v_max3_f32 v21, v21, v48, v49
    v_max3_f32 v21, v21, v50, v51
    v_max3_f32 v21, v21, v52, v53
    v_max3_f32 v21, v21, v54, v55
    v_mov_b32 v152, v21
    s_nop 1
    v_permlane32_swap_b32 v21, v152
    v_max_f32 v21, v21, v152
    v_sub_f32 v24, 0, v21
    v_sub_f32 v25, 0, v21
    v_sub_f32 v26, 0, v21
    v_sub_f32 v27, 0, v21
    v_sub_f32 v28, 0, v21
    v_sub_f32 v29, 0, v21
    v_sub_f32 v30, 0, v21
    v_sub_f32 v31, 0, v21
    v_sub_f32 v32, 0, v21
    v_sub_f32 v33, 0, v21
    v_sub_f32 v34, 0, v21
    v_sub_f32 v35, 0, v21
    v_sub_f32 v36, 0, v21
    v_sub_f32 v37, 0, v21
    v_sub_f32 v38, 0, v21
    v_sub_f32 v39, 0, v21
    s_cmp_eq_u32 s99, 0
    s_cbranch_scc0 ng_13
    v_mov_b32 v24, 0xf149f2ca
    v_mov_b32 v25, 0xf149f2ca
    v_mov_b32 v26, 0xf149f2ca
    v_mov_b32 v27, 0xf149f2ca
    v_mov_b32 v28, 0xf149f2ca
    v_mov_b32 v29, 0xf149f2ca
    v_mov_b32 v30, 0xf149f2ca
    v_mov_b32 v31, 0xf149f2ca
    v_mov_b32 v32, 0xf149f2ca
    v_mov_b32 v33, 0xf149f2ca
    v_mov_b32 v34, 0xf149f2ca
    v_mov_b32 v35, 0xf149f2ca
    v_mov_b32 v36, 0xf149f2ca
    v_mov_b32 v37, 0xf149f2ca
    v_mov_b32 v38, 0xf149f2ca
    v_mov_b32 v39, 0xf149f2ca
ng_13:
    s_waitcnt lgkmcnt(4)
    s_nop 0
    v_mfma_f32_32x32x16_bf16 v[72:87], v[112:115], v[4:7], v[24:39]
    v_mfma_f32_32x32x16_bf16 v[72:87], v[116:119], v[8:11], v[72:87]
    ds_read_b128 v[104:107], v20 offset:24576
    ds_read_b128 v[108:111], v20 offset:25600
    v_sub_f32 v40, v40, v21
    v_sub_f32 v41, v41, v21
    v_sub_f32 v42, v42, v21
    v_sub_f32 v43, v43, v21
    v_sub_f32 v44, v44, v21
    v_sub_f32 v45, v45, v21
    v_sub_f32 v46, v46, v21
    v_sub_f32 v47, v47, v21
    v_sub_f32 v48, v48, v21
    v_sub_f32 v49, v49, v21
    v_sub_f32 v50, v50, v21
    v_sub_f32 v51, v51, v21
    v_sub_f32 v52, v52, v21
    v_sub_f32 v53, v53, v21
    v_sub_f32 v54, v54, v21
    v_sub_f32 v55, v55, v21
    v_exp_f32 v40, v40
    v_exp_f32 v41, v41
    v_exp_f32 v42, v42
    v_exp_f32 v43, v43
    v_exp_f32 v44, v44
    v_exp_f32 v45, v45
    v_exp_f32 v46, v46
    v_exp_f32 v47, v47
    v_exp_f32 v48, v48
    v_exp_f32 v49, v49
    v_exp_f32 v50, v50
    v_exp_f32 v51, v51
    v_exp_f32 v52, v52
    v_exp_f32 v53, v53
    v_exp_f32 v54, v54
    v_exp_f32 v55, v55
    v_add_f32 v22, v40, v41
    v_add_f32 v23, v42, v43
    v_add_f32 v22, v22, v44
    v_add_f32 v23, v23, v45
    v_add_f32 v22, v22, v46
    v_add_f32 v23, v23, v47
    v_add_f32 v22, v22, v48
    v_add_f32 v23, v23, v49
    v_add_f32 v22, v22, v50
    v_add_f32 v23, v23, v51
    v_add_f32 v22, v22, v52
    v_add_f32 v23, v23, v53
    v_add_f32 v22, v22, v54
    v_add_f32 v23, v23, v55
    v_cvt_pk_bf16_f32 v144, v40, v41
    v_cvt_pk_bf16_f32 v145, v42, v43
    v_cvt_pk_bf16_f32 v146, v44, v45
    v_cvt_pk_bf16_f32 v147, v46, v47
    v_cvt_pk_bf16_f32 v148, v48, v49
    v_cvt_pk_bf16_f32 v149, v50, v51
    v_cvt_pk_bf16_f32 v150, v52, v53
    v_cvt_pk_bf16_f32 v151, v54, v55
    v_and_b32 v136, v144, v12
    v_and_b32 v137, v145, v13
    v_and_b32 v138, v146, v14
    v_and_b32 v139, v147, v15
    v_and_b32 v140, v148, v16
    v_and_b32 v141, v149, v17
    v_and_b32 v142, v150, v18
    v_and_b32 v143, v151, v19
    v_xor_b32 v144, v144, v136
    v_xor_b32 v145, v145, v137
    v_xor_b32 v146, v146, v138
    v_xor_b32 v147, v147, v139
    v_xor_b32 v148, v148, v140
    v_xor_b32 v149, v149, v141
    v_xor_b32 v150, v150, v142
    v_xor_b32 v151, v151, v143
    s_waitcnt lgkmcnt(2)
    v_mfma_f32_32x32x16_bf16 v[88:103], v[120:123], v[136:139], 0
    v_mfma_f32_32x32x16_bf16 v[88:103], v[124:127], v[140:143], v[88:103]
    v_mfma_f32_32x32x16_bf16 v[88:103], v[128:131], v[144:147], v[88:103]
    v_mfma_f32_32x32x16_bf16 v[88:103], v[132:135], v[148:151], v[88:103]
    s_add_u32 s96, s25, 15
    s_and_b32 s96, s96, 15
    s_lshl_b32 s96, s96, 17
    s_add_u32 m0, s101, 61440
    s_nop 0
    buffer_load_dwordx4 v243, s[8:11], s96 offen lds
    ds_read_b128 v[128:131], v20 offset:30720
    ds_read_b128 v[132:135], v20 offset:31744
    s_cmp_eq_u32 s99, 1
    s_cbranch_scc0 ng_14
    v_mov_b32 v24, 0xf149f2ca
    v_mov_b32 v25, 0xf149f2ca
    v_mov_b32 v26, 0xf149f2ca
    v_mov_b32 v27, 0xf149f2ca
    v_mov_b32 v28, 0xf149f2ca
    v_mov_b32 v29, 0xf149f2ca
    v_mov_b32 v30, 0xf149f2ca
    v_mov_b32 v31, 0xf149f2ca
    v_mov_b32 v32, 0xf149f2ca
    v_mov_b32 v33, 0xf149f2ca
    v_mov_b32 v34, 0xf149f2ca
    v_mov_b32 v35, 0xf149f2ca
    v_mov_b32 v36, 0xf149f2ca
    v_mov_b32 v37, 0xf149f2ca
    v_mov_b32 v38, 0xf149f2ca
    v_mov_b32 v39, 0xf149f2ca
ng_14:
    s_waitcnt lgkmcnt(2)
    s_nop 0
    v_mfma_f32_32x32x16_bf16 v[56:71], v[104:107], v[4:7], v[24:39]
    v_mfma_f32_32x32x16_bf16 v[56:71], v[108:111], v[8:11], v[56:71]
    ds_read_b128 v[112:115], v20 offset:20480
    ds_read_b128 v[116:119], v20 offset:21504
    v_exp_f32 v72, v72
    v_exp_f32 v73, v73
    v_exp_f32 v74, v74
    v_exp_f32 v75, v75
    v_exp_f32 v76, v76
    v_exp_f32 v77, v77
    v_exp_f32 v78, v78
    v_exp_f32 v79, v79
    v_exp_f32 v80, v80
    v_exp_f32 v81, v81
    v_exp_f32 v82, v82
    v_exp_f32 v83, v83
    v_exp_f32 v84, v84
    v_exp_f32 v85, v85
    v_exp_f32 v86, v86
    v_exp_f32 v87, v87
    v_add_f32 v22, v22, v72
    v_add_f32 v23, v23, v73
    v_add_f32 v22, v22, v74
    v_add_f32 v23, v23, v75
    v_add_f32 v22, v22, v76
    v_add_f32 v23, v23, v77
    v_add_f32 v22, v22, v78
    v_add_f32 v23, v23, v79
    v_add_f32 v22, v22, v80
    v_add_f32 v23, v23, v81
    v_add_f32 v22, v22, v82
    v_add_f32 v23, v23, v83
    v_add_f32 v22, v22, v84
    v_add_f32 v23, v23, v85
    v_add_f32 v22, v22, v86
    v_add_f32 v23, v23, v87
    v_cvt_pk_bf16_f32 v144, v72, v73
    v_cvt_pk_bf16_f32 v145, v74, v75
    v_cvt_pk_bf16_f32 v146, v76, v77
    v_cvt_pk_bf16_f32 v147, v78, v79
    v_cvt_pk_bf16_f32 v148, v80, v81
    v_cvt_pk_bf16_f32 v149, v82, v83
    v_cvt_pk_bf16_f32 v150, v84, v85
    v_cvt_pk_bf16_f32 v151, v86, v87
    s_waitcnt lgkmcnt(2)
    v_mfma_f32_32x32x16_bf16 v[88:103], v[128:131], v[144:147], v[88:103]
    v_mfma_f32_32x32x16_bf16 v[88:103], v[132:135], v[148:151], v[88:103]
    ds_read_b128 v[120:123], v20 offset:26624
    ds_read_b128 v[124:127], v20 offset:27648
    s_cmp_eq_u32 s99, 2
    s_cbranch_scc0 ng_15
    v_mov_b32 v24, 0xf149f2ca
    v_mov_b32 v25, 0xf149f2ca
    v_mov_b32 v26, 0xf149f2ca
    v_mov_b32 v27, 0xf149f2ca
    v_mov_b32 v28, 0xf149f2ca
    v_mov_b32 v29, 0xf149f2ca
    v_mov_b32 v30, 0xf149f2ca
    v_mov_b32 v31, 0xf149f2ca
    v_mov_b32 v32, 0xf149f2ca
    v_mov_b32 v33, 0xf149f2ca
    v_mov_b32 v34, 0xf149f2ca
    v_mov_b32 v35, 0xf149f2ca
    v_mov_b32 v36, 0xf149f2ca
    v_mov_b32 v37, 0xf149f2ca
    v_mov_b32 v38, 0xf149f2ca
    v_mov_b32 v39, 0xf149f2ca
ng_15:
    s_waitcnt lgkmcnt(2)
    s_nop 0
    v_mfma_f32_32x32x16_bf16 v[72:87], v[112:115], v[4:7], v[24:39]
    v_mfma_f32_32x32x16_bf16 v[72:87], v[116:119], v[8:11], v[72:87]
    ds_read_b128 v[104:107], v20 offset:16384
    ds_read_b128 v[108:111], v20 offset:17408
    v_exp_f32 v56, v56
    v_exp_f32 v57, v57
    v_exp_f32 v58, v58
    v_exp_f32 v59, v59
    v_exp_f32 v60, v60
    v_exp_f32 v61, v61
    v_exp_f32 v62, v62
    v_exp_f32 v63, v63
    v_exp_f32 v64, v64
    v_exp_f32 v65, v65
    v_exp_f32 v66, v66
    v_exp_f32 v67, v67
    v_exp_f32 v68, v68
    v_exp_f32 v69, v69
    v_exp_f32 v70, v70
    v_exp_f32 v71, v71
    v_add_f32 v22, v22, v56
    v_add_f32 v23, v23, v57
    v_add_f32 v22, v22, v58
    v_add_f32 v23, v23, v59
    v_add_f32 v22, v22, v60
    v_add_f32 v23, v23, v61
    v_add_f32 v22, v22, v62
    v_add_f32 v23, v23, v63
    v_add_f32 v22, v22, v64
    v_add_f32 v23, v23, v65
    v_add_f32 v22, v22, v66
    v_add_f32 v23, v23, v67
    v_add_f32 v22, v22, v68
    v_add_f32 v23, v23, v69
    v_add_f32 v22, v22, v70
    v_add_f32 v23, v23, v71
    v_cvt_pk_bf16_f32 v136, v56, v57
    v_cvt_pk_bf16_f32 v137, v58, v59
    v_cvt_pk_bf16_f32 v138, v60, v61
    v_cvt_pk_bf16_f32 v139, v62, v63
    v_cvt_pk_bf16_f32 v140, v64, v65
    v_cvt_pk_bf16_f32 v141, v66, v67
    v_cvt_pk_bf16_f32 v142, v68, v69
    v_cvt_pk_bf16_f32 v143, v70, v71
    s_waitcnt lgkmcnt(2)
    v_mfma_f32_32x32x16_bf16 v[88:103], v[120:123], v[136:139], v[88:103]
    v_mfma_f32_32x32x16_bf16 v[88:103], v[124:127], v[140:143], v[88:103]
    ds_read_b128 v[128:131], v20 offset:22528
    ds_read_b128 v[132:135], v20 offset:23552
    s_cmp_eq_u32 s99, 3
    s_cbranch_scc0 ng_16
    v_mov_b32 v24, 0xf149f2ca
    v_mov_b32 v25, 0xf149f2ca
    v_mov_b32 v26, 0xf149f2ca
    v_mov_b32 v27, 0xf149f2ca
    v_mov_b32 v28, 0xf149f2ca
    v_mov_b32 v29, 0xf149f2ca
    v_mov_b32 v30, 0xf149f2ca
    v_mov_b32 v31, 0xf149f2ca
    v_mov_b32 v32, 0xf149f2ca
    v_mov_b32 v33, 0xf149f2ca
    v_mov_b32 v34, 0xf149f2ca
    v_mov_b32 v35, 0xf149f2ca
    v_mov_b32 v36, 0xf149f2ca
    v_mov_b32 v37, 0xf149f2ca
    v_mov_b32 v38, 0xf149f2ca
    v_mov_b32 v39, 0xf149f2ca
ng_16:
    s_waitcnt lgkmcnt(2)
    s_nop 0
    v_mfma_f32_32x32x16_bf16 v[56:71], v[104:107], v[4:7], v[24:39]
    v_mfma_f32_32x32x16_bf16 v[56:71], v[108:111], v[8:11], v[56:71]
    ds_read_b128 v[112:115], v20 offset:12288
    ds_read_b128 v[116:119], v20 offset:13312
    v_exp_f32 v72, v72
    v_exp_f32 v73, v73
    v_exp_f32 v74, v74
    v_exp_f32 v75, v75
    v_exp_f32 v76, v76
    v_exp_f32 v77, v77
    v_exp_f32 v78, v78
    v_exp_f32 v79, v79
    v_exp_f32 v80, v80
    v_exp_f32 v81, v81
    v_exp_f32 v82, v82
    v_exp_f32 v83, v83
    v_exp_f32 v84, v84
    v_exp_f32 v85, v85
    v_exp_f32 v86, v86
    v_exp_f32 v87, v87
    v_add_f32 v22, v22, v72
    v_add_f32 v23, v23, v73
    v_add_f32 v22, v22, v74
    v_add_f32 v23, v23, v75
    v_add_f32 v22, v22, v76
    v_add_f32 v23, v23, v77
    v_add_f32 v22, v22, v78
    v_add_f32 v23, v23, v79
    v_add_f32 v22, v22, v80
    v_add_f32 v23, v23, v81
    v_add_f32 v22, v22, v82
    v_add_f32 v23, v23, v83
    v_add_f32 v22, v22, v84
    v_add_f32 v23, v23, v85
    v_add_f32 v22, v22, v86
    v_add_f32 v23, v23, v87
    v_cvt_pk_bf16_f32 v144, v72, v73
    v_cvt_pk_bf16_f32 v145, v74, v75
    v_cvt_pk_bf16_f32 v146, v76, v77
    v_cvt_pk_bf16_f32 v147, v78, v79
    v_cvt_pk_bf16_f32 v148, v80, v81
    v_cvt_pk_bf16_f32 v149, v82, v83
    v_cvt_pk_bf16_f32 v150, v84, v85
    v_cvt_pk_bf16_f32 v151, v86, v87
    s_waitcnt lgkmcnt(2)
    v_mfma_f32_32x32x16_bf16 v[88:103], v[128:131], v[144:147], v[88:103]
    v_mfma_f32_32x32x16_bf16 v[88:103], v[132:135], v[148:151], v[88:103]
    ds_read_b128 v[120:123], v20 offset:18432
    ds_read_b128 v[124:127], v20 offset:19456
    s_cmp_eq_u32 s99, 4
    s_cbranch_scc0 ng_17
    v_mov_b32 v24, 0xf149f2ca
    v_mov_b32 v25, 0xf149f2ca
    v_mov_b32 v26, 0xf149f2ca
    v_mov_b32 v27, 0xf149f2ca
    v_mov_b32 v28, 0xf149f2ca
    v_mov_b32 v29, 0xf149f2ca
    v_mov_b32 v30, 0xf149f2ca
    v_mov_b32 v31, 0xf149f2ca
    v_mov_b32 v32, 0xf149f2ca
    v_mov_b32 v33, 0xf149f2ca
    v_mov_b32 v34, 0xf149f2ca
    v_mov_b32 v35, 0xf149f2ca
    v_mov_b32 v36, 0xf149f2ca
    v_mov_b32 v37, 0xf149f2ca
    v_mov_b32 v38, 0xf149f2ca
    v_mov_b32 v39, 0xf149f2ca
ng_17:
    s_waitcnt lgkmcnt(2)
    s_nop 0
    v_mfma_f32_32x32x16_bf16 v[72:87], v[112:115], v[4:7], v[24:39]
    v_mfma_f32_32x32x16_bf16 v[72:87], v[116:119], v[8:11], v[72:87]
    ds_read_b128 v[104:107], v20 offset:8192
    ds_read_b128 v[108:111], v20 offset:9216
    v_exp_f32 v56, v56
    v_exp_f32 v57, v57
    v_exp_f32 v58, v58
    v_exp_f32 v59, v59
    v_exp_f32 v60, v60
    v_exp_f32 v61, v61
    v_exp_f32 v62, v62
    v_exp_f32 v63, v63
    v_exp_f32 v64, v64
    v_exp_f32 v65, v65
    v_exp_f32 v66, v66
    v_exp_f32 v67, v67
    v_exp_f32 v68, v68
    v_exp_f32 v69, v69
    v_exp_f32 v70, v70
    v_exp_f32 v71, v71
    v_add_f32 v22, v22, v56
    v_add_f32 v23, v23, v57
    v_add_f32 v22, v22, v58
    v_add_f32 v23, v23, v59
    v_add_f32 v22, v22, v60
    v_add_f32 v23, v23, v61
    v_add_f32 v22, v22, v62
    v_add_f32 v23, v23, v63
    v_add_f32 v22, v22, v64
    v_add_f32 v23, v23, v65
    v_add_f32 v22, v22, v66
    v_add_f32 v23, v23, v67
    v_add_f32 v22, v22, v68
    v_add_f32 v23, v23, v69
    v_add_f32 v22, v22, v70
    v_add_f32 v23, v23, v71
    v_cvt_pk_bf16_f32 v136, v56, v57
    v_cvt_pk_bf16_f32 v137, v58, v59
    v_cvt_pk_bf16_f32 v138, v60, v61
    v_cvt_pk_bf16_f32 v139, v62, v63
    v_cvt_pk_bf16_f32 v140, v64, v65
    v_cvt_pk_bf16_f32 v141, v66, v67
    v_cvt_pk_bf16_f32 v142, v68, v69
    v_cvt_pk_bf16_f32 v143, v70, v71
    s_waitcnt lgkmcnt(2)
    v_mfma_f32_32x32x16_bf16 v[88:103], v[120:123], v[136:139], v[88:103]
    v_mfma_f32_32x32x16_bf16 v[88:103], v[124:127], v[140:143], v[88:103]
    ds_read_b128 v[128:131], v20 offset:14336
    ds_read_b128 v[132:135], v20 offset:15360
    s_cmp_eq_u32 s99, 5
    s_cbranch_scc0 ng_18
    v_mov_b32 v24, 0xf149f2ca
    v_mov_b32 v25, 0xf149f2ca
    v_mov_b32 v26, 0xf149f2ca
    v_mov_b32 v27, 0xf149f2ca
    v_mov_b32 v28, 0xf149f2ca
    v_mov_b32 v29, 0xf149f2ca
    v_mov_b32 v30, 0xf149f2ca
    v_mov_b32 v31, 0xf149f2ca
    v_mov_b32 v32, 0xf149f2ca
    v_mov_b32 v33, 0xf149f2ca
    v_mov_b32 v34, 0xf149f2ca
    v_mov_b32 v35, 0xf149f2ca
    v_mov_b32 v36, 0xf149f2ca
    v_mov_b32 v37, 0xf149f2ca
    v_mov_b32 v38, 0xf149f2ca
    v_mov_b32 v39, 0xf149f2ca
ng_18:
    s_waitcnt lgkmcnt(2)
    s_nop 0
    v_mfma_f32_32x32x16_bf16 v[56:71], v[104:107], v[4:7], v[24:39]
    v_mfma_f32_32x32x16_bf16 v[56:71], v[108:111], v[8:11], v[56:71]
    ds_read_b128 v[112:115], v20 offset:4096
    ds_read_b128 v[116:119], v20 offset:5120
    v_exp_f32 v72, v72
    v_exp_f32 v73, v73
    v_exp_f32 v74, v74
    v_exp_f32 v75, v75
    v_exp_f32 v76, v76
    v_exp_f32 v77, v77
    v_exp_f32 v78, v78
    v_exp_f32 v79, v79
    v_exp_f32 v80, v80
    v_exp_f32 v81, v81
    v_exp_f32 v82, v82
    v_exp_f32 v83, v83
    v_exp_f32 v84, v84
    v_exp_f32 v85, v85
    v_exp_f32 v86, v86
    v_exp_f32 v87, v87
    v_add_f32 v22, v22, v72
    v_add_f32 v23, v23, v73
    v_add_f32 v22, v22, v74
    v_add_f32 v23, v23, v75
    v_add_f32 v22, v22, v76
    v_add_f32 v23, v23, v77
    v_add_f32 v22, v22, v78
    v_add_f32 v23, v23, v79
    v_add_f32 v22, v22, v80
    v_add_f32 v23, v23, v81
    v_add_f32 v22, v22, v82
    v_add_f32 v23, v23, v83
    v_add_f32 v22, v22, v84
    v_add_f32 v23, v23, v85
    v_add_f32 v22, v22, v86
    v_add_f32 v23, v23, v87
    v_cvt_pk_bf16_f32 v144, v72, v73
    v_cvt_pk_bf16_f32 v145, v74, v75
    v_cvt_pk_bf16_f32 v146, v76, v77
    v_cvt_pk_bf16_f32 v147, v78, v79
    v_cvt_pk_bf16_f32 v148, v80, v81
    v_cvt_pk_bf16_f32 v149, v82, v83
    v_cvt_pk_bf16_f32 v150, v84, v85
    v_cvt_pk_bf16_f32 v151, v86, v87
    s_waitcnt lgkmcnt(2)
    v_mfma_f32_32x32x16_bf16 v[88:103], v[128:131], v[144:147], v[88:103]
    v_mfma_f32_32x32x16_bf16 v[88:103], v[132:135], v[148:151], v[88:103]
    ds_read_b128 v[120:123], v20 offset:10240
    ds_read_b128 v[124:127], v20 offset:11264
    s_cmp_eq_u32 s99, 6
    s_cbranch_scc0 ng_19
    v_mov_b32 v24, 0xf149f2ca
    v_mov_b32 v25, 0xf149f2ca
    v_mov_b32 v26, 0xf149f2ca
    v_mov_b32 v27, 0xf149f2ca
    v_mov_b32 v28, 0xf149f2ca
    v_mov_b32 v29, 0xf149f2ca
    v_mov_b32 v30, 0xf149f2ca
    v_mov_b32 v31, 0xf149f2ca
    v_mov_b32 v32, 0xf149f2ca
    v_mov_b32 v33, 0xf149f2ca
    v_mov_b32 v34, 0xf149f2ca
    v_mov_b32 v35, 0xf149f2ca
    v_mov_b32 v36, 0xf149f2ca
    v_mov_b32 v37, 0xf149f2ca
    v_mov_b32 v38, 0xf149f2ca
    v_mov_b32 v39, 0xf149f2ca
ng_19:
    s_waitcnt lgkmcnt(2)
    s_nop 0
    v_mfma_f32_32x32x16_bf16 v[72:87], v[112:115], v[4:7], v[24:39]
    v_mfma_f32_32x32x16_bf16 v[72:87], v[116:119], v[8:11], v[72:87]
    v_exp_f32 v56, v56
    v_exp_f32 v57, v57
    v_exp_f32 v58, v58
    v_exp_f32 v59, v59
    v_exp_f32 v60, v60
    v_exp_f32 v61, v61
    v_exp_f32 v62, v62
    v_exp_f32 v63, v63
    v_exp_f32 v64, v64
    v_exp_f32 v65, v65
    v_exp_f32 v66, v66
    v_exp_f32 v67, v67
    v_exp_f32 v68, v68
    v_exp_f32 v69, v69
    v_exp_f32 v70, v70
    v_exp_f32 v71, v71
    v_add_f32 v22, v22, v56
    v_add_f32 v23, v23, v57
    v_add_f32 v22, v22, v58
    v_add_f32 v23, v23, v59
    v_add_f32 v22, v22, v60
    v_add_f32 v23, v23, v61
    v_add_f32 v22, v22, v62
    v_add_f32 v23, v23, v63
    v_add_f32 v22, v22, v64
    v_add_f32 v23, v23, v65
    v_add_f32 v22, v22, v66
    v_add_f32 v23, v23, v67
    v_add_f32 v22, v22, v68
    v_add_f32 v23, v23, v69
    v_add_f32 v22, v22, v70
    v_add_f32 v23, v23, v71
    v_cvt_pk_bf16_f32 v136, v56, v57
    v_cvt_pk_bf16_f32 v137, v58, v59
    v_cvt_pk_bf16_f32 v138, v60, v61
    v_cvt_pk_bf16_f32 v139, v62, v63
    v_cvt_pk_bf16_f32 v140, v64, v65
    v_cvt_pk_bf16_f32 v141, v66, v67
    v_cvt_pk_bf16_f32 v142, v68, v69
    v_cvt_pk_bf16_f32 v143, v70, v71
    s_waitcnt lgkmcnt(0)
    v_mfma_f32_32x32x16_bf16 v[88:103], v[120:123], v[136:139], v[88:103]
    v_mfma_f32_32x32x16_bf16 v[88:103], v[124:127], v[140:143], v[88:103]
    ds_read_b128 v[128:131], v20 offset:6144
    ds_read_b128 v[132:135], v20 offset:7168
    v_exp_f32 v72, v72
    v_exp_f32 v73, v73
    v_exp_f32 v74, v74
    v_exp_f32 v75, v75
    v_exp_f32 v76, v76
    v_exp_f32 v77, v77
    v_exp_f32 v78, v78
    v_exp_f32 v79, v79
    v_exp_f32 v80, v80
    v_exp_f32 v81, v81
    v_exp_f32 v82, v82
    v_exp_f32 v83, v83
    v_exp_f32 v84, v84
    v_exp_f32 v85, v85
    v_exp_f32 v86, v86
    v_exp_f32 v87, v87
    v_add_f32 v22, v22, v72
    v_add_f32 v23, v23, v73
    v_add_f32 v22, v22, v74
    v_add_f32 v23, v23, v75
    v_add_f32 v22, v22, v76
    v_add_f32 v23, v23, v77
    v_add_f32 v22, v22, v78
    v_add_f32 v23, v23, v79
    v_add_f32 v22, v22, v80
    v_add_f32 v23, v23, v81
    v_add_f32 v22, v22, v82
    v_add_f32 v23, v23, v83
    v_add_f32 v22, v22, v84
    v_add_f32 v23, v23, v85
    v_add_f32 v22, v22, v86
    v_add_f32 v23, v23, v87
    v_cvt_pk_bf16_f32 v144, v72, v73
    v_cvt_pk_bf16_f32 v145, v74, v75
    v_cvt_pk_bf16_f32 v146, v76, v77
    v_cvt_pk_bf16_f32 v147, v78, v79
    v_cvt_pk_bf16_f32 v148, v80, v81
    v_cvt_pk_bf16_f32 v149, v82, v83
    v_cvt_pk_bf16_f32 v150, v84, v85
    v_cvt_pk_bf16_f32 v151, v86, v87
    s_waitcnt lgkmcnt(0)
    v_mfma_f32_32x32x16_bf16 v[88:103], v[128:131], v[144:147], v[88:103]
    v_mfma_f32_32x32x16_bf16 v[88:103], v[132:135], v[148:151], v[88:103]
    v_add_f32 v22, v22, v23
    v_mov_b32 v152, v22
    s_nop 1
    v_permlane32_swap_b32 v22, v152
    v_add_f32 v22, v22, v152
    v_rcp_f32 v22, v22
    s_lshl_b32 s36, s99, 16
    s_add_u32 s36, s36, 0x800000
    s_lshl_b32 s33, s25, 11
    s_add_u32 s33, s33, s36
    s_lshl_b32 s30, s24, 9
    s_lshl_b32 s31, s3, 6
    s_add_u32 s30, s30, s31
    s_add_u32 s30, s30, s26
    s_add_u32 s30, s30, 0xdd2000
    s_lshl_b32 s31, s25, 2
    s_add_u32 s31, s31, s30
    v_pk_mul_f32 v[88:89], v[88:89], v[22:23] op_sel_hi:[1,0]
    v_pk_mul_f32 v[90:91], v[90:91], v[22:23] op_sel_hi:[1,0]
    v_pk_mul_f32 v[92:93], v[92:93], v[22:23] op_sel_hi:[1,0]
    v_pk_mul_f32 v[94:95], v[94:95], v[22:23] op_sel_hi:[1,0]
    v_pk_mul_f32 v[96:97], v[96:97], v[22:23] op_sel_hi:[1,0]
    v_pk_mul_f32 v[98:99], v[98:99], v[22:23] op_sel_hi:[1,0]
    v_pk_mul_f32 v[100:101], v[100:101], v[22:23] op_sel_hi:[1,0]
    v_pk_mul_f32 v[102:103], v[102:103], v[22:23] op_sel_hi:[1,0]
    v_cvt_pk_bf16_f32 v88, v88, v89
    v_cvt_pk_bf16_f32 v89, v90, v91
    v_cvt_pk_bf16_f32 v90, v92, v93
    v_cvt_pk_bf16_f32 v91, v94, v95
    v_cvt_pk_bf16_f32 v92, v96, v97
    v_cvt_pk_bf16_f32 v93, v98, v99
    v_cvt_pk_bf16_f32 v94, v100, v101
    v_cvt_pk_bf16_f32 v95, v102, v103
    s_cmp_lg_u32 s77, 0
    s_cbranch_scc1 lc_20
    buffer_store_dwordx4 v[88:91], v253, s[20:23], s33 offen sc1
    buffer_store_dwordx4 v[92:95], v253, s[20:23], s33 offen offset:1024 sc1
    s_branch lc_21
lc_20:
    buffer_store_dwordx4 v[88:91], v253, s[20:23], s33 offen
    buffer_store_dwordx4 v[92:95], v253, s[20:23], s33 offen offset:1024
lc_21:
    v_bfe_u32 v33, v252, 2, 2
    v_lshrrev_b32 v32, 5, v252
    v_lshl_add_u32 v34, v32, 3, v33
    v_lshlrev_b32 v34, 7, v34
    v_lshrrev_b32 v33, 1, v33
    v_lshl_add_u32 v34, v33, 6, v34
    v_bfe_u32 v33, v252, 4, 1
    v_lshl_add_u32 v34, v33, 5, v34
    v_and_b32 v33, 3, v252
    v_lshl_add_u32 v56, v33, 3, v34
    v_xor_b32 v57, 64, v56
    v_add_u32 v58, 0x10000, v56
    v_add_u32 v59, 0x10000, v57
    v_and_b32 v60, 15, v252
    v_lshlrev_b32 v60, 2, v60
    s_waitcnt vmcnt(2)
    v_lshlrev_b32 v0, 16, v208
    v_and_b32 v1, 0xffff0000, v208
    v_lshlrev_b32 v2, 16, v209
    v_and_b32 v3, 0xffff0000, v209
    v_lshlrev_b32 v4, 16, v210
    v_and_b32 v5, 0xffff0000, v210
    v_lshlrev_b32 v6, 16, v211
    v_and_b32 v7, 0xffff0000, v211
    v_lshlrev_b32 v8, 16, v212
    v_and_b32 v9, 0xffff0000, v212
    v_lshlrev_b32 v10, 16, v213
    v_and_b32 v11, 0xffff0000, v213
    v_lshlrev_b32 v12, 16, v214
    v_and_b32 v13, 0xffff0000, v214
    v_lshlrev_b32 v14, 16, v215
    v_and_b32 v15, 0xffff0000, v215
    v_lshlrev_b32 v16, 16, v216
    v_and_b32 v17, 0xffff0000, v216
    v_lshlrev_b32 v18, 16, v217
    v_and_b32 v19, 0xffff0000, v217
    v_lshlrev_b32 v20, 16, v218
    v_and_b32 v21, 0xffff0000, v218
    v_lshlrev_b32 v22, 16, v219
    v_and_b32 v23, 0xffff0000, v219
    v_lshlrev_b32 v24, 16, v220
    v_and_b32 v25, 0xffff0000, v220
    v_lshlrev_b32 v26, 16, v221
    v_and_b32 v27, 0xffff0000, v221
    v_lshlrev_b32 v28, 16, v222
    v_and_b32 v29, 0xffff0000, v222
    v_lshlrev_b32 v30, 16, v223
    v_and_b32 v31, 0xffff0000, v223
    v_pk_fma_f32 v[0:1], v[0:1], v[240:241], v[240:241] op_sel:[0,0,1] op_sel_hi:[1,0,1]
    v_pk_fma_f32 v[2:3], v[2:3], v[240:241], v[240:241] op_sel:[0,0,1] op_sel_hi:[1,0,1]
    v_pk_fma_f32 v[4:5], v[4:5], v[240:241], v[240:241] op_sel:[0,0,1] op_sel_hi:[1,0,1]
    v_pk_fma_f32 v[6:7], v[6:7], v[240:241], v[240:241] op_sel:[0,0,1] op_sel_hi:[1,0,1]
    v_pk_fma_f32 v[8:9], v[8:9], v[240:241], v[240:241] op_sel:[0,0,1] op_sel_hi:[1,0,1]
    v_pk_fma_f32 v[10:11], v[10:11], v[240:241], v[240:241] op_sel:[0,0,1] op_sel_hi:[1,0,1]
    v_pk_fma_f32 v[12:13], v[12:13], v[240:241], v[240:241] op_sel:[0,0,1] op_sel_hi:[1,0,1]
    v_pk_fma_f32 v[14:15], v[14:15], v[240:241], v[240:241] op_sel:[0,0,1] op_sel_hi:[1,0,1]
    v_pk_fma_f32 v[16:17], v[16:17], v[240:241], v[240:241] op_sel:[0,0,1] op_sel_hi:[1,0,1]
    v_pk_fma_f32 v[18:19], v[18:19], v[240:241], v[240:241] op_sel:[0,0,1] op_sel_hi:[1,0,1]
    v_pk_fma_f32 v[20:21], v[20:21], v[240:241], v[240:241] op_sel:[0,0,1] op_sel_hi:[1,0,1]
    v_pk_fma_f32 v[22:23], v[22:23], v[240:241], v[240:241] op_sel:[0,0,1] op_sel_hi:[1,0,1]
    v_pk_fma_f32 v[24:25], v[24:25], v[240:241], v[240:241] op_sel:[0,0,1] op_sel_hi:[1,0,1]
    v_pk_fma_f32 v[26:27], v[26:27], v[240:241], v[240:241] op_sel:[0,0,1] op_sel_hi:[1,0,1]
    v_pk_fma_f32 v[28:29], v[28:29], v[240:241], v[240:241] op_sel:[0,0,1] op_sel_hi:[1,0,1]
    v_pk_fma_f32 v[30:31], v[30:31], v[240:241], v[240:241] op_sel:[0,0,1] op_sel_hi:[1,0,1]
    v_mov_b32 v154, s88
    s_mov_b64 exec, 1
    s_waitcnt vmcnt(0)
    s_cmp_lg_u32 s77, 0
    s_cbranch_scc1 lc_22
    buffer_store_dword v154, v253, s[20:23], s31 offen sc1
    s_branch lc_23
lc_22:
    buffer_store_dword v154, v253, s[20:23], s31 offen
lc_23:
    s_mov_b64 exec, -1
    s_barrier
    s_add_u32 s96, s25, 0
    s_and_b32 s96, s96, 15
    s_lshl_b32 s96, s96, 17
    s_add_u32 s96, s96, 65536
    s_add_u32 m0, s101, 65536
    s_nop 0
    buffer_load_dwordx4 v243, s[8:11], s96 offen lds
    s_add_u32 s96, s25, 1
    s_and_b32 s96, s96, 15
    s_lshl_b32 s96, s96, 17
    s_add_u32 s96, s96, 65536
    s_add_u32 m0, s101, 69632
    s_nop 0
    buffer_load_dwordx4 v243, s[8:11], s96 offen lds
    s_add_u32 s96, s25, 2
    s_and_b32 s96, s96, 15
    s_lshl_b32 s96, s96, 17
    s_add_u32 s96, s96, 65536
    s_add_u32 m0, s101, 73728
    s_nop 0
    buffer_load_dwordx4 v243, s[8:11], s96 offen lds
    s_add_u32 s96, s25, 3
    s_and_b32 s96, s96, 15
    s_lshl_b32 s96, s96, 17
    s_add_u32 s96, s96, 65536
    s_add_u32 m0, s101, 77824
    s_nop 0
    buffer_load_dwordx4 v243, s[8:11], s96 offen lds
    s_add_u32 s96, s25, 4
    s_and_b32 s96, s96, 15
    s_lshl_b32 s96, s96, 17
    s_add_u32 s96, s96, 65536
    s_add_u32 m0, s101, 81920
    s_nop 0
    buffer_load_dwordx4 v243, s[8:11], s96 offen lds
    s_add_u32 s96, s25, 5
    s_and_b32 s96, s96, 15
    s_lshl_b32 s96, s96, 17
    s_add_u32 s96, s96, 65536
    s_add_u32 m0, s101, 86016
    s_nop 0
    buffer_load_dwordx4 v243, s[8:11], s96 offen lds
    s_add_u32 s96, s25, 6
    s_and_b32 s96, s96, 15
    s_lshl_b32 s96, s96, 17
    s_add_u32 s96, s96, 65536
    s_add_u32 m0, s101, 90112
    s_nop 0
    buffer_load_dwordx4 v243, s[8:11], s96 offen lds
    s_add_u32 s96, s25, 7
    s_and_b32 s96, s96, 15
    s_lshl_b32 s96, s96, 17
    s_add_u32 s96, s96, 65536
    s_add_u32 m0, s101, 94208
    s_nop 0
    buffer_load_dwordx4 v243, s[8:11], s96 offen lds
    s_add_u32 s96, s25, 8
    s_and_b32 s96, s96, 15
    s_lshl_b32 s96, s96, 17
    s_add_u32 s96, s96, 65536
    s_add_u32 m0, s101, 98304
    s_nop 0
    buffer_load_dwordx4 v243, s[8:11], s96 offen lds
    s_add_u32 s96, s25, 9
    s_and_b32 s96, s96, 15
    s_lshl_b32 s96, s96, 17
    s_add_u32 s96, s96, 65536
    s_add_u32 m0, s101, 102400
    s_nop 0
    buffer_load_dwordx4 v243, s[8:11], s96 offen lds
    s_add_u32 s96, s25, 10
    s_and_b32 s96, s96, 15
    s_lshl_b32 s96, s96, 17
    s_add_u32 s96, s96, 65536
    s_add_u32 m0, s101, 106496
    s_nop 0
    buffer_load_dwordx4 v243, s[8:11], s96 offen lds
    s_add_u32 s96, s25, 11
    s_and_b32 s96, s96, 15
    s_lshl_b32 s96, s96, 17
    s_add_u32 s96, s96, 65536
    s_add_u32 m0, s101, 110592
    s_nop 0
    buffer_load_dwordx4 v243, s[8:11], s96 offen lds
    v_bfe_u32 v100, v252, 4, 1
    v_lshlrev_b32 v100, 11, v100
    v_lshrrev_b32 v101, 5, v252
    v_lshl_add_u32 v100, v101, 8, v100
    v_and_b32 v101, 15, v252
    v_lshl_add_u32 v100, v101, 4, v100
    s_lshl_b32 s34, s28, 12
    s_add_u32 s34, s34, 147456
    v_add_u32 v101, s34, v100
    s_lshl_b32 s37, s25, 11
    ds_read_b64_tr_b16 v[32:33], v56 offset:0
    ds_read_b64_tr_b16 v[34:35], v56 offset:512
    ds_read_b64_tr_b16 v[36:37], v57 offset:0
    ds_read_b64_tr_b16 v[38:39], v57 offset:512
    ds_read_b64_tr_b16 v[40:41], v56 offset:2048
    ds_read_b64_tr_b16 v[42:43], v56 offset:2560
    ds_read_b64_tr_b16 v[44:45], v57 offset:2048
    ds_read_b64_tr_b16 v[46:47], v57 offset:2560
    s_mov_b32 s78, s27
pl_24:
    buffer_load_dword v61, v60, s[20:23], s30 offen offset:0 sc1
    s_waitcnt vmcnt(0)
pc_25:
    v_cmp_ne_u32 vcc, s88, v61
    s_cbranch_vccz pd_26
    s_sub_u32 s78, s78, 1
    s_cmp_lg_u32 s78, 0
    s_cbranch_scc1 pl_24
    s_mov_b32 s27, 1
pd_26:
    s_add_u32 s38, s36, s37
    buffer_load_dwordx4 v[104:107], v253, s[20:23], s38 offen offset:0 sc1
    s_add_u32 s37, s37, 2048
    s_and_b32 s37, s37, 0x7800
    buffer_load_dwordx4 v[108:111], v253, s[20:23], s38 offen offset:1024 sc1
    s_add_u32 s38, s36, s37
    buffer_load_dwordx4 v[112:115], v253, s[20:23], s38 offen offset:0 sc1
    s_add_u32 s37, s37, 2048
    s_and_b32 s37, s37, 0x7800
    buffer_load_dwordx4 v[116:119], v253, s[20:23], s38 offen offset:1024 sc1
    s_add_u32 s38, s36, s37
    buffer_load_dwordx4 v[120:123], v253, s[20:23], s38 offen offset:0 sc1
    s_add_u32 s37, s37, 2048
    s_and_b32 s37, s37, 0x7800
    buffer_load_dwordx4 v[124:127], v253, s[20:23], s38 offen offset:1024 sc1
    s_add_u32 s38, s36, s37
    buffer_load_dwordx4 v[128:131], v253, s[20:23], s38 offen offset:0 sc1
    s_add_u32 s37, s37, 2048
    s_and_b32 s37, s37, 0x7800
    buffer_load_dwordx4 v[132:135], v253, s[20:23], s38 offen offset:1024 sc1
    s_waitcnt vmcnt(7) lgkmcnt(4)
    v_mfma_f32_32x32x16_bf16 v[0:15], v[32:35], v[104:107], v[0:15]
    s_add_u32 s38, s36, s37
    buffer_load_dwordx4 v[136:139], v253, s[20:23], s38 offen offset:0 sc1
    ds_read_b64_tr_b16 v[48:49], v56 offset:4096
    ds_read_b64_tr_b16 v[50:51], v56 offset:4608
    v_mfma_f32_32x32x16_bf16 v[16:31], v[36:39], v[104:107], v[16:31]
    ds_read_b64_tr_b16 v[52:53], v57 offset:4096
    ds_read_b64_tr_b16 v[54:55], v57 offset:4608
    s_waitcnt vmcnt(7) lgkmcnt(4)
    v_mfma_f32_32x32x16_bf16 v[0:15], v[40:43], v[108:111], v[0:15]
    s_add_u32 s37, s37, 2048
    s_and_b32 s37, s37, 0x7800
    buffer_load_dwordx4 v[104:107], v253, s[20:23], s38 offen offset:1024 sc1
    ds_read_b64_tr_b16 v[32:33], v56 offset:6144
    ds_read_b64_tr_b16 v[34:35], v56 offset:6656
    v_mfma_f32_32x32x16_bf16 v[16:31], v[44:47], v[108:111], v[16:31]
    ds_read_b64_tr_b16 v[36:37], v57 offset:6144
    ds_read_b64_tr_b16 v[38:39], v57 offset:6656
    s_waitcnt vmcnt(7) lgkmcnt(4)
    v_mfma_f32_32x32x16_bf16 v[0:15], v[48:51], v[112:115], v[0:15]
    s_add_u32 s38, s36, s37
    buffer_load_dwordx4 v[108:111], v253, s[20:23], s38 offen offset:0 sc1
    ds_read_b64_tr_b16 v[40:41], v56 offset:8192
    ds_read_b64_tr_b16 v[42:43], v56 offset:8704
    v_mfma_f32_32x32x16_bf16 v[16:31], v[52:55], v[112:115], v[16:31]
    ds_read_b64_tr_b16 v[44:45], v57 offset:8192
    ds_read_b64_tr_b16 v[46:47], v57 offset:8704
    s_waitcnt vmcnt(7) lgkmcnt(4)
    v_mfma_f32_32x32x16_bf16 v[0:15], v[32:35], v[116:119], v[0:15]
    s_add_u32 s37, s37, 2048
    s_and_b32 s37, s37, 0x7800
    buffer_load_dwordx4 v[112:115], v253, s[20:23], s38 offen offset:1024 sc1
    ds_read_b64_tr_b16 v[48:49], v56 offset:10240
    ds_read_b64_tr_b16 v[50:51], v56 offset:10752
    v_mfma_f32_32x32x16_bf16 v[16:31], v[36:39], v[116:119], v[16:31]
    ds_read_b64_tr_b16 v[52:53], v57 offset:10240
    ds_read_b64_tr_b16 v[54:55], v57 offset:10752
    s_waitcnt vmcnt(7) lgkmcnt(4)
    v_mfma_f32_32x32x16_bf16 v[0:15], v[40:43], v[120:123], v[0:15]
    s_add_u32 s38, s36, s37
    buffer_load_dwordx4 v[116:119], v253, s[20:23], s38 offen offset:0 sc1
    ds_read_b64_tr_b16 v[32:33], v56 offset:12288
    ds_read_b64_tr_b16 v[34:35], v56 offset:12800
    v_mfma_f32_32x32x16_bf16 v[16:31], v[44:47], v[120:123], v[16:31]
    ds_read_b64_tr_b16 v[36:37], v57 offset:12288
    ds_read_b64_tr_b16 v[38:39], v57 offset:12800
    s_waitcnt vmcnt(7) lgkmcnt(4)
    v_mfma_f32_32x32x16_bf16 v[0:15], v[48:51], v[124:127], v[0:15]
    s_add_u32 s37, s37, 2048
    s_and_b32 s37, s37, 0x7800
    buffer_load_dwordx4 v[120:123], v253, s[20:23], s38 offen offset:1024 sc1
    ds_read_b64_tr_b16 v[40:41], v56 offset:14336
    ds_read_b64_tr_b16 v[42:43], v56 offset:14848
    v_mfma_f32_32x32x16_bf16 v[16:31], v[52:55], v[124:127], v[16:31]
    ds_read_b64_tr_b16 v[44:45], v57 offset:14336
    ds_read_b64_tr_b16 v[46:47], v57 offset:14848
    s_waitcnt vmcnt(7) lgkmcnt(4)
    v_mfma_f32_32x32x16_bf16 v[0:15], v[32:35], v[128:131], v[0:15]
    s_add_u32 s38, s36, s37
    buffer_load_dwordx4 v[124:127], v253, s[20:23], s38 offen offset:0 sc1
    ds_read_b64_tr_b16 v[48:49], v56 offset:16384
    ds_read_b64_tr_b16 v[50:51], v56 offset:16896
    v_mfma_f32_32x32x16_bf16 v[16:31], v[36:39], v[128:131], v[16:31]
    ds_read_b64_tr_b16 v[52:53], v57 offset:16384
    ds_read_b64_tr_b16 v[54:55], v57 offset:16896
    s_waitcnt vmcnt(7) lgkmcnt(4)
    v_mfma_f32_32x32x16_bf16 v[0:15], v[40:43], v[132:135], v[0:15]
    s_add_u32 s37, s37, 2048
    s_and_b32 s37, s37, 0x7800
    buffer_load_dwordx4 v[128:131], v253, s[20:23], s38 offen offset:1024 sc1
    ds_read_b64_tr_b16 v[32:33], v56 offset:18432
    ds_read_b64_tr_b16 v[34:35], v56 offset:18944
    v_mfma_f32_32x32x16_bf16 v[16:31], v[44:47], v[132:135], v[16:31]
    ds_read_b64_tr_b16 v[36:37], v57 offset:18432
    ds_read_b64_tr_b16 v[38:39], v57 offset:18944
    s_waitcnt vmcnt(7) lgkmcnt(4)
    v_mfma_f32_32x32x16_bf16 v[0:15], v[48:51], v[136:139], v[0:15]
    s_add_u32 s38, s36, s37
    buffer_load_dwordx4 v[132:135], v253, s[20:23], s38 offen offset:0 sc1
    ds_read_b64_tr_b16 v[40:41], v56 offset:20480
    ds_read_b64_tr_b16 v[42:43], v56 offset:20992
    v_mfma_f32_32x32x16_bf16 v[16:31], v[52:55], v[136:139], v[16:31]
    ds_read_b64_tr_b16 v[44:45], v57 offset:20480
    ds_read_b64_tr_b16 v[46:47], v57 offset:20992
    s_waitcnt vmcnt(7) lgkmcnt(4)
    v_mfma_f32_32x32x16_bf16 v[0:15], v[32:35], v[104:107], v[0:15]
    s_add_u32 s37, s37, 2048
    s_and_b32 s37, s37, 0x7800
    buffer_load_dwordx4 v[136:139], v253, s[20:23], s38 offen offset:1024 sc1
    ds_read_b64_tr_b16 v[48:49], v56 offset:22528
    ds_read_b64_tr_b16 v[50:51], v56 offset:23040
    v_mfma_f32_32x32x16_bf16 v[16:31], v[36:39], v[104:107], v[16:31]
    ds_read_b64_tr_b16 v[52:53], v57 offset:22528
    ds_read_b64_tr_b16 v[54:55], v57 offset:23040
    s_waitcnt vmcnt(7) lgkmcnt(4)
    v_mfma_f32_32x32x16_bf16 v[0:15], v[40:43], v[108:111], v[0:15]
    s_add_u32 s38, s36, s37
    buffer_load_dwordx4 v[104:107], v253, s[20:23], s38 offen offset:0 sc1
    ds_read_b64_tr_b16 v[32:33], v56 offset:24576
    ds_read_b64_tr_b16 v[34:35], v56 offset:25088
    v_mfma_f32_32x32x16_bf16 v[16:31], v[44:47], v[108:111], v[16:31]
    ds_read_b64_tr_b16 v[36:37], v57 offset:24576
    ds_read_b64_tr_b16 v[38:39], v57 offset:25088
    s_waitcnt vmcnt(7) lgkmcnt(4)
    v_mfma_f32_32x32x16_bf16 v[0:15], v[48:51], v[112:115], v[0:15]
    s_add_u32 s37, s37, 2048
    s_and_b32 s37, s37, 0x7800
    buffer_load_dwordx4 v[108:111], v253, s[20:23], s38 offen offset:1024 sc1
    ds_read_b64_tr_b16 v[40:41], v56 offset:26624
    ds_read_b64_tr_b16 v[42:43], v56 offset:27136
    v_mfma_f32_32x32x16_bf16 v[16:31], v[52:55], v[112:115], v[16:31]
    ds_read_b64_tr_b16 v[44:45], v57 offset:26624
    ds_read_b64_tr_b16 v[46:47], v57 offset:27136
    s_waitcnt vmcnt(7) lgkmcnt(4)
    v_mfma_f32_32x32x16_bf16 v[0:15], v[32:35], v[116:119], v[0:15]
    s_add_u32 s38, s36, s37
    buffer_load_dwordx4 v[112:115], v253, s[20:23], s38 offen offset:0 sc1
    ds_read_b64_tr_b16 v[48:49], v56 offset:28672
    ds_read_b64_tr_b16 v[50:51], v56 offset:29184
    v_mfma_f32_32x32x16_bf16 v[16:31], v[36:39], v[116:119], v[16:31]
    ds_read_b64_tr_b16 v[52:53], v57 offset:28672
    ds_read_b64_tr_b16 v[54:55], v57 offset:29184
    s_waitcnt vmcnt(7) lgkmcnt(4)
    v_mfma_f32_32x32x16_bf16 v[0:15], v[40:43], v[120:123], v[0:15]
    s_add_u32 s37, s37, 2048
    s_and_b32 s37, s37, 0x7800
    buffer_load_dwordx4 v[116:119], v253, s[20:23], s38 offen offset:1024 sc1
    ds_read_b64_tr_b16 v[32:33], v56 offset:30720
    ds_read_b64_tr_b16 v[34:35], v56 offset:31232
    v_mfma_f32_32x32x16_bf16 v[16:31], v[44:47], v[120:123], v[16:31]
    ds_read_b64_tr_b16 v[36:37], v57 offset:30720
    ds_read_b64_tr_b16 v[38:39], v57 offset:31232
    s_waitcnt vmcnt(7) lgkmcnt(4)
    v_mfma_f32_32x32x16_bf16 v[0:15], v[48:51], v[124:127], v[0:15]
    s_add_u32 s38, s36, s37
    buffer_load_dwordx4 v[120:123], v253, s[20:23], s38 offen offset:0 sc1
    ds_read_b64_tr_b16 v[40:41], v56 offset:32768
    ds_read_b64_tr_b16 v[42:43], v56 offset:33280
    v_mfma_f32_32x32x16_bf16 v[16:31], v[52:55], v[124:127], v[16:31]
    ds_read_b64_tr_b16 v[44:45], v57 offset:32768
    ds_read_b64_tr_b16 v[46:47], v57 offset:33280
    s_waitcnt vmcnt(7) lgkmcnt(4)
    v_mfma_f32_32x32x16_bf16 v[0:15], v[32:35], v[128:131], v[0:15]
    s_add_u32 s37, s37, 2048
    s_and_b32 s37, s37, 0x7800
    buffer_load_dwordx4 v[124:127], v253, s[20:23], s38 offen offset:1024 sc1
    ds_read_b64_tr_b16 v[48:49], v56 offset:34816
    ds_read_b64_tr_b16 v[50:51], v56 offset:35328
    v_mfma_f32_32x32x16_bf16 v[16:31], v[36:39], v[128:131], v[16:31]
    ds_read_b64_tr_b16 v[52:53], v57 offset:34816
    ds_read_b64_tr_b16 v[54:55], v57 offset:35328
    s_waitcnt vmcnt(7) lgkmcnt(4)
    v_mfma_f32_32x32x16_bf16 v[0:15], v[40:43], v[132:135], v[0:15]
    s_add_u32 s38, s36, s37
    buffer_load_dwordx4 v[128:131], v253, s[20:23], s38 offen offset:0 sc1
    ds_read_b64_tr_b16 v[32:33], v56 offset:36864
    ds_read_b64_tr_b16 v[34:35], v56 offset:37376
    v_mfma_f32_32x32x16_bf16 v[16:31], v[44:47], v[132:135], v[16:31]
    ds_read_b64_tr_b16 v[36:37], v57 offset:36864
    ds_read_b64_tr_b16 v[38:39], v57 offset:37376
    s_waitcnt vmcnt(7) lgkmcnt(4)
    v_mfma_f32_32x32x16_bf16 v[0:15], v[48:51], v[136:139], v[0:15]
    s_add_u32 s37, s37, 2048
    s_and_b32 s37, s37, 0x7800
    buffer_load_dwordx4 v[132:135], v253, s[20:23], s38 offen offset:1024 sc1
    ds_read_b64_tr_b16 v[40:41], v56 offset:38912
    ds_read_b64_tr_b16 v[42:43], v56 offset:39424
    v_mfma_f32_32x32x16_bf16 v[16:31], v[52:55], v[136:139], v[16:31]
    ds_read_b64_tr_b16 v[44:45], v57 offset:38912
    ds_read_b64_tr_b16 v[46:47], v57 offset:39424
    s_waitcnt vmcnt(7) lgkmcnt(4)
    v_mfma_f32_32x32x16_bf16 v[0:15], v[32:35], v[104:107], v[0:15]
    s_add_u32 s38, s36, s37
    buffer_load_dwordx4 v[136:139], v253, s[20:23], s38 offen offset:0 sc1
    ds_read_b64_tr_b16 v[48:49], v56 offset:40960
    ds_read_b64_tr_b16 v[50:51], v56 offset:41472
    v_mfma_f32_32x32x16_bf16 v[16:31], v[36:39], v[104:107], v[16:31]
    ds_read_b64_tr_b16 v[52:53], v57 offset:40960
    ds_read_b64_tr_b16 v[54:55], v57 offset:41472
    s_waitcnt vmcnt(7) lgkmcnt(4)
    v_mfma_f32_32x32x16_bf16 v[0:15], v[40:43], v[108:111], v[0:15]
    s_add_u32 s37, s37, 2048
    s_and_b32 s37, s37, 0x7800
    buffer_load_dwordx4 v[104:107], v253, s[20:23], s38 offen offset:1024 sc1
    ds_read_b64_tr_b16 v[32:33], v56 offset:43008
    ds_read_b64_tr_b16 v[34:35], v56 offset:43520
    v_mfma_f32_32x32x16_bf16 v[16:31], v[44:47], v[108:111], v[16:31]
    ds_read_b64_tr_b16 v[36:37], v57 offset:43008
    ds_read_b64_tr_b16 v[38:39], v57 offset:43520
    s_waitcnt vmcnt(7) lgkmcnt(4)
    v_mfma_f32_32x32x16_bf16 v[0:15], v[48:51], v[112:115], v[0:15]
    buffer_load_dword v61, v60, s[20:23], s30 offen offset:256 sc1
    s_add_u32 s38, s36, s37
    buffer_load_dwordx4 v[108:111], v253, s[20:23], s38 offen offset:0 sc1
    ds_read_b64_tr_b16 v[40:41], v56 offset:45056
    ds_read_b64_tr_b16 v[42:43], v56 offset:45568
    v_mfma_f32_32x32x16_bf16 v[16:31], v[52:55], v[112:115], v[16:31]
    ds_read_b64_tr_b16 v[44:45], v57 offset:45056
    ds_read_b64_tr_b16 v[46:47], v57 offset:45568
    s_waitcnt vmcnt(8) lgkmcnt(4)
    v_mfma_f32_32x32x16_bf16 v[0:15], v[32:35], v[116:119], v[0:15]
    s_add_u32 s37, s37, 2048
    s_and_b32 s37, s37, 0x7800
    buffer_load_dwordx4 v[112:115], v253, s[20:23], s38 offen offset:1024 sc1
    ds_read_b64_tr_b16 v[48:49], v56 offset:47104
    ds_read_b64_tr_b16 v[50:51], v56 offset:47616
    v_mfma_f32_32x32x16_bf16 v[16:31], v[36:39], v[116:119], v[16:31]
    ds_read_b64_tr_b16 v[52:53], v57 offset:47104
    ds_read_b64_tr_b16 v[54:55], v57 offset:47616
    s_waitcnt vmcnt(8) lgkmcnt(4)
    v_mfma_f32_32x32x16_bf16 v[0:15], v[40:43], v[120:123], v[0:15]
    s_add_u32 s38, s36, s37
    buffer_load_dwordx4 v[116:119], v253, s[20:23], s38 offen offset:0 sc1
    ds_read_b64_tr_b16 v[32:33], v56 offset:49152
    ds_read_b64_tr_b16 v[34:35], v56 offset:49664
    v_mfma_f32_32x32x16_bf16 v[16:31], v[44:47], v[120:123], v[16:31]
    ds_read_b64_tr_b16 v[36:37], v57 offset:49152
    ds_read_b64_tr_b16 v[38:39], v57 offset:49664
    s_waitcnt vmcnt(8) lgkmcnt(4)
    v_mfma_f32_32x32x16_bf16 v[0:15], v[48:51], v[124:127], v[0:15]
    s_add_u32 s37, s37, 2048
    s_and_b32 s37, s37, 0x7800
    buffer_load_dwordx4 v[120:123], v253, s[20:23], s38 offen offset:1024 sc1
    ds_read_b64_tr_b16 v[40:41], v56 offset:51200
    ds_read_b64_tr_b16 v[42:43], v56 offset:51712
    v_mfma_f32_32x32x16_bf16 v[16:31], v[52:55], v[124:127], v[16:31]
    ds_read_b64_tr_b16 v[44:45], v57 offset:51200
    ds_read_b64_tr_b16 v[46:47], v57 offset:51712
    s_waitcnt vmcnt(8) lgkmcnt(4)
    v_mfma_f32_32x32x16_bf16 v[0:15], v[32:35], v[128:131], v[0:15]
    s_mov_b32 s78, s27
    s_waitcnt vmcnt(4)
    s_branch pc_28
pl_27:
    buffer_load_dword v61, v60, s[20:23], s30 offen offset:256 sc1
    s_waitcnt vmcnt(0)
pc_28:
    v_cmp_ne_u32 vcc, s88, v61
    s_cbranch_vccz pd_29
    s_sub_u32 s78, s78, 1
    s_cmp_lg_u32 s78, 0
    s_cbranch_scc1 pl_27
    s_mov_b32 s27, 1
pd_29:
    s_add_u32 s36, s36, 32768
    s_add_u32 s38, s36, s37
    buffer_load_dwordx4 v[124:127], v253, s[20:23], s38 offen offset:0 sc1
    ds_read_b64_tr_b16 v[48:49], v56 offset:53248
    ds_read_b64_tr_b16 v[50:51], v56 offset:53760
    v_mfma_f32_32x32x16_bf16 v[16:31], v[36:39], v[128:131], v[16:31]
    ds_read_b64_tr_b16 v[52:53], v57 offset:53248
    ds_read_b64_tr_b16 v[54:55], v57 offset:53760
    s_waitcnt vmcnt(8) lgkmcnt(4)
    v_mfma_f32_32x32x16_bf16 v[0:15], v[40:43], v[132:135], v[0:15]
    s_add_u32 s37, s37, 2048
    s_and_b32 s37, s37, 0x7800
    buffer_load_dwordx4 v[128:131], v253, s[20:23], s38 offen offset:1024 sc1
    ds_read_b64_tr_b16 v[32:33], v56 offset:55296
    ds_read_b64_tr_b16 v[34:35], v56 offset:55808
    v_mfma_f32_32x32x16_bf16 v[16:31], v[44:47], v[132:135], v[16:31]
    ds_read_b64_tr_b16 v[36:37], v57 offset:55296
    ds_read_b64_tr_b16 v[38:39], v57 offset:55808
    s_waitcnt vmcnt(8) lgkmcnt(4)
    v_mfma_f32_32x32x16_bf16 v[0:15], v[48:51], v[136:139], v[0:15]
    s_add_u32 s38, s36, s37
    buffer_load_dwordx4 v[132:135], v253, s[20:23], s38 offen offset:0 sc1
    ds_read_b64_tr_b16 v[40:41], v56 offset:57344
    ds_read_b64_tr_b16 v[42:43], v56 offset:57856
    v_mfma_f32_32x32x16_bf16 v[16:31], v[52:55], v[136:139], v[16:31]
    ds_read_b64_tr_b16 v[44:45], v57 offset:57344
    ds_read_b64_tr_b16 v[46:47], v57 offset:57856
    s_waitcnt vmcnt(8) lgkmcnt(4)
    v_mfma_f32_32x32x16_bf16 v[0:15], v[32:35], v[104:107], v[0:15]
    s_add_u32 s37, s37, 2048
    s_and_b32 s37, s37, 0x7800
    buffer_load_dwordx4 v[136:139], v253, s[20:23], s38 offen offset:1024 sc1
    ds_read_b64_tr_b16 v[48:49], v56 offset:59392
    ds_read_b64_tr_b16 v[50:51], v56 offset:59904
    v_mfma_f32_32x32x16_bf16 v[16:31], v[36:39], v[104:107], v[16:31]
    ds_read_b64_tr_b16 v[52:53], v57 offset:59392
    ds_read_b64_tr_b16 v[54:55], v57 offset:59904
    s_waitcnt vmcnt(7) lgkmcnt(4)
    v_mfma_f32_32x32x16_bf16 v[0:15], v[40:43], v[108:111], v[0:15]
    s_add_u32 s38, s36, s37
    buffer_load_dwordx4 v[104:107], v253, s[20:23], s38 offen offset:0 sc1
    ds_read_b64_tr_b16 v[32:33], v56 offset:61440
    ds_read_b64_tr_b16 v[34:35], v56 offset:61952
    v_mfma_f32_32x32x16_bf16 v[16:31], v[44:47], v[108:111], v[16:31]
    ds_read_b64_tr_b16 v[36:37], v57 offset:61440
    ds_read_b64_tr_b16 v[38:39], v57 offset:61952
    s_waitcnt vmcnt(7) lgkmcnt(4)
    v_mfma_f32_32x32x16_bf16 v[0:15], v[48:51], v[112:115], v[0:15]
    s_add_u32 s37, s37, 2048
    s_and_b32 s37, s37, 0x7800
    buffer_load_dwordx4 v[108:111], v253, s[20:23], s38 offen offset:1024 sc1
    ds_read_b64_tr_b16 v[40:41], v56 offset:63488
    ds_read_b64_tr_b16 v[42:43], v56 offset:64000
    v_mfma_f32_32x32x16_bf16 v[16:31], v[52:55], v[112:115], v[16:31]
    ds_read_b64_tr_b16 v[44:45], v57 offset:63488
    ds_read_b64_tr_b16 v[46:47], v57 offset:64000
    s_barrier
    s_waitcnt vmcnt(7) lgkmcnt(4)
    v_mfma_f32_32x32x16_bf16 v[0:15], v[32:35], v[116:119], v[0:15]
    s_add_u32 s38, s36, s37
    buffer_load_dwordx4 v[112:115], v253, s[20:23], s38 offen offset:0 sc1
    ds_read_b64_tr_b16 v[48:49], v58 offset:0
    ds_read_b64_tr_b16 v[50:51], v58 offset:512
    v_mfma_f32_32x32x16_bf16 v[16:31], v[36:39], v[116:119], v[16:31]
    ds_read_b64_tr_b16 v[52:53], v59 offset:0
    ds_read_b64_tr_b16 v[54:55], v59 offset:512
    s_waitcnt vmcnt(7) lgkmcnt(4)
    v_mfma_f32_32x32x16_bf16 v[0:15], v[40:43], v[120:123], v[0:15]
    s_add_u32 s37, s37, 2048
    s_and_b32 s37, s37, 0x7800
    buffer_load_dwordx4 v[116:119], v253, s[20:23], s38 offen offset:1024 sc1
    ds_read_b64_tr_b16 v[32:33], v58 offset:2048
    ds_read_b64_tr_b16 v[34:35], v58 offset:2560
    v_mfma_f32_32x32x16_bf16 v[16:31], v[44:47], v[120:123], v[16:31]
    ds_read_b64_tr_b16 v[36:37], v59 offset:2048
    ds_read_b64_tr_b16 v[38:39], v59 offset:2560
    s_waitcnt vmcnt(7) lgkmcnt(4)
    v_mfma_f32_32x32x16_bf16 v[0:15], v[48:51], v[124:127], v[0:15]
    s_add_u32 s38, s36, s37
    buffer_load_dwordx4 v[120:123], v253, s[20:23], s38 offen offset:0 sc1
    ds_read_b64_tr_b16 v[40:41], v58 offset:4096
    ds_read_b64_tr_b16 v[42:43], v58 offset:4608
    v_mfma_f32_32x32x16_bf16 v[16:31], v[52:55], v[124:127], v[16:31]
    ds_read_b64_tr_b16 v[44:45], v59 offset:4096
    ds_read_b64_tr_b16 v[46:47], v59 offset:4608
    s_waitcnt vmcnt(7) lgkmcnt(4)
    v_mfma_f32_32x32x16_bf16 v[0:15], v[32:35], v[128:131], v[0:15]
    s_add_u32 s37, s37, 2048
    s_and_b32 s37, s37, 0x7800
    buffer_load_dwordx4 v[124:127], v253, s[20:23], s38 offen offset:1024 sc1
    ds_read_b64_tr_b16 v[48:49], v58 offset:6144
    ds_read_b64_tr_b16 v[50:51], v58 offset:6656
    v_mfma_f32_32x32x16_bf16 v[16:31], v[36:39], v[128:131], v[16:31]
    ds_read_b64_tr_b16 v[52:53], v59 offset:6144
    ds_read_b64_tr_b16 v[54:55], v59 offset:6656
    s_waitcnt vmcnt(7) lgkmcnt(4)
    v_mfma_f32_32x32x16_bf16 v[0:15], v[40:43], v[132:135], v[0:15]
    s_add_u32 s38, s36, s37
    buffer_load_dwordx4 v[128:131], v253, s[20:23], s38 offen offset:0 sc1
    ds_read_b64_tr_b16 v[32:33], v58 offset:8192
    ds_read_b64_tr_b16 v[34:35], v58 offset:8704
    v_mfma_f32_32x32x16_bf16 v[16:31], v[44:47], v[132:135], v[16:31]
    ds_read_b64_tr_b16 v[36:37], v59 offset:8192
    ds_read_b64_tr_b16 v[38:39], v59 offset:8704
    s_waitcnt vmcnt(7) lgkmcnt(4)
    v_mfma_f32_32x32x16_bf16 v[0:15], v[48:51], v[136:139], v[0:15]
    s_add_u32 s37, s37, 2048
    s_and_b32 s37, s37, 0x7800
    buffer_load_dwordx4 v[132:135], v253, s[20:23], s38 offen offset:1024 sc1
    ds_read_b64_tr_b16 v[40:41], v58 offset:10240
    ds_read_b64_tr_b16 v[42:43], v58 offset:10752
    v_mfma_f32_32x32x16_bf16 v[16:31], v[52:55], v[136:139], v[16:31]
    ds_read_b64_tr_b16 v[44:45], v59 offset:10240
    ds_read_b64_tr_b16 v[46:47], v59 offset:10752
    s_waitcnt vmcnt(7) lgkmcnt(4)
    v_mfma_f32_32x32x16_bf16 v[0:15], v[32:35], v[104:107], v[0:15]
    s_add_u32 s38, s36, s37
    buffer_load_dwordx4 v[136:139], v253, s[20:23], s38 offen offset:0 sc1
    ds_read_b64_tr_b16 v[48:49], v58 offset:12288
    ds_read_b64_tr_b16 v[50:51], v58 offset:12800
    v_mfma_f32_32x32x16_bf16 v[16:31], v[36:39], v[104:107], v[16:31]
    ds_read_b64_tr_b16 v[52:53], v59 offset:12288
    ds_read_b64_tr_b16 v[54:55], v59 offset:12800
    s_waitcnt vmcnt(7) lgkmcnt(4)
    v_mfma_f32_32x32x16_bf16 v[0:15], v[40:43], v[108:111], v[0:15]
    s_add_u32 s37, s37, 2048
    s_and_b32 s37, s37, 0x7800
    buffer_load_dwordx4 v[104:107], v253, s[20:23], s38 offen offset:1024 sc1
    ds_read_b64_tr_b16 v[32:33], v58 offset:14336
    ds_read_b64_tr_b16 v[34:35], v58 offset:14848
    v_mfma_f32_32x32x16_bf16 v[16:31], v[44:47], v[108:111], v[16:31]
    ds_read_b64_tr_b16 v[36:37], v59 offset:14336
    ds_read_b64_tr_b16 v[38:39], v59 offset:14848
    s_waitcnt vmcnt(7) lgkmcnt(4)
    v_mfma_f32_32x32x16_bf16 v[0:15], v[48:51], v[112:115], v[0:15]
    s_add_u32 s38, s36, s37
    buffer_load_dwordx4 v[108:111], v253, s[20:23], s38 offen offset:0 sc1
    ds_read_b64_tr_b16 v[40:41], v58 offset:16384
    ds_read_b64_tr_b16 v[42:43], v58 offset:16896
    v_mfma_f32_32x32x16_bf16 v[16:31], v[52:55], v[112:115], v[16:31]
    ds_read_b64_tr_b16 v[44:45], v59 offset:16384
    ds_read_b64_tr_b16 v[46:47], v59 offset:16896
    s_waitcnt vmcnt(7) lgkmcnt(4)
    v_mfma_f32_32x32x16_bf16 v[0:15], v[32:35], v[116:119], v[0:15]
    s_add_u32 s37, s37, 2048
    s_and_b32 s37, s37, 0x7800
    buffer_load_dwordx4 v[112:115], v253, s[20:23], s38 offen offset:1024 sc1
    ds_read_b64_tr_b16 v[48:49], v58 offset:18432
    ds_read_b64_tr_b16 v[50:51], v58 offset:18944
    v_mfma_f32_32x32x16_bf16 v[16:31], v[36:39], v[116:119], v[16:31]
    ds_read_b64_tr_b16 v[52:53], v59 offset:18432
    ds_read_b64_tr_b16 v[54:55], v59 offset:18944
    s_waitcnt vmcnt(7) lgkmcnt(4)
    v_mfma_f32_32x32x16_bf16 v[0:15], v[40:43], v[120:123], v[0:15]
    s_add_u32 s38, s36, s37
    buffer_load_dwordx4 v[116:119], v253, s[20:23], s38 offen offset:0 sc1
    ds_read_b64_tr_b16 v[32:33], v58 offset:20480
    ds_read_b64_tr_b16 v[34:35], v58 offset:20992
    v_mfma_f32_32x32x16_bf16 v[16:31], v[44:47], v[120:123], v[16:31]
    ds_read_b64_tr_b16 v[36:37], v59 offset:20480
    ds_read_b64_tr_b16 v[38:39], v59 offset:20992
    s_waitcnt vmcnt(7) lgkmcnt(4)
    v_mfma_f32_32x32x16_bf16 v[0:15], v[48:51], v[124:127], v[0:15]
    s_add_u32 s37, s37, 2048
    s_and_b32 s37, s37, 0x7800
    buffer_load_dwordx4 v[120:123], v253, s[20:23], s38 offen offset:1024 sc1
    ds_read_b64_tr_b16 v[40:41], v58 offset:22528
    ds_read_b64_tr_b16 v[42:43], v58 offset:23040
    v_mfma_f32_32x32x16_bf16 v[16:31], v[52:55], v[124:127], v[16:31]
    ds_read_b64_tr_b16 v[44:45], v59 offset:22528
    ds_read_b64_tr_b16 v[46:47], v59 offset:23040
    s_waitcnt vmcnt(7) lgkmcnt(4)
    v_mfma_f32_32x32x16_bf16 v[0:15], v[32:35], v[128:131], v[0:15]
    s_add_u32 s38, s36, s37
    buffer_load_dwordx4 v[124:127], v253, s[20:23], s38 offen offset:0 sc1
    ds_read_b64_tr_b16 v[48:49], v58 offset:24576
    ds_read_b64_tr_b16 v[50:51], v58 offset:25088
    v_mfma_f32_32x32x16_bf16 v[16:31], v[36:39], v[128:131], v[16:31]
    ds_read_b64_tr_b16 v[52:53], v59 offset:24576
    ds_read_b64_tr_b16 v[54:55], v59 offset:25088
    s_waitcnt vmcnt(7) lgkmcnt(4)
    v_mfma_f32_32x32x16_bf16 v[0:15], v[40:43], v[132:135], v[0:15]
    s_add_u32 s37, s37, 2048
    s_and_b32 s37, s37, 0x7800
    buffer_load_dwordx4 v[128:131], v253, s[20:23], s38 offen offset:1024 sc1
    ds_read_b64_tr_b16 v[32:33], v58 offset:26624
    ds_read_b64_tr_b16 v[34:35], v58 offset:27136
    v_mfma_f32_32x32x16_bf16 v[16:31], v[44:47], v[132:135], v[16:31]
    ds_read_b64_tr_b16 v[36:37], v59 offset:26624
    ds_read_b64_tr_b16 v[38:39], v59 offset:27136
    s_waitcnt vmcnt(7) lgkmcnt(4)
    v_mfma_f32_32x32x16_bf16 v[0:15], v[48:51], v[136:139], v[0:15]
    s_add_u32 s38, s36, s37
    buffer_load_dwordx4 v[132:135], v253, s[20:23], s38 offen offset:0 sc1
    ds_read_b64_tr_b16 v[40:41], v58 offset:28672
    ds_read_b64_tr_b16 v[42:43], v58 offset:29184
    v_mfma_f32_32x32x16_bf16 v[16:31], v[52:55], v[136:139], v[16:31]
    ds_read_b64_tr_b16 v[44:45], v59 offset:28672
    ds_read_b64_tr_b16 v[46:47], v59 offset:29184
    s_waitcnt vmcnt(7) lgkmcnt(4)
    v_mfma_f32_32x32x16_bf16 v[0:15], v[32:35], v[104:107], v[0:15]
    s_add_u32 s37, s37, 2048
    s_and_b32 s37, s37, 0x7800
    buffer_load_dwordx4 v[136:139], v253, s[20:23], s38 offen offset:1024 sc1
    ds_read_b64_tr_b16 v[48:49], v58 offset:30720
    ds_read_b64_tr_b16 v[50:51], v58 offset:31232
    v_mfma_f32_32x32x16_bf16 v[16:31], v[36:39], v[104:107], v[16:31]
    ds_read_b64_tr_b16 v[52:53], v59 offset:30720
    ds_read_b64_tr_b16 v[54:55], v59 offset:31232
    s_waitcnt vmcnt(7) lgkmcnt(4)
    v_mfma_f32_32x32x16_bf16 v[0:15], v[40:43], v[108:111], v[0:15]
    s_add_u32 s38, s36, s37
    buffer_load_dwordx4 v[104:107], v253, s[20:23], s38 offen offset:0 sc1
    ds_read_b64_tr_b16 v[32:33], v58 offset:32768
    ds_read_b64_tr_b16 v[34:35], v58 offset:33280
    v_mfma_f32_32x32x16_bf16 v[16:31], v[44:47], v[108:111], v[16:31]
    ds_read_b64_tr_b16 v[36:37], v59 offset:32768
    ds_read_b64_tr_b16 v[38:39], v59 offset:33280
    s_waitcnt vmcnt(7) lgkmcnt(4)
    v_mfma_f32_32x32x16_bf16 v[0:15], v[48:51], v[112:115], v[0:15]
    s_add_u32 s37, s37, 2048
    s_and_b32 s37, s37, 0x7800
    buffer_load_dwordx4 v[108:111], v253, s[20:23], s38 offen offset:1024 sc1
    ds_read_b64_tr_b16 v[40:41], v58 offset:34816
    ds_read_b64_tr_b16 v[42:43], v58 offset:35328
    v_mfma_f32_32x32x16_bf16 v[16:31], v[52:55], v[112:115], v[16:31]
    ds_read_b64_tr_b16 v[44:45], v59 offset:34816
    ds_read_b64_tr_b16 v[46:47], v59 offset:35328
    s_waitcnt vmcnt(7) lgkmcnt(4)
    v_mfma_f32_32x32x16_bf16 v[0:15], v[32:35], v[116:119], v[0:15]
    s_add_u32 s38, s36, s37
    buffer_load_dwordx4 v[112:115], v253, s[20:23], s38 offen offset:0 sc1
    ds_read_b64_tr_b16 v[48:49], v58 offset:36864
    ds_read_b64_tr_b16 v[50:51], v58 offset:37376
    v_mfma_f32_32x32x16_bf16 v[16:31], v[36:39], v[116:119], v[16:31]
    ds_read_b64_tr_b16 v[52:53], v59 offset:36864
    ds_read_b64_tr_b16 v[54:55], v59 offset:37376
    s_waitcnt vmcnt(7) lgkmcnt(4)
    v_mfma_f32_32x32x16_bf16 v[0:15], v[40:43], v[120:123], v[0:15]
    s_add_u32 s37, s37, 2048
    s_and_b32 s37, s37, 0x7800
    buffer_load_dwordx4 v[116:119], v253, s[20:23], s38 offen offset:1024 sc1
    ds_read_b64_tr_b16 v[32:33], v58 offset:38912
    ds_read_b64_tr_b16 v[34:35], v58 offset:39424
    v_mfma_f32_32x32x16_bf16 v[16:31], v[44:47], v[120:123], v[16:31]
    ds_read_b64_tr_b16 v[36:37], v59 offset:38912
    ds_read_b64_tr_b16 v[38:39], v59 offset:39424
    s_waitcnt vmcnt(7) lgkmcnt(4)
    v_mfma_f32_32x32x16_bf16 v[0:15], v[48:51], v[124:127], v[0:15]
    s_add_u32 s38, s36, s37
    buffer_load_dwordx4 v[120:123], v253, s[20:23], s38 offen offset:0 sc1
    ds_read_b64_tr_b16 v[40:41], v58 offset:40960
    ds_read_b64_tr_b16 v[42:43], v58 offset:41472
    v_mfma_f32_32x32x16_bf16 v[16:31], v[52:55], v[124:127], v[16:31]
    ds_read_b64_tr_b16 v[44:45], v59 offset:40960
    ds_read_b64_tr_b16 v[46:47], v59 offset:41472
    s_waitcnt vmcnt(7) lgkmcnt(4)
    v_mfma_f32_32x32x16_bf16 v[0:15], v[32:35], v[128:131], v[0:15]
    s_add_u32 s37, s37, 2048
    s_and_b32 s37, s37, 0x7800
    buffer_load_dwordx4 v[124:127], v253, s[20:23], s38 offen offset:1024 sc1
    ds_read_b64_tr_b16 v[48:49], v58 offset:43008
    ds_read_b64_tr_b16 v[50:51], v58 offset:43520
    v_mfma_f32_32x32x16_bf16 v[16:31], v[36:39], v[128:131], v[16:31]
    ds_read_b64_tr_b16 v[52:53], v59 offset:43008
    ds_read_b64_tr_b16 v[54:55], v59 offset:43520
    s_waitcnt vmcnt(7) lgkmcnt(4)
    v_mfma_f32_32x32x16_bf16 v[0:15], v[40:43], v[132:135], v[0:15]
    s_add_u32 s38, s36, s37
    buffer_load_dwordx4 v[128:131], v253, s[20:23], s38 offen offset:0 sc1
    ds_read_b64_tr_b16 v[32:33], v58 offset:45056
    ds_read_b64_tr_b16 v[34:35], v58 offset:45568
    v_mfma_f32_32x32x16_bf16 v[16:31], v[44:47], v[132:135], v[16:31]
    ds_read_b64_tr_b16 v[36:37], v59 offset:45056
    ds_read_b64_tr_b16 v[38:39], v59 offset:45568
    s_waitcnt vmcnt(7) lgkmcnt(4)
    v_mfma_f32_32x32x16_bf16 v[0:15], v[48:51], v[136:139], v[0:15]
    s_add_u32 s37, s37, 2048
    s_and_b32 s37, s37, 0x7800
    buffer_load_dwordx4 v[132:135], v253, s[20:23], s38 offen offset:1024 sc1
    ds_read_b64_tr_b16 v[40:41], v58 offset:47104
    ds_read_b64_tr_b16 v[42:43], v58 offset:47616
    v_mfma_f32_32x32x16_bf16 v[16:31], v[52:55], v[136:139], v[16:31]
    ds_read_b64_tr_b16 v[44:45], v59 offset:47104
    ds_read_b64_tr_b16 v[46:47], v59 offset:47616
    s_barrier
    s_waitcnt vmcnt(7) lgkmcnt(4)
    v_mfma_f32_32x32x16_bf16 v[0:15], v[32:35], v[104:107], v[0:15]
    s_add_u32 s38, s36, s37
    buffer_load_dwordx4 v[136:139], v253, s[20:23], s38 offen offset:0 sc1
    ds_read_b64_tr_b16 v[48:49], v58 offset:49152
    ds_read_b64_tr_b16 v[50:51], v58 offset:49664
    v_mfma_f32_32x32x16_bf16 v[16:31], v[36:39], v[104:107], v[16:31]
    ds_read_b64_tr_b16 v[52:53], v59 offset:49152
    ds_read_b64_tr_b16 v[54:55], v59 offset:49664
    s_waitcnt vmcnt(7) lgkmcnt(4)
    v_mfma_f32_32x32x16_bf16 v[0:15], v[40:43], v[108:111], v[0:15]
    s_add_u32 s37, s37, 2048
    s_and_b32 s37, s37, 0x7800
    buffer_load_dwordx4 v[104:107], v253, s[20:23], s38 offen offset:1024 sc1
    ds_read_b64_tr_b16 v[32:33], v58 offset:51200
    ds_read_b64_tr_b16 v[34:35], v58 offset:51712
    v_mfma_f32_32x32x16_bf16 v[16:31], v[44:47], v[108:111], v[16:31]
    ds_read_b64_tr_b16 v[36:37], v59 offset:51200
    ds_read_b64_tr_b16 v[38:39], v59 offset:51712
    s_waitcnt vmcnt(7) lgkmcnt(4)
    v_mfma_f32_32x32x16_bf16 v[0:15], v[48:51], v[112:115], v[0:15]
    ds_read_b64_tr_b16 v[40:41], v58 offset:53248
    ds_read_b64_tr_b16 v[42:43], v58 offset:53760
    v_mfma_f32_32x32x16_bf16 v[16:31], v[52:55], v[112:115], v[16:31]
    ds_read_b64_tr_b16 v[44:45], v59 offset:53248
    ds_read_b64_tr_b16 v[46:47], v59 offset:53760
    s_waitcnt vmcnt(6) lgkmcnt(4)
    v_mfma_f32_32x32x16_bf16 v[0:15], v[32:35], v[116:119], v[0:15]
    ds_read_b64_tr_b16 v[48:49], v58 offset:55296
    ds_read_b64_tr_b16 v[50:51], v58 offset:55808
    v_mfma_f32_32x32x16_bf16 v[16:31], v[36:39], v[116:119], v[16:31]
    ds_read_b64_tr_b16 v[52:53], v59 offset:55296
    ds_read_b64_tr_b16 v[54:55], v59 offset:55808
    s_waitcnt vmcnt(5) lgkmcnt(4)
    v_mfma_f32_32x32x16_bf16 v[0:15], v[40:43], v[120:123], v[0:15]
    ds_read_b64_tr_b16 v[32:33], v58 offset:57344
    ds_read_b64_tr_b16 v[34:35], v58 offset:57856
    v_mfma_f32_32x32x16_bf16 v[16:31], v[44:47], v[120:123], v[16:31]
    ds_read_b64_tr_b16 v[36:37], v59 offset:57344
    ds_read_b64_tr_b16 v[38:39], v59 offset:57856
    s_waitcnt vmcnt(4) lgkmcnt(4)
    v_mfma_f32_32x32x16_bf16 v[0:15], v[48:51], v[124:127], v[0:15]
    ds_read_b64_tr_b16 v[40:41], v58 offset:59392
    ds_read_b64_tr_b16 v[42:43], v58 offset:59904
    v_mfma_f32_32x32x16_bf16 v[16:31], v[52:55], v[124:127], v[16:31]
    ds_read_b64_tr_b16 v[44:45], v59 offset:59392
    ds_read_b64_tr_b16 v[46:47], v59 offset:59904
    s_waitcnt vmcnt(3) lgkmcnt(4)
    v_mfma_f32_32x32x16_bf16 v[0:15], v[32:35], v[128:131], v[0:15]
    ds_read_b64_tr_b16 v[48:49], v58 offset:61440
    ds_read_b64_tr_b16 v[50:51], v58 offset:61952
    v_mfma_f32_32x32x16_bf16 v[16:31], v[36:39], v[128:131], v[16:31]
    ds_read_b64_tr_b16 v[52:53], v59 offset:61440
    ds_read_b64_tr_b16 v[54:55], v59 offset:61952
    s_waitcnt vmcnt(2) lgkmcnt(4)
    v_mfma_f32_32x32x16_bf16 v[0:15], v[40:43], v[132:135], v[0:15]
    ds_read_b64_tr_b16 v[32:33], v58 offset:63488
    ds_read_b64_tr_b16 v[34:35], v58 offset:64000
    v_mfma_f32_32x32x16_bf16 v[16:31], v[44:47], v[132:135], v[16:31]
    ds_read_b64_tr_b16 v[36:37], v59 offset:63488
    ds_read_b64_tr_b16 v[38:39], v59 offset:64000
    s_waitcnt vmcnt(1) lgkmcnt(4)
    v_mfma_f32_32x32x16_bf16 v[0:15], v[48:51], v[136:139], v[0:15]
    v_mfma_f32_32x32x16_bf16 v[16:31], v[52:55], v[136:139], v[16:31]
    s_waitcnt vmcnt(0) lgkmcnt(0)
    v_mfma_f32_32x32x16_bf16 v[0:15], v[32:35], v[104:107], v[0:15]
    v_mfma_f32_32x32x16_bf16 v[16:31], v[36:39], v[104:107], v[16:31]
    s_lshl_b32 s35, s24, 4
    s_add_u32 s35, s35, s98
    s_lshl_b32 s35, s35, 14
    s_lshl_b32 s34, s3, 12
    s_add_u32 s35, s35, s34
    s_add_u32 s35, s35, 0x2000000
    s_lshl_b32 s30, s99, 13
    s_add_u32 s30, s30, s26
    s_add_u32 s30, s30, 0xc00000
    s_lshl_b32 s31, s98, 9
    s_add_u32 s31, s31, s30
    v_mov_b32 v96, 0
    v_mov_b32 v97, 0
    v_mov_b32 v98, 0
    v_mov_b32 v99, v242
    v_cvt_pk_bf16_f32 v208, v0, v1
    v_cvt_pk_bf16_f32 v209, v2, v3
    v_cvt_pk_bf16_f32 v210, v4, v5
    v_cvt_pk_bf16_f32 v211, v6, v7
    v_cvt_pk_bf16_f32 v212, v8, v9
    v_cvt_pk_bf16_f32 v213, v10, v11
    v_cvt_pk_bf16_f32 v214, v12, v13
    v_cvt_pk_bf16_f32 v215, v14, v15
    v_cvt_pk_bf16_f32 v216, v16, v17
    v_cvt_pk_bf16_f32 v217, v18, v19
    v_cvt_pk_bf16_f32 v218, v20, v21
    v_cvt_pk_bf16_f32 v219, v22, v23
    v_cvt_pk_bf16_f32 v220, v24, v25
    v_cvt_pk_bf16_f32 v221, v26, v27
    v_cvt_pk_bf16_f32 v222, v28, v29
    v_cvt_pk_bf16_f32 v223, v30, v31
    s_cmp_lg_u32 s26, 0
    s_cbranch_scc1 sk_30
    s_cmp_lg_u32 s77, 0
    s_cbranch_scc1 lc_31
    buffer_store_dwordx4 v[208:211], v100, s[20:23], s35 offen offset:0 sc1
    buffer_store_dwordx4 v[212:215], v100, s[20:23], s35 offen offset:512 sc1
    buffer_store_dwordx4 v[216:219], v100, s[20:23], s35 offen offset:1024 sc1
    buffer_store_dwordx4 v[220:223], v100, s[20:23], s35 offen offset:1536 sc1
    s_branch lc_32
lc_31:
    buffer_store_dwordx4 v[208:211], v100, s[20:23], s35 offen offset:0
    buffer_store_dwordx4 v[212:215], v100, s[20:23], s35 offen offset:512
    buffer_store_dwordx4 v[216:219], v100, s[20:23], s35 offen offset:1024
    buffer_store_dwordx4 v[220:223], v100, s[20:23], s35 offen offset:1536
lc_32:
    ds_write_b128 v101, v[208:211] offset:0
    ds_write_b128 v101, v[212:215] offset:512
    ds_write_b128 v101, v[216:219] offset:1024
    ds_write_b128 v101, v[220:223] offset:1536
sk_30:
    v_dot2c_f32_bf16 v96, 0x3f803f80, v208
    v_dot2c_f32_bf16 v97, v208, v208
    v_dot2c_f32_bf16 v98, v224, v208
    v_dot2c_f32_bf16 v96, 0x3f803f80, v209
    v_dot2c_f32_bf16 v97, v209, v209
    v_dot2c_f32_bf16 v98, v225, v209
    v_dot2c_f32_bf16 v96, 0x3f803f80, v210
    v_dot2c_f32_bf16 v97, v210, v210
    v_dot2c_f32_bf16 v98, v226, v210
    v_dot2c_f32_bf16 v96, 0x3f803f80, v211
    v_dot2c_f32_bf16 v97, v211, v211
    v_dot2c_f32_bf16 v98, v227, v211
    v_dot2c_f32_bf16 v96, 0x3f803f80, v212
    v_dot2c_f32_bf16 v97, v212, v212
    v_dot2c_f32_bf16 v98, v228, v212
    v_dot2c_f32_bf16 v96, 0x3f803f80, v213
    v_dot2c_f32_bf16 v97, v213, v213
    v_dot2c_f32_bf16 v98, v229, v213
    v_dot2c_f32_bf16 v96, 0x3f803f80, v214
    v_dot2c_f32_bf16 v97, v214, v214
    v_dot2c_f32_bf16 v98, v230, v214
    v_dot2c_f32_bf16 v96, 0x3f803f80, v215
    v_dot2c_f32_bf16 v97, v215, v215
    v_dot2c_f32_bf16 v98, v231, v215
    v_dot2c_f32_bf16 v96, 0x3f803f80, v216
    v_dot2c_f32_bf16 v97, v216, v216
    v_dot2c_f32_bf16 v98, v232, v216
    v_dot2c_f32_bf16 v96, 0x3f803f80, v217
    v_dot2c_f32_bf16 v97, v217, v217
    v_dot2c_f32_bf16 v98, v233, v217
    v_dot2c_f32_bf16 v96, 0x3f803f80, v218
    v_dot2c_f32_bf16 v97, v218, v218
    v_dot2c_f32_bf16 v98, v234, v218
    v_dot2c_f32_bf16 v96, 0x3f803f80, v219
    v_dot2c_f32_bf16 v97, v219, v219
    v_dot2c_f32_bf16 v98, v235, v219
    v_dot2c_f32_bf16 v96, 0x3f803f80, v220
    v_dot2c_f32_bf16 v97, v220, v220
    v_dot2c_f32_bf16 v98, v236, v220
    v_dot2c_f32_bf16 v96, 0x3f803f80, v221
    v_dot2c_f32_bf16 v97, v221, v221
    v_dot2c_f32_bf16 v98, v237, v221
    v_dot2c_f32_bf16 v96, 0x3f803f80, v222
    v_dot2c_f32_bf16 v97, v222, v222
    v_dot2c_f32_bf16 v98, v238, v222
    v_dot2c_f32_bf16 v96, 0x3f803f80, v223
    v_dot2c_f32_bf16 v97, v223, v223
    v_dot2c_f32_bf16 v98, v239, v223
    s_nop 0
    v_mov_b32 v48, v96
    v_mov_b32 v49, v97
    v_mov_b32 v50, v98
    v_mov_b32 v51, v99
    v_permlane32_swap_b32 v96, v48
    v_permlane32_swap_b32 v97, v49
    v_permlane32_swap_b32 v98, v50
    v_permlane32_swap_b32 v99, v51
    v_add_f32 v96, v96, v48
    v_add_f32 v97, v97, v49
    v_add_f32 v98, v98, v50
    v_add_f32 v99, v99, v51
    s_mov_b32 exec_hi, 0
    s_waitcnt vmcnt(0)
    s_cmp_lg_u32 s77, 0
    s_cbranch_scc1 lc_33
    buffer_store_dwordx4 v[96:99], v253, s[20:23], s31 offen sc1
    s_branch lc_34
lc_33:
    buffer_store_dwordx4 v[96:99], v253, s[20:23], s31 offen
lc_34:
    s_mov_b64 exec, -1
    s_cmp_lg_u32 s26, 0
    s_cbranch_scc1 e_final
    s_mov_b32 s26, 16777216
    s_and_b32 s30, s3, 1
    s_lshl_b32 s30, s30, 13
    v_add_u32 v176, s30, v253
    v_add_u32 v177, 1024, v176
    s_lshr_b32 s30, s16, 7
    s_sub_u32 s30, 3, s30
    s_and_b32 s30, s30, 7
    s_and_b32 s31, s24, 1
    s_lshl_b32 s31, s31, 3
    s_add_u32 s30, s30, s31
    s_and_b32 s31, s24, 14
    s_add_u32 s84, s31, s30
    s_lshl_b32 s31, s25, 2
    s_add_u32 s31, s31, s28
    s_mul_i32 s31, s31, 6144
    s_lshl_b32 s30, s30, 7
    s_add_u32 s30, s30, s31
    v_min_u32 v190, 2, v252
    v_lshl_add_u32 v190, v190, 11, s30
    s_add_u32 s84, s84, 14
    v_mov_b32 v0, 0
    v_mov_b32 v1, 0
    v_mov_b32 v2, 0
    v_mov_b32 v3, 0
    v_mov_b32 v4, 0
    v_mov_b32 v5, 0
    v_mov_b32 v6, 0
    v_mov_b32 v7, 0
    v_mov_b32 v8, 0
    v_mov_b32 v9, 0
    v_mov_b32 v10, 0
    v_mov_b32 v11, 0
    v_mov_b32 v12, 0
    v_mov_b32 v13, 0
    v_mov_b32 v14, 0
    v_mov_b32 v15, 0
    v_mov_b32 v16, 0
    v_mov_b32 v17, 0
    v_mov_b32 v18, 0
    v_mov_b32 v19, 0
    v_mov_b32 v20, 0
    v_mov_b32 v21, 0
    v_mov_b32 v22, 0
    v_mov_b32 v23, 0
    v_mov_b32 v24, 0
    v_mov_b32 v25, 0
    v_mov_b32 v26, 0
    v_mov_b32 v27, 0
    v_mov_b32 v28, 0
    v_mov_b32 v29, 0
    v_mov_b32 v30, 0
    v_mov_b32 v31, 0
    v_mov_b32 v32, 0
    v_mov_b32 v33, 0
    v_mov_b32 v34, 0
    v_mov_b32 v35, 0
    v_mov_b32 v36, 0
    v_mov_b32 v37, 0
    v_mov_b32 v38, 0
    v_mov_b32 v39, 0
    v_mov_b32 v40, 0
    v_mov_b32 v41, 0
    v_mov_b32 v42, 0
    v_mov_b32 v43, 0
    v_mov_b32 v44, 0
    v_mov_b32 v45, 0
    v_mov_b32 v46, 0
    v_mov_b32 v47, 0
    v_mov_b32 v48, 0
    v_mov_b32 v49, 0
    v_mov_b32 v50, 0
    v_mov_b32 v51, 0
    v_mov_b32 v52, 0
    v_mov_b32 v53, 0
    v_mov_b32 v54, 0
    v_mov_b32 v55, 0
    v_mov_b32 v56, 0
    v_mov_b32 v57, 0
    v_mov_b32 v58, 0
    v_mov_b32 v59, 0
    v_mov_b32 v60, 0
    v_mov_b32 v61, 0
    v_mov_b32 v62, 0
    v_mov_b32 v63, 0
    v_mov_b32 v64, 0
    v_mov_b32 v65, 0
    v_mov_b32 v66, 0
    v_mov_b32 v67, 0
    v_mov_b32 v68, 0
    v_mov_b32 v69, 0
    v_mov_b32 v70, 0
    v_mov_b32 v71, 0
    v_mov_b32 v72, 0
    v_mov_b32 v73, 0
    v_mov_b32 v74, 0
    v_mov_b32 v75, 0
    v_mov_b32 v76, 0
    v_mov_b32 v77, 0
    v_mov_b32 v78, 0
    v_mov_b32 v79, 0
    v_mov_b32 v80, 0
    v_mov_b32 v81, 0
    v_mov_b32 v82, 0
    v_mov_b32 v83, 0
    v_mov_b32 v84, 0
    v_mov_b32 v85, 0
    v_mov_b32 v86, 0
    v_mov_b32 v87, 0
    v_mov_b32 v88, 0
    v_mov_b32 v89, 0
    v_mov_b32 v90, 0
    v_mov_b32 v91, 0
    v_mov_b32 v92, 0
    v_mov_b32 v93, 0
    v_mov_b32 v94, 0
    v_mov_b32 v95, 0
    s_waitcnt lgkmcnt(0)
    s_branch e_q
e_arr:
    s_mov_b64 exec, 3
    s_mov_b32 s89, 0xdd9000
    buffer_store_dwordx2 v[250:251], v249, s[20:23], s89 offen sc1
    s_mov_b64 exec, -1
    s_branch e_arr_ret
e_final:
    s_mov_b32 s78, s27
pl_35:
    s_lshl_b32 s30, s99, 13
    s_add_u32 s30, s30, 0x1c00000
    s_add_u32 s31, s30, 4096
    buffer_load_dwordx4 v[64:67], v253, s[20:23], s30 offen offset:0 sc1
    buffer_load_dwordx4 v[68:71], v253, s[20:23], s30 offen offset:1024 sc1
    buffer_load_dwordx4 v[72:75], v253, s[20:23], s30 offen offset:2048 sc1
    buffer_load_dwordx4 v[76:79], v253, s[20:23], s30 offen offset:3072 sc1
    buffer_load_dwordx4 v[80:83], v253, s[20:23], s31 offen offset:0 sc1
    buffer_load_dwordx4 v[84:87], v253, s[20:23], s31 offen offset:1024 sc1
    buffer_load_dwordx4 v[88:91], v253, s[20:23], s31 offen offset:2048 sc1
    buffer_load_dwordx4 v[92:95], v253, s[20:23], s31 offen offset:3072 sc1
    s_waitcnt vmcnt(0)
pc_36:
    v_max3_u32 v48, v64, v65, v66
    v_max3_u32 v48, v48, v67, v68
    v_max3_u32 v48, v48, v69, v70
    v_max3_u32 v48, v48, v71, v72
    v_max3_u32 v48, v48, v73, v74
    v_max3_u32 v48, v48, v75, v76
    v_max3_u32 v48, v48, v77, v78
    v_max3_u32 v48, v48, v79, v80
    v_max3_u32 v48, v48, v81, v82
    v_max3_u32 v48, v48, v83, v84
    v_max3_u32 v48, v48, v85, v86
    v_max3_u32 v48, v48, v87, v88
    v_max3_u32 v48, v48, v89, v90
    v_max3_u32 v48, v48, v91, v92
    v_max3_u32 v48, v48, v93, v94
    v_max_u32 v48, v48, v95
    v_cmp_eq_u32 vcc, -1, v48
    s_cbranch_vccz pd_37
    s_sub_u32 s78, s78, 1
    s_cmp_lg_u32 s78, 0
    s_cbranch_scc1 pl_35
    s_mov_b32 s27, 1
pd_37:
    v_pk_add_f32 v[64:65], v[64:65], v[68:69]
    v_pk_add_f32 v[66:67], v[66:67], v[70:71]
    v_pk_add_f32 v[64:65], v[64:65], v[72:73]
    v_pk_add_f32 v[66:67], v[66:67], v[74:75]
    v_pk_add_f32 v[64:65], v[64:65], v[76:77]
    v_pk_add_f32 v[66:67], v[66:67], v[78:79]
    v_pk_add_f32 v[64:65], v[64:65], v[80:81]
    v_pk_add_f32 v[66:67], v[66:67], v[82:83]
    v_pk_add_f32 v[64:65], v[64:65], v[84:85]
    v_pk_add_f32 v[66:67], v[66:67], v[86:87]
    v_pk_add_f32 v[64:65], v[64:65], v[88:89]
    v_pk_add_f32 v[66:67], v[66:67], v[90:91]
    v_pk_add_f32 v[64:65], v[64:65], v[92:93]
    v_pk_add_f32 v[66:67], v[66:67], v[94:95]
    v_mov_b32 v48, v64
    v_mov_b32 v49, v65
    v_mov_b32 v50, v66
    v_mov_b32 v51, v67
    v_permlane32_swap_b32 v64, v48
    v_permlane32_swap_b32 v65, v49
    v_permlane32_swap_b32 v66, v50
    v_permlane32_swap_b32 v67, v51
    v_add_f32 v64, v64, v48
    v_add_f32 v65, v65, v49
    v_add_f32 v66, v66, v50
    v_add_f32 v67, v67, v51
    v_mul_f32 v54, 0x3a800000, v64
    v_mul_f32 v65, 0x3a800000, v65
    v_fma_f32 v65, -v54, v54, v65
    v_max_f32 v65, 0, v65
    v_add_f32 v55, 0x3727c5ac, v65
    v_rsq_f32 v55, v55
    v_fma_f32 v52, -v54, v67, v66
    v_and_b32 v53, 31, v252
    v_mul_f32 v52, v52, v55
    s_lshl_b32 s32, s99, 5
    v_add_u32 v53, s32, v53
    v_mov_b32 v48, v52
    s_nop 1
    v_max_f32_dpp v48, v48, v48 quad_perm:[1,0,3,2] row_mask:0xf bank_mask:0xf
    s_nop 1
    v_max_f32_dpp v48, v48, v48 quad_perm:[2,3,0,1] row_mask:0xf bank_mask:0xf
    s_nop 1
    v_max_f32_dpp v48, v48, v48 row_half_mirror row_mask:0xf bank_mask:0xf
    s_nop 1
    v_max_f32_dpp v48, v48, v48 row_mirror row_mask:0xf bank_mask:0xf
    v_mov_b32 v49, v48
    s_nop 1
    v_permlane16_swap_b32 v48, v49
    v_max_f32 v48, v48, v49
    v_cmp_eq_f32 vcc, v48, v52
    v_lshrrev_b32 v50, 5, v252
    v_lshlrev_b32 v50, 4, v50
    s_lshl_b32 s32, s99, 11
    s_lshl_b32 s33, s98, 7
    s_add_u32 s32, s32, s33
    s_add_u32 s32, s32, 0x1d60000
    s_lshl_b32 s34, s99, 4
    s_add_u32 s34, s34, 0x1dc0000
    s_ff1_i32_b32 s35, vcc_lo
    s_lshl_b32 s35, 1, s35
    s_cmp_eq_u32 s25, 0
    s_cselect_b32 exec_lo, s35, 0
    s_mov_b32 exec_hi, 0
    buffer_store_dwordx4 v[52:55], v50, s[20:23], s34 offen sc1
    s_mov_b32 exec_lo, s35
    s_mov_b32 exec_hi, s35
    buffer_store_dwordx4 v[208:211], v50, s[20:23], s32 offen offset:0 sc1
    buffer_store_dwordx4 v[212:215], v50, s[20:23], s32 offen offset:32 sc1
    buffer_store_dwordx4 v[216:219], v50, s[20:23], s32 offen offset:64 sc1
    buffer_store_dwordx4 v[220:223], v50, s[20:23], s32 offen offset:96 sc1
    s_mov_b64 exec, -1
    v_add_f32 v240, 1.0, v55
    v_mul_f32 v241, v54, v55
    v_sub_f32 v241, 0, v241
    v_pk_fma_f32 v[0:1], v[0:1], v[240:241], v[240:241] op_sel:[0,0,1] op_sel_hi:[1,0,1]
    v_pk_fma_f32 v[2:3], v[2:3], v[240:241], v[240:241] op_sel:[0,0,1] op_sel_hi:[1,0,1]
    v_pk_fma_f32 v[4:5], v[4:5], v[240:241], v[240:241] op_sel:[0,0,1] op_sel_hi:[1,0,1]
    v_pk_fma_f32 v[6:7], v[6:7], v[240:241], v[240:241] op_sel:[0,0,1] op_sel_hi:[1,0,1]
    v_pk_fma_f32 v[8:9], v[8:9], v[240:241], v[240:241] op_sel:[0,0,1] op_sel_hi:[1,0,1]
    v_pk_fma_f32 v[10:11], v[10:11], v[240:241], v[240:241] op_sel:[0,0,1] op_sel_hi:[1,0,1]
    v_pk_fma_f32 v[12:13], v[12:13], v[240:241], v[240:241] op_sel:[0,0,1] op_sel_hi:[1,0,1]
    v_pk_fma_f32 v[14:15], v[14:15], v[240:241], v[240:241] op_sel:[0,0,1] op_sel_hi:[1,0,1]
    v_pk_fma_f32 v[16:17], v[16:17], v[240:241], v[240:241] op_sel:[0,0,1] op_sel_hi:[1,0,1]
    v_pk_fma_f32 v[18:19], v[18:19], v[240:241], v[240:241] op_sel:[0,0,1] op_sel_hi:[1,0,1]
    v_pk_fma_f32 v[20:21], v[20:21], v[240:241], v[240:241] op_sel:[0,0,1] op_sel_hi:[1,0,1]
    v_pk_fma_f32 v[22:23], v[22:23], v[240:241], v[240:241] op_sel:[0,0,1] op_sel_hi:[1,0,1]
    v_pk_fma_f32 v[24:25], v[24:25], v[240:241], v[240:241] op_sel:[0,0,1] op_sel_hi:[1,0,1]
    v_pk_fma_f32 v[26:27], v[26:27], v[240:241], v[240:241] op_sel:[0,0,1] op_sel_hi:[1,0,1]
    v_pk_fma_f32 v[28:29], v[28:29], v[240:241], v[240:241] op_sel:[0,0,1] op_sel_hi:[1,0,1]
    v_pk_fma_f32 v[30:31], v[30:31], v[240:241], v[240:241] op_sel:[0,0,1] op_sel_hi:[1,0,1]
    v_cvt_pk_bf16_f32 v64, v0, v1
    v_cvt_pk_bf16_f32 v65, v2, v3
    v_cvt_pk_bf16_f32 v66, v4, v5
    v_cvt_pk_bf16_f32 v67, v6, v7
    v_cvt_pk_bf16_f32 v68, v8, v9
    v_cvt_pk_bf16_f32 v69, v10, v11
    v_cvt_pk_bf16_f32 v70, v12, v13
    v_cvt_pk_bf16_f32 v71, v14, v15
    v_cvt_pk_bf16_f32 v72, v16, v17
    v_cvt_pk_bf16_f32 v73, v18, v19
    v_cvt_pk_bf16_f32 v74, v20, v21
    v_cvt_pk_bf16_f32 v75, v22, v23
    v_cvt_pk_bf16_f32 v76, v24, v25
    v_cvt_pk_bf16_f32 v77, v26, v27
    v_cvt_pk_bf16_f32 v78, v28, v29
    v_cvt_pk_bf16_f32 v79, v30, v31
    v_permlane32_swap_b32 v64, v66
    v_permlane32_swap_b32 v65, v67
    v_permlane32_swap_b32 v68, v70
    v_permlane32_swap_b32 v69, v71
    v_permlane32_swap_b32 v72, v74
    v_permlane32_swap_b32 v73, v75
    v_permlane32_swap_b32 v76, v78
    v_permlane32_swap_b32 v77, v79
    v_lshl_add_u32 v50, v53, 11, v50
    s_mov_b32 s79, s26
    s_cmp_lg_u32 s3, 0
    s_cbranch_scc1 sk_39
    s_mov_b32 s78, s27
pl_40:
    s_add_u32 s32, s79, 0xdc0000
    buffer_load_dwordx4 v[0:3], v253, s[20:23], s32 offen sc1
    s_waitcnt vmcnt(0)
pc_41:
    v_max3_u32 v4, v0, v1, v2
    v_max_u32 v4, v4, v3
    v_cmp_eq_u32 vcc, -1, v4
    s_cbranch_vccz pd_42
    s_sub_u32 s78, s78, 1
    s_cmp_lg_u32 s78, 0
    s_cbranch_scc1 pl_40
    s_mov_b32 s27, 1
pd_42:
    v_mov_b32 v4, v0
    s_nop 1
    v_max_f32_dpp v4, v4, v4 quad_perm:[1,0,3,2] row_mask:0xf bank_mask:0xf
    s_nop 1
    v_max_f32_dpp v4, v4, v4 quad_perm:[2,3,0,1] row_mask:0xf bank_mask:0xf
    s_nop 1
    v_max_f32_dpp v4, v4, v4 row_half_mirror row_mask:0xf bank_mask:0xf
    s_nop 1
    v_max_f32_dpp v4, v4, v4 row_mirror row_mask:0xf bank_mask:0xf
    v_mov_b32 v5, v4
    s_nop 1
    v_permlane16_swap_b32 v4, v5
    v_max_f32 v4, v4, v5
    v_mov_b32 v5, v4
    s_nop 1
    v_permlane32_swap_b32 v4, v5
    v_max_f32 v4, v4, v5
    v_cmp_eq_f32 vcc, v4, v0
    s_ff1_i32_b64 s32, vcc
    s_and_b32 s32, s32, 63
    s_lshl_b64 exec, 1, s32
    ds_write_b128 v189, v[0:3] offset:3072
    s_mov_b64 exec, -1
sk_39:
    s_waitcnt lgkmcnt(0)
    s_barrier
    ds_read_b32 v0, v189 offset:3076
    s_waitcnt lgkmcnt(0)
    v_and_b32 v0, 0x7ff, v0
    v_cmp_ne_u32 vcc, v0, v53
    s_mov_b64 exec, vcc
    buffer_store_dwordx4 v[64:67], v50, s[12:15], s33 offen offset:0
    buffer_store_dwordx4 v[68:71], v50, s[12:15], s33 offen offset:32
    buffer_store_dwordx4 v[72:75], v50, s[12:15], s33 offen offset:64
    buffer_store_dwordx4 v[76:79], v50, s[12:15], s33 offen offset:96
    s_mov_b64 exec, -1
    s_branch k_end
l_start:
    v_lshrrev_b32 v21, 3, v252
    v_lshrrev_b32 v20, 4, v252
    v_xor_b32 v20, v20, v252
    v_and_b32 v20, 7, v20
    v_lshlrev_b32 v20, 4, v20
    v_lshl_add_u32 v4, v21, 11, v20
    v_xor_b32 v5, 64, v4
    v_add_u32 v5, 15360, v5
    v_add_u32 v6, 30720, v4
    v_add_u32 v7, 30720, v5
    s_lshl_b32 s84, s99, 16
    s_lshl_b32 s85, s25, 7
    s_lshl_b32 s86, s28, 12
    s_mul_i32 s87, s28, 6144
    v_and_b32 v20, 4, v21
    v_add_u32 v20, v20, v21
    v_mul_u32_u24 v20, 6144, v20
    v_and_b32 v21, 6, v21
    v_xor_b32 v21, v21, v252
    v_and_b32 v21, 7, v21
    v_lshl_add_u32 v20, v21, 4, v20
    s_mul_i32 s32, s28, 3
    s_bfe_u32 s33, s32, 0x10001
    s_mul_i32 s33, s33, 196608
    s_and_b32 s34, s32, 1
    s_mul_i32 s34, s34, 24576
    s_add_u32 s33, s33, s34
    s_lshr_b32 s34, s32, 2
    s_lshl_b32 s34, s34, 11
    s_add_u32 s33, s33, s34
    v_add_u32 v8, s33, v20
    v_add_u32 v9, 97280, v8
    s_add_u32 s32, s32, 1
    s_bfe_u32 s33, s32, 0x10001
    s_mul_i32 s33, s33, 196608
    s_and_b32 s34, s32, 1
    s_mul_i32 s34, s34, 24576
    s_add_u32 s33, s33, s34
    s_lshr_b32 s34, s32, 2
    s_lshl_b32 s34, s34, 11
    s_add_u32 s33, s33, s34
    s_sub_u32 s33, s33, 2048
    v_add_u32 v10, s33, v20
    v_add_u32 v11, 97280, v10
    s_add_u32 s32, s32, 1
    s_bfe_u32 s33, s32, 0x10001
    s_mul_i32 s33, s33, 196608
    s_and_b32 s34, s32, 1
    s_mul_i32 s34, s34, 24576
    s_add_u32 s33, s33, s34
    s_lshr_b32 s34, s32, 2
    s_lshl_b32 s34, s34, 11
    s_add_u32 s33, s33, s34
    v_add_u32 v12, s33, v20
    v_add_u32 v13, 97280, v12
    s_waitcnt lgkmcnt(0)
    s_mov_b32 s88, 0xdd8000
    s_load_dword s88, s[20:21], s88
    s_mov_b64 s[16:17], s[6:7]
    s_mov_b32 s6, 0x400000
    s_mov_b32 s7, 0x20000
    s_add_u32 s96, s94, 0
    s_and_b32 s96, s96, 15
    s_lshl_b32 s97, s96, 7
    s_add_u32 s97, s97, s84
    s_add_u32 m0, s86, 147456
    s_nop 0
    buffer_load_dwordx4 v4, s[4:7], s97 offen offset:0 lds
    buffer_load_dwordx4 v5, s[4:7], s97 offen offset:1024 lds
    buffer_load_dwordx4 v6, s[4:7], s97 offen offset:2048 lds
    buffer_load_dwordx4 v7, s[4:7], s97 offen offset:3072 lds
    s_add_u32 s96, s94, 0
    s_and_b32 s96, s96, 15
    s_mul_i32 s96, s96, 393216
    s_add_u32 s96, s96, s85
    s_add_u32 m0, s87, 40960
    s_nop 0
    buffer_load_dwordx4 v8, s[16:19], s96 offen offset:0 lds
    buffer_load_dwordx4 v9, s[16:19], s96 offen offset:1024 lds
    buffer_load_dwordx4 v10, s[16:19], s96 offen offset:2048 lds
    buffer_load_dwordx4 v11, s[16:19], s96 offen offset:3072 lds
    s_mov_b32 s40, 0xffffffff
    s_mov_b32 s41, 0xfffffff0
    s_mov_b32 s42, 0xfffffffe
    s_mov_b32 s43, 0xffffffe0
    s_mov_b32 s44, 0xfffffffc
    s_mov_b32 s45, 0xffffffc0
    s_mov_b32 s46, 0xfffffff8
    s_mov_b32 s47, 0xffffff80
    s_mov_b32 s48, 0xffff0000
    s_mov_b32 s49, 0xfff00000
    s_mov_b32 s50, 0xfffe0000
    s_mov_b32 s51, 0xffe00000
    s_mov_b32 s52, 0xfffc0000
    s_mov_b32 s53, 0xffc00000
    s_mov_b32 s54, 0xfff80000
    s_mov_b32 s55, 0xff800000
    s_mov_b32 s56, 0xffffff00
    s_mov_b32 s57, 0xfffff000
    s_mov_b32 s58, 0xfffffe00
    s_mov_b32 s59, 0xffffe000
    s_mov_b32 s60, 0xfffffc00
    s_mov_b32 s61, 0xffffc000
    s_mov_b32 s62, 0xfffff800
    s_mov_b32 s63, 0xffff8000
    s_mov_b32 s64, 0xff000000
    s_mov_b32 s65, 0xf0000000
    s_mov_b32 s66, 0xfe000000
    s_mov_b32 s67, 0xe0000000
    s_mov_b32 s68, 0xfc000000
    s_mov_b32 s69, 0xc0000000
    s_mov_b32 s70, 0xf8000000
    s_mov_b32 s71, 0x80000000
    v_bfe_u32 v20, v252, 3, 2
    v_lshrrev_b32 v21, 5, v252
    v_lshl_add_u32 v20, v21, 3, v20
    s_lshr_b32 s32, s28, 1
    s_lshl_b32 s32, s32, 4
    s_and_b32 s33, s28, 1
    s_lshl_b32 s33, s33, 2
    s_add_u32 s32, s32, s33
    v_add_u32 v20, s32, v20
    v_lshlrev_b32 v20, 11, v20
    v_lshrrev_b32 v21, 2, v252
    v_and_b32 v21, 4, v21
    v_xor_b32 v21, v21, v252
    v_and_b32 v21, 7, v21
    v_lshl_add_u32 v20, v21, 4, v20
    s_lshl_b32 s32, s98, 7
    v_add_u32 v14, s32, v20
    v_lshrrev_b32 v20, 2, v252
    v_lshlrev_b32 v20, 2, v20
    v_bfe_u32 v21, v252, 1, 1
    v_add_u32 v20, v20, v21
    v_mul_u32_u24 v20, 28672, v20
    v_and_b32 v21, 1, v252
    v_lshl_add_u32 v20, v21, 4, v20
    s_mul_i32 s30, s28, 1835008
    s_lshl_b32 s31, s29, 5
    s_add_u32 s30, s30, s31
    v_add_u32 v155, s30, v20
    v_lshlrev_b32 v21, 14, v21
    v_lshrrev_b32 v20, 1, v252
    v_lshl_add_u32 v20, v20, 4, v21
    s_lshl_b32 s30, s28, 9
    s_lshl_b32 s31, s29, 15
    s_add_u32 s30, s30, s31
    v_add_u32 v153, s30, v20
    s_load_dwordx2 s[80:81], s[0:1], 40
    s_cmp_lt_u32 s29, 224
    s_cselect_b32 s82, 0x700000, 0
    s_mov_b32 s83, 0x20000
    s_load_dwordx2 s[12:13], s[0:1], 56
    s_cmp_lt_u32 s29, 224
    s_cselect_b32 s14, 0x700000, 0
    s_mov_b32 s15, 0x20000
    s_mov_b32 s73, -1
    s_mov_b32 s100, 0
    s_sub_u32 s30, s25, s24
    s_add_u32 s30, s30, 31
    v_and_b32 v15, 16, v252
    v_mul_u32_u24 v15, s30, v15
    v_and_b32 v20, 31, v252
    v_add_lshl_u32 v15, v15, v20, 3
    s_lshl_b32 s30, s24, 7
    s_add_u32 s30, s30, 0xdd9000
    v_add_u32 v15, s30, v15
    s_add_u32 m0, s87, 45056
    s_nop 0
    buffer_load_dwordx4 v12, s[16:19], s96 offen offset:0 lds
    buffer_load_dwordx4 v13, s[16:19], s96 offen offset:1024 lds
    s_add_u32 s96, s95, 1
    s_and_b32 s96, s96, 15
    s_lshl_b32 s97, s96, 7
    s_add_u32 s97, s97, s84
    s_add_u32 m0, s86, 131072
    s_nop 0
    buffer_load_dwordx4 v4, s[4:7], s97 offen offset:0 lds
    buffer_load_dwordx4 v5, s[4:7], s97 offen offset:1024 lds
    buffer_load_dwordx4 v6, s[4:7], s97 offen offset:2048 lds
    buffer_load_dwordx4 v7, s[4:7], s97 offen offset:3072 lds
    s_add_u32 s96, s95, 1
    s_and_b32 s96, s96, 15
    s_mul_i32 s96, s96, 393216
    s_add_u32 s96, s96, s85
    s_add_u32 m0, s87, 65536
    s_nop 0
    buffer_load_dwordx4 v8, s[16:19], s96 offen offset:0 lds
    buffer_load_dwordx4 v9, s[16:19], s96 offen offset:1024 lds
    buffer_load_dwordx4 v10, s[16:19], s96 offen offset:2048 lds
    s_waitcnt vmcnt(7) lgkmcnt(0)
    s_add_u32 s88, s88, 0x9e3779b9
    s_barrier
    buffer_load_dwordx4 v11, s[16:19], s96 offen offset:3072 lds
    s_add_u32 m0, s87, 69632
    s_nop 0
    buffer_load_dwordx4 v12, s[16:19], s96 offen offset:0 lds
    buffer_load_dwordx4 v13, s[16:19], s96 offen offset:1024 lds
    s_add_u32 s96, s94, 2
    s_and_b32 s96, s96, 15
    s_lshl_b32 s97, s96, 7
    s_add_u32 s97, s97, s84
    s_add_u32 m0, s86, 114688
    s_nop 0
    buffer_load_dwordx4 v4, s[4:7], s97 offen offset:0 lds
    buffer_load_dwordx4 v5, s[4:7], s97 offen offset:1024 lds
    buffer_load_dwordx4 v6, s[4:7], s97 offen offset:2048 lds
    buffer_load_dwordx4 v7, s[4:7], s97 offen offset:3072 lds
    s_add_u32 s96, s94, 2
    s_and_b32 s96, s96, 15
    s_mul_i32 s96, s96, 393216
    s_add_u32 s96, s96, s85
    s_add_u32 m0, s87, 90112
    s_nop 0
    buffer_load_dwordx4 v8, s[16:19], s96 offen offset:0 lds
    buffer_load_dwordx4 v9, s[16:19], s96 offen offset:1024 lds
    buffer_load_dwordx4 v10, s[16:19], s96 offen offset:2048 lds
    buffer_load_dwordx4 v11, s[16:19], s96 offen offset:3072 lds
    s_add_u32 m0, s87, 94208
    s_nop 0
    buffer_load_dwordx4 v12, s[16:19], s96 offen offset:0 lds
    buffer_load_dwordx4 v13, s[16:19], s96 offen offset:1024 lds
    s_waitcnt vmcnt(10) lgkmcnt(0)
    s_barrier
    s_add_u32 s96, s95, 3
    s_and_b32 s96, s96, 15
    s_lshl_b32 s97, s96, 7
    s_add_u32 s97, s97, s84
    s_add_u32 m0, s86, 147456
    s_nop 0
    buffer_load_dwordx4 v4, s[4:7], s97 offen offset:0 lds
    buffer_load_dwordx4 v5, s[4:7], s97 offen offset:1024 lds
    buffer_load_dwordx4 v6, s[4:7], s97 offen offset:2048 lds
    buffer_load_dwordx4 v7, s[4:7], s97 offen offset:3072 lds
    s_add_u32 s96, s95, 3
    s_and_b32 s96, s96, 15
    s_mul_i32 s96, s96, 393216
    s_add_u32 s96, s96, s85
    s_add_u32 m0, s87, 40960
    s_nop 0
    buffer_load_dwordx4 v8, s[16:19], s96 offen offset:0 lds
    buffer_load_dwordx4 v9, s[16:19], s96 offen offset:1024 lds
    v_and_b32 v28, 31, v252
    v_bfe_u32 v29, v28, 1, 3
    v_lshrrev_b32 v30, 5, v252
    v_xor_b32 v29, v29, v30
    v_lshlrev_b32 v29, 4, v29
    v_lshl_add_u32 v28, v28, 7, v29
    s_add_u32 s30, s86, 131072
    v_add_u32 v28, s30, v28
    v_xor_b32 v29, 32, v28
    v_xor_b32 v30, 64, v28
    v_xor_b32 v31, 96, v28
    ds_read_b128 v[32:35], v28
    ds_read_b128 v[36:39], v29
    ds_read_b128 v[40:43], v30
    buffer_load_dwordx4 v10, s[16:19], s96 offen offset:2048 lds
    ds_read_b128 v[44:47], v31
    s_min_u32 s30, s28, 2
    s_lshl_b32 s30, s30, 13
    s_add_u32 s30, s30, 65536
    v_lshrrev_b32 v20, 2, v252
    v_bfe_u32 v21, v20, 1, 2
    v_lshlrev_b32 v20, 7, v20
    v_lshl_add_u32 v20, v21, 5, v20
    v_and_b32 v21, 3, v252
    v_lshl_add_u32 v20, v21, 3, v20
    v_add_u32 v144, s30, v20
    v_xor_b32 v145, 32, v144
    v_xor_b32 v146, 64, v144
    v_xor_b32 v147, 96, v144
    buffer_load_dwordx4 v11, s[16:19], s96 offen offset:3072 lds
    ds_read_b64_tr_b16 v[100:101], v144 offset:0
    ds_read_b64_tr_b16 v[102:103], v144 offset:2048
    ds_read_b64_tr_b16 v[104:105], v144 offset:4096
    ds_read_b64_tr_b16 v[106:107], v144 offset:6144
    ds_read_b64_tr_b16 v[108:109], v145 offset:0
    ds_read_b64_tr_b16 v[110:111], v145 offset:2048
    ds_read_b64_tr_b16 v[112:113], v145 offset:4096
    ds_read_b64_tr_b16 v[114:115], v145 offset:6144
    ds_read_b64_tr_b16 v[116:117], v146 offset:0
    ds_read_b64_tr_b16 v[118:119], v146 offset:2048
    ds_read_b64_tr_b16 v[120:121], v146 offset:4096
    ds_read_b64_tr_b16 v[122:123], v146 offset:6144
    ds_read_b64_tr_b16 v[124:125], v147 offset:0
    ds_read_b64_tr_b16 v[126:127], v147 offset:2048
    s_add_u32 m0, s87, 45056
    s_nop 0
    buffer_load_dwordx4 v12, s[16:19], s96 offen offset:0 lds
    ds_read_b64_tr_b16 v[128:129], v147 offset:4096
    ds_read_b64_tr_b16 v[130:131], v147 offset:6144
    v_mov_b32 v16, -1
    v_mov_b32 v17, -1
    v_mov_b32 v18, -1
    v_mov_b32 v19, -1
    s_lshr_b32 s30, s28, 1
    s_mul_i32 s30, s30, 16777216
    s_and_b32 s31, s28, 1
    s_lshl_b32 s32, s31, 20
    s_lshl_b32 s33, s72, 10
    s_add_u32 s32, s32, s33
    s_add_u32 s32, s32, s30
    s_add_u32 s32, s32, 0xc00000
    buffer_load_dwordx4 v13, s[16:19], s96 offen offset:1024 lds
    buffer_store_dwordx4 v[16:19], v253, s[20:23], s32 offen sc1
    s_add_u32 s32, s32, 262144
    buffer_store_dwordx4 v[16:19], v253, s[20:23], s32 offen sc1
    s_add_u32 s32, s32, 262144
    buffer_store_dwordx4 v[16:19], v253, s[20:23], s32 offen sc1
    s_add_u32 s32, s32, 262144
    s_lshl_b32 s33, s72, 7
    s_add_u32 s33, s33, s30
    s_add_u32 s33, s33, 0xdc0000
    s_cmp_eq_u32 s31, 0
    s_cselect_b32 s32, s32, s33
    s_cselect_b64 exec, -1, 0xff
    buffer_store_dwordx4 v[16:19], v253, s[20:23], s32 offen sc1
    s_mov_b64 exec, -1
    s_waitcnt vmcnt(14) lgkmcnt(0)
    s_barrier
    s_add_u32 s96, s94, 4
    s_and_b32 s96, s96, 15
    s_lshl_b32 s97, s96, 7
    s_add_u32 s97, s97, s84
    s_add_u32 m0, s86, 131072
    s_nop 0
    buffer_load_dwordx4 v4, s[4:7], s97 offen offset:0 lds
    buffer_load_dwordx4 v5, s[4:7], s97 offen offset:1024 lds
    v_mov_b32 v48, 0
    v_mov_b32 v49, 0
    v_mov_b32 v50, 0
    v_mov_b32 v51, 0
    s_lshl_b32 s30, s99, 12
    s_lshl_b32 s31, s25, 8
    s_add_u32 s30, s30, s31
    s_add_u32 s30, s30, 0x2400000
    v_lshlrev_b32 v28, 3, v252
    v_dot2c_f32_bf16 v48, 0x3f803f80, v32
    v_dot2c_f32_bf16 v49, v32, v32
    v_dot2c_f32_bf16 v50, 0x3f803f80, v33
    buffer_load_dwordx4 v6, s[4:7], s97 offen offset:2048 lds
    v_dot2c_f32_bf16 v51, v33, v33
    v_dot2c_f32_bf16 v48, 0x3f803f80, v34
    v_dot2c_f32_bf16 v49, v34, v34
    v_dot2c_f32_bf16 v50, 0x3f803f80, v35
    v_dot2c_f32_bf16 v51, v35, v35
    v_dot2c_f32_bf16 v48, 0x3f803f80, v36
    v_dot2c_f32_bf16 v49, v36, v36
    v_dot2c_f32_bf16 v50, 0x3f803f80, v37
    v_dot2c_f32_bf16 v51, v37, v37
    v_dot2c_f32_bf16 v48, 0x3f803f80, v38
    v_dot2c_f32_bf16 v49, v38, v38
    buffer_load_dwordx4 v7, s[4:7], s97 offen offset:3072 lds
    v_dot2c_f32_bf16 v50, 0x3f803f80, v39
    v_dot2c_f32_bf16 v51, v39, v39
    v_dot2c_f32_bf16 v48, 0x3f803f80, v40
    v_dot2c_f32_bf16 v49, v40, v40
    v_dot2c_f32_bf16 v50, 0x3f803f80, v41
    v_dot2c_f32_bf16 v51, v41, v41
    v_dot2c_f32_bf16 v48, 0x3f803f80, v42
    v_dot2c_f32_bf16 v49, v42, v42
    v_dot2c_f32_bf16 v50, 0x3f803f80, v43
    v_dot2c_f32_bf16 v51, v43, v43
    v_dot2c_f32_bf16 v48, 0x3f803f80, v44
    s_add_u32 s96, s94, 4
    s_and_b32 s96, s96, 15
    s_mul_i32 s96, s96, 393216
    s_add_u32 s96, s96, s85
    s_add_u32 m0, s87, 65536
    s_nop 0
    buffer_load_dwordx4 v8, s[16:19], s96 offen offset:0 lds
    v_dot2c_f32_bf16 v49, v44, v44
    v_dot2c_f32_bf16 v50, 0x3f803f80, v45
    v_dot2c_f32_bf16 v51, v45, v45
    v_dot2c_f32_bf16 v48, 0x3f803f80, v46
    v_dot2c_f32_bf16 v49, v46, v46
    v_dot2c_f32_bf16 v50, 0x3f803f80, v47
    v_dot2c_f32_bf16 v51, v47, v47
    s_nop 2
    v_pk_add_f32 v[48:49], v[48:49], v[50:51]
    v_mov_b32 v50, v48
    v_mov_b32 v51, v49
    s_nop 0
    v_permlane32_swap_b32 v48, v50
    buffer_load_dwordx4 v9, s[16:19], s96 offen offset:1024 lds
    v_permlane32_swap_b32 v49, v51
    v_pk_add_f32 v[48:49], v[48:49], v[50:51]
    s_mov_b32 exec_hi, 0
    buffer_store_dwordx2 v[48:49], v28, s[20:23], s30 offen sc1
    s_mov_b64 exec, -1
    v_mov_b32 v140, 0
    v_mov_b32 v141, 0
    v_mov_b32 v142, 0
    v_mov_b32 v143, 0
    v_dot2c_f32_bf16 v140, 0x3f803f80, v100
    v_dot2c_f32_bf16 v141, 0x3f803f80, v108
    v_dot2c_f32_bf16 v142, 0x3f803f80, v116
    buffer_load_dwordx4 v10, s[16:19], s96 offen offset:2048 lds
    v_dot2c_f32_bf16 v143, 0x3f803f80, v124
    v_dot2c_f32_bf16 v140, 0x3f803f80, v101
    v_dot2c_f32_bf16 v141, 0x3f803f80, v109
    v_dot2c_f32_bf16 v142, 0x3f803f80, v117
    v_dot2c_f32_bf16 v143, 0x3f803f80, v125
    v_dot2c_f32_bf16 v140, 0x3f803f80, v102
    v_dot2c_f32_bf16 v141, 0x3f803f80, v110
    v_dot2c_f32_bf16 v142, 0x3f803f80, v118
    v_dot2c_f32_bf16 v143, 0x3f803f80, v126
    v_dot2c_f32_bf16 v140, 0x3f803f80, v103
    v_dot2c_f32_bf16 v141, 0x3f803f80, v111
    buffer_load_dwordx4 v11, s[16:19], s96 offen offset:3072 lds
    v_dot2c_f32_bf16 v142, 0x3f803f80, v119
    v_dot2c_f32_bf16 v143, 0x3f803f80, v127
    v_dot2c_f32_bf16 v140, 0x3f803f80, v104
    v_dot2c_f32_bf16 v141, 0x3f803f80, v112
    v_dot2c_f32_bf16 v142, 0x3f803f80, v120
    v_dot2c_f32_bf16 v143, 0x3f803f80, v128
    v_dot2c_f32_bf16 v140, 0x3f803f80, v105
    v_dot2c_f32_bf16 v141, 0x3f803f80, v113
    v_dot2c_f32_bf16 v142, 0x3f803f80, v121
    v_dot2c_f32_bf16 v143, 0x3f803f80, v129
    v_dot2c_f32_bf16 v140, 0x3f803f80, v106
    s_add_u32 m0, s87, 69632
    s_nop 0
    buffer_load_dwordx4 v12, s[16:19], s96 offen offset:0 lds
    v_dot2c_f32_bf16 v141, 0x3f803f80, v114
    v_dot2c_f32_bf16 v142, 0x3f803f80, v122
    v_dot2c_f32_bf16 v143, 0x3f803f80, v130
    v_dot2c_f32_bf16 v140, 0x3f803f80, v107
    v_dot2c_f32_bf16 v141, 0x3f803f80, v115
    v_dot2c_f32_bf16 v142, 0x3f803f80, v123
    v_dot2c_f32_bf16 v143, 0x3f803f80, v131
    s_min_u32 s32, s28, 2
    s_lshl_b32 s32, s32, 12
    s_lshl_b32 s33, s25, 14
    s_add_u32 s32, s32, s33
    buffer_load_dwordx4 v13, s[16:19], s96 offen offset:1024 lds
    s_add_u32 s32, s32, 0x2500000
    s_lshl_b32 s33, s24, 8
    s_add_u32 s32, s32, s33
    v_lshlrev_b32 v20, 2, v252
    v_permlane32_swap_b32 v140, v142
    v_permlane32_swap_b32 v141, v143
    v_add_f32 v140, v140, v142
    v_add_f32 v141, v141, v143
    s_nop 1
    v_permlane16_swap_b32 v140, v141
    v_add_f32 v140, v140, v141
    buffer_store_dword v140, v20, s[20:23], s32 offen sc1
    s_waitcnt vmcnt(16) lgkmcnt(0)
    s_barrier
    s_add_u32 s96, s95, 5
    s_and_b32 s96, s96, 15
    s_lshl_b32 s97, s96, 7
    s_add_u32 s97, s97, s84
    s_add_u32 m0, s86, 114688
    s_nop 0
    buffer_load_dwordx4 v4, s[4:7], s97 offen offset:0 lds
    buffer_load_dwordx4 v5, s[4:7], s97 offen offset:1024 lds
    buffer_load_dwordx4 v6, s[4:7], s97 offen offset:2048 lds
    buffer_load_dwordx4 v7, s[4:7], s97 offen offset:3072 lds
    s_add_u32 s96, s95, 5
    s_and_b32 s96, s96, 15
    s_mul_i32 s96, s96, 393216
    s_add_u32 s96, s96, s85
    s_add_u32 m0, s87, 90112
    s_nop 0
    buffer_load_dwordx4 v8, s[16:19], s96 offen offset:0 lds
    buffer_load_dwordx4 v9, s[16:19], s96 offen offset:1024 lds
    buffer_load_dwordx4 v10, s[16:19], s96 offen offset:2048 lds
    buffer_load_dwordx4 v11, s[16:19], s96 offen offset:3072 lds
    s_add_u32 m0, s87, 94208
    s_nop 0
    buffer_load_dwordx4 v12, s[16:19], s96 offen offset:0 lds
    buffer_load_dwordx4 v13, s[16:19], s96 offen offset:1024 lds
    s_waitcnt vmcnt(11) lgkmcnt(0)
    s_barrier
    s_add_u32 s96, s94, 6
    s_and_b32 s96, s96, 15
    s_lshl_b32 s97, s96, 7
    s_add_u32 s97, s97, s84
    s_add_u32 m0, s86, 147456
    s_nop 0
    buffer_load_dwordx4 v4, s[4:7], s97 offen offset:0 lds
    buffer_load_dwordx4 v5, s[4:7], s97 offen offset:1024 lds
    buffer_load_dwordx4 v6, s[4:7], s97 offen offset:2048 lds
    buffer_load_dwordx4 v7, s[4:7], s97 offen offset:3072 lds
    s_add_u32 s96, s94, 6
    s_and_b32 s96, s96, 15
    s_mul_i32 s96, s96, 393216
    s_add_u32 s96, s96, s85
    s_add_u32 m0, s87, 40960
    s_nop 0
    buffer_load_dwordx4 v8, s[16:19], s96 offen offset:0 lds
    buffer_load_dwordx4 v9, s[16:19], s96 offen offset:1024 lds
    buffer_load_dwordx4 v10, s[16:19], s96 offen offset:2048 lds
    buffer_load_dwordx4 v11, s[16:19], s96 offen offset:3072 lds
    s_add_u32 m0, s87, 45056
    s_nop 0
    buffer_load_dwordx4 v12, s[16:19], s96 offen offset:0 lds
    buffer_load_dwordx4 v13, s[16:19], s96 offen offset:1024 lds
    s_waitcnt vmcnt(10) lgkmcnt(0)
    s_barrier
    s_add_u32 s96, s95, 7
    s_and_b32 s96, s96, 15
    s_lshl_b32 s97, s96, 7
    s_add_u32 s97, s97, s84
    s_add_u32 m0, s86, 131072
    s_nop 0
    buffer_load_dwordx4 v4, s[4:7], s97 offen offset:0 lds
    buffer_load_dwordx4 v5, s[4:7], s97 offen offset:1024 lds
    buffer_load_dwordx4 v6, s[4:7], s97 offen offset:2048 lds
    buffer_load_dwordx4 v7, s[4:7], s97 offen offset:3072 lds
    s_add_u32 s96, s95, 7
    s_and_b32 s96, s96, 15
    s_mul_i32 s96, s96, 393216
    s_add_u32 s96, s96, s85
    s_add_u32 m0, s87, 65536
    s_nop 0
    buffer_load_dwordx4 v8, s[16:19], s96 offen offset:0 lds
    buffer_load_dwordx4 v9, s[16:19], s96 offen offset:1024 lds
    buffer_load_dwordx4 v10, s[16:19], s96 offen offset:2048 lds
    buffer_load_dwordx4 v11, s[16:19], s96 offen offset:3072 lds
    s_add_u32 m0, s87, 69632
    s_nop 0
    buffer_load_dwordx4 v12, s[16:19], s96 offen offset:0 lds
    buffer_load_dwordx4 v13, s[16:19], s96 offen offset:1024 lds
    s_waitcnt vmcnt(10) lgkmcnt(0)
    s_barrier
    s_add_u32 s96, s94, 8
    s_and_b32 s96, s96, 15
    s_lshl_b32 s97, s96, 7
    s_add_u32 s97, s97, s84
    s_add_u32 m0, s86, 114688
    s_nop 0
    buffer_load_dwordx4 v4, s[4:7], s97 offen offset:0 lds
    buffer_load_dwordx4 v5, s[4:7], s97 offen offset:1024 lds
    buffer_load_dwordx4 v6, s[4:7], s97 offen offset:2048 lds
    buffer_load_dwordx4 v7, s[4:7], s97 offen offset:3072 lds
    s_add_u32 s96, s94, 8
    s_and_b32 s96, s96, 15
    s_mul_i32 s96, s96, 393216
    s_add_u32 s96, s96, s85
    s_add_u32 m0, s87, 90112
    s_nop 0
    buffer_load_dwordx4 v8, s[16:19], s96 offen offset:0 lds
    buffer_load_dwordx4 v9, s[16:19], s96 offen offset:1024 lds
    buffer_load_dwordx4 v10, s[16:19], s96 offen offset:2048 lds
    buffer_load_dwordx4 v11, s[16:19], s96 offen offset:3072 lds
    s_add_u32 m0, s87, 94208
    s_nop 0
    buffer_load_dwordx4 v12, s[16:19], s96 offen offset:0 lds
    buffer_load_dwordx4 v13, s[16:19], s96 offen offset:1024 lds
    s_waitcnt vmcnt(10) lgkmcnt(0)
    s_barrier
    s_add_u32 s96, s95, 9
    s_and_b32 s96, s96, 15
    s_lshl_b32 s97, s96, 7
    s_add_u32 s97, s97, s84
    s_add_u32 m0, s86, 147456
    s_nop 0
    buffer_load_dwordx4 v4, s[4:7], s97 offen offset:0 lds
    buffer_load_dwordx4 v5, s[4:7], s97 offen offset:1024 lds
    buffer_load_dwordx4 v6, s[4:7], s97 offen offset:2048 lds
    buffer_load_dwordx4 v7, s[4:7], s97 offen offset:3072 lds
    s_add_u32 s96, s95, 9
    s_and_b32 s96, s96, 15
    s_mul_i32 s96, s96, 393216
    s_add_u32 s96, s96, s85
    s_add_u32 m0, s87, 40960
    s_nop 0
    buffer_load_dwordx4 v8, s[16:19], s96 offen offset:0 lds
    buffer_load_dwordx4 v9, s[16:19], s96 offen offset:1024 lds
    buffer_load_dwordx4 v10, s[16:19], s96 offen offset:2048 lds
    buffer_load_dwordx4 v11, s[16:19], s96 offen offset:3072 lds
    s_add_u32 m0, s87, 45056
    s_nop 0
    buffer_load_dwordx4 v12, s[16:19], s96 offen offset:0 lds
    buffer_load_dwordx4 v13, s[16:19], s96 offen offset:1024 lds
    s_waitcnt vmcnt(10) lgkmcnt(0)
    s_barrier
    s_add_u32 s96, s94, 10
    s_and_b32 s96, s96, 15
    s_lshl_b32 s97, s96, 7
    s_add_u32 s97, s97, s84
    s_add_u32 m0, s86, 131072
    s_nop 0
    buffer_load_dwordx4 v4, s[4:7], s97 offen offset:0 lds
    buffer_load_dwordx4 v5, s[4:7], s97 offen offset:1024 lds
    buffer_load_dwordx4 v6, s[4:7], s97 offen offset:2048 lds
    buffer_load_dwordx4 v7, s[4:7], s97 offen offset:3072 lds
    s_add_u32 s96, s94, 10
    s_and_b32 s96, s96, 15
    s_mul_i32 s96, s96, 393216
    s_add_u32 s96, s96, s85
    s_add_u32 m0, s87, 65536
    s_nop 0
    buffer_load_dwordx4 v8, s[16:19], s96 offen offset:0 lds
    buffer_load_dwordx4 v9, s[16:19], s96 offen offset:1024 lds
    buffer_load_dwordx4 v10, s[16:19], s96 offen offset:2048 lds
    buffer_load_dwordx4 v11, s[16:19], s96 offen offset:3072 lds
    s_add_u32 m0, s87, 69632
    s_nop 0
    buffer_load_dwordx4 v12, s[16:19], s96 offen offset:0 lds
    buffer_load_dwordx4 v13, s[16:19], s96 offen offset:1024 lds
    s_waitcnt vmcnt(10) lgkmcnt(0)
    s_barrier
    s_add_u32 s96, s95, 11
    s_and_b32 s96, s96, 15
    s_lshl_b32 s97, s96, 7
    s_add_u32 s97, s97, s84
    s_add_u32 m0, s86, 114688
    s_nop 0
    buffer_load_dwordx4 v4, s[4:7], s97 offen offset:0 lds
    buffer_load_dwordx4 v5, s[4:7], s97 offen offset:1024 lds
    buffer_load_dwordx4 v6, s[4:7], s97 offen offset:2048 lds
    buffer_load_dwordx4 v7, s[4:7], s97 offen offset:3072 lds
    s_add_u32 s96, s95, 11
    s_and_b32 s96, s96, 15
    s_mul_i32 s96, s96, 393216
    s_add_u32 s96, s96, s85
    s_add_u32 m0, s87, 90112
    s_nop 0
    buffer_load_dwordx4 v8, s[16:19], s96 offen offset:0 lds
    buffer_load_dwordx4 v9, s[16:19], s96 offen offset:1024 lds
    buffer_load_dwordx4 v10, s[16:19], s96 offen offset:2048 lds
    buffer_load_dwordx4 v11, s[16:19], s96 offen offset:3072 lds
    s_add_u32 m0, s87, 94208
    s_nop 0
    buffer_load_dwordx4 v12, s[16:19], s96 offen offset:0 lds
    buffer_load_dwordx4 v13, s[16:19], s96 offen offset:1024 lds
    s_waitcnt vmcnt(10) lgkmcnt(0)
    s_barrier
    s_add_u32 s96, s94, 12
    s_and_b32 s96, s96, 15
    s_lshl_b32 s97, s96, 7
    s_add_u32 s97, s97, s84
    s_add_u32 m0, s86, 147456
    s_nop 0
    buffer_load_dwordx4 v4, s[4:7], s97 offen offset:0 lds
    buffer_load_dwordx4 v5, s[4:7], s97 offen offset:1024 lds
    s_getpc_b64 s[32:33]
pc_43:
    buffer_load_dwordx4 v6, s[4:7], s97 offen offset:2048 lds
    s_sub_u32 s32, s32, pc_43-interleave_layers__sliding_block__moe_arch_mod__prompt_kernel
    s_subb_u32 s33, s33, 0
    buffer_load_dwordx4 v7, s[4:7], s97 offen offset:3072 lds
    s_lshr_b32 s34, s2, 3
    s_add_u32 s96, s94, 12
    s_and_b32 s96, s96, 15
    s_mul_i32 s96, s96, 393216
    s_add_u32 s96, s96, s85
    s_add_u32 m0, s87, 40960
    s_nop 0
    buffer_load_dwordx4 v8, s[16:19], s96 offen offset:0 lds
    s_lshl_b32 s34, s34, 2
    buffer_load_dwordx4 v9, s[16:19], s96 offen offset:1024 lds
    s_add_u32 s34, s34, s28
    s_and_b32 s34, s34, 127
    buffer_load_dwordx4 v10, s[16:19], s96 offen offset:2048 lds
    s_lshl_b32 s34, s34, 7
    buffer_load_dwordx4 v11, s[16:19], s96 offen offset:3072 lds
    v_lshl_add_u32 v154, v252, 14, s34
    s_mov_b32 s34, k_exit-interleave_layers__sliding_block__moe_arch_mod__prompt_kernel
    s_add_u32 m0, s87, 45056
    s_nop 0
    buffer_load_dwordx4 v12, s[16:19], s96 offen offset:0 lds
    s_mov_b32 s35, 0x20000
    buffer_load_dwordx4 v13, s[16:19], s96 offen offset:1024 lds
    buffer_load_dword v154, v154, s[32:35], 0 offen
    s_waitcnt vmcnt(11) lgkmcnt(0)
    s_barrier
    buffer_load_dwordx2 v[16:17], v15, s[20:23], 0 offen sc1
    s_add_u32 s96, s95, 13
    s_and_b32 s96, s96, 15
    s_lshl_b32 s97, s96, 7
    s_add_u32 s97, s97, s84
    s_add_u32 m0, s86, 131072
    s_nop 0
    buffer_load_dwordx4 v4, s[4:7], s97 offen offset:0 lds
    buffer_load_dwordx4 v5, s[4:7], s97 offen offset:1024 lds
    buffer_load_dwordx4 v6, s[4:7], s97 offen offset:2048 lds
    buffer_load_dwordx4 v7, s[4:7], s97 offen offset:3072 lds
    s_add_u32 s96, s95, 13
    s_and_b32 s96, s96, 15
    s_mul_i32 s96, s96, 393216
    s_add_u32 s96, s96, s85
    s_add_u32 m0, s87, 65536
    s_nop 0
    buffer_load_dwordx4 v8, s[16:19], s96 offen offset:0 lds
    buffer_load_dwordx4 v9, s[16:19], s96 offen offset:1024 lds
    buffer_load_dwordx4 v10, s[16:19], s96 offen offset:2048 lds
    buffer_load_dwordx4 v11, s[16:19], s96 offen offset:3072 lds
    s_add_u32 m0, s87, 69632
    s_nop 0
    buffer_load_dwordx4 v12, s[16:19], s96 offen offset:0 lds
    buffer_load_dwordx4 v13, s[16:19], s96 offen offset:1024 lds
    s_waitcnt vmcnt(12) lgkmcnt(0)
    s_barrier
    s_add_u32 s96, s94, 14
    s_and_b32 s96, s96, 15
    s_lshl_b32 s97, s96, 7
    s_add_u32 s97, s97, s84
    s_add_u32 m0, s86, 114688
    s_nop 0
    buffer_load_dwordx4 v4, s[4:7], s97 offen offset:0 lds
    buffer_load_dwordx4 v5, s[4:7], s97 offen offset:1024 lds
    buffer_load_dwordx4 v6, s[4:7], s97 offen offset:2048 lds
    buffer_load_dwordx4 v7, s[4:7], s97 offen offset:3072 lds
    s_add_u32 s96, s94, 14
    s_and_b32 s96, s96, 15
    s_mul_i32 s96, s96, 393216
    s_add_u32 s96, s96, s85
    s_add_u32 m0, s87, 90112
    s_nop 0
    buffer_load_dwordx4 v8, s[16:19], s96 offen offset:0 lds
    buffer_load_dwordx4 v9, s[16:19], s96 offen offset:1024 lds
    buffer_load_dwordx4 v10, s[16:19], s96 offen offset:2048 lds
    buffer_load_dwordx4 v11, s[16:19], s96 offen offset:3072 lds
    s_add_u32 m0, s87, 94208
    s_nop 0
    buffer_load_dwordx4 v12, s[16:19], s96 offen offset:0 lds
    buffer_load_dwordx4 v13, s[16:19], s96 offen offset:1024 lds
    s_mov_b32 s78, s27
    s_waitcnt vmcnt(20)
    s_branch pc_45
pl_44:
    buffer_load_dwordx2 v[16:17], v15, s[20:23], 0 offen sc1
    s_waitcnt vmcnt(0)
pc_45:
    v_cmp_ne_u32 vcc, s88, v16
    s_cbranch_vccz pd_46
    s_sub_u32 s78, s78, 1
    s_cmp_lg_u32 s78, 0
    s_cbranch_scc1 pl_44
    s_mov_b32 s27, 1
pd_46:
    s_getreg_b32 s30, hwreg(HW_REG_XCC_ID, 0, 4)
    v_cmp_ne_u32 vcc, s30, v17
    s_and_b32 s30, vcc_lo, 0xffff
    s_cselect_b32 s77, 0, 1
    v_mov_b32 v20, s73
    v_mov_b32 v21, s77
    v_mov_b32 v19, 0
    ds_write_b64 v19, v[20:21] offset:3072
    s_waitcnt vmcnt(10) lgkmcnt(0)
    s_barrier
    s_add_u32 s96, s95, 15
    s_and_b32 s96, s96, 15
    s_lshl_b32 s97, s96, 7
    s_add_u32 s97, s97, s84
    s_add_u32 m0, s86, 147456
    s_nop 0
    buffer_load_dwordx4 v4, s[4:7], s97 offen offset:0 lds
    buffer_load_dwordx4 v5, s[4:7], s97 offen offset:1024 lds
    buffer_load_dwordx4 v6, s[4:7], s97 offen offset:2048 lds
    buffer_load_dwordx4 v7, s[4:7], s97 offen offset:3072 lds
    s_add_u32 s96, s95, 15
    s_and_b32 s96, s96, 15
    s_mul_i32 s96, s96, 393216
    s_add_u32 s96, s96, s85
    s_add_u32 m0, s87, 40960
    s_nop 0
    buffer_load_dwordx4 v8, s[16:19], s96 offen offset:0 lds
    buffer_load_dwordx4 v9, s[16:19], s96 offen offset:1024 lds
    buffer_load_dwordx4 v10, s[16:19], s96 offen offset:2048 lds
    buffer_load_dwordx4 v11, s[16:19], s96 offen offset:3072 lds
    s_add_u32 m0, s87, 45056
    s_nop 0
    buffer_load_dwordx4 v12, s[16:19], s96 offen offset:0 lds
    buffer_load_dwordx4 v13, s[16:19], s96 offen offset:1024 lds
    s_waitcnt vmcnt(10) lgkmcnt(0)
    s_barrier
    s_load_dwordx2 s[4:5], s[0:1], 48
    s_cmp_lt_u32 s29, 224
    s_cselect_b32 s6, 0x700000, 0
    s_mov_b32 s7, 0x20000
    s_lshl_b32 s30, s99, 12
    s_add_u32 s30, s30, 0x2400000
    buffer_load_dwordx4 v[64:67], v253, s[20:23], s30 offen offset:0 sc1
    buffer_load_dwordx4 v[68:71], v253, s[20:23], s30 offen offset:1024 sc1
    buffer_load_dwordx4 v[72:75], v253, s[20:23], s30 offen offset:2048 sc1
    buffer_load_dwordx4 v[76:79], v253, s[20:23], s30 offen offset:3072 sc1
    s_min_u32 s32, s28, 2
    s_lshl_b32 s32, s32, 12
    s_lshl_b32 s33, s25, 14
    s_add_u32 s32, s32, s33
    s_add_u32 s32, s32, 0x2500000
    buffer_load_dwordx4 v[32:35], v253, s[20:23], s32 offen offset:0 sc1
    buffer_load_dwordx4 v[36:39], v253, s[20:23], s32 offen offset:1024 sc1
    buffer_load_dwordx4 v[40:43], v253, s[20:23], s32 offen offset:2048 sc1
    buffer_load_dwordx4 v[44:47], v253, s[20:23], s32 offen offset:3072 sc1
    s_add_u32 s96, s25, 1
    s_and_b32 s96, s96, 15
    s_lshl_b32 s96, s96, 17
    s_add_u32 m0, s101, 4096
    s_nop 0
    buffer_load_dwordx4 v14, s[8:11], s96 offen lds
    s_add_u32 s96, s25, 2
    s_and_b32 s96, s96, 15
    s_lshl_b32 s96, s96, 17
    s_add_u32 m0, s101, 8192
    s_nop 0
    buffer_load_dwordx4 v14, s[8:11], s96 offen lds
    s_add_u32 s96, s25, 3
    s_and_b32 s96, s96, 15
    s_lshl_b32 s96, s96, 17
    s_add_u32 m0, s101, 12288
    s_nop 0
    buffer_load_dwordx4 v14, s[8:11], s96 offen lds
    s_waitcnt vmcnt(11) lgkmcnt(0)
    s_barrier
    s_waitcnt vmcnt(3)
    v_pk_add_f32 v[64:65], v[64:65], v[68:69]
    v_pk_add_f32 v[66:67], v[66:67], v[70:71]
    v_pk_add_f32 v[64:65], v[64:65], v[72:73]
    v_pk_add_f32 v[66:67], v[66:67], v[74:75]
    v_pk_add_f32 v[64:65], v[64:65], v[76:77]
    v_pk_add_f32 v[66:67], v[66:67], v[78:79]
    s_nop 1
    v_permlane32_swap_b32 v64, v66
    v_permlane32_swap_b32 v65, v67
    v_pk_add_f32 v[64:65], v[64:65], v[66:67]
    v_mov_b32 v48, v64
    v_mov_b32 v49, v65
    s_nop 0
    v_permlane16_swap_b32 v64, v48
    v_permlane16_swap_b32 v65, v49
    v_add_f32 v64, v64, v48
    v_add_f32 v65, v65, v49
    v_mul_f32 v54, 0x3a800000, v64
    v_mul_f32 v65, 0x3a800000, v65
    v_fma_f32 v65, -v54, v54, v65
    v_max_f32 v65, 0, v65
    v_add_f32 v55, 0x3727c5ac, v65
    v_rsq_f32 v55, v55
    v_pk_add_f32 v[32:33], v[32:33], v[36:37]
    v_pk_add_f32 v[34:35], v[34:35], v[38:39]
    v_pk_add_f32 v[32:33], v[32:33], v[40:41]
    v_pk_add_f32 v[34:35], v[34:35], v[42:43]
    v_pk_add_f32 v[32:33], v[32:33], v[44:45]
    v_pk_add_f32 v[34:35], v[34:35], v[46:47]
    s_nop 1
    v_permlane32_swap_b32 v32, v34
    v_permlane32_swap_b32 v33, v35
    v_add_f32 v32, v32, v34
    v_add_f32 v33, v33, v35
    s_nop 1
    v_permlane16_swap_b32 v32, v33
    v_add_f32 v32, v32, v33
    v_mov_b32 v2, v32
    v_and_b32 v48, 15, v252
    v_lshrrev_b32 v49, 5, v252
    v_lshl_add_u32 v48, v48, 1, v49
    v_bfe_u32 v49, v252, 4, 1
    v_cmp_eq_u32 vcc, 0, v49
    v_lshlrev_b32 v49, 9, v49
    v_lshl_add_u32 v48, v48, 2, v49
    s_lshl_b32 s32, s28, 7
    v_add_u32 v48, s32, v48
    v_cndmask_b32 v49, v54, v55, vcc
    v_cndmask_b32 v50, 0, 1.0, vcc
    ds_write_b32 v48, v49 offset:0
    ds_write_b32 v48, v50 offset:2048
    v_and_b32 v48, 15, v252
    v_lshrrev_b32 v51, 4, v252
    v_lshl_add_u32 v48, v48, 2, v51
    s_min_u32 s32, s28, 2
    s_lshl_b32 s32, s32, 8
    v_lshl_add_u32 v48, v48, 2, s32
    ds_write_b32 v48, v2 offset:1024
    s_waitcnt lgkmcnt(0)
    s_barrier
l_att:
    s_add_u32 s96, s25, 10
    s_and_b32 s96, s96, 15
    s_lshl_b32 s96, s96, 17
    s_add_u32 m0, s101, 40960
    s_nop 0
    buffer_load_dwordx4 v14, s[8:11], s96 offen lds
    s_add_u32 s96, s25, 11
    s_and_b32 s96, s96, 15
    s_lshl_b32 s96, s96, 17
    s_add_u32 m0, s101, 45056
    s_nop 0
    buffer_load_dwordx4 v14, s[8:11], s96 offen lds
    s_cmp_lg_u32 s26, 0
    s_cbranch_scc1 sk_47
    s_add_u32 s96, s25, 4
    s_and_b32 s96, s96, 15
    s_lshl_b32 s96, s96, 17
    s_add_u32 m0, s101, 16384
    s_nop 0
    buffer_load_dwordx4 v14, s[8:11], s96 offen lds
    s_add_u32 s96, s25, 5
    s_and_b32 s96, s96, 15
    s_lshl_b32 s96, s96, 17
    s_add_u32 m0, s101, 20480
    s_nop 0
    buffer_load_dwordx4 v14, s[8:11], s96 offen lds
    s_add_u32 s96, s25, 6
    s_and_b32 s96, s96, 15
    s_lshl_b32 s96, s96, 17
    s_add_u32 m0, s101, 24576
    s_nop 0
    buffer_load_dwordx4 v14, s[8:11], s96 offen lds
    s_add_u32 s96, s25, 7
    s_and_b32 s96, s96, 15
    s_lshl_b32 s96, s96, 17
    s_add_u32 m0, s101, 28672
    s_nop 0
    buffer_load_dwordx4 v14, s[8:11], s96 offen lds
    s_add_u32 s96, s25, 8
    s_and_b32 s96, s96, 15
    s_lshl_b32 s96, s96, 17
    s_add_u32 m0, s101, 32768
    s_nop 0
    buffer_load_dwordx4 v14, s[8:11], s96 offen lds
    s_add_u32 s96, s25, 9
    s_and_b32 s96, s96, 15
    s_lshl_b32 s96, s96, 17
    s_add_u32 m0, s101, 36864
    s_nop 0
    buffer_load_dwordx4 v14, s[8:11], s96 offen lds
sk_47:
    v_mov_b32 v20, 0xffff
    v_mov_b32 v21, 0xffff0000
    v_cndmask_b32 v22, 0, v20, s[40:41]
    v_cndmask_b32 v23, 0, v21, s[42:43]
    v_or_b32 v12, v22, v23
    v_cndmask_b32 v22, 0, v20, s[44:45]
    v_cndmask_b32 v23, 0, v21, s[46:47]
    v_or_b32 v13, v22, v23
    v_cndmask_b32 v22, 0, v20, s[48:49]
    v_cndmask_b32 v23, 0, v21, s[50:51]
    v_or_b32 v14, v22, v23
    v_cndmask_b32 v22, 0, v20, s[52:53]
    v_cndmask_b32 v23, 0, v21, s[54:55]
    v_or_b32 v15, v22, v23
    v_cndmask_b32 v22, 0, v20, s[56:57]
    v_cndmask_b32 v23, 0, v21, s[58:59]
    v_or_b32 v16, v22, v23
    v_cndmask_b32 v22, 0, v20, s[60:61]
    v_cndmask_b32 v23, 0, v21, s[62:63]
    v_or_b32 v17, v22, v23
    v_cndmask_b32 v22, 0, v20, s[64:65]
    v_cndmask_b32 v23, 0, v21, s[66:67]
    v_or_b32 v18, v22, v23
    v_cndmask_b32 v22, 0, v20, s[68:69]
    v_cndmask_b32 v23, 0, v21, s[70:71]
    v_or_b32 v19, v22, v23
    s_lshl_b32 s34, s28, 12
    s_add_u32 s34, s34, 114688
    v_add_u32 v20, s34, v253
    s_lshl_b32 s34, s3, 11
    s_add_u32 s34, s34, 49152
    v_add_u32 v3, s34, v253
    v_mov_b32 v24, 0
    v_mov_b32 v25, 0
    v_mov_b32 v26, 0
    v_mov_b32 v27, 0
    v_mov_b32 v28, 0
    v_mov_b32 v29, 0
    v_mov_b32 v30, 0
    v_mov_b32 v31, 0
    v_mov_b32 v32, 0
    v_mov_b32 v33, 0
    v_mov_b32 v34, 0
    v_mov_b32 v35, 0
    v_mov_b32 v36, 0
    v_mov_b32 v37, 0
    v_mov_b32 v38, 0
    v_mov_b32 v39, 0
    s_lshr_b32 s33, s28, 1
    s_add_u32 s33, s33, s24
    s_sub_u32 s33, s33, 2
    s_cmp_lt_i32 s33, 0
    s_cbranch_scc1 sk_48
    s_and_b32 s34, s28, 1
    s_lshl_b32 s35, s25, 7
    s_lshl_b32 s30, s33, 2
    s_add_u32 s35, s35, s30
    s_lshl_b32 s30, s34, 1
    s_add_u32 s35, s35, s30
    s_lshl_b32 s35, s35, 12
    s_add_u32 s35, s35, s26
    s_lshl_b32 s30, s25, 8
    s_lshl_b32 s31, s33, 4
    s_add_u32 s30, s30, s31
    s_lshl_b32 s31, s34, 3
    s_add_u32 s30, s30, s31
    s_add_u32 s30, s30, s26
    s_add_u32 s30, s30, 0xdd0000
    v_and_b32 v40, 4, v252
    s_mov_b32 s78, s27
pl_49:
    buffer_load_dword v42, v40, s[20:23], s30 offen sc1
    s_waitcnt vmcnt(0)
pc_50:
    v_cmp_ne_u32 vcc, s88, v42
    s_cbranch_vccz pd_51
    s_sub_u32 s78, s78, 1
    s_cmp_lg_u32 s78, 0
    s_cbranch_scc1 pl_49
    s_mov_b32 s27, 1
pd_51:
    s_lshl_b32 s30, s28, 13
    s_add_u32 m0, s30, 65536
    s_add_u32 s31, s35, 0
    buffer_load_dwordx4 v253, s[20:23], s31 offen offset:0 sc1 lds
    buffer_load_dwordx4 v253, s[20:23], s31 offen offset:1024 sc1 lds
    s_add_u32 m0, s30, 69632
    s_add_u32 s31, s35, 4096
    buffer_load_dwordx4 v253, s[20:23], s31 offen offset:0 sc1 lds
    buffer_load_dwordx4 v253, s[20:23], s31 offen offset:1024 sc1 lds
    s_add_u32 m0, s30, 65536
    s_add_u32 s31, s35, 0
    buffer_load_dwordx4 v253, s[20:23], s31 offen offset:2048 sc1 lds
    buffer_load_dwordx4 v253, s[20:23], s31 offen offset:3072 sc1 lds
    s_add_u32 m0, s30, 69632
    s_add_u32 s31, s35, 4096
    buffer_load_dwordx4 v253, s[20:23], s31 offen offset:2048 sc1 lds
    buffer_load_dwordx4 v253, s[20:23], s31 offen offset:3072 sc1 lds
    s_add_u32 m0, s30, 114688
    s_add_u32 s31, s35, 262144
    buffer_load_dwordx4 v253, s[20:23], s31 offen offset:0 sc1 lds
    buffer_load_dwordx4 v253, s[20:23], s31 offen offset:1024 sc1 lds
    s_add_u32 m0, s30, 118784
    s_add_u32 s31, s35, 266240
    buffer_load_dwordx4 v253, s[20:23], s31 offen offset:0 sc1 lds
    buffer_load_dwordx4 v253, s[20:23], s31 offen offset:1024 sc1 lds
    s_add_u32 m0, s30, 114688
    s_add_u32 s31, s35, 262144
    buffer_load_dwordx4 v253, s[20:23], s31 offen offset:2048 sc1 lds
    buffer_load_dwordx4 v253, s[20:23], s31 offen offset:3072 sc1 lds
    s_add_u32 m0, s30, 118784
    s_add_u32 s31, s35, 266240
    buffer_load_dwordx4 v253, s[20:23], s31 offen offset:2048 sc1 lds
    buffer_load_dwordx4 v253, s[20:23], s31 offen offset:3072 sc1 lds
    s_waitcnt vmcnt(12)
sk_48:
    s_cmp_eq_u32 s100, 0
    s_cbranch_scc1 sk_52
    s_waitcnt vmcnt(0)
sk_52:
    s_barrier
    s_cmp_eq_u32 s100, 0
    s_cbranch_scc1 sk_53
    s_cmp_lg_u32 s38, 0
    s_cselect_b64 exec, -1, 0
    ds_write_b16 v0, v1
    s_mov_b64 exec, -1
    s_waitcnt lgkmcnt(0)
    s_barrier
sk_53:
    ds_read_b128 v[4:7], v3
    ds_read_b128 v[8:11], v3 offset:1024
    s_waitcnt vmcnt(0) lgkmcnt(0)
    s_barrier
    ds_read_b128 v[104:107], v20 offset:32768
    ds_read_b128 v[108:111], v20 offset:33792
    ds_read_b128 v[112:115], v20 offset:28672
    ds_read_b128 v[116:119], v20 offset:29696
    s_waitcnt lgkmcnt(2)
    v_mfma_f32_32x32x16_bf16 v[40:55], v[104:107], v[4:7], 0
    v_mfma_f32_32x32x16_bf16 v[40:55], v[108:111], v[8:11], v[40:55]
    s_cmp_lg_u32 s26, 0
    s_cbranch_scc1 sk_54
    s_xor_b32 s96, s29, 0
    s_and_b32 s97, s96, 2
    s_and_b32 s96, s96, 3
    s_mul_i32 s97, s97, 14336
    s_mul_i32 s96, s96, 14336
    s_add_u32 s96, s96, s97
    buffer_load_dwordx4 v[156:159], v155, s[80:83], s96 offen
sk_54:
    ds_read_b128 v[104:107], v20 offset:24576
    ds_read_b128 v[108:111], v20 offset:25600
    s_cmp_eq_u32 s99, 0
    s_cbranch_scc0 ng_55
    v_mov_b32 v24, 0xf149f2ca
    v_mov_b32 v25, 0xf149f2ca
    v_mov_b32 v26, 0xf149f2ca
    v_mov_b32 v27, 0xf149f2ca
    v_mov_b32 v28, 0xf149f2ca
    v_mov_b32 v29, 0xf149f2ca
    v_mov_b32 v30, 0xf149f2ca
    v_mov_b32 v31, 0xf149f2ca
    v_mov_b32 v32, 0xf149f2ca
    v_mov_b32 v33, 0xf149f2ca
    v_mov_b32 v34, 0xf149f2ca
    v_mov_b32 v35, 0xf149f2ca
    v_mov_b32 v36, 0xf149f2ca
    v_mov_b32 v37, 0xf149f2ca
    v_mov_b32 v38, 0xf149f2ca
    v_mov_b32 v39, 0xf149f2ca
ng_55:
    s_waitcnt lgkmcnt(2)
    s_nop 0
    v_mfma_f32_32x32x16_bf16 v[72:87], v[112:115], v[4:7], v[24:39]
    v_mfma_f32_32x32x16_bf16 v[72:87], v[116:119], v[8:11], v[72:87]
    s_cmp_lg_u32 s26, 0
    s_cbranch_scc1 sk_56
    s_xor_b32 s96, s29, 0
    s_and_b32 s97, s96, 2
    s_and_b32 s96, s96, 3
    s_mul_i32 s97, s97, 14336
    s_mul_i32 s96, s96, 14336
    s_add_u32 s96, s96, s97
    s_add_u32 s96, s96, 7168
    buffer_load_dwordx4 v[160:163], v155, s[80:83], s96 offen
sk_56:
    ds_read_b128 v[112:115], v20 offset:20480
    ds_read_b128 v[116:119], v20 offset:21504
    s_cmp_eq_u32 s99, 1
    s_cbranch_scc0 ng_57
    v_mov_b32 v24, 0xf149f2ca
    v_mov_b32 v25, 0xf149f2ca
    v_mov_b32 v26, 0xf149f2ca
    v_mov_b32 v27, 0xf149f2ca
    v_mov_b32 v28, 0xf149f2ca
    v_mov_b32 v29, 0xf149f2ca
    v_mov_b32 v30, 0xf149f2ca
    v_mov_b32 v31, 0xf149f2ca
    v_mov_b32 v32, 0xf149f2ca
    v_mov_b32 v33, 0xf149f2ca
    v_mov_b32 v34, 0xf149f2ca
    v_mov_b32 v35, 0xf149f2ca
    v_mov_b32 v36, 0xf149f2ca
    v_mov_b32 v37, 0xf149f2ca
    v_mov_b32 v38, 0xf149f2ca
    v_mov_b32 v39, 0xf149f2ca
ng_57:
    s_waitcnt lgkmcnt(2)
    s_nop 0
    v_mfma_f32_32x32x16_bf16 v[56:71], v[104:107], v[4:7], v[24:39]
    v_mfma_f32_32x32x16_bf16 v[56:71], v[108:111], v[8:11], v[56:71]
    s_nop 1
    v_max_f32 v21, v72, v73
    v_max3_f32 v21, v21, v74, v75
    v_max3_f32 v21, v21, v76, v77
    v_max3_f32 v21, v21, v78, v79
    v_max3_f32 v21, v21, v80, v81
    v_max3_f32 v21, v21, v82, v83
    v_max3_f32 v21, v21, v84, v85
    v_max3_f32 v21, v21, v86, v87
    s_cmp_lg_u32 s26, 0
    s_cbranch_scc1 sk_58
    s_xor_b32 s96, s29, 1
    s_and_b32 s97, s96, 2
    s_and_b32 s96, s96, 3
    s_mul_i32 s97, s97, 14336
    s_mul_i32 s96, s96, 14336
    s_add_u32 s96, s96, s97
    buffer_load_dwordx4 v[164:167], v155, s[80:83], s96 offen
sk_58:
    ds_read_b128 v[104:107], v20 offset:16384
    ds_read_b128 v[108:111], v20 offset:17408
    s_cmp_eq_u32 s99, 2
    s_cbranch_scc0 ng_59
    v_mov_b32 v24, 0xf149f2ca
    v_mov_b32 v25, 0xf149f2ca
    v_mov_b32 v26, 0xf149f2ca
    v_mov_b32 v27, 0xf149f2ca
    v_mov_b32 v28, 0xf149f2ca
    v_mov_b32 v29, 0xf149f2ca
    v_mov_b32 v30, 0xf149f2ca
    v_mov_b32 v31, 0xf149f2ca
    v_mov_b32 v32, 0xf149f2ca
    v_mov_b32 v33, 0xf149f2ca
    v_mov_b32 v34, 0xf149f2ca
    v_mov_b32 v35, 0xf149f2ca
    v_mov_b32 v36, 0xf149f2ca
    v_mov_b32 v37, 0xf149f2ca
    v_mov_b32 v38, 0xf149f2ca
    v_mov_b32 v39, 0xf149f2ca
ng_59:
    s_waitcnt lgkmcnt(2)
    s_nop 0
    v_mfma_f32_32x32x16_bf16 v[72:87], v[112:115], v[4:7], v[24:39]
    v_mfma_f32_32x32x16_bf16 v[72:87], v[116:119], v[8:11], v[72:87]
    v_max3_f32 v21, v21, v56, v57
    v_max3_f32 v21, v21, v58, v59
    v_max3_f32 v21, v21, v60, v61
    v_max3_f32 v21, v21, v62, v63
    v_max3_f32 v21, v21, v64, v65
    v_max3_f32 v21, v21, v66, v67
    v_max3_f32 v21, v21, v68, v69
    v_max3_f32 v21, v21, v70, v71
    s_cmp_lg_u32 s26, 0
    s_cbranch_scc1 sk_60
    s_xor_b32 s96, s29, 1
    s_and_b32 s97, s96, 2
    s_and_b32 s96, s96, 3
    s_mul_i32 s97, s97, 14336
    s_mul_i32 s96, s96, 14336
    s_add_u32 s96, s96, s97
    s_add_u32 s96, s96, 7168
    buffer_load_dwordx4 v[168:171], v155, s[80:83], s96 offen
sk_60:
    ds_read_b128 v[112:115], v20 offset:12288
    ds_read_b128 v[116:119], v20 offset:13312
    s_cmp_eq_u32 s99, 3
    s_cbranch_scc0 ng_61
    v_mov_b32 v24, 0xf149f2ca
    v_mov_b32 v25, 0xf149f2ca
    v_mov_b32 v26, 0xf149f2ca
    v_mov_b32 v27, 0xf149f2ca
    v_mov_b32 v28, 0xf149f2ca
    v_mov_b32 v29, 0xf149f2ca
    v_mov_b32 v30, 0xf149f2ca
    v_mov_b32 v31, 0xf149f2ca
    v_mov_b32 v32, 0xf149f2ca
    v_mov_b32 v33, 0xf149f2ca
    v_mov_b32 v34, 0xf149f2ca
    v_mov_b32 v35, 0xf149f2ca
    v_mov_b32 v36, 0xf149f2ca
    v_mov_b32 v37, 0xf149f2ca
    v_mov_b32 v38, 0xf149f2ca
    v_mov_b32 v39, 0xf149f2ca
ng_61:
    s_waitcnt lgkmcnt(2)
    s_nop 0
    v_mfma_f32_32x32x16_bf16 v[56:71], v[104:107], v[4:7], v[24:39]
    v_mfma_f32_32x32x16_bf16 v[56:71], v[108:111], v[8:11], v[56:71]
    v_max3_f32 v21, v21, v72, v73
    v_max3_f32 v21, v21, v74, v75
    v_max3_f32 v21, v21, v76, v77
    v_max3_f32 v21, v21, v78, v79
    v_max3_f32 v21, v21, v80, v81
    v_max3_f32 v21, v21, v82, v83
    v_max3_f32 v21, v21, v84, v85
    v_max3_f32 v21, v21, v86, v87
    s_cmp_lg_u32 s26, 0
    s_cbranch_scc1 sk_62
    s_xor_b32 s96, s29, 2
    s_and_b32 s97, s96, 2
    s_and_b32 s96, s96, 3
    s_mul_i32 s97, s97, 14336
    s_mul_i32 s96, s96, 14336
    s_add_u32 s96, s96, s97
    buffer_load_dwordx4 v[172:175], v155, s[80:83], s96 offen
sk_62:
    ds_read_b128 v[104:107], v20 offset:8192
    ds_read_b128 v[108:111], v20 offset:9216
    s_cmp_eq_u32 s99, 4
    s_cbranch_scc0 ng_63
    v_mov_b32 v24, 0xf149f2ca
    v_mov_b32 v25, 0xf149f2ca
    v_mov_b32 v26, 0xf149f2ca
    v_mov_b32 v27, 0xf149f2ca
    v_mov_b32 v28, 0xf149f2ca
    v_mov_b32 v29, 0xf149f2ca
    v_mov_b32 v30, 0xf149f2ca
    v_mov_b32 v31, 0xf149f2ca
    v_mov_b32 v32, 0xf149f2ca
    v_mov_b32 v33, 0xf149f2ca
    v_mov_b32 v34, 0xf149f2ca
    v_mov_b32 v35, 0xf149f2ca
    v_mov_b32 v36, 0xf149f2ca
    v_mov_b32 v37, 0xf149f2ca
    v_mov_b32 v38, 0xf149f2ca
    v_mov_b32 v39, 0xf149f2ca
ng_63:
    s_waitcnt lgkmcnt(2)
    s_nop 0
    v_mfma_f32_32x32x16_bf16 v[72:87], v[112:115], v[4:7], v[24:39]
    v_mfma_f32_32x32x16_bf16 v[72:87], v[116:119], v[8:11], v[72:87]
    v_max3_f32 v21, v21, v56, v57
    v_max3_f32 v21, v21, v58, v59
    v_max3_f32 v21, v21, v60, v61
    v_max3_f32 v21, v21, v62, v63
    v_max3_f32 v21, v21, v64, v65
    v_max3_f32 v21, v21, v66, v67
    v_max3_f32 v21, v21, v68, v69
    v_max3_f32 v21, v21, v70, v71
    s_cmp_lg_u32 s26, 0
    s_cbranch_scc1 sk_64
    s_xor_b32 s96, s29, 2
    s_and_b32 s97, s96, 2
    s_and_b32 s96, s96, 3
    s_mul_i32 s97, s97, 14336
    s_mul_i32 s96, s96, 14336
    s_add_u32 s96, s96, s97
    s_add_u32 s96, s96, 7168
    buffer_load_dwordx4 v[176:179], v155, s[80:83], s96 offen
sk_64:
    ds_read_b128 v[112:115], v20 offset:4096
    ds_read_b128 v[116:119], v20 offset:5120
    s_cmp_eq_u32 s99, 5
    s_cbranch_scc0 ng_65
    v_mov_b32 v24, 0xf149f2ca
    v_mov_b32 v25, 0xf149f2ca
    v_mov_b32 v26, 0xf149f2ca
    v_mov_b32 v27, 0xf149f2ca
    v_mov_b32 v28, 0xf149f2ca
    v_mov_b32 v29, 0xf149f2ca
    v_mov_b32 v30, 0xf149f2ca
    v_mov_b32 v31, 0xf149f2ca
    v_mov_b32 v32, 0xf149f2ca
    v_mov_b32 v33, 0xf149f2ca
    v_mov_b32 v34, 0xf149f2ca
    v_mov_b32 v35, 0xf149f2ca
    v_mov_b32 v36, 0xf149f2ca
    v_mov_b32 v37, 0xf149f2ca
    v_mov_b32 v38, 0xf149f2ca
    v_mov_b32 v39, 0xf149f2ca
ng_65:
    s_waitcnt lgkmcnt(2)
    s_nop 0
    v_mfma_f32_32x32x16_bf16 v[56:71], v[104:107], v[4:7], v[24:39]
    v_mfma_f32_32x32x16_bf16 v[56:71], v[108:111], v[8:11], v[56:71]
    v_max3_f32 v21, v21, v72, v73
    v_max3_f32 v21, v21, v74, v75
    v_max3_f32 v21, v21, v76, v77
    v_max3_f32 v21, v21, v78, v79
    v_max3_f32 v21, v21, v80, v81
    v_max3_f32 v21, v21, v82, v83
    v_max3_f32 v21, v21, v84, v85
    v_max3_f32 v21, v21, v86, v87
    s_cmp_lg_u32 s26, 0
    s_cbranch_scc1 sk_66
    s_xor_b32 s96, s29, 3
    s_and_b32 s97, s96, 2
    s_and_b32 s96, s96, 3
    s_mul_i32 s97, s97, 14336
    s_mul_i32 s96, s96, 14336
    s_add_u32 s96, s96, s97
    buffer_load_dwordx4 v[180:183], v155, s[80:83], s96 offen
sk_66:
    ds_read_b128 v[104:107], v20 offset:0
    ds_read_b128 v[108:111], v20 offset:1024
    s_cmp_eq_u32 s99, 6
    s_cbranch_scc0 ng_67
    v_mov_b32 v24, 0xf149f2ca
    v_mov_b32 v25, 0xf149f2ca
    v_mov_b32 v26, 0xf149f2ca
    v_mov_b32 v27, 0xf149f2ca
    v_mov_b32 v28, 0xf149f2ca
    v_mov_b32 v29, 0xf149f2ca
    v_mov_b32 v30, 0xf149f2ca
    v_mov_b32 v31, 0xf149f2ca
    v_mov_b32 v32, 0xf149f2ca
    v_mov_b32 v33, 0xf149f2ca
    v_mov_b32 v34, 0xf149f2ca
    v_mov_b32 v35, 0xf149f2ca
    v_mov_b32 v36, 0xf149f2ca
    v_mov_b32 v37, 0xf149f2ca
    v_mov_b32 v38, 0xf149f2ca
    v_mov_b32 v39, 0xf149f2ca
ng_67:
    s_waitcnt lgkmcnt(2)
    s_nop 0
    v_mfma_f32_32x32x16_bf16 v[72:87], v[112:115], v[4:7], v[24:39]
    v_mfma_f32_32x32x16_bf16 v[72:87], v[116:119], v[8:11], v[72:87]
    v_max3_f32 v21, v21, v56, v57
    v_max3_f32 v21, v21, v58, v59
    v_max3_f32 v21, v21, v60, v61
    v_max3_f32 v21, v21, v62, v63
    v_max3_f32 v21, v21, v64, v65
    v_max3_f32 v21, v21, v66, v67
    v_max3_f32 v21, v21, v68, v69
    v_max3_f32 v21, v21, v70, v71
    s_cmp_lg_u32 s26, 0
    s_cbranch_scc1 sk_68
    s_xor_b32 s96, s29, 3
    s_and_b32 s97, s96, 2
    s_and_b32 s96, s96, 3
    s_mul_i32 s97, s97, 14336
    s_mul_i32 s96, s96, 14336
    s_add_u32 s96, s96, s97
    s_add_u32 s96, s96, 7168
    buffer_load_dwordx4 v[184:187], v155, s[80:83], s96 offen
sk_68:
    s_cmp_eq_u32 s99, 7
    s_cbranch_scc0 ng_69
    v_mov_b32 v24, 0xf149f2ca
    v_mov_b32 v25, 0xf149f2ca
    v_mov_b32 v26, 0xf149f2ca
    v_mov_b32 v27, 0xf149f2ca
    v_mov_b32 v28, 0xf149f2ca
    v_mov_b32 v29, 0xf149f2ca
    v_mov_b32 v30, 0xf149f2ca
    v_mov_b32 v31, 0xf149f2ca
    v_mov_b32 v32, 0xf149f2ca
    v_mov_b32 v33, 0xf149f2ca
    v_mov_b32 v34, 0xf149f2ca
    v_mov_b32 v35, 0xf149f2ca
    v_mov_b32 v36, 0xf149f2ca
    v_mov_b32 v37, 0xf149f2ca
    v_mov_b32 v38, 0xf149f2ca
    v_mov_b32 v39, 0xf149f2ca
ng_69:
    s_waitcnt lgkmcnt(0)
    s_nop 0
    v_mfma_f32_32x32x16_bf16 v[56:71], v[104:107], v[4:7], v[24:39]
    v_mfma_f32_32x32x16_bf16 v[56:71], v[108:111], v[8:11], v[56:71]
    v_max3_f32 v21, v21, v72, v73
    v_max3_f32 v21, v21, v74, v75
    v_max3_f32 v21, v21, v76, v77
    v_max3_f32 v21, v21, v78, v79
    v_max3_f32 v21, v21, v80, v81
    v_max3_f32 v21, v21, v82, v83
    v_max3_f32 v21, v21, v84, v85
    v_max3_f32 v21, v21, v86, v87
    s_cmp_lg_u32 s26, 0
    s_cbranch_scc1 sk_70
    s_xor_b32 s96, s29, 0
    s_and_b32 s97, s96, 2
    s_and_b32 s96, s96, 3
    s_mul_i32 s97, s97, 14336
    s_mul_i32 s96, s96, 14336
    s_add_u32 s96, s96, s97
    buffer_load_dwordx4 v[188:191], v155, s[4:7], s96 offen
sk_70:
    ds_read_b128 v[112:115], v20 offset:28672
    ds_read_b128 v[116:119], v20 offset:29696
    ds_read_b128 v[120:123], v20 offset:34816
    ds_read_b128 v[124:127], v20 offset:35840
    ds_read_b128 v[128:131], v20 offset:2048
    ds_read_b128 v[132:135], v20 offset:3072
    v_cndmask_b32 v40, v56, v40, s[40:41]
    v_cndmask_b32 v41, v57, v41, s[42:43]
    v_cndmask_b32 v42, v58, v42, s[44:45]
    v_cndmask_b32 v43, v59, v43, s[46:47]
    v_cndmask_b32 v44, v60, v44, s[48:49]
    v_cndmask_b32 v45, v61, v45, s[50:51]
    v_cndmask_b32 v46, v62, v46, s[52:53]
    v_cndmask_b32 v47, v63, v47, s[54:55]
    v_cndmask_b32 v48, v64, v48, s[56:57]
    v_cndmask_b32 v49, v65, v49, s[58:59]
    v_cndmask_b32 v50, v66, v50, s[60:61]
    v_cndmask_b32 v51, v67, v51, s[62:63]
    v_cndmask_b32 v52, v68, v52, s[64:65]
    v_cndmask_b32 v53, v69, v53, s[66:67]
    v_cndmask_b32 v54, v70, v54, s[68:69]
    v_cndmask_b32 v55, v71, v55, s[70:71]
    v_max3_f32 v21, v21, v40, v41
    v_max3_f32 v21, v21, v42, v43
    v_max3_f32 v21, v21, v44, v45
    v_max3_f32 v21, v21, v46, v47
    v_max3_f32 v21, v21, v48, v49
    v_max3_f32 v21, v21, v50, v51
    v_max3_f32 v21, v21, v52, v53
    v_max3_f32 v21, v21, v54, v55
    v_mov_b32 v152, v21
    s_nop 1
    v_permlane32_swap_b32 v21, v152
    v_max_f32 v21, v21, v152
    v_sub_f32 v24, 0, v21
    v_sub_f32 v25, 0, v21
    v_sub_f32 v26, 0, v21
    v_sub_f32 v27, 0, v21
    v_sub_f32 v28, 0, v21
    v_sub_f32 v29, 0, v21
    v_sub_f32 v30, 0, v21
    v_sub_f32 v31, 0, v21
    v_sub_f32 v32, 0, v21
    v_sub_f32 v33, 0, v21
    v_sub_f32 v34, 0, v21
    v_sub_f32 v35, 0, v21
    v_sub_f32 v36, 0, v21
    v_sub_f32 v37, 0, v21
    v_sub_f32 v38, 0, v21
    v_sub_f32 v39, 0, v21
    s_cmp_eq_u32 s99, 0
    s_cbranch_scc0 ng_71
    v_mov_b32 v24, 0xf149f2ca
    v_mov_b32 v25, 0xf149f2ca
    v_mov_b32 v26, 0xf149f2ca
    v_mov_b32 v27, 0xf149f2ca
    v_mov_b32 v28, 0xf149f2ca
    v_mov_b32 v29, 0xf149f2ca
    v_mov_b32 v30, 0xf149f2ca
    v_mov_b32 v31, 0xf149f2ca
    v_mov_b32 v32, 0xf149f2ca
    v_mov_b32 v33, 0xf149f2ca
    v_mov_b32 v34, 0xf149f2ca
    v_mov_b32 v35, 0xf149f2ca
    v_mov_b32 v36, 0xf149f2ca
    v_mov_b32 v37, 0xf149f2ca
    v_mov_b32 v38, 0xf149f2ca
    v_mov_b32 v39, 0xf149f2ca
ng_71:
    s_waitcnt lgkmcnt(4)
    s_nop 0
    v_mfma_f32_32x32x16_bf16 v[72:87], v[112:115], v[4:7], v[24:39]
    v_mfma_f32_32x32x16_bf16 v[72:87], v[116:119], v[8:11], v[72:87]
    ds_read_b128 v[104:107], v20 offset:24576
    ds_read_b128 v[108:111], v20 offset:25600
    v_sub_f32 v40, v40, v21
    v_sub_f32 v41, v41, v21
    v_sub_f32 v42, v42, v21
    v_sub_f32 v43, v43, v21
    v_sub_f32 v44, v44, v21
    v_sub_f32 v45, v45, v21
    v_sub_f32 v46, v46, v21
    v_sub_f32 v47, v47, v21
    v_sub_f32 v48, v48, v21
    v_sub_f32 v49, v49, v21
    v_sub_f32 v50, v50, v21
    v_sub_f32 v51, v51, v21
    v_sub_f32 v52, v52, v21
    v_sub_f32 v53, v53, v21
    v_sub_f32 v54, v54, v21
    v_sub_f32 v55, v55, v21
    v_exp_f32 v40, v40
    v_exp_f32 v41, v41
    v_exp_f32 v42, v42
    v_exp_f32 v43, v43
    v_exp_f32 v44, v44
    v_exp_f32 v45, v45
    v_exp_f32 v46, v46
    v_exp_f32 v47, v47
    v_exp_f32 v48, v48
    v_exp_f32 v49, v49
    v_exp_f32 v50, v50
    v_exp_f32 v51, v51
    v_exp_f32 v52, v52
    v_exp_f32 v53, v53
    v_exp_f32 v54, v54
    v_exp_f32 v55, v55
    v_add_f32 v22, v40, v41
    v_add_f32 v23, v42, v43
    v_add_f32 v22, v22, v44
    v_add_f32 v23, v23, v45
    v_add_f32 v22, v22, v46
    v_add_f32 v23, v23, v47
    v_add_f32 v22, v22, v48
    v_add_f32 v23, v23, v49
    v_add_f32 v22, v22, v50
    v_add_f32 v23, v23, v51
    v_add_f32 v22, v22, v52
    v_add_f32 v23, v23, v53
    v_add_f32 v22, v22, v54
    v_add_f32 v23, v23, v55
    v_cvt_pk_bf16_f32 v144, v40, v41
    v_cvt_pk_bf16_f32 v145, v42, v43
    v_cvt_pk_bf16_f32 v146, v44, v45
    v_cvt_pk_bf16_f32 v147, v46, v47
    v_cvt_pk_bf16_f32 v148, v48, v49
    v_cvt_pk_bf16_f32 v149, v50, v51
    v_cvt_pk_bf16_f32 v150, v52, v53
    v_cvt_pk_bf16_f32 v151, v54, v55
    v_and_b32 v136, v144, v12
    v_and_b32 v137, v145, v13
    v_and_b32 v138, v146, v14
    v_and_b32 v139, v147, v15
    v_and_b32 v140, v148, v16
    v_and_b32 v141, v149, v17
    v_and_b32 v142, v150, v18
    v_and_b32 v143, v151, v19
    v_xor_b32 v144, v144, v136
    v_xor_b32 v145, v145, v137
    v_xor_b32 v146, v146, v138
    v_xor_b32 v147, v147, v139
    v_xor_b32 v148, v148, v140
    v_xor_b32 v149, v149, v141
    v_xor_b32 v150, v150, v142
    v_xor_b32 v151, v151, v143
    s_waitcnt lgkmcnt(2)
    v_mfma_f32_32x32x16_bf16 v[88:103], v[120:123], v[136:139], 0
    v_mfma_f32_32x32x16_bf16 v[88:103], v[124:127], v[140:143], v[88:103]
    v_mfma_f32_32x32x16_bf16 v[88:103], v[128:131], v[144:147], v[88:103]
    v_mfma_f32_32x32x16_bf16 v[88:103], v[132:135], v[148:151], v[88:103]
    s_cmp_lg_u32 s26, 0
    s_cbranch_scc1 sk_72
    s_xor_b32 s96, s29, 0
    s_and_b32 s97, s96, 2
    s_and_b32 s96, s96, 3
    s_mul_i32 s97, s97, 14336
    s_mul_i32 s96, s96, 14336
    s_add_u32 s96, s96, s97
    s_add_u32 s96, s96, 7168
    buffer_load_dwordx4 v[192:195], v155, s[4:7], s96 offen
sk_72:
    ds_read_b128 v[128:131], v20 offset:30720
    ds_read_b128 v[132:135], v20 offset:31744
    s_cmp_eq_u32 s99, 1
    s_cbranch_scc0 ng_73
    v_mov_b32 v24, 0xf149f2ca
    v_mov_b32 v25, 0xf149f2ca
    v_mov_b32 v26, 0xf149f2ca
    v_mov_b32 v27, 0xf149f2ca
    v_mov_b32 v28, 0xf149f2ca
    v_mov_b32 v29, 0xf149f2ca
    v_mov_b32 v30, 0xf149f2ca
    v_mov_b32 v31, 0xf149f2ca
    v_mov_b32 v32, 0xf149f2ca
    v_mov_b32 v33, 0xf149f2ca
    v_mov_b32 v34, 0xf149f2ca
    v_mov_b32 v35, 0xf149f2ca
    v_mov_b32 v36, 0xf149f2ca
    v_mov_b32 v37, 0xf149f2ca
    v_mov_b32 v38, 0xf149f2ca
    v_mov_b32 v39, 0xf149f2ca
ng_73:
    s_waitcnt lgkmcnt(2)
    s_nop 0
    v_mfma_f32_32x32x16_bf16 v[56:71], v[104:107], v[4:7], v[24:39]
    v_mfma_f32_32x32x16_bf16 v[56:71], v[108:111], v[8:11], v[56:71]
    ds_read_b128 v[112:115], v20 offset:20480
    ds_read_b128 v[116:119], v20 offset:21504
    v_exp_f32 v72, v72
    v_exp_f32 v73, v73
    v_exp_f32 v74, v74
    v_exp_f32 v75, v75
    v_exp_f32 v76, v76
    v_exp_f32 v77, v77
    v_exp_f32 v78, v78
    v_exp_f32 v79, v79
    v_exp_f32 v80, v80
    v_exp_f32 v81, v81
    v_exp_f32 v82, v82
    v_exp_f32 v83, v83
    v_exp_f32 v84, v84
    v_exp_f32 v85, v85
    v_exp_f32 v86, v86
    v_exp_f32 v87, v87
    v_add_f32 v22, v22, v72
    v_add_f32 v23, v23, v73
    v_add_f32 v22, v22, v74
    v_add_f32 v23, v23, v75
    v_add_f32 v22, v22, v76
    v_add_f32 v23, v23, v77
    v_add_f32 v22, v22, v78
    v_add_f32 v23, v23, v79
    v_add_f32 v22, v22, v80
    v_add_f32 v23, v23, v81
    v_add_f32 v22, v22, v82
    v_add_f32 v23, v23, v83
    v_add_f32 v22, v22, v84
    v_add_f32 v23, v23, v85
    v_add_f32 v22, v22, v86
    v_add_f32 v23, v23, v87
    v_cvt_pk_bf16_f32 v144, v72, v73
    v_cvt_pk_bf16_f32 v145, v74, v75
    v_cvt_pk_bf16_f32 v146, v76, v77
    v_cvt_pk_bf16_f32 v147, v78, v79
    v_cvt_pk_bf16_f32 v148, v80, v81
    v_cvt_pk_bf16_f32 v149, v82, v83
    v_cvt_pk_bf16_f32 v150, v84, v85
    v_cvt_pk_bf16_f32 v151, v86, v87
    s_waitcnt lgkmcnt(2)
    v_mfma_f32_32x32x16_bf16 v[88:103], v[128:131], v[144:147], v[88:103]
    v_mfma_f32_32x32x16_bf16 v[88:103], v[132:135], v[148:151], v[88:103]
    s_cmp_lg_u32 s26, 0
    s_cbranch_scc1 sk_74
    s_xor_b32 s96, s29, 1
    s_and_b32 s97, s96, 2
    s_and_b32 s96, s96, 3
    s_mul_i32 s97, s97, 14336
    s_mul_i32 s96, s96, 14336
    s_add_u32 s96, s96, s97
    buffer_load_dwordx4 v[196:199], v155, s[4:7], s96 offen
sk_74:
    ds_read_b128 v[120:123], v20 offset:26624
    ds_read_b128 v[124:127], v20 offset:27648
    s_cmp_eq_u32 s99, 2
    s_cbranch_scc0 ng_75
    v_mov_b32 v24, 0xf149f2ca
    v_mov_b32 v25, 0xf149f2ca
    v_mov_b32 v26, 0xf149f2ca
    v_mov_b32 v27, 0xf149f2ca
    v_mov_b32 v28, 0xf149f2ca
    v_mov_b32 v29, 0xf149f2ca
    v_mov_b32 v30, 0xf149f2ca
    v_mov_b32 v31, 0xf149f2ca
    v_mov_b32 v32, 0xf149f2ca
    v_mov_b32 v33, 0xf149f2ca
    v_mov_b32 v34, 0xf149f2ca
    v_mov_b32 v35, 0xf149f2ca
    v_mov_b32 v36, 0xf149f2ca
    v_mov_b32 v37, 0xf149f2ca
    v_mov_b32 v38, 0xf149f2ca
    v_mov_b32 v39, 0xf149f2ca
ng_75:
    s_waitcnt lgkmcnt(2)
    s_nop 0
    v_mfma_f32_32x32x16_bf16 v[72:87], v[112:115], v[4:7], v[24:39]
    v_mfma_f32_32x32x16_bf16 v[72:87], v[116:119], v[8:11], v[72:87]
    ds_read_b128 v[104:107], v20 offset:16384
    ds_read_b128 v[108:111], v20 offset:17408
    v_exp_f32 v56, v56
    v_exp_f32 v57, v57
    v_exp_f32 v58, v58
    v_exp_f32 v59, v59
    v_exp_f32 v60, v60
    v_exp_f32 v61, v61
    v_exp_f32 v62, v62
    v_exp_f32 v63, v63
    v_exp_f32 v64, v64
    v_exp_f32 v65, v65
    v_exp_f32 v66, v66
    v_exp_f32 v67, v67
    v_exp_f32 v68, v68
    v_exp_f32 v69, v69
    v_exp_f32 v70, v70
    v_exp_f32 v71, v71
    v_add_f32 v22, v22, v56
    v_add_f32 v23, v23, v57
    v_add_f32 v22, v22, v58
    v_add_f32 v23, v23, v59
    v_add_f32 v22, v22, v60
    v_add_f32 v23, v23, v61
    v_add_f32 v22, v22, v62
    v_add_f32 v23, v23, v63
    v_add_f32 v22, v22, v64
    v_add_f32 v23, v23, v65
    v_add_f32 v22, v22, v66
    v_add_f32 v23, v23, v67
    v_add_f32 v22, v22, v68
    v_add_f32 v23, v23, v69
    v_add_f32 v22, v22, v70
    v_add_f32 v23, v23, v71
    v_cvt_pk_bf16_f32 v136, v56, v57
    v_cvt_pk_bf16_f32 v137, v58, v59
    v_cvt_pk_bf16_f32 v138, v60, v61
    v_cvt_pk_bf16_f32 v139, v62, v63
    v_cvt_pk_bf16_f32 v140, v64, v65
    v_cvt_pk_bf16_f32 v141, v66, v67
    v_cvt_pk_bf16_f32 v142, v68, v69
    v_cvt_pk_bf16_f32 v143, v70, v71
    s_waitcnt lgkmcnt(2)
    v_mfma_f32_32x32x16_bf16 v[88:103], v[120:123], v[136:139], v[88:103]
    v_mfma_f32_32x32x16_bf16 v[88:103], v[124:127], v[140:143], v[88:103]
    s_cmp_lg_u32 s26, 0
    s_cbranch_scc1 sk_76
    s_xor_b32 s96, s29, 1
    s_and_b32 s97, s96, 2
    s_and_b32 s96, s96, 3
    s_mul_i32 s97, s97, 14336
    s_mul_i32 s96, s96, 14336
    s_add_u32 s96, s96, s97
    s_add_u32 s96, s96, 7168
    buffer_load_dwordx4 v[200:203], v155, s[4:7], s96 offen
sk_76:
    ds_read_b128 v[128:131], v20 offset:22528
    ds_read_b128 v[132:135], v20 offset:23552
    s_cmp_eq_u32 s99, 3
    s_cbranch_scc0 ng_77
    v_mov_b32 v24, 0xf149f2ca
    v_mov_b32 v25, 0xf149f2ca
    v_mov_b32 v26, 0xf149f2ca
    v_mov_b32 v27, 0xf149f2ca
    v_mov_b32 v28, 0xf149f2ca
    v_mov_b32 v29, 0xf149f2ca
    v_mov_b32 v30, 0xf149f2ca
    v_mov_b32 v31, 0xf149f2ca
    v_mov_b32 v32, 0xf149f2ca
    v_mov_b32 v33, 0xf149f2ca
    v_mov_b32 v34, 0xf149f2ca
    v_mov_b32 v35, 0xf149f2ca
    v_mov_b32 v36, 0xf149f2ca
    v_mov_b32 v37, 0xf149f2ca
    v_mov_b32 v38, 0xf149f2ca
    v_mov_b32 v39, 0xf149f2ca
ng_77:
    s_waitcnt lgkmcnt(2)
    s_nop 0
    v_mfma_f32_32x32x16_bf16 v[56:71], v[104:107], v[4:7], v[24:39]
    v_mfma_f32_32x32x16_bf16 v[56:71], v[108:111], v[8:11], v[56:71]
    ds_read_b128 v[112:115], v20 offset:12288
    ds_read_b128 v[116:119], v20 offset:13312
    v_exp_f32 v72, v72
    v_exp_f32 v73, v73
    v_exp_f32 v74, v74
    v_exp_f32 v75, v75
    v_exp_f32 v76, v76
    v_exp_f32 v77, v77
    v_exp_f32 v78, v78
    v_exp_f32 v79, v79
    v_exp_f32 v80, v80
    v_exp_f32 v81, v81
    v_exp_f32 v82, v82
    v_exp_f32 v83, v83
    v_exp_f32 v84, v84
    v_exp_f32 v85, v85
    v_exp_f32 v86, v86
    v_exp_f32 v87, v87
    v_add_f32 v22, v22, v72
    v_add_f32 v23, v23, v73
    v_add_f32 v22, v22, v74
    v_add_f32 v23, v23, v75
    v_add_f32 v22, v22, v76
    v_add_f32 v23, v23, v77
    v_add_f32 v22, v22, v78
    v_add_f32 v23, v23, v79
    v_add_f32 v22, v22, v80
    v_add_f32 v23, v23, v81
    v_add_f32 v22, v22, v82
    v_add_f32 v23, v23, v83
    v_add_f32 v22, v22, v84
    v_add_f32 v23, v23, v85
    v_add_f32 v22, v22, v86
    v_add_f32 v23, v23, v87
    v_cvt_pk_bf16_f32 v144, v72, v73
    v_cvt_pk_bf16_f32 v145, v74, v75
    v_cvt_pk_bf16_f32 v146, v76, v77
    v_cvt_pk_bf16_f32 v147, v78, v79
    v_cvt_pk_bf16_f32 v148, v80, v81
    v_cvt_pk_bf16_f32 v149, v82, v83
    v_cvt_pk_bf16_f32 v150, v84, v85
    v_cvt_pk_bf16_f32 v151, v86, v87
    s_waitcnt lgkmcnt(2)
    v_mfma_f32_32x32x16_bf16 v[88:103], v[128:131], v[144:147], v[88:103]
    v_mfma_f32_32x32x16_bf16 v[88:103], v[132:135], v[148:151], v[88:103]
    s_cmp_lg_u32 s26, 0
    s_cbranch_scc1 sk_78
    s_xor_b32 s96, s29, 2
    s_and_b32 s97, s96, 2
    s_and_b32 s96, s96, 3
    s_mul_i32 s97, s97, 14336
    s_mul_i32 s96, s96, 14336
    s_add_u32 s96, s96, s97
    buffer_load_dwordx4 v[204:207], v155, s[4:7], s96 offen
sk_78:
    ds_read_b128 v[120:123], v20 offset:18432
    ds_read_b128 v[124:127], v20 offset:19456
    s_cmp_eq_u32 s99, 4
    s_cbranch_scc0 ng_79
    v_mov_b32 v24, 0xf149f2ca
    v_mov_b32 v25, 0xf149f2ca
    v_mov_b32 v26, 0xf149f2ca
    v_mov_b32 v27, 0xf149f2ca
    v_mov_b32 v28, 0xf149f2ca
    v_mov_b32 v29, 0xf149f2ca
    v_mov_b32 v30, 0xf149f2ca
    v_mov_b32 v31, 0xf149f2ca
    v_mov_b32 v32, 0xf149f2ca
    v_mov_b32 v33, 0xf149f2ca
    v_mov_b32 v34, 0xf149f2ca
    v_mov_b32 v35, 0xf149f2ca
    v_mov_b32 v36, 0xf149f2ca
    v_mov_b32 v37, 0xf149f2ca
    v_mov_b32 v38, 0xf149f2ca
    v_mov_b32 v39, 0xf149f2ca
ng_79:
    s_waitcnt lgkmcnt(2)
    s_nop 0
    v_mfma_f32_32x32x16_bf16 v[72:87], v[112:115], v[4:7], v[24:39]
    v_mfma_f32_32x32x16_bf16 v[72:87], v[116:119], v[8:11], v[72:87]
    ds_read_b128 v[104:107], v20 offset:8192
    ds_read_b128 v[108:111], v20 offset:9216
    v_exp_f32 v56, v56
    v_exp_f32 v57, v57
    v_exp_f32 v58, v58
    v_exp_f32 v59, v59
    v_exp_f32 v60, v60
    v_exp_f32 v61, v61
    v_exp_f32 v62, v62
    v_exp_f32 v63, v63
    v_exp_f32 v64, v64
    v_exp_f32 v65, v65
    v_exp_f32 v66, v66
    v_exp_f32 v67, v67
    v_exp_f32 v68, v68
    v_exp_f32 v69, v69
    v_exp_f32 v70, v70
    v_exp_f32 v71, v71
    v_add_f32 v22, v22, v56
    v_add_f32 v23, v23, v57
    v_add_f32 v22, v22, v58
    v_add_f32 v23, v23, v59
    v_add_f32 v22, v22, v60
    v_add_f32 v23, v23, v61
    v_add_f32 v22, v22, v62
    v_add_f32 v23, v23, v63
    v_add_f32 v22, v22, v64
    v_add_f32 v23, v23, v65
    v_add_f32 v22, v22, v66
    v_add_f32 v23, v23, v67
    v_add_f32 v22, v22, v68
    v_add_f32 v23, v23, v69
    v_add_f32 v22, v22, v70
    v_add_f32 v23, v23, v71
    v_cvt_pk_bf16_f32 v136, v56, v57
    v_cvt_pk_bf16_f32 v137, v58, v59
    v_cvt_pk_bf16_f32 v138, v60, v61
    v_cvt_pk_bf16_f32 v139, v62, v63
    v_cvt_pk_bf16_f32 v140, v64, v65
    v_cvt_pk_bf16_f32 v141, v66, v67
    v_cvt_pk_bf16_f32 v142, v68, v69
    v_cvt_pk_bf16_f32 v143, v70, v71
    s_waitcnt lgkmcnt(2)
    v_mfma_f32_32x32x16_bf16 v[88:103], v[120:123], v[136:139], v[88:103]
    v_mfma_f32_32x32x16_bf16 v[88:103], v[124:127], v[140:143], v[88:103]
    s_barrier
    s_cmp_lg_u32 s26, 0
    s_cbranch_scc1 sk_80
    s_xor_b32 s96, s29, 2
    s_and_b32 s97, s96, 2
    s_and_b32 s96, s96, 3
    s_mul_i32 s97, s97, 14336
    s_mul_i32 s96, s96, 14336
    s_add_u32 s96, s96, s97
    s_add_u32 s96, s96, 7168
    buffer_load_dwordx4 v[208:211], v155, s[4:7], s96 offen
sk_80:
    ds_read_b128 v[128:131], v20 offset:14336
    ds_read_b128 v[132:135], v20 offset:15360
    s_cmp_eq_u32 s99, 5
    s_cbranch_scc0 ng_81
    v_mov_b32 v24, 0xf149f2ca
    v_mov_b32 v25, 0xf149f2ca
    v_mov_b32 v26, 0xf149f2ca
    v_mov_b32 v27, 0xf149f2ca
    v_mov_b32 v28, 0xf149f2ca
    v_mov_b32 v29, 0xf149f2ca
    v_mov_b32 v30, 0xf149f2ca
    v_mov_b32 v31, 0xf149f2ca
    v_mov_b32 v32, 0xf149f2ca
    v_mov_b32 v33, 0xf149f2ca
    v_mov_b32 v34, 0xf149f2ca
    v_mov_b32 v35, 0xf149f2ca
    v_mov_b32 v36, 0xf149f2ca
    v_mov_b32 v37, 0xf149f2ca
    v_mov_b32 v38, 0xf149f2ca
    v_mov_b32 v39, 0xf149f2ca
ng_81:
    s_waitcnt lgkmcnt(2)
    s_nop 0
    v_mfma_f32_32x32x16_bf16 v[56:71], v[104:107], v[4:7], v[24:39]
    v_mfma_f32_32x32x16_bf16 v[56:71], v[108:111], v[8:11], v[56:71]
    ds_read_b128 v[112:115], v20 offset:4096
    ds_read_b128 v[116:119], v20 offset:5120
    v_exp_f32 v72, v72
    v_exp_f32 v73, v73
    v_exp_f32 v74, v74
    v_exp_f32 v75, v75
    v_exp_f32 v76, v76
    v_exp_f32 v77, v77
    v_exp_f32 v78, v78
    v_exp_f32 v79, v79
    v_exp_f32 v80, v80
    v_exp_f32 v81, v81
    v_exp_f32 v82, v82
    v_exp_f32 v83, v83
    v_exp_f32 v84, v84
    v_exp_f32 v85, v85
    v_exp_f32 v86, v86
    v_exp_f32 v87, v87
    v_add_f32 v22, v22, v72
    v_add_f32 v23, v23, v73
    v_add_f32 v22, v22, v74
    v_add_f32 v23, v23, v75
    v_add_f32 v22, v22, v76
    v_add_f32 v23, v23, v77
    v_add_f32 v22, v22, v78
    v_add_f32 v23, v23, v79
    v_add_f32 v22, v22, v80
    v_add_f32 v23, v23, v81
    v_add_f32 v22, v22, v82
    v_add_f32 v23, v23, v83
    v_add_f32 v22, v22, v84
    v_add_f32 v23, v23, v85
    v_add_f32 v22, v22, v86
    v_add_f32 v23, v23, v87
    v_cvt_pk_bf16_f32 v144, v72, v73
    v_cvt_pk_bf16_f32 v145, v74, v75
    v_cvt_pk_bf16_f32 v146, v76, v77
    v_cvt_pk_bf16_f32 v147, v78, v79
    v_cvt_pk_bf16_f32 v148, v80, v81
    v_cvt_pk_bf16_f32 v149, v82, v83
    v_cvt_pk_bf16_f32 v150, v84, v85
    v_cvt_pk_bf16_f32 v151, v86, v87
    s_waitcnt lgkmcnt(2)
    v_mfma_f32_32x32x16_bf16 v[88:103], v[128:131], v[144:147], v[88:103]
    v_mfma_f32_32x32x16_bf16 v[88:103], v[132:135], v[148:151], v[88:103]
    s_cmp_lg_u32 s26, 0
    s_cbranch_scc1 sk_82
    s_xor_b32 s96, s29, 3
    s_and_b32 s97, s96, 2
    s_and_b32 s96, s96, 3
    s_mul_i32 s97, s97, 14336
    s_mul_i32 s96, s96, 14336
    s_add_u32 s96, s96, s97
    buffer_load_dwordx4 v[212:215], v155, s[4:7], s96 offen
sk_82:
    ds_read_b128 v[120:123], v20 offset:10240
    ds_read_b128 v[124:127], v20 offset:11264
    s_cmp_eq_u32 s99, 6
    s_cbranch_scc0 ng_83
    v_mov_b32 v24, 0xf149f2ca
    v_mov_b32 v25, 0xf149f2ca
    v_mov_b32 v26, 0xf149f2ca
    v_mov_b32 v27, 0xf149f2ca
    v_mov_b32 v28, 0xf149f2ca
    v_mov_b32 v29, 0xf149f2ca
    v_mov_b32 v30, 0xf149f2ca
    v_mov_b32 v31, 0xf149f2ca
    v_mov_b32 v32, 0xf149f2ca
    v_mov_b32 v33, 0xf149f2ca
    v_mov_b32 v34, 0xf149f2ca
    v_mov_b32 v35, 0xf149f2ca
    v_mov_b32 v36, 0xf149f2ca
    v_mov_b32 v37, 0xf149f2ca
    v_mov_b32 v38, 0xf149f2ca
    v_mov_b32 v39, 0xf149f2ca
ng_83:
    s_waitcnt lgkmcnt(2)
    s_nop 0
    v_mfma_f32_32x32x16_bf16 v[72:87], v[112:115], v[4:7], v[24:39]
    v_mfma_f32_32x32x16_bf16 v[72:87], v[116:119], v[8:11], v[72:87]
    v_exp_f32 v56, v56
    v_exp_f32 v57, v57
    v_exp_f32 v58, v58
    v_exp_f32 v59, v59
    v_exp_f32 v60, v60
    v_exp_f32 v61, v61
    v_exp_f32 v62, v62
    v_exp_f32 v63, v63
    v_exp_f32 v64, v64
    v_exp_f32 v65, v65
    v_exp_f32 v66, v66
    v_exp_f32 v67, v67
    v_exp_f32 v68, v68
    v_exp_f32 v69, v69
    v_exp_f32 v70, v70
    v_exp_f32 v71, v71
    v_add_f32 v22, v22, v56
    v_add_f32 v23, v23, v57
    v_add_f32 v22, v22, v58
    v_add_f32 v23, v23, v59
    v_add_f32 v22, v22, v60
    v_add_f32 v23, v23, v61
    v_add_f32 v22, v22, v62
    v_add_f32 v23, v23, v63
    v_add_f32 v22, v22, v64
    v_add_f32 v23, v23, v65
    v_add_f32 v22, v22, v66
    v_add_f32 v23, v23, v67
    v_add_f32 v22, v22, v68
    v_add_f32 v23, v23, v69
    v_add_f32 v22, v22, v70
    v_add_f32 v23, v23, v71
    v_cvt_pk_bf16_f32 v136, v56, v57
    v_cvt_pk_bf16_f32 v137, v58, v59
    v_cvt_pk_bf16_f32 v138, v60, v61
    v_cvt_pk_bf16_f32 v139, v62, v63
    v_cvt_pk_bf16_f32 v140, v64, v65
    v_cvt_pk_bf16_f32 v141, v66, v67
    v_cvt_pk_bf16_f32 v142, v68, v69
    v_cvt_pk_bf16_f32 v143, v70, v71
    s_waitcnt lgkmcnt(0)
    v_mfma_f32_32x32x16_bf16 v[88:103], v[120:123], v[136:139], v[88:103]
    v_mfma_f32_32x32x16_bf16 v[88:103], v[124:127], v[140:143], v[88:103]
    s_cmp_lg_u32 s26, 0
    s_cbranch_scc1 sk_84
    s_xor_b32 s96, s29, 3
    s_and_b32 s97, s96, 2
    s_and_b32 s96, s96, 3
    s_mul_i32 s97, s97, 14336
    s_mul_i32 s96, s96, 14336
    s_add_u32 s96, s96, s97
    s_add_u32 s96, s96, 7168
    buffer_load_dwordx4 v[216:219], v155, s[4:7], s96 offen
sk_84:
    ds_read_b128 v[128:131], v20 offset:6144
    ds_read_b128 v[132:135], v20 offset:7168
    v_exp_f32 v72, v72
    v_exp_f32 v73, v73
    v_exp_f32 v74, v74
    v_exp_f32 v75, v75
    v_exp_f32 v76, v76
    v_exp_f32 v77, v77
    v_exp_f32 v78, v78
    v_exp_f32 v79, v79
    v_exp_f32 v80, v80
    v_exp_f32 v81, v81
    v_exp_f32 v82, v82
    v_exp_f32 v83, v83
    v_exp_f32 v84, v84
    v_exp_f32 v85, v85
    v_exp_f32 v86, v86
    v_exp_f32 v87, v87
    v_add_f32 v22, v22, v72
    v_add_f32 v23, v23, v73
    v_add_f32 v22, v22, v74
    v_add_f32 v23, v23, v75
    v_add_f32 v22, v22, v76
    v_add_f32 v23, v23, v77
    v_add_f32 v22, v22, v78
    v_add_f32 v23, v23, v79
    v_add_f32 v22, v22, v80
    v_add_f32 v23, v23, v81
    v_add_f32 v22, v22, v82
    v_add_f32 v23, v23, v83
    v_add_f32 v22, v22, v84
    v_add_f32 v23, v23, v85
    v_add_f32 v22, v22, v86
    v_add_f32 v23, v23, v87
    v_cvt_pk_bf16_f32 v144, v72, v73
    v_cvt_pk_bf16_f32 v145, v74, v75
    v_cvt_pk_bf16_f32 v146, v76, v77
    v_cvt_pk_bf16_f32 v147, v78, v79
    v_cvt_pk_bf16_f32 v148, v80, v81
    v_cvt_pk_bf16_f32 v149, v82, v83
    v_cvt_pk_bf16_f32 v150, v84, v85
    v_cvt_pk_bf16_f32 v151, v86, v87
    s_waitcnt lgkmcnt(0)
    v_mfma_f32_32x32x16_bf16 v[88:103], v[128:131], v[144:147], v[88:103]
    v_mfma_f32_32x32x16_bf16 v[88:103], v[132:135], v[148:151], v[88:103]
    v_add_f32 v22, v22, v23
    v_mov_b32 v152, v22
    s_nop 1
    v_permlane32_swap_b32 v22, v152
    v_add_f32 v22, v22, v152
    v_rcp_f32 v22, v22
    s_lshl_b32 s36, s99, 16
    s_add_u32 s36, s36, 0x808000
    s_lshl_b32 s33, s25, 11
    s_add_u32 s33, s33, s36
    s_lshl_b32 s30, s24, 9
    s_lshl_b32 s31, s3, 6
    s_add_u32 s30, s30, s31
    s_add_u32 s30, s30, s26
    s_add_u32 s30, s30, 0xdd2000
    s_lshl_b32 s31, s25, 2
    s_add_u32 s31, s31, s30
    v_pk_mul_f32 v[88:89], v[88:89], v[22:23] op_sel_hi:[1,0]
    v_pk_mul_f32 v[90:91], v[90:91], v[22:23] op_sel_hi:[1,0]
    v_pk_mul_f32 v[92:93], v[92:93], v[22:23] op_sel_hi:[1,0]
    v_pk_mul_f32 v[94:95], v[94:95], v[22:23] op_sel_hi:[1,0]
    v_pk_mul_f32 v[96:97], v[96:97], v[22:23] op_sel_hi:[1,0]
    v_pk_mul_f32 v[98:99], v[98:99], v[22:23] op_sel_hi:[1,0]
    v_pk_mul_f32 v[100:101], v[100:101], v[22:23] op_sel_hi:[1,0]
    v_pk_mul_f32 v[102:103], v[102:103], v[22:23] op_sel_hi:[1,0]
    v_cvt_pk_bf16_f32 v88, v88, v89
    v_cvt_pk_bf16_f32 v89, v90, v91
    v_cvt_pk_bf16_f32 v90, v92, v93
    v_cvt_pk_bf16_f32 v91, v94, v95
    v_cvt_pk_bf16_f32 v92, v96, v97
    v_cvt_pk_bf16_f32 v93, v98, v99
    v_cvt_pk_bf16_f32 v94, v100, v101
    v_cvt_pk_bf16_f32 v95, v102, v103
    s_cmp_lg_u32 s77, 0
    s_cbranch_scc1 lc_85
    buffer_store_dwordx4 v[88:91], v253, s[20:23], s33 offen sc1
    buffer_store_dwordx4 v[92:95], v253, s[20:23], s33 offen offset:1024 sc1
    s_branch lc_86
lc_85:
    buffer_store_dwordx4 v[88:91], v253, s[20:23], s33 offen
    buffer_store_dwordx4 v[92:95], v253, s[20:23], s33 offen offset:1024
lc_86:
    v_mov_b32 v154, s88
    s_mov_b64 exec, 1
    s_waitcnt vmcnt(0)
    s_cmp_lg_u32 s77, 0
    s_cbranch_scc1 lc_87
    buffer_store_dword v154, v253, s[20:23], s31 offen sc1
    s_branch lc_88
lc_87:
    buffer_store_dword v154, v253, s[20:23], s31 offen
lc_88:
    s_mov_b64 exec, -1
    s_cmp_lg_u32 s26, 0
    s_cbranch_scc1 sk_89
    s_mov_b32 s96, 0
    buffer_load_dwordx4 v[220:223], v153, s[12:15], s96 offen
    s_mov_b32 s96, 2048
    buffer_load_dwordx4 v[224:227], v153, s[12:15], s96 offen
    s_mov_b32 s96, 4096
    buffer_load_dwordx4 v[228:231], v153, s[12:15], s96 offen
    s_mov_b32 s96, 6144
    buffer_load_dwordx4 v[232:235], v153, s[12:15], s96 offen
    s_mov_b32 s96, 8192
    buffer_load_dwordx4 v[236:239], v153, s[12:15], s96 offen
    s_mov_b32 s96, 10240
    buffer_load_dwordx4 v[240:243], v153, s[12:15], s96 offen
    s_mov_b32 s96, 12288
    buffer_load_dwordx4 v[244:247], v153, s[12:15], s96 offen
    s_mov_b32 s96, 14336
    buffer_load_dwordx4 v[248:251], v153, s[12:15], s96 offen
sk_89:
    v_bfe_u32 v20, v252, 3, 2
    v_lshrrev_b32 v21, 5, v252
    v_lshl_add_u32 v20, v21, 3, v20
    s_lshr_b32 s32, s28, 1
    s_lshl_b32 s32, s32, 4
    s_and_b32 s33, s28, 1
    s_lshl_b32 s33, s33, 2
    s_add_u32 s32, s32, s33
    v_add_u32 v20, s32, v20
    v_lshlrev_b32 v20, 11, v20
    v_lshrrev_b32 v21, 2, v252
    v_and_b32 v21, 4, v21
    v_xor_b32 v21, v21, v252
    v_and_b32 v21, 7, v21
    v_lshl_add_u32 v20, v21, 4, v20
    s_lshl_b32 s32, s98, 7
    v_add_u32 v14, s32, v20
    s_lshl_b32 s32, s28, 9
    s_sub_u32 s34, s29, 224
    s_lshl_b32 s34, s34, 1
    s_add_u32 s89, s34, s28
    s_and_b32 s35, s28, 1
    s_add_u32 s34, s34, s35
    s_lshl_b32 s34, s34, 5
    v_lshrrev_b32 v22, 1, v252
    v_and_b32 v23, 1, v252
    s_cmp_lt_u32 s29, 224
    s_cselect_b32 s32, s32, s34
    s_cselect_b64 vcc, -1, 0
    v_cndmask_b32 v22, v23, v22, vcc
    v_lshl_add_u32 v22, v22, 4, s32
    s_mov_b32 s79, s26
    s_cmp_lg_u32 s26, 0
    s_cbranch_scc1 sk_90
    s_waitcnt vmcnt(0)
    s_getpc_b64 s[32:33]
pc_91:
    s_sub_u32 s32, s32, pc_91-interleave_layers__sliding_block__moe_arch_mod__prompt_kernel
    s_subb_u32 s33, s33, 0
    s_lshr_b32 s34, s2, 3
    s_lshl_b32 s34, s34, 2
    s_add_u32 s34, s34, s28
    s_and_b32 s34, s34, 127
    s_lshl_b32 s34, s34, 7
    v_lshl_add_u32 v19, v252, 14, s34
    s_mov_b32 s34, k_exit-interleave_layers__sliding_block__moe_arch_mod__prompt_kernel
    s_mov_b32 s35, 0x20000
    buffer_load_dword v19, v19, s[32:35], 0 offen
    s_lshr_b32 s30, s16, 7
    s_sub_u32 s30, 3, s30
    s_and_b32 s30, s30, 7
    s_and_b32 s31, s24, 1
    s_lshl_b32 s31, s31, 3
    s_add_u32 s30, s30, s31
    s_and_b32 s31, s24, 14
    s_add_u32 s35, s31, s30
    s_lshl_b32 s31, s25, 2
    s_add_u32 s31, s31, s28
    s_mul_i32 s31, s31, 6144
    s_lshl_b32 s30, s30, 7
    s_add_u32 s30, s30, s31
    v_min_u32 v18, 2, v252
    v_lshl_add_u32 v18, v18, 11, s30
    s_add_u32 s30, s35, 14
    s_and_b32 s30, s30, 15
    s_mul_i32 s30, s30, 393216
    buffer_load_dword v19, v18, s[16:19], s30 offen
    s_add_u32 s30, s35, 15
    s_and_b32 s30, s30, 15
    s_mul_i32 s30, s30, 393216
    buffer_load_dword v19, v18, s[16:19], s30 offen
    s_add_u32 s30, s35, 0
    s_and_b32 s30, s30, 15
    s_mul_i32 s30, s30, 393216
    buffer_load_dword v19, v18, s[16:19], s30 offen
    s_add_u32 s30, s35, 1
    s_and_b32 s30, s30, 15
    s_mul_i32 s30, s30, 393216
    buffer_load_dword v19, v18, s[16:19], s30 offen
    s_add_u32 s30, s35, 2
    s_and_b32 s30, s30, 15
    s_mul_i32 s30, s30, 393216
    buffer_load_dword v19, v18, s[16:19], s30 offen
    s_add_u32 s30, s35, 3
    s_and_b32 s30, s30, 15
    s_mul_i32 s30, s30, 393216
    buffer_load_dword v19, v18, s[16:19], s30 offen
    s_mov_b32 s30, 0x05040100
    s_mov_b32 s31, 0x07060302
    v_perm_b32 v155, v160, v156, s30
    v_perm_b32 v160, v160, v156, s31
    v_perm_b32 v156, v161, v157, s30
    v_perm_b32 v161, v161, v157, s31
    v_perm_b32 v157, v162, v158, s30
    v_perm_b32 v162, v162, v158, s31
    v_perm_b32 v158, v163, v159, s30
    v_perm_b32 v163, v163, v159, s31
    v_perm_b32 v159, v168, v164, s30
    v_perm_b32 v168, v168, v164, s31
    v_perm_b32 v164, v169, v165, s30
    v_perm_b32 v169, v169, v165, s31
    v_perm_b32 v165, v170, v166, s30
    v_perm_b32 v170, v170, v166, s31
    v_perm_b32 v166, v171, v167, s30
    v_perm_b32 v171, v171, v167, s31
    v_perm_b32 v167, v176, v172, s30
    v_perm_b32 v176, v176, v172, s31
    v_perm_b32 v172, v177, v173, s30
    v_perm_b32 v177, v177, v173, s31
    v_perm_b32 v173, v178, v174, s30
    v_perm_b32 v178, v178, v174, s31
    v_perm_b32 v174, v179, v175, s30
    v_perm_b32 v179, v179, v175, s31
    v_perm_b32 v175, v184, v180, s30
    v_perm_b32 v184, v184, v180, s31
    v_perm_b32 v180, v185, v181, s30
    v_perm_b32 v185, v185, v181, s31
    v_perm_b32 v181, v186, v182, s30
    v_perm_b32 v186, v186, v182, s31
    v_perm_b32 v182, v187, v183, s30
    v_perm_b32 v187, v187, v183, s31
    v_perm_b32 v183, v192, v188, s30
    v_perm_b32 v192, v192, v188, s31
    v_perm_b32 v188, v193, v189, s30
    v_perm_b32 v193, v193, v189, s31
    v_perm_b32 v189, v194, v190, s30
    v_perm_b32 v194, v194, v190, s31
    v_perm_b32 v190, v195, v191, s30
    v_perm_b32 v195, v195, v191, s31
    v_perm_b32 v191, v200, v196, s30
    v_perm_b32 v200, v200, v196, s31
    v_perm_b32 v196, v201, v197, s30
    v_perm_b32 v201, v201, v197, s31
    v_perm_b32 v197, v202, v198, s30
    v_perm_b32 v202, v202, v198, s31
    v_perm_b32 v198, v203, v199, s30
    v_perm_b32 v203, v203, v199, s31
    v_perm_b32 v199, v208, v204, s30
    v_perm_b32 v208, v208, v204, s31
    v_perm_b32 v204, v209, v205, s30
    v_perm_b32 v209, v209, v205, s31
    v_perm_b32 v205, v210, v206, s30
    v_perm_b32 v210, v210, v206, s31
    v_perm_b32 v206, v211, v207, s30
    v_perm_b32 v211, v211, v207, s31
    v_perm_b32 v207, v216, v212, s30
    v_perm_b32 v216, v216, v212, s31
    v_perm_b32 v212, v217, v213, s30
    v_perm_b32 v217, v217, v213, s31
    v_perm_b32 v213, v218, v214, s30
    v_perm_b32 v218, v218, v214, s31
    v_perm_b32 v214, v219, v215, s30
    v_perm_b32 v219, v219, v215, s31
    v_perm_b32 v215, v224, v220, s30
    v_perm_b32 v224, v224, v220, s31
    v_perm_b32 v220, v225, v221, s30
    v_perm_b32 v225, v225, v221, s31
    v_perm_b32 v221, v226, v222, s30
    v_perm_b32 v226, v226, v222, s31
    v_perm_b32 v222, v227, v223, s30
    v_perm_b32 v227, v227, v223, s31
    v_perm_b32 v223, v232, v228, s30
    v_perm_b32 v232, v232, v228, s31
    v_perm_b32 v228, v233, v229, s30
    v_perm_b32 v233, v233, v229, s31
    v_perm_b32 v229, v234, v230, s30
    v_perm_b32 v234, v234, v230, s31
    v_perm_b32 v230, v235, v231, s30
    v_perm_b32 v235, v235, v231, s31
    v_perm_b32 v231, v240, v236, s30
    v_perm_b32 v240, v240, v236, s31
    v_perm_b32 v236, v241, v237, s30
    v_perm_b32 v241, v241, v237, s31
    v_perm_b32 v237, v242, v238, s30
    v_perm_b32 v242, v242, v238, s31
    v_perm_b32 v238, v243, v239, s30
    v_perm_b32 v243, v243, v239, s31
    v_perm_b32 v239, v248, v244, s30
    v_perm_b32 v248, v248, v244, s31
    v_perm_b32 v244, v249, v245, s30
    v_perm_b32 v249, v249, v245, s31
    v_perm_b32 v245, v250, v246, s30
    v_perm_b32 v250, v250, v246, s31
    v_perm_b32 v246, v251, v247, s30
    v_perm_b32 v251, v251, v247, s31
    v_lshrrev_b32 v21, 3, v252
    s_lshl_b32 s84, s24, 18
    s_add_u32 s84, s84, s86
    s_add_u32 s84, s84, 0x2000000
    v_mul_u32_u24 v20, 6144, v21
    v_and_b32 v21, 6, v21
    v_xor_b32 v21, v21, v252
    v_and_b32 v21, 7, v21
    v_lshl_add_u32 v20, v21, 4, v20
    s_mul_i32 s32, s28, 3
    s_bfe_u32 s33, s32, 0x10001
    s_mul_i32 s33, s33, 196608
    s_and_b32 s34, s32, 1
    s_mul_i32 s34, s34, 49152
    s_add_u32 s33, s33, s34
    s_lshr_b32 s34, s32, 2
    s_lshl_b32 s34, s34, 11
    s_add_u32 s33, s33, s34
    v_add_u32 v8, s33, v20
    v_add_u32 v9, 97280, v8
    s_add_u32 s32, s32, 1
    s_bfe_u32 s33, s32, 0x10001
    s_mul_i32 s33, s33, 196608
    s_and_b32 s34, s32, 1
    s_mul_i32 s34, s34, 49152
    s_add_u32 s33, s33, s34
    s_lshr_b32 s34, s32, 2
    s_lshl_b32 s34, s34, 11
    s_add_u32 s33, s33, s34
    s_sub_u32 s33, s33, 2048
    v_add_u32 v10, s33, v20
    v_add_u32 v11, 97280, v10
    s_add_u32 s32, s32, 1
    s_bfe_u32 s33, s32, 0x10001
    s_mul_i32 s33, s33, 196608
    s_and_b32 s34, s32, 1
    s_mul_i32 s34, s34, 49152
    s_add_u32 s33, s33, s34
    s_lshr_b32 s34, s32, 2
    s_lshl_b32 s34, s34, 11
    s_add_u32 s33, s33, s34
    v_add_u32 v12, s33, v20
    v_add_u32 v13, 97280, v12
    s_sub_u32 s30, s95, 1
    s_sub_u32 s95, s94, 3
    s_mov_b32 s94, s30
    v_bfe_u32 v116, v252, 4, 1
    v_lshlrev_b32 v116, 11, v116
    v_lshrrev_b32 v117, 5, v252
    v_lshl_add_u32 v116, v117, 8, v116
    v_and_b32 v117, 15, v252
    v_lshl_add_u32 v116, v117, 4, v116
    s_lshl_b32 s34, s28, 12
    s_add_u32 s34, s34, 147456
    v_add_u32 v117, s34, v116
    v_and_b32 v16, 15, v252
    v_lshlrev_b32 v16, 9, v16
    s_load_dwordx2 s[12:13], s[0:1], 64
    s_mov_b32 s14, 0x400000
    s_mov_b32 s15, 0x20000
    s_waitcnt lgkmcnt(0)
sk_90:
    s_barrier
    s_add_u32 s96, s25, 12
    s_and_b32 s96, s96, 15
    s_lshl_b32 s96, s96, 17
    s_add_u32 s96, s96, 65536
    s_add_u32 m0, s101, 114688
    s_nop 0
    buffer_load_dwordx4 v14, s[8:11], s96 offen lds
    s_add_u32 s96, s25, 13
    s_and_b32 s96, s96, 15
    s_lshl_b32 s96, s96, 17
    s_add_u32 s96, s96, 65536
    s_add_u32 m0, s101, 118784
    s_nop 0
    buffer_load_dwordx4 v14, s[8:11], s96 offen lds
    s_add_u32 s96, s25, 14
    s_and_b32 s96, s96, 15
    s_lshl_b32 s96, s96, 17
    s_add_u32 s96, s96, 65536
    s_add_u32 m0, s101, 122880
    s_nop 0
    buffer_load_dwordx4 v14, s[8:11], s96 offen lds
    s_add_u32 s96, s25, 15
    s_and_b32 s96, s96, 15
    s_lshl_b32 s96, s96, 17
    s_add_u32 s96, s96, 65536
    s_add_u32 m0, s101, 126976
    s_nop 0
    buffer_load_dwordx4 v14, s[8:11], s96 offen lds
    s_waitcnt vmcnt(0)
    s_barrier
    s_cmp_lg_u32 s26, 0
    s_cbranch_scc1 l_tail
    s_mov_b32 s26, 16777216
    s_add_u32 s96, s94, 0
    s_and_b32 s96, s96, 15
    s_mul_i32 s96, s96, 393216
    s_add_u32 s96, s96, s85
    s_add_u32 m0, s87, 40960
    s_nop 0
    buffer_load_dwordx4 v8, s[16:19], s96 offen offset:0 lds
    buffer_load_dwordx4 v9, s[16:19], s96 offen offset:1024 lds
    buffer_load_dwordx4 v10, s[16:19], s96 offen offset:2048 lds
    buffer_load_dwordx4 v11, s[16:19], s96 offen offset:3072 lds
    s_add_u32 m0, s87, 45056
    s_nop 0
    buffer_load_dwordx4 v12, s[16:19], s96 offen offset:0 lds
    buffer_load_dwordx4 v13, s[16:19], s96 offen offset:1024 lds
    s_add_u32 s96, s95, 1
    s_and_b32 s96, s96, 15
    s_mul_i32 s96, s96, 393216
    s_add_u32 s96, s96, s85
    s_add_u32 m0, s87, 65536
    s_nop 0
    buffer_load_dwordx4 v8, s[16:19], s96 offen offset:0 lds
    buffer_load_dwordx4 v9, s[16:19], s96 offen offset:1024 lds
    buffer_load_dwordx4 v10, s[16:19], s96 offen offset:2048 lds
    buffer_load_dwordx4 v11, s[16:19], s96 offen offset:3072 lds
    s_add_u32 m0, s87, 69632
    s_nop 0
    buffer_load_dwordx4 v12, s[16:19], s96 offen offset:0 lds
    buffer_load_dwordx4 v13, s[16:19], s96 offen offset:1024 lds
    s_lshl_b32 s30, s99, 13
    s_add_u32 s30, s30, 0xc00000
    s_waitcnt vmcnt(6)
    s_barrier
    s_add_u32 s96, s94, 2
    s_and_b32 s96, s96, 15
    s_mul_i32 s96, s96, 393216
    s_add_u32 s96, s96, s85
    s_add_u32 m0, s87, 90112
    s_nop 0
    buffer_load_dwordx4 v8, s[16:19], s96 offen offset:0 lds
    buffer_load_dwordx4 v9, s[16:19], s96 offen offset:1024 lds
    buffer_load_dwordx4 v10, s[16:19], s96 offen offset:2048 lds
    buffer_load_dwordx4 v11, s[16:19], s96 offen offset:3072 lds
    s_add_u32 m0, s87, 94208
    s_nop 0
    buffer_load_dwordx4 v12, s[16:19], s96 offen offset:0 lds
    buffer_load_dwordx4 v13, s[16:19], s96 offen offset:1024 lds
    ds_read_b128 v[100:103], v117 offset:0
    ds_read_b128 v[104:107], v117 offset:512
    ds_read_b128 v[108:111], v117 offset:1024
    ds_read_b128 v[112:115], v117 offset:1536
    s_mov_b32 s78, s27
pl_92:
    buffer_load_dword v17, v16, s[20:23], s30 offen sc1
    s_waitcnt vmcnt(0)
pc_93:
    v_cmp_eq_u32 vcc, -1, v17
    s_cbranch_vccz pd_94
    s_sub_u32 s78, s78, 1
    s_cmp_lg_u32 s78, 0
    s_cbranch_scc1 pl_92
    s_mov_b32 s27, 1
pd_94:
    s_add_u32 s96, s95, 1
    s_and_b32 s96, s96, 15
    s_lshl_b32 s97, s96, 14
    s_add_u32 s97, s97, s84
    s_add_u32 m0, s86, 131072
    s_nop 0
    buffer_load_dwordx4 v253, s[20:23], s97 offen offset:0 sc1 lds
    buffer_load_dwordx4 v253, s[20:23], s97 offen offset:1024 sc1 lds
    buffer_load_dwordx4 v253, s[20:23], s97 offen offset:2048 sc1 lds
    buffer_load_dwordx4 v253, s[20:23], s97 offen offset:3072 sc1 lds
    s_lshl_b32 s30, s99, 13
    s_add_u32 s30, s30, 0xc00000
    s_add_u32 s31, s30, 4096
    buffer_load_dwordx4 v[64:67], v253, s[20:23], s30 offen offset:0 sc1
    buffer_load_dwordx4 v[68:71], v253, s[20:23], s30 offen offset:1024 sc1
    buffer_load_dwordx4 v[72:75], v253, s[20:23], s30 offen offset:2048 sc1
    buffer_load_dwordx4 v[76:79], v253, s[20:23], s30 offen offset:3072 sc1
    buffer_load_dwordx4 v[80:83], v253, s[20:23], s31 offen offset:0 sc1
    buffer_load_dwordx4 v[84:87], v253, s[20:23], s31 offen offset:1024 sc1
    buffer_load_dwordx4 v[88:91], v253, s[20:23], s31 offen offset:2048 sc1
    buffer_load_dwordx4 v[92:95], v253, s[20:23], s31 offen offset:3072 sc1
    s_waitcnt vmcnt(8) lgkmcnt(0)
    s_barrier
    s_add_u32 s96, s94, 2
    s_and_b32 s96, s96, 15
    s_lshl_b32 s97, s96, 14
    s_add_u32 s97, s97, s84
    s_add_u32 m0, s86, 114688
    s_nop 0
    buffer_load_dwordx4 v253, s[20:23], s97 offen offset:0 sc1 lds
    buffer_load_dwordx4 v253, s[20:23], s97 offen offset:1024 sc1 lds
    buffer_load_dwordx4 v253, s[20:23], s97 offen offset:2048 sc1 lds
    buffer_load_dwordx4 v253, s[20:23], s97 offen offset:3072 sc1 lds
    s_mov_b32 s78, s27
    s_waitcnt vmcnt(4)
    s_branch pc_96
pl_95:
    s_lshl_b32 s30, s99, 13
    s_add_u32 s30, s30, 0xc00000
    s_add_u32 s31, s30, 4096
    buffer_load_dwordx4 v[64:67], v253, s[20:23], s30 offen offset:0 sc1
    buffer_load_dwordx4 v[68:71], v253, s[20:23], s30 offen offset:1024 sc1
    buffer_load_dwordx4 v[72:75], v253, s[20:23], s30 offen offset:2048 sc1
    buffer_load_dwordx4 v[76:79], v253, s[20:23], s30 offen offset:3072 sc1
    buffer_load_dwordx4 v[80:83], v253, s[20:23], s31 offen offset:0 sc1
    buffer_load_dwordx4 v[84:87], v253, s[20:23], s31 offen offset:1024 sc1
    buffer_load_dwordx4 v[88:91], v253, s[20:23], s31 offen offset:2048 sc1
    buffer_load_dwordx4 v[92:95], v253, s[20:23], s31 offen offset:3072 sc1
    s_waitcnt vmcnt(0)
pc_96:
    v_max3_u32 v48, v64, v65, v66
    v_max3_u32 v48, v48, v67, v68
    v_max3_u32 v48, v48, v69, v70
    v_max3_u32 v48, v48, v71, v72
    v_max3_u32 v48, v48, v73, v74
    v_max3_u32 v48, v48, v75, v76
    v_max3_u32 v48, v48, v77, v78
    v_max3_u32 v48, v48, v79, v80
    v_max3_u32 v48, v48, v81, v82
    v_max3_u32 v48, v48, v83, v84
    v_max3_u32 v48, v48, v85, v86
    v_max3_u32 v48, v48, v87, v88
    v_max3_u32 v48, v48, v89, v90
    v_max3_u32 v48, v48, v91, v92
    v_max3_u32 v48, v48, v93, v94
    v_max_u32 v48, v48, v95
    v_cmp_eq_u32 vcc, -1, v48
    s_cbranch_vccz pd_97
    s_sub_u32 s78, s78, 1
    s_cmp_lg_u32 s78, 0
    s_cbranch_scc1 pl_95
    s_mov_b32 s27, 1
pd_97:
    s_add_u32 s96, s95, 3
    s_and_b32 s96, s96, 15
    s_lshl_b32 s97, s96, 14
    s_add_u32 s97, s97, s84
    s_add_u32 m0, s86, 147456
    s_nop 0
    buffer_load_dwordx4 v253, s[20:23], s97 offen offset:0 sc1 lds
    buffer_load_dwordx4 v253, s[20:23], s97 offen offset:1024 sc1 lds
    buffer_load_dwordx4 v253, s[20:23], s97 offen offset:2048 sc1 lds
    v_pk_add_f32 v[64:65], v[64:65], v[68:69]
    v_pk_add_f32 v[66:67], v[66:67], v[70:71]
    v_pk_add_f32 v[64:65], v[64:65], v[72:73]
    v_pk_add_f32 v[66:67], v[66:67], v[74:75]
    v_pk_add_f32 v[64:65], v[64:65], v[76:77]
    v_pk_add_f32 v[66:67], v[66:67], v[78:79]
    v_pk_add_f32 v[64:65], v[64:65], v[80:81]
    v_pk_add_f32 v[66:67], v[66:67], v[82:83]
    buffer_load_dwordx4 v253, s[20:23], s97 offen offset:3072 sc1 lds
    v_pk_add_f32 v[64:65], v[64:65], v[84:85]
    v_pk_add_f32 v[66:67], v[66:67], v[86:87]
    v_pk_add_f32 v[64:65], v[64:65], v[88:89]
    v_pk_add_f32 v[66:67], v[66:67], v[90:91]
    v_pk_add_f32 v[64:65], v[64:65], v[92:93]
    v_pk_add_f32 v[66:67], v[66:67], v[94:95]
    v_mov_b32 v48, v64
    v_mov_b32 v49, v65
    v_mov_b32 v50, v66
    v_mov_b32 v51, v67
    v_permlane32_swap_b32 v64, v48
    v_permlane32_swap_b32 v65, v49
    v_permlane32_swap_b32 v66, v50
    s_add_u32 s96, s95, 3
    s_and_b32 s96, s96, 15
    s_mul_i32 s96, s96, 393216
    s_add_u32 s96, s96, s85
    s_add_u32 m0, s87, 40960
    s_nop 0
    buffer_load_dwordx4 v8, s[16:19], s96 offen offset:0 lds
    v_permlane32_swap_b32 v67, v51
    v_add_f32 v64, v64, v48
    v_add_f32 v65, v65, v49
    v_add_f32 v66, v66, v50
    v_add_f32 v67, v67, v51
    v_mul_f32 v54, 0x3a800000, v64
    v_mul_f32 v65, 0x3a800000, v65
    v_fma_f32 v65, -v54, v54, v65
    v_max_f32 v65, 0, v65
    v_add_f32 v55, 0x3727c5ac, v65
    v_rsq_f32 v55, v55
    v_fma_f32 v52, -v54, v67, v66
    buffer_load_dwordx4 v9, s[16:19], s96 offen offset:1024 lds
    v_and_b32 v53, 31, v252
    v_mul_f32 v52, v52, v55
    s_lshl_b32 s32, s99, 5
    v_add_u32 v53, s32, v53
    v_mov_b32 v48, v52
    s_nop 1
    v_max_f32_dpp v48, v48, v48 quad_perm:[1,0,3,2] row_mask:0xf bank_mask:0xf
    s_nop 1
    v_max_f32_dpp v48, v48, v48 quad_perm:[2,3,0,1] row_mask:0xf bank_mask:0xf
    s_nop 1
    v_max_f32_dpp v48, v48, v48 row_half_mirror row_mask:0xf bank_mask:0xf
    s_nop 1
    v_max_f32_dpp v48, v48, v48 row_mirror row_mask:0xf bank_mask:0xf
    v_mov_b32 v49, v48
    s_nop 1
    v_permlane16_swap_b32 v48, v49
    v_max_f32 v48, v48, v49
    v_cmp_eq_f32 vcc, v48, v52
    buffer_load_dwordx4 v10, s[16:19], s96 offen offset:2048 lds
    v_lshrrev_b32 v50, 5, v252
    v_lshlrev_b32 v50, 4, v50
    s_lshl_b32 s32, s99, 11
    s_lshl_b32 s33, s98, 7
    s_add_u32 s32, s32, s33
    s_add_u32 s32, s32, 0xd60000
    s_lshl_b32 s34, s99, 4
    s_add_u32 s34, s34, 0xdc0000
    s_ff1_i32_b32 s35, vcc_lo
    s_lshl_b32 s35, 1, s35
    s_cmp_eq_u32 s25, 0
    s_cselect_b32 exec_lo, s35, 0
    s_mov_b32 exec_hi, 0
    buffer_store_dwordx4 v[52:55], v50, s[20:23], s34 offen sc1
    s_mov_b32 exec_lo, s35
    s_mov_b32 exec_hi, s35
    buffer_store_dwordx4 v[100:103], v50, s[20:23], s32 offen offset:0 sc1
    buffer_store_dwordx4 v[104:107], v50, s[20:23], s32 offen offset:32 sc1
    buffer_store_dwordx4 v[108:111], v50, s[20:23], s32 offen offset:64 sc1
    buffer_store_dwordx4 v[112:115], v50, s[20:23], s32 offen offset:96 sc1
    s_mov_b64 exec, -1
    buffer_load_dwordx4 v11, s[16:19], s96 offen offset:3072 lds
    v_add_f32 v56, 1.0, v55
    v_mul_f32 v57, v54, v55
    s_add_u32 m0, s87, 45056
    s_nop 0
    buffer_load_dwordx4 v12, s[16:19], s96 offen offset:0 lds
    v_mul_f32 v58, v56, v56
    v_sub_f32 v57, 0, v57
    v_mul_f32 v58, v58, v65
    v_add_f32 v58, 0x3727c5ac, v58
    v_rsq_f32 v58, v58
    s_nop 0
    v_mul_f32 v58, v58, v56
    v_and_b32 v48, 31, v252
    v_lshrrev_b32 v49, 5, v252
    v_cmp_eq_u32 vcc, 0, v49
    v_lshlrev_b32 v49, 9, v49
    v_lshl_add_u32 v48, v48, 2, v49
    s_lshl_b32 s32, s28, 7
    buffer_load_dwordx4 v13, s[16:19], s96 offen offset:1024 lds
    v_add_u32 v48, s32, v48
    v_cndmask_b32 v49, v54, v58, vcc
    v_cndmask_b32 v50, v57, v56, vcc
    ds_write_b32 v48, v49 offset:0
    ds_write_b32 v48, v50 offset:2048
    v_and_b32 v48, 15, v252
    v_lshrrev_b32 v51, 4, v252
    v_lshl_add_u32 v48, v48, 2, v51
    s_min_u32 s32, s28, 2
    s_lshl_b32 s32, s32, 8
    v_lshl_add_u32 v48, v48, 2, s32
    ds_write_b32 v48, v2 offset:1024
    s_waitcnt vmcnt(14) lgkmcnt(0)
    s_barrier
    s_add_u32 s96, s94, 4
    s_and_b32 s96, s96, 15
    s_lshl_b32 s97, s96, 14
    s_add_u32 s97, s97, s84
    s_add_u32 m0, s86, 131072
    s_nop 0
    buffer_load_dwordx4 v253, s[20:23], s97 offen offset:0 sc1 lds
    buffer_load_dwordx4 v253, s[20:23], s97 offen offset:1024 sc1 lds
    buffer_load_dwordx4 v253, s[20:23], s97 offen offset:2048 sc1 lds
    buffer_load_dwordx4 v253, s[20:23], s97 offen offset:3072 sc1 lds
    s_add_u32 s96, s94, 4
    s_and_b32 s96, s96, 15
    s_mul_i32 s96, s96, 393216
    s_add_u32 s96, s96, s85
    s_add_u32 m0, s87, 65536
    s_nop 0
    buffer_load_dwordx4 v8, s[16:19], s96 offen offset:0 lds
    buffer_load_dwordx4 v9, s[16:19], s96 offen offset:1024 lds
    buffer_load_dwordx4 v10, s[16:19], s96 offen offset:2048 lds
    buffer_load_dwordx4 v11, s[16:19], s96 offen offset:3072 lds
    s_add_u32 m0, s87, 69632
    s_nop 0
    buffer_load_dwordx4 v12, s[16:19], s96 offen offset:0 lds
    buffer_load_dwordx4 v13, s[16:19], s96 offen offset:1024 lds
    s_waitcnt vmcnt(10) lgkmcnt(0)
    s_barrier
    s_add_u32 s96, s95, 5
    s_and_b32 s96, s96, 15
    s_lshl_b32 s97, s96, 14
    s_add_u32 s97, s97, s84
    s_add_u32 m0, s86, 114688
    s_nop 0
    buffer_load_dwordx4 v253, s[20:23], s97 offen offset:0 sc1 lds
    buffer_load_dwordx4 v253, s[20:23], s97 offen offset:1024 sc1 lds
    buffer_load_dwordx4 v253, s[20:23], s97 offen offset:2048 sc1 lds
    buffer_load_dwordx4 v253, s[20:23], s97 offen offset:3072 sc1 lds
    s_add_u32 s96, s95, 5
    s_and_b32 s96, s96, 15
    s_mul_i32 s96, s96, 393216
    s_add_u32 s96, s96, s85
    s_add_u32 m0, s87, 90112
    s_nop 0
    buffer_load_dwordx4 v8, s[16:19], s96 offen offset:0 lds
    buffer_load_dwordx4 v9, s[16:19], s96 offen offset:1024 lds
    buffer_load_dwordx4 v10, s[16:19], s96 offen offset:2048 lds
    buffer_load_dwordx4 v11, s[16:19], s96 offen offset:3072 lds
    s_add_u32 m0, s87, 94208
    s_nop 0
    buffer_load_dwordx4 v12, s[16:19], s96 offen offset:0 lds
    buffer_load_dwordx4 v13, s[16:19], s96 offen offset:1024 lds
    s_waitcnt vmcnt(10) lgkmcnt(0)
    s_barrier
    s_add_u32 s32, s79, 0xdc0000
    s_add_u32 s96, s94, 6
    s_and_b32 s96, s96, 15
    s_lshl_b32 s97, s96, 14
    s_add_u32 s97, s97, s84
    s_add_u32 m0, s86, 147456
    s_nop 0
    buffer_load_dwordx4 v253, s[20:23], s97 offen offset:0 sc1 lds
    buffer_load_dwordx4 v253, s[20:23], s97 offen offset:1024 sc1 lds
    buffer_load_dwordx4 v253, s[20:23], s97 offen offset:2048 sc1 lds
    buffer_load_dwordx4 v253, s[20:23], s97 offen offset:3072 sc1 lds
    s_add_u32 s96, s94, 6
    s_and_b32 s96, s96, 15
    s_mul_i32 s96, s96, 393216
    s_add_u32 s96, s96, s85
    s_add_u32 m0, s87, 40960
    s_nop 0
    buffer_load_dwordx4 v8, s[16:19], s96 offen offset:0 lds
    buffer_load_dwordx4 v[16:19], v253, s[20:23], s32 offen sc1
    buffer_load_dwordx4 v9, s[16:19], s96 offen offset:1024 lds
    buffer_load_dwordx4 v10, s[16:19], s96 offen offset:2048 lds
    buffer_load_dwordx4 v11, s[16:19], s96 offen offset:3072 lds
    s_add_u32 m0, s87, 45056
    s_nop 0
    buffer_load_dwordx4 v12, s[16:19], s96 offen offset:0 lds
    buffer_load_dwordx4 v13, s[16:19], s96 offen offset:1024 lds
    s_waitcnt vmcnt(11) lgkmcnt(0)
    s_barrier
    s_mov_b32 s78, s27
    s_waitcnt vmcnt(5)
    s_branch pc_100
pl_99:
    s_add_u32 s32, s79, 0xdc0000
    buffer_load_dwordx4 v[16:19], v253, s[20:23], s32 offen sc1
    s_waitcnt vmcnt(0)
pc_100:
    v_max3_u32 v20, v16, v17, v18
    v_max_u32 v20, v20, v19
    v_cmp_eq_u32 vcc, -1, v20
    s_cbranch_vccz pd_101
    s_sub_u32 s78, s78, 1
    s_cmp_lg_u32 s78, 0
    s_cbranch_scc1 pl_99
    s_mov_b32 s27, 1
pd_101:
    s_add_u32 s96, s95, 7
    s_and_b32 s96, s96, 15
    s_lshl_b32 s97, s96, 14
    s_add_u32 s97, s97, s84
    s_add_u32 m0, s86, 131072
    s_nop 0
    buffer_load_dwordx4 v253, s[20:23], s97 offen offset:0 sc1 lds
    buffer_load_dwordx4 v253, s[20:23], s97 offen offset:1024 sc1 lds
    buffer_load_dwordx4 v253, s[20:23], s97 offen offset:2048 sc1 lds
    v_mov_b32 v20, v16
    buffer_load_dwordx4 v253, s[20:23], s97 offen offset:3072 sc1 lds
    s_nop 0
    v_max_f32_dpp v20, v20, v20 quad_perm:[1,0,3,2] row_mask:0xf bank_mask:0xf
    s_nop 1
    v_max_f32_dpp v20, v20, v20 quad_perm:[2,3,0,1] row_mask:0xf bank_mask:0xf
    s_nop 1
    v_max_f32_dpp v20, v20, v20 row_half_mirror row_mask:0xf bank_mask:0xf
    s_nop 1
    v_max_f32_dpp v20, v20, v20 row_mirror row_mask:0xf bank_mask:0xf
    v_mov_b32 v21, v20
    s_add_u32 s96, s95, 7
    s_and_b32 s96, s96, 15
    s_mul_i32 s96, s96, 393216
    s_add_u32 s96, s96, s85
    s_add_u32 m0, s87, 65536
    s_nop 0
    buffer_load_dwordx4 v8, s[16:19], s96 offen offset:0 lds
    v_permlane16_swap_b32 v20, v21
    v_max_f32 v20, v20, v21
    v_mov_b32 v21, v20
    s_nop 1
    v_permlane32_swap_b32 v20, v21
    buffer_load_dwordx4 v9, s[16:19], s96 offen offset:1024 lds
    v_max_f32 v20, v20, v21
    v_cmp_eq_f32 vcc, v20, v16
    s_ff1_i32_b64 s32, vcc
    s_and_b32 s32, s32, 63
    v_readlane_b32 s74, v16, s32
    buffer_load_dwordx4 v10, s[16:19], s96 offen offset:2048 lds
    v_readlane_b32 s73, v17, s32
    v_readlane_b32 s75, v18, s32
    v_readlane_b32 s76, v19, s32
    s_and_b32 s73, s73, 2047
    s_lshr_b32 s33, s73, 5
    buffer_load_dwordx4 v11, s[16:19], s96 offen offset:3072 lds
    s_lshl_b32 s33, s33, 11
    s_add_u32 s33, s33, s79
    s_add_u32 s33, s33, 0xd60000
    buffer_load_dwordx4 v[24:27], v22, s[20:23], s33 offen sc1
    v_mov_b32 v20, s73
    s_add_u32 m0, s87, 69632
    s_nop 0
    buffer_load_dwordx4 v12, s[16:19], s96 offen offset:0 lds
    v_mov_b32 v21, s77
    v_mov_b32 v19, 0
    ds_write_b64 v19, v[20:21] offset:3072
    s_lshr_b32 s39, s73, 5
    s_lshl_b32 s34, s24, 2
    buffer_load_dwordx4 v13, s[16:19], s96 offen offset:1024 lds
    s_sub_u32 s39, s39, s34
    s_add_u32 s39, s39, 8
    s_cmp_lt_u32 s39, 12
    s_cselect_b32 s100, 1, 0
    s_waitcnt vmcnt(11) lgkmcnt(0)
    s_barrier
    s_add_u32 s96, s94, 8
    s_and_b32 s96, s96, 15
    s_lshl_b32 s97, s96, 14
    s_add_u32 s97, s97, s84
    s_add_u32 m0, s86, 114688
    s_nop 0
    buffer_load_dwordx4 v253, s[20:23], s97 offen offset:0 sc1 lds
    buffer_load_dwordx4 v253, s[20:23], s97 offen offset:1024 sc1 lds
    s_mov_b32 s78, s27
    s_waitcnt vmcnt(4)
    s_branch pc_103
pl_102:
    s_lshr_b32 s33, s73, 5
    s_lshl_b32 s33, s33, 11
    s_add_u32 s33, s33, s79
    s_add_u32 s33, s33, 0xd60000
    buffer_load_dwordx4 v[24:27], v22, s[20:23], s33 offen sc1
    s_waitcnt vmcnt(0)
pc_103:
    v_max3_u32 v30, v24, v25, v26
    v_max_u32 v30, v30, v27
    v_cmp_eq_u32 vcc, -1, v30
    s_cbranch_vccz pd_104
    s_sub_u32 s78, s78, 1
    s_cmp_lg_u32 s78, 0
    s_cbranch_scc1 pl_102
    s_mov_b32 s27, 1
pd_104:
    buffer_load_dwordx4 v253, s[20:23], s97 offen offset:2048 sc1 lds
    v_and_b32 v30, 2, v252
    v_cmp_eq_u32 vcc, 2, v30
    v_mov_b32 v28, s76
    v_mul_f32 v29, s75, v28
    v_add_f32 v28, 1.0, v28
    v_cndmask_b32 v30, v24, v26, vcc
    v_cndmask_b32 v31, v25, v27, vcc
    v_lshlrev_b32 v92, 16, v30
    v_and_b32 v93, 0xffff0000, v30
    v_lshlrev_b32 v94, 16, v31
    v_and_b32 v95, 0xffff0000, v31
    v_fma_f32 v92, v92, v28, -v29
    v_fma_f32 v93, v93, v28, -v29
    v_fma_f32 v94, v94, v28, -v29
    v_fma_f32 v95, v95, v28, -v29
    v_mov_b32 v96, 0xbfb8aa3b
    v_mul_f32 v96, s74, v96
    v_exp_f32 v96, v96
    s_nop 0
    v_add_f32 v96, 1.0, v96
    v_rcp_f32 v96, v96
    buffer_load_dwordx4 v253, s[20:23], s97 offen offset:3072 sc1 lds
    v_mov_b32 v28, s76
    v_mul_f32 v29, s75, v28
    v_lshlrev_b32 v30, 16, v24
    v_and_b32 v31, 0xffff0000, v24
    v_fma_f32 v30, v30, v28, -v29
    v_fma_f32 v31, v31, v28, -v29
    v_cvt_pk_bf16_f32 v24, v30, v31
    v_lshlrev_b32 v30, 16, v25
    v_and_b32 v31, 0xffff0000, v25
    v_fma_f32 v30, v30, v28, -v29
    v_fma_f32 v31, v31, v28, -v29
    v_cvt_pk_bf16_f32 v25, v30, v31
    v_lshlrev_b32 v30, 16, v26
    v_and_b32 v31, 0xffff0000, v26
    v_fma_f32 v30, v30, v28, -v29
    v_fma_f32 v31, v31, v28, -v29
    v_cvt_pk_bf16_f32 v26, v30, v31
    v_lshlrev_b32 v30, 16, v27
    v_and_b32 v31, 0xffff0000, v27
    v_fma_f32 v30, v30, v28, -v29
    v_fma_f32 v31, v31, v28, -v29
    s_add_u32 s96, s94, 8
    s_and_b32 s96, s96, 15
    s_mul_i32 s96, s96, 393216
    s_add_u32 s96, s96, s85
    s_add_u32 m0, s87, 90112
    s_nop 0
    buffer_load_dwordx4 v8, s[16:19], s96 offen offset:0 lds
    v_cvt_pk_bf16_f32 v27, v30, v31
    s_bitcmp0_b32 s29, 0
    s_cbranch_scc1 sk_105
    v_swap_b32 v24, v25
    v_swap_b32 v26, v27
sk_105:
    s_bitcmp0_b32 s29, 1
    s_cbranch_scc1 sk_106
    v_swap_b32 v24, v26
    v_swap_b32 v25, v27
sk_106:
    v_dot2_f32_bf16 v32, v155, v24, 0
    v_dot2_f32_bf16 v33, v160, v24, 0
    v_dot2_f32_bf16 v34, v156, v24, 0
    v_dot2_f32_bf16 v35, v161, v24, 0
    v_dot2_f32_bf16 v36, v157, v24, 0
    v_dot2_f32_bf16 v37, v162, v24, 0
    buffer_load_dwordx4 v9, s[16:19], s96 offen offset:1024 lds
    v_dot2_f32_bf16 v38, v158, v24, 0
    v_dot2_f32_bf16 v39, v163, v24, 0
    v_dot2_f32_bf16 v40, v183, v24, 0
    v_dot2_f32_bf16 v41, v192, v24, 0
    v_dot2_f32_bf16 v42, v188, v24, 0
    v_dot2_f32_bf16 v43, v193, v24, 0
    v_dot2_f32_bf16 v44, v189, v24, 0
    v_dot2_f32_bf16 v45, v194, v24, 0
    v_dot2_f32_bf16 v46, v190, v24, 0
    v_dot2_f32_bf16 v47, v195, v24, 0
    v_dot2_f32_bf16 v32, v159, v25, v32
    v_dot2_f32_bf16 v33, v168, v25, v33
    v_dot2_f32_bf16 v34, v164, v25, v34
    v_dot2_f32_bf16 v35, v169, v25, v35
    v_dot2_f32_bf16 v36, v165, v25, v36
    v_dot2_f32_bf16 v37, v170, v25, v37
    v_dot2_f32_bf16 v38, v166, v25, v38
    v_dot2_f32_bf16 v39, v171, v25, v39
    v_dot2_f32_bf16 v40, v191, v25, v40
    v_dot2_f32_bf16 v41, v200, v25, v41
    v_dot2_f32_bf16 v42, v196, v25, v42
    buffer_load_dwordx4 v10, s[16:19], s96 offen offset:2048 lds
    v_dot2_f32_bf16 v43, v201, v25, v43
    v_dot2_f32_bf16 v44, v197, v25, v44
    v_dot2_f32_bf16 v45, v202, v25, v45
    v_dot2_f32_bf16 v46, v198, v25, v46
    v_dot2_f32_bf16 v47, v203, v25, v47
    v_dot2_f32_bf16 v32, v167, v26, v32
    v_dot2_f32_bf16 v33, v176, v26, v33
    v_dot2_f32_bf16 v34, v172, v26, v34
    v_dot2_f32_bf16 v35, v177, v26, v35
    v_dot2_f32_bf16 v36, v173, v26, v36
    v_dot2_f32_bf16 v37, v178, v26, v37
    v_dot2_f32_bf16 v38, v174, v26, v38
    v_dot2_f32_bf16 v39, v179, v26, v39
    v_dot2_f32_bf16 v40, v199, v26, v40
    v_dot2_f32_bf16 v41, v208, v26, v41
    v_dot2_f32_bf16 v42, v204, v26, v42
    v_dot2_f32_bf16 v43, v209, v26, v43
    v_dot2_f32_bf16 v44, v205, v26, v44
    v_dot2_f32_bf16 v45, v210, v26, v45
    v_dot2_f32_bf16 v46, v206, v26, v46
    v_dot2_f32_bf16 v47, v211, v26, v47
    buffer_load_dwordx4 v11, s[16:19], s96 offen offset:3072 lds
    v_dot2_f32_bf16 v32, v175, v27, v32
    v_dot2_f32_bf16 v33, v184, v27, v33
    v_dot2_f32_bf16 v34, v180, v27, v34
    v_dot2_f32_bf16 v35, v185, v27, v35
    v_dot2_f32_bf16 v36, v181, v27, v36
    v_dot2_f32_bf16 v37, v186, v27, v37
    v_dot2_f32_bf16 v38, v182, v27, v38
    v_dot2_f32_bf16 v39, v187, v27, v39
    v_dot2_f32_bf16 v40, v207, v27, v40
    v_dot2_f32_bf16 v41, v216, v27, v41
    v_dot2_f32_bf16 v42, v212, v27, v42
    v_dot2_f32_bf16 v43, v217, v27, v43
    v_dot2_f32_bf16 v44, v213, v27, v44
    v_dot2_f32_bf16 v45, v218, v27, v45
    v_dot2_f32_bf16 v46, v214, v27, v46
    v_dot2_f32_bf16 v47, v219, v27, v47
    v_lshrrev_b32 v31, 5, v252
    v_lshlrev_b32 v30, 6, v31
    v_permlane32_swap_b32 v32, v40
    v_permlane32_swap_b32 v33, v41
    v_permlane32_swap_b32 v34, v42
    s_add_u32 m0, s87, 94208
    s_nop 0
    buffer_load_dwordx4 v12, s[16:19], s96 offen offset:0 lds
    v_permlane32_swap_b32 v35, v43
    v_permlane32_swap_b32 v36, v44
    v_permlane32_swap_b32 v37, v45
    v_permlane32_swap_b32 v38, v46
    v_permlane32_swap_b32 v39, v47
    v_add_f32 v32, v32, v40
    v_add_f32 v33, v33, v41
    v_add_f32 v34, v34, v42
    v_add_f32 v35, v35, v43
    v_add_f32 v36, v36, v44
    v_add_f32 v37, v37, v45
    v_add_f32 v38, v38, v46
    v_add_f32 v39, v39, v47
    v_and_b32 v31, 1, v252
    v_lshl_add_u32 v30, v31, 5, v30
    v_permlane16_swap_b32 v32, v36
    v_permlane16_swap_b32 v33, v37
    v_permlane16_swap_b32 v34, v38
    v_permlane16_swap_b32 v35, v39
    v_add_f32 v32, v32, v36
    v_add_f32 v33, v33, v37
    buffer_load_dwordx4 v13, s[16:19], s96 offen offset:1024 lds
    v_add_f32 v34, v34, v38
    v_add_f32 v35, v35, v39
    v_and_b32 v31, 16, v252
    s_lshl_b32 s32, s28, 7
    v_add3_u32 v30, v31, v30, s32
    v_add_f32_dpp v32, v32, v32 quad_perm:[2,3,0,1] row_mask:0xf bank_mask:0xf
    v_add_f32_dpp v33, v33, v33 quad_perm:[2,3,0,1] row_mask:0xf bank_mask:0xf
    v_add_f32_dpp v34, v34, v34 quad_perm:[2,3,0,1] row_mask:0xf bank_mask:0xf
    v_add_f32_dpp v35, v35, v35 quad_perm:[2,3,0,1] row_mask:0xf bank_mask:0xf
    v_add_f32_dpp v32, v32, v32 row_ror:4 row_mask:0xf bank_mask:0xf
    v_add_f32_dpp v33, v33, v33 row_ror:4 row_mask:0xf bank_mask:0xf
    v_add_f32_dpp v34, v34, v34 row_ror:4 row_mask:0xf bank_mask:0xf
    v_add_f32_dpp v35, v35, v35 row_ror:4 row_mask:0xf bank_mask:0xf
    v_add_f32_dpp v32, v32, v32 row_ror:8 row_mask:0xf bank_mask:0xf
    v_add_f32_dpp v33, v33, v33 row_ror:8 row_mask:0xf bank_mask:0xf
    v_add_f32_dpp v34, v34, v34 row_ror:8 row_mask:0xf bank_mask:0xf
    v_add_f32_dpp v35, v35, v35 row_ror:8 row_mask:0xf bank_mask:0xf
    s_mov_b32 exec_lo, 0x00030003
    s_mov_b32 exec_hi, 0x00030003
    ds_write_b128 v30, v[32:35] offset:3328
    s_mov_b64 exec, -1
    s_waitcnt vmcnt(10) lgkmcnt(0)
    s_barrier
    s_add_u32 s96, s95, 9
    s_and_b32 s96, s96, 15
    s_lshl_b32 s97, s96, 14
    s_add_u32 s97, s97, s84
    s_add_u32 m0, s86, 147456
    s_nop 0
    buffer_load_dwordx4 v253, s[20:23], s97 offen offset:0 sc1 lds
    buffer_load_dwordx4 v253, s[20:23], s97 offen offset:1024 sc1 lds
    v_and_b32 v30, 1, v252
    v_bfe_u32 v31, v252, 1, 3
    v_lshl_add_u32 v30, v30, 3, v31
    v_lshlrev_b32 v30, 2, v30
    v_add_u32 v30, 3328, v30
    ds_read2_b32 v[32:33], v30 offset0:0 offset1:16
    ds_read2_b32 v[34:35], v30 offset0:32 offset1:48
    ds_read2_b32 v[36:37], v30 offset0:64 offset1:80
    ds_read2_b32 v[38:39], v30 offset0:96 offset1:112
    v_lshrrev_b32 v30, 2, v252
    buffer_load_dwordx4 v253, s[20:23], s97 offen offset:2048 sc1 lds
    v_mul_u32_u24 v30, 14336, v30
    v_and_b32 v31, 3, v252
    v_lshl_add_u32 v30, v31, 4, v30
    v_and_b32 v31, 1, v252
    v_cmp_eq_u32 vcc, 1, v31
    s_mul_i32 s32, s28, 229376
    s_lshl_b32 s33, s29, 6
    s_add_u32 s32, s32, s33
    s_add_u32 s32, s32, s79
    s_add_u32 s32, s32, 0xc80000
    buffer_load_dwordx4 v253, s[20:23], s97 offen offset:3072 sc1 lds
    s_waitcnt lgkmcnt(0)
    v_pk_add_f32 v[32:33], v[32:33], v[34:35]
    v_pk_add_f32 v[36:37], v[36:37], v[38:39]
    v_pk_add_f32 v[32:33], v[32:33], v[36:37]
    v_mul_f32 v34, 0xbfb8aa3b, v32
    v_exp_f32 v34, v34
    v_mul_f32 v32, v32, v33
    v_add_f32 v34, 1.0, v34
    v_rcp_f32 v34, v34
    s_add_u32 s96, s95, 9
    s_and_b32 s96, s96, 15
    s_mul_i32 s96, s96, 393216
    s_add_u32 s96, s96, s85
    s_add_u32 m0, s87, 40960
    s_nop 0
    buffer_load_dwordx4 v8, s[16:19], s96 offen offset:0 lds
    v_mul_f32 v32, v32, v34
    s_nop 1
    v_mov_b32_dpp v33, v32 quad_perm:[2,3,2,3] row_mask:0xf bank_mask:0xf
    v_cvt_pk_bf16_f32 v32, v32, v33
    ds_swizzle_b32 v36, v32 offset:0x1
    ds_swizzle_b32 v37, v32 offset:0x81
    ds_swizzle_b32 v38, v32 offset:0x101
    ds_swizzle_b32 v39, v32 offset:0x181
    s_waitcnt lgkmcnt(0)
    v_dot2_f32_bf16 v40, v215, v36, 0
    v_dot2_f32_bf16 v41, v224, v36, 0
    buffer_load_dwordx4 v9, s[16:19], s96 offen offset:1024 lds
    v_dot2_f32_bf16 v42, v220, v36, 0
    v_dot2_f32_bf16 v43, v225, v36, 0
    v_dot2_f32_bf16 v44, v221, v36, 0
    v_dot2_f32_bf16 v45, v226, v36, 0
    v_dot2_f32_bf16 v46, v222, v36, 0
    v_dot2_f32_bf16 v47, v227, v36, 0
    v_dot2_f32_bf16 v40, v223, v37, v40
    v_dot2_f32_bf16 v41, v232, v37, v41
    v_dot2_f32_bf16 v42, v228, v37, v42
    v_dot2_f32_bf16 v43, v233, v37, v43
    buffer_load_dwordx4 v10, s[16:19], s96 offen offset:2048 lds
    v_dot2_f32_bf16 v44, v229, v37, v44
    v_dot2_f32_bf16 v45, v234, v37, v45
    v_dot2_f32_bf16 v46, v230, v37, v46
    v_dot2_f32_bf16 v47, v235, v37, v47
    v_dot2_f32_bf16 v40, v231, v38, v40
    v_dot2_f32_bf16 v41, v240, v38, v41
    v_dot2_f32_bf16 v42, v236, v38, v42
    v_dot2_f32_bf16 v43, v241, v38, v43
    v_dot2_f32_bf16 v44, v237, v38, v44
    buffer_load_dwordx4 v11, s[16:19], s96 offen offset:3072 lds
    v_dot2_f32_bf16 v45, v242, v38, v45
    v_dot2_f32_bf16 v46, v238, v38, v46
    v_dot2_f32_bf16 v47, v243, v38, v47
    v_dot2_f32_bf16 v40, v239, v39, v40
    v_dot2_f32_bf16 v41, v248, v39, v41
    v_dot2_f32_bf16 v42, v244, v39, v42
    v_dot2_f32_bf16 v43, v249, v39, v43
    v_dot2_f32_bf16 v44, v245, v39, v44
    v_dot2_f32_bf16 v45, v250, v39, v45
    v_dot2_f32_bf16 v46, v246, v39, v46
    s_add_u32 m0, s87, 45056
    s_nop 0
    buffer_load_dwordx4 v12, s[16:19], s96 offen offset:0 lds
    v_dot2_f32_bf16 v47, v251, v39, v47
    v_add_f32_dpp v40, v40, v40 quad_perm:[1,0,3,2] row_mask:0xf bank_mask:0xf
    v_add_f32_dpp v41, v41, v41 quad_perm:[1,0,3,2] row_mask:0xf bank_mask:0xf
    v_add_f32_dpp v42, v42, v42 quad_perm:[1,0,3,2] row_mask:0xf bank_mask:0xf
    v_add_f32_dpp v43, v43, v43 quad_perm:[1,0,3,2] row_mask:0xf bank_mask:0xf
    v_add_f32_dpp v44, v44, v44 quad_perm:[1,0,3,2] row_mask:0xf bank_mask:0xf
    v_add_f32_dpp v45, v45, v45 quad_perm:[1,0,3,2] row_mask:0xf bank_mask:0xf
    v_add_f32_dpp v46, v46, v46 quad_perm:[1,0,3,2] row_mask:0xf bank_mask:0xf
    v_add_f32_dpp v47, v47, v47 quad_perm:[1,0,3,2] row_mask:0xf bank_mask:0xf
    v_cndmask_b32 v40, v40, v44, vcc
    buffer_load_dwordx4 v13, s[16:19], s96 offen offset:1024 lds
    v_cndmask_b32 v41, v41, v45, vcc
    v_cndmask_b32 v42, v42, v46, vcc
    v_cndmask_b32 v43, v43, v47, vcc
    s_cmp_lt_u32 s29, 224
    s_cselect_b64 exec, -1, 0
    buffer_store_dwordx4 v[40:43], v30, s[20:23], s32 offen sc1
    s_mov_b64 exec, -1
    s_waitcnt vmcnt(10) lgkmcnt(0)
    s_barrier
    s_add_u32 s96, s94, 10
    s_and_b32 s96, s96, 15
    s_lshl_b32 s97, s96, 14
    s_add_u32 s97, s97, s84
    s_add_u32 m0, s86, 131072
    s_nop 0
    buffer_load_dwordx4 v253, s[20:23], s97 offen offset:0 sc1 lds
    buffer_load_dwordx4 v253, s[20:23], s97 offen offset:1024 sc1 lds
    buffer_load_dwordx4 v253, s[20:23], s97 offen offset:2048 sc1 lds
    buffer_load_dwordx4 v253, s[20:23], s97 offen offset:3072 sc1 lds
    s_add_u32 s96, s94, 10
    s_and_b32 s96, s96, 15
    s_mul_i32 s96, s96, 393216
    s_add_u32 s96, s96, s85
    s_add_u32 m0, s87, 65536
    s_nop 0
    buffer_load_dwordx4 v8, s[16:19], s96 offen offset:0 lds
    buffer_load_dwordx4 v9, s[16:19], s96 offen offset:1024 lds
    buffer_load_dwordx4 v10, s[16:19], s96 offen offset:2048 lds
    buffer_load_dwordx4 v11, s[16:19], s96 offen offset:3072 lds
    s_add_u32 m0, s87, 69632
    s_nop 0
    buffer_load_dwordx4 v12, s[16:19], s96 offen offset:0 lds
    buffer_load_dwordx4 v13, s[16:19], s96 offen offset:1024 lds
    s_waitcnt vmcnt(10) lgkmcnt(0)
    s_barrier
    s_cmp_lt_u32 s29, 224
    s_cbranch_scc1 sk_108
    s_cmp_ge_u32 s28, 2
    s_cbranch_scc1 sk_108
    s_mul_i32 s32, s89, 14336
    s_add_u32 s32, s32, s79
    s_add_u32 s32, s32, 0xc80000
    buffer_load_dwordx4 v[32:35], v253, s[20:23], s32 offen offset:0 sc1
    buffer_load_dwordx4 v[36:39], v253, s[20:23], s32 offen offset:1024 sc1
    buffer_load_dwordx4 v[40:43], v253, s[20:23], s32 offen offset:2048 sc1
    buffer_load_dwordx4 v[44:47], v253, s[20:23], s32 offen offset:3072 sc1
    s_add_u32 s32, s32, 4096
    buffer_load_dwordx4 v[48:51], v253, s[20:23], s32 offen offset:0 sc1
    buffer_load_dwordx4 v[52:55], v253, s[20:23], s32 offen offset:1024 sc1
    buffer_load_dwordx4 v[56:59], v253, s[20:23], s32 offen offset:2048 sc1
    buffer_load_dwordx4 v[60:63], v253, s[20:23], s32 offen offset:3072 sc1
    s_add_u32 s32, s32, 4096
    buffer_load_dwordx4 v[64:67], v253, s[20:23], s32 offen offset:0 sc1
    buffer_load_dwordx4 v[68:71], v253, s[20:23], s32 offen offset:1024 sc1
    buffer_load_dwordx4 v[72:75], v253, s[20:23], s32 offen offset:2048 sc1
    buffer_load_dwordx4 v[76:79], v253, s[20:23], s32 offen offset:3072 sc1
    s_add_u32 s32, s32, 4096
    buffer_load_dwordx4 v[80:83], v253, s[20:23], s32 offen offset:0 sc1
    buffer_load_dwordx4 v[84:87], v253, s[20:23], s32 offen offset:1024 sc1
sk_108:
    s_add_u32 s96, s95, 11
    s_and_b32 s96, s96, 15
    s_lshl_b32 s97, s96, 14
    s_add_u32 s97, s97, s84
    s_add_u32 m0, s86, 114688
    s_nop 0
    buffer_load_dwordx4 v253, s[20:23], s97 offen offset:0 sc1 lds
    buffer_load_dwordx4 v253, s[20:23], s97 offen offset:1024 sc1 lds
    buffer_load_dwordx4 v253, s[20:23], s97 offen offset:2048 sc1 lds
    buffer_load_dwordx4 v253, s[20:23], s97 offen offset:3072 sc1 lds
    s_add_u32 s96, s95, 11
    s_and_b32 s96, s96, 15
    s_mul_i32 s96, s96, 393216
    s_add_u32 s96, s96, s85
    s_add_u32 m0, s87, 90112
    s_nop 0
    buffer_load_dwordx4 v8, s[16:19], s96 offen offset:0 lds
    buffer_load_dwordx4 v9, s[16:19], s96 offen offset:1024 lds
    buffer_load_dwordx4 v10, s[16:19], s96 offen offset:2048 lds
    buffer_load_dwordx4 v11, s[16:19], s96 offen offset:3072 lds
    s_add_u32 m0, s87, 94208
    s_nop 0
    buffer_load_dwordx4 v12, s[16:19], s96 offen offset:0 lds
    buffer_load_dwordx4 v13, s[16:19], s96 offen offset:1024 lds
    s_waitcnt vmcnt(10) lgkmcnt(0)
    s_barrier
    s_add_u32 s96, s94, 12
    s_and_b32 s96, s96, 15
    s_lshl_b32 s97, s96, 14
    s_add_u32 s97, s97, s84
    s_add_u32 m0, s86, 147456
    s_nop 0
    buffer_load_dwordx4 v253, s[20:23], s97 offen offset:0 sc1 lds
    buffer_load_dwordx4 v253, s[20:23], s97 offen offset:1024 sc1 lds
    buffer_load_dwordx4 v253, s[20:23], s97 offen offset:2048 sc1 lds
    buffer_load_dwordx4 v253, s[20:23], s97 offen offset:3072 sc1 lds
    s_add_u32 s96, s94, 12
    s_and_b32 s96, s96, 15
    s_mul_i32 s96, s96, 393216
    s_add_u32 s96, s96, s85
    s_add_u32 m0, s87, 40960
    s_nop 0
    buffer_load_dwordx4 v8, s[16:19], s96 offen offset:0 lds
    buffer_load_dwordx4 v9, s[16:19], s96 offen offset:1024 lds
    buffer_load_dwordx4 v10, s[16:19], s96 offen offset:2048 lds
    buffer_load_dwordx4 v11, s[16:19], s96 offen offset:3072 lds
    s_add_u32 m0, s87, 45056
    s_nop 0
    buffer_load_dwordx4 v12, s[16:19], s96 offen offset:0 lds
    buffer_load_dwordx4 v13, s[16:19], s96 offen offset:1024 lds
    s_cmp_lt_u32 s29, 224
    s_cbranch_scc1 sk_109
    s_cmp_ge_u32 s28, 2
    s_cbranch_scc1 sk_109
    s_mov_b32 s78, s27
    s_waitcnt vmcnt(20)
    s_branch pc_111
pl_110:
    s_mul_i32 s32, s89, 14336
    s_add_u32 s32, s32, s79
    s_add_u32 s32, s32, 0xc80000
    buffer_load_dwordx4 v[32:35], v253, s[20:23], s32 offen offset:0 sc1
    buffer_load_dwordx4 v[36:39], v253, s[20:23], s32 offen offset:1024 sc1
    buffer_load_dwordx4 v[40:43], v253, s[20:23], s32 offen offset:2048 sc1
    buffer_load_dwordx4 v[44:47], v253, s[20:23], s32 offen offset:3072 sc1
    s_add_u32 s32, s32, 4096
    buffer_load_dwordx4 v[48:51], v253, s[20:23], s32 offen offset:0 sc1
    buffer_load_dwordx4 v[52:55], v253, s[20:23], s32 offen offset:1024 sc1
    buffer_load_dwordx4 v[56:59], v253, s[20:23], s32 offen offset:2048 sc1
    buffer_load_dwordx4 v[60:63], v253, s[20:23], s32 offen offset:3072 sc1
    s_add_u32 s32, s32, 4096
    buffer_load_dwordx4 v[64:67], v253, s[20:23], s32 offen offset:0 sc1
    buffer_load_dwordx4 v[68:71], v253, s[20:23], s32 offen offset:1024 sc1
    buffer_load_dwordx4 v[72:75], v253, s[20:23], s32 offen offset:2048 sc1
    buffer_load_dwordx4 v[76:79], v253, s[20:23], s32 offen offset:3072 sc1
    s_add_u32 s32, s32, 4096
    buffer_load_dwordx4 v[80:83], v253, s[20:23], s32 offen offset:0 sc1
    buffer_load_dwordx4 v[84:87], v253, s[20:23], s32 offen offset:1024 sc1
    s_waitcnt vmcnt(0)
pc_111:
    v_max3_u32 v30, v32, v33, v34
    v_max3_u32 v30, v30, v35, v36
    v_max3_u32 v30, v30, v37, v38
    v_max3_u32 v30, v30, v39, v40
    v_max3_u32 v30, v30, v41, v42
    v_max3_u32 v30, v30, v43, v44
    v_max3_u32 v30, v30, v45, v46
    v_max3_u32 v30, v30, v47, v48
    v_max3_u32 v30, v30, v49, v50
    v_max3_u32 v30, v30, v51, v52
    v_max3_u32 v30, v30, v53, v54
    v_max3_u32 v30, v30, v55, v56
    v_max3_u32 v30, v30, v57, v58
    v_max3_u32 v30, v30, v59, v60
    v_max3_u32 v30, v30, v61, v62
    v_max3_u32 v30, v30, v63, v64
    v_max3_u32 v30, v30, v65, v66
    v_max3_u32 v30, v30, v67, v68
    v_max3_u32 v30, v30, v69, v70
    v_max3_u32 v30, v30, v71, v72
    v_max3_u32 v30, v30, v73, v74
    v_max3_u32 v30, v30, v75, v76
    v_max3_u32 v30, v30, v77, v78
    v_max3_u32 v30, v30, v79, v80
    v_max3_u32 v30, v30, v81, v82
    v_max3_u32 v30, v30, v83, v84
    v_max3_u32 v30, v30, v85, v86
    v_max_u32 v30, v30, v87
    v_cmp_eq_u32 vcc, -1, v30
    s_cbranch_vccz pd_112
    s_sub_u32 s78, s78, 1
    s_cmp_lg_u32 s78, 0
    s_cbranch_scc1 pl_110
    s_mov_b32 s27, 1
pd_112:
    v_pk_add_f32 v[32:33], v[32:33], v[36:37]
    v_pk_add_f32 v[34:35], v[34:35], v[38:39]
    v_pk_add_f32 v[32:33], v[32:33], v[40:41]
    v_pk_add_f32 v[34:35], v[34:35], v[42:43]
    v_pk_add_f32 v[32:33], v[32:33], v[44:45]
    v_pk_add_f32 v[34:35], v[34:35], v[46:47]
    v_pk_add_f32 v[32:33], v[32:33], v[48:49]
    v_pk_add_f32 v[34:35], v[34:35], v[50:51]
    v_pk_add_f32 v[32:33], v[32:33], v[52:53]
    v_pk_add_f32 v[34:35], v[34:35], v[54:55]
    v_pk_add_f32 v[32:33], v[32:33], v[56:57]
    v_pk_add_f32 v[34:35], v[34:35], v[58:59]
    v_pk_add_f32 v[32:33], v[32:33], v[60:61]
    v_pk_add_f32 v[34:35], v[34:35], v[62:63]
    v_pk_add_f32 v[32:33], v[32:33], v[64:65]
    v_pk_add_f32 v[34:35], v[34:35], v[66:67]
    v_pk_add_f32 v[32:33], v[32:33], v[68:69]
    v_pk_add_f32 v[34:35], v[34:35], v[70:71]
    v_pk_add_f32 v[32:33], v[32:33], v[72:73]
    v_pk_add_f32 v[34:35], v[34:35], v[74:75]
    v_pk_add_f32 v[32:33], v[32:33], v[76:77]
    v_pk_add_f32 v[34:35], v[34:35], v[78:79]
    v_pk_add_f32 v[32:33], v[32:33], v[80:81]
    v_pk_add_f32 v[34:35], v[34:35], v[82:83]
    v_pk_add_f32 v[32:33], v[32:33], v[84:85]
    v_pk_add_f32 v[34:35], v[34:35], v[86:87]
    s_nop 0
    v_add_f32_dpp v32, v32, v32 row_ror:4 row_mask:0xf bank_mask:0xf
    v_add_f32_dpp v33, v33, v33 row_ror:4 row_mask:0xf bank_mask:0xf
    v_add_f32_dpp v34, v34, v34 row_ror:4 row_mask:0xf bank_mask:0xf
    v_add_f32_dpp v35, v35, v35 row_ror:4 row_mask:0xf bank_mask:0xf
    v_add_f32_dpp v32, v32, v32 row_ror:8 row_mask:0xf bank_mask:0xf
    v_add_f32_dpp v33, v33, v33 row_ror:8 row_mask:0xf bank_mask:0xf
    v_add_f32_dpp v34, v34, v34 row_ror:8 row_mask:0xf bank_mask:0xf
    v_add_f32_dpp v35, v35, v35 row_ror:8 row_mask:0xf bank_mask:0xf
    v_mov_b32 v36, v32
    v_mov_b32 v37, v33
    v_mov_b32 v38, v34
    v_mov_b32 v39, v35
    v_permlane16_swap_b32 v32, v36
    v_permlane16_swap_b32 v33, v37
    v_permlane16_swap_b32 v34, v38
    v_permlane16_swap_b32 v35, v39
    v_add_f32 v32, v32, v36
    v_add_f32 v33, v33, v37
    v_add_f32 v34, v34, v38
    v_add_f32 v35, v35, v39
    v_mov_b32 v36, v32
    v_mov_b32 v37, v33
    v_mov_b32 v38, v34
    v_mov_b32 v39, v35
    v_permlane32_swap_b32 v32, v36
    v_permlane32_swap_b32 v33, v37
    v_permlane32_swap_b32 v34, v38
    v_permlane32_swap_b32 v35, v39
    v_add_f32 v32, v32, v36
    v_add_f32 v33, v33, v37
    v_add_f32 v34, v34, v38
    v_add_f32 v35, v35, v39
    v_fma_f32 v32, v32, v96, v92
    v_fma_f32 v33, v33, v96, v93
    v_fma_f32 v34, v34, v96, v94
    v_fma_f32 v35, v35, v96, v95
    v_cvt_pk_bf16_f32 v32, v32, v33
    v_cvt_pk_bf16_f32 v33, v34, v35
    s_lshl_b32 s32, s89, 5
    s_add_u32 s32, s32, 0xdc4000
    v_and_b32 v30, 1, v252
    v_bfe_u32 v31, v252, 1, 1
    v_lshlrev_b32 v30, 4, v30
    v_lshl_add_u32 v30, v31, 3, v30
    s_mov_b64 exec, 15
    buffer_store_dwordx2 v[32:33], v30, s[20:23], s32 offen sc1
    s_mov_b64 exec, -1
sk_109:
    s_waitcnt vmcnt(10) lgkmcnt(0)
    s_barrier
    s_add_u32 s96, s95, 13
    s_and_b32 s96, s96, 15
    s_lshl_b32 s97, s96, 14
    s_add_u32 s97, s97, s84
    s_add_u32 m0, s86, 131072
    s_nop 0
    buffer_load_dwordx4 v253, s[20:23], s97 offen offset:0 sc1 lds
    buffer_load_dwordx4 v253, s[20:23], s97 offen offset:1024 sc1 lds
    buffer_load_dwordx4 v253, s[20:23], s97 offen offset:2048 sc1 lds
    buffer_load_dwordx4 v253, s[20:23], s97 offen offset:3072 sc1 lds
    s_add_u32 s96, s95, 13
    s_and_b32 s96, s96, 15
    s_mul_i32 s96, s96, 393216
    s_add_u32 s96, s96, s85
    s_add_u32 m0, s87, 65536
    s_nop 0
    buffer_load_dwordx4 v8, s[16:19], s96 offen offset:0 lds
    buffer_load_dwordx4 v9, s[16:19], s96 offen offset:1024 lds
    buffer_load_dwordx4 v10, s[16:19], s96 offen offset:2048 lds
    buffer_load_dwordx4 v11, s[16:19], s96 offen offset:3072 lds
    s_add_u32 m0, s87, 69632
    s_nop 0
    buffer_load_dwordx4 v12, s[16:19], s96 offen offset:0 lds
    buffer_load_dwordx4 v13, s[16:19], s96 offen offset:1024 lds
    s_waitcnt vmcnt(10) lgkmcnt(0)
    s_barrier
    s_add_u32 s35, s94, 12
    s_and_b32 s35, s35, 15
    s_lshl_b32 s35, s35, 7
    s_add_u32 s35, s35, 0xdc4000
    s_add_u32 s96, s94, 14
    s_and_b32 s96, s96, 15
    s_lshl_b32 s97, s96, 14
    s_add_u32 s97, s97, s84
    s_add_u32 m0, s86, 114688
    s_nop 0
    buffer_load_dwordx4 v253, s[20:23], s97 offen offset:0 sc1 lds
    v_and_b32 v19, 48, v252
    buffer_load_dwordx4 v[132:135], v19, s[20:23], s35 offen offset:0 sc1
    buffer_load_dwordx4 v[136:139], v19, s[20:23], s35 offen offset:64 sc1
    buffer_load_dwordx4 v253, s[20:23], s97 offen offset:1024 sc1 lds
    s_min_u32 s30, s28, 2
    s_lshl_b32 s30, s30, 13
    s_add_u32 s30, s30, 40960
    buffer_load_dwordx4 v253, s[20:23], s97 offen offset:2048 sc1 lds
    v_lshrrev_b32 v20, 2, v252
    v_bfe_u32 v21, v20, 1, 2
    v_lshlrev_b32 v20, 7, v20
    v_lshl_add_u32 v20, v21, 5, v20
    buffer_load_dwordx4 v253, s[20:23], s97 offen offset:3072 sc1 lds
    v_and_b32 v21, 3, v252
    v_lshl_add_u32 v20, v21, 3, v20
    v_add_u32 v144, s30, v20
    s_add_u32 s96, s94, 14
    s_and_b32 s96, s96, 15
    s_mul_i32 s96, s96, 393216
    s_add_u32 s96, s96, s85
    s_add_u32 m0, s87, 90112
    s_nop 0
    buffer_load_dwordx4 v8, s[16:19], s96 offen offset:0 lds
    v_xor_b32 v145, 32, v144
    v_xor_b32 v146, 64, v144
    v_xor_b32 v147, 96, v144
    buffer_load_dwordx4 v9, s[16:19], s96 offen offset:1024 lds
    ds_read_b64_tr_b16 v[100:101], v144 offset:0
    ds_read_b64_tr_b16 v[102:103], v144 offset:2048
    ds_read_b64_tr_b16 v[104:105], v144 offset:4096
    buffer_load_dwordx4 v10, s[16:19], s96 offen offset:2048 lds
    ds_read_b64_tr_b16 v[106:107], v144 offset:6144
    ds_read_b64_tr_b16 v[108:109], v145 offset:0
    ds_read_b64_tr_b16 v[110:111], v145 offset:2048
    ds_read_b64_tr_b16 v[112:113], v145 offset:4096
    buffer_load_dwordx4 v11, s[16:19], s96 offen offset:3072 lds
    ds_read_b64_tr_b16 v[114:115], v145 offset:6144
    ds_read_b64_tr_b16 v[116:117], v146 offset:0
    ds_read_b64_tr_b16 v[118:119], v146 offset:2048
    s_add_u32 m0, s87, 94208
    s_nop 0
    buffer_load_dwordx4 v12, s[16:19], s96 offen offset:0 lds
    ds_read_b64_tr_b16 v[120:121], v146 offset:4096
    ds_read_b64_tr_b16 v[122:123], v146 offset:6144
    ds_read_b64_tr_b16 v[124:125], v147 offset:0
    buffer_load_dwordx4 v13, s[16:19], s96 offen offset:1024 lds
    ds_read_b64_tr_b16 v[126:127], v147 offset:2048
    ds_read_b64_tr_b16 v[128:129], v147 offset:4096
    ds_read_b64_tr_b16 v[130:131], v147 offset:6144
    s_waitcnt vmcnt(12) lgkmcnt(0)
    s_barrier
    s_add_u32 s96, s95, 15
    s_and_b32 s96, s96, 15
    s_lshl_b32 s97, s96, 14
    s_add_u32 s97, s97, s84
    s_add_u32 m0, s86, 147456
    s_nop 0
    buffer_load_dwordx4 v253, s[20:23], s97 offen offset:0 sc1 lds
    buffer_load_dwordx4 v253, s[20:23], s97 offen offset:1024 sc1 lds
    s_mov_b32 s78, s27
    s_waitcnt vmcnt(11)
    s_branch pc_114
pl_113:
    buffer_load_dwordx4 v[132:135], v19, s[20:23], s35 offen offset:0 sc1
    buffer_load_dwordx4 v[136:139], v19, s[20:23], s35 offen offset:64 sc1
    s_waitcnt vmcnt(0)
pc_114:
    v_max3_u32 v30, v132, v133, v134
    v_max3_u32 v30, v30, v135, v136
    v_max3_u32 v30, v30, v137, v138
    v_max_u32 v30, v30, v139
    v_cmp_eq_u32 vcc, -1, v30
    s_cbranch_vccz pd_115
    s_sub_u32 s78, s78, 1
    s_cmp_lg_u32 s78, 0
    s_cbranch_scc1 pl_113
    s_mov_b32 s27, 1
pd_115:
    buffer_load_dwordx4 v253, s[20:23], s97 offen offset:2048 sc1 lds
    buffer_load_dwordx4 v253, s[20:23], s97 offen offset:3072 sc1 lds
    v_mov_b32 v140, 0
    v_mov_b32 v141, 0
    v_mov_b32 v142, 0
    s_add_u32 s96, s95, 15
    s_and_b32 s96, s96, 15
    s_mul_i32 s96, s96, 393216
    s_add_u32 s96, s96, s85
    s_add_u32 m0, s87, 40960
    s_nop 0
    buffer_load_dwordx4 v8, s[16:19], s96 offen offset:0 lds
    v_mov_b32 v143, 0
    v_dot2c_f32_bf16 v140, v132, v100
    v_dot2c_f32_bf16 v141, v132, v108
    v_dot2c_f32_bf16 v142, v132, v116
    v_dot2c_f32_bf16 v143, v132, v124
    v_dot2c_f32_bf16 v140, v133, v101
    v_dot2c_f32_bf16 v141, v133, v109
    v_dot2c_f32_bf16 v142, v133, v117
    buffer_load_dwordx4 v9, s[16:19], s96 offen offset:1024 lds
    v_dot2c_f32_bf16 v143, v133, v125
    v_dot2c_f32_bf16 v140, v134, v102
    v_dot2c_f32_bf16 v141, v134, v110
    v_dot2c_f32_bf16 v142, v134, v118
    v_dot2c_f32_bf16 v143, v134, v126
    v_dot2c_f32_bf16 v140, v135, v103
    v_dot2c_f32_bf16 v141, v135, v111
    v_dot2c_f32_bf16 v142, v135, v119
    buffer_load_dwordx4 v10, s[16:19], s96 offen offset:2048 lds
    v_dot2c_f32_bf16 v143, v135, v127
    v_dot2c_f32_bf16 v140, v136, v104
    v_dot2c_f32_bf16 v141, v136, v112
    v_dot2c_f32_bf16 v142, v136, v120
    v_dot2c_f32_bf16 v143, v136, v128
    v_dot2c_f32_bf16 v140, v137, v105
    v_dot2c_f32_bf16 v141, v137, v113
    v_dot2c_f32_bf16 v142, v137, v121
    buffer_load_dwordx4 v11, s[16:19], s96 offen offset:3072 lds
    v_dot2c_f32_bf16 v143, v137, v129
    v_dot2c_f32_bf16 v140, v138, v106
    v_dot2c_f32_bf16 v141, v138, v114
    v_dot2c_f32_bf16 v142, v138, v122
    v_dot2c_f32_bf16 v143, v138, v130
    v_dot2c_f32_bf16 v140, v139, v107
    v_dot2c_f32_bf16 v141, v139, v115
    v_dot2c_f32_bf16 v142, v139, v123
    s_add_u32 m0, s87, 45056
    s_nop 0
    buffer_load_dwordx4 v12, s[16:19], s96 offen offset:0 lds
    v_dot2c_f32_bf16 v143, v139, v131
    s_min_u32 s32, s28, 2
    s_lshl_b32 s32, s32, 12
    s_lshl_b32 s33, s25, 14
    s_add_u32 s32, s32, s33
    s_add_u32 s32, s32, 0x1d80000
    s_lshl_b32 s33, s24, 8
    s_add_u32 s32, s32, s33
    buffer_load_dwordx4 v13, s[16:19], s96 offen offset:1024 lds
    v_lshlrev_b32 v20, 2, v252
    v_permlane32_swap_b32 v140, v142
    v_permlane32_swap_b32 v141, v143
    v_add_f32 v140, v140, v142
    v_add_f32 v141, v141, v143
    s_nop 1
    v_permlane16_swap_b32 v140, v141
    v_add_f32 v140, v140, v141
    buffer_store_dword v140, v20, s[20:23], s32 offen sc1
    s_waitcnt vmcnt(11) lgkmcnt(0)
    s_barrier
    s_getpc_b64 s[32:33]
pc_116:
    s_sub_u32 s32, s32, pc_116-interleave_layers__sliding_block__moe_arch_mod__prompt_kernel
    s_subb_u32 s33, s33, 0
    s_lshr_b32 s34, s2, 3
    s_lshl_b32 s34, s34, 2
    s_add_u32 s34, s34, s28
    s_and_b32 s34, s34, 127
    s_lshl_b32 s34, s34, 7
    v_lshl_add_u32 v154, v252, 14, s34
    s_mov_b32 s34, k_exit-interleave_layers__sliding_block__moe_arch_mod__prompt_kernel
    s_mov_b32 s35, 0x20000
    buffer_load_dword v154, v154, s[32:35], 0 offen
    s_waitcnt vmcnt(2) lgkmcnt(0)
    s_barrier
    s_cmp_eq_u32 s100, 0
    s_cbranch_scc1 sk_117
    s_min_u32 s32, s28, 2
    s_lshl_b32 s32, s32, 12
    s_lshl_b32 s33, s25, 14
    s_add_u32 s32, s32, s33
    s_add_u32 s32, s32, 0x1d80000
    buffer_load_dwordx4 v[32:35], v253, s[20:23], s32 offen offset:0 sc1
    buffer_load_dwordx4 v[36:39], v253, s[20:23], s32 offen offset:1024 sc1
    buffer_load_dwordx4 v[40:43], v253, s[20:23], s32 offen offset:2048 sc1
    buffer_load_dwordx4 v[44:47], v253, s[20:23], s32 offen offset:3072 sc1
    s_mov_b32 s32, 0xdc4000
    buffer_load_dwordx4 v[48:51], v253, s[20:23], s32 offen offset:0 sc1
    buffer_load_dwordx4 v[52:55], v253, s[20:23], s32 offen offset:1024 sc1
    v_and_b32 v20, 7, v252
    v_lshrrev_b32 v21, 4, v252
    v_lshl_add_u32 v21, v20, 2, v21
    s_and_b32 s34, s73, 31
    s_and_b32 s32, s34, 7
    s_and_b32 s33, s34, 8
    s_lshl_b32 s33, s33, 1
    s_add_u32 s32, s32, s33
    s_lshr_b32 s33, s34, 4
    s_lshl_b32 s33, s33, 3
    s_add_u32 s32, s32, s33
    s_cmp_eq_u32 s28, 1
    s_cselect_b32 s34, s32, s34
    v_mov_b32 v20, s34
    s_cmp_ge_u32 s28, 2
    s_cselect_b64 vcc, -1, 0
    s_cselect_b32 s32, 2048, 0
    v_cndmask_b32 v30, v20, v21, vcc
    v_cndmask_b32 v31, v21, v20, vcc
    v_lshlrev_b32 v0, 4, v30
    v_bfe_u32 v20, v31, 2, 2
    v_lshl_add_u32 v0, v20, 9, v0
    v_lshrrev_b32 v20, 4, v31
    v_lshl_add_u32 v0, v20, 3, v0
    v_and_b32 v20, 3, v31
    v_lshl_add_u32 v0, v20, 1, v0
    s_lshl_b32 s33, s39, 12
    s_add_u32 s33, s33, s32
    s_add_u32 s33, s33, 65536
    s_lshl_b32 s34, s39, 11
    s_add_u32 s34, s34, 32768
    s_cmp_ge_u32 s39, 8
    s_cselect_b32 s38, 1, 0
    s_movk_i32 s32, 8192
    s_cmp_eq_u32 s28, 0
    s_cselect_b32 s33, s34, s33
    s_cselect_b32 s32, s32, 49152
    s_cselect_b32 s38, s38, 1
    s_cselect_b32 s37, 0x3e8293ee, 1.0
    v_bfe_u32 v20, v252, 3, 1
    v_mul_u32_u24 v20, s32, v20
    v_add3_u32 v0, v0, v20, s33
sk_117:
    s_waitcnt lgkmcnt(0)
    s_barrier
    s_cmp_eq_u32 s100, 0
    s_cbranch_scc1 sk_118
    s_mov_b32 s78, s27
    s_waitcnt vmcnt(0)
    s_branch pc_120
pl_119:
    s_min_u32 s32, s28, 2
    s_lshl_b32 s32, s32, 12
    s_lshl_b32 s33, s25, 14
    s_add_u32 s32, s32, s33
    s_add_u32 s32, s32, 0x1d80000
    buffer_load_dwordx4 v[32:35], v253, s[20:23], s32 offen offset:0 sc1
    buffer_load_dwordx4 v[36:39], v253, s[20:23], s32 offen offset:1024 sc1
    buffer_load_dwordx4 v[40:43], v253, s[20:23], s32 offen offset:2048 sc1
    buffer_load_dwordx4 v[44:47], v253, s[20:23], s32 offen offset:3072 sc1
    s_mov_b32 s32, 0xdc4000
    buffer_load_dwordx4 v[48:51], v253, s[20:23], s32 offen offset:0 sc1
    buffer_load_dwordx4 v[52:55], v253, s[20:23], s32 offen offset:1024 sc1
    s_waitcnt vmcnt(0)
pc_120:
    v_max3_u32 v30, v32, v33, v34
    v_max3_u32 v30, v30, v35, v36
    v_max3_u32 v30, v30, v37, v38
    v_max3_u32 v30, v30, v39, v40
    v_max3_u32 v30, v30, v41, v42
    v_max3_u32 v30, v30, v43, v44
    v_max3_u32 v30, v30, v45, v46
    v_max3_u32 v30, v30, v47, v48
    v_max3_u32 v30, v30, v49, v50
    v_max3_u32 v30, v30, v51, v52
    v_max3_u32 v30, v30, v53, v54
    v_max_u32 v30, v30, v55
    v_cmp_eq_u32 vcc, -1, v30
    s_cbranch_vccz pd_121
    s_sub_u32 s78, s78, 1
    s_cmp_lg_u32 s78, 0
    s_cbranch_scc1 pl_119
    s_mov_b32 s27, 1
pd_121:
    v_mov_b32 v28, 0
    v_mov_b32 v29, 0
    v_dot2c_f32_bf16 v28, 0x3f803f80, v48
    v_dot2c_f32_bf16 v29, v48, v48
    v_dot2c_f32_bf16 v28, 0x3f803f80, v49
    v_dot2c_f32_bf16 v29, v49, v49
    v_dot2c_f32_bf16 v28, 0x3f803f80, v50
    v_dot2c_f32_bf16 v29, v50, v50
    v_dot2c_f32_bf16 v28, 0x3f803f80, v51
    v_dot2c_f32_bf16 v29, v51, v51
    v_dot2c_f32_bf16 v28, 0x3f803f80, v52
    v_dot2c_f32_bf16 v29, v52, v52
    v_dot2c_f32_bf16 v28, 0x3f803f80, v53
    v_dot2c_f32_bf16 v29, v53, v53
    v_dot2c_f32_bf16 v28, 0x3f803f80, v54
    v_dot2c_f32_bf16 v29, v54, v54
    v_dot2c_f32_bf16 v28, 0x3f803f80, v55
    v_dot2c_f32_bf16 v29, v55, v55
    v_pk_add_f32 v[32:33], v[32:33], v[36:37]
    v_pk_add_f32 v[34:35], v[34:35], v[38:39]
    v_pk_add_f32 v[32:33], v[32:33], v[40:41]
    v_pk_add_f32 v[34:35], v[34:35], v[42:43]
    v_pk_add_f32 v[32:33], v[32:33], v[44:45]
    v_pk_add_f32 v[34:35], v[34:35], v[46:47]
    s_nop 1
    v_permlane32_swap_b32 v32, v34
    v_permlane32_swap_b32 v33, v35
    v_add_f32 v32, v32, v34
    v_add_f32 v33, v33, v35
    s_nop 1
    v_permlane16_swap_b32 v32, v33
    v_add_f32 v32, v32, v33
    v_add_f32_dpp v28, v28, v28 quad_perm:[1,0,3,2] row_mask:0xf bank_mask:0xf
    s_nop 1
    v_add_f32_dpp v28, v28, v28 quad_perm:[2,3,0,1] row_mask:0xf bank_mask:0xf
    s_nop 1
    v_add_f32_dpp v28, v28, v28 row_half_mirror row_mask:0xf bank_mask:0xf
    s_nop 1
    v_add_f32_dpp v28, v28, v28 row_mirror row_mask:0xf bank_mask:0xf
    v_mov_b32 v30, v28
    s_nop 1
    v_permlane16_swap_b32 v28, v30
    v_add_f32 v28, v28, v30
    v_mov_b32 v30, v28
    s_nop 1
    v_permlane32_swap_b32 v28, v30
    v_add_f32 v28, v28, v30
    v_add_f32_dpp v29, v29, v29 quad_perm:[1,0,3,2] row_mask:0xf bank_mask:0xf
    s_nop 1
    v_add_f32_dpp v29, v29, v29 quad_perm:[2,3,0,1] row_mask:0xf bank_mask:0xf
    s_nop 1
    v_add_f32_dpp v29, v29, v29 row_half_mirror row_mask:0xf bank_mask:0xf
    s_nop 1
    v_add_f32_dpp v29, v29, v29 row_mirror row_mask:0xf bank_mask:0xf
    v_mov_b32 v30, v29
    s_nop 1
    v_permlane16_swap_b32 v29, v30
    v_add_f32 v29, v29, v30
    v_mov_b32 v30, v29
    s_nop 1
    v_permlane32_swap_b32 v29, v30
    v_add_f32 v29, v29, v30
    v_mul_f32 v28, 0x3a800000, v28
    v_mul_f32 v29, 0x3a800000, v29
    v_fma_f32 v29, -v28, v28, v29
    v_max_f32 v29, 0, v29
    v_add_f32 v29, 0x3727c5ac, v29
    v_rsq_f32 v29, v29
    v_fma_f32 v32, -v28, v2, v32
    v_mul_f32 v29, s37, v29
    v_mul_f32 v32, v32, v29
    v_cvt_pk_bf16_f32 v1, v32, v32
sk_118:
    s_branch l_att
l_tail:
    v_mov_b32 v20, 0
    s_or_b32 s34, s72, s28
    s_cmp_lg_u32 s34, 0
    s_cbranch_scc1 sk_122
    s_mov_b32 s34, 0xdd8000
    v_mov_b32 v154, s88
    s_mov_b64 exec, 1
    s_waitcnt vmcnt(0)
    buffer_store_dword v154, v253, s[20:23], s34 offen sc1
    s_mov_b64 exec, -1
sk_122:
    s_barrier
    ds_read_b128 v[16:19], v20 offset:3072
    s_waitcnt lgkmcnt(0)
    v_readlane_b32 s74, v16, 0
    v_readlane_b32 s73, v17, 0
    v_readlane_b32 s75, v18, 0
    v_readlane_b32 s76, v19, 0
    s_and_b32 s73, s73, 2047
    s_mov_b32 s78, s27
pl_123:
    s_lshr_b32 s33, s73, 5
    s_lshl_b32 s33, s33, 11
    s_add_u32 s33, s33, s79
    s_add_u32 s33, s33, 0xd60000
    buffer_load_dwordx4 v[24:27], v22, s[20:23], s33 offen sc1
    s_waitcnt vmcnt(0)
pc_124:
    v_max3_u32 v30, v24, v25, v26
    v_max_u32 v30, v30, v27
    v_cmp_eq_u32 vcc, -1, v30
    s_cbranch_vccz pd_125
    s_sub_u32 s78, s78, 1
    s_cmp_lg_u32 s78, 0
    s_cbranch_scc1 pl_123
    s_mov_b32 s27, 1
pd_125:
    s_cmp_ge_u32 s29, 224
    s_cbranch_scc1 l_tred
    v_mov_b32 v28, s76
    v_mul_f32 v29, s75, v28
    v_lshlrev_b32 v30, 16, v24
    v_and_b32 v31, 0xffff0000, v24
    v_fma_f32 v30, v30, v28, -v29
    v_fma_f32 v31, v31, v28, -v29
    v_cvt_pk_bf16_f32 v24, v30, v31
    v_lshlrev_b32 v30, 16, v25
    v_and_b32 v31, 0xffff0000, v25
    v_fma_f32 v30, v30, v28, -v29
    v_fma_f32 v31, v31, v28, -v29
    v_cvt_pk_bf16_f32 v25, v30, v31
    v_lshlrev_b32 v30, 16, v26
    v_and_b32 v31, 0xffff0000, v26
    v_fma_f32 v30, v30, v28, -v29
    v_fma_f32 v31, v31, v28, -v29
    v_cvt_pk_bf16_f32 v26, v30, v31
    v_lshlrev_b32 v30, 16, v27
    v_and_b32 v31, 0xffff0000, v27
    v_fma_f32 v30, v30, v28, -v29
    v_fma_f32 v31, v31, v28, -v29
    v_cvt_pk_bf16_f32 v27, v30, v31
    s_bitcmp0_b32 s29, 0
    s_cbranch_scc1 sk_126
    v_swap_b32 v24, v25
    v_swap_b32 v26, v27
sk_126:
    s_bitcmp0_b32 s29, 1
    s_cbranch_scc1 sk_127
    v_swap_b32 v24, v26
    v_swap_b32 v25, v27
sk_127:
    v_dot2_f32_bf16 v32, v155, v24, 0
    v_dot2_f32_bf16 v33, v160, v24, 0
    v_dot2_f32_bf16 v34, v156, v24, 0
    v_dot2_f32_bf16 v35, v161, v24, 0
    v_dot2_f32_bf16 v36, v157, v24, 0
    v_dot2_f32_bf16 v37, v162, v24, 0
    v_dot2_f32_bf16 v38, v158, v24, 0
    v_dot2_f32_bf16 v39, v163, v24, 0
    v_dot2_f32_bf16 v40, v183, v24, 0
    v_dot2_f32_bf16 v41, v192, v24, 0
    v_dot2_f32_bf16 v42, v188, v24, 0
    v_dot2_f32_bf16 v43, v193, v24, 0
    v_dot2_f32_bf16 v44, v189, v24, 0
    v_dot2_f32_bf16 v45, v194, v24, 0
    v_dot2_f32_bf16 v46, v190, v24, 0
    v_dot2_f32_bf16 v47, v195, v24, 0
    v_dot2_f32_bf16 v32, v159, v25, v32
    v_dot2_f32_bf16 v33, v168, v25, v33
    v_dot2_f32_bf16 v34, v164, v25, v34
    v_dot2_f32_bf16 v35, v169, v25, v35
    v_dot2_f32_bf16 v36, v165, v25, v36
    v_dot2_f32_bf16 v37, v170, v25, v37
    v_dot2_f32_bf16 v38, v166, v25, v38
    v_dot2_f32_bf16 v39, v171, v25, v39
    v_dot2_f32_bf16 v40, v191, v25, v40
    v_dot2_f32_bf16 v41, v200, v25, v41
    v_dot2_f32_bf16 v42, v196, v25, v42
    v_dot2_f32_bf16 v43, v201, v25, v43
    v_dot2_f32_bf16 v44, v197, v25, v44
    v_dot2_f32_bf16 v45, v202, v25, v45
    v_dot2_f32_bf16 v46, v198, v25, v46
    v_dot2_f32_bf16 v47, v203, v25, v47
    v_dot2_f32_bf16 v32, v167, v26, v32
    v_dot2_f32_bf16 v33, v176, v26, v33
    v_dot2_f32_bf16 v34, v172, v26, v34
    v_dot2_f32_bf16 v35, v177, v26, v35
    v_dot2_f32_bf16 v36, v173, v26, v36
    v_dot2_f32_bf16 v37, v178, v26, v37
    v_dot2_f32_bf16 v38, v174, v26, v38
    v_dot2_f32_bf16 v39, v179, v26, v39
    v_dot2_f32_bf16 v40, v199, v26, v40
    v_dot2_f32_bf16 v41, v208, v26, v41
    v_dot2_f32_bf16 v42, v204, v26, v42
    v_dot2_f32_bf16 v43, v209, v26, v43
    v_dot2_f32_bf16 v44, v205, v26, v44
    v_dot2_f32_bf16 v45, v210, v26, v45
    v_dot2_f32_bf16 v46, v206, v26, v46
    v_dot2_f32_bf16 v47, v211, v26, v47
    v_dot2_f32_bf16 v32, v175, v27, v32
    v_dot2_f32_bf16 v33, v184, v27, v33
    v_dot2_f32_bf16 v34, v180, v27, v34
    v_dot2_f32_bf16 v35, v185, v27, v35
    v_dot2_f32_bf16 v36, v181, v27, v36
    v_dot2_f32_bf16 v37, v186, v27, v37
    v_dot2_f32_bf16 v38, v182, v27, v38
    v_dot2_f32_bf16 v39, v187, v27, v39
    v_dot2_f32_bf16 v40, v207, v27, v40
    v_dot2_f32_bf16 v41, v216, v27, v41
    v_dot2_f32_bf16 v42, v212, v27, v42
    v_dot2_f32_bf16 v43, v217, v27, v43
    v_dot2_f32_bf16 v44, v213, v27, v44
    v_dot2_f32_bf16 v45, v218, v27, v45
    v_dot2_f32_bf16 v46, v214, v27, v46
    v_dot2_f32_bf16 v47, v219, v27, v47
    v_lshrrev_b32 v31, 5, v252
    v_lshlrev_b32 v30, 6, v31
    v_permlane32_swap_b32 v32, v40
    v_permlane32_swap_b32 v33, v41
    v_permlane32_swap_b32 v34, v42
    v_permlane32_swap_b32 v35, v43
    v_permlane32_swap_b32 v36, v44
    v_permlane32_swap_b32 v37, v45
    v_permlane32_swap_b32 v38, v46
    v_permlane32_swap_b32 v39, v47
    v_add_f32 v32, v32, v40
    v_add_f32 v33, v33, v41
    v_add_f32 v34, v34, v42
    v_add_f32 v35, v35, v43
    v_add_f32 v36, v36, v44
    v_add_f32 v37, v37, v45
    v_add_f32 v38, v38, v46
    v_add_f32 v39, v39, v47
    v_and_b32 v31, 1, v252
    v_lshl_add_u32 v30, v31, 5, v30
    v_permlane16_swap_b32 v32, v36
    v_permlane16_swap_b32 v33, v37
    v_permlane16_swap_b32 v34, v38
    v_permlane16_swap_b32 v35, v39
    v_add_f32 v32, v32, v36
    v_add_f32 v33, v33, v37
    v_add_f32 v34, v34, v38
    v_add_f32 v35, v35, v39
    v_and_b32 v31, 16, v252
    s_lshl_b32 s32, s28, 7
    v_add3_u32 v30, v31, v30, s32
    v_add_f32_dpp v32, v32, v32 quad_perm:[2,3,0,1] row_mask:0xf bank_mask:0xf
    v_add_f32_dpp v33, v33, v33 quad_perm:[2,3,0,1] row_mask:0xf bank_mask:0xf
    v_add_f32_dpp v34, v34, v34 quad_perm:[2,3,0,1] row_mask:0xf bank_mask:0xf
    v_add_f32_dpp v35, v35, v35 quad_perm:[2,3,0,1] row_mask:0xf bank_mask:0xf
    v_add_f32_dpp v32, v32, v32 row_ror:4 row_mask:0xf bank_mask:0xf
    v_add_f32_dpp v33, v33, v33 row_ror:4 row_mask:0xf bank_mask:0xf
    v_add_f32_dpp v34, v34, v34 row_ror:4 row_mask:0xf bank_mask:0xf
    v_add_f32_dpp v35, v35, v35 row_ror:4 row_mask:0xf bank_mask:0xf
    v_add_f32_dpp v32, v32, v32 row_ror:8 row_mask:0xf bank_mask:0xf
    v_add_f32_dpp v33, v33, v33 row_ror:8 row_mask:0xf bank_mask:0xf
    v_add_f32_dpp v34, v34, v34 row_ror:8 row_mask:0xf bank_mask:0xf
    v_add_f32_dpp v35, v35, v35 row_ror:8 row_mask:0xf bank_mask:0xf
    s_mov_b32 exec_lo, 0x00030003
    s_mov_b32 exec_hi, 0x00030003
    ds_write_b128 v30, v[32:35] offset:3328
    s_mov_b64 exec, -1
    s_waitcnt lgkmcnt(0)
    s_barrier
    v_and_b32 v30, 1, v252
    v_bfe_u32 v31, v252, 1, 3
    v_lshl_add_u32 v30, v30, 3, v31
    v_lshlrev_b32 v30, 2, v30
    v_add_u32 v30, 3328, v30
    ds_read2_b32 v[32:33], v30 offset0:0 offset1:16
    ds_read2_b32 v[34:35], v30 offset0:32 offset1:48
    ds_read2_b32 v[36:37], v30 offset0:64 offset1:80
    ds_read2_b32 v[38:39], v30 offset0:96 offset1:112
    v_lshrrev_b32 v30, 2, v252
    v_mul_u32_u24 v30, 14336, v30
    v_and_b32 v31, 3, v252
    v_lshl_add_u32 v30, v31, 4, v30
    v_and_b32 v31, 1, v252
    v_cmp_eq_u32 vcc, 1, v31
    s_mul_i32 s32, s28, 229376
    s_lshl_b32 s33, s29, 6
    s_add_u32 s32, s32, s33
    s_add_u32 s32, s32, s79
    s_add_u32 s32, s32, 0xc80000
    s_waitcnt lgkmcnt(0)
    v_pk_add_f32 v[32:33], v[32:33], v[34:35]
    v_pk_add_f32 v[36:37], v[36:37], v[38:39]
    v_pk_add_f32 v[32:33], v[32:33], v[36:37]
    v_mul_f32 v34, 0xbfb8aa3b, v32
    v_exp_f32 v34, v34
    v_mul_f32 v32, v32, v33
    v_add_f32 v34, 1.0, v34
    v_rcp_f32 v34, v34
    s_nop 0
    v_mul_f32 v32, v32, v34
    s_nop 1
    v_mov_b32_dpp v33, v32 quad_perm:[2,3,2,3] row_mask:0xf bank_mask:0xf
    v_cvt_pk_bf16_f32 v32, v32, v33
    ds_swizzle_b32 v36, v32 offset:0x1
    ds_swizzle_b32 v37, v32 offset:0x81
    ds_swizzle_b32 v38, v32 offset:0x101
    ds_swizzle_b32 v39, v32 offset:0x181
    s_waitcnt lgkmcnt(0)
    v_dot2_f32_bf16 v40, v215, v36, 0
    v_dot2_f32_bf16 v41, v224, v36, 0
    v_dot2_f32_bf16 v42, v220, v36, 0
    v_dot2_f32_bf16 v43, v225, v36, 0
    v_dot2_f32_bf16 v44, v221, v36, 0
    v_dot2_f32_bf16 v45, v226, v36, 0
    v_dot2_f32_bf16 v46, v222, v36, 0
    v_dot2_f32_bf16 v47, v227, v36, 0
    v_dot2_f32_bf16 v40, v223, v37, v40
    v_dot2_f32_bf16 v41, v232, v37, v41
    v_dot2_f32_bf16 v42, v228, v37, v42
    v_dot2_f32_bf16 v43, v233, v37, v43
    v_dot2_f32_bf16 v44, v229, v37, v44
    v_dot2_f32_bf16 v45, v234, v37, v45
    v_dot2_f32_bf16 v46, v230, v37, v46
    v_dot2_f32_bf16 v47, v235, v37, v47
    v_dot2_f32_bf16 v40, v231, v38, v40
    v_dot2_f32_bf16 v41, v240, v38, v41
    v_dot2_f32_bf16 v42, v236, v38, v42
    v_dot2_f32_bf16 v43, v241, v38, v43
    v_dot2_f32_bf16 v44, v237, v38, v44
    v_dot2_f32_bf16 v45, v242, v38, v45
    v_dot2_f32_bf16 v46, v238, v38, v46
    v_dot2_f32_bf16 v47, v243, v38, v47
    v_dot2_f32_bf16 v40, v239, v39, v40
    v_dot2_f32_bf16 v41, v248, v39, v41
    v_dot2_f32_bf16 v42, v244, v39, v42
    v_dot2_f32_bf16 v43, v249, v39, v43
    v_dot2_f32_bf16 v44, v245, v39, v44
    v_dot2_f32_bf16 v45, v250, v39, v45
    v_dot2_f32_bf16 v46, v246, v39, v46
    v_dot2_f32_bf16 v47, v251, v39, v47
    v_add_f32_dpp v40, v40, v40 quad_perm:[1,0,3,2] row_mask:0xf bank_mask:0xf
    v_add_f32_dpp v41, v41, v41 quad_perm:[1,0,3,2] row_mask:0xf bank_mask:0xf
    v_add_f32_dpp v42, v42, v42 quad_perm:[1,0,3,2] row_mask:0xf bank_mask:0xf
    v_add_f32_dpp v43, v43, v43 quad_perm:[1,0,3,2] row_mask:0xf bank_mask:0xf
    v_add_f32_dpp v44, v44, v44 quad_perm:[1,0,3,2] row_mask:0xf bank_mask:0xf
    v_add_f32_dpp v45, v45, v45 quad_perm:[1,0,3,2] row_mask:0xf bank_mask:0xf
    v_add_f32_dpp v46, v46, v46 quad_perm:[1,0,3,2] row_mask:0xf bank_mask:0xf
    v_add_f32_dpp v47, v47, v47 quad_perm:[1,0,3,2] row_mask:0xf bank_mask:0xf
    v_cndmask_b32 v40, v40, v44, vcc
    v_cndmask_b32 v41, v41, v45, vcc
    v_cndmask_b32 v42, v42, v46, vcc
    v_cndmask_b32 v43, v43, v47, vcc
    s_cmp_lt_u32 s29, 224
    s_cselect_b64 exec, -1, 0
    buffer_store_dwordx4 v[40:43], v30, s[20:23], s32 offen sc1
    s_mov_b64 exec, -1
    s_branch k_end
l_tred:
    s_cmp_ge_u32 s28, 2
    s_cbranch_scc1 k_end
    v_and_b32 v30, 2, v252
    v_cmp_eq_u32 vcc, 2, v30
    v_mov_b32 v28, s76
    v_mul_f32 v29, s75, v28
    v_add_f32 v28, 1.0, v28
    v_cndmask_b32 v30, v24, v26, vcc
    v_cndmask_b32 v31, v25, v27, vcc
    v_lshlrev_b32 v92, 16, v30
    v_and_b32 v93, 0xffff0000, v30
    v_lshlrev_b32 v94, 16, v31
    v_and_b32 v95, 0xffff0000, v31
    v_fma_f32 v92, v92, v28, -v29
    v_fma_f32 v93, v93, v28, -v29
    v_fma_f32 v94, v94, v28, -v29
    v_fma_f32 v95, v95, v28, -v29
    v_mov_b32 v96, 0xbfb8aa3b
    v_mul_f32 v96, s74, v96
    v_exp_f32 v96, v96
    s_nop 0
    v_add_f32 v96, 1.0, v96
    v_rcp_f32 v96, v96
    s_mov_b32 s78, s27
pl_129:
    s_mul_i32 s32, s89, 14336
    s_add_u32 s32, s32, s79
    s_add_u32 s32, s32, 0xc80000
    buffer_load_dwordx4 v[32:35], v253, s[20:23], s32 offen offset:0 sc1
    buffer_load_dwordx4 v[36:39], v253, s[20:23], s32 offen offset:1024 sc1
    buffer_load_dwordx4 v[40:43], v253, s[20:23], s32 offen offset:2048 sc1
    buffer_load_dwordx4 v[44:47], v253, s[20:23], s32 offen offset:3072 sc1
    s_add_u32 s32, s32, 4096
    buffer_load_dwordx4 v[48:51], v253, s[20:23], s32 offen offset:0 sc1
    buffer_load_dwordx4 v[52:55], v253, s[20:23], s32 offen offset:1024 sc1
    buffer_load_dwordx4 v[56:59], v253, s[20:23], s32 offen offset:2048 sc1
    buffer_load_dwordx4 v[60:63], v253, s[20:23], s32 offen offset:3072 sc1
    s_add_u32 s32, s32, 4096
    buffer_load_dwordx4 v[64:67], v253, s[20:23], s32 offen offset:0 sc1
    buffer_load_dwordx4 v[68:71], v253, s[20:23], s32 offen offset:1024 sc1
    buffer_load_dwordx4 v[72:75], v253, s[20:23], s32 offen offset:2048 sc1
    buffer_load_dwordx4 v[76:79], v253, s[20:23], s32 offen offset:3072 sc1
    s_add_u32 s32, s32, 4096
    buffer_load_dwordx4 v[80:83], v253, s[20:23], s32 offen offset:0 sc1
    buffer_load_dwordx4 v[84:87], v253, s[20:23], s32 offen offset:1024 sc1
    s_waitcnt vmcnt(0)
pc_130:
    v_max3_u32 v30, v32, v33, v34
    v_max3_u32 v30, v30, v35, v36
    v_max3_u32 v30, v30, v37, v38
    v_max3_u32 v30, v30, v39, v40
    v_max3_u32 v30, v30, v41, v42
    v_max3_u32 v30, v30, v43, v44
    v_max3_u32 v30, v30, v45, v46
    v_max3_u32 v30, v30, v47, v48
    v_max3_u32 v30, v30, v49, v50
    v_max3_u32 v30, v30, v51, v52
    v_max3_u32 v30, v30, v53, v54
    v_max3_u32 v30, v30, v55, v56
    v_max3_u32 v30, v30, v57, v58
    v_max3_u32 v30, v30, v59, v60
    v_max3_u32 v30, v30, v61, v62
    v_max3_u32 v30, v30, v63, v64
    v_max3_u32 v30, v30, v65, v66
    v_max3_u32 v30, v30, v67, v68
    v_max3_u32 v30, v30, v69, v70
    v_max3_u32 v30, v30, v71, v72
    v_max3_u32 v30, v30, v73, v74
    v_max3_u32 v30, v30, v75, v76
    v_max3_u32 v30, v30, v77, v78
    v_max3_u32 v30, v30, v79, v80
    v_max3_u32 v30, v30, v81, v82
    v_max3_u32 v30, v30, v83, v84
    v_max3_u32 v30, v30, v85, v86
    v_max_u32 v30, v30, v87
    v_cmp_eq_u32 vcc, -1, v30
    s_cbranch_vccz pd_131
    s_sub_u32 s78, s78, 1
    s_cmp_lg_u32 s78, 0
    s_cbranch_scc1 pl_129
    s_mov_b32 s27, 1
pd_131:
    v_pk_add_f32 v[32:33], v[32:33], v[36:37]
    v_pk_add_f32 v[34:35], v[34:35], v[38:39]
    v_pk_add_f32 v[32:33], v[32:33], v[40:41]
    v_pk_add_f32 v[34:35], v[34:35], v[42:43]
    v_pk_add_f32 v[32:33], v[32:33], v[44:45]
    v_pk_add_f32 v[34:35], v[34:35], v[46:47]
    v_pk_add_f32 v[32:33], v[32:33], v[48:49]
    v_pk_add_f32 v[34:35], v[34:35], v[50:51]
    v_pk_add_f32 v[32:33], v[32:33], v[52:53]
    v_pk_add_f32 v[34:35], v[34:35], v[54:55]
    v_pk_add_f32 v[32:33], v[32:33], v[56:57]
    v_pk_add_f32 v[34:35], v[34:35], v[58:59]
    v_pk_add_f32 v[32:33], v[32:33], v[60:61]
    v_pk_add_f32 v[34:35], v[34:35], v[62:63]
    v_pk_add_f32 v[32:33], v[32:33], v[64:65]
    v_pk_add_f32 v[34:35], v[34:35], v[66:67]
    v_pk_add_f32 v[32:33], v[32:33], v[68:69]
    v_pk_add_f32 v[34:35], v[34:35], v[70:71]
    v_pk_add_f32 v[32:33], v[32:33], v[72:73]
    v_pk_add_f32 v[34:35], v[34:35], v[74:75]
    v_pk_add_f32 v[32:33], v[32:33], v[76:77]
    v_pk_add_f32 v[34:35], v[34:35], v[78:79]
    v_pk_add_f32 v[32:33], v[32:33], v[80:81]
    v_pk_add_f32 v[34:35], v[34:35], v[82:83]
    v_pk_add_f32 v[32:33], v[32:33], v[84:85]
    v_pk_add_f32 v[34:35], v[34:35], v[86:87]
    s_nop 0
    v_add_f32_dpp v32, v32, v32 row_ror:4 row_mask:0xf bank_mask:0xf
    v_add_f32_dpp v33, v33, v33 row_ror:4 row_mask:0xf bank_mask:0xf
    v_add_f32_dpp v34, v34, v34 row_ror:4 row_mask:0xf bank_mask:0xf
    v_add_f32_dpp v35, v35, v35 row_ror:4 row_mask:0xf bank_mask:0xf
    v_add_f32_dpp v32, v32, v32 row_ror:8 row_mask:0xf bank_mask:0xf
    v_add_f32_dpp v33, v33, v33 row_ror:8 row_mask:0xf bank_mask:0xf
    v_add_f32_dpp v34, v34, v34 row_ror:8 row_mask:0xf bank_mask:0xf
    v_add_f32_dpp v35, v35, v35 row_ror:8 row_mask:0xf bank_mask:0xf
    v_mov_b32 v36, v32
    v_mov_b32 v37, v33
    v_mov_b32 v38, v34
    v_mov_b32 v39, v35
    v_permlane16_swap_b32 v32, v36
    v_permlane16_swap_b32 v33, v37
    v_permlane16_swap_b32 v34, v38
    v_permlane16_swap_b32 v35, v39
    v_add_f32 v32, v32, v36
    v_add_f32 v33, v33, v37
    v_add_f32 v34, v34, v38
    v_add_f32 v35, v35, v39
    v_mov_b32 v36, v32
    v_mov_b32 v37, v33
    v_mov_b32 v38, v34
    v_mov_b32 v39, v35
    v_permlane32_swap_b32 v32, v36
    v_permlane32_swap_b32 v33, v37
    v_permlane32_swap_b32 v34, v38
    v_permlane32_swap_b32 v35, v39
    v_add_f32 v32, v32, v36
    v_add_f32 v33, v33, v37
    v_add_f32 v34, v34, v38
    v_add_f32 v35, v35, v39
    v_fma_f32 v32, v32, v96, v92
    v_fma_f32 v33, v33, v96, v93
    v_fma_f32 v34, v34, v96, v94
    v_fma_f32 v35, v35, v96, v95
    v_cvt_pk_bf16_f32 v32, v32, v33
    v_cvt_pk_bf16_f32 v33, v34, v35
    s_lshl_b32 s32, s73, 11
    s_lshl_b32 s33, s89, 5
    s_add_u32 s32, s32, s33
    v_lshlrev_b32 v30, 3, v252
    s_mov_b64 exec, 15
    buffer_store_dwordx2 v[32:33], v30, s[12:15], s32 offen sc1
    s_mov_b64 exec, -1
k_end:
k_exit:
    s_endpgm
.section .rodata,"a"
.p2align 6
.amdhsa_kernel interleave_layers__sliding_block__moe_arch_mod__prompt_kernel
  .amdhsa_next_free_vgpr 256
  .amdhsa_next_free_sgpr 102
  .amdhsa_accum_offset 256
  .amdhsa_group_segment_fixed_size 0
  .amdhsa_kernarg_size 88
  .amdhsa_user_sgpr_count 2
  .amdhsa_user_sgpr_kernarg_segment_ptr 1
  .amdhsa_system_sgpr_workgroup_id_x 1
.end_amdhsa_kernel
```

```asm
; @launch grid=(256,1,1) block=(512,1,1) lds=163840
.amdgcn_target "amdgcn-amd-amdhsa--gfx950"
.text
.globl interleave_layers__sliding_block__moe_arch_mod__prompt_kernel
.p2align 8
.type interleave_layers__sliding_block__moe_arch_mod__prompt_kernel,@function
interleave_layers__sliding_block__moe_arch_mod__prompt_kernel:
    s_cmp_ge_u32 s2, 256
    s_cbranch_scc1 k_exit
    s_load_dwordx4 s[4:7], s[0:1], 0
    s_load_dwordx2 s[8:9], s[0:1], 16
    s_load_dwordx2 s[20:21], s[0:1], 80
    s_load_dwordx2 s[80:81], s[0:1], 32
    v_lshrrev_b32 v1, 6, v0
    v_and_b32 v252, 63, v0
    v_readfirstlane_b32 s3, v1
    v_lshlrev_b32 v253, 4, v252
    s_and_b32 s30, s2, 7
    s_lshr_b32 s31, s2, 3
    s_and_b32 s32, s31, 1
    s_lshl_b32 s33, s30, 1
    s_add_u32 s24, s33, s32
    s_lshr_b32 s25, s31, 1
    s_add_u32 s33, s33, s25
    s_add_u32 s94, s33, s32
    s_sub_u32 s95, s33, s32
    s_add_u32 s98, s95, 15
    s_and_b32 s98, s98, 15
    s_mul_i32 s29, s30, 28
    s_lshl_b32 s32, s30, 2
    s_add_u32 s32, s32, 196
    s_cmp_lt_u32 s31, 28
    s_cselect_b32 s29, s29, s32
    s_add_u32 s29, s29, s31
    s_lshl_b32 s72, s24, 4
    s_add_u32 s72, s72, s25
    s_mov_b32 s26, 0
    s_mov_b32 s27, 20000
    s_and_b32 s28, s3, 3
    s_lshl_b32 s99, s24, 2
    s_add_u32 s99, s99, s28
    s_lshl_b32 s101, s28, 10
    s_mov_b32 s18, 0x600000
    s_mov_b32 s19, 0x20000
    s_mov_b32 s10, 0x200000
    s_mov_b32 s11, 0x20000
    s_mov_b32 s22, 0x8000000
    s_mov_b32 s23, 0x20000
    s_mov_b32 s82, 0x800
    s_mov_b32 s83, 0x20000
    s_cmp_ge_u32 s3, 4
    s_cbranch_scc1 l_start
    s_getpc_b64 s[32:33]
pc_1:
    s_sub_u32 s32, s32, pc_1-interleave_layers__sliding_block__moe_arch_mod__prompt_kernel
    s_subb_u32 s33, s33, 0
    s_lshr_b32 s34, s2, 3
    s_lshl_b32 s34, s34, 2
    s_add_u32 s34, s34, s28
    s_and_b32 s34, s34, 63
    s_lshl_b32 s34, s34, 7
    v_lshl_add_u32 v191, v252, 13, s34
    s_mov_b32 s34, k_exit-interleave_layers__sliding_block__moe_arch_mod__prompt_kernel
    s_mov_b32 s35, 0x20000
    buffer_load_dword v191, v191, s[32:35], 0 offen
    s_waitcnt lgkmcnt(0)
    s_mov_b32 s88, 0xdd8000
    s_load_dword s88, s[20:21], s88
    s_mov_b64 s[16:17], s[6:7]
    s_mov_b32 s6, 0x400000
    s_mov_b32 s7, 0x20000
    s_load_dwordx2 s[12:13], s[0:1], 64
    s_mov_b32 s14, 0x400000
    s_mov_b32 s15, 0x20000
    s_lshr_b32 s30, s16, 7
    s_sub_u32 s30, 3, s30
    s_and_b32 s30, s30, 7
    s_and_b32 s31, s24, 1
    s_lshl_b32 s31, s31, 3
    s_add_u32 s30, s30, s31
    s_and_b32 s31, s24, 14
    s_add_u32 s84, s31, s30
    s_lshl_b32 s31, s25, 2
    s_add_u32 s31, s31, s28
    s_mul_i32 s31, s31, 6144
    s_lshl_b32 s30, s30, 7
    s_add_u32 s30, s30, s31
    v_min_u32 v190, 2, v252
    v_lshl_add_u32 v190, v190, 11, s30
    s_add_u32 s30, s84, 0
    s_and_b32 s30, s30, 15
    s_mul_i32 s30, s30, 393216
    buffer_load_dword v191, v190, s[16:19], s30 offen
    s_add_u32 s30, s84, 1
    s_and_b32 s30, s30, 15
    s_mul_i32 s30, s30, 393216
    buffer_load_dword v191, v190, s[16:19], s30 offen
    v_lshrrev_b32 v5, 5, v252
    v_lshlrev_b32 v6, 3, v5
    s_lshl_b32 s33, s98, 7
    buffer_load_dwordx2 v[224:225], v6, s[80:83], s33 offen offset:0
    buffer_load_dwordx2 v[226:227], v6, s[80:83], s33 offen offset:16
    buffer_load_dwordx2 v[228:229], v6, s[80:83], s33 offen offset:32
    buffer_load_dwordx2 v[230:231], v6, s[80:83], s33 offen offset:48
    buffer_load_dwordx2 v[232:233], v6, s[80:83], s33 offen offset:64
    buffer_load_dwordx2 v[234:235], v6, s[80:83], s33 offen offset:80
    buffer_load_dwordx2 v[236:237], v6, s[80:83], s33 offen offset:96
    buffer_load_dwordx2 v[238:239], v6, s[80:83], s33 offen offset:112
    s_mov_b32 s40, 0xffffffff
    s_mov_b32 s41, 0xfffffff0
    s_mov_b32 s42, 0xfffffffe
    s_mov_b32 s43, 0xffffffe0
    s_mov_b32 s44, 0xfffffffc
    s_mov_b32 s45, 0xffffffc0
    s_mov_b32 s46, 0xfffffff8
    s_mov_b32 s47, 0xffffff80
    s_mov_b32 s48, 0xffff0000
    s_mov_b32 s49, 0xfff00000
    s_mov_b32 s50, 0xfffe0000
    s_mov_b32 s51, 0xffe00000
    s_mov_b32 s52, 0xfffc0000
    s_mov_b32 s53, 0xffc00000
    s_mov_b32 s54, 0xfff80000
    s_mov_b32 s55, 0xff800000
    s_mov_b32 s56, 0xffffff00
    s_mov_b32 s57, 0xfffff000
    s_mov_b32 s58, 0xfffffe00
    s_mov_b32 s59, 0xffffe000
    s_mov_b32 s60, 0xfffffc00
    s_mov_b32 s61, 0xffffc000
    s_mov_b32 s62, 0xfffff800
    s_mov_b32 s63, 0xffff8000
    s_mov_b32 s64, 0xff000000
    s_mov_b32 s65, 0xf0000000
    s_mov_b32 s66, 0xfe000000
    s_mov_b32 s67, 0xe0000000
    s_mov_b32 s68, 0xfc000000
    s_mov_b32 s69, 0xc0000000
    s_mov_b32 s70, 0xf8000000
    s_mov_b32 s71, 0x80000000
    v_bfe_u32 v20, v252, 3, 2
    v_lshrrev_b32 v21, 5, v252
    v_lshl_add_u32 v20, v21, 3, v20
    s_lshr_b32 s32, s28, 1
    s_lshl_b32 s32, s32, 4
    s_and_b32 s33, s28, 1
    s_lshl_b32 s33, s33, 2
    s_add_u32 s32, s32, s33
    v_add_u32 v20, s32, v20
    v_lshlrev_b32 v20, 11, v20
    v_lshrrev_b32 v21, 2, v252
    v_and_b32 v21, 4, v21
    v_xor_b32 v21, v21, v252
    v_and_b32 v21, 7, v21
    v_lshl_add_u32 v20, v21, 4, v20
    s_lshl_b32 s32, s98, 7
    v_add_u32 v243, s32, v20
    s_and_b32 s34, s3, 1
    s_lshr_b32 s35, s3, 1
    v_and_b32 v4, 15, v252
    v_lshrrev_b32 v7, 4, v252
    v_lshrrev_b32 v6, 1, v4
    v_xor_b32 v6, v6, v7
    v_lshlrev_b32 v6, 4, v6
    v_lshl_add_u32 v6, v4, 7, v6
    s_lshl_b32 s30, s34, 13
    v_add_u32 v176, s30, v6
    v_xor_b32 v177, 64, v176
    s_lshl_b32 s30, s35, 1
    v_lshrrev_b32 v20, 2, v252
    v_bfe_u32 v21, v20, 1, 2
    v_xor_b32 v21, s30, v21
    v_lshlrev_b32 v20, 7, v20
    v_lshl_add_u32 v20, v21, 5, v20
    v_and_b32 v21, 3, v252
    v_lshl_add_u32 v20, v21, 3, v20
    v_add_u32 v178, 40960, v20
    v_xor_b32 v179, 32, v178
    v_and_b32 v8, 31, v252
    v_bfe_u32 v6, v8, 1, 3
    v_xor_b32 v6, v6, v5
    v_lshlrev_b32 v6, 4, v6
    v_lshl_add_u32 v6, v8, 7, v6
    s_lshl_b32 s30, s3, 12
    s_add_u32 s30, s30, 147456
    v_add_u32 v192, s30, v6
    v_xor_b32 v193, 32, v192
    v_xor_b32 v194, 64, v192
    v_xor_b32 v195, 96, v192
    s_lshl_b32 s30, s34, 8
    v_lshl_add_u32 v184, v4, 2, s30
    v_lshl_add_u32 v185, v7, 4, s30
    s_lshl_b32 s30, s35, 7
    v_lshl_add_u32 v186, v7, 4, s30
    s_add_u32 s30, s30, 1536
    v_lshl_add_u32 v187, v4, 2, s30
    s_lshl_b32 s30, s3, 7
    s_add_u32 s30, s30, 2048
    v_lshl_add_u32 v188, v8, 2, s30
    v_mov_b32 v189, 0
    v_lshlrev_b32 v6, 9, v7
    v_lshl_add_u32 v245, v4, 4, v6
    v_and_b32 v9, 8, v4
    v_lshl_add_u32 v244, v9, 4, v245
    s_mul_i32 s30, s35, 49152
    s_lshl_b32 s31, s34, 13
    s_add_u32 s30, s30, s31
    s_add_u32 s30, s30, 98304
    v_add_u32 v246, s30, v244
    v_add_u32 v247, s30, v245
    s_lshl_b32 s30, s3, 12
    s_add_u32 s30, s30, 49152
    v_add_u32 v248, s30, v245
    s_getreg_b32 s30, hwreg(HW_REG_XCC_ID, 0, 4)
    v_mov_b32 v251, s30
    s_lshl_b32 s30, s25, 4
    s_add_u32 s30, s30, s24
    s_sub_u32 s30, s30, s72
    s_add_u32 s30, s30, 512
    v_mul_u32_u24 v249, s30, v252
    v_add_u32 v249, s72, v249
    v_lshlrev_b32 v249, 3, v249
    s_cmp_eq_u32 s3, 0
    s_cselect_b32 s89, 10, -1
    v_mov_b32 v242, 0
    v_mov_b32 v0, 0
    v_mov_b32 v1, 0
    v_mov_b32 v2, 0
    v_mov_b32 v3, 0
    v_mov_b32 v4, 0
    v_mov_b32 v5, 0
    v_mov_b32 v6, 0
    v_mov_b32 v7, 0
    v_mov_b32 v8, 0
    v_mov_b32 v9, 0
    v_mov_b32 v10, 0
    v_mov_b32 v11, 0
    v_mov_b32 v12, 0
    v_mov_b32 v13, 0
    v_mov_b32 v14, 0
    v_mov_b32 v15, 0
    v_mov_b32 v16, 0
    v_mov_b32 v17, 0
    v_mov_b32 v18, 0
    v_mov_b32 v19, 0
    v_mov_b32 v20, 0
    v_mov_b32 v21, 0
    v_mov_b32 v22, 0
    v_mov_b32 v23, 0
    v_mov_b32 v24, 0
    v_mov_b32 v25, 0
    v_mov_b32 v26, 0
    v_mov_b32 v27, 0
    v_mov_b32 v28, 0
    v_mov_b32 v29, 0
    v_mov_b32 v30, 0
    v_mov_b32 v31, 0
    v_mov_b32 v32, 0
    v_mov_b32 v33, 0
    v_mov_b32 v34, 0
    v_mov_b32 v35, 0
    v_mov_b32 v36, 0
    v_mov_b32 v37, 0
    v_mov_b32 v38, 0
    v_mov_b32 v39, 0
    v_mov_b32 v40, 0
    v_mov_b32 v41, 0
    v_mov_b32 v42, 0
    v_mov_b32 v43, 0
    v_mov_b32 v44, 0
    v_mov_b32 v45, 0
    v_mov_b32 v46, 0
    v_mov_b32 v47, 0
    v_mov_b32 v48, 0
    v_mov_b32 v49, 0
    v_mov_b32 v50, 0
    v_mov_b32 v51, 0
    v_mov_b32 v52, 0
    v_mov_b32 v53, 0
    v_mov_b32 v54, 0
    v_mov_b32 v55, 0
    v_mov_b32 v56, 0
    v_mov_b32 v57, 0
    v_mov_b32 v58, 0
    v_mov_b32 v59, 0
    v_mov_b32 v60, 0
    v_mov_b32 v61, 0
    v_mov_b32 v62, 0
    v_mov_b32 v63, 0
    v_mov_b32 v64, 0
    v_mov_b32 v65, 0
    v_mov_b32 v66, 0
    v_mov_b32 v67, 0
    v_mov_b32 v68, 0
    v_mov_b32 v69, 0
    v_mov_b32 v70, 0
    v_mov_b32 v71, 0
    v_mov_b32 v72, 0
    v_mov_b32 v73, 0
    v_mov_b32 v74, 0
    v_mov_b32 v75, 0
    v_mov_b32 v76, 0
    v_mov_b32 v77, 0
    v_mov_b32 v78, 0
    v_mov_b32 v79, 0
    v_mov_b32 v80, 0
    v_mov_b32 v81, 0
    v_mov_b32 v82, 0
    v_mov_b32 v83, 0
    v_mov_b32 v84, 0
    v_mov_b32 v85, 0
    v_mov_b32 v86, 0
    v_mov_b32 v87, 0
    v_mov_b32 v88, 0
    v_mov_b32 v89, 0
    v_mov_b32 v90, 0
    v_mov_b32 v91, 0
    v_mov_b32 v92, 0
    v_mov_b32 v93, 0
    v_mov_b32 v94, 0
    v_mov_b32 v95, 0
    s_waitcnt vmcnt(0) lgkmcnt(0)
    s_add_u32 s88, s88, 0x9e3779b9
    v_mov_b32 v250, s88
    v_dot2c_f32_bf16 v242, 0x3f803f80, v224
    v_dot2c_f32_bf16 v242, 0x3f803f80, v225
    v_dot2c_f32_bf16 v242, 0x3f803f80, v226
    v_dot2c_f32_bf16 v242, 0x3f803f80, v227
    v_dot2c_f32_bf16 v242, 0x3f803f80, v228
    v_dot2c_f32_bf16 v242, 0x3f803f80, v229
    v_dot2c_f32_bf16 v242, 0x3f803f80, v230
    v_dot2c_f32_bf16 v242, 0x3f803f80, v231
    v_dot2c_f32_bf16 v242, 0x3f803f80, v232
    v_dot2c_f32_bf16 v242, 0x3f803f80, v233
    v_dot2c_f32_bf16 v242, 0x3f803f80, v234
    v_dot2c_f32_bf16 v242, 0x3f803f80, v235
    v_dot2c_f32_bf16 v242, 0x3f803f80, v236
    v_dot2c_f32_bf16 v242, 0x3f803f80, v237
    v_dot2c_f32_bf16 v242, 0x3f803f80, v238
    v_dot2c_f32_bf16 v242, 0x3f803f80, v239
    s_add_u32 s30, s84, 2
    s_and_b32 s30, s30, 15
    s_mul_i32 s30, s30, 393216
    buffer_load_dword v191, v190, s[16:19], s30 offen
    s_add_u32 s30, s84, 3
    s_and_b32 s30, s30, 15
    s_mul_i32 s30, s30, 393216
    buffer_load_dword v191, v190, s[16:19], s30 offen
    s_add_u32 s30, s84, 4
    s_and_b32 s30, s30, 15
    s_mul_i32 s30, s30, 393216
    buffer_load_dword v191, v190, s[16:19], s30 offen
    s_add_u32 s30, s84, 5
    s_and_b32 s30, s30, 15
    s_mul_i32 s30, s30, 393216
    buffer_load_dword v191, v190, s[16:19], s30 offen
    s_setprio 1
e_q:
    s_mov_b32 s31, 0
    s_mov_b32 s32, 147456
    s_mov_b32 s36, 15
    v_add_u32 v180, s32, v176
    v_mov_b32 v182, v178
    v_add_u32 v181, s32, v177
    v_mov_b32 v183, v179
    s_barrier
    ds_read_b128 v[96:99], v180 offset:0
    ds_read_b64_tr_b16 v[112:113], v182 offset:0
    ds_read_b64_tr_b16 v[114:115], v182 offset:2048
    ds_read_b128 v[100:103], v180 offset:2048
    ds_read_b128 v[104:107], v180 offset:4096
    ds_read_b128 v[108:111], v180 offset:6144
    ds_read_b64_tr_b16 v[116:117], v183 offset:0
    ds_read_b64_tr_b16 v[118:119], v183 offset:2048
    ds_read_b64_tr_b16 v[120:121], v182 offset:8192
    ds_read_b64_tr_b16 v[122:123], v182 offset:10240
    ds_read_b64_tr_b16 v[124:125], v183 offset:8192
    ds_read_b64_tr_b16 v[126:127], v183 offset:10240
    ds_read_b64_tr_b16 v[128:129], v182 offset:16384
    ds_read_b64_tr_b16 v[130:131], v182 offset:18432
    ds_read_b64_tr_b16 v[132:133], v183 offset:16384
    ds_read_b64_tr_b16 v[134:135], v183 offset:18432
    s_add_u32 s85, s84, 5
e_loop:
    s_waitcnt lgkmcnt(0)
    v_mfma_f32_16x16x32_bf16 v[0:3], v[112:115], v[96:99], v[0:3]
    ds_read_b128 v[136:139], v181 offset:0
    v_mfma_f32_16x16x32_bf16 v[8:11], v[112:115], v[100:103], v[8:11]
    ds_read_b64_tr_b16 v[152:153], v182 offset:4096
    v_mfma_f32_16x16x32_bf16 v[16:19], v[112:115], v[104:107], v[16:19]
    ds_read_b64_tr_b16 v[154:155], v182 offset:6144
    v_mfma_f32_16x16x32_bf16 v[24:27], v[112:115], v[108:111], v[24:27]
    ds_read_b128 v[140:143], v181 offset:2048
    v_mfma_f32_16x16x32_bf16 v[28:31], v[116:119], v[108:111], v[28:31]
    ds_read_b128 v[144:147], v181 offset:4096
    v_mfma_f32_16x16x32_bf16 v[20:23], v[116:119], v[104:107], v[20:23]
    ds_read_b128 v[148:151], v181 offset:6144
    v_mfma_f32_16x16x32_bf16 v[12:15], v[116:119], v[100:103], v[12:15]
    ds_read_b64_tr_b16 v[156:157], v183 offset:4096
    v_mfma_f32_16x16x32_bf16 v[4:7], v[116:119], v[96:99], v[4:7]
    ds_read_b64_tr_b16 v[158:159], v183 offset:6144
    v_mfma_f32_16x16x32_bf16 v[32:35], v[120:123], v[96:99], v[32:35]
    ds_read_b64_tr_b16 v[160:161], v182 offset:12288
    v_mfma_f32_16x16x32_bf16 v[40:43], v[120:123], v[100:103], v[40:43]
    ds_read_b64_tr_b16 v[162:163], v182 offset:14336
    v_mfma_f32_16x16x32_bf16 v[48:51], v[120:123], v[104:107], v[48:51]
    ds_read_b64_tr_b16 v[164:165], v183 offset:12288
    v_mfma_f32_16x16x32_bf16 v[56:59], v[120:123], v[108:111], v[56:59]
    ds_read_b64_tr_b16 v[166:167], v183 offset:14336
    v_mfma_f32_16x16x32_bf16 v[60:63], v[124:127], v[108:111], v[60:63]
    ds_read_b64_tr_b16 v[168:169], v182 offset:20480
    v_mfma_f32_16x16x32_bf16 v[52:55], v[124:127], v[104:107], v[52:55]
    ds_read_b64_tr_b16 v[170:171], v182 offset:22528
    v_mfma_f32_16x16x32_bf16 v[44:47], v[124:127], v[100:103], v[44:47]
    ds_read_b64_tr_b16 v[172:173], v183 offset:20480
    v_mfma_f32_16x16x32_bf16 v[36:39], v[124:127], v[96:99], v[36:39]
    ds_read_b64_tr_b16 v[174:175], v183 offset:22528
    v_mfma_f32_16x16x32_bf16 v[64:67], v[96:99], v[128:131], v[64:67]
    s_cmp_eq_u32 s36, s89
    s_cbranch_scc1 e_arr
e_arr_ret:
    v_mfma_f32_16x16x32_bf16 v[68:71], v[100:103], v[128:131], v[68:71]
    s_add_u32 s31, s31, 24576
    s_sub_u32 s32, s32, 16384
    v_mfma_f32_16x16x32_bf16 v[72:75], v[104:107], v[128:131], v[72:75]
    s_cmp_ge_u32 s31, 73728
    s_cselect_b32 s31, 0, s31
    s_cselect_b32 s32, 147456, s32
    v_mfma_f32_16x16x32_bf16 v[76:79], v[108:111], v[128:131], v[76:79]
    v_add_u32 v182, s31, v178
    v_add_u32 v180, s32, v176
    v_mfma_f32_16x16x32_bf16 v[92:95], v[108:111], v[132:135], v[92:95]
    v_add_u32 v183, s31, v179
    v_add_u32 v181, s32, v177
    v_mfma_f32_16x16x32_bf16 v[88:91], v[104:107], v[132:135], v[88:91]
    s_add_u32 s85, s85, 1
    s_and_b32 s30, s85, 15
    v_mfma_f32_16x16x32_bf16 v[84:87], v[100:103], v[132:135], v[84:87]
    s_mul_i32 s30, s30, 393216
    s_cmp_ge_u32 s36, 6
    v_mfma_f32_16x16x32_bf16 v[80:83], v[96:99], v[132:135], v[80:83]
    s_waitcnt lgkmcnt(0)
    v_mfma_f32_16x16x32_bf16 v[0:3], v[152:155], v[136:139], v[0:3]
    s_barrier
    ds_read_b128 v[96:99], v180 offset:0
    v_mfma_f32_16x16x32_bf16 v[8:11], v[152:155], v[140:143], v[8:11]
    ds_read_b64_tr_b16 v[112:113], v182 offset:0
    v_mfma_f32_16x16x32_bf16 v[16:19], v[152:155], v[144:147], v[16:19]
    ds_read_b64_tr_b16 v[114:115], v182 offset:2048
    v_mfma_f32_16x16x32_bf16 v[24:27], v[152:155], v[148:151], v[24:27]
    ds_read_b128 v[100:103], v180 offset:2048
    v_mfma_f32_16x16x32_bf16 v[28:31], v[156:159], v[148:151], v[28:31]
    ds_read_b128 v[104:107], v180 offset:4096
    v_mfma_f32_16x16x32_bf16 v[20:23], v[156:159], v[144:147], v[20:23]
    ds_read_b128 v[108:111], v180 offset:6144
    v_mfma_f32_16x16x32_bf16 v[12:15], v[156:159], v[140:143], v[12:15]
    ds_read_b64_tr_b16 v[116:117], v183 offset:0
    v_mfma_f32_16x16x32_bf16 v[4:7], v[156:159], v[136:139], v[4:7]
    ds_read_b64_tr_b16 v[118:119], v183 offset:2048
    v_mfma_f32_16x16x32_bf16 v[32:35], v[160:163], v[136:139], v[32:35]
    ds_read_b64_tr_b16 v[120:121], v182 offset:8192
    v_mfma_f32_16x16x32_bf16 v[40:43], v[160:163], v[140:143], v[40:43]
    ds_read_b64_tr_b16 v[122:123], v182 offset:10240
    v_mfma_f32_16x16x32_bf16 v[48:51], v[160:163], v[144:147], v[48:51]
    ds_read_b64_tr_b16 v[124:125], v183 offset:8192
    v_mfma_f32_16x16x32_bf16 v[56:59], v[160:163], v[148:151], v[56:59]
    ds_read_b64_tr_b16 v[126:127], v183 offset:10240
    v_mfma_f32_16x16x32_bf16 v[60:63], v[164:167], v[148:151], v[60:63]
    ds_read_b64_tr_b16 v[128:129], v182 offset:16384
    v_mfma_f32_16x16x32_bf16 v[52:55], v[164:167], v[144:147], v[52:55]
    ds_read_b64_tr_b16 v[130:131], v182 offset:18432
    v_mfma_f32_16x16x32_bf16 v[44:47], v[164:167], v[140:143], v[44:47]
    ds_read_b64_tr_b16 v[132:133], v183 offset:16384
    v_mfma_f32_16x16x32_bf16 v[36:39], v[164:167], v[136:139], v[36:39]
    ds_read_b64_tr_b16 v[134:135], v183 offset:18432
    v_mfma_f32_16x16x32_bf16 v[64:67], v[136:139], v[168:171], v[64:67]
    s_cselect_b64 exec, 7, 0
    buffer_load_dword v191, v190, s[16:19], s30 offen
    s_mov_b64 exec, -1
    v_mfma_f32_16x16x32_bf16 v[68:71], v[140:143], v[168:171], v[68:71]
    s_sub_u32 s36, s36, 1
    s_cmp_eq_u32 s36, 0
    v_mfma_f32_16x16x32_bf16 v[72:75], v[144:147], v[168:171], v[72:75]
    v_mfma_f32_16x16x32_bf16 v[76:79], v[148:151], v[168:171], v[76:79]
    v_mfma_f32_16x16x32_bf16 v[92:95], v[148:151], v[172:175], v[92:95]
    v_mfma_f32_16x16x32_bf16 v[88:91], v[144:147], v[172:175], v[88:91]
    v_mfma_f32_16x16x32_bf16 v[84:87], v[140:143], v[172:175], v[84:87]
    v_mfma_f32_16x16x32_bf16 v[80:83], v[136:139], v[172:175], v[80:83]
    s_cbranch_scc0 e_loop
    s_waitcnt lgkmcnt(0)
    v_mfma_f32_16x16x32_bf16 v[0:3], v[112:115], v[96:99], v[0:3]
    ds_read_b128 v[136:139], v181 offset:0
    v_mfma_f32_16x16x32_bf16 v[8:11], v[112:115], v[100:103], v[8:11]
    ds_read_b64_tr_b16 v[152:153], v182 offset:4096
    v_mfma_f32_16x16x32_bf16 v[16:19], v[112:115], v[104:107], v[16:19]
    ds_read_b64_tr_b16 v[154:155], v182 offset:6144
    v_mfma_f32_16x16x32_bf16 v[24:27], v[112:115], v[108:111], v[24:27]
    ds_read_b128 v[140:143], v181 offset:2048
    v_mfma_f32_16x16x32_bf16 v[28:31], v[116:119], v[108:111], v[28:31]
    ds_read_b128 v[144:147], v181 offset:4096
    v_mfma_f32_16x16x32_bf16 v[20:23], v[116:119], v[104:107], v[20:23]
    ds_read_b128 v[148:151], v181 offset:6144
    v_mfma_f32_16x16x32_bf16 v[12:15], v[116:119], v[100:103], v[12:15]
    ds_read_b64_tr_b16 v[156:157], v183 offset:4096
    v_mfma_f32_16x16x32_bf16 v[4:7], v[116:119], v[96:99], v[4:7]
    ds_read_b64_tr_b16 v[158:159], v183 offset:6144
    v_mfma_f32_16x16x32_bf16 v[32:35], v[120:123], v[96:99], v[32:35]
    ds_read_b64_tr_b16 v[160:161], v182 offset:12288
    v_mfma_f32_16x16x32_bf16 v[40:43], v[120:123], v[100:103], v[40:43]
    ds_read_b64_tr_b16 v[162:163], v182 offset:14336
    v_mfma_f32_16x16x32_bf16 v[48:51], v[120:123], v[104:107], v[48:51]
    ds_read_b64_tr_b16 v[164:165], v183 offset:12288
    v_mfma_f32_16x16x32_bf16 v[56:59], v[120:123], v[108:111], v[56:59]
    ds_read_b64_tr_b16 v[166:167], v183 offset:14336
    v_mfma_f32_16x16x32_bf16 v[60:63], v[124:127], v[108:111], v[60:63]
    ds_read_b64_tr_b16 v[168:169], v182 offset:20480
    v_mfma_f32_16x16x32_bf16 v[52:55], v[124:127], v[104:107], v[52:55]
    ds_read_b64_tr_b16 v[170:171], v182 offset:22528
    v_mfma_f32_16x16x32_bf16 v[44:47], v[124:127], v[100:103], v[44:47]
    ds_read_b64_tr_b16 v[172:173], v183 offset:20480
    v_mfma_f32_16x16x32_bf16 v[36:39], v[124:127], v[96:99], v[36:39]
    ds_read_b64_tr_b16 v[174:175], v183 offset:22528
    v_mfma_f32_16x16x32_bf16 v[64:67], v[96:99], v[128:131], v[64:67]
    s_cmp_lg_u32 s26, 0
    s_cbranch_scc1 e_nores
    ds_read_b128 v[208:211], v192
    ds_read_b128 v[212:215], v193
    ds_read_b128 v[216:219], v194
    ds_read_b128 v[220:223], v195
e_nores:
    v_mfma_f32_16x16x32_bf16 v[68:71], v[100:103], v[128:131], v[68:71]
    s_and_b32 s34, s3, 1
    s_lshr_b32 s35, s3, 1
    s_lshl_b32 s30, s25, 1
    v_mfma_f32_16x16x32_bf16 v[72:75], v[104:107], v[128:131], v[72:75]
    s_add_u32 s30, s30, s35
    s_lshl_b32 s30, s30, 6
    s_lshl_b32 s31, s24, 2
    v_mfma_f32_16x16x32_bf16 v[76:79], v[108:111], v[128:131], v[76:79]
    s_add_u32 s30, s30, s31
    s_lshl_b32 s31, s34, 1
    s_add_u32 s30, s30, s31
    v_mfma_f32_16x16x32_bf16 v[92:95], v[108:111], v[132:135], v[92:95]
    s_lshl_b32 s32, s30, 12
    s_add_u32 s32, s32, s26
    s_add_u32 s33, s32, 4096
    v_mfma_f32_16x16x32_bf16 v[88:91], v[104:107], v[132:135], v[88:91]
    v_mfma_f32_16x16x32_bf16 v[84:87], v[100:103], v[132:135], v[84:87]
    v_mfma_f32_16x16x32_bf16 v[80:83], v[96:99], v[132:135], v[80:83]
    s_waitcnt vmcnt(0) lgkmcnt(0)
    v_mfma_f32_16x16x32_bf16 v[32:35], v[160:163], v[136:139], v[32:35]
    s_barrier
    ds_read2_b32 v[204:205], v184 offset0:128 offset1:144
    ds_read_b128 v[128:131], v186 offset:1280
    v_mfma_f32_16x16x32_bf16 v[40:43], v[160:163], v[140:143], v[40:43]
    ds_read_b128 v[132:135], v186 offset:1344
    ds_read2_b32 v[192:193], v184 offset0:0 offset1:16
    v_mfma_f32_16x16x32_bf16 v[48:51], v[160:163], v[144:147], v[48:51]
    ds_read2_b32 v[206:207], v184 offset0:160 offset1:176
    ds_read2_b32 v[194:195], v184 offset0:32 offset1:48
    v_mfma_f32_16x16x32_bf16 v[56:59], v[160:163], v[148:151], v[56:59]
    ds_read2_b32 v[190:191], v187 offset0:0 offset1:16
    ds_read_b128 v[112:115], v185 offset:512
    v_mfma_f32_16x16x32_bf16 v[36:39], v[164:167], v[136:139], v[36:39]
    ds_read_b128 v[96:99], v185 offset:0
    ds_read_b128 v[116:119], v185 offset:576
    v_mfma_f32_16x16x32_bf16 v[44:47], v[164:167], v[140:143], v[44:47]
    ds_read_b128 v[100:103], v185 offset:64
    ds_read_b128 v[120:123], v185 offset:640
    v_mfma_f32_16x16x32_bf16 v[52:55], v[164:167], v[144:147], v[52:55]
    ds_read_b128 v[104:107], v185 offset:128
    ds_read_b128 v[124:127], v185 offset:704
    v_mfma_f32_16x16x32_bf16 v[60:63], v[164:167], v[148:151], v[60:63]
    ds_read_b128 v[108:111], v185 offset:192
    ds_read_b128 v[196:199], v186 offset:1024
    v_mfma_f32_16x16x32_bf16 v[64:67], v[136:139], v[168:171], v[64:67]
    ds_read_b128 v[200:203], v186 offset:1088
    ds_read2_b32 v[240:241], v188 offset0:0 offset1:128
    v_mfma_f32_16x16x32_bf16 v[68:71], v[140:143], v[168:171], v[68:71]
    ds_read_b64 v[250:251], v189 offset:3072
    v_mfma_f32_16x16x32_bf16 v[72:75], v[144:147], v[168:171], v[72:75]
    s_waitcnt lgkmcnt(13)
    v_fma_f32 v32, v128, -v204, v32
    v_fma_f32 v33, v129, -v204, v33
    v_fma_f32 v34, v130, -v204, v34
    v_mfma_f32_16x16x32_bf16 v[76:79], v[148:151], v[168:171], v[76:79]
    v_fma_f32 v35, v131, -v204, v35
    v_fma_f32 v36, v132, -v204, v36
    v_fma_f32 v37, v133, -v204, v37
    v_mfma_f32_16x16x32_bf16 v[80:83], v[136:139], v[172:175], v[80:83]
    v_fma_f32 v38, v134, -v204, v38
    v_fma_f32 v39, v135, -v204, v39
    v_mul_f32 v32, v32, v192
    v_mfma_f32_16x16x32_bf16 v[84:87], v[140:143], v[172:175], v[84:87]
    v_mul_f32 v33, v33, v192
    v_mul_f32 v34, v34, v192
    v_mul_f32 v35, v35, v192
    v_mfma_f32_16x16x32_bf16 v[88:91], v[144:147], v[172:175], v[88:91]
    v_mul_f32 v36, v36, v192
    v_mul_f32 v37, v37, v192
    v_mul_f32 v38, v38, v192
    v_mfma_f32_16x16x32_bf16 v[92:95], v[148:151], v[172:175], v[92:95]
    v_mul_f32 v39, v39, v192
    v_cvt_pk_bf16_f32 v32, v32, v33
    v_cvt_pk_bf16_f32 v33, v34, v35
    v_mfma_f32_16x16x32_bf16 v[0:3], v[152:155], v[136:139], v[0:3]
    v_cvt_pk_bf16_f32 v34, v36, v37
    v_cvt_pk_bf16_f32 v35, v38, v39
    buffer_store_dwordx4 v[32:35], v244, s[20:23], s32 offen offset:0 sc1
    v_mfma_f32_16x16x32_bf16 v[8:11], v[152:155], v[140:143], v[8:11]
    v_fma_f32 v40, v128, -v205, v40
    v_fma_f32 v41, v129, -v205, v41
    v_fma_f32 v42, v130, -v205, v42
    v_mfma_f32_16x16x32_bf16 v[16:19], v[152:155], v[144:147], v[16:19]
    v_fma_f32 v43, v131, -v205, v43
    v_fma_f32 v44, v132, -v205, v44
    v_fma_f32 v45, v133, -v205, v45
    v_mfma_f32_16x16x32_bf16 v[24:27], v[152:155], v[148:151], v[24:27]
    v_fma_f32 v46, v134, -v205, v46
    v_fma_f32 v47, v135, -v205, v47
    v_mul_f32 v40, v40, v193
    v_mfma_f32_16x16x32_bf16 v[4:7], v[156:159], v[136:139], v[4:7]
    v_mul_f32 v41, v41, v193
    v_mul_f32 v42, v42, v193
    v_mul_f32 v43, v43, v193
    v_mfma_f32_16x16x32_bf16 v[12:15], v[156:159], v[140:143], v[12:15]
    v_mul_f32 v44, v44, v193
    v_mul_f32 v45, v45, v193
    v_mul_f32 v46, v46, v193
    v_mfma_f32_16x16x32_bf16 v[20:23], v[156:159], v[144:147], v[20:23]
    v_mul_f32 v47, v47, v193
    v_cvt_pk_bf16_f32 v40, v40, v41
    v_cvt_pk_bf16_f32 v41, v42, v43
    v_mfma_f32_16x16x32_bf16 v[28:31], v[156:159], v[148:151], v[28:31]
    v_cvt_pk_bf16_f32 v42, v44, v45
    v_cvt_pk_bf16_f32 v43, v46, v47
    buffer_store_dwordx4 v[40:43], v244, s[20:23], s32 offen offset:128 sc1
    v_pk_fma_f32 v[48:49], v[128:129], v[206:207], v[48:49] op_sel_hi:[1,0,1] neg_lo:[0,1,0] neg_hi:[0,1,0]
    v_pk_fma_f32 v[50:51], v[130:131], v[206:207], v[50:51] op_sel_hi:[1,0,1] neg_lo:[0,1,0] neg_hi:[0,1,0]
    v_pk_fma_f32 v[52:53], v[132:133], v[206:207], v[52:53] op_sel_hi:[1,0,1] neg_lo:[0,1,0] neg_hi:[0,1,0]
    v_pk_fma_f32 v[54:55], v[134:135], v[206:207], v[54:55] op_sel_hi:[1,0,1] neg_lo:[0,1,0] neg_hi:[0,1,0]
    v_pk_mul_f32 v[48:49], v[48:49], v[194:195] op_sel_hi:[1,0]
    v_pk_mul_f32 v[50:51], v[50:51], v[194:195] op_sel_hi:[1,0]
    v_pk_mul_f32 v[52:53], v[52:53], v[194:195] op_sel_hi:[1,0]
    v_pk_mul_f32 v[54:55], v[54:55], v[194:195] op_sel_hi:[1,0]
    v_cvt_pk_bf16_f32 v48, v48, v49
    v_cvt_pk_bf16_f32 v49, v50, v51
    v_cvt_pk_bf16_f32 v50, v52, v53
    v_cvt_pk_bf16_f32 v51, v54, v55
    buffer_store_dwordx4 v[48:51], v244, s[20:23], s33 offen offset:0 sc1
    v_pk_fma_f32 v[56:57], v[128:129], v[206:207], v[56:57] op_sel:[0,1,0] op_sel_hi:[1,1,1] neg_lo:[0,1,0] neg_hi:[0,1,0]
    v_pk_fma_f32 v[58:59], v[130:131], v[206:207], v[58:59] op_sel:[0,1,0] op_sel_hi:[1,1,1] neg_lo:[0,1,0] neg_hi:[0,1,0]
    v_pk_fma_f32 v[60:61], v[132:133], v[206:207], v[60:61] op_sel:[0,1,0] op_sel_hi:[1,1,1] neg_lo:[0,1,0] neg_hi:[0,1,0]
    v_pk_fma_f32 v[62:63], v[134:135], v[206:207], v[62:63] op_sel:[0,1,0] op_sel_hi:[1,1,1] neg_lo:[0,1,0] neg_hi:[0,1,0]
    v_pk_mul_f32 v[56:57], v[56:57], v[194:195] op_sel:[0,1] op_sel_hi:[1,1]
    v_pk_mul_f32 v[58:59], v[58:59], v[194:195] op_sel:[0,1] op_sel_hi:[1,1]
    v_pk_mul_f32 v[60:61], v[60:61], v[194:195] op_sel:[0,1] op_sel_hi:[1,1]
    v_pk_mul_f32 v[62:63], v[62:63], v[194:195] op_sel:[0,1] op_sel_hi:[1,1]
    v_cvt_pk_bf16_f32 v56, v56, v57
    v_cvt_pk_bf16_f32 v57, v58, v59
    v_cvt_pk_bf16_f32 v58, v60, v61
    v_cvt_pk_bf16_f32 v59, v62, v63
    buffer_store_dwordx4 v[56:59], v244, s[20:23], s33 offen offset:128 sc1
    s_waitcnt lgkmcnt(0)
    v_pk_fma_f32 v[64:65], v[112:113], v[190:191], v[64:65] op_sel_hi:[1,0,1] neg_lo:[0,1,0] neg_hi:[0,1,0]
    v_pk_fma_f32 v[66:67], v[114:115], v[190:191], v[66:67] op_sel_hi:[1,0,1] neg_lo:[0,1,0] neg_hi:[0,1,0]
    v_pk_fma_f32 v[68:69], v[116:117], v[190:191], v[68:69] op_sel_hi:[1,0,1] neg_lo:[0,1,0] neg_hi:[0,1,0]
    v_pk_fma_f32 v[70:71], v[118:119], v[190:191], v[70:71] op_sel_hi:[1,0,1] neg_lo:[0,1,0] neg_hi:[0,1,0]
    v_pk_mul_f32 v[64:65], v[64:65], v[96:97]
    v_pk_mul_f32 v[66:67], v[66:67], v[98:99]
    v_pk_mul_f32 v[68:69], v[68:69], v[100:101]
    v_pk_mul_f32 v[70:71], v[70:71], v[102:103]
    v_cvt_pk_bf16_f32 v64, v64, v65
    v_cvt_pk_bf16_f32 v65, v66, v67
    v_cvt_pk_bf16_f32 v66, v68, v69
    v_cvt_pk_bf16_f32 v67, v70, v71
    buffer_store_dwordx4 v[64:67], v245, s[20:23], s32 offen offset:2048 sc1
    v_pk_fma_f32 v[80:81], v[112:113], v[190:191], v[80:81] op_sel:[0,1,0] op_sel_hi:[1,1,1] neg_lo:[0,1,0] neg_hi:[0,1,0]
    v_pk_fma_f32 v[82:83], v[114:115], v[190:191], v[82:83] op_sel:[0,1,0] op_sel_hi:[1,1,1] neg_lo:[0,1,0] neg_hi:[0,1,0]
    v_pk_fma_f32 v[84:85], v[116:117], v[190:191], v[84:85] op_sel:[0,1,0] op_sel_hi:[1,1,1] neg_lo:[0,1,0] neg_hi:[0,1,0]
    v_pk_fma_f32 v[86:87], v[118:119], v[190:191], v[86:87] op_sel:[0,1,0] op_sel_hi:[1,1,1] neg_lo:[0,1,0] neg_hi:[0,1,0]
    v_pk_mul_f32 v[80:81], v[80:81], v[96:97]
    v_pk_mul_f32 v[82:83], v[82:83], v[98:99]
    v_pk_mul_f32 v[84:85], v[84:85], v[100:101]
    v_pk_mul_f32 v[86:87], v[86:87], v[102:103]
    v_cvt_pk_bf16_f32 v80, v80, v81
    v_cvt_pk_bf16_f32 v81, v82, v83
    v_cvt_pk_bf16_f32 v82, v84, v85
    v_cvt_pk_bf16_f32 v83, v86, v87
    buffer_store_dwordx4 v[80:83], v245, s[20:23], s32 offen offset:2304 sc1
    v_pk_fma_f32 v[72:73], v[120:121], v[190:191], v[72:73] op_sel_hi:[1,0,1] neg_lo:[0,1,0] neg_hi:[0,1,0]
    v_pk_fma_f32 v[74:75], v[122:123], v[190:191], v[74:75] op_sel_hi:[1,0,1] neg_lo:[0,1,0] neg_hi:[0,1,0]
    v_pk_fma_f32 v[76:77], v[124:125], v[190:191], v[76:77] op_sel_hi:[1,0,1] neg_lo:[0,1,0] neg_hi:[0,1,0]
    v_pk_fma_f32 v[78:79], v[126:127], v[190:191], v[78:79] op_sel_hi:[1,0,1] neg_lo:[0,1,0] neg_hi:[0,1,0]
    v_pk_mul_f32 v[72:73], v[72:73], v[104:105]
    v_pk_mul_f32 v[74:75], v[74:75], v[106:107]
    v_pk_mul_f32 v[76:77], v[76:77], v[108:109]
    v_pk_mul_f32 v[78:79], v[78:79], v[110:111]
    v_cvt_pk_bf16_f32 v72, v72, v73
    v_cvt_pk_bf16_f32 v73, v74, v75
    v_cvt_pk_bf16_f32 v74, v76, v77
    v_cvt_pk_bf16_f32 v75, v78, v79
    buffer_store_dwordx4 v[72:75], v245, s[20:23], s33 offen offset:2048 sc1
    v_pk_fma_f32 v[88:89], v[120:121], v[190:191], v[88:89] op_sel:[0,1,0] op_sel_hi:[1,1,1] neg_lo:[0,1,0] neg_hi:[0,1,0]
    v_pk_fma_f32 v[90:91], v[122:123], v[190:191], v[90:91] op_sel:[0,1,0] op_sel_hi:[1,1,1] neg_lo:[0,1,0] neg_hi:[0,1,0]
    v_pk_fma_f32 v[92:93], v[124:125], v[190:191], v[92:93] op_sel:[0,1,0] op_sel_hi:[1,1,1] neg_lo:[0,1,0] neg_hi:[0,1,0]
    v_pk_fma_f32 v[94:95], v[126:127], v[190:191], v[94:95] op_sel:[0,1,0] op_sel_hi:[1,1,1] neg_lo:[0,1,0] neg_hi:[0,1,0]
    v_pk_mul_f32 v[88:89], v[88:89], v[104:105]
    v_pk_mul_f32 v[90:91], v[90:91], v[106:107]
    v_pk_mul_f32 v[92:93], v[92:93], v[108:109]
    v_pk_mul_f32 v[94:95], v[94:95], v[110:111]
    v_cvt_pk_bf16_f32 v88, v88, v89
    v_cvt_pk_bf16_f32 v89, v90, v91
    v_cvt_pk_bf16_f32 v90, v92, v93
    v_cvt_pk_bf16_f32 v91, v94, v95
    buffer_store_dwordx4 v[88:91], v245, s[20:23], s33 offen offset:2304 sc1
    ds_write_b128 v246, v[32:35] offset:0
    v_mul_f32 v192, 0x3e8293ee, v192
    ds_write_b128 v246, v[40:43] offset:128
    v_mul_f32 v193, 0x3e8293ee, v193
    ds_write_b128 v246, v[48:51] offset:4096
    v_mul_f32 v194, 0x3e8293ee, v194
    ds_write_b128 v246, v[56:59] offset:4224
    v_mul_f32 v195, 0x3e8293ee, v195
    v_pk_fma_f32 v[0:1], v[196:197], v[204:205], v[0:1] op_sel_hi:[1,0,1] neg_lo:[0,1,0] neg_hi:[0,1,0]
    v_pk_fma_f32 v[2:3], v[198:199], v[204:205], v[2:3] op_sel_hi:[1,0,1] neg_lo:[0,1,0] neg_hi:[0,1,0]
    v_pk_fma_f32 v[4:5], v[200:201], v[204:205], v[4:5] op_sel_hi:[1,0,1] neg_lo:[0,1,0] neg_hi:[0,1,0]
    v_pk_fma_f32 v[6:7], v[202:203], v[204:205], v[6:7] op_sel_hi:[1,0,1] neg_lo:[0,1,0] neg_hi:[0,1,0]
    v_pk_mul_f32 v[0:1], v[0:1], v[192:193] op_sel_hi:[1,0]
    v_pk_mul_f32 v[2:3], v[2:3], v[192:193] op_sel_hi:[1,0]
    v_pk_mul_f32 v[4:5], v[4:5], v[192:193] op_sel_hi:[1,0]
    v_pk_mul_f32 v[6:7], v[6:7], v[192:193] op_sel_hi:[1,0]
    v_cvt_pk_bf16_f32 v0, v0, v1
    v_cvt_pk_bf16_f32 v1, v2, v3
    v_cvt_pk_bf16_f32 v2, v4, v5
    v_cvt_pk_bf16_f32 v3, v6, v7
    ds_write_b128 v247, v[64:67] offset:2048
    ds_write_b128 v248, v[0:3] offset:0
    v_pk_fma_f32 v[8:9], v[196:197], v[204:205], v[8:9] op_sel:[0,1,0] op_sel_hi:[1,1,1] neg_lo:[0,1,0] neg_hi:[0,1,0]
    v_pk_fma_f32 v[10:11], v[198:199], v[204:205], v[10:11] op_sel:[0,1,0] op_sel_hi:[1,1,1] neg_lo:[0,1,0] neg_hi:[0,1,0]
    v_pk_fma_f32 v[12:13], v[200:201], v[204:205], v[12:13] op_sel:[0,1,0] op_sel_hi:[1,1,1] neg_lo:[0,1,0] neg_hi:[0,1,0]
    v_pk_fma_f32 v[14:15], v[202:203], v[204:205], v[14:15] op_sel:[0,1,0] op_sel_hi:[1,1,1] neg_lo:[0,1,0] neg_hi:[0,1,0]
    v_pk_mul_f32 v[8:9], v[8:9], v[192:193] op_sel:[0,1] op_sel_hi:[1,1]
    v_pk_mul_f32 v[10:11], v[10:11], v[192:193] op_sel:[0,1] op_sel_hi:[1,1]
    v_pk_mul_f32 v[12:13], v[12:13], v[192:193] op_sel:[0,1] op_sel_hi:[1,1]
    v_pk_mul_f32 v[14:15], v[14:15], v[192:193] op_sel:[0,1] op_sel_hi:[1,1]
    v_cvt_pk_bf16_f32 v8, v8, v9
    v_cvt_pk_bf16_f32 v9, v10, v11
    v_cvt_pk_bf16_f32 v10, v12, v13
    v_cvt_pk_bf16_f32 v11, v14, v15
    ds_write_b128 v247, v[80:83] offset:2304
    ds_write_b128 v248, v[8:11] offset:256
    v_pk_fma_f32 v[16:17], v[196:197], v[206:207], v[16:17] op_sel_hi:[1,0,1] neg_lo:[0,1,0] neg_hi:[0,1,0]
    v_pk_fma_f32 v[18:19], v[198:199], v[206:207], v[18:19] op_sel_hi:[1,0,1] neg_lo:[0,1,0] neg_hi:[0,1,0]
    v_pk_fma_f32 v[20:21], v[200:201], v[206:207], v[20:21] op_sel_hi:[1,0,1] neg_lo:[0,1,0] neg_hi:[0,1,0]
    v_pk_fma_f32 v[22:23], v[202:203], v[206:207], v[22:23] op_sel_hi:[1,0,1] neg_lo:[0,1,0] neg_hi:[0,1,0]
    v_pk_mul_f32 v[16:17], v[16:17], v[194:195] op_sel_hi:[1,0]
    v_pk_mul_f32 v[18:19], v[18:19], v[194:195] op_sel_hi:[1,0]
    v_pk_mul_f32 v[20:21], v[20:21], v[194:195] op_sel_hi:[1,0]
    v_pk_mul_f32 v[22:23], v[22:23], v[194:195] op_sel_hi:[1,0]
    v_cvt_pk_bf16_f32 v16, v16, v17
    v_cvt_pk_bf16_f32 v17, v18, v19
    v_cvt_pk_bf16_f32 v18, v20, v21
    v_cvt_pk_bf16_f32 v19, v22, v23
    ds_write_b128 v247, v[72:75] offset:6144
    ds_write_b128 v248, v[16:19] offset:2048
    v_pk_fma_f32 v[24:25], v[196:197], v[206:207], v[24:25] op_sel:[0,1,0] op_sel_hi:[1,1,1] neg_lo:[0,1,0] neg_hi:[0,1,0]
    v_pk_fma_f32 v[26:27], v[198:199], v[206:207], v[26:27] op_sel:[0,1,0] op_sel_hi:[1,1,1] neg_lo:[0,1,0] neg_hi:[0,1,0]
    v_pk_fma_f32 v[28:29], v[200:201], v[206:207], v[28:29] op_sel:[0,1,0] op_sel_hi:[1,1,1] neg_lo:[0,1,0] neg_hi:[0,1,0]
    v_pk_fma_f32 v[30:31], v[202:203], v[206:207], v[30:31] op_sel:[0,1,0] op_sel_hi:[1,1,1] neg_lo:[0,1,0] neg_hi:[0,1,0]
    v_pk_mul_f32 v[24:25], v[24:25], v[194:195] op_sel:[0,1] op_sel_hi:[1,1]
    v_pk_mul_f32 v[26:27], v[26:27], v[194:195] op_sel:[0,1] op_sel_hi:[1,1]
    v_pk_mul_f32 v[28:29], v[28:29], v[194:195] op_sel:[0,1] op_sel_hi:[1,1]
    v_pk_mul_f32 v[30:31], v[30:31], v[194:195] op_sel:[0,1] op_sel_hi:[1,1]
    v_cvt_pk_bf16_f32 v24, v24, v25
    v_cvt_pk_bf16_f32 v25, v26, v27
    v_cvt_pk_bf16_f32 v26, v28, v29
    v_cvt_pk_bf16_f32 v27, v30, v31
    ds_write_b128 v247, v[88:91] offset:6400
    ds_write_b128 v248, v[24:27] offset:2304
    s_lshl_b32 s30, s25, 8
    s_lshl_b32 s31, s24, 4
    s_add_u32 s30, s30, s31
    s_lshl_b32 s31, s34, 3
    s_add_u32 s30, s30, s31
    s_lshl_b32 s31, s35, 2
    s_add_u32 s30, s30, s31
    s_add_u32 s30, s30, s26
    s_add_u32 s30, s30, 0xdd0000
    v_mov_b32 v154, s88
    s_mov_b64 exec, 1
    s_waitcnt vmcnt(0)
    buffer_store_dword v154, v253, s[20:23], s30 offen sc1
    s_mov_b64 exec, -1
    v_readfirstlane_b32 s73, v250
    v_readfirstlane_b32 s77, v251
    s_lshr_b32 s39, s73, 5
    s_lshl_b32 s34, s24, 2
    s_sub_u32 s39, s39, s34
    s_add_u32 s39, s39, 8
    s_cmp_lt_u32 s39, 12
    s_cselect_b32 s100, 1, 0
    s_cmp_lg_u32 s26, 0
    s_cbranch_scc1 sk_2
    v_permlane32_swap_b32 v208, v210
    v_permlane32_swap_b32 v209, v211
    v_permlane32_swap_b32 v212, v214
    v_permlane32_swap_b32 v213, v215
    v_permlane32_swap_b32 v216, v218
    v_permlane32_swap_b32 v217, v219
    v_permlane32_swap_b32 v220, v222
    v_permlane32_swap_b32 v221, v223
sk_2:
    v_mov_b32 v20, 0xffff
    v_mov_b32 v21, 0xffff0000
    v_cndmask_b32 v22, 0, v20, s[40:41]
    v_cndmask_b32 v23, 0, v21, s[42:43]
    v_or_b32 v12, v22, v23
    v_cndmask_b32 v22, 0, v20, s[44:45]
    v_cndmask_b32 v23, 0, v21, s[46:47]
    v_or_b32 v13, v22, v23
    v_cndmask_b32 v22, 0, v20, s[48:49]
    v_cndmask_b32 v23, 0, v21, s[50:51]
    v_or_b32 v14, v22, v23
    v_cndmask_b32 v22, 0, v20, s[52:53]
    v_cndmask_b32 v23, 0, v21, s[54:55]
    v_or_b32 v15, v22, v23
    v_cndmask_b32 v22, 0, v20, s[56:57]
    v_cndmask_b32 v23, 0, v21, s[58:59]
    v_or_b32 v16, v22, v23
    v_cndmask_b32 v22, 0, v20, s[60:61]
    v_cndmask_b32 v23, 0, v21, s[62:63]
    v_or_b32 v17, v22, v23
    v_cndmask_b32 v22, 0, v20, s[64:65]
    v_cndmask_b32 v23, 0, v21, s[66:67]
    v_or_b32 v18, v22, v23
    v_cndmask_b32 v22, 0, v20, s[68:69]
    v_cndmask_b32 v23, 0, v21, s[70:71]
    v_or_b32 v19, v22, v23
    s_lshl_b32 s34, s28, 12
    s_add_u32 s34, s34, 65536
    v_add_u32 v20, s34, v253
    s_lshl_b32 s34, s3, 11
    s_add_u32 s34, s34, 49152
    v_add_u32 v3, s34, v253
    v_mov_b32 v24, 0
    v_mov_b32 v25, 0
    v_mov_b32 v26, 0
    v_mov_b32 v27, 0
    v_mov_b32 v28, 0
    v_mov_b32 v29, 0
    v_mov_b32 v30, 0
    v_mov_b32 v31, 0
    v_mov_b32 v32, 0
    v_mov_b32 v33, 0
    v_mov_b32 v34, 0
    v_mov_b32 v35, 0
    v_mov_b32 v36, 0
    v_mov_b32 v37, 0
    v_mov_b32 v38, 0
    v_mov_b32 v39, 0
    s_waitcnt lgkmcnt(0)
    s_barrier
    s_cmp_eq_u32 s100, 0
    s_cbranch_scc1 sk_3
    s_barrier
    ds_read_b128 v[4:7], v3
    ds_read_b128 v[8:11], v3 offset:1024
    s_lshr_b32 s34, s73, 5
    s_waitcnt lgkmcnt(0)
    s_barrier
    s_cmp_lg_u32 s34, s99
    s_cbranch_scc1 sk_4
    s_and_b32 s32, s73, 31
    v_and_b32 v0, 31, v252
    v_cmp_eq_u32 vcc, s32, v0
    v_lshrrev_b32 v0, 5, v252
    v_lshlrev_b32 v0, 4, v0
    s_lshl_b32 s34, s98, 7
    s_add_u32 s34, s34, 0xdc4000
    s_mov_b64 exec, vcc
    buffer_load_dwordx4 v[208:211], v0, s[20:23], s34 offen offset:0 sc1
    buffer_load_dwordx4 v[212:215], v0, s[20:23], s34 offen offset:32 sc1
    buffer_load_dwordx4 v[216:219], v0, s[20:23], s34 offen offset:64 sc1
    buffer_load_dwordx4 v[220:223], v0, s[20:23], s34 offen offset:96 sc1
    v_mov_b32 v240, 1.0
    v_mov_b32 v241, 0
    s_mov_b64 exec, -1
sk_4:
sk_3:
    s_cmp_lg_u32 s100, 0
    s_cbranch_scc1 sk_5
    ds_read_b128 v[4:7], v3
    ds_read_b128 v[8:11], v3 offset:1024
sk_5:
    ds_read_b128 v[104:107], v20 offset:32768
    ds_read_b128 v[108:111], v20 offset:33792
    ds_read_b128 v[112:115], v20 offset:28672
    ds_read_b128 v[116:119], v20 offset:29696
    s_waitcnt lgkmcnt(2)
    v_mfma_f32_32x32x16_bf16 v[40:55], v[104:107], v[4:7], 0
    v_mfma_f32_32x32x16_bf16 v[40:55], v[108:111], v[8:11], v[40:55]
    ds_read_b128 v[104:107], v20 offset:24576
    ds_read_b128 v[108:111], v20 offset:25600
    s_cmp_eq_u32 s99, 0
    s_cbranch_scc0 ng_6
    v_mov_b32 v24, 0xf149f2ca
    v_mov_b32 v25, 0xf149f2ca
    v_mov_b32 v26, 0xf149f2ca
    v_mov_b32 v27, 0xf149f2ca
    v_mov_b32 v28, 0xf149f2ca
    v_mov_b32 v29, 0xf149f2ca
    v_mov_b32 v30, 0xf149f2ca
    v_mov_b32 v31, 0xf149f2ca
    v_mov_b32 v32, 0xf149f2ca
    v_mov_b32 v33, 0xf149f2ca
    v_mov_b32 v34, 0xf149f2ca
    v_mov_b32 v35, 0xf149f2ca
    v_mov_b32 v36, 0xf149f2ca
    v_mov_b32 v37, 0xf149f2ca
    v_mov_b32 v38, 0xf149f2ca
    v_mov_b32 v39, 0xf149f2ca
ng_6:
    s_waitcnt lgkmcnt(2)
    s_nop 0
    v_mfma_f32_32x32x16_bf16 v[72:87], v[112:115], v[4:7], v[24:39]
    v_mfma_f32_32x32x16_bf16 v[72:87], v[116:119], v[8:11], v[72:87]
    ds_read_b128 v[112:115], v20 offset:20480
    ds_read_b128 v[116:119], v20 offset:21504
    s_cmp_eq_u32 s99, 1
    s_cbranch_scc0 ng_7
    s_nop 1
    v_mov_b32 v24, 0xf149f2ca
    v_mov_b32 v25, 0xf149f2ca
    v_mov_b32 v26, 0xf149f2ca
    v_mov_b32 v27, 0xf149f2ca
    v_mov_b32 v28, 0xf149f2ca
    v_mov_b32 v29, 0xf149f2ca
    v_mov_b32 v30, 0xf149f2ca
    v_mov_b32 v31, 0xf149f2ca
    v_mov_b32 v32, 0xf149f2ca
    v_mov_b32 v33, 0xf149f2ca
    v_mov_b32 v34, 0xf149f2ca
    v_mov_b32 v35, 0xf149f2ca
    v_mov_b32 v36, 0xf149f2ca
    v_mov_b32 v37, 0xf149f2ca
    v_mov_b32 v38, 0xf149f2ca
    v_mov_b32 v39, 0xf149f2ca
ng_7:
    s_waitcnt lgkmcnt(2)
    s_nop 0
    v_mfma_f32_32x32x16_bf16 v[56:71], v[104:107], v[4:7], v[24:39]
    v_mfma_f32_32x32x16_bf16 v[56:71], v[108:111], v[8:11], v[56:71]
    s_nop 3
    v_max_f32 v21, v72, v73
    v_max3_f32 v21, v21, v74, v75
    v_max3_f32 v21, v21, v76, v77
    v_max3_f32 v21, v21, v78, v79
    v_max3_f32 v21, v21, v80, v81
    v_max3_f32 v21, v21, v82, v83
    v_max3_f32 v21, v21, v84, v85
    v_max3_f32 v21, v21, v86, v87
    ds_read_b128 v[104:107], v20 offset:16384
    ds_read_b128 v[108:111], v20 offset:17408
    s_cmp_eq_u32 s99, 2
    s_cbranch_scc0 ng_8
    v_mov_b32 v24, 0xf149f2ca
    v_mov_b32 v25, 0xf149f2ca
    v_mov_b32 v26, 0xf149f2ca
    v_mov_b32 v27, 0xf149f2ca
    v_mov_b32 v28, 0xf149f2ca
    v_mov_b32 v29, 0xf149f2ca
    v_mov_b32 v30, 0xf149f2ca
    v_mov_b32 v31, 0xf149f2ca
    v_mov_b32 v32, 0xf149f2ca
    v_mov_b32 v33, 0xf149f2ca
    v_mov_b32 v34, 0xf149f2ca
    v_mov_b32 v35, 0xf149f2ca
    v_mov_b32 v36, 0xf149f2ca
    v_mov_b32 v37, 0xf149f2ca
    v_mov_b32 v38, 0xf149f2ca
    v_mov_b32 v39, 0xf149f2ca
ng_8:
    s_waitcnt lgkmcnt(2)
    s_nop 0
    v_mfma_f32_32x32x16_bf16 v[72:87], v[112:115], v[4:7], v[24:39]
    v_mfma_f32_32x32x16_bf16 v[72:87], v[116:119], v[8:11], v[72:87]
    v_max3_f32 v21, v21, v56, v57
    v_max3_f32 v21, v21, v58, v59
    v_max3_f32 v21, v21, v60, v61
    v_max3_f32 v21, v21, v62, v63
    v_max3_f32 v21, v21, v64, v65
    v_max3_f32 v21, v21, v66, v67
    v_max3_f32 v21, v21, v68, v69
    v_max3_f32 v21, v21, v70, v71
    ds_read_b128 v[112:115], v20 offset:12288
    ds_read_b128 v[116:119], v20 offset:13312
    s_cmp_eq_u32 s99, 3
    s_cbranch_scc0 ng_9
    v_mov_b32 v24, 0xf149f2ca
    v_mov_b32 v25, 0xf149f2ca
    v_mov_b32 v26, 0xf149f2ca
    v_mov_b32 v27, 0xf149f2ca
    v_mov_b32 v28, 0xf149f2ca
    v_mov_b32 v29, 0xf149f2ca
    v_mov_b32 v30, 0xf149f2ca
    v_mov_b32 v31, 0xf149f2ca
    v_mov_b32 v32, 0xf149f2ca
    v_mov_b32 v33, 0xf149f2ca
    v_mov_b32 v34, 0xf149f2ca
    v_mov_b32 v35, 0xf149f2ca
    v_mov_b32 v36, 0xf149f2ca
    v_mov_b32 v37, 0xf149f2ca
    v_mov_b32 v38, 0xf149f2ca
    v_mov_b32 v39, 0xf149f2ca
ng_9:
    s_waitcnt lgkmcnt(2)
    s_nop 0
    v_mfma_f32_32x32x16_bf16 v[56:71], v[104:107], v[4:7], v[24:39]
    v_mfma_f32_32x32x16_bf16 v[56:71], v[108:111], v[8:11], v[56:71]
    v_max3_f32 v21, v21, v72, v73
    v_max3_f32 v21, v21, v74, v75
    v_max3_f32 v21, v21, v76, v77
    v_max3_f32 v21, v21, v78, v79
    v_max3_f32 v21, v21, v80, v81
    v_max3_f32 v21, v21, v82, v83
    v_max3_f32 v21, v21, v84, v85
    v_max3_f32 v21, v21, v86, v87
    ds_read_b128 v[104:107], v20 offset:8192
    ds_read_b128 v[108:111], v20 offset:9216
    s_cmp_eq_u32 s99, 4
    s_cbranch_scc0 ng_10
    v_mov_b32 v24, 0xf149f2ca
    v_mov_b32 v25, 0xf149f2ca
    v_mov_b32 v26, 0xf149f2ca
    v_mov_b32 v27, 0xf149f2ca
    v_mov_b32 v28, 0xf149f2ca
    v_mov_b32 v29, 0xf149f2ca
    v_mov_b32 v30, 0xf149f2ca
    v_mov_b32 v31, 0xf149f2ca
    v_mov_b32 v32, 0xf149f2ca
    v_mov_b32 v33, 0xf149f2ca
    v_mov_b32 v34, 0xf149f2ca
    v_mov_b32 v35, 0xf149f2ca
    v_mov_b32 v36, 0xf149f2ca
    v_mov_b32 v37, 0xf149f2ca
    v_mov_b32 v38, 0xf149f2ca
    v_mov_b32 v39, 0xf149f2ca
ng_10:
    s_waitcnt lgkmcnt(2)
    s_nop 0
    v_mfma_f32_32x32x16_bf16 v[72:87], v[112:115], v[4:7], v[24:39]
    v_mfma_f32_32x32x16_bf16 v[72:87], v[116:119], v[8:11], v[72:87]
    v_max3_f32 v21, v21, v56, v57
    v_max3_f32 v21, v21, v58, v59
    v_max3_f32 v21, v21, v60, v61
    v_max3_f32 v21, v21, v62, v63
    v_max3_f32 v21, v21, v64, v65
    v_max3_f32 v21, v21, v66, v67
    v_max3_f32 v21, v21, v68, v69
    v_max3_f32 v21, v21, v70, v71
    s_cmp_lg_u32 s100, 0
    s_cbranch_scc1 sk_11
    s_barrier
sk_11:
    s_add_u32 s96, s25, 0
    s_and_b32 s96, s96, 15
    s_lshl_b32 s96, s96, 17
    s_add_u32 m0, s101, 0
    s_nop 0
    buffer_load_dwordx4 v243, s[8:11], s96 offen lds
    ds_read_b128 v[112:115], v20 offset:4096
    ds_read_b128 v[116:119], v20 offset:5120
    s_cmp_eq_u32 s99, 5
    s_cbranch_scc0 ng_12
    v_mov_b32 v24, 0xf149f2ca
    v_mov_b32 v25, 0xf149f2ca
    v_mov_b32 v26, 0xf149f2ca
    v_mov_b32 v27, 0xf149f2ca
    v_mov_b32 v28, 0xf149f2ca
    v_mov_b32 v29, 0xf149f2ca
    v_mov_b32 v30, 0xf149f2ca
    v_mov_b32 v31, 0xf149f2ca
    v_mov_b32 v32, 0xf149f2ca
    v_mov_b32 v33, 0xf149f2ca
    v_mov_b32 v34, 0xf149f2ca
    v_mov_b32 v35, 0xf149f2ca
    v_mov_b32 v36, 0xf149f2ca
    v_mov_b32 v37, 0xf149f2ca
    v_mov_b32 v38, 0xf149f2ca
    v_mov_b32 v39, 0xf149f2ca
ng_12:
    s_waitcnt lgkmcnt(2)
    s_nop 0
    v_mfma_f32_32x32x16_bf16 v[56:71], v[104:107], v[4:7], v[24:39]
    v_mfma_f32_32x32x16_bf16 v[56:71], v[108:111], v[8:11], v[56:71]
    v_max3_f32 v21, v21, v72, v73
    v_max3_f32 v21, v21, v74, v75
    v_max3_f32 v21, v21, v76, v77
    v_max3_f32 v21, v21, v78, v79
    v_max3_f32 v21, v21, v80, v81
    v_max3_f32 v21, v21, v82, v83
    v_max3_f32 v21, v21, v84, v85
    v_max3_f32 v21, v21, v86, v87
    s_add_u32 s96, s25, 12
    s_and_b32 s96, s96, 15
    s_lshl_b32 s96, s96, 17
    s_add_u32 m0, s101, 49152
    s_nop 0
    buffer_load_dwordx4 v243, s[8:11], s96 offen lds
    ds_read_b128 v[104:107], v20 offset:0
    ds_read_b128 v[108:111], v20 offset:1024
    s_cmp_eq_u32 s99, 6
    s_cbranch_scc0 ng_13
    v_mov_b32 v24, 0xf149f2ca
    v_mov_b32 v25, 0xf149f2ca
    v_mov_b32 v26, 0xf149f2ca
    v_mov_b32 v27, 0xf149f2ca
    v_mov_b32 v28, 0xf149f2ca
    v_mov_b32 v29, 0xf149f2ca
    v_mov_b32 v30, 0xf149f2ca
    v_mov_b32 v31, 0xf149f2ca
    v_mov_b32 v32, 0xf149f2ca
    v_mov_b32 v33, 0xf149f2ca
    v_mov_b32 v34, 0xf149f2ca
    v_mov_b32 v35, 0xf149f2ca
    v_mov_b32 v36, 0xf149f2ca
    v_mov_b32 v37, 0xf149f2ca
    v_mov_b32 v38, 0xf149f2ca
    v_mov_b32 v39, 0xf149f2ca
ng_13:
    s_waitcnt lgkmcnt(2)
    s_nop 0
    v_mfma_f32_32x32x16_bf16 v[72:87], v[112:115], v[4:7], v[24:39]
    v_mfma_f32_32x32x16_bf16 v[72:87], v[116:119], v[8:11], v[72:87]
    v_max3_f32 v21, v21, v56, v57
    v_max3_f32 v21, v21, v58, v59
    v_max3_f32 v21, v21, v60, v61
    v_max3_f32 v21, v21, v62, v63
    v_max3_f32 v21, v21, v64, v65
    v_max3_f32 v21, v21, v66, v67
    v_max3_f32 v21, v21, v68, v69
    v_max3_f32 v21, v21, v70, v71
    s_add_u32 s96, s25, 13
    s_and_b32 s96, s96, 15
    s_lshl_b32 s96, s96, 17
    s_add_u32 m0, s101, 53248
    s_nop 0
    buffer_load_dwordx4 v243, s[8:11], s96 offen lds
    s_cmp_eq_u32 s99, 7
    s_cbranch_scc0 ng_14
    v_mov_b32 v24, 0xf149f2ca
    v_mov_b32 v25, 0xf149f2ca
    v_mov_b32 v26, 0xf149f2ca
    v_mov_b32 v27, 0xf149f2ca
    v_mov_b32 v28, 0xf149f2ca
    v_mov_b32 v29, 0xf149f2ca
    v_mov_b32 v30, 0xf149f2ca
    v_mov_b32 v31, 0xf149f2ca
    v_mov_b32 v32, 0xf149f2ca
    v_mov_b32 v33, 0xf149f2ca
    v_mov_b32 v34, 0xf149f2ca
    v_mov_b32 v35, 0xf149f2ca
    v_mov_b32 v36, 0xf149f2ca
    v_mov_b32 v37, 0xf149f2ca
    v_mov_b32 v38, 0xf149f2ca
    v_mov_b32 v39, 0xf149f2ca
ng_14:
    s_waitcnt lgkmcnt(0)
    s_nop 0
    v_mfma_f32_32x32x16_bf16 v[56:71], v[104:107], v[4:7], v[24:39]
    v_mfma_f32_32x32x16_bf16 v[56:71], v[108:111], v[8:11], v[56:71]
    v_max3_f32 v21, v21, v72, v73
    v_max3_f32 v21, v21, v74, v75
    v_max3_f32 v21, v21, v76, v77
    v_max3_f32 v21, v21, v78, v79
    v_max3_f32 v21, v21, v80, v81
    v_max3_f32 v21, v21, v82, v83
    v_max3_f32 v21, v21, v84, v85
    v_max3_f32 v21, v21, v86, v87
    s_add_u32 s96, s25, 14
    s_and_b32 s96, s96, 15
    s_lshl_b32 s96, s96, 17
    s_add_u32 m0, s101, 57344
    s_nop 0
    buffer_load_dwordx4 v243, s[8:11], s96 offen lds
    ds_read_b128 v[112:115], v20 offset:28672
    ds_read_b128 v[116:119], v20 offset:29696
    ds_read_b128 v[120:123], v20 offset:34816
    ds_read_b128 v[124:127], v20 offset:35840
    ds_read_b128 v[128:131], v20 offset:2048
    ds_read_b128 v[132:135], v20 offset:3072
    v_cndmask_b32 v40, v56, v40, s[40:41]
    v_cndmask_b32 v41, v57, v41, s[42:43]
    v_cndmask_b32 v42, v58, v42, s[44:45]
    v_cndmask_b32 v43, v59, v43, s[46:47]
    v_cndmask_b32 v44, v60, v44, s[48:49]
    v_cndmask_b32 v45, v61, v45, s[50:51]
    v_cndmask_b32 v46, v62, v46, s[52:53]
    v_cndmask_b32 v47, v63, v47, s[54:55]
    v_cndmask_b32 v48, v64, v48, s[56:57]
    v_cndmask_b32 v49, v65, v49, s[58:59]
    v_cndmask_b32 v50, v66, v50, s[60:61]
    v_cndmask_b32 v51, v67, v51, s[62:63]
    v_cndmask_b32 v52, v68, v52, s[64:65]
    v_cndmask_b32 v53, v69, v53, s[66:67]
    v_cndmask_b32 v54, v70, v54, s[68:69]
    v_cndmask_b32 v55, v71, v55, s[70:71]
    v_max3_f32 v21, v21, v40, v41
    v_max3_f32 v21, v21, v42, v43
    v_max3_f32 v21, v21, v44, v45
    v_max3_f32 v21, v21, v46, v47
    v_max3_f32 v21, v21, v48, v49
    v_max3_f32 v21, v21, v50, v51
    v_max3_f32 v21, v21, v52, v53
    v_max3_f32 v21, v21, v54, v55
    v_mov_b32 v152, v21
    s_nop 1
    v_permlane32_swap_b32 v21, v152
    v_max_f32 v21, v21, v152
    v_sub_f32 v24, 0, v21
    v_sub_f32 v25, 0, v21
    v_sub_f32 v26, 0, v21
    v_sub_f32 v27, 0, v21
    v_sub_f32 v28, 0, v21
    v_sub_f32 v29, 0, v21
    v_sub_f32 v30, 0, v21
    v_sub_f32 v31, 0, v21
    v_sub_f32 v32, 0, v21
    v_sub_f32 v33, 0, v21
    v_sub_f32 v34, 0, v21
    v_sub_f32 v35, 0, v21
    v_sub_f32 v36, 0, v21
    v_sub_f32 v37, 0, v21
    v_sub_f32 v38, 0, v21
    v_sub_f32 v39, 0, v21
    s_cmp_eq_u32 s99, 0
    s_cbranch_scc0 ng_15
    v_mov_b32 v24, 0xf149f2ca
    v_mov_b32 v25, 0xf149f2ca
    v_mov_b32 v26, 0xf149f2ca
    v_mov_b32 v27, 0xf149f2ca
    v_mov_b32 v28, 0xf149f2ca
    v_mov_b32 v29, 0xf149f2ca
    v_mov_b32 v30, 0xf149f2ca
    v_mov_b32 v31, 0xf149f2ca
    v_mov_b32 v32, 0xf149f2ca
    v_mov_b32 v33, 0xf149f2ca
    v_mov_b32 v34, 0xf149f2ca
    v_mov_b32 v35, 0xf149f2ca
    v_mov_b32 v36, 0xf149f2ca
    v_mov_b32 v37, 0xf149f2ca
    v_mov_b32 v38, 0xf149f2ca
    v_mov_b32 v39, 0xf149f2ca
ng_15:
    s_waitcnt lgkmcnt(4)
    s_nop 0
    v_mfma_f32_32x32x16_bf16 v[72:87], v[112:115], v[4:7], v[24:39]
    v_mfma_f32_32x32x16_bf16 v[72:87], v[116:119], v[8:11], v[72:87]
    ds_read_b128 v[104:107], v20 offset:24576
    ds_read_b128 v[108:111], v20 offset:25600
    v_sub_f32 v40, v40, v21
    v_sub_f32 v41, v41, v21
    v_sub_f32 v42, v42, v21
    v_sub_f32 v43, v43, v21
    v_sub_f32 v44, v44, v21
    v_sub_f32 v45, v45, v21
    v_sub_f32 v46, v46, v21
    v_sub_f32 v47, v47, v21
    v_sub_f32 v48, v48, v21
    v_sub_f32 v49, v49, v21
    v_sub_f32 v50, v50, v21
    v_sub_f32 v51, v51, v21
    v_sub_f32 v52, v52, v21
    v_sub_f32 v53, v53, v21
    v_sub_f32 v54, v54, v21
    v_sub_f32 v55, v55, v21
    v_exp_f32 v40, v40
    v_exp_f32 v41, v41
    v_exp_f32 v42, v42
    v_exp_f32 v43, v43
    v_exp_f32 v44, v44
    v_exp_f32 v45, v45
    v_exp_f32 v46, v46
    v_exp_f32 v47, v47
    v_exp_f32 v48, v48
    v_exp_f32 v49, v49
    v_exp_f32 v50, v50
    v_exp_f32 v51, v51
    v_exp_f32 v52, v52
    v_exp_f32 v53, v53
    v_exp_f32 v54, v54
    v_exp_f32 v55, v55
    v_add_f32 v22, v40, v41
    v_add_f32 v23, v42, v43
    v_add_f32 v22, v22, v44
    v_add_f32 v23, v23, v45
    v_add_f32 v22, v22, v46
    v_add_f32 v23, v23, v47
    v_add_f32 v22, v22, v48
    v_add_f32 v23, v23, v49
    v_add_f32 v22, v22, v50
    v_add_f32 v23, v23, v51
    v_add_f32 v22, v22, v52
    v_add_f32 v23, v23, v53
    v_add_f32 v22, v22, v54
    v_add_f32 v23, v23, v55
    v_cvt_pk_bf16_f32 v144, v40, v41
    v_cvt_pk_bf16_f32 v145, v42, v43
    v_cvt_pk_bf16_f32 v146, v44, v45
    v_cvt_pk_bf16_f32 v147, v46, v47
    v_cvt_pk_bf16_f32 v148, v48, v49
    v_cvt_pk_bf16_f32 v149, v50, v51
    v_cvt_pk_bf16_f32 v150, v52, v53
    v_cvt_pk_bf16_f32 v151, v54, v55
    v_and_b32 v136, v144, v12
    v_and_b32 v137, v145, v13
    v_and_b32 v138, v146, v14
    v_and_b32 v139, v147, v15
    v_and_b32 v140, v148, v16
    v_and_b32 v141, v149, v17
    v_and_b32 v142, v150, v18
    v_and_b32 v143, v151, v19
    v_xor_b32 v144, v144, v136
    v_xor_b32 v145, v145, v137
    v_xor_b32 v146, v146, v138
    v_xor_b32 v147, v147, v139
    v_xor_b32 v148, v148, v140
    v_xor_b32 v149, v149, v141
    v_xor_b32 v150, v150, v142
    v_xor_b32 v151, v151, v143
    s_waitcnt lgkmcnt(2)
    v_mfma_f32_32x32x16_bf16 v[88:103], v[120:123], v[136:139], 0
    v_mfma_f32_32x32x16_bf16 v[88:103], v[124:127], v[140:143], v[88:103]
    v_mfma_f32_32x32x16_bf16 v[88:103], v[128:131], v[144:147], v[88:103]
    v_mfma_f32_32x32x16_bf16 v[88:103], v[132:135], v[148:151], v[88:103]
    s_add_u32 s96, s25, 15
    s_and_b32 s96, s96, 15
    s_lshl_b32 s96, s96, 17
    s_add_u32 m0, s101, 61440
    s_nop 0
    buffer_load_dwordx4 v243, s[8:11], s96 offen lds
    ds_read_b128 v[128:131], v20 offset:30720
    ds_read_b128 v[132:135], v20 offset:31744
    s_cmp_eq_u32 s99, 1
    s_cbranch_scc0 ng_16
    v_mov_b32 v24, 0xf149f2ca
    v_mov_b32 v25, 0xf149f2ca
    v_mov_b32 v26, 0xf149f2ca
    v_mov_b32 v27, 0xf149f2ca
    v_mov_b32 v28, 0xf149f2ca
    v_mov_b32 v29, 0xf149f2ca
    v_mov_b32 v30, 0xf149f2ca
    v_mov_b32 v31, 0xf149f2ca
    v_mov_b32 v32, 0xf149f2ca
    v_mov_b32 v33, 0xf149f2ca
    v_mov_b32 v34, 0xf149f2ca
    v_mov_b32 v35, 0xf149f2ca
    v_mov_b32 v36, 0xf149f2ca
    v_mov_b32 v37, 0xf149f2ca
    v_mov_b32 v38, 0xf149f2ca
    v_mov_b32 v39, 0xf149f2ca
ng_16:
    s_waitcnt lgkmcnt(2)
    s_nop 0
    v_mfma_f32_32x32x16_bf16 v[56:71], v[104:107], v[4:7], v[24:39]
    v_mfma_f32_32x32x16_bf16 v[56:71], v[108:111], v[8:11], v[56:71]
    ds_read_b128 v[112:115], v20 offset:20480
    ds_read_b128 v[116:119], v20 offset:21504
    v_exp_f32 v72, v72
    v_exp_f32 v73, v73
    v_exp_f32 v74, v74
    v_exp_f32 v75, v75
    v_exp_f32 v76, v76
    v_exp_f32 v77, v77
    v_exp_f32 v78, v78
    v_exp_f32 v79, v79
    v_exp_f32 v80, v80
    v_exp_f32 v81, v81
    v_exp_f32 v82, v82
    v_exp_f32 v83, v83
    v_exp_f32 v84, v84
    v_exp_f32 v85, v85
    v_exp_f32 v86, v86
    v_exp_f32 v87, v87
    v_add_f32 v22, v22, v72
    v_add_f32 v23, v23, v73
    v_add_f32 v22, v22, v74
    v_add_f32 v23, v23, v75
    v_add_f32 v22, v22, v76
    v_add_f32 v23, v23, v77
    v_add_f32 v22, v22, v78
    v_add_f32 v23, v23, v79
    v_add_f32 v22, v22, v80
    v_add_f32 v23, v23, v81
    v_add_f32 v22, v22, v82
    v_add_f32 v23, v23, v83
    v_add_f32 v22, v22, v84
    v_add_f32 v23, v23, v85
    v_add_f32 v22, v22, v86
    v_add_f32 v23, v23, v87
    v_cvt_pk_bf16_f32 v144, v72, v73
    v_cvt_pk_bf16_f32 v145, v74, v75
    v_cvt_pk_bf16_f32 v146, v76, v77
    v_cvt_pk_bf16_f32 v147, v78, v79
    v_cvt_pk_bf16_f32 v148, v80, v81
    v_cvt_pk_bf16_f32 v149, v82, v83
    v_cvt_pk_bf16_f32 v150, v84, v85
    v_cvt_pk_bf16_f32 v151, v86, v87
    s_waitcnt lgkmcnt(2)
    v_mfma_f32_32x32x16_bf16 v[88:103], v[128:131], v[144:147], v[88:103]
    v_mfma_f32_32x32x16_bf16 v[88:103], v[132:135], v[148:151], v[88:103]
    ds_read_b128 v[120:123], v20 offset:26624
    ds_read_b128 v[124:127], v20 offset:27648
    s_cmp_eq_u32 s99, 2
    s_cbranch_scc0 ng_17
    v_mov_b32 v24, 0xf149f2ca
    v_mov_b32 v25, 0xf149f2ca
    v_mov_b32 v26, 0xf149f2ca
    v_mov_b32 v27, 0xf149f2ca
    v_mov_b32 v28, 0xf149f2ca
    v_mov_b32 v29, 0xf149f2ca
    v_mov_b32 v30, 0xf149f2ca
    v_mov_b32 v31, 0xf149f2ca
    v_mov_b32 v32, 0xf149f2ca
    v_mov_b32 v33, 0xf149f2ca
    v_mov_b32 v34, 0xf149f2ca
    v_mov_b32 v35, 0xf149f2ca
    v_mov_b32 v36, 0xf149f2ca
    v_mov_b32 v37, 0xf149f2ca
    v_mov_b32 v38, 0xf149f2ca
    v_mov_b32 v39, 0xf149f2ca
ng_17:
    s_waitcnt lgkmcnt(2)
    s_nop 0
    v_mfma_f32_32x32x16_bf16 v[72:87], v[112:115], v[4:7], v[24:39]
    v_mfma_f32_32x32x16_bf16 v[72:87], v[116:119], v[8:11], v[72:87]
    ds_read_b128 v[104:107], v20 offset:16384
    ds_read_b128 v[108:111], v20 offset:17408
    v_exp_f32 v56, v56
    v_exp_f32 v57, v57
    v_exp_f32 v58, v58
    v_exp_f32 v59, v59
    v_exp_f32 v60, v60
    v_exp_f32 v61, v61
    v_exp_f32 v62, v62
    v_exp_f32 v63, v63
    v_exp_f32 v64, v64
    v_exp_f32 v65, v65
    v_exp_f32 v66, v66
    v_exp_f32 v67, v67
    v_exp_f32 v68, v68
    v_exp_f32 v69, v69
    v_exp_f32 v70, v70
    v_exp_f32 v71, v71
    v_add_f32 v22, v22, v56
    v_add_f32 v23, v23, v57
    v_add_f32 v22, v22, v58
    v_add_f32 v23, v23, v59
    v_add_f32 v22, v22, v60
    v_add_f32 v23, v23, v61
    v_add_f32 v22, v22, v62
    v_add_f32 v23, v23, v63
    v_add_f32 v22, v22, v64
    v_add_f32 v23, v23, v65
    v_add_f32 v22, v22, v66
    v_add_f32 v23, v23, v67
    v_add_f32 v22, v22, v68
    v_add_f32 v23, v23, v69
    v_add_f32 v22, v22, v70
    v_add_f32 v23, v23, v71
    v_cvt_pk_bf16_f32 v136, v56, v57
    v_cvt_pk_bf16_f32 v137, v58, v59
    v_cvt_pk_bf16_f32 v138, v60, v61
    v_cvt_pk_bf16_f32 v139, v62, v63
    v_cvt_pk_bf16_f32 v140, v64, v65
    v_cvt_pk_bf16_f32 v141, v66, v67
    v_cvt_pk_bf16_f32 v142, v68, v69
    v_cvt_pk_bf16_f32 v143, v70, v71
    s_waitcnt lgkmcnt(2)
    v_mfma_f32_32x32x16_bf16 v[88:103], v[120:123], v[136:139], v[88:103]
    v_mfma_f32_32x32x16_bf16 v[88:103], v[124:127], v[140:143], v[88:103]
    ds_read_b128 v[128:131], v20 offset:22528
    ds_read_b128 v[132:135], v20 offset:23552
    s_cmp_eq_u32 s99, 3
    s_cbranch_scc0 ng_18
    v_mov_b32 v24, 0xf149f2ca
    v_mov_b32 v25, 0xf149f2ca
    v_mov_b32 v26, 0xf149f2ca
    v_mov_b32 v27, 0xf149f2ca
    v_mov_b32 v28, 0xf149f2ca
    v_mov_b32 v29, 0xf149f2ca
    v_mov_b32 v30, 0xf149f2ca
    v_mov_b32 v31, 0xf149f2ca
    v_mov_b32 v32, 0xf149f2ca
    v_mov_b32 v33, 0xf149f2ca
    v_mov_b32 v34, 0xf149f2ca
    v_mov_b32 v35, 0xf149f2ca
    v_mov_b32 v36, 0xf149f2ca
    v_mov_b32 v37, 0xf149f2ca
    v_mov_b32 v38, 0xf149f2ca
    v_mov_b32 v39, 0xf149f2ca
ng_18:
    s_waitcnt lgkmcnt(2)
    s_nop 0
    v_mfma_f32_32x32x16_bf16 v[56:71], v[104:107], v[4:7], v[24:39]
    v_mfma_f32_32x32x16_bf16 v[56:71], v[108:111], v[8:11], v[56:71]
    ds_read_b128 v[112:115], v20 offset:12288
    ds_read_b128 v[116:119], v20 offset:13312
    v_exp_f32 v72, v72
    v_exp_f32 v73, v73
    v_exp_f32 v74, v74
    v_exp_f32 v75, v75
    v_exp_f32 v76, v76
    v_exp_f32 v77, v77
    v_exp_f32 v78, v78
    v_exp_f32 v79, v79
    v_exp_f32 v80, v80
    v_exp_f32 v81, v81
    v_exp_f32 v82, v82
    v_exp_f32 v83, v83
    v_exp_f32 v84, v84
    v_exp_f32 v85, v85
    v_exp_f32 v86, v86
    v_exp_f32 v87, v87
    v_add_f32 v22, v22, v72
    v_add_f32 v23, v23, v73
    v_add_f32 v22, v22, v74
    v_add_f32 v23, v23, v75
    v_add_f32 v22, v22, v76
    v_add_f32 v23, v23, v77
    v_add_f32 v22, v22, v78
    v_add_f32 v23, v23, v79
    v_add_f32 v22, v22, v80
    v_add_f32 v23, v23, v81
    v_add_f32 v22, v22, v82
    v_add_f32 v23, v23, v83
    v_add_f32 v22, v22, v84
    v_add_f32 v23, v23, v85
    v_add_f32 v22, v22, v86
    v_add_f32 v23, v23, v87
    v_cvt_pk_bf16_f32 v144, v72, v73
    v_cvt_pk_bf16_f32 v145, v74, v75
    v_cvt_pk_bf16_f32 v146, v76, v77
    v_cvt_pk_bf16_f32 v147, v78, v79
    v_cvt_pk_bf16_f32 v148, v80, v81
    v_cvt_pk_bf16_f32 v149, v82, v83
    v_cvt_pk_bf16_f32 v150, v84, v85
    v_cvt_pk_bf16_f32 v151, v86, v87
    s_waitcnt lgkmcnt(2)
    v_mfma_f32_32x32x16_bf16 v[88:103], v[128:131], v[144:147], v[88:103]
    v_mfma_f32_32x32x16_bf16 v[88:103], v[132:135], v[148:151], v[88:103]
    ds_read_b128 v[120:123], v20 offset:18432
    ds_read_b128 v[124:127], v20 offset:19456
    s_cmp_eq_u32 s99, 4
    s_cbranch_scc0 ng_19
    v_mov_b32 v24, 0xf149f2ca
    v_mov_b32 v25, 0xf149f2ca
    v_mov_b32 v26, 0xf149f2ca
    v_mov_b32 v27, 0xf149f2ca
    v_mov_b32 v28, 0xf149f2ca
    v_mov_b32 v29, 0xf149f2ca
    v_mov_b32 v30, 0xf149f2ca
    v_mov_b32 v31, 0xf149f2ca
    v_mov_b32 v32, 0xf149f2ca
    v_mov_b32 v33, 0xf149f2ca
    v_mov_b32 v34, 0xf149f2ca
    v_mov_b32 v35, 0xf149f2ca
    v_mov_b32 v36, 0xf149f2ca
    v_mov_b32 v37, 0xf149f2ca
    v_mov_b32 v38, 0xf149f2ca
    v_mov_b32 v39, 0xf149f2ca
ng_19:
    s_waitcnt lgkmcnt(2)
    s_nop 0
    v_mfma_f32_32x32x16_bf16 v[72:87], v[112:115], v[4:7], v[24:39]
    v_mfma_f32_32x32x16_bf16 v[72:87], v[116:119], v[8:11], v[72:87]
    ds_read_b128 v[104:107], v20 offset:8192
    ds_read_b128 v[108:111], v20 offset:9216
    v_exp_f32 v56, v56
    v_exp_f32 v57, v57
    v_exp_f32 v58, v58
    v_exp_f32 v59, v59
    v_exp_f32 v60, v60
    v_exp_f32 v61, v61
    v_exp_f32 v62, v62
    v_exp_f32 v63, v63
    v_exp_f32 v64, v64
    v_exp_f32 v65, v65
    v_exp_f32 v66, v66
    v_exp_f32 v67, v67
    v_exp_f32 v68, v68
    v_exp_f32 v69, v69
    v_exp_f32 v70, v70
    v_exp_f32 v71, v71
    v_add_f32 v22, v22, v56
    v_add_f32 v23, v23, v57
    v_add_f32 v22, v22, v58
    v_add_f32 v23, v23, v59
    v_add_f32 v22, v22, v60
    v_add_f32 v23, v23, v61
    v_add_f32 v22, v22, v62
    v_add_f32 v23, v23, v63
    v_add_f32 v22, v22, v64
    v_add_f32 v23, v23, v65
    v_add_f32 v22, v22, v66
    v_add_f32 v23, v23, v67
    v_add_f32 v22, v22, v68
    v_add_f32 v23, v23, v69
    v_add_f32 v22, v22, v70
    v_add_f32 v23, v23, v71
    v_cvt_pk_bf16_f32 v136, v56, v57
    v_cvt_pk_bf16_f32 v137, v58, v59
    v_cvt_pk_bf16_f32 v138, v60, v61
    v_cvt_pk_bf16_f32 v139, v62, v63
    v_cvt_pk_bf16_f32 v140, v64, v65
    v_cvt_pk_bf16_f32 v141, v66, v67
    v_cvt_pk_bf16_f32 v142, v68, v69
    v_cvt_pk_bf16_f32 v143, v70, v71
    s_waitcnt lgkmcnt(2)
    v_mfma_f32_32x32x16_bf16 v[88:103], v[120:123], v[136:139], v[88:103]
    v_mfma_f32_32x32x16_bf16 v[88:103], v[124:127], v[140:143], v[88:103]
    ds_read_b128 v[128:131], v20 offset:14336
    ds_read_b128 v[132:135], v20 offset:15360
    s_cmp_eq_u32 s99, 5
    s_cbranch_scc0 ng_20
    v_mov_b32 v24, 0xf149f2ca
    v_mov_b32 v25, 0xf149f2ca
    v_mov_b32 v26, 0xf149f2ca
    v_mov_b32 v27, 0xf149f2ca
    v_mov_b32 v28, 0xf149f2ca
    v_mov_b32 v29, 0xf149f2ca
    v_mov_b32 v30, 0xf149f2ca
    v_mov_b32 v31, 0xf149f2ca
    v_mov_b32 v32, 0xf149f2ca
    v_mov_b32 v33, 0xf149f2ca
    v_mov_b32 v34, 0xf149f2ca
    v_mov_b32 v35, 0xf149f2ca
    v_mov_b32 v36, 0xf149f2ca
    v_mov_b32 v37, 0xf149f2ca
    v_mov_b32 v38, 0xf149f2ca
    v_mov_b32 v39, 0xf149f2ca
ng_20:
    s_waitcnt lgkmcnt(2)
    s_nop 0
    v_mfma_f32_32x32x16_bf16 v[56:71], v[104:107], v[4:7], v[24:39]
    v_mfma_f32_32x32x16_bf16 v[56:71], v[108:111], v[8:11], v[56:71]
    ds_read_b128 v[112:115], v20 offset:4096
    ds_read_b128 v[116:119], v20 offset:5120
    v_exp_f32 v72, v72
    v_exp_f32 v73, v73
    v_exp_f32 v74, v74
    v_exp_f32 v75, v75
    v_exp_f32 v76, v76
    v_exp_f32 v77, v77
    v_exp_f32 v78, v78
    v_exp_f32 v79, v79
    v_exp_f32 v80, v80
    v_exp_f32 v81, v81
    v_exp_f32 v82, v82
    v_exp_f32 v83, v83
    v_exp_f32 v84, v84
    v_exp_f32 v85, v85
    v_exp_f32 v86, v86
    v_exp_f32 v87, v87
    v_add_f32 v22, v22, v72
    v_add_f32 v23, v23, v73
    v_add_f32 v22, v22, v74
    v_add_f32 v23, v23, v75
    v_add_f32 v22, v22, v76
    v_add_f32 v23, v23, v77
    v_add_f32 v22, v22, v78
    v_add_f32 v23, v23, v79
    v_add_f32 v22, v22, v80
    v_add_f32 v23, v23, v81
    v_add_f32 v22, v22, v82
    v_add_f32 v23, v23, v83
    v_add_f32 v22, v22, v84
    v_add_f32 v23, v23, v85
    v_add_f32 v22, v22, v86
    v_add_f32 v23, v23, v87
    v_cvt_pk_bf16_f32 v144, v72, v73
    v_cvt_pk_bf16_f32 v145, v74, v75
    v_cvt_pk_bf16_f32 v146, v76, v77
    v_cvt_pk_bf16_f32 v147, v78, v79
    v_cvt_pk_bf16_f32 v148, v80, v81
    v_cvt_pk_bf16_f32 v149, v82, v83
    v_cvt_pk_bf16_f32 v150, v84, v85
    v_cvt_pk_bf16_f32 v151, v86, v87
    s_waitcnt lgkmcnt(2)
    v_mfma_f32_32x32x16_bf16 v[88:103], v[128:131], v[144:147], v[88:103]
    v_mfma_f32_32x32x16_bf16 v[88:103], v[132:135], v[148:151], v[88:103]
    ds_read_b128 v[120:123], v20 offset:10240
    ds_read_b128 v[124:127], v20 offset:11264
    s_cmp_eq_u32 s99, 6
    s_cbranch_scc0 ng_21
    v_mov_b32 v24, 0xf149f2ca
    v_mov_b32 v25, 0xf149f2ca
    v_mov_b32 v26, 0xf149f2ca
    v_mov_b32 v27, 0xf149f2ca
    v_mov_b32 v28, 0xf149f2ca
    v_mov_b32 v29, 0xf149f2ca
    v_mov_b32 v30, 0xf149f2ca
    v_mov_b32 v31, 0xf149f2ca
    v_mov_b32 v32, 0xf149f2ca
    v_mov_b32 v33, 0xf149f2ca
    v_mov_b32 v34, 0xf149f2ca
    v_mov_b32 v35, 0xf149f2ca
    v_mov_b32 v36, 0xf149f2ca
    v_mov_b32 v37, 0xf149f2ca
    v_mov_b32 v38, 0xf149f2ca
    v_mov_b32 v39, 0xf149f2ca
ng_21:
    s_waitcnt lgkmcnt(2)
    s_nop 0
    v_mfma_f32_32x32x16_bf16 v[72:87], v[112:115], v[4:7], v[24:39]
    v_mfma_f32_32x32x16_bf16 v[72:87], v[116:119], v[8:11], v[72:87]
    v_exp_f32 v56, v56
    v_exp_f32 v57, v57
    v_exp_f32 v58, v58
    v_exp_f32 v59, v59
    v_exp_f32 v60, v60
    v_exp_f32 v61, v61
    v_exp_f32 v62, v62
    v_exp_f32 v63, v63
    v_exp_f32 v64, v64
    v_exp_f32 v65, v65
    v_exp_f32 v66, v66
    v_exp_f32 v67, v67
    v_exp_f32 v68, v68
    v_exp_f32 v69, v69
    v_exp_f32 v70, v70
    v_exp_f32 v71, v71
    v_add_f32 v22, v22, v56
    v_add_f32 v23, v23, v57
    v_add_f32 v22, v22, v58
    v_add_f32 v23, v23, v59
    v_add_f32 v22, v22, v60
    v_add_f32 v23, v23, v61
    v_add_f32 v22, v22, v62
    v_add_f32 v23, v23, v63
    v_add_f32 v22, v22, v64
    v_add_f32 v23, v23, v65
    v_add_f32 v22, v22, v66
    v_add_f32 v23, v23, v67
    v_add_f32 v22, v22, v68
    v_add_f32 v23, v23, v69
    v_add_f32 v22, v22, v70
    v_add_f32 v23, v23, v71
    v_cvt_pk_bf16_f32 v136, v56, v57
    v_cvt_pk_bf16_f32 v137, v58, v59
    v_cvt_pk_bf16_f32 v138, v60, v61
    v_cvt_pk_bf16_f32 v139, v62, v63
    v_cvt_pk_bf16_f32 v140, v64, v65
    v_cvt_pk_bf16_f32 v141, v66, v67
    v_cvt_pk_bf16_f32 v142, v68, v69
    v_cvt_pk_bf16_f32 v143, v70, v71
    s_waitcnt lgkmcnt(0)
    v_mfma_f32_32x32x16_bf16 v[88:103], v[120:123], v[136:139], v[88:103]
    v_mfma_f32_32x32x16_bf16 v[88:103], v[124:127], v[140:143], v[88:103]
    ds_read_b128 v[128:131], v20 offset:6144
    ds_read_b128 v[132:135], v20 offset:7168
    v_exp_f32 v72, v72
    v_exp_f32 v73, v73
    v_exp_f32 v74, v74
    v_exp_f32 v75, v75
    v_exp_f32 v76, v76
    v_exp_f32 v77, v77
    v_exp_f32 v78, v78
    v_exp_f32 v79, v79
    v_exp_f32 v80, v80
    v_exp_f32 v81, v81
    v_exp_f32 v82, v82
    v_exp_f32 v83, v83
    v_exp_f32 v84, v84
    v_exp_f32 v85, v85
    v_exp_f32 v86, v86
    v_exp_f32 v87, v87
    v_add_f32 v22, v22, v72
    v_add_f32 v23, v23, v73
    v_add_f32 v22, v22, v74
    v_add_f32 v23, v23, v75
    v_add_f32 v22, v22, v76
    v_add_f32 v23, v23, v77
    v_add_f32 v22, v22, v78
    v_add_f32 v23, v23, v79
    v_add_f32 v22, v22, v80
    v_add_f32 v23, v23, v81
    v_add_f32 v22, v22, v82
    v_add_f32 v23, v23, v83
    v_add_f32 v22, v22, v84
    v_add_f32 v23, v23, v85
    v_add_f32 v22, v22, v86
    v_add_f32 v23, v23, v87
    v_cvt_pk_bf16_f32 v144, v72, v73
    v_cvt_pk_bf16_f32 v145, v74, v75
    v_cvt_pk_bf16_f32 v146, v76, v77
    v_cvt_pk_bf16_f32 v147, v78, v79
    v_cvt_pk_bf16_f32 v148, v80, v81
    v_cvt_pk_bf16_f32 v149, v82, v83
    v_cvt_pk_bf16_f32 v150, v84, v85
    v_cvt_pk_bf16_f32 v151, v86, v87
    s_waitcnt lgkmcnt(0)
    v_mfma_f32_32x32x16_bf16 v[88:103], v[128:131], v[144:147], v[88:103]
    v_mfma_f32_32x32x16_bf16 v[88:103], v[132:135], v[148:151], v[88:103]
    v_add_f32 v22, v22, v23
    v_mov_b32 v152, v22
    s_nop 1
    v_permlane32_swap_b32 v22, v152
    v_add_f32 v22, v22, v152
    v_rcp_f32 v22, v22
    s_lshl_b32 s36, s99, 16
    s_add_u32 s36, s36, 0x800000
    s_lshl_b32 s33, s25, 11
    s_add_u32 s33, s33, s36
    s_lshl_b32 s30, s24, 9
    s_lshl_b32 s31, s3, 6
    s_add_u32 s30, s30, s31
    s_add_u32 s30, s30, s26
    s_add_u32 s30, s30, 0xdd2000
    s_lshl_b32 s31, s25, 2
    s_add_u32 s31, s31, s30
    v_pk_mul_f32 v[88:89], v[88:89], v[22:23] op_sel_hi:[1,0]
    v_pk_mul_f32 v[90:91], v[90:91], v[22:23] op_sel_hi:[1,0]
    v_pk_mul_f32 v[92:93], v[92:93], v[22:23] op_sel_hi:[1,0]
    v_pk_mul_f32 v[94:95], v[94:95], v[22:23] op_sel_hi:[1,0]
    v_pk_mul_f32 v[96:97], v[96:97], v[22:23] op_sel_hi:[1,0]
    v_pk_mul_f32 v[98:99], v[98:99], v[22:23] op_sel_hi:[1,0]
    v_pk_mul_f32 v[100:101], v[100:101], v[22:23] op_sel_hi:[1,0]
    v_pk_mul_f32 v[102:103], v[102:103], v[22:23] op_sel_hi:[1,0]
    v_cvt_pk_bf16_f32 v88, v88, v89
    v_cvt_pk_bf16_f32 v89, v90, v91
    v_cvt_pk_bf16_f32 v90, v92, v93
    v_cvt_pk_bf16_f32 v91, v94, v95
    v_cvt_pk_bf16_f32 v92, v96, v97
    v_cvt_pk_bf16_f32 v93, v98, v99
    v_cvt_pk_bf16_f32 v94, v100, v101
    v_cvt_pk_bf16_f32 v95, v102, v103
    s_cmp_lg_u32 s77, 0
    s_cbranch_scc1 lc_22
    buffer_store_dwordx4 v[88:91], v253, s[20:23], s33 offen sc1
    buffer_store_dwordx4 v[92:95], v253, s[20:23], s33 offen offset:1024 sc1
    s_branch lc_23
lc_22:
    buffer_store_dwordx4 v[88:91], v253, s[20:23], s33 offen
    buffer_store_dwordx4 v[92:95], v253, s[20:23], s33 offen offset:1024
lc_23:
    v_bfe_u32 v33, v252, 2, 2
    v_lshrrev_b32 v32, 5, v252
    v_lshl_add_u32 v34, v32, 3, v33
    v_lshlrev_b32 v34, 7, v34
    v_lshrrev_b32 v33, 1, v33
    v_lshl_add_u32 v34, v33, 6, v34
    v_bfe_u32 v33, v252, 4, 1
    v_lshl_add_u32 v34, v33, 5, v34
    v_and_b32 v33, 3, v252
    v_lshl_add_u32 v56, v33, 3, v34
    v_xor_b32 v57, 64, v56
    v_add_u32 v58, 0x10000, v56
    v_add_u32 v59, 0x10000, v57
    v_and_b32 v60, 15, v252
    v_lshlrev_b32 v60, 2, v60
    s_waitcnt vmcnt(2)
    v_lshlrev_b32 v0, 16, v208
    v_and_b32 v1, 0xffff0000, v208
    v_lshlrev_b32 v2, 16, v209
    v_and_b32 v3, 0xffff0000, v209
    v_lshlrev_b32 v4, 16, v210
    v_and_b32 v5, 0xffff0000, v210
    v_lshlrev_b32 v6, 16, v211
    v_and_b32 v7, 0xffff0000, v211
    v_lshlrev_b32 v8, 16, v212
    v_and_b32 v9, 0xffff0000, v212
    v_lshlrev_b32 v10, 16, v213
    v_and_b32 v11, 0xffff0000, v213
    v_lshlrev_b32 v12, 16, v214
    v_and_b32 v13, 0xffff0000, v214
    v_lshlrev_b32 v14, 16, v215
    v_and_b32 v15, 0xffff0000, v215
    v_lshlrev_b32 v16, 16, v216
    v_and_b32 v17, 0xffff0000, v216
    v_lshlrev_b32 v18, 16, v217
    v_and_b32 v19, 0xffff0000, v217
    v_lshlrev_b32 v20, 16, v218
    v_and_b32 v21, 0xffff0000, v218
    v_lshlrev_b32 v22, 16, v219
    v_and_b32 v23, 0xffff0000, v219
    v_lshlrev_b32 v24, 16, v220
    v_and_b32 v25, 0xffff0000, v220
    v_lshlrev_b32 v26, 16, v221
    v_and_b32 v27, 0xffff0000, v221
    v_lshlrev_b32 v28, 16, v222
    v_and_b32 v29, 0xffff0000, v222
    v_lshlrev_b32 v30, 16, v223
    v_and_b32 v31, 0xffff0000, v223
    v_pk_fma_f32 v[0:1], v[0:1], v[240:241], v[240:241] op_sel:[0,0,1] op_sel_hi:[1,0,1]
    v_pk_fma_f32 v[2:3], v[2:3], v[240:241], v[240:241] op_sel:[0,0,1] op_sel_hi:[1,0,1]
    v_pk_fma_f32 v[4:5], v[4:5], v[240:241], v[240:241] op_sel:[0,0,1] op_sel_hi:[1,0,1]
    v_pk_fma_f32 v[6:7], v[6:7], v[240:241], v[240:241] op_sel:[0,0,1] op_sel_hi:[1,0,1]
    v_pk_fma_f32 v[8:9], v[8:9], v[240:241], v[240:241] op_sel:[0,0,1] op_sel_hi:[1,0,1]
    v_pk_fma_f32 v[10:11], v[10:11], v[240:241], v[240:241] op_sel:[0,0,1] op_sel_hi:[1,0,1]
    v_pk_fma_f32 v[12:13], v[12:13], v[240:241], v[240:241] op_sel:[0,0,1] op_sel_hi:[1,0,1]
    v_pk_fma_f32 v[14:15], v[14:15], v[240:241], v[240:241] op_sel:[0,0,1] op_sel_hi:[1,0,1]
    v_pk_fma_f32 v[16:17], v[16:17], v[240:241], v[240:241] op_sel:[0,0,1] op_sel_hi:[1,0,1]
    v_pk_fma_f32 v[18:19], v[18:19], v[240:241], v[240:241] op_sel:[0,0,1] op_sel_hi:[1,0,1]
    v_pk_fma_f32 v[20:21], v[20:21], v[240:241], v[240:241] op_sel:[0,0,1] op_sel_hi:[1,0,1]
    v_pk_fma_f32 v[22:23], v[22:23], v[240:241], v[240:241] op_sel:[0,0,1] op_sel_hi:[1,0,1]
    v_pk_fma_f32 v[24:25], v[24:25], v[240:241], v[240:241] op_sel:[0,0,1] op_sel_hi:[1,0,1]
    v_pk_fma_f32 v[26:27], v[26:27], v[240:241], v[240:241] op_sel:[0,0,1] op_sel_hi:[1,0,1]
    v_pk_fma_f32 v[28:29], v[28:29], v[240:241], v[240:241] op_sel:[0,0,1] op_sel_hi:[1,0,1]
    v_pk_fma_f32 v[30:31], v[30:31], v[240:241], v[240:241] op_sel:[0,0,1] op_sel_hi:[1,0,1]
    v_mov_b32 v154, s88
    s_mov_b64 exec, 1
    s_waitcnt vmcnt(0)
    s_cmp_lg_u32 s77, 0
    s_cbranch_scc1 lc_24
    buffer_store_dword v154, v253, s[20:23], s31 offen sc1
    s_branch lc_25
lc_24:
    buffer_store_dword v154, v253, s[20:23], s31 offen
lc_25:
    s_mov_b64 exec, -1
    s_barrier
    s_add_u32 s96, s25, 0
    s_and_b32 s96, s96, 15
    s_lshl_b32 s96, s96, 17
    s_add_u32 s96, s96, 65536
    s_add_u32 m0, s101, 65536
    s_nop 0
    buffer_load_dwordx4 v243, s[8:11], s96 offen lds
    s_add_u32 s96, s25, 1
    s_and_b32 s96, s96, 15
    s_lshl_b32 s96, s96, 17
    s_add_u32 s96, s96, 65536
    s_add_u32 m0, s101, 69632
    s_nop 0
    buffer_load_dwordx4 v243, s[8:11], s96 offen lds
    s_add_u32 s96, s25, 2
    s_and_b32 s96, s96, 15
    s_lshl_b32 s96, s96, 17
    s_add_u32 s96, s96, 65536
    s_add_u32 m0, s101, 73728
    s_nop 0
    buffer_load_dwordx4 v243, s[8:11], s96 offen lds
    s_add_u32 s96, s25, 3
    s_and_b32 s96, s96, 15
    s_lshl_b32 s96, s96, 17
    s_add_u32 s96, s96, 65536
    s_add_u32 m0, s101, 77824
    s_nop 0
    buffer_load_dwordx4 v243, s[8:11], s96 offen lds
    s_add_u32 s96, s25, 4
    s_and_b32 s96, s96, 15
    s_lshl_b32 s96, s96, 17
    s_add_u32 s96, s96, 65536
    s_add_u32 m0, s101, 81920
    s_nop 0
    buffer_load_dwordx4 v243, s[8:11], s96 offen lds
    s_add_u32 s96, s25, 5
    s_and_b32 s96, s96, 15
    s_lshl_b32 s96, s96, 17
    s_add_u32 s96, s96, 65536
    s_add_u32 m0, s101, 86016
    s_nop 0
    buffer_load_dwordx4 v243, s[8:11], s96 offen lds
    s_add_u32 s96, s25, 6
    s_and_b32 s96, s96, 15
    s_lshl_b32 s96, s96, 17
    s_add_u32 s96, s96, 65536
    s_add_u32 m0, s101, 90112
    s_nop 0
    buffer_load_dwordx4 v243, s[8:11], s96 offen lds
    s_add_u32 s96, s25, 7
    s_and_b32 s96, s96, 15
    s_lshl_b32 s96, s96, 17
    s_add_u32 s96, s96, 65536
    s_add_u32 m0, s101, 94208
    s_nop 0
    buffer_load_dwordx4 v243, s[8:11], s96 offen lds
    s_add_u32 s96, s25, 8
    s_and_b32 s96, s96, 15
    s_lshl_b32 s96, s96, 17
    s_add_u32 s96, s96, 65536
    s_add_u32 m0, s101, 98304
    s_nop 0
    buffer_load_dwordx4 v243, s[8:11], s96 offen lds
    s_add_u32 s96, s25, 9
    s_and_b32 s96, s96, 15
    s_lshl_b32 s96, s96, 17
    s_add_u32 s96, s96, 65536
    s_add_u32 m0, s101, 102400
    s_nop 0
    buffer_load_dwordx4 v243, s[8:11], s96 offen lds
    s_add_u32 s96, s25, 10
    s_and_b32 s96, s96, 15
    s_lshl_b32 s96, s96, 17
    s_add_u32 s96, s96, 65536
    s_add_u32 m0, s101, 106496
    s_nop 0
    buffer_load_dwordx4 v243, s[8:11], s96 offen lds
    s_add_u32 s96, s25, 11
    s_and_b32 s96, s96, 15
    s_lshl_b32 s96, s96, 17
    s_add_u32 s96, s96, 65536
    s_add_u32 m0, s101, 110592
    s_nop 0
    buffer_load_dwordx4 v243, s[8:11], s96 offen lds
    v_bfe_u32 v100, v252, 4, 1
    v_lshlrev_b32 v100, 11, v100
    v_lshrrev_b32 v101, 5, v252
    v_lshl_add_u32 v100, v101, 8, v100
    v_and_b32 v101, 15, v252
    v_lshl_add_u32 v100, v101, 4, v100
    s_lshl_b32 s34, s28, 12
    s_add_u32 s34, s34, 147456
    v_add_u32 v101, s34, v100
    s_lshl_b32 s37, s25, 11
    ds_read_b64_tr_b16 v[32:33], v56 offset:0
    ds_read_b64_tr_b16 v[34:35], v56 offset:512
    ds_read_b64_tr_b16 v[36:37], v57 offset:0
    ds_read_b64_tr_b16 v[38:39], v57 offset:512
    ds_read_b64_tr_b16 v[40:41], v56 offset:2048
    ds_read_b64_tr_b16 v[42:43], v56 offset:2560
    ds_read_b64_tr_b16 v[44:45], v57 offset:2048
    ds_read_b64_tr_b16 v[46:47], v57 offset:2560
    s_mov_b32 s78, s27
pl_26:
    buffer_load_dword v61, v60, s[20:23], s30 offen offset:0 sc1
    s_waitcnt vmcnt(0)
pc_27:
    v_cmp_ne_u32 vcc, s88, v61
    s_cbranch_vccz pd_28
    s_sub_u32 s78, s78, 1
    s_cmp_lg_u32 s78, 0
    s_cbranch_scc1 pl_26
    s_mov_b32 s27, 1
pd_28:
    s_add_u32 s38, s36, s37
    buffer_load_dwordx4 v[104:107], v253, s[20:23], s38 offen offset:0 sc1
    s_add_u32 s37, s37, 2048
    s_and_b32 s37, s37, 0x7800
    buffer_load_dwordx4 v[108:111], v253, s[20:23], s38 offen offset:1024 sc1
    s_add_u32 s38, s36, s37
    buffer_load_dwordx4 v[112:115], v253, s[20:23], s38 offen offset:0 sc1
    s_add_u32 s37, s37, 2048
    s_and_b32 s37, s37, 0x7800
    buffer_load_dwordx4 v[116:119], v253, s[20:23], s38 offen offset:1024 sc1
    s_add_u32 s38, s36, s37
    buffer_load_dwordx4 v[120:123], v253, s[20:23], s38 offen offset:0 sc1
    s_add_u32 s37, s37, 2048
    s_and_b32 s37, s37, 0x7800
    buffer_load_dwordx4 v[124:127], v253, s[20:23], s38 offen offset:1024 sc1
    s_add_u32 s38, s36, s37
    buffer_load_dwordx4 v[128:131], v253, s[20:23], s38 offen offset:0 sc1
    s_add_u32 s37, s37, 2048
    s_and_b32 s37, s37, 0x7800
    buffer_load_dwordx4 v[132:135], v253, s[20:23], s38 offen offset:1024 sc1
    s_waitcnt vmcnt(7) lgkmcnt(4)
    v_mfma_f32_32x32x16_bf16 v[0:15], v[32:35], v[104:107], v[0:15]
    s_add_u32 s38, s36, s37
    buffer_load_dwordx4 v[136:139], v253, s[20:23], s38 offen offset:0 sc1
    ds_read_b64_tr_b16 v[48:49], v56 offset:4096
    ds_read_b64_tr_b16 v[50:51], v56 offset:4608
    v_mfma_f32_32x32x16_bf16 v[16:31], v[36:39], v[104:107], v[16:31]
    ds_read_b64_tr_b16 v[52:53], v57 offset:4096
    ds_read_b64_tr_b16 v[54:55], v57 offset:4608
    s_waitcnt vmcnt(7) lgkmcnt(4)
    v_mfma_f32_32x32x16_bf16 v[0:15], v[40:43], v[108:111], v[0:15]
    s_add_u32 s37, s37, 2048
    s_and_b32 s37, s37, 0x7800
    buffer_load_dwordx4 v[104:107], v253, s[20:23], s38 offen offset:1024 sc1
    ds_read_b64_tr_b16 v[32:33], v56 offset:6144
    ds_read_b64_tr_b16 v[34:35], v56 offset:6656
    v_mfma_f32_32x32x16_bf16 v[16:31], v[44:47], v[108:111], v[16:31]
    ds_read_b64_tr_b16 v[36:37], v57 offset:6144
    ds_read_b64_tr_b16 v[38:39], v57 offset:6656
    s_waitcnt vmcnt(7) lgkmcnt(4)
    v_mfma_f32_32x32x16_bf16 v[0:15], v[48:51], v[112:115], v[0:15]
    s_add_u32 s38, s36, s37
    buffer_load_dwordx4 v[108:111], v253, s[20:23], s38 offen offset:0 sc1
    ds_read_b64_tr_b16 v[40:41], v56 offset:8192
    ds_read_b64_tr_b16 v[42:43], v56 offset:8704
    v_mfma_f32_32x32x16_bf16 v[16:31], v[52:55], v[112:115], v[16:31]
    ds_read_b64_tr_b16 v[44:45], v57 offset:8192
    ds_read_b64_tr_b16 v[46:47], v57 offset:8704
    s_waitcnt vmcnt(7) lgkmcnt(4)
    v_mfma_f32_32x32x16_bf16 v[0:15], v[32:35], v[116:119], v[0:15]
    s_add_u32 s37, s37, 2048
    s_and_b32 s37, s37, 0x7800
    buffer_load_dwordx4 v[112:115], v253, s[20:23], s38 offen offset:1024 sc1
    ds_read_b64_tr_b16 v[48:49], v56 offset:10240
    ds_read_b64_tr_b16 v[50:51], v56 offset:10752
    v_mfma_f32_32x32x16_bf16 v[16:31], v[36:39], v[116:119], v[16:31]
    ds_read_b64_tr_b16 v[52:53], v57 offset:10240
    ds_read_b64_tr_b16 v[54:55], v57 offset:10752
    s_waitcnt vmcnt(7) lgkmcnt(4)
    v_mfma_f32_32x32x16_bf16 v[0:15], v[40:43], v[120:123], v[0:15]
    s_add_u32 s38, s36, s37
    buffer_load_dwordx4 v[116:119], v253, s[20:23], s38 offen offset:0 sc1
    ds_read_b64_tr_b16 v[32:33], v56 offset:12288
    ds_read_b64_tr_b16 v[34:35], v56 offset:12800
    v_mfma_f32_32x32x16_bf16 v[16:31], v[44:47], v[120:123], v[16:31]
    ds_read_b64_tr_b16 v[36:37], v57 offset:12288
    ds_read_b64_tr_b16 v[38:39], v57 offset:12800
    s_waitcnt vmcnt(7) lgkmcnt(4)
    v_mfma_f32_32x32x16_bf16 v[0:15], v[48:51], v[124:127], v[0:15]
    s_add_u32 s37, s37, 2048
    s_and_b32 s37, s37, 0x7800
    buffer_load_dwordx4 v[120:123], v253, s[20:23], s38 offen offset:1024 sc1
    ds_read_b64_tr_b16 v[40:41], v56 offset:14336
    ds_read_b64_tr_b16 v[42:43], v56 offset:14848
    v_mfma_f32_32x32x16_bf16 v[16:31], v[52:55], v[124:127], v[16:31]
    ds_read_b64_tr_b16 v[44:45], v57 offset:14336
    ds_read_b64_tr_b16 v[46:47], v57 offset:14848
    s_waitcnt vmcnt(7) lgkmcnt(4)
    v_mfma_f32_32x32x16_bf16 v[0:15], v[32:35], v[128:131], v[0:15]
    s_add_u32 s38, s36, s37
    buffer_load_dwordx4 v[124:127], v253, s[20:23], s38 offen offset:0 sc1
    ds_read_b64_tr_b16 v[48:49], v56 offset:16384
    ds_read_b64_tr_b16 v[50:51], v56 offset:16896
    v_mfma_f32_32x32x16_bf16 v[16:31], v[36:39], v[128:131], v[16:31]
    ds_read_b64_tr_b16 v[52:53], v57 offset:16384
    ds_read_b64_tr_b16 v[54:55], v57 offset:16896
    s_waitcnt vmcnt(7) lgkmcnt(4)
    v_mfma_f32_32x32x16_bf16 v[0:15], v[40:43], v[132:135], v[0:15]
    s_add_u32 s37, s37, 2048
    s_and_b32 s37, s37, 0x7800
    buffer_load_dwordx4 v[128:131], v253, s[20:23], s38 offen offset:1024 sc1
    ds_read_b64_tr_b16 v[32:33], v56 offset:18432
    ds_read_b64_tr_b16 v[34:35], v56 offset:18944
    v_mfma_f32_32x32x16_bf16 v[16:31], v[44:47], v[132:135], v[16:31]
    ds_read_b64_tr_b16 v[36:37], v57 offset:18432
    ds_read_b64_tr_b16 v[38:39], v57 offset:18944
    s_waitcnt vmcnt(7) lgkmcnt(4)
    v_mfma_f32_32x32x16_bf16 v[0:15], v[48:51], v[136:139], v[0:15]
    s_add_u32 s38, s36, s37
    buffer_load_dwordx4 v[132:135], v253, s[20:23], s38 offen offset:0 sc1
    ds_read_b64_tr_b16 v[40:41], v56 offset:20480
    ds_read_b64_tr_b16 v[42:43], v56 offset:20992
    v_mfma_f32_32x32x16_bf16 v[16:31], v[52:55], v[136:139], v[16:31]
    ds_read_b64_tr_b16 v[44:45], v57 offset:20480
    ds_read_b64_tr_b16 v[46:47], v57 offset:20992
    s_waitcnt vmcnt(7) lgkmcnt(4)
    v_mfma_f32_32x32x16_bf16 v[0:15], v[32:35], v[104:107], v[0:15]
    s_add_u32 s37, s37, 2048
    s_and_b32 s37, s37, 0x7800
    buffer_load_dwordx4 v[136:139], v253, s[20:23], s38 offen offset:1024 sc1
    ds_read_b64_tr_b16 v[48:49], v56 offset:22528
    ds_read_b64_tr_b16 v[50:51], v56 offset:23040
    v_mfma_f32_32x32x16_bf16 v[16:31], v[36:39], v[104:107], v[16:31]
    ds_read_b64_tr_b16 v[52:53], v57 offset:22528
    ds_read_b64_tr_b16 v[54:55], v57 offset:23040
    s_waitcnt vmcnt(7) lgkmcnt(4)
    v_mfma_f32_32x32x16_bf16 v[0:15], v[40:43], v[108:111], v[0:15]
    s_add_u32 s38, s36, s37
    buffer_load_dwordx4 v[104:107], v253, s[20:23], s38 offen offset:0 sc1
    ds_read_b64_tr_b16 v[32:33], v56 offset:24576
    ds_read_b64_tr_b16 v[34:35], v56 offset:25088
    v_mfma_f32_32x32x16_bf16 v[16:31], v[44:47], v[108:111], v[16:31]
    ds_read_b64_tr_b16 v[36:37], v57 offset:24576
    ds_read_b64_tr_b16 v[38:39], v57 offset:25088
    s_waitcnt vmcnt(7) lgkmcnt(4)
    v_mfma_f32_32x32x16_bf16 v[0:15], v[48:51], v[112:115], v[0:15]
    s_add_u32 s37, s37, 2048
    s_and_b32 s37, s37, 0x7800
    buffer_load_dwordx4 v[108:111], v253, s[20:23], s38 offen offset:1024 sc1
    ds_read_b64_tr_b16 v[40:41], v56 offset:26624
    ds_read_b64_tr_b16 v[42:43], v56 offset:27136
    v_mfma_f32_32x32x16_bf16 v[16:31], v[52:55], v[112:115], v[16:31]
    ds_read_b64_tr_b16 v[44:45], v57 offset:26624
    ds_read_b64_tr_b16 v[46:47], v57 offset:27136
    s_waitcnt vmcnt(7) lgkmcnt(4)
    v_mfma_f32_32x32x16_bf16 v[0:15], v[32:35], v[116:119], v[0:15]
    s_add_u32 s38, s36, s37
    buffer_load_dwordx4 v[112:115], v253, s[20:23], s38 offen offset:0 sc1
    ds_read_b64_tr_b16 v[48:49], v56 offset:28672
    ds_read_b64_tr_b16 v[50:51], v56 offset:29184
    v_mfma_f32_32x32x16_bf16 v[16:31], v[36:39], v[116:119], v[16:31]
    ds_read_b64_tr_b16 v[52:53], v57 offset:28672
    ds_read_b64_tr_b16 v[54:55], v57 offset:29184
    s_waitcnt vmcnt(7) lgkmcnt(4)
    v_mfma_f32_32x32x16_bf16 v[0:15], v[40:43], v[120:123], v[0:15]
    s_add_u32 s37, s37, 2048
    s_and_b32 s37, s37, 0x7800
    buffer_load_dwordx4 v[116:119], v253, s[20:23], s38 offen offset:1024 sc1
    ds_read_b64_tr_b16 v[32:33], v56 offset:30720
    ds_read_b64_tr_b16 v[34:35], v56 offset:31232
    v_mfma_f32_32x32x16_bf16 v[16:31], v[44:47], v[120:123], v[16:31]
    ds_read_b64_tr_b16 v[36:37], v57 offset:30720
    ds_read_b64_tr_b16 v[38:39], v57 offset:31232
    s_waitcnt vmcnt(7) lgkmcnt(4)
    v_mfma_f32_32x32x16_bf16 v[0:15], v[48:51], v[124:127], v[0:15]
    s_add_u32 s38, s36, s37
    buffer_load_dwordx4 v[120:123], v253, s[20:23], s38 offen offset:0 sc1
    ds_read_b64_tr_b16 v[40:41], v56 offset:32768
    ds_read_b64_tr_b16 v[42:43], v56 offset:33280
    v_mfma_f32_32x32x16_bf16 v[16:31], v[52:55], v[124:127], v[16:31]
    ds_read_b64_tr_b16 v[44:45], v57 offset:32768
    ds_read_b64_tr_b16 v[46:47], v57 offset:33280
    s_waitcnt vmcnt(7) lgkmcnt(4)
    v_mfma_f32_32x32x16_bf16 v[0:15], v[32:35], v[128:131], v[0:15]
    s_add_u32 s37, s37, 2048
    s_and_b32 s37, s37, 0x7800
    buffer_load_dwordx4 v[124:127], v253, s[20:23], s38 offen offset:1024 sc1
    ds_read_b64_tr_b16 v[48:49], v56 offset:34816
    ds_read_b64_tr_b16 v[50:51], v56 offset:35328
    v_mfma_f32_32x32x16_bf16 v[16:31], v[36:39], v[128:131], v[16:31]
    ds_read_b64_tr_b16 v[52:53], v57 offset:34816
    ds_read_b64_tr_b16 v[54:55], v57 offset:35328
    s_waitcnt vmcnt(7) lgkmcnt(4)
    v_mfma_f32_32x32x16_bf16 v[0:15], v[40:43], v[132:135], v[0:15]
    s_add_u32 s38, s36, s37
    buffer_load_dwordx4 v[128:131], v253, s[20:23], s38 offen offset:0 sc1
    ds_read_b64_tr_b16 v[32:33], v56 offset:36864
    ds_read_b64_tr_b16 v[34:35], v56 offset:37376
    v_mfma_f32_32x32x16_bf16 v[16:31], v[44:47], v[132:135], v[16:31]
    ds_read_b64_tr_b16 v[36:37], v57 offset:36864
    ds_read_b64_tr_b16 v[38:39], v57 offset:37376
    s_waitcnt vmcnt(7) lgkmcnt(4)
    v_mfma_f32_32x32x16_bf16 v[0:15], v[48:51], v[136:139], v[0:15]
    s_add_u32 s37, s37, 2048
    s_and_b32 s37, s37, 0x7800
    buffer_load_dwordx4 v[132:135], v253, s[20:23], s38 offen offset:1024 sc1
    ds_read_b64_tr_b16 v[40:41], v56 offset:38912
    ds_read_b64_tr_b16 v[42:43], v56 offset:39424
    v_mfma_f32_32x32x16_bf16 v[16:31], v[52:55], v[136:139], v[16:31]
    ds_read_b64_tr_b16 v[44:45], v57 offset:38912
    ds_read_b64_tr_b16 v[46:47], v57 offset:39424
    s_waitcnt vmcnt(7) lgkmcnt(4)
    v_mfma_f32_32x32x16_bf16 v[0:15], v[32:35], v[104:107], v[0:15]
    s_add_u32 s38, s36, s37
    buffer_load_dwordx4 v[136:139], v253, s[20:23], s38 offen offset:0 sc1
    ds_read_b64_tr_b16 v[48:49], v56 offset:40960
    ds_read_b64_tr_b16 v[50:51], v56 offset:41472
    v_mfma_f32_32x32x16_bf16 v[16:31], v[36:39], v[104:107], v[16:31]
    ds_read_b64_tr_b16 v[52:53], v57 offset:40960
    ds_read_b64_tr_b16 v[54:55], v57 offset:41472
    s_waitcnt vmcnt(7) lgkmcnt(4)
    v_mfma_f32_32x32x16_bf16 v[0:15], v[40:43], v[108:111], v[0:15]
    s_add_u32 s37, s37, 2048
    s_and_b32 s37, s37, 0x7800
    buffer_load_dwordx4 v[104:107], v253, s[20:23], s38 offen offset:1024 sc1
    ds_read_b64_tr_b16 v[32:33], v56 offset:43008
    ds_read_b64_tr_b16 v[34:35], v56 offset:43520
    v_mfma_f32_32x32x16_bf16 v[16:31], v[44:47], v[108:111], v[16:31]
    ds_read_b64_tr_b16 v[36:37], v57 offset:43008
    ds_read_b64_tr_b16 v[38:39], v57 offset:43520
    s_waitcnt vmcnt(7) lgkmcnt(4)
    v_mfma_f32_32x32x16_bf16 v[0:15], v[48:51], v[112:115], v[0:15]
    buffer_load_dword v61, v60, s[20:23], s30 offen offset:256 sc1
    s_add_u32 s38, s36, s37
    buffer_load_dwordx4 v[108:111], v253, s[20:23], s38 offen offset:0 sc1
    ds_read_b64_tr_b16 v[40:41], v56 offset:45056
    ds_read_b64_tr_b16 v[42:43], v56 offset:45568
    v_mfma_f32_32x32x16_bf16 v[16:31], v[52:55], v[112:115], v[16:31]
    ds_read_b64_tr_b16 v[44:45], v57 offset:45056
    ds_read_b64_tr_b16 v[46:47], v57 offset:45568
    s_waitcnt vmcnt(8) lgkmcnt(4)
    v_mfma_f32_32x32x16_bf16 v[0:15], v[32:35], v[116:119], v[0:15]
    s_add_u32 s37, s37, 2048
    s_and_b32 s37, s37, 0x7800
    buffer_load_dwordx4 v[112:115], v253, s[20:23], s38 offen offset:1024 sc1
    ds_read_b64_tr_b16 v[48:49], v56 offset:47104
    ds_read_b64_tr_b16 v[50:51], v56 offset:47616
    v_mfma_f32_32x32x16_bf16 v[16:31], v[36:39], v[116:119], v[16:31]
    ds_read_b64_tr_b16 v[52:53], v57 offset:47104
    ds_read_b64_tr_b16 v[54:55], v57 offset:47616
    s_waitcnt vmcnt(8) lgkmcnt(4)
    v_mfma_f32_32x32x16_bf16 v[0:15], v[40:43], v[120:123], v[0:15]
    s_add_u32 s38, s36, s37
    buffer_load_dwordx4 v[116:119], v253, s[20:23], s38 offen offset:0 sc1
    ds_read_b64_tr_b16 v[32:33], v56 offset:49152
    ds_read_b64_tr_b16 v[34:35], v56 offset:49664
    v_mfma_f32_32x32x16_bf16 v[16:31], v[44:47], v[120:123], v[16:31]
    ds_read_b64_tr_b16 v[36:37], v57 offset:49152
    ds_read_b64_tr_b16 v[38:39], v57 offset:49664
    s_waitcnt vmcnt(8) lgkmcnt(4)
    v_mfma_f32_32x32x16_bf16 v[0:15], v[48:51], v[124:127], v[0:15]
    s_add_u32 s37, s37, 2048
    s_and_b32 s37, s37, 0x7800
    buffer_load_dwordx4 v[120:123], v253, s[20:23], s38 offen offset:1024 sc1
    ds_read_b64_tr_b16 v[40:41], v56 offset:51200
    ds_read_b64_tr_b16 v[42:43], v56 offset:51712
    v_mfma_f32_32x32x16_bf16 v[16:31], v[52:55], v[124:127], v[16:31]
    ds_read_b64_tr_b16 v[44:45], v57 offset:51200
    ds_read_b64_tr_b16 v[46:47], v57 offset:51712
    s_waitcnt vmcnt(8) lgkmcnt(4)
    v_mfma_f32_32x32x16_bf16 v[0:15], v[32:35], v[128:131], v[0:15]
    s_mov_b32 s78, s27
    s_waitcnt vmcnt(4)
    s_branch pc_30
pl_29:
    buffer_load_dword v61, v60, s[20:23], s30 offen offset:256 sc1
    s_waitcnt vmcnt(0)
pc_30:
    v_cmp_ne_u32 vcc, s88, v61
    s_cbranch_vccz pd_31
    s_sub_u32 s78, s78, 1
    s_cmp_lg_u32 s78, 0
    s_cbranch_scc1 pl_29
    s_mov_b32 s27, 1
pd_31:
    s_add_u32 s36, s36, 32768
    s_add_u32 s38, s36, s37
    buffer_load_dwordx4 v[124:127], v253, s[20:23], s38 offen offset:0 sc1
    ds_read_b64_tr_b16 v[48:49], v56 offset:53248
    ds_read_b64_tr_b16 v[50:51], v56 offset:53760
    v_mfma_f32_32x32x16_bf16 v[16:31], v[36:39], v[128:131], v[16:31]
    ds_read_b64_tr_b16 v[52:53], v57 offset:53248
    ds_read_b64_tr_b16 v[54:55], v57 offset:53760
    s_waitcnt vmcnt(8) lgkmcnt(4)
    v_mfma_f32_32x32x16_bf16 v[0:15], v[40:43], v[132:135], v[0:15]
    s_add_u32 s37, s37, 2048
    s_and_b32 s37, s37, 0x7800
    buffer_load_dwordx4 v[128:131], v253, s[20:23], s38 offen offset:1024 sc1
    ds_read_b64_tr_b16 v[32:33], v56 offset:55296
    ds_read_b64_tr_b16 v[34:35], v56 offset:55808
    v_mfma_f32_32x32x16_bf16 v[16:31], v[44:47], v[132:135], v[16:31]
    ds_read_b64_tr_b16 v[36:37], v57 offset:55296
    ds_read_b64_tr_b16 v[38:39], v57 offset:55808
    s_waitcnt vmcnt(8) lgkmcnt(4)
    v_mfma_f32_32x32x16_bf16 v[0:15], v[48:51], v[136:139], v[0:15]
    s_add_u32 s38, s36, s37
    buffer_load_dwordx4 v[132:135], v253, s[20:23], s38 offen offset:0 sc1
    ds_read_b64_tr_b16 v[40:41], v56 offset:57344
    ds_read_b64_tr_b16 v[42:43], v56 offset:57856
    v_mfma_f32_32x32x16_bf16 v[16:31], v[52:55], v[136:139], v[16:31]
    ds_read_b64_tr_b16 v[44:45], v57 offset:57344
    ds_read_b64_tr_b16 v[46:47], v57 offset:57856
    s_waitcnt vmcnt(8) lgkmcnt(4)
    v_mfma_f32_32x32x16_bf16 v[0:15], v[32:35], v[104:107], v[0:15]
    s_add_u32 s37, s37, 2048
    s_and_b32 s37, s37, 0x7800
    buffer_load_dwordx4 v[136:139], v253, s[20:23], s38 offen offset:1024 sc1
    ds_read_b64_tr_b16 v[48:49], v56 offset:59392
    ds_read_b64_tr_b16 v[50:51], v56 offset:59904
    v_mfma_f32_32x32x16_bf16 v[16:31], v[36:39], v[104:107], v[16:31]
    ds_read_b64_tr_b16 v[52:53], v57 offset:59392
    ds_read_b64_tr_b16 v[54:55], v57 offset:59904
    s_waitcnt vmcnt(7) lgkmcnt(4)
    v_mfma_f32_32x32x16_bf16 v[0:15], v[40:43], v[108:111], v[0:15]
    s_add_u32 s38, s36, s37
    buffer_load_dwordx4 v[104:107], v253, s[20:23], s38 offen offset:0 sc1
    ds_read_b64_tr_b16 v[32:33], v56 offset:61440
    ds_read_b64_tr_b16 v[34:35], v56 offset:61952
    v_mfma_f32_32x32x16_bf16 v[16:31], v[44:47], v[108:111], v[16:31]
    ds_read_b64_tr_b16 v[36:37], v57 offset:61440
    ds_read_b64_tr_b16 v[38:39], v57 offset:61952
    s_waitcnt vmcnt(7) lgkmcnt(4)
    v_mfma_f32_32x32x16_bf16 v[0:15], v[48:51], v[112:115], v[0:15]
    s_add_u32 s37, s37, 2048
    s_and_b32 s37, s37, 0x7800
    buffer_load_dwordx4 v[108:111], v253, s[20:23], s38 offen offset:1024 sc1
    ds_read_b64_tr_b16 v[40:41], v56 offset:63488
    ds_read_b64_tr_b16 v[42:43], v56 offset:64000
    v_mfma_f32_32x32x16_bf16 v[16:31], v[52:55], v[112:115], v[16:31]
    ds_read_b64_tr_b16 v[44:45], v57 offset:63488
    ds_read_b64_tr_b16 v[46:47], v57 offset:64000
    s_barrier
    s_waitcnt vmcnt(7) lgkmcnt(4)
    v_mfma_f32_32x32x16_bf16 v[0:15], v[32:35], v[116:119], v[0:15]
    s_add_u32 s38, s36, s37
    buffer_load_dwordx4 v[112:115], v253, s[20:23], s38 offen offset:0 sc1
    ds_read_b64_tr_b16 v[48:49], v58 offset:0
    ds_read_b64_tr_b16 v[50:51], v58 offset:512
    v_mfma_f32_32x32x16_bf16 v[16:31], v[36:39], v[116:119], v[16:31]
    ds_read_b64_tr_b16 v[52:53], v59 offset:0
    ds_read_b64_tr_b16 v[54:55], v59 offset:512
    s_waitcnt vmcnt(7) lgkmcnt(4)
    v_mfma_f32_32x32x16_bf16 v[0:15], v[40:43], v[120:123], v[0:15]
    s_add_u32 s37, s37, 2048
    s_and_b32 s37, s37, 0x7800
    buffer_load_dwordx4 v[116:119], v253, s[20:23], s38 offen offset:1024 sc1
    ds_read_b64_tr_b16 v[32:33], v58 offset:2048
    ds_read_b64_tr_b16 v[34:35], v58 offset:2560
    v_mfma_f32_32x32x16_bf16 v[16:31], v[44:47], v[120:123], v[16:31]
    ds_read_b64_tr_b16 v[36:37], v59 offset:2048
    ds_read_b64_tr_b16 v[38:39], v59 offset:2560
    s_waitcnt vmcnt(7) lgkmcnt(4)
    v_mfma_f32_32x32x16_bf16 v[0:15], v[48:51], v[124:127], v[0:15]
    s_add_u32 s38, s36, s37
    buffer_load_dwordx4 v[120:123], v253, s[20:23], s38 offen offset:0 sc1
    ds_read_b64_tr_b16 v[40:41], v58 offset:4096
    ds_read_b64_tr_b16 v[42:43], v58 offset:4608
    v_mfma_f32_32x32x16_bf16 v[16:31], v[52:55], v[124:127], v[16:31]
    ds_read_b64_tr_b16 v[44:45], v59 offset:4096
    ds_read_b64_tr_b16 v[46:47], v59 offset:4608
    s_waitcnt vmcnt(7) lgkmcnt(4)
    v_mfma_f32_32x32x16_bf16 v[0:15], v[32:35], v[128:131], v[0:15]
    s_add_u32 s37, s37, 2048
    s_and_b32 s37, s37, 0x7800
    buffer_load_dwordx4 v[124:127], v253, s[20:23], s38 offen offset:1024 sc1
    ds_read_b64_tr_b16 v[48:49], v58 offset:6144
    ds_read_b64_tr_b16 v[50:51], v58 offset:6656
    v_mfma_f32_32x32x16_bf16 v[16:31], v[36:39], v[128:131], v[16:31]
    ds_read_b64_tr_b16 v[52:53], v59 offset:6144
    ds_read_b64_tr_b16 v[54:55], v59 offset:6656
    s_waitcnt vmcnt(7) lgkmcnt(4)
    v_mfma_f32_32x32x16_bf16 v[0:15], v[40:43], v[132:135], v[0:15]
    s_add_u32 s38, s36, s37
    buffer_load_dwordx4 v[128:131], v253, s[20:23], s38 offen offset:0 sc1
    ds_read_b64_tr_b16 v[32:33], v58 offset:8192
    ds_read_b64_tr_b16 v[34:35], v58 offset:8704
    v_mfma_f32_32x32x16_bf16 v[16:31], v[44:47], v[132:135], v[16:31]
    ds_read_b64_tr_b16 v[36:37], v59 offset:8192
    ds_read_b64_tr_b16 v[38:39], v59 offset:8704
    s_waitcnt vmcnt(7) lgkmcnt(4)
    v_mfma_f32_32x32x16_bf16 v[0:15], v[48:51], v[136:139], v[0:15]
    s_add_u32 s37, s37, 2048
    s_and_b32 s37, s37, 0x7800
    buffer_load_dwordx4 v[132:135], v253, s[20:23], s38 offen offset:1024 sc1
    ds_read_b64_tr_b16 v[40:41], v58 offset:10240
    ds_read_b64_tr_b16 v[42:43], v58 offset:10752
    v_mfma_f32_32x32x16_bf16 v[16:31], v[52:55], v[136:139], v[16:31]
    ds_read_b64_tr_b16 v[44:45], v59 offset:10240
    ds_read_b64_tr_b16 v[46:47], v59 offset:10752
    s_waitcnt vmcnt(7) lgkmcnt(4)
    v_mfma_f32_32x32x16_bf16 v[0:15], v[32:35], v[104:107], v[0:15]
    s_add_u32 s38, s36, s37
    buffer_load_dwordx4 v[136:139], v253, s[20:23], s38 offen offset:0 sc1
    ds_read_b64_tr_b16 v[48:49], v58 offset:12288
    ds_read_b64_tr_b16 v[50:51], v58 offset:12800
    v_mfma_f32_32x32x16_bf16 v[16:31], v[36:39], v[104:107], v[16:31]
    ds_read_b64_tr_b16 v[52:53], v59 offset:12288
    ds_read_b64_tr_b16 v[54:55], v59 offset:12800
    s_waitcnt vmcnt(7) lgkmcnt(4)
    v_mfma_f32_32x32x16_bf16 v[0:15], v[40:43], v[108:111], v[0:15]
    s_add_u32 s37, s37, 2048
    s_and_b32 s37, s37, 0x7800
    buffer_load_dwordx4 v[104:107], v253, s[20:23], s38 offen offset:1024 sc1
    ds_read_b64_tr_b16 v[32:33], v58 offset:14336
    ds_read_b64_tr_b16 v[34:35], v58 offset:14848
    v_mfma_f32_32x32x16_bf16 v[16:31], v[44:47], v[108:111], v[16:31]
    ds_read_b64_tr_b16 v[36:37], v59 offset:14336
    ds_read_b64_tr_b16 v[38:39], v59 offset:14848
    s_waitcnt vmcnt(7) lgkmcnt(4)
    v_mfma_f32_32x32x16_bf16 v[0:15], v[48:51], v[112:115], v[0:15]
    s_add_u32 s38, s36, s37
    buffer_load_dwordx4 v[108:111], v253, s[20:23], s38 offen offset:0 sc1
    ds_read_b64_tr_b16 v[40:41], v58 offset:16384
    ds_read_b64_tr_b16 v[42:43], v58 offset:16896
    v_mfma_f32_32x32x16_bf16 v[16:31], v[52:55], v[112:115], v[16:31]
    ds_read_b64_tr_b16 v[44:45], v59 offset:16384
    ds_read_b64_tr_b16 v[46:47], v59 offset:16896
    s_waitcnt vmcnt(7) lgkmcnt(4)
    v_mfma_f32_32x32x16_bf16 v[0:15], v[32:35], v[116:119], v[0:15]
    s_add_u32 s37, s37, 2048
    s_and_b32 s37, s37, 0x7800
    buffer_load_dwordx4 v[112:115], v253, s[20:23], s38 offen offset:1024 sc1
    ds_read_b64_tr_b16 v[48:49], v58 offset:18432
    ds_read_b64_tr_b16 v[50:51], v58 offset:18944
    v_mfma_f32_32x32x16_bf16 v[16:31], v[36:39], v[116:119], v[16:31]
    ds_read_b64_tr_b16 v[52:53], v59 offset:18432
    ds_read_b64_tr_b16 v[54:55], v59 offset:18944
    s_waitcnt vmcnt(7) lgkmcnt(4)
    v_mfma_f32_32x32x16_bf16 v[0:15], v[40:43], v[120:123], v[0:15]
    s_add_u32 s38, s36, s37
    buffer_load_dwordx4 v[116:119], v253, s[20:23], s38 offen offset:0 sc1
    ds_read_b64_tr_b16 v[32:33], v58 offset:20480
    ds_read_b64_tr_b16 v[34:35], v58 offset:20992
    v_mfma_f32_32x32x16_bf16 v[16:31], v[44:47], v[120:123], v[16:31]
    ds_read_b64_tr_b16 v[36:37], v59 offset:20480
    ds_read_b64_tr_b16 v[38:39], v59 offset:20992
    s_waitcnt vmcnt(7) lgkmcnt(4)
    v_mfma_f32_32x32x16_bf16 v[0:15], v[48:51], v[124:127], v[0:15]
    s_add_u32 s37, s37, 2048
    s_and_b32 s37, s37, 0x7800
    buffer_load_dwordx4 v[120:123], v253, s[20:23], s38 offen offset:1024 sc1
    ds_read_b64_tr_b16 v[40:41], v58 offset:22528
    ds_read_b64_tr_b16 v[42:43], v58 offset:23040
    v_mfma_f32_32x32x16_bf16 v[16:31], v[52:55], v[124:127], v[16:31]
    ds_read_b64_tr_b16 v[44:45], v59 offset:22528
    ds_read_b64_tr_b16 v[46:47], v59 offset:23040
    s_waitcnt vmcnt(7) lgkmcnt(4)
    v_mfma_f32_32x32x16_bf16 v[0:15], v[32:35], v[128:131], v[0:15]
    s_add_u32 s38, s36, s37
    buffer_load_dwordx4 v[124:127], v253, s[20:23], s38 offen offset:0 sc1
    ds_read_b64_tr_b16 v[48:49], v58 offset:24576
    ds_read_b64_tr_b16 v[50:51], v58 offset:25088
    v_mfma_f32_32x32x16_bf16 v[16:31], v[36:39], v[128:131], v[16:31]
    ds_read_b64_tr_b16 v[52:53], v59 offset:24576
    ds_read_b64_tr_b16 v[54:55], v59 offset:25088
    s_waitcnt vmcnt(7) lgkmcnt(4)
    v_mfma_f32_32x32x16_bf16 v[0:15], v[40:43], v[132:135], v[0:15]
    s_add_u32 s37, s37, 2048
    s_and_b32 s37, s37, 0x7800
    buffer_load_dwordx4 v[128:131], v253, s[20:23], s38 offen offset:1024 sc1
    ds_read_b64_tr_b16 v[32:33], v58 offset:26624
    ds_read_b64_tr_b16 v[34:35], v58 offset:27136
    v_mfma_f32_32x32x16_bf16 v[16:31], v[44:47], v[132:135], v[16:31]
    ds_read_b64_tr_b16 v[36:37], v59 offset:26624
    ds_read_b64_tr_b16 v[38:39], v59 offset:27136
    s_waitcnt vmcnt(7) lgkmcnt(4)
    v_mfma_f32_32x32x16_bf16 v[0:15], v[48:51], v[136:139], v[0:15]
    s_add_u32 s38, s36, s37
    buffer_load_dwordx4 v[132:135], v253, s[20:23], s38 offen offset:0 sc1
    ds_read_b64_tr_b16 v[40:41], v58 offset:28672
    ds_read_b64_tr_b16 v[42:43], v58 offset:29184
    v_mfma_f32_32x32x16_bf16 v[16:31], v[52:55], v[136:139], v[16:31]
    ds_read_b64_tr_b16 v[44:45], v59 offset:28672
    ds_read_b64_tr_b16 v[46:47], v59 offset:29184
    s_waitcnt vmcnt(7) lgkmcnt(4)
    v_mfma_f32_32x32x16_bf16 v[0:15], v[32:35], v[104:107], v[0:15]
    s_add_u32 s37, s37, 2048
    s_and_b32 s37, s37, 0x7800
    buffer_load_dwordx4 v[136:139], v253, s[20:23], s38 offen offset:1024 sc1
    ds_read_b64_tr_b16 v[48:49], v58 offset:30720
    ds_read_b64_tr_b16 v[50:51], v58 offset:31232
    v_mfma_f32_32x32x16_bf16 v[16:31], v[36:39], v[104:107], v[16:31]
    ds_read_b64_tr_b16 v[52:53], v59 offset:30720
    ds_read_b64_tr_b16 v[54:55], v59 offset:31232
    s_waitcnt vmcnt(7) lgkmcnt(4)
    v_mfma_f32_32x32x16_bf16 v[0:15], v[40:43], v[108:111], v[0:15]
    s_add_u32 s38, s36, s37
    buffer_load_dwordx4 v[104:107], v253, s[20:23], s38 offen offset:0 sc1
    ds_read_b64_tr_b16 v[32:33], v58 offset:32768
    ds_read_b64_tr_b16 v[34:35], v58 offset:33280
    v_mfma_f32_32x32x16_bf16 v[16:31], v[44:47], v[108:111], v[16:31]
    ds_read_b64_tr_b16 v[36:37], v59 offset:32768
    ds_read_b64_tr_b16 v[38:39], v59 offset:33280
    s_waitcnt vmcnt(7) lgkmcnt(4)
    v_mfma_f32_32x32x16_bf16 v[0:15], v[48:51], v[112:115], v[0:15]
    s_add_u32 s37, s37, 2048
    s_and_b32 s37, s37, 0x7800
    buffer_load_dwordx4 v[108:111], v253, s[20:23], s38 offen offset:1024 sc1
    ds_read_b64_tr_b16 v[40:41], v58 offset:34816
    ds_read_b64_tr_b16 v[42:43], v58 offset:35328
    v_mfma_f32_32x32x16_bf16 v[16:31], v[52:55], v[112:115], v[16:31]
    ds_read_b64_tr_b16 v[44:45], v59 offset:34816
    ds_read_b64_tr_b16 v[46:47], v59 offset:35328
    s_waitcnt vmcnt(7) lgkmcnt(4)
    v_mfma_f32_32x32x16_bf16 v[0:15], v[32:35], v[116:119], v[0:15]
    s_add_u32 s38, s36, s37
    buffer_load_dwordx4 v[112:115], v253, s[20:23], s38 offen offset:0 sc1
    ds_read_b64_tr_b16 v[48:49], v58 offset:36864
    ds_read_b64_tr_b16 v[50:51], v58 offset:37376
    v_mfma_f32_32x32x16_bf16 v[16:31], v[36:39], v[116:119], v[16:31]
    ds_read_b64_tr_b16 v[52:53], v59 offset:36864
    ds_read_b64_tr_b16 v[54:55], v59 offset:37376
    s_waitcnt vmcnt(7) lgkmcnt(4)
    v_mfma_f32_32x32x16_bf16 v[0:15], v[40:43], v[120:123], v[0:15]
    s_add_u32 s37, s37, 2048
    s_and_b32 s37, s37, 0x7800
    buffer_load_dwordx4 v[116:119], v253, s[20:23], s38 offen offset:1024 sc1
    ds_read_b64_tr_b16 v[32:33], v58 offset:38912
    ds_read_b64_tr_b16 v[34:35], v58 offset:39424
    v_mfma_f32_32x32x16_bf16 v[16:31], v[44:47], v[120:123], v[16:31]
    ds_read_b64_tr_b16 v[36:37], v59 offset:38912
    ds_read_b64_tr_b16 v[38:39], v59 offset:39424
    s_waitcnt vmcnt(7) lgkmcnt(4)
    v_mfma_f32_32x32x16_bf16 v[0:15], v[48:51], v[124:127], v[0:15]
    s_add_u32 s38, s36, s37
    buffer_load_dwordx4 v[120:123], v253, s[20:23], s38 offen offset:0 sc1
    ds_read_b64_tr_b16 v[40:41], v58 offset:40960
    ds_read_b64_tr_b16 v[42:43], v58 offset:41472
    v_mfma_f32_32x32x16_bf16 v[16:31], v[52:55], v[124:127], v[16:31]
    ds_read_b64_tr_b16 v[44:45], v59 offset:40960
    ds_read_b64_tr_b16 v[46:47], v59 offset:41472
    s_waitcnt vmcnt(7) lgkmcnt(4)
    v_mfma_f32_32x32x16_bf16 v[0:15], v[32:35], v[128:131], v[0:15]
    s_add_u32 s37, s37, 2048
    s_and_b32 s37, s37, 0x7800
    buffer_load_dwordx4 v[124:127], v253, s[20:23], s38 offen offset:1024 sc1
    ds_read_b64_tr_b16 v[48:49], v58 offset:43008
    ds_read_b64_tr_b16 v[50:51], v58 offset:43520
    v_mfma_f32_32x32x16_bf16 v[16:31], v[36:39], v[128:131], v[16:31]
    ds_read_b64_tr_b16 v[52:53], v59 offset:43008
    ds_read_b64_tr_b16 v[54:55], v59 offset:43520
    s_waitcnt vmcnt(7) lgkmcnt(4)
    v_mfma_f32_32x32x16_bf16 v[0:15], v[40:43], v[132:135], v[0:15]
    s_add_u32 s38, s36, s37
    buffer_load_dwordx4 v[128:131], v253, s[20:23], s38 offen offset:0 sc1
    ds_read_b64_tr_b16 v[32:33], v58 offset:45056
    ds_read_b64_tr_b16 v[34:35], v58 offset:45568
    v_mfma_f32_32x32x16_bf16 v[16:31], v[44:47], v[132:135], v[16:31]
    ds_read_b64_tr_b16 v[36:37], v59 offset:45056
    ds_read_b64_tr_b16 v[38:39], v59 offset:45568
    s_waitcnt vmcnt(7) lgkmcnt(4)
    v_mfma_f32_32x32x16_bf16 v[0:15], v[48:51], v[136:139], v[0:15]
    s_add_u32 s37, s37, 2048
    s_and_b32 s37, s37, 0x7800
    buffer_load_dwordx4 v[132:135], v253, s[20:23], s38 offen offset:1024 sc1
    ds_read_b64_tr_b16 v[40:41], v58 offset:47104
    ds_read_b64_tr_b16 v[42:43], v58 offset:47616
    v_mfma_f32_32x32x16_bf16 v[16:31], v[52:55], v[136:139], v[16:31]
    ds_read_b64_tr_b16 v[44:45], v59 offset:47104
    ds_read_b64_tr_b16 v[46:47], v59 offset:47616
    s_barrier
    s_waitcnt vmcnt(7) lgkmcnt(4)
    v_mfma_f32_32x32x16_bf16 v[0:15], v[32:35], v[104:107], v[0:15]
    s_add_u32 s38, s36, s37
    buffer_load_dwordx4 v[136:139], v253, s[20:23], s38 offen offset:0 sc1
    ds_read_b64_tr_b16 v[48:49], v58 offset:49152
    ds_read_b64_tr_b16 v[50:51], v58 offset:49664
    v_mfma_f32_32x32x16_bf16 v[16:31], v[36:39], v[104:107], v[16:31]
    ds_read_b64_tr_b16 v[52:53], v59 offset:49152
    ds_read_b64_tr_b16 v[54:55], v59 offset:49664
    s_waitcnt vmcnt(7) lgkmcnt(4)
    v_mfma_f32_32x32x16_bf16 v[0:15], v[40:43], v[108:111], v[0:15]
    s_add_u32 s37, s37, 2048
    s_and_b32 s37, s37, 0x7800
    buffer_load_dwordx4 v[104:107], v253, s[20:23], s38 offen offset:1024 sc1
    ds_read_b64_tr_b16 v[32:33], v58 offset:51200
    ds_read_b64_tr_b16 v[34:35], v58 offset:51712
    v_mfma_f32_32x32x16_bf16 v[16:31], v[44:47], v[108:111], v[16:31]
    ds_read_b64_tr_b16 v[36:37], v59 offset:51200
    ds_read_b64_tr_b16 v[38:39], v59 offset:51712
    s_waitcnt vmcnt(7) lgkmcnt(4)
    v_mfma_f32_32x32x16_bf16 v[0:15], v[48:51], v[112:115], v[0:15]
    ds_read_b64_tr_b16 v[40:41], v58 offset:53248
    ds_read_b64_tr_b16 v[42:43], v58 offset:53760
    v_mfma_f32_32x32x16_bf16 v[16:31], v[52:55], v[112:115], v[16:31]
    ds_read_b64_tr_b16 v[44:45], v59 offset:53248
    ds_read_b64_tr_b16 v[46:47], v59 offset:53760
    s_waitcnt vmcnt(6) lgkmcnt(4)
    v_mfma_f32_32x32x16_bf16 v[0:15], v[32:35], v[116:119], v[0:15]
    ds_read_b64_tr_b16 v[48:49], v58 offset:55296
    ds_read_b64_tr_b16 v[50:51], v58 offset:55808
    v_mfma_f32_32x32x16_bf16 v[16:31], v[36:39], v[116:119], v[16:31]
    ds_read_b64_tr_b16 v[52:53], v59 offset:55296
    ds_read_b64_tr_b16 v[54:55], v59 offset:55808
    s_waitcnt vmcnt(5) lgkmcnt(4)
    v_mfma_f32_32x32x16_bf16 v[0:15], v[40:43], v[120:123], v[0:15]
    ds_read_b64_tr_b16 v[32:33], v58 offset:57344
    ds_read_b64_tr_b16 v[34:35], v58 offset:57856
    v_mfma_f32_32x32x16_bf16 v[16:31], v[44:47], v[120:123], v[16:31]
    ds_read_b64_tr_b16 v[36:37], v59 offset:57344
    ds_read_b64_tr_b16 v[38:39], v59 offset:57856
    s_waitcnt vmcnt(4) lgkmcnt(4)
    v_mfma_f32_32x32x16_bf16 v[0:15], v[48:51], v[124:127], v[0:15]
    ds_read_b64_tr_b16 v[40:41], v58 offset:59392
    ds_read_b64_tr_b16 v[42:43], v58 offset:59904
    v_mfma_f32_32x32x16_bf16 v[16:31], v[52:55], v[124:127], v[16:31]
    ds_read_b64_tr_b16 v[44:45], v59 offset:59392
    ds_read_b64_tr_b16 v[46:47], v59 offset:59904
    s_waitcnt vmcnt(3) lgkmcnt(4)
    v_mfma_f32_32x32x16_bf16 v[0:15], v[32:35], v[128:131], v[0:15]
    ds_read_b64_tr_b16 v[48:49], v58 offset:61440
    ds_read_b64_tr_b16 v[50:51], v58 offset:61952
    v_mfma_f32_32x32x16_bf16 v[16:31], v[36:39], v[128:131], v[16:31]
    ds_read_b64_tr_b16 v[52:53], v59 offset:61440
    ds_read_b64_tr_b16 v[54:55], v59 offset:61952
    s_waitcnt vmcnt(2) lgkmcnt(4)
    v_mfma_f32_32x32x16_bf16 v[0:15], v[40:43], v[132:135], v[0:15]
    ds_read_b64_tr_b16 v[32:33], v58 offset:63488
    ds_read_b64_tr_b16 v[34:35], v58 offset:64000
    v_mfma_f32_32x32x16_bf16 v[16:31], v[44:47], v[132:135], v[16:31]
    ds_read_b64_tr_b16 v[36:37], v59 offset:63488
    ds_read_b64_tr_b16 v[38:39], v59 offset:64000
    s_waitcnt vmcnt(1) lgkmcnt(4)
    v_mfma_f32_32x32x16_bf16 v[0:15], v[48:51], v[136:139], v[0:15]
    v_mfma_f32_32x32x16_bf16 v[16:31], v[52:55], v[136:139], v[16:31]
    s_waitcnt vmcnt(0) lgkmcnt(0)
    v_mfma_f32_32x32x16_bf16 v[0:15], v[32:35], v[104:107], v[0:15]
    v_mfma_f32_32x32x16_bf16 v[16:31], v[36:39], v[104:107], v[16:31]
    s_lshl_b32 s35, s24, 4
    s_add_u32 s35, s35, s98
    s_lshl_b32 s35, s35, 14
    s_lshl_b32 s34, s3, 12
    s_add_u32 s35, s35, s34
    s_add_u32 s35, s35, 0x2000000
    s_lshl_b32 s30, s99, 13
    s_add_u32 s30, s30, s26
    s_add_u32 s30, s30, 0xc00000
    s_lshl_b32 s31, s98, 9
    s_add_u32 s31, s31, s30
    v_mov_b32 v96, 0
    v_mov_b32 v97, 0
    v_mov_b32 v98, 0
    v_mov_b32 v99, v242
    v_cvt_pk_bf16_f32 v208, v0, v1
    v_cvt_pk_bf16_f32 v209, v2, v3
    v_cvt_pk_bf16_f32 v210, v4, v5
    v_cvt_pk_bf16_f32 v211, v6, v7
    v_cvt_pk_bf16_f32 v212, v8, v9
    v_cvt_pk_bf16_f32 v213, v10, v11
    v_cvt_pk_bf16_f32 v214, v12, v13
    v_cvt_pk_bf16_f32 v215, v14, v15
    v_cvt_pk_bf16_f32 v216, v16, v17
    v_cvt_pk_bf16_f32 v217, v18, v19
    v_cvt_pk_bf16_f32 v218, v20, v21
    v_cvt_pk_bf16_f32 v219, v22, v23
    v_cvt_pk_bf16_f32 v220, v24, v25
    v_cvt_pk_bf16_f32 v221, v26, v27
    v_cvt_pk_bf16_f32 v222, v28, v29
    v_cvt_pk_bf16_f32 v223, v30, v31
    s_cmp_lg_u32 s26, 0
    s_cbranch_scc1 sk_32
    s_cmp_lg_u32 s77, 0
    s_cbranch_scc1 lc_33
    buffer_store_dwordx4 v[208:211], v100, s[20:23], s35 offen offset:0 sc1
    buffer_store_dwordx4 v[212:215], v100, s[20:23], s35 offen offset:512 sc1
    buffer_store_dwordx4 v[216:219], v100, s[20:23], s35 offen offset:1024 sc1
    buffer_store_dwordx4 v[220:223], v100, s[20:23], s35 offen offset:1536 sc1
    s_branch lc_34
lc_33:
    buffer_store_dwordx4 v[208:211], v100, s[20:23], s35 offen offset:0
    buffer_store_dwordx4 v[212:215], v100, s[20:23], s35 offen offset:512
    buffer_store_dwordx4 v[216:219], v100, s[20:23], s35 offen offset:1024
    buffer_store_dwordx4 v[220:223], v100, s[20:23], s35 offen offset:1536
lc_34:
    ds_write_b128 v101, v[208:211] offset:0
    ds_write_b128 v101, v[212:215] offset:512
    ds_write_b128 v101, v[216:219] offset:1024
    ds_write_b128 v101, v[220:223] offset:1536
sk_32:
    v_dot2c_f32_bf16 v96, 0x3f803f80, v208
    v_dot2c_f32_bf16 v97, v208, v208
    v_dot2c_f32_bf16 v98, v224, v208
    v_dot2c_f32_bf16 v96, 0x3f803f80, v209
    v_dot2c_f32_bf16 v97, v209, v209
    v_dot2c_f32_bf16 v98, v225, v209
    v_dot2c_f32_bf16 v96, 0x3f803f80, v210
    v_dot2c_f32_bf16 v97, v210, v210
    v_dot2c_f32_bf16 v98, v226, v210
    v_dot2c_f32_bf16 v96, 0x3f803f80, v211
    v_dot2c_f32_bf16 v97, v211, v211
    v_dot2c_f32_bf16 v98, v227, v211
    v_dot2c_f32_bf16 v96, 0x3f803f80, v212
    v_dot2c_f32_bf16 v97, v212, v212
    v_dot2c_f32_bf16 v98, v228, v212
    v_dot2c_f32_bf16 v96, 0x3f803f80, v213
    v_dot2c_f32_bf16 v97, v213, v213
    v_dot2c_f32_bf16 v98, v229, v213
    v_dot2c_f32_bf16 v96, 0x3f803f80, v214
    v_dot2c_f32_bf16 v97, v214, v214
    v_dot2c_f32_bf16 v98, v230, v214
    v_dot2c_f32_bf16 v96, 0x3f803f80, v215
    v_dot2c_f32_bf16 v97, v215, v215
    v_dot2c_f32_bf16 v98, v231, v215
    v_dot2c_f32_bf16 v96, 0x3f803f80, v216
    v_dot2c_f32_bf16 v97, v216, v216
    v_dot2c_f32_bf16 v98, v232, v216
    v_dot2c_f32_bf16 v96, 0x3f803f80, v217
    v_dot2c_f32_bf16 v97, v217, v217
    v_dot2c_f32_bf16 v98, v233, v217
    v_dot2c_f32_bf16 v96, 0x3f803f80, v218
    v_dot2c_f32_bf16 v97, v218, v218
    v_dot2c_f32_bf16 v98, v234, v218
    v_dot2c_f32_bf16 v96, 0x3f803f80, v219
    v_dot2c_f32_bf16 v97, v219, v219
    v_dot2c_f32_bf16 v98, v235, v219
    v_dot2c_f32_bf16 v96, 0x3f803f80, v220
    v_dot2c_f32_bf16 v97, v220, v220
    v_dot2c_f32_bf16 v98, v236, v220
    v_dot2c_f32_bf16 v96, 0x3f803f80, v221
    v_dot2c_f32_bf16 v97, v221, v221
    v_dot2c_f32_bf16 v98, v237, v221
    v_dot2c_f32_bf16 v96, 0x3f803f80, v222
    v_dot2c_f32_bf16 v97, v222, v222
    v_dot2c_f32_bf16 v98, v238, v222
    v_dot2c_f32_bf16 v96, 0x3f803f80, v223
    v_dot2c_f32_bf16 v97, v223, v223
    v_dot2c_f32_bf16 v98, v239, v223
    s_nop 0
    v_mov_b32 v48, v96
    v_mov_b32 v49, v97
    v_mov_b32 v50, v98
    v_mov_b32 v51, v99
    v_permlane32_swap_b32 v96, v48
    v_permlane32_swap_b32 v97, v49
    v_permlane32_swap_b32 v98, v50
    v_permlane32_swap_b32 v99, v51
    v_add_f32 v96, v96, v48
    v_add_f32 v97, v97, v49
    v_add_f32 v98, v98, v50
    v_add_f32 v99, v99, v51
    s_mov_b32 exec_hi, 0
    s_waitcnt vmcnt(0)
    s_cmp_lg_u32 s77, 0
    s_cbranch_scc1 lc_35
    buffer_store_dwordx4 v[96:99], v253, s[20:23], s31 offen sc1
    s_branch lc_36
lc_35:
    buffer_store_dwordx4 v[96:99], v253, s[20:23], s31 offen
lc_36:
    s_mov_b64 exec, -1
    s_cmp_lg_u32 s26, 0
    s_cbranch_scc1 e_final
    s_mov_b32 s26, 16777216
    s_and_b32 s30, s3, 1
    s_lshl_b32 s30, s30, 13
    v_add_u32 v176, s30, v253
    v_add_u32 v177, 1024, v176
    s_lshr_b32 s30, s16, 7
    s_sub_u32 s30, 3, s30
    s_and_b32 s30, s30, 7
    s_and_b32 s31, s24, 1
    s_lshl_b32 s31, s31, 3
    s_add_u32 s30, s30, s31
    s_and_b32 s31, s24, 14
    s_add_u32 s84, s31, s30
    s_lshl_b32 s31, s25, 2
    s_add_u32 s31, s31, s28
    s_mul_i32 s31, s31, 6144
    s_lshl_b32 s30, s30, 7
    s_add_u32 s30, s30, s31
    v_min_u32 v190, 2, v252
    v_lshl_add_u32 v190, v190, 11, s30
    s_add_u32 s84, s84, 14
    v_mov_b32 v0, 0
    v_mov_b32 v1, 0
    v_mov_b32 v2, 0
    v_mov_b32 v3, 0
    v_mov_b32 v4, 0
    v_mov_b32 v5, 0
    v_mov_b32 v6, 0
    v_mov_b32 v7, 0
    v_mov_b32 v8, 0
    v_mov_b32 v9, 0
    v_mov_b32 v10, 0
    v_mov_b32 v11, 0
    v_mov_b32 v12, 0
    v_mov_b32 v13, 0
    v_mov_b32 v14, 0
    v_mov_b32 v15, 0
    v_mov_b32 v16, 0
    v_mov_b32 v17, 0
    v_mov_b32 v18, 0
    v_mov_b32 v19, 0
    v_mov_b32 v20, 0
    v_mov_b32 v21, 0
    v_mov_b32 v22, 0
    v_mov_b32 v23, 0
    v_mov_b32 v24, 0
    v_mov_b32 v25, 0
    v_mov_b32 v26, 0
    v_mov_b32 v27, 0
    v_mov_b32 v28, 0
    v_mov_b32 v29, 0
    v_mov_b32 v30, 0
    v_mov_b32 v31, 0
    v_mov_b32 v32, 0
    v_mov_b32 v33, 0
    v_mov_b32 v34, 0
    v_mov_b32 v35, 0
    v_mov_b32 v36, 0
    v_mov_b32 v37, 0
    v_mov_b32 v38, 0
    v_mov_b32 v39, 0
    v_mov_b32 v40, 0
    v_mov_b32 v41, 0
    v_mov_b32 v42, 0
    v_mov_b32 v43, 0
    v_mov_b32 v44, 0
    v_mov_b32 v45, 0
    v_mov_b32 v46, 0
    v_mov_b32 v47, 0
    v_mov_b32 v48, 0
    v_mov_b32 v49, 0
    v_mov_b32 v50, 0
    v_mov_b32 v51, 0
    v_mov_b32 v52, 0
    v_mov_b32 v53, 0
    v_mov_b32 v54, 0
    v_mov_b32 v55, 0
    v_mov_b32 v56, 0
    v_mov_b32 v57, 0
    v_mov_b32 v58, 0
    v_mov_b32 v59, 0
    v_mov_b32 v60, 0
    v_mov_b32 v61, 0
    v_mov_b32 v62, 0
    v_mov_b32 v63, 0
    v_mov_b32 v64, 0
    v_mov_b32 v65, 0
    v_mov_b32 v66, 0
    v_mov_b32 v67, 0
    v_mov_b32 v68, 0
    v_mov_b32 v69, 0
    v_mov_b32 v70, 0
    v_mov_b32 v71, 0
    v_mov_b32 v72, 0
    v_mov_b32 v73, 0
    v_mov_b32 v74, 0
    v_mov_b32 v75, 0
    v_mov_b32 v76, 0
    v_mov_b32 v77, 0
    v_mov_b32 v78, 0
    v_mov_b32 v79, 0
    v_mov_b32 v80, 0
    v_mov_b32 v81, 0
    v_mov_b32 v82, 0
    v_mov_b32 v83, 0
    v_mov_b32 v84, 0
    v_mov_b32 v85, 0
    v_mov_b32 v86, 0
    v_mov_b32 v87, 0
    v_mov_b32 v88, 0
    v_mov_b32 v89, 0
    v_mov_b32 v90, 0
    v_mov_b32 v91, 0
    v_mov_b32 v92, 0
    v_mov_b32 v93, 0
    v_mov_b32 v94, 0
    v_mov_b32 v95, 0
    s_waitcnt lgkmcnt(0)
    s_branch e_q
e_arr:
    s_mov_b64 exec, 3
    s_mov_b32 s89, 0xdd9000
    buffer_store_dwordx2 v[250:251], v249, s[20:23], s89 offen sc1
    s_mov_b64 exec, -1
    s_branch e_arr_ret
e_final:
    s_mov_b32 s78, s27
pl_37:
    s_lshl_b32 s30, s99, 13
    s_add_u32 s30, s30, 0x1c00000
    s_add_u32 s31, s30, 4096
    buffer_load_dwordx4 v[64:67], v253, s[20:23], s30 offen offset:0 sc1
    buffer_load_dwordx4 v[68:71], v253, s[20:23], s30 offen offset:1024 sc1
    buffer_load_dwordx4 v[72:75], v253, s[20:23], s30 offen offset:2048 sc1
    buffer_load_dwordx4 v[76:79], v253, s[20:23], s30 offen offset:3072 sc1
    buffer_load_dwordx4 v[80:83], v253, s[20:23], s31 offen offset:0 sc1
    buffer_load_dwordx4 v[84:87], v253, s[20:23], s31 offen offset:1024 sc1
    buffer_load_dwordx4 v[88:91], v253, s[20:23], s31 offen offset:2048 sc1
    buffer_load_dwordx4 v[92:95], v253, s[20:23], s31 offen offset:3072 sc1
    s_waitcnt vmcnt(0)
pc_38:
    v_max3_u32 v48, v64, v68, v72
    v_max3_u32 v48, v48, v76, v80
    v_max3_u32 v48, v48, v84, v88
    v_max_u32 v48, v48, v92
    v_cmp_eq_u32 vcc, -1, v48
    s_cbranch_vccz pd_39
    s_sub_u32 s78, s78, 1
    s_cmp_lg_u32 s78, 0
    s_cbranch_scc1 pl_37
    s_mov_b32 s27, 1
pd_39:
    v_pk_add_f32 v[64:65], v[64:65], v[68:69]
    v_pk_add_f32 v[66:67], v[66:67], v[70:71]
    v_pk_add_f32 v[64:65], v[64:65], v[72:73]
    v_pk_add_f32 v[66:67], v[66:67], v[74:75]
    v_pk_add_f32 v[64:65], v[64:65], v[76:77]
    v_pk_add_f32 v[66:67], v[66:67], v[78:79]
    v_pk_add_f32 v[64:65], v[64:65], v[80:81]
    v_pk_add_f32 v[66:67], v[66:67], v[82:83]
    v_pk_add_f32 v[64:65], v[64:65], v[84:85]
    v_pk_add_f32 v[66:67], v[66:67], v[86:87]
    v_pk_add_f32 v[64:65], v[64:65], v[88:89]
    v_pk_add_f32 v[66:67], v[66:67], v[90:91]
    v_pk_add_f32 v[64:65], v[64:65], v[92:93]
    v_pk_add_f32 v[66:67], v[66:67], v[94:95]
    v_mov_b32 v48, v64
    v_mov_b32 v49, v65
    v_mov_b32 v50, v66
    v_mov_b32 v51, v67
    v_permlane32_swap_b32 v64, v48
    v_permlane32_swap_b32 v65, v49
    v_permlane32_swap_b32 v66, v50
    v_permlane32_swap_b32 v67, v51
    v_add_f32 v64, v64, v48
    v_add_f32 v65, v65, v49
    v_add_f32 v66, v66, v50
    v_add_f32 v67, v67, v51
    v_mul_f32 v54, 0x3a800000, v64
    v_mul_f32 v65, 0x3a800000, v65
    v_fma_f32 v65, -v54, v54, v65
    v_max_f32 v65, 0, v65
    v_add_f32 v55, 0x3727c5ac, v65
    v_rsq_f32 v55, v55
    v_fma_f32 v52, -v54, v67, v66
    v_and_b32 v53, 31, v252
    v_mul_f32 v52, v52, v55
    s_lshl_b32 s32, s99, 5
    v_add_u32 v53, s32, v53
    v_mov_b32 v48, v52
    s_nop 1
    v_max_f32_dpp v48, v48, v48 quad_perm:[1,0,3,2] row_mask:0xf bank_mask:0xf
    s_nop 1
    v_max_f32_dpp v48, v48, v48 quad_perm:[2,3,0,1] row_mask:0xf bank_mask:0xf
    s_nop 1
    v_max_f32_dpp v48, v48, v48 row_half_mirror row_mask:0xf bank_mask:0xf
    s_nop 1
    v_max_f32_dpp v48, v48, v48 row_mirror row_mask:0xf bank_mask:0xf
    v_mov_b32 v49, v48
    s_nop 1
    v_permlane16_swap_b32 v48, v49
    v_max_f32 v48, v48, v49
    v_cmp_eq_f32 vcc, v48, v52
    v_lshrrev_b32 v50, 5, v252
    v_lshlrev_b32 v50, 4, v50
    s_lshl_b32 s32, s99, 11
    s_lshl_b32 s33, s98, 7
    s_add_u32 s32, s32, s33
    s_add_u32 s32, s32, 0x1d60000
    s_lshl_b32 s34, s99, 4
    s_add_u32 s34, s34, 0x1dc0000
    s_ff1_i32_b32 s35, vcc_lo
    s_lshl_b32 s35, 1, s35
    s_cmp_eq_u32 s25, 0
    s_cselect_b32 exec_lo, s35, 0
    s_mov_b32 exec_hi, 0
    buffer_store_dwordx4 v[52:55], v50, s[20:23], s34 offen sc1
    s_mov_b32 exec_lo, s35
    s_mov_b32 exec_hi, s35
    buffer_store_dwordx4 v[208:211], v50, s[20:23], s32 offen offset:0 sc1
    buffer_store_dwordx4 v[212:215], v50, s[20:23], s32 offen offset:32 sc1
    buffer_store_dwordx4 v[216:219], v50, s[20:23], s32 offen offset:64 sc1
    buffer_store_dwordx4 v[220:223], v50, s[20:23], s32 offen offset:96 sc1
    s_mov_b64 exec, -1
    v_add_f32 v240, 1.0, v55
    v_mul_f32 v241, v54, v55
    v_sub_f32 v241, 0, v241
    v_pk_fma_f32 v[0:1], v[0:1], v[240:241], v[240:241] op_sel:[0,0,1] op_sel_hi:[1,0,1]
    v_pk_fma_f32 v[2:3], v[2:3], v[240:241], v[240:241] op_sel:[0,0,1] op_sel_hi:[1,0,1]
    v_pk_fma_f32 v[4:5], v[4:5], v[240:241], v[240:241] op_sel:[0,0,1] op_sel_hi:[1,0,1]
    v_pk_fma_f32 v[6:7], v[6:7], v[240:241], v[240:241] op_sel:[0,0,1] op_sel_hi:[1,0,1]
    v_pk_fma_f32 v[8:9], v[8:9], v[240:241], v[240:241] op_sel:[0,0,1] op_sel_hi:[1,0,1]
    v_pk_fma_f32 v[10:11], v[10:11], v[240:241], v[240:241] op_sel:[0,0,1] op_sel_hi:[1,0,1]
    v_pk_fma_f32 v[12:13], v[12:13], v[240:241], v[240:241] op_sel:[0,0,1] op_sel_hi:[1,0,1]
    v_pk_fma_f32 v[14:15], v[14:15], v[240:241], v[240:241] op_sel:[0,0,1] op_sel_hi:[1,0,1]
    v_pk_fma_f32 v[16:17], v[16:17], v[240:241], v[240:241] op_sel:[0,0,1] op_sel_hi:[1,0,1]
    v_pk_fma_f32 v[18:19], v[18:19], v[240:241], v[240:241] op_sel:[0,0,1] op_sel_hi:[1,0,1]
    v_pk_fma_f32 v[20:21], v[20:21], v[240:241], v[240:241] op_sel:[0,0,1] op_sel_hi:[1,0,1]
    v_pk_fma_f32 v[22:23], v[22:23], v[240:241], v[240:241] op_sel:[0,0,1] op_sel_hi:[1,0,1]
    v_pk_fma_f32 v[24:25], v[24:25], v[240:241], v[240:241] op_sel:[0,0,1] op_sel_hi:[1,0,1]
    v_pk_fma_f32 v[26:27], v[26:27], v[240:241], v[240:241] op_sel:[0,0,1] op_sel_hi:[1,0,1]
    v_pk_fma_f32 v[28:29], v[28:29], v[240:241], v[240:241] op_sel:[0,0,1] op_sel_hi:[1,0,1]
    v_pk_fma_f32 v[30:31], v[30:31], v[240:241], v[240:241] op_sel:[0,0,1] op_sel_hi:[1,0,1]
    v_cvt_pk_bf16_f32 v64, v0, v1
    v_cvt_pk_bf16_f32 v65, v2, v3
    v_cvt_pk_bf16_f32 v66, v4, v5
    v_cvt_pk_bf16_f32 v67, v6, v7
    v_cvt_pk_bf16_f32 v68, v8, v9
    v_cvt_pk_bf16_f32 v69, v10, v11
    v_cvt_pk_bf16_f32 v70, v12, v13
    v_cvt_pk_bf16_f32 v71, v14, v15
    v_cvt_pk_bf16_f32 v72, v16, v17
    v_cvt_pk_bf16_f32 v73, v18, v19
    v_cvt_pk_bf16_f32 v74, v20, v21
    v_cvt_pk_bf16_f32 v75, v22, v23
    v_cvt_pk_bf16_f32 v76, v24, v25
    v_cvt_pk_bf16_f32 v77, v26, v27
    v_cvt_pk_bf16_f32 v78, v28, v29
    v_cvt_pk_bf16_f32 v79, v30, v31
    v_permlane32_swap_b32 v64, v66
    v_permlane32_swap_b32 v65, v67
    v_permlane32_swap_b32 v68, v70
    v_permlane32_swap_b32 v69, v71
    v_permlane32_swap_b32 v72, v74
    v_permlane32_swap_b32 v73, v75
    v_permlane32_swap_b32 v76, v78
    v_permlane32_swap_b32 v77, v79
    v_lshl_add_u32 v50, v53, 11, v50
    s_mov_b32 s79, s26
    s_cmp_lg_u32 s3, 0
    s_cbranch_scc1 sk_41
    s_mov_b32 s78, s27
pl_42:
    s_add_u32 s32, s79, 0xdc0000
    buffer_load_dwordx4 v[0:3], v253, s[20:23], s32 offen sc1
    s_waitcnt vmcnt(0)
pc_43:
    v_max3_u32 v4, v0, v1, v2
    v_max_u32 v4, v4, v3
    v_cmp_eq_u32 vcc, -1, v4
    s_cbranch_vccz pd_44
    s_sub_u32 s78, s78, 1
    s_cmp_lg_u32 s78, 0
    s_cbranch_scc1 pl_42
    s_mov_b32 s27, 1
pd_44:
    v_mov_b32 v4, v0
    s_nop 1
    v_max_f32_dpp v4, v4, v4 quad_perm:[1,0,3,2] row_mask:0xf bank_mask:0xf
    s_nop 1
    v_max_f32_dpp v4, v4, v4 quad_perm:[2,3,0,1] row_mask:0xf bank_mask:0xf
    s_nop 1
    v_max_f32_dpp v4, v4, v4 row_half_mirror row_mask:0xf bank_mask:0xf
    s_nop 1
    v_max_f32_dpp v4, v4, v4 row_mirror row_mask:0xf bank_mask:0xf
    v_mov_b32 v5, v4
    s_nop 1
    v_permlane16_swap_b32 v4, v5
    v_max_f32 v4, v4, v5
    v_mov_b32 v5, v4
    s_nop 1
    v_permlane32_swap_b32 v4, v5
    v_max_f32 v4, v4, v5
    v_cmp_eq_f32 vcc, v4, v0
    s_ff1_i32_b64 s32, vcc
    s_and_b32 s32, s32, 63
    s_lshl_b64 exec, 1, s32
    ds_write_b128 v189, v[0:3] offset:3072
    s_mov_b64 exec, -1
sk_41:
    s_waitcnt lgkmcnt(0)
    s_barrier
    ds_read_b32 v0, v189 offset:3076
    s_waitcnt lgkmcnt(0)
    v_and_b32 v0, 0x7ff, v0
    v_cmp_ne_u32 vcc, v0, v53
    s_mov_b64 exec, vcc
    buffer_store_dwordx4 v[64:67], v50, s[12:15], s33 offen offset:0
    buffer_store_dwordx4 v[68:71], v50, s[12:15], s33 offen offset:32
    buffer_store_dwordx4 v[72:75], v50, s[12:15], s33 offen offset:64
    buffer_store_dwordx4 v[76:79], v50, s[12:15], s33 offen offset:96
    s_mov_b64 exec, -1
    s_branch k_end
l_start:
    v_lshrrev_b32 v21, 3, v252
    v_lshrrev_b32 v20, 4, v252
    v_xor_b32 v20, v20, v252
    v_and_b32 v20, 7, v20
    v_lshlrev_b32 v20, 4, v20
    v_lshl_add_u32 v4, v21, 11, v20
    v_xor_b32 v5, 64, v4
    v_add_u32 v5, 15360, v5
    v_add_u32 v6, 30720, v4
    v_add_u32 v7, 30720, v5
    s_lshl_b32 s84, s99, 16
    s_lshl_b32 s85, s25, 7
    s_lshl_b32 s86, s28, 12
    s_mul_i32 s87, s28, 6144
    v_and_b32 v20, 4, v21
    v_add_u32 v20, v20, v21
    v_mul_u32_u24 v20, 6144, v20
    v_and_b32 v21, 6, v21
    v_xor_b32 v21, v21, v252
    v_and_b32 v21, 7, v21
    v_lshl_add_u32 v20, v21, 4, v20
    s_mul_i32 s32, s28, 3
    s_bfe_u32 s33, s32, 0x10001
    s_mul_i32 s33, s33, 196608
    s_and_b32 s34, s32, 1
    s_mul_i32 s34, s34, 24576
    s_add_u32 s33, s33, s34
    s_lshr_b32 s34, s32, 2
    s_lshl_b32 s34, s34, 11
    s_add_u32 s33, s33, s34
    v_add_u32 v8, s33, v20
    v_add_u32 v9, 97280, v8
    s_add_u32 s32, s32, 1
    s_bfe_u32 s33, s32, 0x10001
    s_mul_i32 s33, s33, 196608
    s_and_b32 s34, s32, 1
    s_mul_i32 s34, s34, 24576
    s_add_u32 s33, s33, s34
    s_lshr_b32 s34, s32, 2
    s_lshl_b32 s34, s34, 11
    s_add_u32 s33, s33, s34
    s_sub_u32 s33, s33, 2048
    v_add_u32 v10, s33, v20
    v_add_u32 v11, 97280, v10
    s_add_u32 s32, s32, 1
    s_bfe_u32 s33, s32, 0x10001
    s_mul_i32 s33, s33, 196608
    s_and_b32 s34, s32, 1
    s_mul_i32 s34, s34, 24576
    s_add_u32 s33, s33, s34
    s_lshr_b32 s34, s32, 2
    s_lshl_b32 s34, s34, 11
    s_add_u32 s33, s33, s34
    v_add_u32 v12, s33, v20
    v_add_u32 v13, 97280, v12
    s_waitcnt lgkmcnt(0)
    s_mov_b32 s88, 0xdd8000
    s_load_dword s88, s[20:21], s88
    s_mov_b64 s[16:17], s[6:7]
    s_mov_b32 s6, 0x400000
    s_mov_b32 s7, 0x20000
    s_add_u32 s96, s94, 0
    s_and_b32 s96, s96, 15
    s_lshl_b32 s97, s96, 7
    s_add_u32 s97, s97, s84
    s_add_u32 m0, s86, 147456
    s_nop 0
    buffer_load_dwordx4 v4, s[4:7], s97 offen offset:0 lds
    buffer_load_dwordx4 v5, s[4:7], s97 offen offset:1024 lds
    buffer_load_dwordx4 v6, s[4:7], s97 offen offset:2048 lds
    buffer_load_dwordx4 v7, s[4:7], s97 offen offset:3072 lds
    s_add_u32 s96, s94, 0
    s_and_b32 s96, s96, 15
    s_mul_i32 s96, s96, 393216
    s_add_u32 s96, s96, s85
    s_add_u32 m0, s87, 40960
    s_nop 0
    buffer_load_dwordx4 v8, s[16:19], s96 offen offset:0 lds
    buffer_load_dwordx4 v9, s[16:19], s96 offen offset:1024 lds
    buffer_load_dwordx4 v10, s[16:19], s96 offen offset:2048 lds
    buffer_load_dwordx4 v11, s[16:19], s96 offen offset:3072 lds
    s_mov_b32 s40, 0xffffffff
    s_mov_b32 s41, 0xfffffff0
    s_mov_b32 s42, 0xfffffffe
    s_mov_b32 s43, 0xffffffe0
    s_mov_b32 s44, 0xfffffffc
    s_mov_b32 s45, 0xffffffc0
    s_mov_b32 s46, 0xfffffff8
    s_mov_b32 s47, 0xffffff80
    s_mov_b32 s48, 0xffff0000
    s_mov_b32 s49, 0xfff00000
    s_mov_b32 s50, 0xfffe0000
    s_mov_b32 s51, 0xffe00000
    s_mov_b32 s52, 0xfffc0000
    s_mov_b32 s53, 0xffc00000
    s_mov_b32 s54, 0xfff80000
    s_mov_b32 s55, 0xff800000
    s_mov_b32 s56, 0xffffff00
    s_mov_b32 s57, 0xfffff000
    s_mov_b32 s58, 0xfffffe00
    s_mov_b32 s59, 0xffffe000
    s_mov_b32 s60, 0xfffffc00
    s_mov_b32 s61, 0xffffc000
    s_mov_b32 s62, 0xfffff800
    s_mov_b32 s63, 0xffff8000
    s_mov_b32 s64, 0xff000000
    s_mov_b32 s65, 0xf0000000
    s_mov_b32 s66, 0xfe000000
    s_mov_b32 s67, 0xe0000000
    s_mov_b32 s68, 0xfc000000
    s_mov_b32 s69, 0xc0000000
    s_mov_b32 s70, 0xf8000000
    s_mov_b32 s71, 0x80000000
    v_bfe_u32 v20, v252, 3, 2
    v_lshrrev_b32 v21, 5, v252
    v_lshl_add_u32 v20, v21, 3, v20
    s_lshr_b32 s32, s28, 1
    s_lshl_b32 s32, s32, 4
    s_and_b32 s33, s28, 1
    s_lshl_b32 s33, s33, 2
    s_add_u32 s32, s32, s33
    v_add_u32 v20, s32, v20
    v_lshlrev_b32 v20, 11, v20
    v_lshrrev_b32 v21, 2, v252
    v_and_b32 v21, 4, v21
    v_xor_b32 v21, v21, v252
    v_and_b32 v21, 7, v21
    v_lshl_add_u32 v20, v21, 4, v20
    s_lshl_b32 s32, s98, 7
    v_add_u32 v14, s32, v20
    v_lshrrev_b32 v20, 2, v252
    v_lshlrev_b32 v20, 2, v20
    v_bfe_u32 v21, v252, 1, 1
    v_add_u32 v20, v20, v21
    v_mul_u32_u24 v20, 28672, v20
    v_and_b32 v21, 1, v252
    v_lshl_add_u32 v20, v21, 4, v20
    s_mul_i32 s30, s28, 1835008
    s_lshl_b32 s31, s29, 5
    s_add_u32 s30, s30, s31
    v_add_u32 v155, s30, v20
    v_lshlrev_b32 v21, 14, v21
    v_lshrrev_b32 v20, 1, v252
    v_lshl_add_u32 v20, v20, 4, v21
    s_lshl_b32 s30, s28, 9
    s_lshl_b32 s31, s29, 15
    s_add_u32 s30, s30, s31
    v_add_u32 v153, s30, v20
    s_load_dwordx2 s[80:81], s[0:1], 40
    s_cmp_lt_u32 s29, 224
    s_cselect_b32 s82, 0x700000, 0
    s_mov_b32 s83, 0x20000
    s_load_dwordx2 s[12:13], s[0:1], 56
    s_cmp_lt_u32 s29, 224
    s_cselect_b32 s14, 0x700000, 0
    s_mov_b32 s15, 0x20000
    s_mov_b32 s73, -1
    s_mov_b32 s100, 0
    s_sub_u32 s30, s25, s24
    s_add_u32 s30, s30, 31
    v_and_b32 v15, 16, v252
    v_mul_u32_u24 v15, s30, v15
    v_and_b32 v20, 31, v252
    v_add_lshl_u32 v15, v15, v20, 3
    s_lshl_b32 s30, s24, 7
    s_add_u32 s30, s30, 0xdd9000
    v_add_u32 v15, s30, v15
    s_add_u32 m0, s87, 45056
    s_nop 0
    buffer_load_dwordx4 v12, s[16:19], s96 offen offset:0 lds
    buffer_load_dwordx4 v13, s[16:19], s96 offen offset:1024 lds
    s_add_u32 s96, s95, 1
    s_and_b32 s96, s96, 15
    s_lshl_b32 s97, s96, 7
    s_add_u32 s97, s97, s84
    s_add_u32 m0, s86, 131072
    s_nop 0
    buffer_load_dwordx4 v4, s[4:7], s97 offen offset:0 lds
    buffer_load_dwordx4 v5, s[4:7], s97 offen offset:1024 lds
    buffer_load_dwordx4 v6, s[4:7], s97 offen offset:2048 lds
    buffer_load_dwordx4 v7, s[4:7], s97 offen offset:3072 lds
    s_add_u32 s96, s95, 1
    s_and_b32 s96, s96, 15
    s_mul_i32 s96, s96, 393216
    s_add_u32 s96, s96, s85
    s_add_u32 m0, s87, 65536
    s_nop 0
    buffer_load_dwordx4 v8, s[16:19], s96 offen offset:0 lds
    buffer_load_dwordx4 v9, s[16:19], s96 offen offset:1024 lds
    buffer_load_dwordx4 v10, s[16:19], s96 offen offset:2048 lds
    s_waitcnt vmcnt(7) lgkmcnt(0)
    s_add_u32 s88, s88, 0x9e3779b9
    s_barrier
    buffer_load_dwordx4 v11, s[16:19], s96 offen offset:3072 lds
    s_add_u32 m0, s87, 69632
    s_nop 0
    buffer_load_dwordx4 v12, s[16:19], s96 offen offset:0 lds
    buffer_load_dwordx4 v13, s[16:19], s96 offen offset:1024 lds
    s_add_u32 s96, s94, 2
    s_and_b32 s96, s96, 15
    s_lshl_b32 s97, s96, 7
    s_add_u32 s97, s97, s84
    s_add_u32 m0, s86, 114688
    s_nop 0
    buffer_load_dwordx4 v4, s[4:7], s97 offen offset:0 lds
    buffer_load_dwordx4 v5, s[4:7], s97 offen offset:1024 lds
    buffer_load_dwordx4 v6, s[4:7], s97 offen offset:2048 lds
    buffer_load_dwordx4 v7, s[4:7], s97 offen offset:3072 lds
    s_add_u32 s96, s94, 2
    s_and_b32 s96, s96, 15
    s_mul_i32 s96, s96, 393216
    s_add_u32 s96, s96, s85
    s_add_u32 m0, s87, 90112
    s_nop 0
    buffer_load_dwordx4 v8, s[16:19], s96 offen offset:0 lds
    buffer_load_dwordx4 v9, s[16:19], s96 offen offset:1024 lds
    buffer_load_dwordx4 v10, s[16:19], s96 offen offset:2048 lds
    buffer_load_dwordx4 v11, s[16:19], s96 offen offset:3072 lds
    s_add_u32 m0, s87, 94208
    s_nop 0
    buffer_load_dwordx4 v12, s[16:19], s96 offen offset:0 lds
    buffer_load_dwordx4 v13, s[16:19], s96 offen offset:1024 lds
    s_waitcnt vmcnt(10) lgkmcnt(0)
    s_barrier
    s_add_u32 s96, s95, 3
    s_and_b32 s96, s96, 15
    s_lshl_b32 s97, s96, 7
    s_add_u32 s97, s97, s84
    s_add_u32 m0, s86, 147456
    s_nop 0
    buffer_load_dwordx4 v4, s[4:7], s97 offen offset:0 lds
    buffer_load_dwordx4 v5, s[4:7], s97 offen offset:1024 lds
    v_and_b32 v28, 31, v252
    v_bfe_u32 v29, v28, 1, 3
    v_lshrrev_b32 v30, 5, v252
    v_xor_b32 v29, v29, v30
    v_lshlrev_b32 v29, 4, v29
    v_lshl_add_u32 v28, v28, 7, v29
    s_add_u32 s30, s86, 131072
    buffer_load_dwordx4 v6, s[4:7], s97 offen offset:2048 lds
    v_add_u32 v28, s30, v28
    v_xor_b32 v29, 32, v28
    v_xor_b32 v30, 64, v28
    v_xor_b32 v31, 96, v28
    ds_read_b128 v[32:35], v28
    ds_read_b128 v[36:39], v29
    ds_read_b128 v[40:43], v30
    buffer_load_dwordx4 v7, s[4:7], s97 offen offset:3072 lds
    ds_read_b128 v[44:47], v31
    s_min_u32 s30, s28, 2
    s_lshl_b32 s30, s30, 13
    s_add_u32 s30, s30, 65536
    v_lshrrev_b32 v20, 2, v252
    v_bfe_u32 v21, v20, 1, 2
    v_lshlrev_b32 v20, 7, v20
    s_add_u32 s96, s95, 3
    s_and_b32 s96, s96, 15
    s_mul_i32 s96, s96, 393216
    s_add_u32 s96, s96, s85
    s_add_u32 m0, s87, 40960
    s_nop 0
    buffer_load_dwordx4 v8, s[16:19], s96 offen offset:0 lds
    v_lshl_add_u32 v20, v21, 5, v20
    v_and_b32 v21, 3, v252
    v_lshl_add_u32 v20, v21, 3, v20
    v_add_u32 v144, s30, v20
    v_xor_b32 v145, 32, v144
    v_xor_b32 v146, 64, v144
    v_xor_b32 v147, 96, v144
    buffer_load_dwordx4 v9, s[16:19], s96 offen offset:1024 lds
    ds_read_b64_tr_b16 v[100:101], v144 offset:0
    ds_read_b64_tr_b16 v[102:103], v144 offset:2048
    ds_read_b64_tr_b16 v[104:105], v144 offset:4096
    ds_read_b64_tr_b16 v[106:107], v144 offset:6144
    ds_read_b64_tr_b16 v[108:109], v145 offset:0
    ds_read_b64_tr_b16 v[110:111], v145 offset:2048
    ds_read_b64_tr_b16 v[112:113], v145 offset:4096
    buffer_load_dwordx4 v10, s[16:19], s96 offen offset:2048 lds
    ds_read_b64_tr_b16 v[114:115], v145 offset:6144
    ds_read_b64_tr_b16 v[116:117], v146 offset:0
    ds_read_b64_tr_b16 v[118:119], v146 offset:2048
    ds_read_b64_tr_b16 v[120:121], v146 offset:4096
    ds_read_b64_tr_b16 v[122:123], v146 offset:6144
    ds_read_b64_tr_b16 v[124:125], v147 offset:0
    ds_read_b64_tr_b16 v[126:127], v147 offset:2048
    buffer_load_dwordx4 v11, s[16:19], s96 offen offset:3072 lds
    ds_read_b64_tr_b16 v[128:129], v147 offset:4096
    ds_read_b64_tr_b16 v[130:131], v147 offset:6144
    v_mov_b32 v16, -1
    v_mov_b32 v17, -1
    v_mov_b32 v18, -1
    v_mov_b32 v19, -1
    s_lshr_b32 s30, s28, 1
    s_add_u32 m0, s87, 45056
    s_nop 0
    buffer_load_dwordx4 v12, s[16:19], s96 offen offset:0 lds
    s_mul_i32 s30, s30, 16777216
    s_and_b32 s31, s28, 1
    s_lshl_b32 s32, s31, 20
    s_lshl_b32 s33, s72, 10
    s_add_u32 s32, s32, s33
    s_add_u32 s32, s32, s30
    s_add_u32 s32, s32, 0xc00000
    buffer_load_dwordx4 v13, s[16:19], s96 offen offset:1024 lds
    buffer_store_dwordx4 v[16:19], v253, s[20:23], s32 offen sc1
    s_add_u32 s32, s32, 262144
    buffer_store_dwordx4 v[16:19], v253, s[20:23], s32 offen sc1
    s_add_u32 s32, s32, 262144
    buffer_store_dwordx4 v[16:19], v253, s[20:23], s32 offen sc1
    s_add_u32 s32, s32, 262144
    s_lshl_b32 s33, s72, 7
    s_add_u32 s33, s33, s30
    s_add_u32 s33, s33, 0xdc0000
    s_cmp_eq_u32 s31, 0
    s_cselect_b32 s32, s32, s33
    s_cselect_b64 exec, -1, 0xff
    buffer_store_dwordx4 v[16:19], v253, s[20:23], s32 offen sc1
    s_mov_b64 exec, -1
    s_waitcnt vmcnt(14) lgkmcnt(0)
    s_barrier
    s_add_u32 s96, s94, 4
    s_and_b32 s96, s96, 15
    s_lshl_b32 s97, s96, 7
    s_add_u32 s97, s97, s84
    s_add_u32 m0, s86, 131072
    s_nop 0
    buffer_load_dwordx4 v4, s[4:7], s97 offen offset:0 lds
    buffer_load_dwordx4 v5, s[4:7], s97 offen offset:1024 lds
    v_mov_b32 v48, 0
    buffer_load_dwordx4 v6, s[4:7], s97 offen offset:2048 lds
    v_mov_b32 v49, 0
    buffer_load_dwordx4 v7, s[4:7], s97 offen offset:3072 lds
    v_mov_b32 v50, 0
    s_add_u32 s96, s94, 4
    s_and_b32 s96, s96, 15
    s_mul_i32 s96, s96, 393216
    s_add_u32 s96, s96, s85
    s_add_u32 m0, s87, 65536
    s_nop 0
    buffer_load_dwordx4 v8, s[16:19], s96 offen offset:0 lds
    v_mov_b32 v51, 0
    buffer_load_dwordx4 v9, s[16:19], s96 offen offset:1024 lds
    v_mov_b32 v140, 0
    buffer_load_dwordx4 v10, s[16:19], s96 offen offset:2048 lds
    v_mov_b32 v141, 0
    buffer_load_dwordx4 v11, s[16:19], s96 offen offset:3072 lds
    v_mov_b32 v142, 0
    s_add_u32 m0, s87, 69632
    s_nop 0
    buffer_load_dwordx4 v12, s[16:19], s96 offen offset:0 lds
    v_mov_b32 v143, 0
    buffer_load_dwordx4 v13, s[16:19], s96 offen offset:1024 lds
    v_dot2c_f32_bf16 v140, 0x3f803f80, v100
    v_dot2c_f32_bf16 v141, 0x3f803f80, v108
    v_dot2c_f32_bf16 v142, 0x3f803f80, v116
    v_dot2c_f32_bf16 v143, 0x3f803f80, v124
    v_dot2c_f32_bf16 v140, 0x3f803f80, v101
    v_dot2c_f32_bf16 v141, 0x3f803f80, v109
    v_dot2c_f32_bf16 v142, 0x3f803f80, v117
    v_dot2c_f32_bf16 v143, 0x3f803f80, v125
    v_dot2c_f32_bf16 v140, 0x3f803f80, v102
    v_dot2c_f32_bf16 v141, 0x3f803f80, v110
    v_dot2c_f32_bf16 v142, 0x3f803f80, v118
    v_dot2c_f32_bf16 v143, 0x3f803f80, v126
    v_dot2c_f32_bf16 v140, 0x3f803f80, v103
    v_dot2c_f32_bf16 v141, 0x3f803f80, v111
    v_dot2c_f32_bf16 v142, 0x3f803f80, v119
    v_dot2c_f32_bf16 v143, 0x3f803f80, v127
    v_dot2c_f32_bf16 v140, 0x3f803f80, v104
    v_dot2c_f32_bf16 v141, 0x3f803f80, v112
    v_dot2c_f32_bf16 v142, 0x3f803f80, v120
    v_dot2c_f32_bf16 v143, 0x3f803f80, v128
    v_dot2c_f32_bf16 v140, 0x3f803f80, v105
    v_dot2c_f32_bf16 v141, 0x3f803f80, v113
    v_dot2c_f32_bf16 v142, 0x3f803f80, v121
    v_dot2c_f32_bf16 v143, 0x3f803f80, v129
    v_dot2c_f32_bf16 v140, 0x3f803f80, v106
    v_dot2c_f32_bf16 v141, 0x3f803f80, v114
    v_dot2c_f32_bf16 v142, 0x3f803f80, v122
    v_dot2c_f32_bf16 v143, 0x3f803f80, v130
    v_dot2c_f32_bf16 v140, 0x3f803f80, v107
    v_dot2c_f32_bf16 v141, 0x3f803f80, v115
    v_dot2c_f32_bf16 v142, 0x3f803f80, v123
    v_dot2c_f32_bf16 v143, 0x3f803f80, v131
    v_dot2c_f32_bf16 v48, 0x3f803f80, v32
    v_dot2c_f32_bf16 v49, v32, v32
    v_dot2c_f32_bf16 v50, 0x3f803f80, v33
    v_dot2c_f32_bf16 v51, v33, v33
    v_dot2c_f32_bf16 v48, 0x3f803f80, v34
    v_dot2c_f32_bf16 v49, v34, v34
    v_dot2c_f32_bf16 v50, 0x3f803f80, v35
    v_dot2c_f32_bf16 v51, v35, v35
    v_dot2c_f32_bf16 v48, 0x3f803f80, v36
    v_dot2c_f32_bf16 v49, v36, v36
    v_dot2c_f32_bf16 v50, 0x3f803f80, v37
    v_dot2c_f32_bf16 v51, v37, v37
    v_dot2c_f32_bf16 v48, 0x3f803f80, v38
    v_dot2c_f32_bf16 v49, v38, v38
    v_dot2c_f32_bf16 v50, 0x3f803f80, v39
    v_dot2c_f32_bf16 v51, v39, v39
    v_dot2c_f32_bf16 v48, 0x3f803f80, v40
    v_dot2c_f32_bf16 v49, v40, v40
    v_dot2c_f32_bf16 v50, 0x3f803f80, v41
    v_dot2c_f32_bf16 v51, v41, v41
    v_dot2c_f32_bf16 v48, 0x3f803f80, v42
    v_dot2c_f32_bf16 v49, v42, v42
    v_dot2c_f32_bf16 v50, 0x3f803f80, v43
    v_dot2c_f32_bf16 v51, v43, v43
    v_dot2c_f32_bf16 v48, 0x3f803f80, v44
    v_dot2c_f32_bf16 v49, v44, v44
    v_dot2c_f32_bf16 v50, 0x3f803f80, v45
    v_dot2c_f32_bf16 v51, v45, v45
    v_dot2c_f32_bf16 v48, 0x3f803f80, v46
    v_dot2c_f32_bf16 v49, v46, v46
    v_dot2c_f32_bf16 v50, 0x3f803f80, v47
    v_dot2c_f32_bf16 v51, v47, v47
    s_waitcnt vmcnt(14) lgkmcnt(0)
    s_barrier
    s_add_u32 s96, s95, 5
    s_and_b32 s96, s96, 15
    s_lshl_b32 s97, s96, 7
    s_add_u32 s97, s97, s84
    s_add_u32 m0, s86, 114688
    s_nop 0
    buffer_load_dwordx4 v4, s[4:7], s97 offen offset:0 lds
    buffer_load_dwordx4 v5, s[4:7], s97 offen offset:1024 lds
    s_lshl_b32 s30, s99, 12
    s_lshl_b32 s31, s25, 8
    buffer_load_dwordx4 v6, s[4:7], s97 offen offset:2048 lds
    s_add_u32 s30, s30, s31
    s_add_u32 s30, s30, 0x2400000
    buffer_load_dwordx4 v7, s[4:7], s97 offen offset:3072 lds
    v_lshlrev_b32 v28, 3, v252
    s_add_u32 s96, s95, 5
    s_and_b32 s96, s96, 15
    s_mul_i32 s96, s96, 393216
    s_add_u32 s96, s96, s85
    s_add_u32 m0, s87, 90112
    s_nop 0
    buffer_load_dwordx4 v8, s[16:19], s96 offen offset:0 lds
    v_add_f32 v48, v48, v50
    v_add_f32 v49, v49, v51
    buffer_load_dwordx4 v9, s[16:19], s96 offen offset:1024 lds
    v_mov_b32 v50, v48
    v_mov_b32 v51, v49
    buffer_load_dwordx4 v10, s[16:19], s96 offen offset:2048 lds
    v_permlane32_swap_b32 v48, v50
    buffer_load_dwordx4 v11, s[16:19], s96 offen offset:3072 lds
    v_permlane32_swap_b32 v49, v51
    v_add_f32 v48, v48, v50
    s_add_u32 m0, s87, 94208
    s_nop 0
    buffer_load_dwordx4 v12, s[16:19], s96 offen offset:0 lds
    v_add_f32 v49, v49, v51
    buffer_load_dwordx4 v13, s[16:19], s96 offen offset:1024 lds
    s_mov_b32 exec_hi, 0
    buffer_store_dwordx2 v[48:49], v28, s[20:23], s30 offen sc1
    s_mov_b64 exec, -1
    s_min_u32 s32, s28, 2
    s_lshl_b32 s32, s32, 12
    s_lshl_b32 s33, s25, 14
    s_add_u32 s32, s32, s33
    s_add_u32 s32, s32, 0x2500000
    s_lshl_b32 s33, s24, 8
    s_add_u32 s32, s32, s33
    v_lshlrev_b32 v20, 2, v252
    v_permlane32_swap_b32 v140, v142
    v_permlane32_swap_b32 v141, v143
    v_add_f32 v140, v140, v142
    v_add_f32 v141, v141, v143
    s_nop 1
    v_permlane16_swap_b32 v140, v141
    v_add_f32 v140, v140, v141
    buffer_store_dword v140, v20, s[20:23], s32 offen sc1
    s_waitcnt vmcnt(12) lgkmcnt(0)
    s_barrier
    s_add_u32 s96, s94, 6
    s_and_b32 s96, s96, 15
    s_lshl_b32 s97, s96, 7
    s_add_u32 s97, s97, s84
    s_add_u32 m0, s86, 147456
    s_nop 0
    buffer_load_dwordx4 v4, s[4:7], s97 offen offset:0 lds
    buffer_load_dwordx4 v5, s[4:7], s97 offen offset:1024 lds
    buffer_load_dwordx4 v6, s[4:7], s97 offen offset:2048 lds
    buffer_load_dwordx4 v7, s[4:7], s97 offen offset:3072 lds
    s_add_u32 s96, s94, 6
    s_and_b32 s96, s96, 15
    s_mul_i32 s96, s96, 393216
    s_add_u32 s96, s96, s85
    s_add_u32 m0, s87, 40960
    s_nop 0
    buffer_load_dwordx4 v8, s[16:19], s96 offen offset:0 lds
    buffer_load_dwordx4 v9, s[16:19], s96 offen offset:1024 lds
    buffer_load_dwordx4 v10, s[16:19], s96 offen offset:2048 lds
    buffer_load_dwordx4 v11, s[16:19], s96 offen offset:3072 lds
    s_add_u32 m0, s87, 45056
    s_nop 0
    buffer_load_dwordx4 v12, s[16:19], s96 offen offset:0 lds
    buffer_load_dwordx4 v13, s[16:19], s96 offen offset:1024 lds
    s_waitcnt vmcnt(10) lgkmcnt(0)
    s_barrier
    s_add_u32 s96, s95, 7
    s_and_b32 s96, s96, 15
    s_lshl_b32 s97, s96, 7
    s_add_u32 s97, s97, s84
    s_add_u32 m0, s86, 131072
    s_nop 0
    buffer_load_dwordx4 v4, s[4:7], s97 offen offset:0 lds
    buffer_load_dwordx4 v5, s[4:7], s97 offen offset:1024 lds
    buffer_load_dwordx4 v6, s[4:7], s97 offen offset:2048 lds
    buffer_load_dwordx4 v7, s[4:7], s97 offen offset:3072 lds
    s_add_u32 s96, s95, 7
    s_and_b32 s96, s96, 15
    s_mul_i32 s96, s96, 393216
    s_add_u32 s96, s96, s85
    s_add_u32 m0, s87, 65536
    s_nop 0
    buffer_load_dwordx4 v8, s[16:19], s96 offen offset:0 lds
    buffer_load_dwordx4 v9, s[16:19], s96 offen offset:1024 lds
    buffer_load_dwordx4 v10, s[16:19], s96 offen offset:2048 lds
    buffer_load_dwordx4 v11, s[16:19], s96 offen offset:3072 lds
    s_add_u32 m0, s87, 69632
    s_nop 0
    buffer_load_dwordx4 v12, s[16:19], s96 offen offset:0 lds
    buffer_load_dwordx4 v13, s[16:19], s96 offen offset:1024 lds
    s_waitcnt vmcnt(10) lgkmcnt(0)
    s_barrier
    s_add_u32 s96, s94, 8
    s_and_b32 s96, s96, 15
    s_lshl_b32 s97, s96, 7
    s_add_u32 s97, s97, s84
    s_add_u32 m0, s86, 114688
    s_nop 0
    buffer_load_dwordx4 v4, s[4:7], s97 offen offset:0 lds
    buffer_load_dwordx4 v5, s[4:7], s97 offen offset:1024 lds
    buffer_load_dwordx4 v6, s[4:7], s97 offen offset:2048 lds
    buffer_load_dwordx4 v7, s[4:7], s97 offen offset:3072 lds
    s_add_u32 s96, s94, 8
    s_and_b32 s96, s96, 15
    s_mul_i32 s96, s96, 393216
    s_add_u32 s96, s96, s85
    s_add_u32 m0, s87, 90112
    s_nop 0
    buffer_load_dwordx4 v8, s[16:19], s96 offen offset:0 lds
    buffer_load_dwordx4 v9, s[16:19], s96 offen offset:1024 lds
    buffer_load_dwordx4 v10, s[16:19], s96 offen offset:2048 lds
    buffer_load_dwordx4 v11, s[16:19], s96 offen offset:3072 lds
    s_add_u32 m0, s87, 94208
    s_nop 0
    buffer_load_dwordx4 v12, s[16:19], s96 offen offset:0 lds
    buffer_load_dwordx4 v13, s[16:19], s96 offen offset:1024 lds
    s_waitcnt vmcnt(10) lgkmcnt(0)
    s_barrier
    s_add_u32 s96, s95, 9
    s_and_b32 s96, s96, 15
    s_lshl_b32 s97, s96, 7
    s_add_u32 s97, s97, s84
    s_add_u32 m0, s86, 147456
    s_nop 0
    buffer_load_dwordx4 v4, s[4:7], s97 offen offset:0 lds
    buffer_load_dwordx4 v5, s[4:7], s97 offen offset:1024 lds
    buffer_load_dwordx4 v6, s[4:7], s97 offen offset:2048 lds
    buffer_load_dwordx4 v7, s[4:7], s97 offen offset:3072 lds
    s_add_u32 s96, s95, 9
    s_and_b32 s96, s96, 15
    s_mul_i32 s96, s96, 393216
    s_add_u32 s96, s96, s85
    s_add_u32 m0, s87, 40960
    s_nop 0
    buffer_load_dwordx4 v8, s[16:19], s96 offen offset:0 lds
    buffer_load_dwordx4 v9, s[16:19], s96 offen offset:1024 lds
    buffer_load_dwordx4 v10, s[16:19], s96 offen offset:2048 lds
    buffer_load_dwordx4 v11, s[16:19], s96 offen offset:3072 lds
    s_add_u32 m0, s87, 45056
    s_nop 0
    buffer_load_dwordx4 v12, s[16:19], s96 offen offset:0 lds
    buffer_load_dwordx4 v13, s[16:19], s96 offen offset:1024 lds
    s_waitcnt vmcnt(10) lgkmcnt(0)
    s_barrier
    s_add_u32 s96, s94, 10
    s_and_b32 s96, s96, 15
    s_lshl_b32 s97, s96, 7
    s_add_u32 s97, s97, s84
    s_add_u32 m0, s86, 131072
    s_nop 0
    buffer_load_dwordx4 v4, s[4:7], s97 offen offset:0 lds
    buffer_load_dwordx4 v5, s[4:7], s97 offen offset:1024 lds
    buffer_load_dwordx4 v6, s[4:7], s97 offen offset:2048 lds
    buffer_load_dwordx4 v7, s[4:7], s97 offen offset:3072 lds
    s_add_u32 s96, s94, 10
    s_and_b32 s96, s96, 15
    s_mul_i32 s96, s96, 393216
    s_add_u32 s96, s96, s85
    s_add_u32 m0, s87, 65536
    s_nop 0
    buffer_load_dwordx4 v8, s[16:19], s96 offen offset:0 lds
    buffer_load_dwordx4 v9, s[16:19], s96 offen offset:1024 lds
    buffer_load_dwordx4 v10, s[16:19], s96 offen offset:2048 lds
    buffer_load_dwordx4 v11, s[16:19], s96 offen offset:3072 lds
    s_add_u32 m0, s87, 69632
    s_nop 0
    buffer_load_dwordx4 v12, s[16:19], s96 offen offset:0 lds
    buffer_load_dwordx4 v13, s[16:19], s96 offen offset:1024 lds
    s_waitcnt vmcnt(10) lgkmcnt(0)
    s_barrier
    s_add_u32 s96, s95, 11
    s_and_b32 s96, s96, 15
    s_lshl_b32 s97, s96, 7
    s_add_u32 s97, s97, s84
    s_add_u32 m0, s86, 114688
    s_nop 0
    buffer_load_dwordx4 v4, s[4:7], s97 offen offset:0 lds
    buffer_load_dwordx4 v5, s[4:7], s97 offen offset:1024 lds
    buffer_load_dwordx4 v6, s[4:7], s97 offen offset:2048 lds
    buffer_load_dwordx4 v7, s[4:7], s97 offen offset:3072 lds
    s_add_u32 s96, s95, 11
    s_and_b32 s96, s96, 15
    s_mul_i32 s96, s96, 393216
    s_add_u32 s96, s96, s85
    s_add_u32 m0, s87, 90112
    s_nop 0
    buffer_load_dwordx4 v8, s[16:19], s96 offen offset:0 lds
    buffer_load_dwordx4 v9, s[16:19], s96 offen offset:1024 lds
    buffer_load_dwordx4 v10, s[16:19], s96 offen offset:2048 lds
    buffer_load_dwordx4 v11, s[16:19], s96 offen offset:3072 lds
    s_add_u32 m0, s87, 94208
    s_nop 0
    buffer_load_dwordx4 v12, s[16:19], s96 offen offset:0 lds
    buffer_load_dwordx4 v13, s[16:19], s96 offen offset:1024 lds
    s_waitcnt vmcnt(10) lgkmcnt(0)
    s_barrier
    s_add_u32 s96, s94, 12
    s_and_b32 s96, s96, 15
    s_lshl_b32 s97, s96, 7
    s_add_u32 s97, s97, s84
    s_add_u32 m0, s86, 147456
    s_nop 0
    buffer_load_dwordx4 v4, s[4:7], s97 offen offset:0 lds
    buffer_load_dwordx4 v5, s[4:7], s97 offen offset:1024 lds
    s_getpc_b64 s[32:33]
pc_45:
    buffer_load_dwordx4 v6, s[4:7], s97 offen offset:2048 lds
    s_sub_u32 s32, s32, pc_45-interleave_layers__sliding_block__moe_arch_mod__prompt_kernel
    s_subb_u32 s33, s33, 0
    buffer_load_dwordx4 v7, s[4:7], s97 offen offset:3072 lds
    s_lshr_b32 s34, s2, 3
    s_add_u32 s96, s94, 12
    s_and_b32 s96, s96, 15
    s_mul_i32 s96, s96, 393216
    s_add_u32 s96, s96, s85
    s_add_u32 m0, s87, 40960
    s_nop 0
    buffer_load_dwordx4 v8, s[16:19], s96 offen offset:0 lds
    s_lshl_b32 s34, s34, 2
    buffer_load_dwordx4 v9, s[16:19], s96 offen offset:1024 lds
    s_add_u32 s34, s34, s28
    s_and_b32 s34, s34, 127
    buffer_load_dwordx4 v10, s[16:19], s96 offen offset:2048 lds
    s_lshl_b32 s34, s34, 7
    buffer_load_dwordx4 v11, s[16:19], s96 offen offset:3072 lds
    v_lshl_add_u32 v154, v252, 14, s34
    s_mov_b32 s34, k_exit-interleave_layers__sliding_block__moe_arch_mod__prompt_kernel
    s_add_u32 m0, s87, 45056
    s_nop 0
    buffer_load_dwordx4 v12, s[16:19], s96 offen offset:0 lds
    s_mov_b32 s35, 0x20000
    buffer_load_dwordx4 v13, s[16:19], s96 offen offset:1024 lds
    buffer_load_dword v154, v154, s[32:35], 0 offen
    s_waitcnt vmcnt(11) lgkmcnt(0)
    s_barrier
    buffer_load_dwordx2 v[16:17], v15, s[20:23], 0 offen sc1
    s_add_u32 s96, s95, 13
    s_and_b32 s96, s96, 15
    s_lshl_b32 s97, s96, 7
    s_add_u32 s97, s97, s84
    s_add_u32 m0, s86, 131072
    s_nop 0
    buffer_load_dwordx4 v4, s[4:7], s97 offen offset:0 lds
    buffer_load_dwordx4 v5, s[4:7], s97 offen offset:1024 lds
    buffer_load_dwordx4 v6, s[4:7], s97 offen offset:2048 lds
    buffer_load_dwordx4 v7, s[4:7], s97 offen offset:3072 lds
    s_add_u32 s96, s95, 13
    s_and_b32 s96, s96, 15
    s_mul_i32 s96, s96, 393216
    s_add_u32 s96, s96, s85
    s_add_u32 m0, s87, 65536
    s_nop 0
    buffer_load_dwordx4 v8, s[16:19], s96 offen offset:0 lds
    buffer_load_dwordx4 v9, s[16:19], s96 offen offset:1024 lds
    buffer_load_dwordx4 v10, s[16:19], s96 offen offset:2048 lds
    buffer_load_dwordx4 v11, s[16:19], s96 offen offset:3072 lds
    s_add_u32 m0, s87, 69632
    s_nop 0
    buffer_load_dwordx4 v12, s[16:19], s96 offen offset:0 lds
    buffer_load_dwordx4 v13, s[16:19], s96 offen offset:1024 lds
    s_waitcnt vmcnt(12) lgkmcnt(0)
    s_barrier
    s_add_u32 s96, s94, 14
    s_and_b32 s96, s96, 15
    s_lshl_b32 s97, s96, 7
    s_add_u32 s97, s97, s84
    s_add_u32 m0, s86, 114688
    s_nop 0
    buffer_load_dwordx4 v4, s[4:7], s97 offen offset:0 lds
    buffer_load_dwordx4 v5, s[4:7], s97 offen offset:1024 lds
    buffer_load_dwordx4 v6, s[4:7], s97 offen offset:2048 lds
    buffer_load_dwordx4 v7, s[4:7], s97 offen offset:3072 lds
    s_add_u32 s96, s94, 14
    s_and_b32 s96, s96, 15
    s_mul_i32 s96, s96, 393216
    s_add_u32 s96, s96, s85
    s_add_u32 m0, s87, 90112
    s_nop 0
    buffer_load_dwordx4 v8, s[16:19], s96 offen offset:0 lds
    buffer_load_dwordx4 v9, s[16:19], s96 offen offset:1024 lds
    buffer_load_dwordx4 v10, s[16:19], s96 offen offset:2048 lds
    buffer_load_dwordx4 v11, s[16:19], s96 offen offset:3072 lds
    s_add_u32 m0, s87, 94208
    s_nop 0
    buffer_load_dwordx4 v12, s[16:19], s96 offen offset:0 lds
    buffer_load_dwordx4 v13, s[16:19], s96 offen offset:1024 lds
    s_mov_b32 s78, s27
    s_waitcnt vmcnt(20)
    s_branch pc_47
pl_46:
    buffer_load_dwordx2 v[16:17], v15, s[20:23], 0 offen sc1
    s_waitcnt vmcnt(0)
pc_47:
    v_cmp_ne_u32 vcc, s88, v16
    s_cbranch_vccz pd_48
    s_sub_u32 s78, s78, 1
    s_cmp_lg_u32 s78, 0
    s_cbranch_scc1 pl_46
    s_mov_b32 s27, 1
pd_48:
    s_getreg_b32 s30, hwreg(HW_REG_XCC_ID, 0, 4)
    v_cmp_ne_u32 vcc, s30, v17
    s_and_b32 s30, vcc_lo, 0xffff
    s_cselect_b32 s77, 0, 1
    v_mov_b32 v20, s73
    v_mov_b32 v21, s77
    v_mov_b32 v19, 0
    ds_write_b64 v19, v[20:21] offset:3072
    s_waitcnt vmcnt(10) lgkmcnt(0)
    s_barrier
    s_add_u32 s96, s95, 15
    s_and_b32 s96, s96, 15
    s_lshl_b32 s97, s96, 7
    s_add_u32 s97, s97, s84
    s_add_u32 m0, s86, 147456
    s_nop 0
    buffer_load_dwordx4 v4, s[4:7], s97 offen offset:0 lds
    buffer_load_dwordx4 v5, s[4:7], s97 offen offset:1024 lds
    buffer_load_dwordx4 v6, s[4:7], s97 offen offset:2048 lds
    buffer_load_dwordx4 v7, s[4:7], s97 offen offset:3072 lds
    s_add_u32 s96, s95, 15
    s_and_b32 s96, s96, 15
    s_mul_i32 s96, s96, 393216
    s_add_u32 s96, s96, s85
    s_add_u32 m0, s87, 40960
    s_nop 0
    buffer_load_dwordx4 v8, s[16:19], s96 offen offset:0 lds
    buffer_load_dwordx4 v9, s[16:19], s96 offen offset:1024 lds
    buffer_load_dwordx4 v10, s[16:19], s96 offen offset:2048 lds
    buffer_load_dwordx4 v11, s[16:19], s96 offen offset:3072 lds
    s_add_u32 m0, s87, 45056
    s_nop 0
    buffer_load_dwordx4 v12, s[16:19], s96 offen offset:0 lds
    buffer_load_dwordx4 v13, s[16:19], s96 offen offset:1024 lds
    s_waitcnt vmcnt(10) lgkmcnt(0)
    s_barrier
    s_load_dwordx2 s[4:5], s[0:1], 48
    s_cmp_lt_u32 s29, 224
    s_cselect_b32 s6, 0x700000, 0
    s_mov_b32 s7, 0x20000
    s_lshl_b32 s30, s99, 12
    s_add_u32 s30, s30, 0x2400000
    buffer_load_dwordx4 v[64:67], v253, s[20:23], s30 offen offset:0 sc1
    buffer_load_dwordx4 v[68:71], v253, s[20:23], s30 offen offset:1024 sc1
    buffer_load_dwordx4 v[72:75], v253, s[20:23], s30 offen offset:2048 sc1
    buffer_load_dwordx4 v[76:79], v253, s[20:23], s30 offen offset:3072 sc1
    s_min_u32 s32, s28, 2
    s_lshl_b32 s32, s32, 12
    s_lshl_b32 s33, s25, 14
    s_add_u32 s32, s32, s33
    s_add_u32 s32, s32, 0x2500000
    buffer_load_dwordx4 v[32:35], v253, s[20:23], s32 offen offset:0 sc1
    buffer_load_dwordx4 v[36:39], v253, s[20:23], s32 offen offset:1024 sc1
    buffer_load_dwordx4 v[40:43], v253, s[20:23], s32 offen offset:2048 sc1
    buffer_load_dwordx4 v[44:47], v253, s[20:23], s32 offen offset:3072 sc1
    s_add_u32 s96, s25, 1
    s_and_b32 s96, s96, 15
    s_lshl_b32 s96, s96, 17
    s_add_u32 m0, s101, 4096
    s_nop 0
    buffer_load_dwordx4 v14, s[8:11], s96 offen lds
    s_add_u32 s96, s25, 2
    s_and_b32 s96, s96, 15
    s_lshl_b32 s96, s96, 17
    s_add_u32 m0, s101, 8192
    s_nop 0
    buffer_load_dwordx4 v14, s[8:11], s96 offen lds
    s_add_u32 s96, s25, 3
    s_and_b32 s96, s96, 15
    s_lshl_b32 s96, s96, 17
    s_add_u32 m0, s101, 12288
    s_nop 0
    buffer_load_dwordx4 v14, s[8:11], s96 offen lds
    s_waitcnt vmcnt(11) lgkmcnt(0)
    s_barrier
    s_waitcnt vmcnt(3)
    v_add_f32 v64, v64, v68
    v_add_f32 v65, v65, v69
    v_add_f32 v66, v66, v70
    v_add_f32 v67, v67, v71
    v_add_f32 v64, v64, v72
    v_add_f32 v65, v65, v73
    v_add_f32 v66, v66, v74
    v_add_f32 v67, v67, v75
    v_add_f32 v64, v64, v76
    v_add_f32 v65, v65, v77
    v_add_f32 v66, v66, v78
    v_add_f32 v67, v67, v79
    s_nop 0
    v_permlane32_swap_b32 v64, v66
    v_permlane32_swap_b32 v65, v67
    v_add_f32 v64, v64, v66
    v_add_f32 v65, v65, v67
    v_mov_b32 v48, v64
    v_mov_b32 v49, v65
    s_nop 0
    v_permlane16_swap_b32 v64, v48
    v_permlane16_swap_b32 v65, v49
    v_add_f32 v64, v64, v48
    v_add_f32 v65, v65, v49
    v_mul_f32 v54, 0x3a800000, v64
    v_mul_f32 v65, 0x3a800000, v65
    v_fma_f32 v65, -v54, v54, v65
    v_max_f32 v65, 0, v65
    v_add_f32 v55, 0x3727c5ac, v65
    v_rsq_f32 v55, v55
    v_add_f32 v32, v32, v36
    v_add_f32 v33, v33, v37
    v_add_f32 v34, v34, v38
    v_add_f32 v35, v35, v39
    v_add_f32 v32, v32, v40
    v_add_f32 v33, v33, v41
    v_add_f32 v34, v34, v42
    v_add_f32 v35, v35, v43
    v_add_f32 v32, v32, v44
    v_add_f32 v33, v33, v45
    v_add_f32 v34, v34, v46
    v_add_f32 v35, v35, v47
    s_nop 0
    v_permlane32_swap_b32 v32, v34
    v_permlane32_swap_b32 v33, v35
    v_add_f32 v32, v32, v34
    v_add_f32 v33, v33, v35
    s_nop 1
    v_permlane16_swap_b32 v32, v33
    v_add_f32 v32, v32, v33
    v_mov_b32 v2, v32
    v_and_b32 v48, 15, v252
    v_lshrrev_b32 v49, 5, v252
    v_lshl_add_u32 v48, v48, 1, v49
    v_bfe_u32 v49, v252, 4, 1
    v_cmp_eq_u32 vcc, 0, v49
    v_lshlrev_b32 v49, 9, v49
    v_lshl_add_u32 v48, v48, 2, v49
    s_lshl_b32 s32, s28, 7
    v_add_u32 v48, s32, v48
    v_cndmask_b32 v49, v54, v55, vcc
    v_cndmask_b32 v50, 0, 1.0, vcc
    ds_write_b32 v48, v49 offset:0
    ds_write_b32 v48, v50 offset:2048
    v_and_b32 v48, 15, v252
    v_lshrrev_b32 v51, 4, v252
    v_lshl_add_u32 v48, v48, 2, v51
    s_min_u32 s32, s28, 2
    s_lshl_b32 s32, s32, 8
    v_lshl_add_u32 v48, v48, 2, s32
    ds_write_b32 v48, v2 offset:1024
    s_waitcnt lgkmcnt(0)
    s_barrier
l_att:
    s_add_u32 s96, s25, 10
    s_and_b32 s96, s96, 15
    s_lshl_b32 s96, s96, 17
    s_add_u32 m0, s101, 40960
    s_nop 0
    buffer_load_dwordx4 v14, s[8:11], s96 offen lds
    s_add_u32 s96, s25, 11
    s_and_b32 s96, s96, 15
    s_lshl_b32 s96, s96, 17
    s_add_u32 m0, s101, 45056
    s_nop 0
    buffer_load_dwordx4 v14, s[8:11], s96 offen lds
    s_cmp_lg_u32 s26, 0
    s_cbranch_scc1 sk_49
    s_add_u32 s96, s25, 4
    s_and_b32 s96, s96, 15
    s_lshl_b32 s96, s96, 17
    s_add_u32 m0, s101, 16384
    s_nop 0
    buffer_load_dwordx4 v14, s[8:11], s96 offen lds
    s_add_u32 s96, s25, 5
    s_and_b32 s96, s96, 15
    s_lshl_b32 s96, s96, 17
    s_add_u32 m0, s101, 20480
    s_nop 0
    buffer_load_dwordx4 v14, s[8:11], s96 offen lds
    s_add_u32 s96, s25, 6
    s_and_b32 s96, s96, 15
    s_lshl_b32 s96, s96, 17
    s_add_u32 m0, s101, 24576
    s_nop 0
    buffer_load_dwordx4 v14, s[8:11], s96 offen lds
    s_add_u32 s96, s25, 7
    s_and_b32 s96, s96, 15
    s_lshl_b32 s96, s96, 17
    s_add_u32 m0, s101, 28672
    s_nop 0
    buffer_load_dwordx4 v14, s[8:11], s96 offen lds
    s_add_u32 s96, s25, 8
    s_and_b32 s96, s96, 15
    s_lshl_b32 s96, s96, 17
    s_add_u32 m0, s101, 32768
    s_nop 0
    buffer_load_dwordx4 v14, s[8:11], s96 offen lds
    s_add_u32 s96, s25, 9
    s_and_b32 s96, s96, 15
    s_lshl_b32 s96, s96, 17
    s_add_u32 m0, s101, 36864
    s_nop 0
    buffer_load_dwordx4 v14, s[8:11], s96 offen lds
sk_49:
    v_mov_b32 v20, 0xffff
    v_mov_b32 v21, 0xffff0000
    v_cndmask_b32 v22, 0, v20, s[40:41]
    v_cndmask_b32 v23, 0, v21, s[42:43]
    v_or_b32 v12, v22, v23
    v_cndmask_b32 v22, 0, v20, s[44:45]
    v_cndmask_b32 v23, 0, v21, s[46:47]
    v_or_b32 v13, v22, v23
    v_cndmask_b32 v22, 0, v20, s[48:49]
    v_cndmask_b32 v23, 0, v21, s[50:51]
    v_or_b32 v14, v22, v23
    v_cndmask_b32 v22, 0, v20, s[52:53]
    v_cndmask_b32 v23, 0, v21, s[54:55]
    v_or_b32 v15, v22, v23
    v_cndmask_b32 v22, 0, v20, s[56:57]
    v_cndmask_b32 v23, 0, v21, s[58:59]
    v_or_b32 v16, v22, v23
    v_cndmask_b32 v22, 0, v20, s[60:61]
    v_cndmask_b32 v23, 0, v21, s[62:63]
    v_or_b32 v17, v22, v23
    v_cndmask_b32 v22, 0, v20, s[64:65]
    v_cndmask_b32 v23, 0, v21, s[66:67]
    v_or_b32 v18, v22, v23
    v_cndmask_b32 v22, 0, v20, s[68:69]
    v_cndmask_b32 v23, 0, v21, s[70:71]
    v_or_b32 v19, v22, v23
    s_lshl_b32 s34, s28, 12
    s_add_u32 s34, s34, 114688
    v_add_u32 v20, s34, v253
    s_lshl_b32 s34, s3, 11
    s_add_u32 s34, s34, 49152
    v_add_u32 v3, s34, v253
    v_mov_b32 v24, 0
    v_mov_b32 v25, 0
    v_mov_b32 v26, 0
    v_mov_b32 v27, 0
    v_mov_b32 v28, 0
    v_mov_b32 v29, 0
    v_mov_b32 v30, 0
    v_mov_b32 v31, 0
    v_mov_b32 v32, 0
    v_mov_b32 v33, 0
    v_mov_b32 v34, 0
    v_mov_b32 v35, 0
    v_mov_b32 v36, 0
    v_mov_b32 v37, 0
    v_mov_b32 v38, 0
    v_mov_b32 v39, 0
    s_lshr_b32 s36, s28, 1
    s_add_u32 s36, s36, s24
    s_sub_u32 s36, s36, 2
    s_cmp_lt_i32 s36, 0
    s_cbranch_scc1 sk_50
    s_and_b32 s34, s28, 1
    s_lshl_b32 s35, s25, 7
    s_lshl_b32 s30, s36, 2
    s_add_u32 s35, s35, s30
    s_lshl_b32 s30, s34, 1
    s_add_u32 s35, s35, s30
    s_lshl_b32 s35, s35, 12
    s_add_u32 s35, s35, s26
    s_lshl_b32 s30, s25, 8
    s_lshl_b32 s31, s36, 4
    s_add_u32 s30, s30, s31
    s_lshl_b32 s31, s34, 3
    s_add_u32 s30, s30, s31
    s_add_u32 s30, s30, s26
    s_add_u32 s30, s30, 0xdd0000
    v_and_b32 v40, 4, v252
    s_mov_b32 s78, s27
pl_51:
    buffer_load_dword v42, v40, s[20:23], s30 offen sc1
    s_waitcnt vmcnt(0)
pc_52:
    v_cmp_ne_u32 vcc, s88, v42
    s_cbranch_vccz pd_53
    s_sub_u32 s78, s78, 1
    s_cmp_lg_u32 s78, 0
    s_cbranch_scc1 pl_51
    s_mov_b32 s27, 1
pd_53:
sk_50:
    s_cmp_eq_u32 s100, 0
    s_cbranch_scc1 sk_54
    s_min_u32 s32, s28, 2
    s_lshl_b32 s32, s32, 12
    s_lshl_b32 s33, s25, 14
    s_add_u32 s32, s32, s33
    s_add_u32 s32, s32, 0x1d80000
    buffer_load_dwordx4 v[56:59], v253, s[20:23], s32 offen offset:0 sc1
    buffer_load_dwordx4 v[60:63], v253, s[20:23], s32 offen offset:1024 sc1
    buffer_load_dwordx4 v[64:67], v253, s[20:23], s32 offen offset:2048 sc1
    buffer_load_dwordx4 v[68:71], v253, s[20:23], s32 offen offset:3072 sc1
    s_mov_b32 s32, 0xdc4000
    buffer_load_dwordx4 v[72:75], v253, s[20:23], s32 offen offset:0 sc1
    buffer_load_dwordx4 v[76:79], v253, s[20:23], s32 offen offset:1024 sc1
sk_54:
    s_cmp_lt_i32 s36, 0
    s_cbranch_scc1 l_nohalo
    s_lshl_b32 s30, s28, 13
    s_add_u32 m0, s30, 65536
    s_add_u32 s31, s35, 0
    buffer_load_dwordx4 v253, s[20:23], s31 offen offset:0 sc1 lds
    buffer_load_dwordx4 v253, s[20:23], s31 offen offset:1024 sc1 lds
    s_add_u32 m0, s30, 69632
    s_add_u32 s31, s35, 4096
    buffer_load_dwordx4 v253, s[20:23], s31 offen offset:0 sc1 lds
    buffer_load_dwordx4 v253, s[20:23], s31 offen offset:1024 sc1 lds
    s_add_u32 m0, s30, 65536
    s_add_u32 s31, s35, 0
    buffer_load_dwordx4 v253, s[20:23], s31 offen offset:2048 sc1 lds
    buffer_load_dwordx4 v253, s[20:23], s31 offen offset:3072 sc1 lds
    s_add_u32 m0, s30, 69632
    s_add_u32 s31, s35, 4096
    buffer_load_dwordx4 v253, s[20:23], s31 offen offset:2048 sc1 lds
    buffer_load_dwordx4 v253, s[20:23], s31 offen offset:3072 sc1 lds
    s_add_u32 m0, s30, 114688
    s_add_u32 s31, s35, 262144
    buffer_load_dwordx4 v253, s[20:23], s31 offen offset:0 sc1 lds
    buffer_load_dwordx4 v253, s[20:23], s31 offen offset:1024 sc1 lds
    s_add_u32 m0, s30, 118784
    s_add_u32 s31, s35, 266240
    buffer_load_dwordx4 v253, s[20:23], s31 offen offset:0 sc1 lds
    buffer_load_dwordx4 v253, s[20:23], s31 offen offset:1024 sc1 lds
    s_add_u32 m0, s30, 114688
    s_add_u32 s31, s35, 262144
    buffer_load_dwordx4 v253, s[20:23], s31 offen offset:2048 sc1 lds
    buffer_load_dwordx4 v253, s[20:23], s31 offen offset:3072 sc1 lds
    s_add_u32 m0, s30, 118784
    s_add_u32 s31, s35, 266240
    buffer_load_dwordx4 v253, s[20:23], s31 offen offset:2048 sc1 lds
    buffer_load_dwordx4 v253, s[20:23], s31 offen offset:3072 sc1 lds
    s_branch l_halo
l_nohalo:
    s_waitcnt vmcnt(0)
l_halo:
    s_cmp_lg_u32 s100, 0
    s_cbranch_scc1 l_patch
    s_waitcnt vmcnt(12)
    s_barrier
l_patched:
    ds_read_b128 v[4:7], v3
    ds_read_b128 v[8:11], v3 offset:1024
    s_waitcnt vmcnt(0) lgkmcnt(0)
    s_barrier
    ds_read_b128 v[104:107], v20 offset:32768
    ds_read_b128 v[108:111], v20 offset:33792
    ds_read_b128 v[112:115], v20 offset:28672
    ds_read_b128 v[116:119], v20 offset:29696
    s_waitcnt lgkmcnt(2)
    v_mfma_f32_32x32x16_bf16 v[40:55], v[104:107], v[4:7], 0
    v_mfma_f32_32x32x16_bf16 v[40:55], v[108:111], v[8:11], v[40:55]
    s_cmp_lg_u32 s26, 0
    s_cbranch_scc1 sk_55
    s_xor_b32 s96, s29, 0
    s_and_b32 s97, s96, 2
    s_and_b32 s96, s96, 3
    s_mul_i32 s97, s97, 14336
    s_mul_i32 s96, s96, 14336
    s_add_u32 s96, s96, s97
    buffer_load_dwordx4 v[156:159], v155, s[80:83], s96 offen
sk_55:
    ds_read_b128 v[104:107], v20 offset:24576
    ds_read_b128 v[108:111], v20 offset:25600
    s_cmp_eq_u32 s99, 0
    s_cbranch_scc0 ng_56
    v_mov_b32 v24, 0xf149f2ca
    v_mov_b32 v25, 0xf149f2ca
    v_mov_b32 v26, 0xf149f2ca
    v_mov_b32 v27, 0xf149f2ca
    v_mov_b32 v28, 0xf149f2ca
    v_mov_b32 v29, 0xf149f2ca
    v_mov_b32 v30, 0xf149f2ca
    v_mov_b32 v31, 0xf149f2ca
    v_mov_b32 v32, 0xf149f2ca
    v_mov_b32 v33, 0xf149f2ca
    v_mov_b32 v34, 0xf149f2ca
    v_mov_b32 v35, 0xf149f2ca
    v_mov_b32 v36, 0xf149f2ca
    v_mov_b32 v37, 0xf149f2ca
    v_mov_b32 v38, 0xf149f2ca
    v_mov_b32 v39, 0xf149f2ca
ng_56:
    s_waitcnt lgkmcnt(2)
    s_nop 0
    v_mfma_f32_32x32x16_bf16 v[72:87], v[112:115], v[4:7], v[24:39]
    v_mfma_f32_32x32x16_bf16 v[72:87], v[116:119], v[8:11], v[72:87]
    s_cmp_lg_u32 s26, 0
    s_cbranch_scc1 sk_57
    s_xor_b32 s96, s29, 0
    s_and_b32 s97, s96, 2
    s_and_b32 s96, s96, 3
    s_mul_i32 s97, s97, 14336
    s_mul_i32 s96, s96, 14336
    s_add_u32 s96, s96, s97
    s_add_u32 s96, s96, 7168
    buffer_load_dwordx4 v[160:163], v155, s[80:83], s96 offen
sk_57:
    ds_read_b128 v[112:115], v20 offset:20480
    ds_read_b128 v[116:119], v20 offset:21504
    s_cmp_eq_u32 s99, 1
    s_cbranch_scc0 ng_58
    v_mov_b32 v24, 0xf149f2ca
    v_mov_b32 v25, 0xf149f2ca
    v_mov_b32 v26, 0xf149f2ca
    v_mov_b32 v27, 0xf149f2ca
    v_mov_b32 v28, 0xf149f2ca
    v_mov_b32 v29, 0xf149f2ca
    v_mov_b32 v30, 0xf149f2ca
    v_mov_b32 v31, 0xf149f2ca
    v_mov_b32 v32, 0xf149f2ca
    v_mov_b32 v33, 0xf149f2ca
    v_mov_b32 v34, 0xf149f2ca
    v_mov_b32 v35, 0xf149f2ca
    v_mov_b32 v36, 0xf149f2ca
    v_mov_b32 v37, 0xf149f2ca
    v_mov_b32 v38, 0xf149f2ca
    v_mov_b32 v39, 0xf149f2ca
ng_58:
    s_waitcnt lgkmcnt(2)
    s_nop 0
    v_mfma_f32_32x32x16_bf16 v[56:71], v[104:107], v[4:7], v[24:39]
    v_mfma_f32_32x32x16_bf16 v[56:71], v[108:111], v[8:11], v[56:71]
    s_nop 1
    v_max_f32 v21, v72, v73
    v_max3_f32 v21, v21, v74, v75
    v_max3_f32 v21, v21, v76, v77
    v_max3_f32 v21, v21, v78, v79
    v_max3_f32 v21, v21, v80, v81
    v_max3_f32 v21, v21, v82, v83
    v_max3_f32 v21, v21, v84, v85
    v_max3_f32 v21, v21, v86, v87
    s_cmp_lg_u32 s26, 0
    s_cbranch_scc1 sk_59
    s_xor_b32 s96, s29, 1
    s_and_b32 s97, s96, 2
    s_and_b32 s96, s96, 3
    s_mul_i32 s97, s97, 14336
    s_mul_i32 s96, s96, 14336
    s_add_u32 s96, s96, s97
    buffer_load_dwordx4 v[164:167], v155, s[80:83], s96 offen
sk_59:
    ds_read_b128 v[104:107], v20 offset:16384
    ds_read_b128 v[108:111], v20 offset:17408
    s_cmp_eq_u32 s99, 2
    s_cbranch_scc0 ng_60
    v_mov_b32 v24, 0xf149f2ca
    v_mov_b32 v25, 0xf149f2ca
    v_mov_b32 v26, 0xf149f2ca
    v_mov_b32 v27, 0xf149f2ca
    v_mov_b32 v28, 0xf149f2ca
    v_mov_b32 v29, 0xf149f2ca
    v_mov_b32 v30, 0xf149f2ca
    v_mov_b32 v31, 0xf149f2ca
    v_mov_b32 v32, 0xf149f2ca
    v_mov_b32 v33, 0xf149f2ca
    v_mov_b32 v34, 0xf149f2ca
    v_mov_b32 v35, 0xf149f2ca
    v_mov_b32 v36, 0xf149f2ca
    v_mov_b32 v37, 0xf149f2ca
    v_mov_b32 v38, 0xf149f2ca
    v_mov_b32 v39, 0xf149f2ca
ng_60:
    s_waitcnt lgkmcnt(2)
    s_nop 0
    v_mfma_f32_32x32x16_bf16 v[72:87], v[112:115], v[4:7], v[24:39]
    v_mfma_f32_32x32x16_bf16 v[72:87], v[116:119], v[8:11], v[72:87]
    v_max3_f32 v21, v21, v56, v57
    v_max3_f32 v21, v21, v58, v59
    v_max3_f32 v21, v21, v60, v61
    v_max3_f32 v21, v21, v62, v63
    v_max3_f32 v21, v21, v64, v65
    v_max3_f32 v21, v21, v66, v67
    v_max3_f32 v21, v21, v68, v69
    v_max3_f32 v21, v21, v70, v71
    s_cmp_lg_u32 s26, 0
    s_cbranch_scc1 sk_61
    s_xor_b32 s96, s29, 1
    s_and_b32 s97, s96, 2
    s_and_b32 s96, s96, 3
    s_mul_i32 s97, s97, 14336
    s_mul_i32 s96, s96, 14336
    s_add_u32 s96, s96, s97
    s_add_u32 s96, s96, 7168
    buffer_load_dwordx4 v[168:171], v155, s[80:83], s96 offen
sk_61:
    ds_read_b128 v[112:115], v20 offset:12288
    ds_read_b128 v[116:119], v20 offset:13312
    s_cmp_eq_u32 s99, 3
    s_cbranch_scc0 ng_62
    v_mov_b32 v24, 0xf149f2ca
    v_mov_b32 v25, 0xf149f2ca
    v_mov_b32 v26, 0xf149f2ca
    v_mov_b32 v27, 0xf149f2ca
    v_mov_b32 v28, 0xf149f2ca
    v_mov_b32 v29, 0xf149f2ca
    v_mov_b32 v30, 0xf149f2ca
    v_mov_b32 v31, 0xf149f2ca
    v_mov_b32 v32, 0xf149f2ca
    v_mov_b32 v33, 0xf149f2ca
    v_mov_b32 v34, 0xf149f2ca
    v_mov_b32 v35, 0xf149f2ca
    v_mov_b32 v36, 0xf149f2ca
    v_mov_b32 v37, 0xf149f2ca
    v_mov_b32 v38, 0xf149f2ca
    v_mov_b32 v39, 0xf149f2ca
ng_62:
    s_waitcnt lgkmcnt(2)
    s_nop 0
    v_mfma_f32_32x32x16_bf16 v[56:71], v[104:107], v[4:7], v[24:39]
    v_mfma_f32_32x32x16_bf16 v[56:71], v[108:111], v[8:11], v[56:71]
    v_max3_f32 v21, v21, v72, v73
    v_max3_f32 v21, v21, v74, v75
    v_max3_f32 v21, v21, v76, v77
    v_max3_f32 v21, v21, v78, v79
    v_max3_f32 v21, v21, v80, v81
    v_max3_f32 v21, v21, v82, v83
    v_max3_f32 v21, v21, v84, v85
    v_max3_f32 v21, v21, v86, v87
    s_cmp_lg_u32 s26, 0
    s_cbranch_scc1 sk_63
    s_xor_b32 s96, s29, 2
    s_and_b32 s97, s96, 2
    s_and_b32 s96, s96, 3
    s_mul_i32 s97, s97, 14336
    s_mul_i32 s96, s96, 14336
    s_add_u32 s96, s96, s97
    buffer_load_dwordx4 v[172:175], v155, s[80:83], s96 offen
sk_63:
    ds_read_b128 v[104:107], v20 offset:8192
    ds_read_b128 v[108:111], v20 offset:9216
    s_cmp_eq_u32 s99, 4
    s_cbranch_scc0 ng_64
    v_mov_b32 v24, 0xf149f2ca
    v_mov_b32 v25, 0xf149f2ca
    v_mov_b32 v26, 0xf149f2ca
    v_mov_b32 v27, 0xf149f2ca
    v_mov_b32 v28, 0xf149f2ca
    v_mov_b32 v29, 0xf149f2ca
    v_mov_b32 v30, 0xf149f2ca
    v_mov_b32 v31, 0xf149f2ca
    v_mov_b32 v32, 0xf149f2ca
    v_mov_b32 v33, 0xf149f2ca
    v_mov_b32 v34, 0xf149f2ca
    v_mov_b32 v35, 0xf149f2ca
    v_mov_b32 v36, 0xf149f2ca
    v_mov_b32 v37, 0xf149f2ca
    v_mov_b32 v38, 0xf149f2ca
    v_mov_b32 v39, 0xf149f2ca
ng_64:
    s_waitcnt lgkmcnt(2)
    s_nop 0
    v_mfma_f32_32x32x16_bf16 v[72:87], v[112:115], v[4:7], v[24:39]
    v_mfma_f32_32x32x16_bf16 v[72:87], v[116:119], v[8:11], v[72:87]
    v_max3_f32 v21, v21, v56, v57
    v_max3_f32 v21, v21, v58, v59
    v_max3_f32 v21, v21, v60, v61
    v_max3_f32 v21, v21, v62, v63
    v_max3_f32 v21, v21, v64, v65
    v_max3_f32 v21, v21, v66, v67
    v_max3_f32 v21, v21, v68, v69
    v_max3_f32 v21, v21, v70, v71
    s_cmp_lg_u32 s26, 0
    s_cbranch_scc1 sk_65
    s_xor_b32 s96, s29, 2
    s_and_b32 s97, s96, 2
    s_and_b32 s96, s96, 3
    s_mul_i32 s97, s97, 14336
    s_mul_i32 s96, s96, 14336
    s_add_u32 s96, s96, s97
    s_add_u32 s96, s96, 7168
    buffer_load_dwordx4 v[176:179], v155, s[80:83], s96 offen
sk_65:
    ds_read_b128 v[112:115], v20 offset:4096
    ds_read_b128 v[116:119], v20 offset:5120
    s_cmp_eq_u32 s99, 5
    s_cbranch_scc0 ng_66
    v_mov_b32 v24, 0xf149f2ca
    v_mov_b32 v25, 0xf149f2ca
    v_mov_b32 v26, 0xf149f2ca
    v_mov_b32 v27, 0xf149f2ca
    v_mov_b32 v28, 0xf149f2ca
    v_mov_b32 v29, 0xf149f2ca
    v_mov_b32 v30, 0xf149f2ca
    v_mov_b32 v31, 0xf149f2ca
    v_mov_b32 v32, 0xf149f2ca
    v_mov_b32 v33, 0xf149f2ca
    v_mov_b32 v34, 0xf149f2ca
    v_mov_b32 v35, 0xf149f2ca
    v_mov_b32 v36, 0xf149f2ca
    v_mov_b32 v37, 0xf149f2ca
    v_mov_b32 v38, 0xf149f2ca
    v_mov_b32 v39, 0xf149f2ca
ng_66:
    s_waitcnt lgkmcnt(2)
    s_nop 0
    v_mfma_f32_32x32x16_bf16 v[56:71], v[104:107], v[4:7], v[24:39]
    v_mfma_f32_32x32x16_bf16 v[56:71], v[108:111], v[8:11], v[56:71]
    v_max3_f32 v21, v21, v72, v73
    v_max3_f32 v21, v21, v74, v75
    v_max3_f32 v21, v21, v76, v77
    v_max3_f32 v21, v21, v78, v79
    v_max3_f32 v21, v21, v80, v81
    v_max3_f32 v21, v21, v82, v83
    v_max3_f32 v21, v21, v84, v85
    v_max3_f32 v21, v21, v86, v87
    s_cmp_lg_u32 s26, 0
    s_cbranch_scc1 sk_67
    s_xor_b32 s96, s29, 3
    s_and_b32 s97, s96, 2
    s_and_b32 s96, s96, 3
    s_mul_i32 s97, s97, 14336
    s_mul_i32 s96, s96, 14336
    s_add_u32 s96, s96, s97
    buffer_load_dwordx4 v[180:183], v155, s[80:83], s96 offen
sk_67:
    ds_read_b128 v[104:107], v20 offset:0
    ds_read_b128 v[108:111], v20 offset:1024
    s_cmp_eq_u32 s99, 6
    s_cbranch_scc0 ng_68
    v_mov_b32 v24, 0xf149f2ca
    v_mov_b32 v25, 0xf149f2ca
    v_mov_b32 v26, 0xf149f2ca
    v_mov_b32 v27, 0xf149f2ca
    v_mov_b32 v28, 0xf149f2ca
    v_mov_b32 v29, 0xf149f2ca
    v_mov_b32 v30, 0xf149f2ca
    v_mov_b32 v31, 0xf149f2ca
    v_mov_b32 v32, 0xf149f2ca
    v_mov_b32 v33, 0xf149f2ca
    v_mov_b32 v34, 0xf149f2ca
    v_mov_b32 v35, 0xf149f2ca
    v_mov_b32 v36, 0xf149f2ca
    v_mov_b32 v37, 0xf149f2ca
    v_mov_b32 v38, 0xf149f2ca
    v_mov_b32 v39, 0xf149f2ca
ng_68:
    s_waitcnt lgkmcnt(2)
    s_nop 0
    v_mfma_f32_32x32x16_bf16 v[72:87], v[112:115], v[4:7], v[24:39]
    v_mfma_f32_32x32x16_bf16 v[72:87], v[116:119], v[8:11], v[72:87]
    v_max3_f32 v21, v21, v56, v57
    v_max3_f32 v21, v21, v58, v59
    v_max3_f32 v21, v21, v60, v61
    v_max3_f32 v21, v21, v62, v63
    v_max3_f32 v21, v21, v64, v65
    v_max3_f32 v21, v21, v66, v67
    v_max3_f32 v21, v21, v68, v69
    v_max3_f32 v21, v21, v70, v71
    s_cmp_lg_u32 s26, 0
    s_cbranch_scc1 sk_69
    s_xor_b32 s96, s29, 3
    s_and_b32 s97, s96, 2
    s_and_b32 s96, s96, 3
    s_mul_i32 s97, s97, 14336
    s_mul_i32 s96, s96, 14336
    s_add_u32 s96, s96, s97
    s_add_u32 s96, s96, 7168
    buffer_load_dwordx4 v[184:187], v155, s[80:83], s96 offen
sk_69:
    s_cmp_eq_u32 s99, 7
    s_cbranch_scc0 ng_70
    v_mov_b32 v24, 0xf149f2ca
    v_mov_b32 v25, 0xf149f2ca
    v_mov_b32 v26, 0xf149f2ca
    v_mov_b32 v27, 0xf149f2ca
    v_mov_b32 v28, 0xf149f2ca
    v_mov_b32 v29, 0xf149f2ca
    v_mov_b32 v30, 0xf149f2ca
    v_mov_b32 v31, 0xf149f2ca
    v_mov_b32 v32, 0xf149f2ca
    v_mov_b32 v33, 0xf149f2ca
    v_mov_b32 v34, 0xf149f2ca
    v_mov_b32 v35, 0xf149f2ca
    v_mov_b32 v36, 0xf149f2ca
    v_mov_b32 v37, 0xf149f2ca
    v_mov_b32 v38, 0xf149f2ca
    v_mov_b32 v39, 0xf149f2ca
ng_70:
    s_waitcnt lgkmcnt(0)
    s_nop 0
    v_mfma_f32_32x32x16_bf16 v[56:71], v[104:107], v[4:7], v[24:39]
    v_mfma_f32_32x32x16_bf16 v[56:71], v[108:111], v[8:11], v[56:71]
    v_max3_f32 v21, v21, v72, v73
    v_max3_f32 v21, v21, v74, v75
    v_max3_f32 v21, v21, v76, v77
    v_max3_f32 v21, v21, v78, v79
    v_max3_f32 v21, v21, v80, v81
    v_max3_f32 v21, v21, v82, v83
    v_max3_f32 v21, v21, v84, v85
    v_max3_f32 v21, v21, v86, v87
    s_cmp_lg_u32 s26, 0
    s_cbranch_scc1 sk_71
    s_xor_b32 s96, s29, 0
    s_and_b32 s97, s96, 2
    s_and_b32 s96, s96, 3
    s_mul_i32 s97, s97, 14336
    s_mul_i32 s96, s96, 14336
    s_add_u32 s96, s96, s97
    buffer_load_dwordx4 v[188:191], v155, s[4:7], s96 offen
sk_71:
    ds_read_b128 v[112:115], v20 offset:28672
    ds_read_b128 v[116:119], v20 offset:29696
    ds_read_b128 v[120:123], v20 offset:34816
    ds_read_b128 v[124:127], v20 offset:35840
    ds_read_b128 v[128:131], v20 offset:2048
    ds_read_b128 v[132:135], v20 offset:3072
    v_cndmask_b32 v40, v56, v40, s[40:41]
    v_cndmask_b32 v41, v57, v41, s[42:43]
    v_cndmask_b32 v42, v58, v42, s[44:45]
    v_cndmask_b32 v43, v59, v43, s[46:47]
    v_cndmask_b32 v44, v60, v44, s[48:49]
    v_cndmask_b32 v45, v61, v45, s[50:51]
    v_cndmask_b32 v46, v62, v46, s[52:53]
    v_cndmask_b32 v47, v63, v47, s[54:55]
    v_cndmask_b32 v48, v64, v48, s[56:57]
    v_cndmask_b32 v49, v65, v49, s[58:59]
    v_cndmask_b32 v50, v66, v50, s[60:61]
    v_cndmask_b32 v51, v67, v51, s[62:63]
    v_cndmask_b32 v52, v68, v52, s[64:65]
    v_cndmask_b32 v53, v69, v53, s[66:67]
    v_cndmask_b32 v54, v70, v54, s[68:69]
    v_cndmask_b32 v55, v71, v55, s[70:71]
    v_max3_f32 v21, v21, v40, v41
    v_max3_f32 v21, v21, v42, v43
    v_max3_f32 v21, v21, v44, v45
    v_max3_f32 v21, v21, v46, v47
    v_max3_f32 v21, v21, v48, v49
    v_max3_f32 v21, v21, v50, v51
    v_max3_f32 v21, v21, v52, v53
    v_max3_f32 v21, v21, v54, v55
    v_mov_b32 v152, v21
    s_nop 1
    v_permlane32_swap_b32 v21, v152
    v_max_f32 v21, v21, v152
    v_sub_f32 v24, 0, v21
    v_sub_f32 v25, 0, v21
    v_sub_f32 v26, 0, v21
    v_sub_f32 v27, 0, v21
    v_sub_f32 v28, 0, v21
    v_sub_f32 v29, 0, v21
    v_sub_f32 v30, 0, v21
    v_sub_f32 v31, 0, v21
    v_sub_f32 v32, 0, v21
    v_sub_f32 v33, 0, v21
    v_sub_f32 v34, 0, v21
    v_sub_f32 v35, 0, v21
    v_sub_f32 v36, 0, v21
    v_sub_f32 v37, 0, v21
    v_sub_f32 v38, 0, v21
    v_sub_f32 v39, 0, v21
    s_cmp_eq_u32 s99, 0
    s_cbranch_scc0 ng_72
    v_mov_b32 v24, 0xf149f2ca
    v_mov_b32 v25, 0xf149f2ca
    v_mov_b32 v26, 0xf149f2ca
    v_mov_b32 v27, 0xf149f2ca
    v_mov_b32 v28, 0xf149f2ca
    v_mov_b32 v29, 0xf149f2ca
    v_mov_b32 v30, 0xf149f2ca
    v_mov_b32 v31, 0xf149f2ca
    v_mov_b32 v32, 0xf149f2ca
    v_mov_b32 v33, 0xf149f2ca
    v_mov_b32 v34, 0xf149f2ca
    v_mov_b32 v35, 0xf149f2ca
    v_mov_b32 v36, 0xf149f2ca
    v_mov_b32 v37, 0xf149f2ca
    v_mov_b32 v38, 0xf149f2ca
    v_mov_b32 v39, 0xf149f2ca
ng_72:
    s_waitcnt lgkmcnt(4)
    s_nop 0
    v_mfma_f32_32x32x16_bf16 v[72:87], v[112:115], v[4:7], v[24:39]
    v_mfma_f32_32x32x16_bf16 v[72:87], v[116:119], v[8:11], v[72:87]
    ds_read_b128 v[104:107], v20 offset:24576
    ds_read_b128 v[108:111], v20 offset:25600
    v_sub_f32 v40, v40, v21
    v_sub_f32 v41, v41, v21
    v_sub_f32 v42, v42, v21
    v_sub_f32 v43, v43, v21
    v_sub_f32 v44, v44, v21
    v_sub_f32 v45, v45, v21
    v_sub_f32 v46, v46, v21
    v_sub_f32 v47, v47, v21
    v_sub_f32 v48, v48, v21
    v_sub_f32 v49, v49, v21
    v_sub_f32 v50, v50, v21
    v_sub_f32 v51, v51, v21
    v_sub_f32 v52, v52, v21
    v_sub_f32 v53, v53, v21
    v_sub_f32 v54, v54, v21
    v_sub_f32 v55, v55, v21
    v_exp_f32 v40, v40
    v_exp_f32 v41, v41
    v_exp_f32 v42, v42
    v_exp_f32 v43, v43
    v_exp_f32 v44, v44
    v_exp_f32 v45, v45
    v_exp_f32 v46, v46
    v_exp_f32 v47, v47
    v_exp_f32 v48, v48
    v_exp_f32 v49, v49
    v_exp_f32 v50, v50
    v_exp_f32 v51, v51
    v_exp_f32 v52, v52
    v_exp_f32 v53, v53
    v_exp_f32 v54, v54
    v_exp_f32 v55, v55
    v_add_f32 v22, v40, v41
    v_add_f32 v23, v42, v43
    v_add_f32 v22, v22, v44
    v_add_f32 v23, v23, v45
    v_add_f32 v22, v22, v46
    v_add_f32 v23, v23, v47
    v_add_f32 v22, v22, v48
    v_add_f32 v23, v23, v49
    v_add_f32 v22, v22, v50
    v_add_f32 v23, v23, v51
    v_add_f32 v22, v22, v52
    v_add_f32 v23, v23, v53
    v_add_f32 v22, v22, v54
    v_add_f32 v23, v23, v55
    v_cvt_pk_bf16_f32 v144, v40, v41
    v_cvt_pk_bf16_f32 v145, v42, v43
    v_cvt_pk_bf16_f32 v146, v44, v45
    v_cvt_pk_bf16_f32 v147, v46, v47
    v_cvt_pk_bf16_f32 v148, v48, v49
    v_cvt_pk_bf16_f32 v149, v50, v51
    v_cvt_pk_bf16_f32 v150, v52, v53
    v_cvt_pk_bf16_f32 v151, v54, v55
    v_and_b32 v136, v144, v12
    v_and_b32 v137, v145, v13
    v_and_b32 v138, v146, v14
    v_and_b32 v139, v147, v15
    v_and_b32 v140, v148, v16
    v_and_b32 v141, v149, v17
    v_and_b32 v142, v150, v18
    v_and_b32 v143, v151, v19
    v_xor_b32 v144, v144, v136
    v_xor_b32 v145, v145, v137
    v_xor_b32 v146, v146, v138
    v_xor_b32 v147, v147, v139
    v_xor_b32 v148, v148, v140
    v_xor_b32 v149, v149, v141
    v_xor_b32 v150, v150, v142
    v_xor_b32 v151, v151, v143
    s_waitcnt lgkmcnt(2)
    v_mfma_f32_32x32x16_bf16 v[88:103], v[120:123], v[136:139], 0
    v_mfma_f32_32x32x16_bf16 v[88:103], v[124:127], v[140:143], v[88:103]
    v_mfma_f32_32x32x16_bf16 v[88:103], v[128:131], v[144:147], v[88:103]
    v_mfma_f32_32x32x16_bf16 v[88:103], v[132:135], v[148:151], v[88:103]
    s_cmp_lg_u32 s26, 0
    s_cbranch_scc1 sk_73
    s_xor_b32 s96, s29, 0
    s_and_b32 s97, s96, 2
    s_and_b32 s96, s96, 3
    s_mul_i32 s97, s97, 14336
    s_mul_i32 s96, s96, 14336
    s_add_u32 s96, s96, s97
    s_add_u32 s96, s96, 7168
    buffer_load_dwordx4 v[192:195], v155, s[4:7], s96 offen
sk_73:
    ds_read_b128 v[128:131], v20 offset:30720
    ds_read_b128 v[132:135], v20 offset:31744
    s_cmp_eq_u32 s99, 1
    s_cbranch_scc0 ng_74
    v_mov_b32 v24, 0xf149f2ca
    v_mov_b32 v25, 0xf149f2ca
    v_mov_b32 v26, 0xf149f2ca
    v_mov_b32 v27, 0xf149f2ca
    v_mov_b32 v28, 0xf149f2ca
    v_mov_b32 v29, 0xf149f2ca
    v_mov_b32 v30, 0xf149f2ca
    v_mov_b32 v31, 0xf149f2ca
    v_mov_b32 v32, 0xf149f2ca
    v_mov_b32 v33, 0xf149f2ca
    v_mov_b32 v34, 0xf149f2ca
    v_mov_b32 v35, 0xf149f2ca
    v_mov_b32 v36, 0xf149f2ca
    v_mov_b32 v37, 0xf149f2ca
    v_mov_b32 v38, 0xf149f2ca
    v_mov_b32 v39, 0xf149f2ca
ng_74:
    s_waitcnt lgkmcnt(2)
    s_nop 0
    v_mfma_f32_32x32x16_bf16 v[56:71], v[104:107], v[4:7], v[24:39]
    v_mfma_f32_32x32x16_bf16 v[56:71], v[108:111], v[8:11], v[56:71]
    ds_read_b128 v[112:115], v20 offset:20480
    ds_read_b128 v[116:119], v20 offset:21504
    v_exp_f32 v72, v72
    v_exp_f32 v73, v73
    v_exp_f32 v74, v74
    v_exp_f32 v75, v75
    v_exp_f32 v76, v76
    v_exp_f32 v77, v77
    v_exp_f32 v78, v78
    v_exp_f32 v79, v79
    v_exp_f32 v80, v80
    v_exp_f32 v81, v81
    v_exp_f32 v82, v82
    v_exp_f32 v83, v83
    v_exp_f32 v84, v84
    v_exp_f32 v85, v85
    v_exp_f32 v86, v86
    v_exp_f32 v87, v87
    v_add_f32 v22, v22, v72
    v_add_f32 v23, v23, v73
    v_add_f32 v22, v22, v74
    v_add_f32 v23, v23, v75
    v_add_f32 v22, v22, v76
    v_add_f32 v23, v23, v77
    v_add_f32 v22, v22, v78
    v_add_f32 v23, v23, v79
    v_add_f32 v22, v22, v80
    v_add_f32 v23, v23, v81
    v_add_f32 v22, v22, v82
    v_add_f32 v23, v23, v83
    v_add_f32 v22, v22, v84
    v_add_f32 v23, v23, v85
    v_add_f32 v22, v22, v86
    v_add_f32 v23, v23, v87
    v_cvt_pk_bf16_f32 v144, v72, v73
    v_cvt_pk_bf16_f32 v145, v74, v75
    v_cvt_pk_bf16_f32 v146, v76, v77
    v_cvt_pk_bf16_f32 v147, v78, v79
    v_cvt_pk_bf16_f32 v148, v80, v81
    v_cvt_pk_bf16_f32 v149, v82, v83
    v_cvt_pk_bf16_f32 v150, v84, v85
    v_cvt_pk_bf16_f32 v151, v86, v87
    s_waitcnt lgkmcnt(2)
    v_mfma_f32_32x32x16_bf16 v[88:103], v[128:131], v[144:147], v[88:103]
    v_mfma_f32_32x32x16_bf16 v[88:103], v[132:135], v[148:151], v[88:103]
    s_cmp_lg_u32 s26, 0
    s_cbranch_scc1 sk_75
    s_xor_b32 s96, s29, 1
    s_and_b32 s97, s96, 2
    s_and_b32 s96, s96, 3
    s_mul_i32 s97, s97, 14336
    s_mul_i32 s96, s96, 14336
    s_add_u32 s96, s96, s97
    buffer_load_dwordx4 v[196:199], v155, s[4:7], s96 offen
sk_75:
    ds_read_b128 v[120:123], v20 offset:26624
    ds_read_b128 v[124:127], v20 offset:27648
    s_cmp_eq_u32 s99, 2
    s_cbranch_scc0 ng_76
    v_mov_b32 v24, 0xf149f2ca
    v_mov_b32 v25, 0xf149f2ca
    v_mov_b32 v26, 0xf149f2ca
    v_mov_b32 v27, 0xf149f2ca
    v_mov_b32 v28, 0xf149f2ca
    v_mov_b32 v29, 0xf149f2ca
    v_mov_b32 v30, 0xf149f2ca
    v_mov_b32 v31, 0xf149f2ca
    v_mov_b32 v32, 0xf149f2ca
    v_mov_b32 v33, 0xf149f2ca
    v_mov_b32 v34, 0xf149f2ca
    v_mov_b32 v35, 0xf149f2ca
    v_mov_b32 v36, 0xf149f2ca
    v_mov_b32 v37, 0xf149f2ca
    v_mov_b32 v38, 0xf149f2ca
    v_mov_b32 v39, 0xf149f2ca
ng_76:
    s_waitcnt lgkmcnt(2)
    s_nop 0
    v_mfma_f32_32x32x16_bf16 v[72:87], v[112:115], v[4:7], v[24:39]
    v_mfma_f32_32x32x16_bf16 v[72:87], v[116:119], v[8:11], v[72:87]
    ds_read_b128 v[104:107], v20 offset:16384
    ds_read_b128 v[108:111], v20 offset:17408
    v_exp_f32 v56, v56
    v_exp_f32 v57, v57
    v_exp_f32 v58, v58
    v_exp_f32 v59, v59
    v_exp_f32 v60, v60
    v_exp_f32 v61, v61
    v_exp_f32 v62, v62
    v_exp_f32 v63, v63
    v_exp_f32 v64, v64
    v_exp_f32 v65, v65
    v_exp_f32 v66, v66
    v_exp_f32 v67, v67
    v_exp_f32 v68, v68
    v_exp_f32 v69, v69
    v_exp_f32 v70, v70
    v_exp_f32 v71, v71
    v_add_f32 v22, v22, v56
    v_add_f32 v23, v23, v57
    v_add_f32 v22, v22, v58
    v_add_f32 v23, v23, v59
    v_add_f32 v22, v22, v60
    v_add_f32 v23, v23, v61
    v_add_f32 v22, v22, v62
    v_add_f32 v23, v23, v63
    v_add_f32 v22, v22, v64
    v_add_f32 v23, v23, v65
    v_add_f32 v22, v22, v66
    v_add_f32 v23, v23, v67
    v_add_f32 v22, v22, v68
    v_add_f32 v23, v23, v69
    v_add_f32 v22, v22, v70
    v_add_f32 v23, v23, v71
    v_cvt_pk_bf16_f32 v136, v56, v57
    v_cvt_pk_bf16_f32 v137, v58, v59
    v_cvt_pk_bf16_f32 v138, v60, v61
    v_cvt_pk_bf16_f32 v139, v62, v63
    v_cvt_pk_bf16_f32 v140, v64, v65
    v_cvt_pk_bf16_f32 v141, v66, v67
    v_cvt_pk_bf16_f32 v142, v68, v69
    v_cvt_pk_bf16_f32 v143, v70, v71
    s_waitcnt lgkmcnt(2)
    v_mfma_f32_32x32x16_bf16 v[88:103], v[120:123], v[136:139], v[88:103]
    v_mfma_f32_32x32x16_bf16 v[88:103], v[124:127], v[140:143], v[88:103]
    s_cmp_lg_u32 s26, 0
    s_cbranch_scc1 sk_77
    s_xor_b32 s96, s29, 1
    s_and_b32 s97, s96, 2
    s_and_b32 s96, s96, 3
    s_mul_i32 s97, s97, 14336
    s_mul_i32 s96, s96, 14336
    s_add_u32 s96, s96, s97
    s_add_u32 s96, s96, 7168
    buffer_load_dwordx4 v[200:203], v155, s[4:7], s96 offen
sk_77:
    ds_read_b128 v[128:131], v20 offset:22528
    ds_read_b128 v[132:135], v20 offset:23552
    s_cmp_eq_u32 s99, 3
    s_cbranch_scc0 ng_78
    v_mov_b32 v24, 0xf149f2ca
    v_mov_b32 v25, 0xf149f2ca
    v_mov_b32 v26, 0xf149f2ca
    v_mov_b32 v27, 0xf149f2ca
    v_mov_b32 v28, 0xf149f2ca
    v_mov_b32 v29, 0xf149f2ca
    v_mov_b32 v30, 0xf149f2ca
    v_mov_b32 v31, 0xf149f2ca
    v_mov_b32 v32, 0xf149f2ca
    v_mov_b32 v33, 0xf149f2ca
    v_mov_b32 v34, 0xf149f2ca
    v_mov_b32 v35, 0xf149f2ca
    v_mov_b32 v36, 0xf149f2ca
    v_mov_b32 v37, 0xf149f2ca
    v_mov_b32 v38, 0xf149f2ca
    v_mov_b32 v39, 0xf149f2ca
ng_78:
    s_waitcnt lgkmcnt(2)
    s_nop 0
    v_mfma_f32_32x32x16_bf16 v[56:71], v[104:107], v[4:7], v[24:39]
    v_mfma_f32_32x32x16_bf16 v[56:71], v[108:111], v[8:11], v[56:71]
    ds_read_b128 v[112:115], v20 offset:12288
    ds_read_b128 v[116:119], v20 offset:13312
    v_exp_f32 v72, v72
    v_exp_f32 v73, v73
    v_exp_f32 v74, v74
    v_exp_f32 v75, v75
    v_exp_f32 v76, v76
    v_exp_f32 v77, v77
    v_exp_f32 v78, v78
    v_exp_f32 v79, v79
    v_exp_f32 v80, v80
    v_exp_f32 v81, v81
    v_exp_f32 v82, v82
    v_exp_f32 v83, v83
    v_exp_f32 v84, v84
    v_exp_f32 v85, v85
    v_exp_f32 v86, v86
    v_exp_f32 v87, v87
    v_add_f32 v22, v22, v72
    v_add_f32 v23, v23, v73
    v_add_f32 v22, v22, v74
    v_add_f32 v23, v23, v75
    v_add_f32 v22, v22, v76
    v_add_f32 v23, v23, v77
    v_add_f32 v22, v22, v78
    v_add_f32 v23, v23, v79
    v_add_f32 v22, v22, v80
    v_add_f32 v23, v23, v81
    v_add_f32 v22, v22, v82
    v_add_f32 v23, v23, v83
    v_add_f32 v22, v22, v84
    v_add_f32 v23, v23, v85
    v_add_f32 v22, v22, v86
    v_add_f32 v23, v23, v87
    v_cvt_pk_bf16_f32 v144, v72, v73
    v_cvt_pk_bf16_f32 v145, v74, v75
    v_cvt_pk_bf16_f32 v146, v76, v77
    v_cvt_pk_bf16_f32 v147, v78, v79
    v_cvt_pk_bf16_f32 v148, v80, v81
    v_cvt_pk_bf16_f32 v149, v82, v83
    v_cvt_pk_bf16_f32 v150, v84, v85
    v_cvt_pk_bf16_f32 v151, v86, v87
    s_waitcnt lgkmcnt(2)
    v_mfma_f32_32x32x16_bf16 v[88:103], v[128:131], v[144:147], v[88:103]
    v_mfma_f32_32x32x16_bf16 v[88:103], v[132:135], v[148:151], v[88:103]
    s_cmp_lg_u32 s26, 0
    s_cbranch_scc1 sk_79
    s_xor_b32 s96, s29, 2
    s_and_b32 s97, s96, 2
    s_and_b32 s96, s96, 3
    s_mul_i32 s97, s97, 14336
    s_mul_i32 s96, s96, 14336
    s_add_u32 s96, s96, s97
    buffer_load_dwordx4 v[204:207], v155, s[4:7], s96 offen
sk_79:
    ds_read_b128 v[120:123], v20 offset:18432
    ds_read_b128 v[124:127], v20 offset:19456
    s_cmp_eq_u32 s99, 4
    s_cbranch_scc0 ng_80
    v_mov_b32 v24, 0xf149f2ca
    v_mov_b32 v25, 0xf149f2ca
    v_mov_b32 v26, 0xf149f2ca
    v_mov_b32 v27, 0xf149f2ca
    v_mov_b32 v28, 0xf149f2ca
    v_mov_b32 v29, 0xf149f2ca
    v_mov_b32 v30, 0xf149f2ca
    v_mov_b32 v31, 0xf149f2ca
    v_mov_b32 v32, 0xf149f2ca
    v_mov_b32 v33, 0xf149f2ca
    v_mov_b32 v34, 0xf149f2ca
    v_mov_b32 v35, 0xf149f2ca
    v_mov_b32 v36, 0xf149f2ca
    v_mov_b32 v37, 0xf149f2ca
    v_mov_b32 v38, 0xf149f2ca
    v_mov_b32 v39, 0xf149f2ca
ng_80:
    s_waitcnt lgkmcnt(2)
    s_nop 0
    v_mfma_f32_32x32x16_bf16 v[72:87], v[112:115], v[4:7], v[24:39]
    v_mfma_f32_32x32x16_bf16 v[72:87], v[116:119], v[8:11], v[72:87]
    ds_read_b128 v[104:107], v20 offset:8192
    ds_read_b128 v[108:111], v20 offset:9216
    v_exp_f32 v56, v56
    v_exp_f32 v57, v57
    v_exp_f32 v58, v58
    v_exp_f32 v59, v59
    v_exp_f32 v60, v60
    v_exp_f32 v61, v61
    v_exp_f32 v62, v62
    v_exp_f32 v63, v63
    v_exp_f32 v64, v64
    v_exp_f32 v65, v65
    v_exp_f32 v66, v66
    v_exp_f32 v67, v67
    v_exp_f32 v68, v68
    v_exp_f32 v69, v69
    v_exp_f32 v70, v70
    v_exp_f32 v71, v71
    v_add_f32 v22, v22, v56
    v_add_f32 v23, v23, v57
    v_add_f32 v22, v22, v58
    v_add_f32 v23, v23, v59
    v_add_f32 v22, v22, v60
    v_add_f32 v23, v23, v61
    v_add_f32 v22, v22, v62
    v_add_f32 v23, v23, v63
    v_add_f32 v22, v22, v64
    v_add_f32 v23, v23, v65
    v_add_f32 v22, v22, v66
    v_add_f32 v23, v23, v67
    v_add_f32 v22, v22, v68
    v_add_f32 v23, v23, v69
    v_add_f32 v22, v22, v70
    v_add_f32 v23, v23, v71
    v_cvt_pk_bf16_f32 v136, v56, v57
    v_cvt_pk_bf16_f32 v137, v58, v59
    v_cvt_pk_bf16_f32 v138, v60, v61
    v_cvt_pk_bf16_f32 v139, v62, v63
    v_cvt_pk_bf16_f32 v140, v64, v65
    v_cvt_pk_bf16_f32 v141, v66, v67
    v_cvt_pk_bf16_f32 v142, v68, v69
    v_cvt_pk_bf16_f32 v143, v70, v71
    s_waitcnt lgkmcnt(2)
    v_mfma_f32_32x32x16_bf16 v[88:103], v[120:123], v[136:139], v[88:103]
    v_mfma_f32_32x32x16_bf16 v[88:103], v[124:127], v[140:143], v[88:103]
    s_barrier
    s_cmp_lg_u32 s26, 0
    s_cbranch_scc1 sk_81
    s_xor_b32 s96, s29, 2
    s_and_b32 s97, s96, 2
    s_and_b32 s96, s96, 3
    s_mul_i32 s97, s97, 14336
    s_mul_i32 s96, s96, 14336
    s_add_u32 s96, s96, s97
    s_add_u32 s96, s96, 7168
    buffer_load_dwordx4 v[208:211], v155, s[4:7], s96 offen
sk_81:
    ds_read_b128 v[128:131], v20 offset:14336
    ds_read_b128 v[132:135], v20 offset:15360
    s_cmp_eq_u32 s99, 5
    s_cbranch_scc0 ng_82
    v_mov_b32 v24, 0xf149f2ca
    v_mov_b32 v25, 0xf149f2ca
    v_mov_b32 v26, 0xf149f2ca
    v_mov_b32 v27, 0xf149f2ca
    v_mov_b32 v28, 0xf149f2ca
    v_mov_b32 v29, 0xf149f2ca
    v_mov_b32 v30, 0xf149f2ca
    v_mov_b32 v31, 0xf149f2ca
    v_mov_b32 v32, 0xf149f2ca
    v_mov_b32 v33, 0xf149f2ca
    v_mov_b32 v34, 0xf149f2ca
    v_mov_b32 v35, 0xf149f2ca
    v_mov_b32 v36, 0xf149f2ca
    v_mov_b32 v37, 0xf149f2ca
    v_mov_b32 v38, 0xf149f2ca
    v_mov_b32 v39, 0xf149f2ca
ng_82:
    s_waitcnt lgkmcnt(2)
    s_nop 0
    v_mfma_f32_32x32x16_bf16 v[56:71], v[104:107], v[4:7], v[24:39]
    v_mfma_f32_32x32x16_bf16 v[56:71], v[108:111], v[8:11], v[56:71]
    ds_read_b128 v[112:115], v20 offset:4096
    ds_read_b128 v[116:119], v20 offset:5120
    v_exp_f32 v72, v72
    v_exp_f32 v73, v73
    v_exp_f32 v74, v74
    v_exp_f32 v75, v75
    v_exp_f32 v76, v76
    v_exp_f32 v77, v77
    v_exp_f32 v78, v78
    v_exp_f32 v79, v79
    v_exp_f32 v80, v80
    v_exp_f32 v81, v81
    v_exp_f32 v82, v82
    v_exp_f32 v83, v83
    v_exp_f32 v84, v84
    v_exp_f32 v85, v85
    v_exp_f32 v86, v86
    v_exp_f32 v87, v87
    v_add_f32 v22, v22, v72
    v_add_f32 v23, v23, v73
    v_add_f32 v22, v22, v74
    v_add_f32 v23, v23, v75
    v_add_f32 v22, v22, v76
    v_add_f32 v23, v23, v77
    v_add_f32 v22, v22, v78
    v_add_f32 v23, v23, v79
    v_add_f32 v22, v22, v80
    v_add_f32 v23, v23, v81
    v_add_f32 v22, v22, v82
    v_add_f32 v23, v23, v83
    v_add_f32 v22, v22, v84
    v_add_f32 v23, v23, v85
    v_add_f32 v22, v22, v86
    v_add_f32 v23, v23, v87
    v_cvt_pk_bf16_f32 v144, v72, v73
    v_cvt_pk_bf16_f32 v145, v74, v75
    v_cvt_pk_bf16_f32 v146, v76, v77
    v_cvt_pk_bf16_f32 v147, v78, v79
    v_cvt_pk_bf16_f32 v148, v80, v81
    v_cvt_pk_bf16_f32 v149, v82, v83
    v_cvt_pk_bf16_f32 v150, v84, v85
    v_cvt_pk_bf16_f32 v151, v86, v87
    s_waitcnt lgkmcnt(2)
    v_mfma_f32_32x32x16_bf16 v[88:103], v[128:131], v[144:147], v[88:103]
    v_mfma_f32_32x32x16_bf16 v[88:103], v[132:135], v[148:151], v[88:103]
    s_cmp_lg_u32 s26, 0
    s_cbranch_scc1 sk_83
    s_xor_b32 s96, s29, 3
    s_and_b32 s97, s96, 2
    s_and_b32 s96, s96, 3
    s_mul_i32 s97, s97, 14336
    s_mul_i32 s96, s96, 14336
    s_add_u32 s96, s96, s97
    buffer_load_dwordx4 v[212:215], v155, s[4:7], s96 offen
sk_83:
    ds_read_b128 v[120:123], v20 offset:10240
    ds_read_b128 v[124:127], v20 offset:11264
    s_cmp_eq_u32 s99, 6
    s_cbranch_scc0 ng_84
    v_mov_b32 v24, 0xf149f2ca
    v_mov_b32 v25, 0xf149f2ca
    v_mov_b32 v26, 0xf149f2ca
    v_mov_b32 v27, 0xf149f2ca
    v_mov_b32 v28, 0xf149f2ca
    v_mov_b32 v29, 0xf149f2ca
    v_mov_b32 v30, 0xf149f2ca
    v_mov_b32 v31, 0xf149f2ca
    v_mov_b32 v32, 0xf149f2ca
    v_mov_b32 v33, 0xf149f2ca
    v_mov_b32 v34, 0xf149f2ca
    v_mov_b32 v35, 0xf149f2ca
    v_mov_b32 v36, 0xf149f2ca
    v_mov_b32 v37, 0xf149f2ca
    v_mov_b32 v38, 0xf149f2ca
    v_mov_b32 v39, 0xf149f2ca
ng_84:
    s_waitcnt lgkmcnt(2)
    s_nop 0
    v_mfma_f32_32x32x16_bf16 v[72:87], v[112:115], v[4:7], v[24:39]
    v_mfma_f32_32x32x16_bf16 v[72:87], v[116:119], v[8:11], v[72:87]
    v_exp_f32 v56, v56
    v_exp_f32 v57, v57
    v_exp_f32 v58, v58
    v_exp_f32 v59, v59
    v_exp_f32 v60, v60
    v_exp_f32 v61, v61
    v_exp_f32 v62, v62
    v_exp_f32 v63, v63
    v_exp_f32 v64, v64
    v_exp_f32 v65, v65
    v_exp_f32 v66, v66
    v_exp_f32 v67, v67
    v_exp_f32 v68, v68
    v_exp_f32 v69, v69
    v_exp_f32 v70, v70
    v_exp_f32 v71, v71
    v_add_f32 v22, v22, v56
    v_add_f32 v23, v23, v57
    v_add_f32 v22, v22, v58
    v_add_f32 v23, v23, v59
    v_add_f32 v22, v22, v60
    v_add_f32 v23, v23, v61
    v_add_f32 v22, v22, v62
    v_add_f32 v23, v23, v63
    v_add_f32 v22, v22, v64
    v_add_f32 v23, v23, v65
    v_add_f32 v22, v22, v66
    v_add_f32 v23, v23, v67
    v_add_f32 v22, v22, v68
    v_add_f32 v23, v23, v69
    v_add_f32 v22, v22, v70
    v_add_f32 v23, v23, v71
    v_cvt_pk_bf16_f32 v136, v56, v57
    v_cvt_pk_bf16_f32 v137, v58, v59
    v_cvt_pk_bf16_f32 v138, v60, v61
    v_cvt_pk_bf16_f32 v139, v62, v63
    v_cvt_pk_bf16_f32 v140, v64, v65
    v_cvt_pk_bf16_f32 v141, v66, v67
    v_cvt_pk_bf16_f32 v142, v68, v69
    v_cvt_pk_bf16_f32 v143, v70, v71
    s_waitcnt lgkmcnt(0)
    v_mfma_f32_32x32x16_bf16 v[88:103], v[120:123], v[136:139], v[88:103]
    v_mfma_f32_32x32x16_bf16 v[88:103], v[124:127], v[140:143], v[88:103]
    s_cmp_lg_u32 s26, 0
    s_cbranch_scc1 sk_85
    s_xor_b32 s96, s29, 3
    s_and_b32 s97, s96, 2
    s_and_b32 s96, s96, 3
    s_mul_i32 s97, s97, 14336
    s_mul_i32 s96, s96, 14336
    s_add_u32 s96, s96, s97
    s_add_u32 s96, s96, 7168
    buffer_load_dwordx4 v[216:219], v155, s[4:7], s96 offen
sk_85:
    ds_read_b128 v[128:131], v20 offset:6144
    ds_read_b128 v[132:135], v20 offset:7168
    v_exp_f32 v72, v72
    v_exp_f32 v73, v73
    v_exp_f32 v74, v74
    v_exp_f32 v75, v75
    v_exp_f32 v76, v76
    v_exp_f32 v77, v77
    v_exp_f32 v78, v78
    v_exp_f32 v79, v79
    v_exp_f32 v80, v80
    v_exp_f32 v81, v81
    v_exp_f32 v82, v82
    v_exp_f32 v83, v83
    v_exp_f32 v84, v84
    v_exp_f32 v85, v85
    v_exp_f32 v86, v86
    v_exp_f32 v87, v87
    v_add_f32 v22, v22, v72
    v_add_f32 v23, v23, v73
    v_add_f32 v22, v22, v74
    v_add_f32 v23, v23, v75
    v_add_f32 v22, v22, v76
    v_add_f32 v23, v23, v77
    v_add_f32 v22, v22, v78
    v_add_f32 v23, v23, v79
    v_add_f32 v22, v22, v80
    v_add_f32 v23, v23, v81
    v_add_f32 v22, v22, v82
    v_add_f32 v23, v23, v83
    v_add_f32 v22, v22, v84
    v_add_f32 v23, v23, v85
    v_add_f32 v22, v22, v86
    v_add_f32 v23, v23, v87
    v_cvt_pk_bf16_f32 v144, v72, v73
    v_cvt_pk_bf16_f32 v145, v74, v75
    v_cvt_pk_bf16_f32 v146, v76, v77
    v_cvt_pk_bf16_f32 v147, v78, v79
    v_cvt_pk_bf16_f32 v148, v80, v81
    v_cvt_pk_bf16_f32 v149, v82, v83
    v_cvt_pk_bf16_f32 v150, v84, v85
    v_cvt_pk_bf16_f32 v151, v86, v87
    s_waitcnt lgkmcnt(0)
    v_mfma_f32_32x32x16_bf16 v[88:103], v[128:131], v[144:147], v[88:103]
    v_mfma_f32_32x32x16_bf16 v[88:103], v[132:135], v[148:151], v[88:103]
    v_add_f32 v22, v22, v23
    v_mov_b32 v152, v22
    s_nop 1
    v_permlane32_swap_b32 v22, v152
    v_add_f32 v22, v22, v152
    v_rcp_f32 v22, v22
    s_lshl_b32 s36, s99, 16
    s_add_u32 s36, s36, 0x808000
    s_lshl_b32 s33, s25, 11
    s_add_u32 s33, s33, s36
    s_lshl_b32 s30, s24, 9
    s_lshl_b32 s31, s3, 6
    s_add_u32 s30, s30, s31
    s_add_u32 s30, s30, s26
    s_add_u32 s30, s30, 0xdd2000
    s_lshl_b32 s31, s25, 2
    s_add_u32 s31, s31, s30
    v_pk_mul_f32 v[88:89], v[88:89], v[22:23] op_sel_hi:[1,0]
    v_pk_mul_f32 v[90:91], v[90:91], v[22:23] op_sel_hi:[1,0]
    v_pk_mul_f32 v[92:93], v[92:93], v[22:23] op_sel_hi:[1,0]
    v_pk_mul_f32 v[94:95], v[94:95], v[22:23] op_sel_hi:[1,0]
    v_pk_mul_f32 v[96:97], v[96:97], v[22:23] op_sel_hi:[1,0]
    v_pk_mul_f32 v[98:99], v[98:99], v[22:23] op_sel_hi:[1,0]
    v_pk_mul_f32 v[100:101], v[100:101], v[22:23] op_sel_hi:[1,0]
    v_pk_mul_f32 v[102:103], v[102:103], v[22:23] op_sel_hi:[1,0]
    v_cvt_pk_bf16_f32 v88, v88, v89
    v_cvt_pk_bf16_f32 v89, v90, v91
    v_cvt_pk_bf16_f32 v90, v92, v93
    v_cvt_pk_bf16_f32 v91, v94, v95
    v_cvt_pk_bf16_f32 v92, v96, v97
    v_cvt_pk_bf16_f32 v93, v98, v99
    v_cvt_pk_bf16_f32 v94, v100, v101
    v_cvt_pk_bf16_f32 v95, v102, v103
    s_cmp_lg_u32 s77, 0
    s_cbranch_scc1 lc_86
    buffer_store_dwordx4 v[88:91], v253, s[20:23], s33 offen sc1
    buffer_store_dwordx4 v[92:95], v253, s[20:23], s33 offen offset:1024 sc1
    s_branch lc_87
lc_86:
    buffer_store_dwordx4 v[88:91], v253, s[20:23], s33 offen
    buffer_store_dwordx4 v[92:95], v253, s[20:23], s33 offen offset:1024
lc_87:
    v_mov_b32 v154, s88
    s_mov_b64 exec, 1
    s_waitcnt vmcnt(0)
    s_cmp_lg_u32 s77, 0
    s_cbranch_scc1 lc_88
    buffer_store_dword v154, v253, s[20:23], s31 offen sc1
    s_branch lc_89
lc_88:
    buffer_store_dword v154, v253, s[20:23], s31 offen
lc_89:
    s_mov_b64 exec, -1
    s_cmp_lg_u32 s26, 0
    s_cbranch_scc1 sk_90
    s_mov_b32 s96, 0
    buffer_load_dwordx4 v[220:223], v153, s[12:15], s96 offen
    s_mov_b32 s96, 2048
    buffer_load_dwordx4 v[224:227], v153, s[12:15], s96 offen
    s_mov_b32 s96, 4096
    buffer_load_dwordx4 v[228:231], v153, s[12:15], s96 offen
    s_mov_b32 s96, 6144
    buffer_load_dwordx4 v[232:235], v153, s[12:15], s96 offen
    s_mov_b32 s96, 8192
    buffer_load_dwordx4 v[236:239], v153, s[12:15], s96 offen
    s_mov_b32 s96, 10240
    buffer_load_dwordx4 v[240:243], v153, s[12:15], s96 offen
    s_mov_b32 s96, 12288
    buffer_load_dwordx4 v[244:247], v153, s[12:15], s96 offen
    s_mov_b32 s96, 14336
    buffer_load_dwordx4 v[248:251], v153, s[12:15], s96 offen
sk_90:
    v_bfe_u32 v20, v252, 3, 2
    v_lshrrev_b32 v21, 5, v252
    v_lshl_add_u32 v20, v21, 3, v20
    s_lshr_b32 s32, s28, 1
    s_lshl_b32 s32, s32, 4
    s_and_b32 s33, s28, 1
    s_lshl_b32 s33, s33, 2
    s_add_u32 s32, s32, s33
    v_add_u32 v20, s32, v20
    v_lshlrev_b32 v20, 11, v20
    v_lshrrev_b32 v21, 2, v252
    v_and_b32 v21, 4, v21
    v_xor_b32 v21, v21, v252
    v_and_b32 v21, 7, v21
    v_lshl_add_u32 v20, v21, 4, v20
    s_lshl_b32 s32, s98, 7
    v_add_u32 v14, s32, v20
    s_lshl_b32 s32, s28, 9
    s_sub_u32 s34, s29, 224
    s_lshl_b32 s34, s34, 1
    s_add_u32 s89, s34, s28
    s_and_b32 s35, s28, 1
    s_add_u32 s34, s34, s35
    s_lshl_b32 s34, s34, 5
    v_lshrrev_b32 v22, 1, v252
    v_and_b32 v23, 1, v252
    s_cmp_lt_u32 s29, 224
    s_cselect_b32 s32, s32, s34
    s_cselect_b64 vcc, -1, 0
    v_cndmask_b32 v22, v23, v22, vcc
    v_lshl_add_u32 v22, v22, 4, s32
    s_mov_b32 s79, s26
    s_cmp_lg_u32 s26, 0
    s_cbranch_scc1 sk_91
    s_waitcnt vmcnt(0)
    s_getpc_b64 s[32:33]
pc_92:
    s_sub_u32 s32, s32, pc_92-interleave_layers__sliding_block__moe_arch_mod__prompt_kernel
    s_subb_u32 s33, s33, 0
    s_lshr_b32 s34, s2, 3
    s_lshl_b32 s34, s34, 2
    s_add_u32 s34, s34, s28
    s_and_b32 s34, s34, 127
    s_lshl_b32 s34, s34, 7
    v_lshl_add_u32 v19, v252, 14, s34
    s_mov_b32 s34, k_exit-interleave_layers__sliding_block__moe_arch_mod__prompt_kernel
    s_mov_b32 s35, 0x20000
    buffer_load_dword v19, v19, s[32:35], 0 offen
    s_lshr_b32 s30, s16, 7
    s_sub_u32 s30, 3, s30
    s_and_b32 s30, s30, 7
    s_and_b32 s31, s24, 1
    s_lshl_b32 s31, s31, 3
    s_add_u32 s30, s30, s31
    s_and_b32 s31, s24, 14
    s_add_u32 s35, s31, s30
    s_lshl_b32 s31, s25, 2
    s_add_u32 s31, s31, s28
    s_mul_i32 s31, s31, 6144
    s_lshl_b32 s30, s30, 7
    s_add_u32 s30, s30, s31
    v_min_u32 v18, 2, v252
    v_lshl_add_u32 v18, v18, 11, s30
    s_add_u32 s30, s35, 14
    s_and_b32 s30, s30, 15
    s_mul_i32 s30, s30, 393216
    buffer_load_dword v19, v18, s[16:19], s30 offen
    s_add_u32 s30, s35, 15
    s_and_b32 s30, s30, 15
    s_mul_i32 s30, s30, 393216
    buffer_load_dword v19, v18, s[16:19], s30 offen
    s_add_u32 s30, s35, 0
    s_and_b32 s30, s30, 15
    s_mul_i32 s30, s30, 393216
    buffer_load_dword v19, v18, s[16:19], s30 offen
    s_add_u32 s30, s35, 1
    s_and_b32 s30, s30, 15
    s_mul_i32 s30, s30, 393216
    buffer_load_dword v19, v18, s[16:19], s30 offen
    s_add_u32 s30, s35, 2
    s_and_b32 s30, s30, 15
    s_mul_i32 s30, s30, 393216
    buffer_load_dword v19, v18, s[16:19], s30 offen
    s_add_u32 s30, s35, 3
    s_and_b32 s30, s30, 15
    s_mul_i32 s30, s30, 393216
    buffer_load_dword v19, v18, s[16:19], s30 offen
    s_mov_b32 s30, 0x05040100
    s_mov_b32 s31, 0x07060302
    v_perm_b32 v155, v160, v156, s30
    v_perm_b32 v160, v160, v156, s31
    v_perm_b32 v156, v161, v157, s30
    v_perm_b32 v161, v161, v157, s31
    v_perm_b32 v157, v162, v158, s30
    v_perm_b32 v162, v162, v158, s31
    v_perm_b32 v158, v163, v159, s30
    v_perm_b32 v163, v163, v159, s31
    v_perm_b32 v159, v168, v164, s30
    v_perm_b32 v168, v168, v164, s31
    v_perm_b32 v164, v169, v165, s30
    v_perm_b32 v169, v169, v165, s31
    v_perm_b32 v165, v170, v166, s30
    v_perm_b32 v170, v170, v166, s31
    v_perm_b32 v166, v171, v167, s30
    v_perm_b32 v171, v171, v167, s31
    v_perm_b32 v167, v176, v172, s30
    v_perm_b32 v176, v176, v172, s31
    v_perm_b32 v172, v177, v173, s30
    v_perm_b32 v177, v177, v173, s31
    v_perm_b32 v173, v178, v174, s30
    v_perm_b32 v178, v178, v174, s31
    v_perm_b32 v174, v179, v175, s30
    v_perm_b32 v179, v179, v175, s31
    v_perm_b32 v175, v184, v180, s30
    v_perm_b32 v184, v184, v180, s31
    v_perm_b32 v180, v185, v181, s30
    v_perm_b32 v185, v185, v181, s31
    v_perm_b32 v181, v186, v182, s30
    v_perm_b32 v186, v186, v182, s31
    v_perm_b32 v182, v187, v183, s30
    v_perm_b32 v187, v187, v183, s31
    v_perm_b32 v183, v192, v188, s30
    v_perm_b32 v192, v192, v188, s31
    v_perm_b32 v188, v193, v189, s30
    v_perm_b32 v193, v193, v189, s31
    v_perm_b32 v189, v194, v190, s30
    v_perm_b32 v194, v194, v190, s31
    v_perm_b32 v190, v195, v191, s30
    v_perm_b32 v195, v195, v191, s31
    v_perm_b32 v191, v200, v196, s30
    v_perm_b32 v200, v200, v196, s31
    v_perm_b32 v196, v201, v197, s30
    v_perm_b32 v201, v201, v197, s31
    v_perm_b32 v197, v202, v198, s30
    v_perm_b32 v202, v202, v198, s31
    v_perm_b32 v198, v203, v199, s30
    v_perm_b32 v203, v203, v199, s31
    v_perm_b32 v199, v208, v204, s30
    v_perm_b32 v208, v208, v204, s31
    v_perm_b32 v204, v209, v205, s30
    v_perm_b32 v209, v209, v205, s31
    v_perm_b32 v205, v210, v206, s30
    v_perm_b32 v210, v210, v206, s31
    v_perm_b32 v206, v211, v207, s30
    v_perm_b32 v211, v211, v207, s31
    v_perm_b32 v207, v216, v212, s30
    v_perm_b32 v216, v216, v212, s31
    v_perm_b32 v212, v217, v213, s30
    v_perm_b32 v217, v217, v213, s31
    v_perm_b32 v213, v218, v214, s30
    v_perm_b32 v218, v218, v214, s31
    v_perm_b32 v214, v219, v215, s30
    v_perm_b32 v219, v219, v215, s31
    v_perm_b32 v215, v224, v220, s30
    v_perm_b32 v224, v224, v220, s31
    v_perm_b32 v220, v225, v221, s30
    v_perm_b32 v225, v225, v221, s31
    v_perm_b32 v221, v226, v222, s30
    v_perm_b32 v226, v226, v222, s31
    v_perm_b32 v222, v227, v223, s30
    v_perm_b32 v227, v227, v223, s31
    v_perm_b32 v223, v232, v228, s30
    v_perm_b32 v232, v232, v228, s31
    v_perm_b32 v228, v233, v229, s30
    v_perm_b32 v233, v233, v229, s31
    v_perm_b32 v229, v234, v230, s30
    v_perm_b32 v234, v234, v230, s31
    v_perm_b32 v230, v235, v231, s30
    v_perm_b32 v235, v235, v231, s31
    v_perm_b32 v231, v240, v236, s30
    v_perm_b32 v240, v240, v236, s31
    v_perm_b32 v236, v241, v237, s30
    v_perm_b32 v241, v241, v237, s31
    v_perm_b32 v237, v242, v238, s30
    v_perm_b32 v242, v242, v238, s31
    v_perm_b32 v238, v243, v239, s30
    v_perm_b32 v243, v243, v239, s31
    v_perm_b32 v239, v248, v244, s30
    v_perm_b32 v248, v248, v244, s31
    v_perm_b32 v244, v249, v245, s30
    v_perm_b32 v249, v249, v245, s31
    v_perm_b32 v245, v250, v246, s30
    v_perm_b32 v250, v250, v246, s31
    v_perm_b32 v246, v251, v247, s30
    v_perm_b32 v251, v251, v247, s31
    v_lshrrev_b32 v21, 3, v252
    s_lshl_b32 s84, s24, 18
    s_add_u32 s84, s84, s86
    s_add_u32 s84, s84, 0x2000000
    v_mul_u32_u24 v20, 6144, v21
    v_and_b32 v21, 6, v21
    v_xor_b32 v21, v21, v252
    v_and_b32 v21, 7, v21
    v_lshl_add_u32 v20, v21, 4, v20
    s_mul_i32 s32, s28, 3
    s_bfe_u32 s33, s32, 0x10001
    s_mul_i32 s33, s33, 196608
    s_and_b32 s34, s32, 1
    s_mul_i32 s34, s34, 49152
    s_add_u32 s33, s33, s34
    s_lshr_b32 s34, s32, 2
    s_lshl_b32 s34, s34, 11
    s_add_u32 s33, s33, s34
    v_add_u32 v8, s33, v20
    v_add_u32 v9, 97280, v8
    s_add_u32 s32, s32, 1
    s_bfe_u32 s33, s32, 0x10001
    s_mul_i32 s33, s33, 196608
    s_and_b32 s34, s32, 1
    s_mul_i32 s34, s34, 49152
    s_add_u32 s33, s33, s34
    s_lshr_b32 s34, s32, 2
    s_lshl_b32 s34, s34, 11
    s_add_u32 s33, s33, s34
    s_sub_u32 s33, s33, 2048
    v_add_u32 v10, s33, v20
    v_add_u32 v11, 97280, v10
    s_add_u32 s32, s32, 1
    s_bfe_u32 s33, s32, 0x10001
    s_mul_i32 s33, s33, 196608
    s_and_b32 s34, s32, 1
    s_mul_i32 s34, s34, 49152
    s_add_u32 s33, s33, s34
    s_lshr_b32 s34, s32, 2
    s_lshl_b32 s34, s34, 11
    s_add_u32 s33, s33, s34
    v_add_u32 v12, s33, v20
    v_add_u32 v13, 97280, v12
    s_sub_u32 s30, s95, 1
    s_sub_u32 s95, s94, 3
    s_mov_b32 s94, s30
    v_bfe_u32 v116, v252, 4, 1
    v_lshlrev_b32 v116, 11, v116
    v_lshrrev_b32 v117, 5, v252
    v_lshl_add_u32 v116, v117, 8, v116
    v_and_b32 v117, 15, v252
    v_lshl_add_u32 v116, v117, 4, v116
    s_lshl_b32 s34, s28, 12
    s_add_u32 s34, s34, 147456
    v_add_u32 v117, s34, v116
    v_and_b32 v16, 15, v252
    v_lshlrev_b32 v16, 9, v16
    s_load_dwordx2 s[12:13], s[0:1], 64
    s_mov_b32 s14, 0x400000
    s_mov_b32 s15, 0x20000
    s_waitcnt lgkmcnt(0)
sk_91:
    s_barrier
    s_add_u32 s96, s25, 12
    s_and_b32 s96, s96, 15
    s_lshl_b32 s96, s96, 17
    s_add_u32 s96, s96, 65536
    s_add_u32 m0, s101, 114688
    s_nop 0
    buffer_load_dwordx4 v14, s[8:11], s96 offen lds
    s_add_u32 s96, s25, 13
    s_and_b32 s96, s96, 15
    s_lshl_b32 s96, s96, 17
    s_add_u32 s96, s96, 65536
    s_add_u32 m0, s101, 118784
    s_nop 0
    buffer_load_dwordx4 v14, s[8:11], s96 offen lds
    s_add_u32 s96, s25, 14
    s_and_b32 s96, s96, 15
    s_lshl_b32 s96, s96, 17
    s_add_u32 s96, s96, 65536
    s_add_u32 m0, s101, 122880
    s_nop 0
    buffer_load_dwordx4 v14, s[8:11], s96 offen lds
    s_add_u32 s96, s25, 15
    s_and_b32 s96, s96, 15
    s_lshl_b32 s96, s96, 17
    s_add_u32 s96, s96, 65536
    s_add_u32 m0, s101, 126976
    s_nop 0
    buffer_load_dwordx4 v14, s[8:11], s96 offen lds
    s_waitcnt vmcnt(0)
    s_barrier
    s_cmp_lg_u32 s26, 0
    s_cbranch_scc1 l_tail
    s_mov_b32 s26, 16777216
    s_mov_b32 s36, 0
    s_add_u32 s96, s94, 0
    s_and_b32 s96, s96, 15
    s_mul_i32 s96, s96, 393216
    s_add_u32 s96, s96, s85
    s_add_u32 m0, s87, 40960
    s_nop 0
    buffer_load_dwordx4 v8, s[16:19], s96 offen offset:0 lds
    buffer_load_dwordx4 v9, s[16:19], s96 offen offset:1024 lds
    buffer_load_dwordx4 v10, s[16:19], s96 offen offset:2048 lds
    buffer_load_dwordx4 v11, s[16:19], s96 offen offset:3072 lds
    s_add_u32 m0, s87, 45056
    s_nop 0
    buffer_load_dwordx4 v12, s[16:19], s96 offen offset:0 lds
    buffer_load_dwordx4 v13, s[16:19], s96 offen offset:1024 lds
    s_add_u32 s96, s95, 1
    s_and_b32 s96, s96, 15
    s_mul_i32 s96, s96, 393216
    s_add_u32 s96, s96, s85
    s_add_u32 m0, s87, 65536
    s_nop 0
    buffer_load_dwordx4 v8, s[16:19], s96 offen offset:0 lds
    buffer_load_dwordx4 v9, s[16:19], s96 offen offset:1024 lds
    buffer_load_dwordx4 v10, s[16:19], s96 offen offset:2048 lds
    buffer_load_dwordx4 v11, s[16:19], s96 offen offset:3072 lds
    s_add_u32 m0, s87, 69632
    s_nop 0
    buffer_load_dwordx4 v12, s[16:19], s96 offen offset:0 lds
    buffer_load_dwordx4 v13, s[16:19], s96 offen offset:1024 lds
    s_add_u32 s96, s95, 1
    s_and_b32 s96, s96, 15
    s_bitcmp1_b32 s36, s96
    s_cbranch_scc1 sk_93
    s_lshl_b32 s30, s99, 13
    s_add_u32 s30, s30, 0xc00000
    s_mov_b32 s78, s27
pl_94:
    buffer_load_dword v17, v16, s[20:23], s30 offen sc1
    s_waitcnt vmcnt(0)
pc_95:
    v_cmp_ne_u32 vcc, -1, v17
    s_mov_b32 s36, vcc_lo
    s_bitcmp0_b32 s36, s96
    s_cselect_b64 vcc, -1, 0
    s_cbranch_vccz pd_96
    s_sub_u32 s78, s78, 1
    s_cmp_lg_u32 s78, 0
    s_cbranch_scc1 pl_94
    s_mov_b32 s27, 1
pd_96:
sk_93:
    s_add_u32 s96, s95, 1
    s_and_b32 s96, s96, 15
    s_lshl_b32 s97, s96, 14
    s_add_u32 s97, s97, s84
    s_add_u32 m0, s86, 131072
    s_nop 0
    buffer_load_dwordx4 v253, s[20:23], s97 offen offset:0 sc1 lds
    buffer_load_dwordx4 v253, s[20:23], s97 offen offset:1024 sc1 lds
    buffer_load_dwordx4 v253, s[20:23], s97 offen offset:2048 sc1 lds
    buffer_load_dwordx4 v253, s[20:23], s97 offen offset:3072 sc1 lds
    s_waitcnt vmcnt(10)
    s_barrier
    s_add_u32 s96, s94, 2
    s_and_b32 s96, s96, 15
    s_mul_i32 s96, s96, 393216
    s_add_u32 s96, s96, s85
    s_add_u32 m0, s87, 90112
    s_nop 0
    buffer_load_dwordx4 v8, s[16:19], s96 offen offset:0 lds
    buffer_load_dwordx4 v9, s[16:19], s96 offen offset:1024 lds
    buffer_load_dwordx4 v10, s[16:19], s96 offen offset:2048 lds
    buffer_load_dwordx4 v11, s[16:19], s96 offen offset:3072 lds
    s_add_u32 m0, s87, 94208
    s_nop 0
    buffer_load_dwordx4 v12, s[16:19], s96 offen offset:0 lds
    buffer_load_dwordx4 v13, s[16:19], s96 offen offset:1024 lds
    ds_read_b128 v[32:35], v117 offset:0
    ds_read_b128 v[36:39], v117 offset:512
    ds_read_b128 v[40:43], v117 offset:1024
    ds_read_b128 v[44:47], v117 offset:1536
    s_add_u32 s96, s94, 2
    s_and_b32 s96, s96, 15
    s_bitcmp1_b32 s36, s96
    s_cbranch_scc1 sk_97
    s_lshl_b32 s30, s99, 13
    s_add_u32 s30, s30, 0xc00000
    s_mov_b32 s78, s27
pl_98:
    buffer_load_dword v17, v16, s[20:23], s30 offen sc1
    s_waitcnt vmcnt(0)
pc_99:
    v_cmp_ne_u32 vcc, -1, v17
    s_mov_b32 s36, vcc_lo
    s_bitcmp0_b32 s36, s96
    s_cselect_b64 vcc, -1, 0
    s_cbranch_vccz pd_100
    s_sub_u32 s78, s78, 1
    s_cmp_lg_u32 s78, 0
    s_cbranch_scc1 pl_98
    s_mov_b32 s27, 1
pd_100:
sk_97:
    s_add_u32 s96, s94, 2
    s_and_b32 s96, s96, 15
    s_lshl_b32 s97, s96, 14
    s_add_u32 s97, s97, s84
    s_add_u32 m0, s86, 114688
    s_nop 0
    buffer_load_dwordx4 v253, s[20:23], s97 offen offset:0 sc1 lds
    buffer_load_dwordx4 v253, s[20:23], s97 offen offset:1024 sc1 lds
    buffer_load_dwordx4 v253, s[20:23], s97 offen offset:2048 sc1 lds
    buffer_load_dwordx4 v253, s[20:23], s97 offen offset:3072 sc1 lds
    s_waitcnt vmcnt(10) lgkmcnt(0)
    s_barrier
    s_lshl_b32 s30, s99, 13
    s_add_u32 s30, s30, 0xc00000
    s_add_u32 s31, s30, 4096
    buffer_load_dwordx4 v[64:67], v253, s[20:23], s30 offen offset:0 sc1
    buffer_load_dwordx4 v[68:71], v253, s[20:23], s30 offen offset:1024 sc1
    buffer_load_dwordx4 v[72:75], v253, s[20:23], s30 offen offset:2048 sc1
    buffer_load_dwordx4 v[76:79], v253, s[20:23], s30 offen offset:3072 sc1
    buffer_load_dwordx4 v[80:83], v253, s[20:23], s31 offen offset:0 sc1
    buffer_load_dwordx4 v[84:87], v253, s[20:23], s31 offen offset:1024 sc1
    buffer_load_dwordx4 v[88:91], v253, s[20:23], s31 offen offset:2048 sc1
    buffer_load_dwordx4 v[92:95], v253, s[20:23], s31 offen offset:3072 sc1
    s_add_u32 s96, s95, 3
    s_and_b32 s96, s96, 15
    s_bitcmp1_b32 s36, s96
    s_cbranch_scc1 sk_111
    s_lshl_b32 s30, s99, 13
    s_add_u32 s30, s30, 0xc00000
    s_mov_b32 s78, s27
pl_112:
    buffer_load_dword v17, v16, s[20:23], s30 offen sc1
    s_waitcnt vmcnt(0)
pc_113:
    v_cmp_ne_u32 vcc, -1, v17
    s_mov_b32 s36, vcc_lo
    s_bitcmp0_b32 s36, s96
    s_cselect_b64 vcc, -1, 0
    s_cbranch_vccz pd_114
    s_sub_u32 s78, s78, 1
    s_cmp_lg_u32 s78, 0
    s_cbranch_scc1 pl_112
    s_mov_b32 s27, 1
pd_114:
sk_111:
    s_add_u32 s96, s95, 3
    s_and_b32 s96, s96, 15
    s_lshl_b32 s97, s96, 14
    s_add_u32 s97, s97, s84
    s_add_u32 m0, s86, 147456
    s_nop 0
    buffer_load_dwordx4 v253, s[20:23], s97 offen offset:0 sc1 lds
    buffer_load_dwordx4 v253, s[20:23], s97 offen offset:1024 sc1 lds
    s_mov_b32 s78, s27
    s_waitcnt vmcnt(2)
    s_branch pc_116
pl_115:
    s_lshl_b32 s30, s99, 13
    s_add_u32 s30, s30, 0xc00000
    s_add_u32 s31, s30, 4096
    buffer_load_dwordx4 v[64:67], v253, s[20:23], s30 offen offset:0 sc1
    buffer_load_dwordx4 v[68:71], v253, s[20:23], s30 offen offset:1024 sc1
    buffer_load_dwordx4 v[72:75], v253, s[20:23], s30 offen offset:2048 sc1
    buffer_load_dwordx4 v[76:79], v253, s[20:23], s30 offen offset:3072 sc1
    buffer_load_dwordx4 v[80:83], v253, s[20:23], s31 offen offset:0 sc1
    buffer_load_dwordx4 v[84:87], v253, s[20:23], s31 offen offset:1024 sc1
    buffer_load_dwordx4 v[88:91], v253, s[20:23], s31 offen offset:2048 sc1
    buffer_load_dwordx4 v[92:95], v253, s[20:23], s31 offen offset:3072 sc1
    s_waitcnt vmcnt(0)
pc_116:
    v_max3_u32 v48, v64, v68, v72
    v_max3_u32 v48, v48, v76, v80
    v_max3_u32 v48, v48, v84, v88
    v_max_u32 v48, v48, v92
    v_cmp_eq_u32 vcc, -1, v48
    s_cbranch_vccz pd_117
    s_sub_u32 s78, s78, 1
    s_cmp_lg_u32 s78, 0
    s_cbranch_scc1 pl_115
    s_mov_b32 s27, 1
pd_117:
    buffer_load_dwordx4 v253, s[20:23], s97 offen offset:2048 sc1 lds
    buffer_load_dwordx4 v253, s[20:23], s97 offen offset:3072 sc1 lds
    v_add_f32 v64, v64, v68
    v_add_f32 v65, v65, v69
    v_add_f32 v66, v66, v70
    v_add_f32 v67, v67, v71
    v_add_f32 v64, v64, v72
    v_add_f32 v65, v65, v73
    v_add_f32 v66, v66, v74
    v_add_f32 v67, v67, v75
    s_add_u32 s96, s95, 3
    s_and_b32 s96, s96, 15
    s_mul_i32 s96, s96, 393216
    s_add_u32 s96, s96, s85
    s_add_u32 m0, s87, 40960
    s_nop 0
    buffer_load_dwordx4 v8, s[16:19], s96 offen offset:0 lds
    v_add_f32 v64, v64, v76
    v_add_f32 v65, v65, v77
    v_add_f32 v66, v66, v78
    v_add_f32 v67, v67, v79
    v_add_f32 v64, v64, v80
    v_add_f32 v65, v65, v81
    v_add_f32 v66, v66, v82
    v_add_f32 v67, v67, v83
    v_add_f32 v64, v64, v84
    v_add_f32 v65, v65, v85
    v_add_f32 v66, v66, v86
    v_add_f32 v67, v67, v87
    buffer_load_dwordx4 v9, s[16:19], s96 offen offset:1024 lds
    v_add_f32 v64, v64, v88
    v_add_f32 v65, v65, v89
    v_add_f32 v66, v66, v90
    v_add_f32 v67, v67, v91
    v_add_f32 v64, v64, v92
    v_add_f32 v65, v65, v93
    v_add_f32 v66, v66, v94
    v_add_f32 v67, v67, v95
    v_mov_b32 v48, v64
    v_mov_b32 v49, v65
    v_mov_b32 v50, v66
    v_mov_b32 v51, v67
    v_permlane32_swap_b32 v64, v48
    buffer_load_dwordx4 v10, s[16:19], s96 offen offset:2048 lds
    v_permlane32_swap_b32 v65, v49
    v_permlane32_swap_b32 v66, v50
    v_permlane32_swap_b32 v67, v51
    v_add_f32 v64, v64, v48
    v_add_f32 v65, v65, v49
    v_add_f32 v66, v66, v50
    v_add_f32 v67, v67, v51
    v_mul_f32 v54, 0x3a800000, v64
    v_mul_f32 v65, 0x3a800000, v65
    v_fma_f32 v65, -v54, v54, v65
    v_max_f32 v65, 0, v65
    v_add_f32 v55, 0x3727c5ac, v65
    buffer_load_dwordx4 v11, s[16:19], s96 offen offset:3072 lds
    v_rsq_f32 v55, v55
    v_fma_f32 v52, -v54, v67, v66
    v_and_b32 v53, 31, v252
    v_mul_f32 v52, v52, v55
    s_lshl_b32 s32, s99, 5
    v_add_u32 v53, s32, v53
    v_mov_b32 v48, v52
    s_nop 1
    v_max_f32_dpp v48, v48, v48 quad_perm:[1,0,3,2] row_mask:0xf bank_mask:0xf
    s_nop 1
    v_max_f32_dpp v48, v48, v48 quad_perm:[2,3,0,1] row_mask:0xf bank_mask:0xf
    s_nop 1
    v_max_f32_dpp v48, v48, v48 row_half_mirror row_mask:0xf bank_mask:0xf
    s_nop 1
    v_max_f32_dpp v48, v48, v48 row_mirror row_mask:0xf bank_mask:0xf
    v_mov_b32 v49, v48
    s_nop 1
    v_permlane16_swap_b32 v48, v49
    s_add_u32 m0, s87, 45056
    s_nop 0
    buffer_load_dwordx4 v12, s[16:19], s96 offen offset:0 lds
    v_max_f32 v48, v48, v49
    v_cmp_eq_f32 vcc, v48, v52
    v_lshrrev_b32 v50, 5, v252
    v_lshlrev_b32 v50, 4, v50
    s_lshl_b32 s32, s99, 11
    s_lshl_b32 s33, s98, 7
    s_add_u32 s32, s32, s33
    s_add_u32 s32, s32, 0xd60000
    s_lshl_b32 s34, s99, 4
    s_add_u32 s34, s34, 0xdc0000
    s_ff1_i32_b32 s35, vcc_lo
    s_lshl_b32 s35, 1, s35
    buffer_load_dwordx4 v13, s[16:19], s96 offen offset:1024 lds
    s_cmp_eq_u32 s25, 0
    s_cselect_b32 exec_lo, s35, 0
    s_mov_b32 exec_hi, 0
    buffer_store_dwordx4 v[52:55], v50, s[20:23], s34 offen sc1
    s_mov_b32 exec_lo, s35
    s_mov_b32 exec_hi, s35
    buffer_store_dwordx4 v[32:35], v50, s[20:23], s32 offen offset:0 sc1
    buffer_store_dwordx4 v[36:39], v50, s[20:23], s32 offen offset:32 sc1
    buffer_store_dwordx4 v[40:43], v50, s[20:23], s32 offen offset:64 sc1
    buffer_store_dwordx4 v[44:47], v50, s[20:23], s32 offen offset:96 sc1
    s_mov_b64 exec, -1
    s_waitcnt vmcnt(22) lgkmcnt(0)
    s_barrier
    s_add_u32 s96, s94, 4
    s_and_b32 s96, s96, 15
    s_lshl_b32 s97, s96, 14
    s_add_u32 s97, s97, s84
    s_add_u32 m0, s86, 131072
    s_nop 0
    buffer_load_dwordx4 v253, s[20:23], s97 offen offset:0 sc1 lds
    buffer_load_dwordx4 v253, s[20:23], s97 offen offset:1024 sc1 lds
    v_add_f32 v56, 1.0, v55
    v_mul_f32 v57, v54, v55
    v_mul_f32 v58, v56, v56
    buffer_load_dwordx4 v253, s[20:23], s97 offen offset:2048 sc1 lds
    v_sub_f32 v57, 0, v57
    v_mul_f32 v58, v58, v65
    v_add_f32 v58, 0x3727c5ac, v58
    buffer_load_dwordx4 v253, s[20:23], s97 offen offset:3072 sc1 lds
    v_rsq_f32 v58, v58
    s_nop 0
    v_mul_f32 v58, v58, v56
    v_and_b32 v48, 31, v252
    s_add_u32 s96, s94, 4
    s_and_b32 s96, s96, 15
    s_mul_i32 s96, s96, 393216
    s_add_u32 s96, s96, s85
    s_add_u32 m0, s87, 65536
    s_nop 0
    buffer_load_dwordx4 v8, s[16:19], s96 offen offset:0 lds
    v_lshrrev_b32 v49, 5, v252
    v_cmp_eq_u32 vcc, 0, v49
    v_lshlrev_b32 v49, 9, v49
    buffer_load_dwordx4 v9, s[16:19], s96 offen offset:1024 lds
    v_lshl_add_u32 v48, v48, 2, v49
    s_lshl_b32 s32, s28, 7
    v_add_u32 v48, s32, v48
    buffer_load_dwordx4 v10, s[16:19], s96 offen offset:2048 lds
    v_cndmask_b32 v49, v54, v58, vcc
    v_cndmask_b32 v50, v57, v56, vcc
    ds_write_b32 v48, v49 offset:0
    buffer_load_dwordx4 v11, s[16:19], s96 offen offset:3072 lds
    ds_write_b32 v48, v50 offset:2048
    v_and_b32 v48, 15, v252
    v_lshrrev_b32 v51, 4, v252
    s_add_u32 m0, s87, 69632
    s_nop 0
    buffer_load_dwordx4 v12, s[16:19], s96 offen offset:0 lds
    v_lshl_add_u32 v48, v48, 2, v51
    s_min_u32 s32, s28, 2
    s_lshl_b32 s32, s32, 8
    buffer_load_dwordx4 v13, s[16:19], s96 offen offset:1024 lds
    v_lshl_add_u32 v48, v48, 2, s32
    ds_write_b32 v48, v2 offset:1024
    s_waitcnt vmcnt(14) lgkmcnt(0)
    s_barrier
    s_add_u32 s96, s95, 5
    s_and_b32 s96, s96, 15
    s_lshl_b32 s97, s96, 14
    s_add_u32 s97, s97, s84
    s_add_u32 m0, s86, 114688
    s_nop 0
    buffer_load_dwordx4 v253, s[20:23], s97 offen offset:0 sc1 lds
    buffer_load_dwordx4 v253, s[20:23], s97 offen offset:1024 sc1 lds
    buffer_load_dwordx4 v253, s[20:23], s97 offen offset:2048 sc1 lds
    buffer_load_dwordx4 v253, s[20:23], s97 offen offset:3072 sc1 lds
    s_add_u32 s96, s95, 5
    s_and_b32 s96, s96, 15
    s_mul_i32 s96, s96, 393216
    s_add_u32 s96, s96, s85
    s_add_u32 m0, s87, 90112
    s_nop 0
    buffer_load_dwordx4 v8, s[16:19], s96 offen offset:0 lds
    buffer_load_dwordx4 v9, s[16:19], s96 offen offset:1024 lds
    buffer_load_dwordx4 v10, s[16:19], s96 offen offset:2048 lds
    buffer_load_dwordx4 v11, s[16:19], s96 offen offset:3072 lds
    s_add_u32 m0, s87, 94208
    s_nop 0
    buffer_load_dwordx4 v12, s[16:19], s96 offen offset:0 lds
    buffer_load_dwordx4 v13, s[16:19], s96 offen offset:1024 lds
    s_waitcnt vmcnt(10) lgkmcnt(0)
    s_barrier
    s_add_u32 s32, s79, 0xdc0000
    buffer_load_dwordx4 v[16:19], v253, s[20:23], s32 offen sc1
    s_add_u32 s96, s94, 6
    s_and_b32 s96, s96, 15
    s_lshl_b32 s97, s96, 14
    s_add_u32 s97, s97, s84
    s_add_u32 m0, s86, 147456
    s_nop 0
    buffer_load_dwordx4 v253, s[20:23], s97 offen offset:0 sc1 lds
    buffer_load_dwordx4 v253, s[20:23], s97 offen offset:1024 sc1 lds
    buffer_load_dwordx4 v253, s[20:23], s97 offen offset:2048 sc1 lds
    buffer_load_dwordx4 v253, s[20:23], s97 offen offset:3072 sc1 lds
    s_add_u32 s96, s94, 6
    s_and_b32 s96, s96, 15
    s_mul_i32 s96, s96, 393216
    s_add_u32 s96, s96, s85
    s_add_u32 m0, s87, 40960
    s_nop 0
    buffer_load_dwordx4 v8, s[16:19], s96 offen offset:0 lds
    buffer_load_dwordx4 v9, s[16:19], s96 offen offset:1024 lds
    buffer_load_dwordx4 v10, s[16:19], s96 offen offset:2048 lds
    buffer_load_dwordx4 v11, s[16:19], s96 offen offset:3072 lds
    s_add_u32 m0, s87, 45056
    s_nop 0
    buffer_load_dwordx4 v12, s[16:19], s96 offen offset:0 lds
    buffer_load_dwordx4 v13, s[16:19], s96 offen offset:1024 lds
    s_waitcnt vmcnt(11) lgkmcnt(0)
    s_barrier
    s_add_u32 s96, s95, 7
    s_and_b32 s96, s96, 15
    s_lshl_b32 s97, s96, 14
    s_add_u32 s97, s97, s84
    s_add_u32 m0, s86, 131072
    s_nop 0
    buffer_load_dwordx4 v253, s[20:23], s97 offen offset:0 sc1 lds
    buffer_load_dwordx4 v253, s[20:23], s97 offen offset:1024 sc1 lds
    s_mov_b32 s78, s27
    s_waitcnt vmcnt(12)
    s_branch pc_120
pl_119:
    s_add_u32 s32, s79, 0xdc0000
    buffer_load_dwordx4 v[16:19], v253, s[20:23], s32 offen sc1
    s_waitcnt vmcnt(0)
pc_120:
    v_max3_u32 v20, v16, v17, v18
    v_max_u32 v20, v20, v19
    v_cmp_eq_u32 vcc, -1, v20
    s_cbranch_vccz pd_121
    s_sub_u32 s78, s78, 1
    s_cmp_lg_u32 s78, 0
    s_cbranch_scc1 pl_119
    s_mov_b32 s27, 1
pd_121:
    buffer_load_dwordx4 v253, s[20:23], s97 offen offset:2048 sc1 lds
    buffer_load_dwordx4 v253, s[20:23], s97 offen offset:3072 sc1 lds
    s_add_u32 s96, s95, 7
    s_and_b32 s96, s96, 15
    s_mul_i32 s96, s96, 393216
    s_add_u32 s96, s96, s85
    s_add_u32 m0, s87, 65536
    s_nop 0
    buffer_load_dwordx4 v8, s[16:19], s96 offen offset:0 lds
    v_mov_b32 v20, v16
    s_nop 1
    v_max_f32_dpp v20, v20, v20 quad_perm:[1,0,3,2] row_mask:0xf bank_mask:0xf
    s_nop 1
    v_max_f32_dpp v20, v20, v20 quad_perm:[2,3,0,1] row_mask:0xf bank_mask:0xf
    s_nop 1
    v_max_f32_dpp v20, v20, v20 row_half_mirror row_mask:0xf bank_mask:0xf
    s_nop 1
    v_max_f32_dpp v20, v20, v20 row_mirror row_mask:0xf bank_mask:0xf
    buffer_load_dwordx4 v9, s[16:19], s96 offen offset:1024 lds
    v_mov_b32 v21, v20
    s_nop 1
    v_permlane16_swap_b32 v20, v21
    v_max_f32 v20, v20, v21
    v_mov_b32 v21, v20
    s_nop 1
    v_permlane32_swap_b32 v20, v21
    v_max_f32 v20, v20, v21
    buffer_load_dwordx4 v10, s[16:19], s96 offen offset:2048 lds
    v_cmp_eq_f32 vcc, v20, v16
    s_ff1_i32_b64 s32, vcc
    s_and_b32 s32, s32, 63
    v_readlane_b32 s74, v16, s32
    v_readlane_b32 s73, v17, s32
    v_readlane_b32 s75, v18, s32
    buffer_load_dwordx4 v11, s[16:19], s96 offen offset:3072 lds
    v_readlane_b32 s76, v19, s32
    s_and_b32 s73, s73, 2047
    s_lshr_b32 s33, s73, 5
    s_lshl_b32 s33, s33, 11
    s_add_u32 s33, s33, s79
    s_add_u32 s33, s33, 0xd60000
    s_add_u32 m0, s87, 69632
    s_nop 0
    buffer_load_dwordx4 v12, s[16:19], s96 offen offset:0 lds
    buffer_load_dwordx4 v[24:27], v22, s[20:23], s33 offen sc1
    v_mov_b32 v20, s73
    v_mov_b32 v21, s77
    v_mov_b32 v19, 0
    ds_write_b64 v19, v[20:21] offset:3072
    s_lshr_b32 s39, s73, 5
    buffer_load_dwordx4 v13, s[16:19], s96 offen offset:1024 lds
    s_lshl_b32 s34, s24, 2
    s_sub_u32 s39, s39, s34
    s_add_u32 s39, s39, 8
    s_cmp_lt_u32 s39, 12
    s_cselect_b32 s100, 1, 0
    s_waitcnt vmcnt(11) lgkmcnt(0)
    s_barrier
    s_add_u32 s96, s94, 8
    s_and_b32 s96, s96, 15
    s_lshl_b32 s97, s96, 14
    s_add_u32 s97, s97, s84
    s_add_u32 m0, s86, 114688
    s_nop 0
    buffer_load_dwordx4 v253, s[20:23], s97 offen offset:0 sc1 lds
    buffer_load_dwordx4 v253, s[20:23], s97 offen offset:1024 sc1 lds
    s_mov_b32 s78, s27
    s_waitcnt vmcnt(3)
    s_branch pc_102
pl_101:
    s_lshr_b32 s33, s73, 5
    s_lshl_b32 s33, s33, 11
    s_add_u32 s33, s33, s79
    s_add_u32 s33, s33, 0xd60000
    buffer_load_dwordx4 v[24:27], v22, s[20:23], s33 offen sc1
    s_waitcnt vmcnt(0)
pc_102:
    v_max3_u32 v30, v24, v25, v26
    v_max_u32 v30, v30, v27
    v_cmp_eq_u32 vcc, -1, v30
    s_cbranch_vccz pd_103
    s_sub_u32 s78, s78, 1
    s_cmp_lg_u32 s78, 0
    s_cbranch_scc1 pl_101
    s_mov_b32 s27, 1
pd_103:
    buffer_load_dwordx4 v253, s[20:23], s97 offen offset:2048 sc1 lds
    buffer_load_dwordx4 v253, s[20:23], s97 offen offset:3072 sc1 lds
    s_cmp_lt_u32 s29, 224
    s_cbranch_scc1 sk_104
    s_cmp_ge_u32 s28, 2
    s_cbranch_scc1 sk_104
    v_and_b32 v30, 2, v252
    v_cmp_eq_u32 vcc, 2, v30
    v_mov_b32 v28, s76
    v_mul_f32 v29, s75, v28
    v_add_f32 v28, 1.0, v28
    v_cndmask_b32 v30, v24, v26, vcc
    v_cndmask_b32 v31, v25, v27, vcc
    v_lshlrev_b32 v92, 16, v30
    v_and_b32 v93, 0xffff0000, v30
    v_lshlrev_b32 v94, 16, v31
    v_and_b32 v95, 0xffff0000, v31
    v_fma_f32 v92, v92, v28, -v29
    v_fma_f32 v93, v93, v28, -v29
    v_fma_f32 v94, v94, v28, -v29
    v_fma_f32 v95, v95, v28, -v29
    v_mov_b32 v96, 0xbfb8aa3b
    v_mul_f32 v96, s74, v96
    v_exp_f32 v96, v96
    s_nop 0
    v_add_f32 v96, 1.0, v96
    v_rcp_f32 v96, v96
sk_104:
    s_add_u32 s96, s94, 8
    s_and_b32 s96, s96, 15
    s_mul_i32 s96, s96, 393216
    s_add_u32 s96, s96, s85
    s_add_u32 m0, s87, 90112
    s_nop 0
    buffer_load_dwordx4 v8, s[16:19], s96 offen offset:0 lds
    buffer_load_dwordx4 v9, s[16:19], s96 offen offset:1024 lds
    v_mov_b32 v28, s76
    v_mul_f32 v29, s75, v28
    v_lshlrev_b32 v30, 16, v24
    v_and_b32 v31, 0xffff0000, v24
    v_fma_f32 v30, v30, v28, -v29
    buffer_load_dwordx4 v10, s[16:19], s96 offen offset:2048 lds
    v_fma_f32 v31, v31, v28, -v29
    v_cvt_pk_bf16_f32 v24, v30, v31
    v_lshlrev_b32 v30, 16, v25
    v_and_b32 v31, 0xffff0000, v25
    v_fma_f32 v30, v30, v28, -v29
    v_fma_f32 v31, v31, v28, -v29
    v_cvt_pk_bf16_f32 v25, v30, v31
    v_lshlrev_b32 v30, 16, v26
    v_and_b32 v31, 0xffff0000, v26
    v_fma_f32 v30, v30, v28, -v29
    buffer_load_dwordx4 v11, s[16:19], s96 offen offset:3072 lds
    v_fma_f32 v31, v31, v28, -v29
    v_cvt_pk_bf16_f32 v26, v30, v31
    v_lshlrev_b32 v30, 16, v27
    v_and_b32 v31, 0xffff0000, v27
    v_fma_f32 v30, v30, v28, -v29
    v_fma_f32 v31, v31, v28, -v29
    v_cvt_pk_bf16_f32 v27, v30, v31
    s_bitcmp0_b32 s29, 0
    s_cbranch_scc1 sk_105
    v_swap_b32 v24, v25
    v_swap_b32 v26, v27
sk_105:
    s_add_u32 m0, s87, 94208
    s_nop 0
    buffer_load_dwordx4 v12, s[16:19], s96 offen offset:0 lds
    s_bitcmp0_b32 s29, 1
    s_cbranch_scc1 sk_106
    v_swap_b32 v24, v26
    v_swap_b32 v25, v27
sk_106:
    buffer_load_dwordx4 v13, s[16:19], s96 offen offset:1024 lds
    v_dot2_f32_bf16 v32, v155, v24, 0
    v_dot2_f32_bf16 v33, v160, v24, 0
    v_dot2_f32_bf16 v34, v156, v24, 0
    v_dot2_f32_bf16 v35, v161, v24, 0
    v_dot2_f32_bf16 v36, v157, v24, 0
    v_dot2_f32_bf16 v37, v162, v24, 0
    v_dot2_f32_bf16 v38, v158, v24, 0
    v_dot2_f32_bf16 v39, v163, v24, 0
    v_dot2_f32_bf16 v40, v183, v24, 0
    v_dot2_f32_bf16 v41, v192, v24, 0
    v_dot2_f32_bf16 v42, v188, v24, 0
    v_dot2_f32_bf16 v43, v193, v24, 0
    v_dot2_f32_bf16 v44, v189, v24, 0
    v_dot2_f32_bf16 v45, v194, v24, 0
    v_dot2_f32_bf16 v46, v190, v24, 0
    v_dot2_f32_bf16 v47, v195, v24, 0
    v_dot2_f32_bf16 v32, v159, v25, v32
    v_dot2_f32_bf16 v33, v168, v25, v33
    v_dot2_f32_bf16 v34, v164, v25, v34
    v_dot2_f32_bf16 v35, v169, v25, v35
    v_dot2_f32_bf16 v36, v165, v25, v36
    v_dot2_f32_bf16 v37, v170, v25, v37
    v_dot2_f32_bf16 v38, v166, v25, v38
    v_dot2_f32_bf16 v39, v171, v25, v39
    v_dot2_f32_bf16 v40, v191, v25, v40
    v_dot2_f32_bf16 v41, v200, v25, v41
    v_dot2_f32_bf16 v42, v196, v25, v42
    v_dot2_f32_bf16 v43, v201, v25, v43
    v_dot2_f32_bf16 v44, v197, v25, v44
    v_dot2_f32_bf16 v45, v202, v25, v45
    v_dot2_f32_bf16 v46, v198, v25, v46
    v_dot2_f32_bf16 v47, v203, v25, v47
    v_dot2_f32_bf16 v32, v167, v26, v32
    v_dot2_f32_bf16 v33, v176, v26, v33
    v_dot2_f32_bf16 v34, v172, v26, v34
    v_dot2_f32_bf16 v35, v177, v26, v35
    v_dot2_f32_bf16 v36, v173, v26, v36
    v_dot2_f32_bf16 v37, v178, v26, v37
    v_dot2_f32_bf16 v38, v174, v26, v38
    v_dot2_f32_bf16 v39, v179, v26, v39
    v_dot2_f32_bf16 v40, v199, v26, v40
    v_dot2_f32_bf16 v41, v208, v26, v41
    v_dot2_f32_bf16 v42, v204, v26, v42
    v_dot2_f32_bf16 v43, v209, v26, v43
    v_dot2_f32_bf16 v44, v205, v26, v44
    v_dot2_f32_bf16 v45, v210, v26, v45
    v_dot2_f32_bf16 v46, v206, v26, v46
    v_dot2_f32_bf16 v47, v211, v26, v47
    v_dot2_f32_bf16 v32, v175, v27, v32
    v_dot2_f32_bf16 v33, v184, v27, v33
    v_dot2_f32_bf16 v34, v180, v27, v34
    v_dot2_f32_bf16 v35, v185, v27, v35
    v_dot2_f32_bf16 v36, v181, v27, v36
    v_dot2_f32_bf16 v37, v186, v27, v37
    v_dot2_f32_bf16 v38, v182, v27, v38
    v_dot2_f32_bf16 v39, v187, v27, v39
    v_dot2_f32_bf16 v40, v207, v27, v40
    v_dot2_f32_bf16 v41, v216, v27, v41
    v_dot2_f32_bf16 v42, v212, v27, v42
    v_dot2_f32_bf16 v43, v217, v27, v43
    v_dot2_f32_bf16 v44, v213, v27, v44
    v_dot2_f32_bf16 v45, v218, v27, v45
    v_dot2_f32_bf16 v46, v214, v27, v46
    v_dot2_f32_bf16 v47, v219, v27, v47
    s_waitcnt vmcnt(10) lgkmcnt(0)
    s_barrier
    s_add_u32 s96, s95, 9
    s_and_b32 s96, s96, 15
    s_lshl_b32 s97, s96, 14
    s_add_u32 s97, s97, s84
    s_add_u32 m0, s86, 147456
    s_nop 0
    buffer_load_dwordx4 v253, s[20:23], s97 offen offset:0 sc1 lds
    buffer_load_dwordx4 v253, s[20:23], s97 offen offset:1024 sc1 lds
    v_lshrrev_b32 v31, 5, v252
    v_lshlrev_b32 v30, 6, v31
    v_permlane32_swap_b32 v32, v40
    v_permlane32_swap_b32 v33, v41
    v_permlane32_swap_b32 v34, v42
    v_permlane32_swap_b32 v35, v43
    buffer_load_dwordx4 v253, s[20:23], s97 offen offset:2048 sc1 lds
    v_permlane32_swap_b32 v36, v44
    v_permlane32_swap_b32 v37, v45
    v_permlane32_swap_b32 v38, v46
    v_permlane32_swap_b32 v39, v47
    v_add_f32 v32, v32, v40
    buffer_load_dwordx4 v253, s[20:23], s97 offen offset:3072 sc1 lds
    v_add_f32 v33, v33, v41
    v_add_f32 v34, v34, v42
    v_add_f32 v35, v35, v43
    v_add_f32 v36, v36, v44
    v_add_f32 v37, v37, v45
    s_add_u32 s96, s95, 9
    s_and_b32 s96, s96, 15
    s_mul_i32 s96, s96, 393216
    s_add_u32 s96, s96, s85
    s_add_u32 m0, s87, 40960
    s_nop 0
    buffer_load_dwordx4 v8, s[16:19], s96 offen offset:0 lds
    v_add_f32 v38, v38, v46
    v_add_f32 v39, v39, v47
    v_and_b32 v31, 1, v252
    v_lshl_add_u32 v30, v31, 5, v30
    v_permlane16_swap_b32 v32, v36
    buffer_load_dwordx4 v9, s[16:19], s96 offen offset:1024 lds
    v_permlane16_swap_b32 v33, v37
    v_permlane16_swap_b32 v34, v38
    v_permlane16_swap_b32 v35, v39
    v_add_f32 v32, v32, v36
    v_add_f32 v33, v33, v37
    v_add_f32 v34, v34, v38
    buffer_load_dwordx4 v10, s[16:19], s96 offen offset:2048 lds
    v_add_f32 v35, v35, v39
    v_and_b32 v31, 16, v252
    s_lshl_b32 s32, s28, 7
    v_add3_u32 v30, v31, v30, s32
    v_add_f32_dpp v32, v32, v32 quad_perm:[2,3,0,1] row_mask:0xf bank_mask:0xf
    buffer_load_dwordx4 v11, s[16:19], s96 offen offset:3072 lds
    v_add_f32_dpp v33, v33, v33 quad_perm:[2,3,0,1] row_mask:0xf bank_mask:0xf
    v_add_f32_dpp v34, v34, v34 quad_perm:[2,3,0,1] row_mask:0xf bank_mask:0xf
    v_add_f32_dpp v35, v35, v35 quad_perm:[2,3,0,1] row_mask:0xf bank_mask:0xf
    v_add_f32_dpp v32, v32, v32 row_ror:4 row_mask:0xf bank_mask:0xf
    v_add_f32_dpp v33, v33, v33 row_ror:4 row_mask:0xf bank_mask:0xf
    s_add_u32 m0, s87, 45056
    s_nop 0
    buffer_load_dwordx4 v12, s[16:19], s96 offen offset:0 lds
    v_add_f32_dpp v34, v34, v34 row_ror:4 row_mask:0xf bank_mask:0xf
    v_add_f32_dpp v35, v35, v35 row_ror:4 row_mask:0xf bank_mask:0xf
    v_add_f32_dpp v32, v32, v32 row_ror:8 row_mask:0xf bank_mask:0xf
    v_add_f32_dpp v33, v33, v33 row_ror:8 row_mask:0xf bank_mask:0xf
    v_add_f32_dpp v34, v34, v34 row_ror:8 row_mask:0xf bank_mask:0xf
    buffer_load_dwordx4 v13, s[16:19], s96 offen offset:1024 lds
    v_add_f32_dpp v35, v35, v35 row_ror:8 row_mask:0xf bank_mask:0xf
    s_mov_b32 exec_lo, 0x00030003
    s_mov_b32 exec_hi, 0x00030003
    ds_write_b128 v30, v[32:35] offset:3328
    s_mov_b64 exec, -1
    s_waitcnt vmcnt(10) lgkmcnt(0)
    s_barrier
    s_add_u32 s96, s94, 10
    s_and_b32 s96, s96, 15
    s_lshl_b32 s97, s96, 14
    s_add_u32 s97, s97, s84
    s_add_u32 m0, s86, 131072
    s_nop 0
    buffer_load_dwordx4 v253, s[20:23], s97 offen offset:0 sc1 lds
    buffer_load_dwordx4 v253, s[20:23], s97 offen offset:1024 sc1 lds
    v_and_b32 v30, 1, v252
    v_bfe_u32 v31, v252, 1, 3
    v_lshl_add_u32 v30, v30, 3, v31
    v_lshlrev_b32 v30, 2, v30
    v_add_u32 v30, 3328, v30
    buffer_load_dwordx4 v253, s[20:23], s97 offen offset:2048 sc1 lds
    ds_read2_b32 v[32:33], v30 offset0:0 offset1:16
    ds_read2_b32 v[34:35], v30 offset0:32 offset1:48
    ds_read2_b32 v[36:37], v30 offset0:64 offset1:80
    ds_read2_b32 v[38:39], v30 offset0:96 offset1:112
    v_lshrrev_b32 v30, 2, v252
    buffer_load_dwordx4 v253, s[20:23], s97 offen offset:3072 sc1 lds
    v_mul_u32_u24 v30, 14336, v30
    v_and_b32 v31, 3, v252
    v_lshl_add_u32 v30, v31, 4, v30
    v_and_b32 v31, 1, v252
    v_cmp_eq_u32 vcc, 1, v31
    s_add_u32 s96, s94, 10
    s_and_b32 s96, s96, 15
    s_mul_i32 s96, s96, 393216
    s_add_u32 s96, s96, s85
    s_add_u32 m0, s87, 65536
    s_nop 0
    buffer_load_dwordx4 v8, s[16:19], s96 offen offset:0 lds
    s_mul_i32 s32, s28, 229376
    s_lshl_b32 s33, s29, 6
    s_add_u32 s32, s32, s33
    s_add_u32 s32, s32, s79
    s_add_u32 s32, s32, 0xc80000
    buffer_load_dwordx4 v9, s[16:19], s96 offen offset:1024 lds
    s_waitcnt lgkmcnt(0)
    v_add_f32 v32, v32, v34
    v_add_f32 v33, v33, v35
    v_add_f32 v36, v36, v38
    v_add_f32 v37, v37, v39
    buffer_load_dwordx4 v10, s[16:19], s96 offen offset:2048 lds
    v_add_f32 v32, v32, v36
    v_add_f32 v33, v33, v37
    v_mul_f32 v34, 0xbfb8aa3b, v32
    v_exp_f32 v34, v34
    v_mul_f32 v32, v32, v33
    buffer_load_dwordx4 v11, s[16:19], s96 offen offset:3072 lds
    v_add_f32 v34, 1.0, v34
    v_rcp_f32 v34, v34
    s_nop 0
    v_mul_f32 v32, v32, v34
    s_nop 1
    v_mov_b32_dpp v33, v32 quad_perm:[2,3,2,3] row_mask:0xf bank_mask:0xf
    v_cvt_pk_bf16_f32 v32, v32, v33
    s_add_u32 m0, s87, 69632
    s_nop 0
    buffer_load_dwordx4 v12, s[16:19], s96 offen offset:0 lds
    ds_swizzle_b32 v36, v32 offset:0x1
    ds_swizzle_b32 v37, v32 offset:0x81
    ds_swizzle_b32 v38, v32 offset:0x101
    ds_swizzle_b32 v39, v32 offset:0x181
    s_waitcnt lgkmcnt(0)
    buffer_load_dwordx4 v13, s[16:19], s96 offen offset:1024 lds
    v_dot2_f32_bf16 v40, v215, v36, 0
    v_dot2_f32_bf16 v41, v224, v36, 0
    v_dot2_f32_bf16 v42, v220, v36, 0
    v_dot2_f32_bf16 v43, v225, v36, 0
    v_dot2_f32_bf16 v44, v221, v36, 0
    v_dot2_f32_bf16 v45, v226, v36, 0
    v_dot2_f32_bf16 v46, v222, v36, 0
    v_dot2_f32_bf16 v47, v227, v36, 0
    v_dot2_f32_bf16 v40, v223, v37, v40
    v_dot2_f32_bf16 v41, v232, v37, v41
    v_dot2_f32_bf16 v42, v228, v37, v42
    v_dot2_f32_bf16 v43, v233, v37, v43
    v_dot2_f32_bf16 v44, v229, v37, v44
    v_dot2_f32_bf16 v45, v234, v37, v45
    v_dot2_f32_bf16 v46, v230, v37, v46
    v_dot2_f32_bf16 v47, v235, v37, v47
    v_dot2_f32_bf16 v40, v231, v38, v40
    v_dot2_f32_bf16 v41, v240, v38, v41
    v_dot2_f32_bf16 v42, v236, v38, v42
    v_dot2_f32_bf16 v43, v241, v38, v43
    v_dot2_f32_bf16 v44, v237, v38, v44
    v_dot2_f32_bf16 v45, v242, v38, v45
    v_dot2_f32_bf16 v46, v238, v38, v46
    v_dot2_f32_bf16 v47, v243, v38, v47
    v_dot2_f32_bf16 v40, v239, v39, v40
    v_dot2_f32_bf16 v41, v248, v39, v41
    v_dot2_f32_bf16 v42, v244, v39, v42
    v_dot2_f32_bf16 v43, v249, v39, v43
    v_dot2_f32_bf16 v44, v245, v39, v44
    v_dot2_f32_bf16 v45, v250, v39, v45
    v_dot2_f32_bf16 v46, v246, v39, v46
    v_dot2_f32_bf16 v47, v251, v39, v47
    v_add_f32_dpp v40, v40, v40 quad_perm:[1,0,3,2] row_mask:0xf bank_mask:0xf
    v_add_f32_dpp v41, v41, v41 quad_perm:[1,0,3,2] row_mask:0xf bank_mask:0xf
    v_add_f32_dpp v42, v42, v42 quad_perm:[1,0,3,2] row_mask:0xf bank_mask:0xf
    v_add_f32_dpp v43, v43, v43 quad_perm:[1,0,3,2] row_mask:0xf bank_mask:0xf
    v_add_f32_dpp v44, v44, v44 quad_perm:[1,0,3,2] row_mask:0xf bank_mask:0xf
    v_add_f32_dpp v45, v45, v45 quad_perm:[1,0,3,2] row_mask:0xf bank_mask:0xf
    v_add_f32_dpp v46, v46, v46 quad_perm:[1,0,3,2] row_mask:0xf bank_mask:0xf
    v_add_f32_dpp v47, v47, v47 quad_perm:[1,0,3,2] row_mask:0xf bank_mask:0xf
    v_cndmask_b32 v40, v40, v44, vcc
    v_cndmask_b32 v41, v41, v45, vcc
    v_cndmask_b32 v42, v42, v46, vcc
    v_cndmask_b32 v43, v43, v47, vcc
    s_cmp_lt_u32 s29, 224
    s_cselect_b64 exec, -1, 0
    buffer_store_dwordx4 v[40:43], v30, s[20:23], s32 offen sc1
    s_mov_b64 exec, -1
    s_waitcnt vmcnt(10) lgkmcnt(0)
    s_barrier
    s_add_u32 s96, s95, 11
    s_and_b32 s96, s96, 15
    s_lshl_b32 s97, s96, 14
    s_add_u32 s97, s97, s84
    s_add_u32 m0, s86, 114688
    s_nop 0
    buffer_load_dwordx4 v253, s[20:23], s97 offen offset:0 sc1 lds
    buffer_load_dwordx4 v253, s[20:23], s97 offen offset:1024 sc1 lds
    buffer_load_dwordx4 v253, s[20:23], s97 offen offset:2048 sc1 lds
    buffer_load_dwordx4 v253, s[20:23], s97 offen offset:3072 sc1 lds
    s_add_u32 s96, s95, 11
    s_and_b32 s96, s96, 15
    s_mul_i32 s96, s96, 393216
    s_add_u32 s96, s96, s85
    s_add_u32 m0, s87, 90112
    s_nop 0
    buffer_load_dwordx4 v8, s[16:19], s96 offen offset:0 lds
    buffer_load_dwordx4 v9, s[16:19], s96 offen offset:1024 lds
    buffer_load_dwordx4 v10, s[16:19], s96 offen offset:2048 lds
    buffer_load_dwordx4 v11, s[16:19], s96 offen offset:3072 lds
    s_add_u32 m0, s87, 94208
    s_nop 0
    buffer_load_dwordx4 v12, s[16:19], s96 offen offset:0 lds
    buffer_load_dwordx4 v13, s[16:19], s96 offen offset:1024 lds
    s_waitcnt vmcnt(10) lgkmcnt(0)
    s_barrier
    s_add_u32 s96, s94, 12
    s_and_b32 s96, s96, 15
    s_lshl_b32 s97, s96, 14
    s_add_u32 s97, s97, s84
    s_add_u32 m0, s86, 147456
    s_nop 0
    buffer_load_dwordx4 v253, s[20:23], s97 offen offset:0 sc1 lds
    buffer_load_dwordx4 v253, s[20:23], s97 offen offset:1024 sc1 lds
    buffer_load_dwordx4 v253, s[20:23], s97 offen offset:2048 sc1 lds
    buffer_load_dwordx4 v253, s[20:23], s97 offen offset:3072 sc1 lds
    s_add_u32 s96, s94, 12
    s_and_b32 s96, s96, 15
    s_mul_i32 s96, s96, 393216
    s_add_u32 s96, s96, s85
    s_add_u32 m0, s87, 40960
    s_nop 0
    buffer_load_dwordx4 v8, s[16:19], s96 offen offset:0 lds
    buffer_load_dwordx4 v9, s[16:19], s96 offen offset:1024 lds
    buffer_load_dwordx4 v10, s[16:19], s96 offen offset:2048 lds
    buffer_load_dwordx4 v11, s[16:19], s96 offen offset:3072 lds
    s_add_u32 m0, s87, 45056
    s_nop 0
    buffer_load_dwordx4 v12, s[16:19], s96 offen offset:0 lds
    buffer_load_dwordx4 v13, s[16:19], s96 offen offset:1024 lds
    s_waitcnt vmcnt(10) lgkmcnt(0)
    s_barrier
    s_cmp_lt_u32 s29, 224
    s_cbranch_scc1 sk_122
    s_cmp_ge_u32 s28, 2
    s_cbranch_scc1 sk_122
    s_mul_i32 s32, s89, 14336
    s_add_u32 s32, s32, s79
    s_add_u32 s32, s32, 0xc80000
    buffer_load_dwordx4 v[32:35], v253, s[20:23], s32 offen offset:0 sc1
    buffer_load_dwordx4 v[36:39], v253, s[20:23], s32 offen offset:1024 sc1
    buffer_load_dwordx4 v[40:43], v253, s[20:23], s32 offen offset:2048 sc1
    buffer_load_dwordx4 v[44:47], v253, s[20:23], s32 offen offset:3072 sc1
    s_add_u32 s32, s32, 4096
    buffer_load_dwordx4 v[48:51], v253, s[20:23], s32 offen offset:0 sc1
    buffer_load_dwordx4 v[52:55], v253, s[20:23], s32 offen offset:1024 sc1
    buffer_load_dwordx4 v[56:59], v253, s[20:23], s32 offen offset:2048 sc1
    buffer_load_dwordx4 v[60:63], v253, s[20:23], s32 offen offset:3072 sc1
    s_add_u32 s32, s32, 4096
    buffer_load_dwordx4 v[64:67], v253, s[20:23], s32 offen offset:0 sc1
    buffer_load_dwordx4 v[68:71], v253, s[20:23], s32 offen offset:1024 sc1
    buffer_load_dwordx4 v[72:75], v253, s[20:23], s32 offen offset:2048 sc1
    buffer_load_dwordx4 v[76:79], v253, s[20:23], s32 offen offset:3072 sc1
    s_add_u32 s32, s32, 4096
    buffer_load_dwordx4 v[80:83], v253, s[20:23], s32 offen offset:0 sc1
    buffer_load_dwordx4 v[84:87], v253, s[20:23], s32 offen offset:1024 sc1
sk_122:
    s_add_u32 s96, s95, 13
    s_and_b32 s96, s96, 15
    s_lshl_b32 s97, s96, 14
    s_add_u32 s97, s97, s84
    s_add_u32 m0, s86, 131072
    s_nop 0
    buffer_load_dwordx4 v253, s[20:23], s97 offen offset:0 sc1 lds
    buffer_load_dwordx4 v253, s[20:23], s97 offen offset:1024 sc1 lds
    buffer_load_dwordx4 v253, s[20:23], s97 offen offset:2048 sc1 lds
    buffer_load_dwordx4 v253, s[20:23], s97 offen offset:3072 sc1 lds
    s_add_u32 s96, s95, 13
    s_and_b32 s96, s96, 15
    s_mul_i32 s96, s96, 393216
    s_add_u32 s96, s96, s85
    s_add_u32 m0, s87, 65536
    s_nop 0
    buffer_load_dwordx4 v8, s[16:19], s96 offen offset:0 lds
    buffer_load_dwordx4 v9, s[16:19], s96 offen offset:1024 lds
    buffer_load_dwordx4 v10, s[16:19], s96 offen offset:2048 lds
    buffer_load_dwordx4 v11, s[16:19], s96 offen offset:3072 lds
    s_add_u32 m0, s87, 69632
    s_nop 0
    buffer_load_dwordx4 v12, s[16:19], s96 offen offset:0 lds
    buffer_load_dwordx4 v13, s[16:19], s96 offen offset:1024 lds
    s_waitcnt vmcnt(10) lgkmcnt(0)
    s_barrier
    s_add_u32 s96, s94, 14
    s_and_b32 s96, s96, 15
    s_lshl_b32 s97, s96, 14
    s_add_u32 s97, s97, s84
    s_add_u32 m0, s86, 114688
    s_nop 0
    buffer_load_dwordx4 v253, s[20:23], s97 offen offset:0 sc1 lds
    buffer_load_dwordx4 v253, s[20:23], s97 offen offset:1024 sc1 lds
    s_cmp_lt_u32 s29, 224
    s_cbranch_scc1 sk_123
    s_cmp_ge_u32 s28, 2
    s_cbranch_scc1 sk_123
    s_mov_b32 s78, s27
    s_waitcnt vmcnt(12)
    s_branch pc_109
pl_108:
    s_mul_i32 s32, s89, 14336
    s_add_u32 s32, s32, s79
    s_add_u32 s32, s32, 0xc80000
    buffer_load_dwordx4 v[32:35], v253, s[20:23], s32 offen offset:0 sc1
    buffer_load_dwordx4 v[36:39], v253, s[20:23], s32 offen offset:1024 sc1
    buffer_load_dwordx4 v[40:43], v253, s[20:23], s32 offen offset:2048 sc1
    buffer_load_dwordx4 v[44:47], v253, s[20:23], s32 offen offset:3072 sc1
    s_add_u32 s32, s32, 4096
    buffer_load_dwordx4 v[48:51], v253, s[20:23], s32 offen offset:0 sc1
    buffer_load_dwordx4 v[52:55], v253, s[20:23], s32 offen offset:1024 sc1
    buffer_load_dwordx4 v[56:59], v253, s[20:23], s32 offen offset:2048 sc1
    buffer_load_dwordx4 v[60:63], v253, s[20:23], s32 offen offset:3072 sc1
    s_add_u32 s32, s32, 4096
    buffer_load_dwordx4 v[64:67], v253, s[20:23], s32 offen offset:0 sc1
    buffer_load_dwordx4 v[68:71], v253, s[20:23], s32 offen offset:1024 sc1
    buffer_load_dwordx4 v[72:75], v253, s[20:23], s32 offen offset:2048 sc1
    buffer_load_dwordx4 v[76:79], v253, s[20:23], s32 offen offset:3072 sc1
    s_add_u32 s32, s32, 4096
    buffer_load_dwordx4 v[80:83], v253, s[20:23], s32 offen offset:0 sc1
    buffer_load_dwordx4 v[84:87], v253, s[20:23], s32 offen offset:1024 sc1
    s_waitcnt vmcnt(0)
pc_109:
    v_max3_u32 v30, v32, v36, v40
    v_max3_u32 v30, v30, v44, v48
    v_max3_u32 v30, v30, v52, v56
    v_max3_u32 v30, v30, v60, v64
    v_max3_u32 v30, v30, v68, v72
    v_max3_u32 v30, v30, v76, v80
    v_max_u32 v30, v30, v84
    v_cmp_eq_u32 vcc, -1, v30
    s_cbranch_vccz pd_110
    s_sub_u32 s78, s78, 1
    s_cmp_lg_u32 s78, 0
    s_cbranch_scc1 pl_108
    s_mov_b32 s27, 1
pd_110:
sk_123:
    buffer_load_dwordx4 v253, s[20:23], s97 offen offset:2048 sc1 lds
    buffer_load_dwordx4 v253, s[20:23], s97 offen offset:3072 sc1 lds
    s_cmp_lt_u32 s29, 224
    s_cbranch_scc1 sk_124
    s_cmp_ge_u32 s28, 2
    s_cbranch_scc1 sk_124
sk_124:
    s_cmp_lt_u32 s29, 224
    s_cbranch_scc1 sk_125
    s_cmp_ge_u32 s28, 2
    s_cbranch_scc1 sk_125
    v_add_f32 v32, v32, v36
    v_add_f32 v33, v33, v37
    v_add_f32 v34, v34, v38
    v_add_f32 v35, v35, v39
    v_add_f32 v32, v32, v40
    v_add_f32 v33, v33, v41
    v_add_f32 v34, v34, v42
    v_add_f32 v35, v35, v43
    v_add_f32 v32, v32, v44
    v_add_f32 v33, v33, v45
sk_125:
    s_add_u32 s96, s94, 14
    s_and_b32 s96, s96, 15
    s_mul_i32 s96, s96, 393216
    s_add_u32 s96, s96, s85
    s_add_u32 m0, s87, 90112
    s_nop 0
    buffer_load_dwordx4 v8, s[16:19], s96 offen offset:0 lds
    s_cmp_lt_u32 s29, 224
    s_cbranch_scc1 sk_126
    s_cmp_ge_u32 s28, 2
    s_cbranch_scc1 sk_126
    v_add_f32 v34, v34, v46
    v_add_f32 v35, v35, v47
    v_add_f32 v32, v32, v48
    v_add_f32 v33, v33, v49
    v_add_f32 v34, v34, v50
    v_add_f32 v35, v35, v51
    v_add_f32 v32, v32, v52
    v_add_f32 v33, v33, v53
    v_add_f32 v34, v34, v54
    v_add_f32 v35, v35, v55
    v_add_f32 v32, v32, v56
    v_add_f32 v33, v33, v57
    v_add_f32 v34, v34, v58
    v_add_f32 v35, v35, v59
    v_add_f32 v32, v32, v60
    v_add_f32 v33, v33, v61
    v_add_f32 v34, v34, v62
    v_add_f32 v35, v35, v63
sk_126:
    buffer_load_dwordx4 v9, s[16:19], s96 offen offset:1024 lds
    s_cmp_lt_u32 s29, 224
    s_cbranch_scc1 sk_127
    s_cmp_ge_u32 s28, 2
    s_cbranch_scc1 sk_127
    v_add_f32 v32, v32, v64
    v_add_f32 v33, v33, v65
    v_add_f32 v34, v34, v66
    v_add_f32 v35, v35, v67
    v_add_f32 v32, v32, v68
    v_add_f32 v33, v33, v69
    v_add_f32 v34, v34, v70
    v_add_f32 v35, v35, v71
    v_add_f32 v32, v32, v72
    v_add_f32 v33, v33, v73
    v_add_f32 v34, v34, v74
    v_add_f32 v35, v35, v75
    v_add_f32 v32, v32, v76
    v_add_f32 v33, v33, v77
    v_add_f32 v34, v34, v78
    v_add_f32 v35, v35, v79
    v_add_f32 v32, v32, v80
sk_127:
    buffer_load_dwordx4 v10, s[16:19], s96 offen offset:2048 lds
    s_cmp_lt_u32 s29, 224
    s_cbranch_scc1 sk_128
    s_cmp_ge_u32 s28, 2
    s_cbranch_scc1 sk_128
    v_add_f32 v33, v33, v81
    v_add_f32 v34, v34, v82
    v_add_f32 v35, v35, v83
    v_add_f32 v32, v32, v84
    v_add_f32 v33, v33, v85
    v_add_f32 v34, v34, v86
    v_add_f32 v35, v35, v87
    v_add_f32_dpp v32, v32, v32 row_ror:4 row_mask:0xf bank_mask:0xf
    v_add_f32_dpp v33, v33, v33 row_ror:4 row_mask:0xf bank_mask:0xf
    v_add_f32_dpp v34, v34, v34 row_ror:4 row_mask:0xf bank_mask:0xf
    v_add_f32_dpp v35, v35, v35 row_ror:4 row_mask:0xf bank_mask:0xf
    v_add_f32_dpp v32, v32, v32 row_ror:8 row_mask:0xf bank_mask:0xf
    v_add_f32_dpp v33, v33, v33 row_ror:8 row_mask:0xf bank_mask:0xf
    v_add_f32_dpp v34, v34, v34 row_ror:8 row_mask:0xf bank_mask:0xf
    v_add_f32_dpp v35, v35, v35 row_ror:8 row_mask:0xf bank_mask:0xf
    v_mov_b32 v36, v32
    v_mov_b32 v37, v33
    v_mov_b32 v38, v34
sk_128:
    buffer_load_dwordx4 v11, s[16:19], s96 offen offset:3072 lds
    s_cmp_lt_u32 s29, 224
    s_cbranch_scc1 sk_129
    s_cmp_ge_u32 s28, 2
    s_cbranch_scc1 sk_129
    v_mov_b32 v39, v35
    v_permlane16_swap_b32 v32, v36
    v_permlane16_swap_b32 v33, v37
    v_permlane16_swap_b32 v34, v38
    v_permlane16_swap_b32 v35, v39
    v_add_f32 v32, v32, v36
    v_add_f32 v33, v33, v37
    v_add_f32 v34, v34, v38
    v_add_f32 v35, v35, v39
    v_mov_b32 v36, v32
    v_mov_b32 v37, v33
    v_mov_b32 v38, v34
    v_mov_b32 v39, v35
    v_permlane32_swap_b32 v32, v36
    v_permlane32_swap_b32 v33, v37
    v_permlane32_swap_b32 v34, v38
    v_permlane32_swap_b32 v35, v39
    v_add_f32 v32, v32, v36
sk_129:
    s_add_u32 m0, s87, 94208
    s_nop 0
    buffer_load_dwordx4 v12, s[16:19], s96 offen offset:0 lds
    buffer_load_dwordx4 v13, s[16:19], s96 offen offset:1024 lds
    s_cmp_lt_u32 s29, 224
    s_cbranch_scc1 sk_130
    s_cmp_ge_u32 s28, 2
    s_cbranch_scc1 sk_130
    v_add_f32 v33, v33, v37
    v_add_f32 v34, v34, v38
    v_add_f32 v35, v35, v39
    v_fma_f32 v32, v32, v96, v92
    v_fma_f32 v33, v33, v96, v93
    v_fma_f32 v34, v34, v96, v94
    v_fma_f32 v35, v35, v96, v95
    v_cvt_pk_bf16_f32 v32, v32, v33
    v_cvt_pk_bf16_f32 v33, v34, v35
    s_lshl_b32 s32, s89, 5
    s_add_u32 s32, s32, 0xdc4000
    v_and_b32 v30, 1, v252
    v_bfe_u32 v31, v252, 1, 1
    v_lshlrev_b32 v30, 4, v30
    v_lshl_add_u32 v30, v31, 3, v30
    s_mov_b64 exec, 15
    buffer_store_dwordx2 v[32:33], v30, s[20:23], s32 offen sc1
    s_mov_b64 exec, -1
sk_130:
    s_waitcnt vmcnt(10) lgkmcnt(0)
    s_barrier
    s_add_u32 s96, s95, 15
    s_and_b32 s96, s96, 15
    s_lshl_b32 s97, s96, 14
    s_add_u32 s97, s97, s84
    s_add_u32 m0, s86, 147456
    s_nop 0
    buffer_load_dwordx4 v253, s[20:23], s97 offen offset:0 sc1 lds
    buffer_load_dwordx4 v253, s[20:23], s97 offen offset:1024 sc1 lds
    buffer_load_dwordx4 v253, s[20:23], s97 offen offset:2048 sc1 lds
    buffer_load_dwordx4 v253, s[20:23], s97 offen offset:3072 sc1 lds
    s_add_u32 s96, s95, 15
    s_and_b32 s96, s96, 15
    s_mul_i32 s96, s96, 393216
    s_add_u32 s96, s96, s85
    s_add_u32 m0, s87, 40960
    s_nop 0
    buffer_load_dwordx4 v8, s[16:19], s96 offen offset:0 lds
    buffer_load_dwordx4 v9, s[16:19], s96 offen offset:1024 lds
    buffer_load_dwordx4 v10, s[16:19], s96 offen offset:2048 lds
    buffer_load_dwordx4 v11, s[16:19], s96 offen offset:3072 lds
    s_add_u32 m0, s87, 45056
    s_nop 0
    buffer_load_dwordx4 v12, s[16:19], s96 offen offset:0 lds
    buffer_load_dwordx4 v13, s[16:19], s96 offen offset:1024 lds
    s_waitcnt vmcnt(10) lgkmcnt(0)
    s_barrier
    s_min_u32 s30, s28, 2
    s_lshl_b32 s30, s30, 13
    s_add_u32 s30, s30, 90112
    v_lshrrev_b32 v20, 2, v252
    v_bfe_u32 v21, v20, 1, 2
    v_lshlrev_b32 v20, 7, v20
    v_lshl_add_u32 v20, v21, 5, v20
    v_and_b32 v21, 3, v252
    v_lshl_add_u32 v20, v21, 3, v20
    v_add_u32 v144, s30, v20
    v_xor_b32 v145, 32, v144
    v_xor_b32 v146, 64, v144
    v_xor_b32 v147, 96, v144
    ds_read_b64_tr_b16 v[100:101], v144 offset:0
    ds_read_b64_tr_b16 v[102:103], v144 offset:2048
    ds_read_b64_tr_b16 v[104:105], v144 offset:4096
    ds_read_b64_tr_b16 v[106:107], v144 offset:6144
    ds_read_b64_tr_b16 v[108:109], v145 offset:0
    ds_read_b64_tr_b16 v[110:111], v145 offset:2048
    ds_read_b64_tr_b16 v[112:113], v145 offset:4096
    ds_read_b64_tr_b16 v[114:115], v145 offset:6144
    ds_read_b64_tr_b16 v[116:117], v146 offset:0
    ds_read_b64_tr_b16 v[118:119], v146 offset:2048
    ds_read_b64_tr_b16 v[120:121], v146 offset:4096
    ds_read_b64_tr_b16 v[122:123], v146 offset:6144
    ds_read_b64_tr_b16 v[124:125], v147 offset:0
    ds_read_b64_tr_b16 v[126:127], v147 offset:2048
    ds_read_b64_tr_b16 v[128:129], v147 offset:4096
    ds_read_b64_tr_b16 v[130:131], v147 offset:6144
    s_getpc_b64 s[32:33]
pc_131:
    s_sub_u32 s32, s32, pc_131-interleave_layers__sliding_block__moe_arch_mod__prompt_kernel
    s_subb_u32 s33, s33, 0
    s_lshr_b32 s34, s2, 3
    s_lshl_b32 s34, s34, 2
    s_add_u32 s34, s34, s28
    s_and_b32 s34, s34, 127
    s_lshl_b32 s34, s34, 7
    v_lshl_add_u32 v154, v252, 14, s34
    s_mov_b32 s34, k_exit-interleave_layers__sliding_block__moe_arch_mod__prompt_kernel
    s_mov_b32 s35, 0x20000
    buffer_load_dword v154, v154, s[32:35], 0 offen
    s_waitcnt vmcnt(1) lgkmcnt(0)
    s_barrier
    s_add_u32 s35, s94, 14
    s_and_b32 s35, s35, 15
    s_lshl_b32 s35, s35, 7
    s_add_u32 s35, s35, 0xdc4000
    v_and_b32 v19, 48, v252
    buffer_load_dwordx4 v[132:135], v19, s[20:23], s35 offen offset:0 sc1
    buffer_load_dwordx4 v[136:139], v19, s[20:23], s35 offen offset:64 sc1
    s_cmp_eq_u32 s100, 0
    s_cbranch_scc1 sk_132
    v_and_b32 v20, 7, v252
    v_lshrrev_b32 v21, 4, v252
    v_lshl_add_u32 v21, v20, 2, v21
    s_and_b32 s34, s73, 31
    s_and_b32 s32, s34, 7
    s_and_b32 s33, s34, 8
    s_lshl_b32 s33, s33, 1
    s_add_u32 s32, s32, s33
    s_lshr_b32 s33, s34, 4
    s_lshl_b32 s33, s33, 3
    s_add_u32 s32, s32, s33
    s_cmp_eq_u32 s28, 1
    s_cselect_b32 s34, s32, s34
    v_mov_b32 v20, s34
    s_cmp_ge_u32 s28, 2
    s_cselect_b64 vcc, -1, 0
    s_cselect_b32 s32, 2048, 0
    v_cndmask_b32 v30, v20, v21, vcc
    v_cndmask_b32 v31, v21, v20, vcc
    v_lshlrev_b32 v0, 4, v30
    v_bfe_u32 v20, v31, 2, 2
    v_lshl_add_u32 v0, v20, 9, v0
    v_lshrrev_b32 v20, 4, v31
    v_lshl_add_u32 v0, v20, 3, v0
    v_and_b32 v20, 3, v31
    v_lshl_add_u32 v0, v20, 1, v0
    s_lshl_b32 s33, s39, 12
    s_add_u32 s33, s33, s32
    s_add_u32 s33, s33, 65536
    s_lshl_b32 s34, s39, 11
    s_add_u32 s34, s34, 32768
    s_cmp_ge_u32 s39, 8
    s_cselect_b32 s38, 1, 0
    s_movk_i32 s32, 8192
    s_cmp_eq_u32 s28, 0
    s_cselect_b32 s33, s34, s33
    s_cselect_b32 s32, s32, 49152
    s_cselect_b32 s38, s38, 1
    s_cselect_b32 s37, 0x3e8293ee, 1.0
    v_bfe_u32 v20, v252, 3, 1
    v_mul_u32_u24 v20, s32, v20
    v_add3_u32 v0, v0, v20, s33
sk_132:
    s_waitcnt lgkmcnt(0)
    s_barrier
    s_mov_b32 s78, s27
    s_waitcnt vmcnt(0)
    s_branch pc_134
pl_133:
    s_add_u32 s35, s94, 14
    s_and_b32 s35, s35, 15
    s_lshl_b32 s35, s35, 7
    s_add_u32 s35, s35, 0xdc4000
    v_and_b32 v19, 48, v252
    buffer_load_dwordx4 v[132:135], v19, s[20:23], s35 offen offset:0 sc1
    buffer_load_dwordx4 v[136:139], v19, s[20:23], s35 offen offset:64 sc1
    s_waitcnt vmcnt(0)
pc_134:
    v_max3_u32 v30, v132, v133, v134
    v_max3_u32 v30, v30, v135, v136
    v_max3_u32 v30, v30, v137, v138
    v_max_u32 v30, v30, v139
    v_cmp_eq_u32 vcc, -1, v30
    s_cbranch_vccz pd_135
    s_sub_u32 s78, s78, 1
    s_cmp_lg_u32 s78, 0
    s_cbranch_scc1 pl_133
    s_mov_b32 s27, 1
pd_135:
    v_mov_b32 v140, 0
    v_mov_b32 v141, 0
    v_mov_b32 v142, 0
    v_mov_b32 v143, 0
    v_dot2c_f32_bf16 v140, v132, v100
    v_dot2c_f32_bf16 v141, v132, v108
    v_dot2c_f32_bf16 v142, v132, v116
    v_dot2c_f32_bf16 v143, v132, v124
    v_dot2c_f32_bf16 v140, v133, v101
    v_dot2c_f32_bf16 v141, v133, v109
    v_dot2c_f32_bf16 v142, v133, v117
    v_dot2c_f32_bf16 v143, v133, v125
    v_dot2c_f32_bf16 v140, v134, v102
    v_dot2c_f32_bf16 v141, v134, v110
    v_dot2c_f32_bf16 v142, v134, v118
    v_dot2c_f32_bf16 v143, v134, v126
    v_dot2c_f32_bf16 v140, v135, v103
    v_dot2c_f32_bf16 v141, v135, v111
    v_dot2c_f32_bf16 v142, v135, v119
    v_dot2c_f32_bf16 v143, v135, v127
    v_dot2c_f32_bf16 v140, v136, v104
    v_dot2c_f32_bf16 v141, v136, v112
    v_dot2c_f32_bf16 v142, v136, v120
    v_dot2c_f32_bf16 v143, v136, v128
    v_dot2c_f32_bf16 v140, v137, v105
    v_dot2c_f32_bf16 v141, v137, v113
    v_dot2c_f32_bf16 v142, v137, v121
    v_dot2c_f32_bf16 v143, v137, v129
    v_dot2c_f32_bf16 v140, v138, v106
    v_dot2c_f32_bf16 v141, v138, v114
    v_dot2c_f32_bf16 v142, v138, v122
    v_dot2c_f32_bf16 v143, v138, v130
    v_dot2c_f32_bf16 v140, v139, v107
    v_dot2c_f32_bf16 v141, v139, v115
    v_dot2c_f32_bf16 v142, v139, v123
    v_dot2c_f32_bf16 v143, v139, v131
    s_min_u32 s32, s28, 2
    s_lshl_b32 s32, s32, 12
    s_lshl_b32 s33, s25, 14
    s_add_u32 s32, s32, s33
    s_add_u32 s32, s32, 0x1d80000
    s_lshl_b32 s33, s24, 8
    s_add_u32 s32, s32, s33
    v_lshlrev_b32 v20, 2, v252
    v_permlane32_swap_b32 v140, v142
    v_permlane32_swap_b32 v141, v143
    v_add_f32 v140, v140, v142
    v_add_f32 v141, v141, v143
    s_nop 1
    v_permlane16_swap_b32 v140, v141
    v_add_f32 v140, v140, v141
    buffer_store_dword v140, v20, s[20:23], s32 offen sc1
    s_branch l_att
l_patch:
    s_mov_b32 s78, s27
    s_waitcnt vmcnt(16)
    s_branch pc_137
pl_136:
    s_min_u32 s32, s28, 2
    s_lshl_b32 s32, s32, 12
    s_lshl_b32 s33, s25, 14
    s_add_u32 s32, s32, s33
    s_add_u32 s32, s32, 0x1d80000
    buffer_load_dwordx4 v[56:59], v253, s[20:23], s32 offen offset:0 sc1
    buffer_load_dwordx4 v[60:63], v253, s[20:23], s32 offen offset:1024 sc1
    buffer_load_dwordx4 v[64:67], v253, s[20:23], s32 offen offset:2048 sc1
    buffer_load_dwordx4 v[68:71], v253, s[20:23], s32 offen offset:3072 sc1
    s_mov_b32 s32, 0xdc4000
    buffer_load_dwordx4 v[72:75], v253, s[20:23], s32 offen offset:0 sc1
    buffer_load_dwordx4 v[76:79], v253, s[20:23], s32 offen offset:1024 sc1
    s_waitcnt vmcnt(0)
pc_137:
    v_max3_u32 v82, v56, v57, v58
    v_max3_u32 v82, v82, v59, v60
    v_max3_u32 v82, v82, v61, v62
    v_max3_u32 v82, v82, v63, v64
    v_max3_u32 v82, v82, v65, v66
    v_max3_u32 v82, v82, v67, v68
    v_max3_u32 v82, v82, v69, v70
    v_max3_u32 v82, v82, v71, v72
    v_max3_u32 v82, v82, v73, v74
    v_max3_u32 v82, v82, v75, v76
    v_max3_u32 v82, v82, v77, v78
    v_max_u32 v82, v82, v79
    v_cmp_eq_u32 vcc, -1, v82
    s_cbranch_vccz pd_138
    s_sub_u32 s78, s78, 1
    s_cmp_lg_u32 s78, 0
    s_cbranch_scc1 pl_136
    s_mov_b32 s27, 1
pd_138:
    v_mov_b32 v80, 0
    v_mov_b32 v81, 0
    v_dot2c_f32_bf16 v80, 0x3f803f80, v72
    v_dot2c_f32_bf16 v81, v72, v72
    v_dot2c_f32_bf16 v80, 0x3f803f80, v73
    v_dot2c_f32_bf16 v81, v73, v73
    v_dot2c_f32_bf16 v80, 0x3f803f80, v74
    v_dot2c_f32_bf16 v81, v74, v74
    v_dot2c_f32_bf16 v80, 0x3f803f80, v75
    v_dot2c_f32_bf16 v81, v75, v75
    v_dot2c_f32_bf16 v80, 0x3f803f80, v76
    v_dot2c_f32_bf16 v81, v76, v76
    v_dot2c_f32_bf16 v80, 0x3f803f80, v77
    v_dot2c_f32_bf16 v81, v77, v77
    v_dot2c_f32_bf16 v80, 0x3f803f80, v78
    v_dot2c_f32_bf16 v81, v78, v78
    v_dot2c_f32_bf16 v80, 0x3f803f80, v79
    v_dot2c_f32_bf16 v81, v79, v79
    v_pk_add_f32 v[56:57], v[56:57], v[60:61]
    v_pk_add_f32 v[58:59], v[58:59], v[62:63]
    v_pk_add_f32 v[56:57], v[56:57], v[64:65]
    v_pk_add_f32 v[58:59], v[58:59], v[66:67]
    v_pk_add_f32 v[56:57], v[56:57], v[68:69]
    v_pk_add_f32 v[58:59], v[58:59], v[70:71]
    s_nop 1
    v_permlane32_swap_b32 v56, v58
    v_permlane32_swap_b32 v57, v59
    v_add_f32 v56, v56, v58
    v_add_f32 v57, v57, v59
    s_nop 1
    v_permlane16_swap_b32 v56, v57
    v_add_f32 v56, v56, v57
    v_add_f32_dpp v80, v80, v80 quad_perm:[1,0,3,2] row_mask:0xf bank_mask:0xf
    v_add_f32_dpp v81, v81, v81 quad_perm:[1,0,3,2] row_mask:0xf bank_mask:0xf
    s_nop 0
    v_add_f32_dpp v80, v80, v80 quad_perm:[2,3,0,1] row_mask:0xf bank_mask:0xf
    v_add_f32_dpp v81, v81, v81 quad_perm:[2,3,0,1] row_mask:0xf bank_mask:0xf
    s_nop 0
    v_add_f32_dpp v80, v80, v80 row_half_mirror row_mask:0xf bank_mask:0xf
    v_add_f32_dpp v81, v81, v81 row_half_mirror row_mask:0xf bank_mask:0xf
    s_nop 0
    v_add_f32_dpp v80, v80, v80 row_mirror row_mask:0xf bank_mask:0xf
    v_add_f32_dpp v81, v81, v81 row_mirror row_mask:0xf bank_mask:0xf
    v_mov_b32 v82, v80
    v_mov_b32 v83, v81
    s_nop 0
    v_permlane16_swap_b32 v80, v82
    v_permlane16_swap_b32 v81, v83
    v_add_f32 v80, v80, v82
    v_add_f32 v81, v81, v83
    v_mov_b32 v82, v80
    v_mov_b32 v83, v81
    s_nop 0
    v_permlane32_swap_b32 v80, v82
    v_permlane32_swap_b32 v81, v83
    v_add_f32 v80, v80, v82
    v_add_f32 v81, v81, v83
    v_mul_f32 v80, 0x3a800000, v80
    v_mul_f32 v81, 0x3a800000, v81
    v_fma_f32 v81, -v80, v80, v81
    v_max_f32 v81, 0, v81
    v_add_f32 v81, 0x3727c5ac, v81
    v_rsq_f32 v81, v81
    v_fma_f32 v56, -v80, v2, v56
    v_mul_f32 v81, s37, v81
    v_mul_f32 v56, v56, v81
    v_cvt_pk_bf16_f32 v1, v56, v56
    s_cmp_lg_u32 s38, 0
    s_waitcnt vmcnt(0)
    s_barrier
    s_cselect_b64 exec, -1, 0
    ds_write_b16 v0, v1
    s_mov_b64 exec, -1
    s_waitcnt lgkmcnt(0)
    s_barrier
    s_branch l_patched
l_tail:
    v_mov_b32 v20, 0
    s_or_b32 s34, s72, s28
    s_cmp_lg_u32 s34, 0
    s_cbranch_scc1 sk_139
    s_mov_b32 s34, 0xdd8000
    v_mov_b32 v154, s88
    s_mov_b64 exec, 1
    s_waitcnt vmcnt(0)
    buffer_store_dword v154, v253, s[20:23], s34 offen sc1
    s_mov_b64 exec, -1
sk_139:
    s_barrier
    ds_read_b128 v[16:19], v20 offset:3072
    s_waitcnt lgkmcnt(0)
    v_readlane_b32 s74, v16, 0
    v_readlane_b32 s73, v17, 0
    v_readlane_b32 s75, v18, 0
    v_readlane_b32 s76, v19, 0
    s_and_b32 s73, s73, 2047
    s_mov_b32 s78, s27
pl_140:
    s_lshr_b32 s33, s73, 5
    s_lshl_b32 s33, s33, 11
    s_add_u32 s33, s33, s79
    s_add_u32 s33, s33, 0xd60000
    buffer_load_dwordx4 v[24:27], v22, s[20:23], s33 offen sc1
    s_waitcnt vmcnt(0)
pc_141:
    v_max3_u32 v30, v24, v25, v26
    v_max_u32 v30, v30, v27
    v_cmp_eq_u32 vcc, -1, v30
    s_cbranch_vccz pd_142
    s_sub_u32 s78, s78, 1
    s_cmp_lg_u32 s78, 0
    s_cbranch_scc1 pl_140
    s_mov_b32 s27, 1
pd_142:
    s_cmp_ge_u32 s29, 224
    s_cbranch_scc1 l_tred
    v_mov_b32 v28, s76
    v_mul_f32 v29, s75, v28
    v_lshlrev_b32 v30, 16, v24
    v_and_b32 v31, 0xffff0000, v24
    v_fma_f32 v30, v30, v28, -v29
    v_fma_f32 v31, v31, v28, -v29
    v_cvt_pk_bf16_f32 v24, v30, v31
    v_lshlrev_b32 v30, 16, v25
    v_and_b32 v31, 0xffff0000, v25
    v_fma_f32 v30, v30, v28, -v29
    v_fma_f32 v31, v31, v28, -v29
    v_cvt_pk_bf16_f32 v25, v30, v31
    v_lshlrev_b32 v30, 16, v26
    v_and_b32 v31, 0xffff0000, v26
    v_fma_f32 v30, v30, v28, -v29
    v_fma_f32 v31, v31, v28, -v29
    v_cvt_pk_bf16_f32 v26, v30, v31
    v_lshlrev_b32 v30, 16, v27
    v_and_b32 v31, 0xffff0000, v27
    v_fma_f32 v30, v30, v28, -v29
    v_fma_f32 v31, v31, v28, -v29
    v_cvt_pk_bf16_f32 v27, v30, v31
    s_bitcmp0_b32 s29, 0
    s_cbranch_scc1 sk_143
    v_swap_b32 v24, v25
    v_swap_b32 v26, v27
sk_143:
    s_bitcmp0_b32 s29, 1
    s_cbranch_scc1 sk_144
    v_swap_b32 v24, v26
    v_swap_b32 v25, v27
sk_144:
    v_dot2_f32_bf16 v32, v155, v24, 0
    v_dot2_f32_bf16 v33, v160, v24, 0
    v_dot2_f32_bf16 v34, v156, v24, 0
    v_dot2_f32_bf16 v35, v161, v24, 0
    v_dot2_f32_bf16 v36, v157, v24, 0
    v_dot2_f32_bf16 v37, v162, v24, 0
    v_dot2_f32_bf16 v38, v158, v24, 0
    v_dot2_f32_bf16 v39, v163, v24, 0
    v_dot2_f32_bf16 v40, v183, v24, 0
    v_dot2_f32_bf16 v41, v192, v24, 0
    v_dot2_f32_bf16 v42, v188, v24, 0
    v_dot2_f32_bf16 v43, v193, v24, 0
    v_dot2_f32_bf16 v44, v189, v24, 0
    v_dot2_f32_bf16 v45, v194, v24, 0
    v_dot2_f32_bf16 v46, v190, v24, 0
    v_dot2_f32_bf16 v47, v195, v24, 0
    v_dot2_f32_bf16 v32, v159, v25, v32
    v_dot2_f32_bf16 v33, v168, v25, v33
    v_dot2_f32_bf16 v34, v164, v25, v34
    v_dot2_f32_bf16 v35, v169, v25, v35
    v_dot2_f32_bf16 v36, v165, v25, v36
    v_dot2_f32_bf16 v37, v170, v25, v37
    v_dot2_f32_bf16 v38, v166, v25, v38
    v_dot2_f32_bf16 v39, v171, v25, v39
    v_dot2_f32_bf16 v40, v191, v25, v40
    v_dot2_f32_bf16 v41, v200, v25, v41
    v_dot2_f32_bf16 v42, v196, v25, v42
    v_dot2_f32_bf16 v43, v201, v25, v43
    v_dot2_f32_bf16 v44, v197, v25, v44
    v_dot2_f32_bf16 v45, v202, v25, v45
    v_dot2_f32_bf16 v46, v198, v25, v46
    v_dot2_f32_bf16 v47, v203, v25, v47
    v_dot2_f32_bf16 v32, v167, v26, v32
    v_dot2_f32_bf16 v33, v176, v26, v33
    v_dot2_f32_bf16 v34, v172, v26, v34
    v_dot2_f32_bf16 v35, v177, v26, v35
    v_dot2_f32_bf16 v36, v173, v26, v36
    v_dot2_f32_bf16 v37, v178, v26, v37
    v_dot2_f32_bf16 v38, v174, v26, v38
    v_dot2_f32_bf16 v39, v179, v26, v39
    v_dot2_f32_bf16 v40, v199, v26, v40
    v_dot2_f32_bf16 v41, v208, v26, v41
    v_dot2_f32_bf16 v42, v204, v26, v42
    v_dot2_f32_bf16 v43, v209, v26, v43
    v_dot2_f32_bf16 v44, v205, v26, v44
    v_dot2_f32_bf16 v45, v210, v26, v45
    v_dot2_f32_bf16 v46, v206, v26, v46
    v_dot2_f32_bf16 v47, v211, v26, v47
    v_dot2_f32_bf16 v32, v175, v27, v32
    v_dot2_f32_bf16 v33, v184, v27, v33
    v_dot2_f32_bf16 v34, v180, v27, v34
    v_dot2_f32_bf16 v35, v185, v27, v35
    v_dot2_f32_bf16 v36, v181, v27, v36
    v_dot2_f32_bf16 v37, v186, v27, v37
    v_dot2_f32_bf16 v38, v182, v27, v38
    v_dot2_f32_bf16 v39, v187, v27, v39
    v_dot2_f32_bf16 v40, v207, v27, v40
    v_dot2_f32_bf16 v41, v216, v27, v41
    v_dot2_f32_bf16 v42, v212, v27, v42
    v_dot2_f32_bf16 v43, v217, v27, v43
    v_dot2_f32_bf16 v44, v213, v27, v44
    v_dot2_f32_bf16 v45, v218, v27, v45
    v_dot2_f32_bf16 v46, v214, v27, v46
    v_dot2_f32_bf16 v47, v219, v27, v47
    v_lshrrev_b32 v31, 5, v252
    v_lshlrev_b32 v30, 6, v31
    v_permlane32_swap_b32 v32, v40
    v_permlane32_swap_b32 v33, v41
    v_permlane32_swap_b32 v34, v42
    v_permlane32_swap_b32 v35, v43
    v_permlane32_swap_b32 v36, v44
    v_permlane32_swap_b32 v37, v45
    v_permlane32_swap_b32 v38, v46
    v_permlane32_swap_b32 v39, v47
    v_add_f32 v32, v32, v40
    v_add_f32 v33, v33, v41
    v_add_f32 v34, v34, v42
    v_add_f32 v35, v35, v43
    v_add_f32 v36, v36, v44
    v_add_f32 v37, v37, v45
    v_add_f32 v38, v38, v46
    v_add_f32 v39, v39, v47
    v_and_b32 v31, 1, v252
    v_lshl_add_u32 v30, v31, 5, v30
    v_permlane16_swap_b32 v32, v36
    v_permlane16_swap_b32 v33, v37
    v_permlane16_swap_b32 v34, v38
    v_permlane16_swap_b32 v35, v39
    v_add_f32 v32, v32, v36
    v_add_f32 v33, v33, v37
    v_add_f32 v34, v34, v38
    v_add_f32 v35, v35, v39
    v_and_b32 v31, 16, v252
    s_lshl_b32 s32, s28, 7
    v_add3_u32 v30, v31, v30, s32
    v_add_f32_dpp v32, v32, v32 quad_perm:[2,3,0,1] row_mask:0xf bank_mask:0xf
    v_add_f32_dpp v33, v33, v33 quad_perm:[2,3,0,1] row_mask:0xf bank_mask:0xf
    v_add_f32_dpp v34, v34, v34 quad_perm:[2,3,0,1] row_mask:0xf bank_mask:0xf
    v_add_f32_dpp v35, v35, v35 quad_perm:[2,3,0,1] row_mask:0xf bank_mask:0xf
    v_add_f32_dpp v32, v32, v32 row_ror:4 row_mask:0xf bank_mask:0xf
    v_add_f32_dpp v33, v33, v33 row_ror:4 row_mask:0xf bank_mask:0xf
    v_add_f32_dpp v34, v34, v34 row_ror:4 row_mask:0xf bank_mask:0xf
    v_add_f32_dpp v35, v35, v35 row_ror:4 row_mask:0xf bank_mask:0xf
    v_add_f32_dpp v32, v32, v32 row_ror:8 row_mask:0xf bank_mask:0xf
    v_add_f32_dpp v33, v33, v33 row_ror:8 row_mask:0xf bank_mask:0xf
    v_add_f32_dpp v34, v34, v34 row_ror:8 row_mask:0xf bank_mask:0xf
    v_add_f32_dpp v35, v35, v35 row_ror:8 row_mask:0xf bank_mask:0xf
    s_mov_b32 exec_lo, 0x00030003
    s_mov_b32 exec_hi, 0x00030003
    ds_write_b128 v30, v[32:35] offset:3328
    s_mov_b64 exec, -1
    s_waitcnt lgkmcnt(0)
    s_barrier
    v_and_b32 v30, 1, v252
    v_bfe_u32 v31, v252, 1, 3
    v_lshl_add_u32 v30, v30, 3, v31
    v_lshlrev_b32 v30, 2, v30
    v_add_u32 v30, 3328, v30
    ds_read2_b32 v[32:33], v30 offset0:0 offset1:16
    ds_read2_b32 v[34:35], v30 offset0:32 offset1:48
    ds_read2_b32 v[36:37], v30 offset0:64 offset1:80
    ds_read2_b32 v[38:39], v30 offset0:96 offset1:112
    v_lshrrev_b32 v30, 2, v252
    v_mul_u32_u24 v30, 14336, v30
    v_and_b32 v31, 3, v252
    v_lshl_add_u32 v30, v31, 4, v30
    v_and_b32 v31, 1, v252
    v_cmp_eq_u32 vcc, 1, v31
    s_mul_i32 s32, s28, 229376
    s_lshl_b32 s33, s29, 6
    s_add_u32 s32, s32, s33
    s_add_u32 s32, s32, s79
    s_add_u32 s32, s32, 0xc80000
    s_waitcnt lgkmcnt(0)
    v_pk_add_f32 v[32:33], v[32:33], v[34:35]
    v_pk_add_f32 v[36:37], v[36:37], v[38:39]
    v_pk_add_f32 v[32:33], v[32:33], v[36:37]
    v_mul_f32 v34, 0xbfb8aa3b, v32
    v_exp_f32 v34, v34
    v_mul_f32 v32, v32, v33
    v_add_f32 v34, 1.0, v34
    v_rcp_f32 v34, v34
    s_nop 0
    v_mul_f32 v32, v32, v34
    s_nop 1
    v_mov_b32_dpp v33, v32 quad_perm:[2,3,2,3] row_mask:0xf bank_mask:0xf
    v_cvt_pk_bf16_f32 v32, v32, v33
    ds_swizzle_b32 v36, v32 offset:0x1
    ds_swizzle_b32 v37, v32 offset:0x81
    ds_swizzle_b32 v38, v32 offset:0x101
    ds_swizzle_b32 v39, v32 offset:0x181
    s_waitcnt lgkmcnt(0)
    v_dot2_f32_bf16 v40, v215, v36, 0
    v_dot2_f32_bf16 v41, v224, v36, 0
    v_dot2_f32_bf16 v42, v220, v36, 0
    v_dot2_f32_bf16 v43, v225, v36, 0
    v_dot2_f32_bf16 v44, v221, v36, 0
    v_dot2_f32_bf16 v45, v226, v36, 0
    v_dot2_f32_bf16 v46, v222, v36, 0
    v_dot2_f32_bf16 v47, v227, v36, 0
    v_dot2_f32_bf16 v40, v223, v37, v40
    v_dot2_f32_bf16 v41, v232, v37, v41
    v_dot2_f32_bf16 v42, v228, v37, v42
    v_dot2_f32_bf16 v43, v233, v37, v43
    v_dot2_f32_bf16 v44, v229, v37, v44
    v_dot2_f32_bf16 v45, v234, v37, v45
    v_dot2_f32_bf16 v46, v230, v37, v46
    v_dot2_f32_bf16 v47, v235, v37, v47
    v_dot2_f32_bf16 v40, v231, v38, v40
    v_dot2_f32_bf16 v41, v240, v38, v41
    v_dot2_f32_bf16 v42, v236, v38, v42
    v_dot2_f32_bf16 v43, v241, v38, v43
    v_dot2_f32_bf16 v44, v237, v38, v44
    v_dot2_f32_bf16 v45, v242, v38, v45
    v_dot2_f32_bf16 v46, v238, v38, v46
    v_dot2_f32_bf16 v47, v243, v38, v47
    v_dot2_f32_bf16 v40, v239, v39, v40
    v_dot2_f32_bf16 v41, v248, v39, v41
    v_dot2_f32_bf16 v42, v244, v39, v42
    v_dot2_f32_bf16 v43, v249, v39, v43
    v_dot2_f32_bf16 v44, v245, v39, v44
    v_dot2_f32_bf16 v45, v250, v39, v45
    v_dot2_f32_bf16 v46, v246, v39, v46
    v_dot2_f32_bf16 v47, v251, v39, v47
    v_add_f32_dpp v40, v40, v40 quad_perm:[1,0,3,2] row_mask:0xf bank_mask:0xf
    v_add_f32_dpp v41, v41, v41 quad_perm:[1,0,3,2] row_mask:0xf bank_mask:0xf
    v_add_f32_dpp v42, v42, v42 quad_perm:[1,0,3,2] row_mask:0xf bank_mask:0xf
    v_add_f32_dpp v43, v43, v43 quad_perm:[1,0,3,2] row_mask:0xf bank_mask:0xf
    v_add_f32_dpp v44, v44, v44 quad_perm:[1,0,3,2] row_mask:0xf bank_mask:0xf
    v_add_f32_dpp v45, v45, v45 quad_perm:[1,0,3,2] row_mask:0xf bank_mask:0xf
    v_add_f32_dpp v46, v46, v46 quad_perm:[1,0,3,2] row_mask:0xf bank_mask:0xf
    v_add_f32_dpp v47, v47, v47 quad_perm:[1,0,3,2] row_mask:0xf bank_mask:0xf
    v_cndmask_b32 v40, v40, v44, vcc
    v_cndmask_b32 v41, v41, v45, vcc
    v_cndmask_b32 v42, v42, v46, vcc
    v_cndmask_b32 v43, v43, v47, vcc
    s_cmp_lt_u32 s29, 224
    s_cselect_b64 exec, -1, 0
    buffer_store_dwordx4 v[40:43], v30, s[20:23], s32 offen sc1
    s_mov_b64 exec, -1
    s_branch k_end
l_tred:
    s_cmp_ge_u32 s28, 2
    s_cbranch_scc1 k_end
    v_and_b32 v30, 2, v252
    v_cmp_eq_u32 vcc, 2, v30
    v_mov_b32 v28, s76
    v_mul_f32 v29, s75, v28
    v_add_f32 v28, 1.0, v28
    v_cndmask_b32 v30, v24, v26, vcc
    v_cndmask_b32 v31, v25, v27, vcc
    v_lshlrev_b32 v92, 16, v30
    v_and_b32 v93, 0xffff0000, v30
    v_lshlrev_b32 v94, 16, v31
    v_and_b32 v95, 0xffff0000, v31
    v_fma_f32 v92, v92, v28, -v29
    v_fma_f32 v93, v93, v28, -v29
    v_fma_f32 v94, v94, v28, -v29
    v_fma_f32 v95, v95, v28, -v29
    v_mov_b32 v96, 0xbfb8aa3b
    v_mul_f32 v96, s74, v96
    v_exp_f32 v96, v96
    s_nop 0
    v_add_f32 v96, 1.0, v96
    v_rcp_f32 v96, v96
    s_mov_b32 s78, s27
pl_146:
    s_mul_i32 s32, s89, 14336
    s_add_u32 s32, s32, s79
    s_add_u32 s32, s32, 0xc80000
    buffer_load_dwordx4 v[32:35], v253, s[20:23], s32 offen offset:0 sc1
    buffer_load_dwordx4 v[36:39], v253, s[20:23], s32 offen offset:1024 sc1
    buffer_load_dwordx4 v[40:43], v253, s[20:23], s32 offen offset:2048 sc1
    buffer_load_dwordx4 v[44:47], v253, s[20:23], s32 offen offset:3072 sc1
    s_add_u32 s32, s32, 4096
    buffer_load_dwordx4 v[48:51], v253, s[20:23], s32 offen offset:0 sc1
    buffer_load_dwordx4 v[52:55], v253, s[20:23], s32 offen offset:1024 sc1
    buffer_load_dwordx4 v[56:59], v253, s[20:23], s32 offen offset:2048 sc1
    buffer_load_dwordx4 v[60:63], v253, s[20:23], s32 offen offset:3072 sc1
    s_add_u32 s32, s32, 4096
    buffer_load_dwordx4 v[64:67], v253, s[20:23], s32 offen offset:0 sc1
    buffer_load_dwordx4 v[68:71], v253, s[20:23], s32 offen offset:1024 sc1
    buffer_load_dwordx4 v[72:75], v253, s[20:23], s32 offen offset:2048 sc1
    buffer_load_dwordx4 v[76:79], v253, s[20:23], s32 offen offset:3072 sc1
    s_add_u32 s32, s32, 4096
    buffer_load_dwordx4 v[80:83], v253, s[20:23], s32 offen offset:0 sc1
    buffer_load_dwordx4 v[84:87], v253, s[20:23], s32 offen offset:1024 sc1
    s_waitcnt vmcnt(0)
pc_147:
    v_max3_u32 v30, v32, v36, v40
    v_max3_u32 v30, v30, v44, v48
    v_max3_u32 v30, v30, v52, v56
    v_max3_u32 v30, v30, v60, v64
    v_max3_u32 v30, v30, v68, v72
    v_max3_u32 v30, v30, v76, v80
    v_max_u32 v30, v30, v84
    v_cmp_eq_u32 vcc, -1, v30
    s_cbranch_vccz pd_148
    s_sub_u32 s78, s78, 1
    s_cmp_lg_u32 s78, 0
    s_cbranch_scc1 pl_146
    s_mov_b32 s27, 1
pd_148:
    v_pk_add_f32 v[32:33], v[32:33], v[36:37]
    v_pk_add_f32 v[34:35], v[34:35], v[38:39]
    v_pk_add_f32 v[32:33], v[32:33], v[40:41]
    v_pk_add_f32 v[34:35], v[34:35], v[42:43]
    v_pk_add_f32 v[32:33], v[32:33], v[44:45]
    v_pk_add_f32 v[34:35], v[34:35], v[46:47]
    v_pk_add_f32 v[32:33], v[32:33], v[48:49]
    v_pk_add_f32 v[34:35], v[34:35], v[50:51]
    v_pk_add_f32 v[32:33], v[32:33], v[52:53]
    v_pk_add_f32 v[34:35], v[34:35], v[54:55]
    v_pk_add_f32 v[32:33], v[32:33], v[56:57]
    v_pk_add_f32 v[34:35], v[34:35], v[58:59]
    v_pk_add_f32 v[32:33], v[32:33], v[60:61]
    v_pk_add_f32 v[34:35], v[34:35], v[62:63]
    v_pk_add_f32 v[32:33], v[32:33], v[64:65]
    v_pk_add_f32 v[34:35], v[34:35], v[66:67]
    v_pk_add_f32 v[32:33], v[32:33], v[68:69]
    v_pk_add_f32 v[34:35], v[34:35], v[70:71]
    v_pk_add_f32 v[32:33], v[32:33], v[72:73]
    v_pk_add_f32 v[34:35], v[34:35], v[74:75]
    v_pk_add_f32 v[32:33], v[32:33], v[76:77]
    v_pk_add_f32 v[34:35], v[34:35], v[78:79]
    v_pk_add_f32 v[32:33], v[32:33], v[80:81]
    v_pk_add_f32 v[34:35], v[34:35], v[82:83]
    v_pk_add_f32 v[32:33], v[32:33], v[84:85]
    v_pk_add_f32 v[34:35], v[34:35], v[86:87]
    s_nop 0
    v_add_f32_dpp v32, v32, v32 row_ror:4 row_mask:0xf bank_mask:0xf
    v_add_f32_dpp v33, v33, v33 row_ror:4 row_mask:0xf bank_mask:0xf
    v_add_f32_dpp v34, v34, v34 row_ror:4 row_mask:0xf bank_mask:0xf
    v_add_f32_dpp v35, v35, v35 row_ror:4 row_mask:0xf bank_mask:0xf
    v_add_f32_dpp v32, v32, v32 row_ror:8 row_mask:0xf bank_mask:0xf
    v_add_f32_dpp v33, v33, v33 row_ror:8 row_mask:0xf bank_mask:0xf
    v_add_f32_dpp v34, v34, v34 row_ror:8 row_mask:0xf bank_mask:0xf
    v_add_f32_dpp v35, v35, v35 row_ror:8 row_mask:0xf bank_mask:0xf
    v_mov_b32 v36, v32
    v_mov_b32 v37, v33
    v_mov_b32 v38, v34
    v_mov_b32 v39, v35
    v_permlane16_swap_b32 v32, v36
    v_permlane16_swap_b32 v33, v37
    v_permlane16_swap_b32 v34, v38
    v_permlane16_swap_b32 v35, v39
    v_add_f32 v32, v32, v36
    v_add_f32 v33, v33, v37
    v_add_f32 v34, v34, v38
    v_add_f32 v35, v35, v39
    v_mov_b32 v36, v32
    v_mov_b32 v37, v33
    v_mov_b32 v38, v34
    v_mov_b32 v39, v35
    v_permlane32_swap_b32 v32, v36
    v_permlane32_swap_b32 v33, v37
    v_permlane32_swap_b32 v34, v38
    v_permlane32_swap_b32 v35, v39
    v_add_f32 v32, v32, v36
    v_add_f32 v33, v33, v37
    v_add_f32 v34, v34, v38
    v_add_f32 v35, v35, v39
    v_fma_f32 v32, v32, v96, v92
    v_fma_f32 v33, v33, v96, v93
    v_fma_f32 v34, v34, v96, v94
    v_fma_f32 v35, v35, v96, v95
    v_cvt_pk_bf16_f32 v32, v32, v33
    v_cvt_pk_bf16_f32 v33, v34, v35
    s_lshl_b32 s32, s73, 11
    s_lshl_b32 s33, s89, 5
    s_add_u32 s32, s32, s33
    v_lshlrev_b32 v30, 3, v252
    s_mov_b64 exec, 15
    buffer_store_dwordx2 v[32:33], v30, s[12:15], s32 offen sc1
    s_mov_b64 exec, -1
k_end:
k_exit:
    s_endpgm
.section .rodata,"a"
.p2align 6
.amdhsa_kernel interleave_layers__sliding_block__moe_arch_mod__prompt_kernel
  .amdhsa_next_free_vgpr 256
  .amdhsa_next_free_sgpr 102
  .amdhsa_accum_offset 256
  .amdhsa_group_segment_fixed_size 0
  .amdhsa_kernarg_size 88
  .amdhsa_user_sgpr_count 2
  .amdhsa_user_sgpr_kernarg_segment_ptr 1
  .amdhsa_system_sgpr_workgroup_id_x 1
.end_amdhsa_kernel
```

```asm
; @launch grid=(256,1,1) block=(512,1,1) lds=163840
.amdgcn_target "amdgcn-amd-amdhsa--gfx950"
.text
.globl interleave_layers__sliding_block__moe_arch_mod__prompt_kernel
.p2align 8
.type interleave_layers__sliding_block__moe_arch_mod__prompt_kernel,@function
interleave_layers__sliding_block__moe_arch_mod__prompt_kernel:
    s_cmp_ge_u32 s2, 256
    s_cbranch_scc1 k_exit
    s_load_dwordx4 s[4:7], s[0:1], 0
    s_load_dwordx2 s[8:9], s[0:1], 16
    s_load_dwordx2 s[20:21], s[0:1], 80
    s_load_dwordx2 s[80:81], s[0:1], 32
    v_lshrrev_b32 v1, 6, v0
    v_and_b32 v252, 63, v0
    v_readfirstlane_b32 s3, v1
    v_lshlrev_b32 v253, 4, v252
    s_and_b32 s30, s2, 7
    s_lshr_b32 s31, s2, 3
    s_and_b32 s32, s31, 1
    s_lshl_b32 s33, s30, 1
    s_add_u32 s24, s33, s32
    s_lshr_b32 s25, s31, 1
    s_add_u32 s33, s33, s25
    s_add_u32 s94, s33, s32
    s_sub_u32 s95, s33, s32
    s_add_u32 s98, s95, 15
    s_and_b32 s98, s98, 15
    s_mul_i32 s29, s30, 28
    s_lshl_b32 s32, s30, 2
    s_add_u32 s32, s32, 196
    s_cmp_lt_u32 s31, 28
    s_cselect_b32 s29, s29, s32
    s_add_u32 s29, s29, s31
    s_lshl_b32 s72, s24, 4
    s_add_u32 s72, s72, s25
    s_mov_b32 s26, 0
    s_mov_b32 s27, 20000
    s_and_b32 s28, s3, 3
    s_lshl_b32 s99, s24, 2
    s_add_u32 s99, s99, s28
    s_lshl_b32 s101, s28, 10
    s_mov_b32 s18, 0x600000
    s_mov_b32 s19, 0x20000
    s_mov_b32 s10, 0x200000
    s_mov_b32 s11, 0x20000
    s_mov_b32 s22, 0x8000000
    s_mov_b32 s23, 0x20000
    s_mov_b32 s82, 0x800
    s_mov_b32 s83, 0x20000
    s_cmp_ge_u32 s3, 4
    s_cbranch_scc1 l_start
    s_getpc_b64 s[32:33]
pc_1:
    s_sub_u32 s32, s32, pc_1-interleave_layers__sliding_block__moe_arch_mod__prompt_kernel
    s_subb_u32 s33, s33, 0
    s_lshr_b32 s34, s2, 3
    s_lshl_b32 s34, s34, 2
    s_add_u32 s34, s34, s28
    s_and_b32 s34, s34, 63
    s_lshl_b32 s34, s34, 7
    v_lshl_add_u32 v191, v252, 13, s34
    s_mov_b32 s34, k_exit-interleave_layers__sliding_block__moe_arch_mod__prompt_kernel
    s_mov_b32 s35, 0x20000
    buffer_load_dword v191, v191, s[32:35], 0 offen
    s_load_dwordx4 s[36:39], s[0:1], 40
    s_load_dwordx2 s[74:75], s[0:1], 56
    s_waitcnt lgkmcnt(0)
    s_mov_b32 s88, 0xdd8000
    s_load_dword s88, s[20:21], s88
    s_mov_b64 s[16:17], s[6:7]
    s_mov_b32 s6, 0x400000
    s_mov_b32 s7, 0x20000
    s_lshr_b32 s30, s2, 3
    s_lshl_b32 s30, s30, 2
    s_add_u32 s30, s30, s3
    s_and_b32 s31, s2, 7
    v_mul_u32_u24 v4, 9363, v252
    v_lshrrev_b32 v4, 16, v4
    v_mul_u32_u24 v5, 7, v4
    v_sub_u32 v5, v252, v5
    v_min_u32 v4, 7, v4
    v_lshl_add_u32 v4, v4, 7, s30
    v_mul_u32_u24 v6, 37, v5
    v_lshrrev_b32 v6, 8, v6
    v_mul_u32_u24 v7, 7, v6
    v_sub_u32 v5, v5, v7
    v_add_u32 v6, 0, v6
    v_cmp_eq_u32 vcc, 2, v6
    v_mov_b32 v7, 7168
    v_mov_b32 v8, 896
    v_cndmask_b32 v7, v7, v8, vcc
    v_mul_u32_u24 v4, v4, v7
    v_mul_u32_u24 v198, 1024, v7
    v_lshl_add_u32 v4, v5, 7, v4
    v_mov_b32 v7, 917504
    v_cndmask_b32 v7, v8, v7, vcc
    v_mad_u32_u24 v4, v7, s31, v4
    v_mov_b32 v196, s36
    v_mov_b32 v7, s74
    v_cndmask_b32 v196, v196, v7, vcc
    v_mov_b32 v197, s37
    v_mov_b32 v7, s75
    v_cndmask_b32 v197, v197, v7, vcc
    v_cmp_eq_u32 vcc, 1, v6
    v_mov_b32 v7, s38
    s_nop 0
    v_cndmask_b32 v196, v196, v7, vcc
    v_mov_b32 v7, s39
    v_cndmask_b32 v197, v197, v7, vcc
    v_add_co_u32 v196, vcc, v196, v4
    s_nop 1
    v_addc_co_u32 v197, vcc, 0, v197, vcc
    s_mov_b32 s30, 0x1000100
    s_mov_b32 s31, 0x1000100
    s_lshl_b32 s86, s3, 4
    s_lshr_b64 s[30:31], s[30:31], s86
    s_and_b32 s86, s30, 0xffff
    s_mul_i32 s30, s25, 6
    s_lshr_b32 s30, s30, 4
    s_lshr_b32 s86, s86, s30
    s_load_dwordx2 s[12:13], s[0:1], 64
    s_mov_b32 s14, 0x400000
    s_mov_b32 s15, 0x20000
    s_lshr_b32 s30, s16, 7
    s_sub_u32 s30, 3, s30
    s_and_b32 s30, s30, 7
    s_and_b32 s31, s24, 1
    s_lshl_b32 s31, s31, 3
    s_add_u32 s30, s30, s31
    s_and_b32 s31, s24, 14
    s_add_u32 s84, s31, s30
    s_lshl_b32 s31, s25, 2
    s_add_u32 s31, s31, s28
    s_mul_i32 s31, s31, 6144
    s_lshl_b32 s30, s30, 7
    s_add_u32 s30, s30, s31
    v_min_u32 v190, 2, v252
    v_lshl_add_u32 v190, v190, 11, s30
    s_add_u32 s30, s84, 0
    s_and_b32 s30, s30, 15
    s_mul_i32 s30, s30, 393216
    buffer_load_dword v191, v190, s[16:19], s30 offen
    s_add_u32 s30, s84, 1
    s_and_b32 s30, s30, 15
    s_mul_i32 s30, s30, 393216
    buffer_load_dword v191, v190, s[16:19], s30 offen
    v_lshrrev_b32 v5, 5, v252
    v_lshlrev_b32 v6, 3, v5
    s_lshl_b32 s33, s98, 7
    buffer_load_dwordx2 v[224:225], v6, s[80:83], s33 offen offset:0
    buffer_load_dwordx2 v[226:227], v6, s[80:83], s33 offen offset:16
    buffer_load_dwordx2 v[228:229], v6, s[80:83], s33 offen offset:32
    buffer_load_dwordx2 v[230:231], v6, s[80:83], s33 offen offset:48
    buffer_load_dwordx2 v[232:233], v6, s[80:83], s33 offen offset:64
    buffer_load_dwordx2 v[234:235], v6, s[80:83], s33 offen offset:80
    buffer_load_dwordx2 v[236:237], v6, s[80:83], s33 offen offset:96
    buffer_load_dwordx2 v[238:239], v6, s[80:83], s33 offen offset:112
    s_mov_b32 s40, 0xffffffff
    s_mov_b32 s41, 0xfffffff0
    s_mov_b32 s42, 0xfffffffe
    s_mov_b32 s43, 0xffffffe0
    s_mov_b32 s44, 0xfffffffc
    s_mov_b32 s45, 0xffffffc0
    s_mov_b32 s46, 0xfffffff8
    s_mov_b32 s47, 0xffffff80
    s_mov_b32 s48, 0xffff0000
    s_mov_b32 s49, 0xfff00000
    s_mov_b32 s50, 0xfffe0000
    s_mov_b32 s51, 0xffe00000
    s_mov_b32 s52, 0xfffc0000
    s_mov_b32 s53, 0xffc00000
    s_mov_b32 s54, 0xfff80000
    s_mov_b32 s55, 0xff800000
    s_mov_b32 s56, 0xffffff00
    s_mov_b32 s57, 0xfffff000
    s_mov_b32 s58, 0xfffffe00
    s_mov_b32 s59, 0xffffe000
    s_mov_b32 s60, 0xfffffc00
    s_mov_b32 s61, 0xffffc000
    s_mov_b32 s62, 0xfffff800
    s_mov_b32 s63, 0xffff8000
    s_mov_b32 s64, 0xff000000
    s_mov_b32 s65, 0xf0000000
    s_mov_b32 s66, 0xfe000000
    s_mov_b32 s67, 0xe0000000
    s_mov_b32 s68, 0xfc000000
    s_mov_b32 s69, 0xc0000000
    s_mov_b32 s70, 0xf8000000
    s_mov_b32 s71, 0x80000000
    v_bfe_u32 v20, v252, 3, 2
    v_lshrrev_b32 v21, 5, v252
    v_lshl_add_u32 v20, v21, 3, v20
    s_lshr_b32 s32, s28, 1
    s_lshl_b32 s32, s32, 4
    s_and_b32 s33, s28, 1
    s_lshl_b32 s33, s33, 2
    s_add_u32 s32, s32, s33
    v_add_u32 v20, s32, v20
    v_lshlrev_b32 v20, 11, v20
    v_lshrrev_b32 v21, 2, v252
    v_and_b32 v21, 4, v21
    v_xor_b32 v21, v21, v252
    v_and_b32 v21, 7, v21
    v_lshl_add_u32 v20, v21, 4, v20
    s_lshl_b32 s32, s98, 7
    v_add_u32 v243, s32, v20
    s_and_b32 s34, s3, 1
    s_lshr_b32 s35, s3, 1
    v_and_b32 v4, 15, v252
    v_lshrrev_b32 v7, 4, v252
    v_lshrrev_b32 v6, 1, v4
    v_xor_b32 v6, v6, v7
    v_lshlrev_b32 v6, 4, v6
    v_lshl_add_u32 v6, v4, 7, v6
    s_lshl_b32 s30, s34, 13
    v_add_u32 v176, s30, v6
    v_xor_b32 v177, 64, v176
    s_lshl_b32 s30, s35, 1
    v_lshrrev_b32 v20, 2, v252
    v_bfe_u32 v21, v20, 1, 2
    v_xor_b32 v21, s30, v21
    v_lshlrev_b32 v20, 7, v20
    v_lshl_add_u32 v20, v21, 5, v20
    v_and_b32 v21, 3, v252
    v_lshl_add_u32 v20, v21, 3, v20
    v_add_u32 v178, 40960, v20
    v_xor_b32 v179, 32, v178
    v_and_b32 v8, 31, v252
    v_bfe_u32 v6, v8, 1, 3
    v_xor_b32 v6, v6, v5
    v_lshlrev_b32 v6, 4, v6
    v_lshl_add_u32 v6, v8, 7, v6
    s_lshl_b32 s30, s3, 12
    s_add_u32 s30, s30, 147456
    v_add_u32 v192, s30, v6
    v_xor_b32 v193, 32, v192
    v_xor_b32 v194, 64, v192
    v_xor_b32 v195, 96, v192
    s_lshl_b32 s30, s34, 8
    v_lshl_add_u32 v184, v4, 2, s30
    v_lshl_add_u32 v185, v7, 4, s30
    s_lshl_b32 s30, s35, 7
    v_lshl_add_u32 v186, v7, 4, s30
    s_add_u32 s30, s30, 1536
    v_lshl_add_u32 v187, v4, 2, s30
    s_lshl_b32 s30, s3, 7
    s_add_u32 s30, s30, 2048
    v_lshl_add_u32 v188, v8, 2, s30
    v_mov_b32 v189, 0
    v_lshlrev_b32 v6, 9, v7
    v_lshl_add_u32 v245, v4, 4, v6
    v_and_b32 v9, 8, v4
    v_lshl_add_u32 v244, v9, 4, v245
    s_mul_i32 s30, s35, 49152
    s_lshl_b32 s31, s34, 13
    s_add_u32 s30, s30, s31
    s_add_u32 s30, s30, 98304
    v_add_u32 v246, s30, v244
    v_add_u32 v247, s30, v245
    s_lshl_b32 s30, s3, 12
    s_add_u32 s30, s30, 49152
    v_add_u32 v248, s30, v245
    s_getreg_b32 s30, hwreg(HW_REG_XCC_ID, 0, 4)
    v_mov_b32 v251, s30
    s_lshl_b32 s30, s25, 4
    s_add_u32 s30, s30, s24
    s_sub_u32 s30, s30, s72
    s_add_u32 s30, s30, 512
    v_mul_u32_u24 v249, s30, v252
    v_add_u32 v249, s72, v249
    v_lshlrev_b32 v249, 3, v249
    s_cmp_eq_u32 s3, 0
    s_cselect_b32 s89, 10, -1
    v_mov_b32 v242, 0
    v_mov_b32 v0, 0
    v_mov_b32 v1, 0
    v_mov_b32 v2, 0
    v_mov_b32 v3, 0
    v_mov_b32 v4, 0
    v_mov_b32 v5, 0
    v_mov_b32 v6, 0
    v_mov_b32 v7, 0
    v_mov_b32 v8, 0
    v_mov_b32 v9, 0
    v_mov_b32 v10, 0
    v_mov_b32 v11, 0
    v_mov_b32 v12, 0
    v_mov_b32 v13, 0
    v_mov_b32 v14, 0
    v_mov_b32 v15, 0
    v_mov_b32 v16, 0
    v_mov_b32 v17, 0
    v_mov_b32 v18, 0
    v_mov_b32 v19, 0
    v_mov_b32 v20, 0
    v_mov_b32 v21, 0
    v_mov_b32 v22, 0
    v_mov_b32 v23, 0
    v_mov_b32 v24, 0
    v_mov_b32 v25, 0
    v_mov_b32 v26, 0
    v_mov_b32 v27, 0
    v_mov_b32 v28, 0
    v_mov_b32 v29, 0
    v_mov_b32 v30, 0
    v_mov_b32 v31, 0
    v_mov_b32 v32, 0
    v_mov_b32 v33, 0
    v_mov_b32 v34, 0
    v_mov_b32 v35, 0
    v_mov_b32 v36, 0
    v_mov_b32 v37, 0
    v_mov_b32 v38, 0
    v_mov_b32 v39, 0
    v_mov_b32 v40, 0
    v_mov_b32 v41, 0
    v_mov_b32 v42, 0
    v_mov_b32 v43, 0
    v_mov_b32 v44, 0
    v_mov_b32 v45, 0
    v_mov_b32 v46, 0
    v_mov_b32 v47, 0
    v_mov_b32 v48, 0
    v_mov_b32 v49, 0
    v_mov_b32 v50, 0
    v_mov_b32 v51, 0
    v_mov_b32 v52, 0
    v_mov_b32 v53, 0
    v_mov_b32 v54, 0
    v_mov_b32 v55, 0
    v_mov_b32 v56, 0
    v_mov_b32 v57, 0
    v_mov_b32 v58, 0
    v_mov_b32 v59, 0
    v_mov_b32 v60, 0
    v_mov_b32 v61, 0
    v_mov_b32 v62, 0
    v_mov_b32 v63, 0
    v_mov_b32 v64, 0
    v_mov_b32 v65, 0
    v_mov_b32 v66, 0
    v_mov_b32 v67, 0
    v_mov_b32 v68, 0
    v_mov_b32 v69, 0
    v_mov_b32 v70, 0
    v_mov_b32 v71, 0
    v_mov_b32 v72, 0
    v_mov_b32 v73, 0
    v_mov_b32 v74, 0
    v_mov_b32 v75, 0
    v_mov_b32 v76, 0
    v_mov_b32 v77, 0
    v_mov_b32 v78, 0
    v_mov_b32 v79, 0
    v_mov_b32 v80, 0
    v_mov_b32 v81, 0
    v_mov_b32 v82, 0
    v_mov_b32 v83, 0
    v_mov_b32 v84, 0
    v_mov_b32 v85, 0
    v_mov_b32 v86, 0
    v_mov_b32 v87, 0
    v_mov_b32 v88, 0
    v_mov_b32 v89, 0
    v_mov_b32 v90, 0
    v_mov_b32 v91, 0
    v_mov_b32 v92, 0
    v_mov_b32 v93, 0
    v_mov_b32 v94, 0
    v_mov_b32 v95, 0
    s_waitcnt vmcnt(0) lgkmcnt(0)
    s_add_u32 s88, s88, 0x9e3779b9
    v_mov_b32 v250, s88
    v_dot2c_f32_bf16 v242, 0x3f803f80, v224
    v_dot2c_f32_bf16 v242, 0x3f803f80, v225
    v_dot2c_f32_bf16 v242, 0x3f803f80, v226
    v_dot2c_f32_bf16 v242, 0x3f803f80, v227
    v_dot2c_f32_bf16 v242, 0x3f803f80, v228
    v_dot2c_f32_bf16 v242, 0x3f803f80, v229
    v_dot2c_f32_bf16 v242, 0x3f803f80, v230
    v_dot2c_f32_bf16 v242, 0x3f803f80, v231
    v_dot2c_f32_bf16 v242, 0x3f803f80, v232
    v_dot2c_f32_bf16 v242, 0x3f803f80, v233
    v_dot2c_f32_bf16 v242, 0x3f803f80, v234
    v_dot2c_f32_bf16 v242, 0x3f803f80, v235
    v_dot2c_f32_bf16 v242, 0x3f803f80, v236
    v_dot2c_f32_bf16 v242, 0x3f803f80, v237
    v_dot2c_f32_bf16 v242, 0x3f803f80, v238
    v_dot2c_f32_bf16 v242, 0x3f803f80, v239
    s_add_u32 s30, s84, 2
    s_and_b32 s30, s30, 15
    s_mul_i32 s30, s30, 393216
    buffer_load_dword v191, v190, s[16:19], s30 offen
    s_add_u32 s30, s84, 3
    s_and_b32 s30, s30, 15
    s_mul_i32 s30, s30, 393216
    buffer_load_dword v191, v190, s[16:19], s30 offen
    s_add_u32 s30, s84, 4
    s_and_b32 s30, s30, 15
    s_mul_i32 s30, s30, 393216
    buffer_load_dword v191, v190, s[16:19], s30 offen
    s_add_u32 s30, s84, 5
    s_and_b32 s30, s30, 15
    s_mul_i32 s30, s30, 393216
    buffer_load_dword v191, v190, s[16:19], s30 offen
    s_setprio 1
e_q:
    s_mov_b32 s31, 0
    s_mov_b32 s32, 147456
    s_mov_b32 s36, 15
    v_add_u32 v180, s32, v176
    v_mov_b32 v182, v178
    v_add_u32 v181, s32, v177
    v_mov_b32 v183, v179
    s_barrier
    ds_read_b128 v[96:99], v180 offset:0
    ds_read_b64_tr_b16 v[112:113], v182 offset:0
    ds_read_b64_tr_b16 v[114:115], v182 offset:2048
    ds_read_b128 v[100:103], v180 offset:2048
    ds_read_b128 v[104:107], v180 offset:4096
    ds_read_b128 v[108:111], v180 offset:6144
    ds_read_b64_tr_b16 v[116:117], v183 offset:0
    ds_read_b64_tr_b16 v[118:119], v183 offset:2048
    ds_read_b64_tr_b16 v[120:121], v182 offset:8192
    ds_read_b64_tr_b16 v[122:123], v182 offset:10240
    ds_read_b64_tr_b16 v[124:125], v183 offset:8192
    ds_read_b64_tr_b16 v[126:127], v183 offset:10240
    ds_read_b64_tr_b16 v[128:129], v182 offset:16384
    ds_read_b64_tr_b16 v[130:131], v182 offset:18432
    ds_read_b64_tr_b16 v[132:133], v183 offset:16384
    ds_read_b64_tr_b16 v[134:135], v183 offset:18432
    s_add_u32 s85, s84, 5
e_loop:
    s_waitcnt lgkmcnt(0)
    v_mfma_f32_16x16x32_bf16 v[0:3], v[112:115], v[96:99], v[0:3]
    ds_read_b128 v[136:139], v181 offset:0
    v_mfma_f32_16x16x32_bf16 v[8:11], v[112:115], v[100:103], v[8:11]
    ds_read_b64_tr_b16 v[152:153], v182 offset:4096
    v_mfma_f32_16x16x32_bf16 v[16:19], v[112:115], v[104:107], v[16:19]
    ds_read_b64_tr_b16 v[154:155], v182 offset:6144
    v_mfma_f32_16x16x32_bf16 v[24:27], v[112:115], v[108:111], v[24:27]
    ds_read_b128 v[140:143], v181 offset:2048
    v_mfma_f32_16x16x32_bf16 v[28:31], v[116:119], v[108:111], v[28:31]
    ds_read_b128 v[144:147], v181 offset:4096
    v_mfma_f32_16x16x32_bf16 v[20:23], v[116:119], v[104:107], v[20:23]
    ds_read_b128 v[148:151], v181 offset:6144
    v_mfma_f32_16x16x32_bf16 v[12:15], v[116:119], v[100:103], v[12:15]
    ds_read_b64_tr_b16 v[156:157], v183 offset:4096
    v_mfma_f32_16x16x32_bf16 v[4:7], v[116:119], v[96:99], v[4:7]
    ds_read_b64_tr_b16 v[158:159], v183 offset:6144
    v_mfma_f32_16x16x32_bf16 v[32:35], v[120:123], v[96:99], v[32:35]
    ds_read_b64_tr_b16 v[160:161], v182 offset:12288
    v_mfma_f32_16x16x32_bf16 v[40:43], v[120:123], v[100:103], v[40:43]
    ds_read_b64_tr_b16 v[162:163], v182 offset:14336
    v_mfma_f32_16x16x32_bf16 v[48:51], v[120:123], v[104:107], v[48:51]
    ds_read_b64_tr_b16 v[164:165], v183 offset:12288
    v_mfma_f32_16x16x32_bf16 v[56:59], v[120:123], v[108:111], v[56:59]
    ds_read_b64_tr_b16 v[166:167], v183 offset:14336
    v_mfma_f32_16x16x32_bf16 v[60:63], v[124:127], v[108:111], v[60:63]
    ds_read_b64_tr_b16 v[168:169], v182 offset:20480
    v_mfma_f32_16x16x32_bf16 v[52:55], v[124:127], v[104:107], v[52:55]
    ds_read_b64_tr_b16 v[170:171], v182 offset:22528
    v_mfma_f32_16x16x32_bf16 v[44:47], v[124:127], v[100:103], v[44:47]
    ds_read_b64_tr_b16 v[172:173], v183 offset:20480
    v_mfma_f32_16x16x32_bf16 v[36:39], v[124:127], v[96:99], v[36:39]
    ds_read_b64_tr_b16 v[174:175], v183 offset:22528
    v_mfma_f32_16x16x32_bf16 v[64:67], v[96:99], v[128:131], v[64:67]
    s_cmp_eq_u32 s36, s89
    s_cbranch_scc1 e_arr
e_arr_ret:
    v_mfma_f32_16x16x32_bf16 v[68:71], v[100:103], v[128:131], v[68:71]
    s_add_u32 s31, s31, 24576
    s_sub_u32 s32, s32, 16384
    v_mfma_f32_16x16x32_bf16 v[72:75], v[104:107], v[128:131], v[72:75]
    s_cmp_ge_u32 s31, 73728
    s_cselect_b32 s31, 0, s31
    s_cselect_b32 s32, 147456, s32
    v_mfma_f32_16x16x32_bf16 v[76:79], v[108:111], v[128:131], v[76:79]
    v_add_u32 v182, s31, v178
    v_add_u32 v180, s32, v176
    v_mfma_f32_16x16x32_bf16 v[92:95], v[108:111], v[132:135], v[92:95]
    v_add_u32 v183, s31, v179
    v_add_u32 v181, s32, v177
    v_mfma_f32_16x16x32_bf16 v[88:91], v[104:107], v[132:135], v[88:91]
    s_add_u32 s85, s85, 1
    s_and_b32 s30, s85, 15
    v_mfma_f32_16x16x32_bf16 v[84:87], v[100:103], v[132:135], v[84:87]
    s_mul_i32 s30, s30, 393216
    s_cmp_ge_u32 s36, 6
    v_mfma_f32_16x16x32_bf16 v[80:83], v[96:99], v[132:135], v[80:83]
    s_waitcnt lgkmcnt(0)
    v_mfma_f32_16x16x32_bf16 v[0:3], v[152:155], v[136:139], v[0:3]
    s_barrier
    ds_read_b128 v[96:99], v180 offset:0
    v_mfma_f32_16x16x32_bf16 v[8:11], v[152:155], v[140:143], v[8:11]
    ds_read_b64_tr_b16 v[112:113], v182 offset:0
    v_mfma_f32_16x16x32_bf16 v[16:19], v[152:155], v[144:147], v[16:19]
    ds_read_b64_tr_b16 v[114:115], v182 offset:2048
    v_mfma_f32_16x16x32_bf16 v[24:27], v[152:155], v[148:151], v[24:27]
    ds_read_b128 v[100:103], v180 offset:2048
    v_mfma_f32_16x16x32_bf16 v[28:31], v[156:159], v[148:151], v[28:31]
    ds_read_b128 v[104:107], v180 offset:4096
    v_mfma_f32_16x16x32_bf16 v[20:23], v[156:159], v[144:147], v[20:23]
    ds_read_b128 v[108:111], v180 offset:6144
    v_mfma_f32_16x16x32_bf16 v[12:15], v[156:159], v[140:143], v[12:15]
    ds_read_b64_tr_b16 v[116:117], v183 offset:0
    v_mfma_f32_16x16x32_bf16 v[4:7], v[156:159], v[136:139], v[4:7]
    ds_read_b64_tr_b16 v[118:119], v183 offset:2048
    v_mfma_f32_16x16x32_bf16 v[32:35], v[160:163], v[136:139], v[32:35]
    ds_read_b64_tr_b16 v[120:121], v182 offset:8192
    v_mfma_f32_16x16x32_bf16 v[40:43], v[160:163], v[140:143], v[40:43]
    ds_read_b64_tr_b16 v[122:123], v182 offset:10240
    v_mfma_f32_16x16x32_bf16 v[48:51], v[160:163], v[144:147], v[48:51]
    ds_read_b64_tr_b16 v[124:125], v183 offset:8192
    v_mfma_f32_16x16x32_bf16 v[56:59], v[160:163], v[148:151], v[56:59]
    ds_read_b64_tr_b16 v[126:127], v183 offset:10240
    v_mfma_f32_16x16x32_bf16 v[60:63], v[164:167], v[148:151], v[60:63]
    ds_read_b64_tr_b16 v[128:129], v182 offset:16384
    v_mfma_f32_16x16x32_bf16 v[52:55], v[164:167], v[144:147], v[52:55]
    ds_read_b64_tr_b16 v[130:131], v182 offset:18432
    v_mfma_f32_16x16x32_bf16 v[44:47], v[164:167], v[140:143], v[44:47]
    ds_read_b64_tr_b16 v[132:133], v183 offset:16384
    v_mfma_f32_16x16x32_bf16 v[36:39], v[164:167], v[136:139], v[36:39]
    ds_read_b64_tr_b16 v[134:135], v183 offset:18432
    v_mfma_f32_16x16x32_bf16 v[64:67], v[136:139], v[168:171], v[64:67]
    s_cselect_b64 exec, 7, 0
    buffer_load_dword v191, v190, s[16:19], s30 offen
    s_mov_b64 exec, -1
    v_mfma_f32_16x16x32_bf16 v[68:71], v[140:143], v[168:171], v[68:71]
    s_bitcmp1_b32 s86, s36
    s_cbranch_scc1 e_fpf
e_fpf_ret:
    v_mfma_f32_16x16x32_bf16 v[72:75], v[144:147], v[168:171], v[72:75]
    s_sub_u32 s36, s36, 1
    s_cmp_eq_u32 s36, 0
    v_mfma_f32_16x16x32_bf16 v[76:79], v[148:151], v[168:171], v[76:79]
    v_mfma_f32_16x16x32_bf16 v[92:95], v[148:151], v[172:175], v[92:95]
    v_mfma_f32_16x16x32_bf16 v[88:91], v[144:147], v[172:175], v[88:91]
    v_mfma_f32_16x16x32_bf16 v[84:87], v[140:143], v[172:175], v[84:87]
    v_mfma_f32_16x16x32_bf16 v[80:83], v[136:139], v[172:175], v[80:83]
    s_cbranch_scc0 e_loop
    s_waitcnt lgkmcnt(0)
    v_mfma_f32_16x16x32_bf16 v[0:3], v[112:115], v[96:99], v[0:3]
    ds_read_b128 v[136:139], v181 offset:0
    v_mfma_f32_16x16x32_bf16 v[8:11], v[112:115], v[100:103], v[8:11]
    ds_read_b64_tr_b16 v[152:153], v182 offset:4096
    v_mfma_f32_16x16x32_bf16 v[16:19], v[112:115], v[104:107], v[16:19]
    ds_read_b64_tr_b16 v[154:155], v182 offset:6144
    v_mfma_f32_16x16x32_bf16 v[24:27], v[112:115], v[108:111], v[24:27]
    ds_read_b128 v[140:143], v181 offset:2048
    v_mfma_f32_16x16x32_bf16 v[28:31], v[116:119], v[108:111], v[28:31]
    ds_read_b128 v[144:147], v181 offset:4096
    v_mfma_f32_16x16x32_bf16 v[20:23], v[116:119], v[104:107], v[20:23]
    ds_read_b128 v[148:151], v181 offset:6144
    v_mfma_f32_16x16x32_bf16 v[12:15], v[116:119], v[100:103], v[12:15]
    ds_read_b64_tr_b16 v[156:157], v183 offset:4096
    v_mfma_f32_16x16x32_bf16 v[4:7], v[116:119], v[96:99], v[4:7]
    ds_read_b64_tr_b16 v[158:159], v183 offset:6144
    v_mfma_f32_16x16x32_bf16 v[32:35], v[120:123], v[96:99], v[32:35]
    ds_read_b64_tr_b16 v[160:161], v182 offset:12288
    v_mfma_f32_16x16x32_bf16 v[40:43], v[120:123], v[100:103], v[40:43]
    ds_read_b64_tr_b16 v[162:163], v182 offset:14336
    v_mfma_f32_16x16x32_bf16 v[48:51], v[120:123], v[104:107], v[48:51]
    ds_read_b64_tr_b16 v[164:165], v183 offset:12288
    v_mfma_f32_16x16x32_bf16 v[56:59], v[120:123], v[108:111], v[56:59]
    ds_read_b64_tr_b16 v[166:167], v183 offset:14336
    v_mfma_f32_16x16x32_bf16 v[60:63], v[124:127], v[108:111], v[60:63]
    ds_read_b64_tr_b16 v[168:169], v182 offset:20480
    v_mfma_f32_16x16x32_bf16 v[52:55], v[124:127], v[104:107], v[52:55]
    ds_read_b64_tr_b16 v[170:171], v182 offset:22528
    v_mfma_f32_16x16x32_bf16 v[44:47], v[124:127], v[100:103], v[44:47]
    ds_read_b64_tr_b16 v[172:173], v183 offset:20480
    v_mfma_f32_16x16x32_bf16 v[36:39], v[124:127], v[96:99], v[36:39]
    ds_read_b64_tr_b16 v[174:175], v183 offset:22528
    v_mfma_f32_16x16x32_bf16 v[64:67], v[96:99], v[128:131], v[64:67]
    s_cmp_lg_u32 s26, 0
    s_cbranch_scc1 e_nores
    ds_read_b128 v[208:211], v192
    ds_read_b128 v[212:215], v193
    ds_read_b128 v[216:219], v194
    ds_read_b128 v[220:223], v195
e_nores:
    v_mfma_f32_16x16x32_bf16 v[68:71], v[100:103], v[128:131], v[68:71]
    s_and_b32 s34, s3, 1
    s_lshr_b32 s35, s3, 1
    s_lshl_b32 s30, s25, 1
    v_mfma_f32_16x16x32_bf16 v[72:75], v[104:107], v[128:131], v[72:75]
    s_add_u32 s30, s30, s35
    s_lshl_b32 s30, s30, 6
    s_lshl_b32 s31, s24, 2
    v_mfma_f32_16x16x32_bf16 v[76:79], v[108:111], v[128:131], v[76:79]
    s_add_u32 s30, s30, s31
    s_lshl_b32 s31, s34, 1
    s_add_u32 s30, s30, s31
    v_mfma_f32_16x16x32_bf16 v[92:95], v[108:111], v[132:135], v[92:95]
    s_lshl_b32 s32, s30, 12
    s_add_u32 s32, s32, s26
    s_add_u32 s33, s32, 4096
    v_mfma_f32_16x16x32_bf16 v[88:91], v[104:107], v[132:135], v[88:91]
    v_mfma_f32_16x16x32_bf16 v[84:87], v[100:103], v[132:135], v[84:87]
    v_mfma_f32_16x16x32_bf16 v[80:83], v[96:99], v[132:135], v[80:83]
    s_waitcnt vmcnt(0) lgkmcnt(0)
    v_mfma_f32_16x16x32_bf16 v[32:35], v[160:163], v[136:139], v[32:35]
    s_barrier
    ds_read2_b32 v[204:205], v184 offset0:128 offset1:144
    ds_read_b128 v[128:131], v186 offset:1280
    v_mfma_f32_16x16x32_bf16 v[40:43], v[160:163], v[140:143], v[40:43]
    ds_read_b128 v[132:135], v186 offset:1344
    ds_read2_b32 v[192:193], v184 offset0:0 offset1:16
    v_mfma_f32_16x16x32_bf16 v[48:51], v[160:163], v[144:147], v[48:51]
    ds_read2_b32 v[206:207], v184 offset0:160 offset1:176
    ds_read2_b32 v[194:195], v184 offset0:32 offset1:48
    v_mfma_f32_16x16x32_bf16 v[56:59], v[160:163], v[148:151], v[56:59]
    ds_read2_b32 v[190:191], v187 offset0:0 offset1:16
    ds_read_b128 v[112:115], v185 offset:512
    v_mfma_f32_16x16x32_bf16 v[36:39], v[164:167], v[136:139], v[36:39]
    ds_read_b128 v[96:99], v185 offset:0
    ds_read_b128 v[116:119], v185 offset:576
    v_mfma_f32_16x16x32_bf16 v[44:47], v[164:167], v[140:143], v[44:47]
    ds_read_b128 v[100:103], v185 offset:64
    ds_read_b128 v[120:123], v185 offset:640
    v_mfma_f32_16x16x32_bf16 v[52:55], v[164:167], v[144:147], v[52:55]
    ds_read_b128 v[104:107], v185 offset:128
    ds_read_b128 v[124:127], v185 offset:704
    v_mfma_f32_16x16x32_bf16 v[60:63], v[164:167], v[148:151], v[60:63]
    ds_read_b128 v[108:111], v185 offset:192
    ds_read_b128 v[196:199], v186 offset:1024
    v_mfma_f32_16x16x32_bf16 v[64:67], v[136:139], v[168:171], v[64:67]
    ds_read_b128 v[200:203], v186 offset:1088
    ds_read2_b32 v[240:241], v188 offset0:0 offset1:128
    v_mfma_f32_16x16x32_bf16 v[68:71], v[140:143], v[168:171], v[68:71]
    ds_read_b64 v[250:251], v189 offset:3072
    v_mfma_f32_16x16x32_bf16 v[72:75], v[144:147], v[168:171], v[72:75]
    s_waitcnt lgkmcnt(13)
    v_fma_f32 v32, v128, -v204, v32
    v_fma_f32 v33, v129, -v204, v33
    v_fma_f32 v34, v130, -v204, v34
    v_mfma_f32_16x16x32_bf16 v[76:79], v[148:151], v[168:171], v[76:79]
    v_fma_f32 v35, v131, -v204, v35
    v_fma_f32 v36, v132, -v204, v36
    v_fma_f32 v37, v133, -v204, v37
    v_mfma_f32_16x16x32_bf16 v[80:83], v[136:139], v[172:175], v[80:83]
    v_fma_f32 v38, v134, -v204, v38
    v_fma_f32 v39, v135, -v204, v39
    v_mul_f32 v32, v32, v192
    v_mfma_f32_16x16x32_bf16 v[84:87], v[140:143], v[172:175], v[84:87]
    v_mul_f32 v33, v33, v192
    v_mul_f32 v34, v34, v192
    v_mul_f32 v35, v35, v192
    v_mfma_f32_16x16x32_bf16 v[88:91], v[144:147], v[172:175], v[88:91]
    v_mul_f32 v36, v36, v192
    v_mul_f32 v37, v37, v192
    v_mul_f32 v38, v38, v192
    v_mfma_f32_16x16x32_bf16 v[92:95], v[148:151], v[172:175], v[92:95]
    v_mul_f32 v39, v39, v192
    v_cvt_pk_bf16_f32 v32, v32, v33
    v_cvt_pk_bf16_f32 v33, v34, v35
    v_mfma_f32_16x16x32_bf16 v[0:3], v[152:155], v[136:139], v[0:3]
    v_cvt_pk_bf16_f32 v34, v36, v37
    v_cvt_pk_bf16_f32 v35, v38, v39
    buffer_store_dwordx4 v[32:35], v244, s[20:23], s32 offen offset:0 sc1
    v_mfma_f32_16x16x32_bf16 v[8:11], v[152:155], v[140:143], v[8:11]
    v_fma_f32 v40, v128, -v205, v40
    v_fma_f32 v41, v129, -v205, v41
    v_fma_f32 v42, v130, -v205, v42
    v_mfma_f32_16x16x32_bf16 v[16:19], v[152:155], v[144:147], v[16:19]
    v_fma_f32 v43, v131, -v205, v43
    v_fma_f32 v44, v132, -v205, v44
    v_fma_f32 v45, v133, -v205, v45
    v_mfma_f32_16x16x32_bf16 v[24:27], v[152:155], v[148:151], v[24:27]
    v_fma_f32 v46, v134, -v205, v46
    v_fma_f32 v47, v135, -v205, v47
    v_mul_f32 v40, v40, v193
    v_mfma_f32_16x16x32_bf16 v[4:7], v[156:159], v[136:139], v[4:7]
    v_mul_f32 v41, v41, v193
    v_mul_f32 v42, v42, v193
    v_mul_f32 v43, v43, v193
    v_mfma_f32_16x16x32_bf16 v[12:15], v[156:159], v[140:143], v[12:15]
    v_mul_f32 v44, v44, v193
    v_mul_f32 v45, v45, v193
    v_mul_f32 v46, v46, v193
    v_mfma_f32_16x16x32_bf16 v[20:23], v[156:159], v[144:147], v[20:23]
    v_mul_f32 v47, v47, v193
    v_cvt_pk_bf16_f32 v40, v40, v41
    v_cvt_pk_bf16_f32 v41, v42, v43
    v_mfma_f32_16x16x32_bf16 v[28:31], v[156:159], v[148:151], v[28:31]
    v_cvt_pk_bf16_f32 v42, v44, v45
    v_cvt_pk_bf16_f32 v43, v46, v47
    buffer_store_dwordx4 v[40:43], v244, s[20:23], s32 offen offset:128 sc1
    v_pk_fma_f32 v[48:49], v[128:129], v[206:207], v[48:49] op_sel_hi:[1,0,1] neg_lo:[0,1,0] neg_hi:[0,1,0]
    v_pk_fma_f32 v[50:51], v[130:131], v[206:207], v[50:51] op_sel_hi:[1,0,1] neg_lo:[0,1,0] neg_hi:[0,1,0]
    v_pk_fma_f32 v[52:53], v[132:133], v[206:207], v[52:53] op_sel_hi:[1,0,1] neg_lo:[0,1,0] neg_hi:[0,1,0]
    v_pk_fma_f32 v[54:55], v[134:135], v[206:207], v[54:55] op_sel_hi:[1,0,1] neg_lo:[0,1,0] neg_hi:[0,1,0]
    v_pk_mul_f32 v[48:49], v[48:49], v[194:195] op_sel_hi:[1,0]
    v_pk_mul_f32 v[50:51], v[50:51], v[194:195] op_sel_hi:[1,0]
    v_pk_mul_f32 v[52:53], v[52:53], v[194:195] op_sel_hi:[1,0]
    v_pk_mul_f32 v[54:55], v[54:55], v[194:195] op_sel_hi:[1,0]
    v_cvt_pk_bf16_f32 v48, v48, v49
    v_cvt_pk_bf16_f32 v49, v50, v51
    v_cvt_pk_bf16_f32 v50, v52, v53
    v_cvt_pk_bf16_f32 v51, v54, v55
    buffer_store_dwordx4 v[48:51], v244, s[20:23], s33 offen offset:0 sc1
    v_pk_fma_f32 v[56:57], v[128:129], v[206:207], v[56:57] op_sel:[0,1,0] op_sel_hi:[1,1,1] neg_lo:[0,1,0] neg_hi:[0,1,0]
    v_pk_fma_f32 v[58:59], v[130:131], v[206:207], v[58:59] op_sel:[0,1,0] op_sel_hi:[1,1,1] neg_lo:[0,1,0] neg_hi:[0,1,0]
    v_pk_fma_f32 v[60:61], v[132:133], v[206:207], v[60:61] op_sel:[0,1,0] op_sel_hi:[1,1,1] neg_lo:[0,1,0] neg_hi:[0,1,0]
    v_pk_fma_f32 v[62:63], v[134:135], v[206:207], v[62:63] op_sel:[0,1,0] op_sel_hi:[1,1,1] neg_lo:[0,1,0] neg_hi:[0,1,0]
    v_pk_mul_f32 v[56:57], v[56:57], v[194:195] op_sel:[0,1] op_sel_hi:[1,1]
    v_pk_mul_f32 v[58:59], v[58:59], v[194:195] op_sel:[0,1] op_sel_hi:[1,1]
    v_pk_mul_f32 v[60:61], v[60:61], v[194:195] op_sel:[0,1] op_sel_hi:[1,1]
    v_pk_mul_f32 v[62:63], v[62:63], v[194:195] op_sel:[0,1] op_sel_hi:[1,1]
    v_cvt_pk_bf16_f32 v56, v56, v57
    v_cvt_pk_bf16_f32 v57, v58, v59
    v_cvt_pk_bf16_f32 v58, v60, v61
    v_cvt_pk_bf16_f32 v59, v62, v63
    buffer_store_dwordx4 v[56:59], v244, s[20:23], s33 offen offset:128 sc1
    s_waitcnt lgkmcnt(0)
    v_pk_fma_f32 v[64:65], v[112:113], v[190:191], v[64:65] op_sel_hi:[1,0,1] neg_lo:[0,1,0] neg_hi:[0,1,0]
    v_pk_fma_f32 v[66:67], v[114:115], v[190:191], v[66:67] op_sel_hi:[1,0,1] neg_lo:[0,1,0] neg_hi:[0,1,0]
    v_pk_fma_f32 v[68:69], v[116:117], v[190:191], v[68:69] op_sel_hi:[1,0,1] neg_lo:[0,1,0] neg_hi:[0,1,0]
    v_pk_fma_f32 v[70:71], v[118:119], v[190:191], v[70:71] op_sel_hi:[1,0,1] neg_lo:[0,1,0] neg_hi:[0,1,0]
    v_pk_mul_f32 v[64:65], v[64:65], v[96:97]
    v_pk_mul_f32 v[66:67], v[66:67], v[98:99]
    v_pk_mul_f32 v[68:69], v[68:69], v[100:101]
    v_pk_mul_f32 v[70:71], v[70:71], v[102:103]
    v_cvt_pk_bf16_f32 v64, v64, v65
    v_cvt_pk_bf16_f32 v65, v66, v67
    v_cvt_pk_bf16_f32 v66, v68, v69
    v_cvt_pk_bf16_f32 v67, v70, v71
    buffer_store_dwordx4 v[64:67], v245, s[20:23], s32 offen offset:2048 sc1
    v_pk_fma_f32 v[80:81], v[112:113], v[190:191], v[80:81] op_sel:[0,1,0] op_sel_hi:[1,1,1] neg_lo:[0,1,0] neg_hi:[0,1,0]
    v_pk_fma_f32 v[82:83], v[114:115], v[190:191], v[82:83] op_sel:[0,1,0] op_sel_hi:[1,1,1] neg_lo:[0,1,0] neg_hi:[0,1,0]
    v_pk_fma_f32 v[84:85], v[116:117], v[190:191], v[84:85] op_sel:[0,1,0] op_sel_hi:[1,1,1] neg_lo:[0,1,0] neg_hi:[0,1,0]
    v_pk_fma_f32 v[86:87], v[118:119], v[190:191], v[86:87] op_sel:[0,1,0] op_sel_hi:[1,1,1] neg_lo:[0,1,0] neg_hi:[0,1,0]
    v_pk_mul_f32 v[80:81], v[80:81], v[96:97]
    v_pk_mul_f32 v[82:83], v[82:83], v[98:99]
    v_pk_mul_f32 v[84:85], v[84:85], v[100:101]
    v_pk_mul_f32 v[86:87], v[86:87], v[102:103]
    v_cvt_pk_bf16_f32 v80, v80, v81
    v_cvt_pk_bf16_f32 v81, v82, v83
    v_cvt_pk_bf16_f32 v82, v84, v85
    v_cvt_pk_bf16_f32 v83, v86, v87
    buffer_store_dwordx4 v[80:83], v245, s[20:23], s32 offen offset:2304 sc1
    v_pk_fma_f32 v[72:73], v[120:121], v[190:191], v[72:73] op_sel_hi:[1,0,1] neg_lo:[0,1,0] neg_hi:[0,1,0]
    v_pk_fma_f32 v[74:75], v[122:123], v[190:191], v[74:75] op_sel_hi:[1,0,1] neg_lo:[0,1,0] neg_hi:[0,1,0]
    v_pk_fma_f32 v[76:77], v[124:125], v[190:191], v[76:77] op_sel_hi:[1,0,1] neg_lo:[0,1,0] neg_hi:[0,1,0]
    v_pk_fma_f32 v[78:79], v[126:127], v[190:191], v[78:79] op_sel_hi:[1,0,1] neg_lo:[0,1,0] neg_hi:[0,1,0]
    v_pk_mul_f32 v[72:73], v[72:73], v[104:105]
    v_pk_mul_f32 v[74:75], v[74:75], v[106:107]
    v_pk_mul_f32 v[76:77], v[76:77], v[108:109]
    v_pk_mul_f32 v[78:79], v[78:79], v[110:111]
    v_cvt_pk_bf16_f32 v72, v72, v73
    v_cvt_pk_bf16_f32 v73, v74, v75
    v_cvt_pk_bf16_f32 v74, v76, v77
    v_cvt_pk_bf16_f32 v75, v78, v79
    buffer_store_dwordx4 v[72:75], v245, s[20:23], s33 offen offset:2048 sc1
    v_pk_fma_f32 v[88:89], v[120:121], v[190:191], v[88:89] op_sel:[0,1,0] op_sel_hi:[1,1,1] neg_lo:[0,1,0] neg_hi:[0,1,0]
    v_pk_fma_f32 v[90:91], v[122:123], v[190:191], v[90:91] op_sel:[0,1,0] op_sel_hi:[1,1,1] neg_lo:[0,1,0] neg_hi:[0,1,0]
    v_pk_fma_f32 v[92:93], v[124:125], v[190:191], v[92:93] op_sel:[0,1,0] op_sel_hi:[1,1,1] neg_lo:[0,1,0] neg_hi:[0,1,0]
    v_pk_fma_f32 v[94:95], v[126:127], v[190:191], v[94:95] op_sel:[0,1,0] op_sel_hi:[1,1,1] neg_lo:[0,1,0] neg_hi:[0,1,0]
    v_pk_mul_f32 v[88:89], v[88:89], v[104:105]
    v_pk_mul_f32 v[90:91], v[90:91], v[106:107]
    v_pk_mul_f32 v[92:93], v[92:93], v[108:109]
    v_pk_mul_f32 v[94:95], v[94:95], v[110:111]
    v_cvt_pk_bf16_f32 v88, v88, v89
    v_cvt_pk_bf16_f32 v89, v90, v91
    v_cvt_pk_bf16_f32 v90, v92, v93
    v_cvt_pk_bf16_f32 v91, v94, v95
    buffer_store_dwordx4 v[88:91], v245, s[20:23], s33 offen offset:2304 sc1
    ds_write_b128 v246, v[32:35] offset:0
    v_mul_f32 v192, 0x3e8293ee, v192
    ds_write_b128 v246, v[40:43] offset:128
    v_mul_f32 v193, 0x3e8293ee, v193
    ds_write_b128 v246, v[48:51] offset:4096
    v_mul_f32 v194, 0x3e8293ee, v194
    ds_write_b128 v246, v[56:59] offset:4224
    v_mul_f32 v195, 0x3e8293ee, v195
    v_pk_fma_f32 v[0:1], v[196:197], v[204:205], v[0:1] op_sel_hi:[1,0,1] neg_lo:[0,1,0] neg_hi:[0,1,0]
    v_pk_fma_f32 v[2:3], v[198:199], v[204:205], v[2:3] op_sel_hi:[1,0,1] neg_lo:[0,1,0] neg_hi:[0,1,0]
    v_pk_fma_f32 v[4:5], v[200:201], v[204:205], v[4:5] op_sel_hi:[1,0,1] neg_lo:[0,1,0] neg_hi:[0,1,0]
    v_pk_fma_f32 v[6:7], v[202:203], v[204:205], v[6:7] op_sel_hi:[1,0,1] neg_lo:[0,1,0] neg_hi:[0,1,0]
    v_pk_mul_f32 v[0:1], v[0:1], v[192:193] op_sel_hi:[1,0]
    v_pk_mul_f32 v[2:3], v[2:3], v[192:193] op_sel_hi:[1,0]
    v_pk_mul_f32 v[4:5], v[4:5], v[192:193] op_sel_hi:[1,0]
    v_pk_mul_f32 v[6:7], v[6:7], v[192:193] op_sel_hi:[1,0]
    v_cvt_pk_bf16_f32 v0, v0, v1
    v_cvt_pk_bf16_f32 v1, v2, v3
    v_cvt_pk_bf16_f32 v2, v4, v5
    v_cvt_pk_bf16_f32 v3, v6, v7
    ds_write_b128 v247, v[64:67] offset:2048
    ds_write_b128 v248, v[0:3] offset:0
    v_pk_fma_f32 v[8:9], v[196:197], v[204:205], v[8:9] op_sel:[0,1,0] op_sel_hi:[1,1,1] neg_lo:[0,1,0] neg_hi:[0,1,0]
    v_pk_fma_f32 v[10:11], v[198:199], v[204:205], v[10:11] op_sel:[0,1,0] op_sel_hi:[1,1,1] neg_lo:[0,1,0] neg_hi:[0,1,0]
    v_pk_fma_f32 v[12:13], v[200:201], v[204:205], v[12:13] op_sel:[0,1,0] op_sel_hi:[1,1,1] neg_lo:[0,1,0] neg_hi:[0,1,0]
    v_pk_fma_f32 v[14:15], v[202:203], v[204:205], v[14:15] op_sel:[0,1,0] op_sel_hi:[1,1,1] neg_lo:[0,1,0] neg_hi:[0,1,0]
    v_pk_mul_f32 v[8:9], v[8:9], v[192:193] op_sel:[0,1] op_sel_hi:[1,1]
    v_pk_mul_f32 v[10:11], v[10:11], v[192:193] op_sel:[0,1] op_sel_hi:[1,1]
    v_pk_mul_f32 v[12:13], v[12:13], v[192:193] op_sel:[0,1] op_sel_hi:[1,1]
    v_pk_mul_f32 v[14:15], v[14:15], v[192:193] op_sel:[0,1] op_sel_hi:[1,1]
    v_cvt_pk_bf16_f32 v8, v8, v9
    v_cvt_pk_bf16_f32 v9, v10, v11
    v_cvt_pk_bf16_f32 v10, v12, v13
    v_cvt_pk_bf16_f32 v11, v14, v15
    ds_write_b128 v247, v[80:83] offset:2304
    ds_write_b128 v248, v[8:11] offset:256
    v_pk_fma_f32 v[16:17], v[196:197], v[206:207], v[16:17] op_sel_hi:[1,0,1] neg_lo:[0,1,0] neg_hi:[0,1,0]
    v_pk_fma_f32 v[18:19], v[198:199], v[206:207], v[18:19] op_sel_hi:[1,0,1] neg_lo:[0,1,0] neg_hi:[0,1,0]
    v_pk_fma_f32 v[20:21], v[200:201], v[206:207], v[20:21] op_sel_hi:[1,0,1] neg_lo:[0,1,0] neg_hi:[0,1,0]
    v_pk_fma_f32 v[22:23], v[202:203], v[206:207], v[22:23] op_sel_hi:[1,0,1] neg_lo:[0,1,0] neg_hi:[0,1,0]
    v_pk_mul_f32 v[16:17], v[16:17], v[194:195] op_sel_hi:[1,0]
    v_pk_mul_f32 v[18:19], v[18:19], v[194:195] op_sel_hi:[1,0]
    v_pk_mul_f32 v[20:21], v[20:21], v[194:195] op_sel_hi:[1,0]
    v_pk_mul_f32 v[22:23], v[22:23], v[194:195] op_sel_hi:[1,0]
    v_cvt_pk_bf16_f32 v16, v16, v17
    v_cvt_pk_bf16_f32 v17, v18, v19
    v_cvt_pk_bf16_f32 v18, v20, v21
    v_cvt_pk_bf16_f32 v19, v22, v23
    ds_write_b128 v247, v[72:75] offset:6144
    ds_write_b128 v248, v[16:19] offset:2048
    v_pk_fma_f32 v[24:25], v[196:197], v[206:207], v[24:25] op_sel:[0,1,0] op_sel_hi:[1,1,1] neg_lo:[0,1,0] neg_hi:[0,1,0]
    v_pk_fma_f32 v[26:27], v[198:199], v[206:207], v[26:27] op_sel:[0,1,0] op_sel_hi:[1,1,1] neg_lo:[0,1,0] neg_hi:[0,1,0]
    v_pk_fma_f32 v[28:29], v[200:201], v[206:207], v[28:29] op_sel:[0,1,0] op_sel_hi:[1,1,1] neg_lo:[0,1,0] neg_hi:[0,1,0]
    v_pk_fma_f32 v[30:31], v[202:203], v[206:207], v[30:31] op_sel:[0,1,0] op_sel_hi:[1,1,1] neg_lo:[0,1,0] neg_hi:[0,1,0]
    v_pk_mul_f32 v[24:25], v[24:25], v[194:195] op_sel:[0,1] op_sel_hi:[1,1]
    v_pk_mul_f32 v[26:27], v[26:27], v[194:195] op_sel:[0,1] op_sel_hi:[1,1]
    v_pk_mul_f32 v[28:29], v[28:29], v[194:195] op_sel:[0,1] op_sel_hi:[1,1]
    v_pk_mul_f32 v[30:31], v[30:31], v[194:195] op_sel:[0,1] op_sel_hi:[1,1]
    v_cvt_pk_bf16_f32 v24, v24, v25
    v_cvt_pk_bf16_f32 v25, v26, v27
    v_cvt_pk_bf16_f32 v26, v28, v29
    v_cvt_pk_bf16_f32 v27, v30, v31
    ds_write_b128 v247, v[88:91] offset:6400
    ds_write_b128 v248, v[24:27] offset:2304
    s_lshl_b32 s30, s25, 8
    s_lshl_b32 s31, s24, 4
    s_add_u32 s30, s30, s31
    s_lshl_b32 s31, s34, 3
    s_add_u32 s30, s30, s31
    s_lshl_b32 s31, s35, 2
    s_add_u32 s30, s30, s31
    s_add_u32 s30, s30, s26
    s_add_u32 s30, s30, 0xdd0000
    v_readfirstlane_b32 s73, v250
    v_readfirstlane_b32 s77, v251
    s_lshr_b32 s39, s73, 5
    s_lshl_b32 s34, s24, 2
    s_sub_u32 s39, s39, s34
    s_add_u32 s39, s39, 8
    s_lshr_b32 s34, s39, 3
    s_add_u32 s34, s34, 1
    s_cmp_lt_u32 s39, 12
    s_cselect_b32 s100, s34, 0
    s_cmp_lg_u32 s26, 0
    s_cbranch_scc1 sk_2
    v_permlane32_swap_b32 v208, v210
    v_permlane32_swap_b32 v209, v211
    v_permlane32_swap_b32 v212, v214
    v_permlane32_swap_b32 v213, v215
    v_permlane32_swap_b32 v216, v218
    v_permlane32_swap_b32 v217, v219
    v_permlane32_swap_b32 v220, v222
    v_permlane32_swap_b32 v221, v223
sk_2:
    v_mov_b32 v20, 0xffff
    v_mov_b32 v21, 0xffff0000
    v_cndmask_b32 v22, 0, v20, s[40:41]
    v_cndmask_b32 v23, 0, v21, s[42:43]
    v_or_b32 v12, v22, v23
    v_cndmask_b32 v22, 0, v20, s[44:45]
    v_cndmask_b32 v23, 0, v21, s[46:47]
    v_or_b32 v13, v22, v23
    v_cndmask_b32 v22, 0, v20, s[48:49]
    v_cndmask_b32 v23, 0, v21, s[50:51]
    v_or_b32 v14, v22, v23
    v_cndmask_b32 v22, 0, v20, s[52:53]
    v_cndmask_b32 v23, 0, v21, s[54:55]
    v_or_b32 v15, v22, v23
    v_cndmask_b32 v22, 0, v20, s[56:57]
    v_cndmask_b32 v23, 0, v21, s[58:59]
    v_or_b32 v16, v22, v23
    v_cndmask_b32 v22, 0, v20, s[60:61]
    v_cndmask_b32 v23, 0, v21, s[62:63]
    v_or_b32 v17, v22, v23
    v_cndmask_b32 v22, 0, v20, s[64:65]
    v_cndmask_b32 v23, 0, v21, s[66:67]
    v_or_b32 v18, v22, v23
    v_cndmask_b32 v22, 0, v20, s[68:69]
    v_cndmask_b32 v23, 0, v21, s[70:71]
    v_or_b32 v19, v22, v23
    s_xor_b32 s76, s99, 0
    s_and_b32 s34, s76, 3
    s_lshl_b32 s33, s34, 12
    s_add_u32 s33, s33, 65536
    v_add_u32 v20, s33, v253
    v_add_u32 v22, 32768, v20
    v_add_u32 v23, 94208, v253
    s_add_u32 s74, s34, 1
    s_mov_b32 s75, 0
    s_lshl_b32 s34, s34, 11
    s_add_u32 s34, s34, 49152
    v_add_u32 v3, s34, v253
    v_mov_b32 v21, 0xf149f2ca
    v_cndmask_b32 v24, v21, 0, s[40:41]
    v_cndmask_b32 v25, v21, 0, s[42:43]
    v_cndmask_b32 v26, v21, 0, s[44:45]
    v_cndmask_b32 v27, v21, 0, s[46:47]
    v_cndmask_b32 v28, v21, 0, s[48:49]
    v_cndmask_b32 v29, v21, 0, s[50:51]
    v_cndmask_b32 v30, v21, 0, s[52:53]
    v_cndmask_b32 v31, v21, 0, s[54:55]
    v_cndmask_b32 v32, v21, 0, s[56:57]
    v_cndmask_b32 v33, v21, 0, s[58:59]
    v_cndmask_b32 v34, v21, 0, s[60:61]
    v_cndmask_b32 v35, v21, 0, s[62:63]
    v_cndmask_b32 v36, v21, 0, s[64:65]
    v_cndmask_b32 v37, v21, 0, s[66:67]
    v_cndmask_b32 v38, v21, 0, s[68:69]
    v_cndmask_b32 v39, v21, 0, s[70:71]
    v_lshrrev_b32 v40, 2, v252
    v_xor_b32 v40, v40, v252
    v_bfe_u32 v40, v40, 2, 1
    v_add_u32 v40, -1, v40
    v_and_b32 v40, 0x3f803f80, v40
    v_mov_b32 v41, v40
    v_mov_b32 v42, v40
    v_mov_b32 v43, v40
    v_mov_b32 v44, 0
    v_mov_b32 v45, 0
    v_mov_b32 v46, 0
    v_mov_b32 v47, 0
    v_mov_b32 v88, 0
    v_mov_b32 v89, 0
    v_mov_b32 v90, 0
    v_mov_b32 v91, 0
    v_mov_b32 v92, 0
    v_mov_b32 v93, 0
    v_mov_b32 v94, 0
    v_mov_b32 v95, 0
    v_mov_b32 v96, 0
    v_mov_b32 v97, 0
    v_mov_b32 v98, 0
    v_mov_b32 v99, 0
    v_mov_b32 v100, 0
    v_mov_b32 v101, 0
    v_mov_b32 v102, 0
    v_mov_b32 v103, 0
    s_cmp_lg_u32 s100, 2
    s_cbranch_scc1 sk_3
    v_mov_b32 v154, s88
    s_mov_b64 exec, 1
    s_waitcnt vmcnt(0)
    buffer_store_dword v154, v253, s[20:23], s30 offen sc1
    s_mov_b64 exec, -1
sk_3:
    s_waitcnt lgkmcnt(0)
    s_barrier
    s_cmp_lg_u32 s100, 2
    s_cbranch_scc1 sk_4
    s_lshr_b32 s34, s73, 5
    s_cmp_lg_u32 s34, s99
    s_cbranch_scc1 sk_5
    s_and_b32 s32, s73, 31
    v_and_b32 v0, 31, v252
    v_cmp_eq_u32 vcc, s32, v0
    v_lshrrev_b32 v0, 5, v252
    v_lshlrev_b32 v0, 4, v0
    s_lshl_b32 s34, s98, 7
    s_add_u32 s34, s34, 0xdc4000
    s_mov_b64 exec, vcc
    buffer_load_dwordx4 v[208:211], v0, s[20:23], s34 offen offset:0 sc1
    buffer_load_dwordx4 v[212:215], v0, s[20:23], s34 offen offset:32 sc1
    buffer_load_dwordx4 v[216:219], v0, s[20:23], s34 offen offset:64 sc1
    buffer_load_dwordx4 v[220:223], v0, s[20:23], s34 offen offset:96 sc1
    v_mov_b32 v240, 1.0
    v_mov_b32 v241, 0
    s_mov_b64 exec, -1
sk_5:
    s_barrier
sk_4:
    ds_read_b128 v[4:7], v3
    ds_read_b128 v[8:11], v3 offset:1024
    ds_read_b128 v[112:115], v22 offset:0
    ds_read_b128 v[116:119], v22 offset:1024
    s_waitcnt lgkmcnt(0)
    v_mfma_f32_32x32x16_bf16 v[56:71], v[112:115], v[4:7], v[24:39]
    v_mfma_f32_32x32x16_bf16 v[56:71], v[116:119], v[8:11], v[56:71]
    ds_read_b128 v[104:107], v23 offset:4096
    ds_read_b128 v[124:127], v22 offset:3072
    ds_read_b128 v[108:111], v23 offset:5120
    ds_read_b128 v[120:123], v22 offset:2048
    s_cmp_eq_u32 s100, 2
    s_cbranch_scc1 sk_7
    v_mov_b32 v154, s88
    s_mov_b64 exec, 1
    s_waitcnt vmcnt(0)
    buffer_store_dword v154, v253, s[20:23], s30 offen sc1
    s_mov_b64 exec, -1
sk_7:
    s_nop 5
    v_max3_f32 v21, v56, v57, v58
    v_max3_f32 v152, v59, v60, v61
    v_max3_f32 v21, v21, v62, v63
    v_max3_f32 v152, v152, v64, v65
    v_max3_f32 v21, v21, v66, v67
    v_max3_f32 v152, v152, v68, v69
    v_max3_f32 v21, v21, v70, v71
    v_max_f32 v21, v21, v152
    v_mov_b32 v152, v21
    s_nop 1
    v_permlane32_swap_b32 v21, v152
    v_max_f32 v21, v21, v152
    v_sub_f32 v24, 0, v21
    v_sub_f32 v25, 0, v21
    v_sub_f32 v26, 0, v21
    v_sub_f32 v27, 0, v21
    v_sub_f32 v28, 0, v21
    v_sub_f32 v29, 0, v21
    v_sub_f32 v30, 0, v21
    v_sub_f32 v31, 0, v21
    v_sub_f32 v32, 0, v21
    v_sub_f32 v33, 0, v21
    v_sub_f32 v34, 0, v21
    v_sub_f32 v35, 0, v21
    v_sub_f32 v36, 0, v21
    v_sub_f32 v37, 0, v21
    v_sub_f32 v38, 0, v21
    v_sub_f32 v39, 0, v21
    s_branch a0_6_go
a0_6_mid:
    s_cmp_ge_u32 s76, 8
    s_cselect_b32 s33, 0, -1
    v_not_b32 v12, v12
    v_or_b32 v12, s33, v12
    v_not_b32 v13, v13
    v_or_b32 v13, s33, v13
    v_not_b32 v14, v14
    v_or_b32 v14, s33, v14
    v_not_b32 v15, v15
    v_or_b32 v15, s33, v15
    v_not_b32 v16, v16
    v_or_b32 v16, s33, v16
    v_not_b32 v17, v17
    v_or_b32 v17, s33, v17
    v_not_b32 v18, v18
    v_or_b32 v18, s33, v18
    v_not_b32 v19, v19
    v_or_b32 v19, s33, v19
    s_and_b32 s32, s76, 3
    s_cmp_ge_u32 s76, 8
    s_cselect_b32 s32, s32, 4
    s_sub_u32 s74, 8, s32
    s_lshl_b32 s32, s32, 12
    s_add_u32 s32, s32, 65536
    v_add_u32 v22, s32, v253
    v_add_u32 v23, s32, v253
    s_cmp_eq_u32 s26, 0
    s_cselect_b32 s75, 2, 1
    s_barrier
    s_cmp_lg_u32 s100, 1
    s_cbranch_scc1 sk_8
    s_barrier
sk_8:
    s_cmp_lt_u32 s76, 4
    s_cbranch_scc1 a0_6_none
    ds_read_b128 v[112:115], v22 offset:0
    ds_read_b128 v[116:119], v22 offset:1024
    ds_read_b128 v[104:107], v23 offset:4096
    ds_read_b128 v[124:127], v22 offset:3072
    ds_read_b128 v[108:111], v23 offset:5120
    ds_read_b128 v[120:123], v22 offset:2048
    s_waitcnt lgkmcnt(4)
a0_6_go:
    s_nop 0
    v_mfma_f32_32x32x16_bf16 v[56:71], v[112:115], v[4:7], v[24:39]
    v_mfma_f32_32x32x16_bf16 v[56:71], v[116:119], v[8:11], v[56:71]
    s_waitcnt lgkmcnt(3)
    v_mfma_f32_32x32x16_bf16 v[72:87], v[104:107], v[4:7], v[24:39]
    ds_read_b128 v[104:107], v23 offset:8192
    s_nop 8
    v_exp_f32 v56, v56
    v_exp_f32 v57, v57
    v_exp_f32 v58, v58
    ds_read_b128 v[128:131], v23 offset:7168
    v_exp_f32 v59, v59
    v_exp_f32 v60, v60
    v_exp_f32 v61, v61
    s_waitcnt lgkmcnt(2)
    v_mfma_f32_32x32x16_bf16 v[72:87], v[108:111], v[8:11], v[72:87]
    ds_read_b128 v[108:111], v23 offset:9216
    v_exp_f32 v62, v62
    v_exp_f32 v63, v63
    v_cvt_pk_bf16_f32 v136, v56, v57
    v_cvt_pk_bf16_f32 v137, v58, v59
    v_cvt_pk_bf16_f32 v138, v60, v61
    v_cvt_pk_bf16_f32 v139, v62, v63
    v_and_b32 v136, v136, v12
    v_and_b32 v137, v137, v13
    v_and_b32 v138, v138, v14
    v_and_b32 v139, v139, v15
    v_exp_f32 v64, v64
    v_exp_f32 v65, v65
    v_mfma_f32_32x32x16_bf16 v[88:103], v[120:123], v[136:139], v[88:103]
    ds_read_b128 v[120:123], v23 offset:6144
    s_cmp_eq_u32 s75, 0
    s_cbranch_scc1 sk_9
    s_add_u32 s96, s25, 0
    s_and_b32 s96, s96, 15
    s_lshl_b32 s96, s96, 17
    s_add_u32 m0, s101, 0
    s_nop 0
    buffer_load_dwordx4 v243, s[8:11], s96 offen lds
sk_9:
    v_exp_f32 v66, v66
    v_exp_f32 v67, v67
    v_exp_f32 v68, v68
    v_exp_f32 v69, v69
    v_mfma_f32_16x16x32_bf16 v[44:47], v[40:43], v[136:139], v[44:47]
    v_exp_f32 v70, v70
    v_exp_f32 v71, v71
    v_cvt_pk_bf16_f32 v140, v64, v65
    v_cvt_pk_bf16_f32 v141, v66, v67
    v_cvt_pk_bf16_f32 v142, v68, v69
    v_cvt_pk_bf16_f32 v143, v70, v71
    v_and_b32 v140, v140, v16
    v_and_b32 v141, v141, v17
    v_and_b32 v142, v142, v18
    v_and_b32 v143, v143, v19
    s_cmp_eq_u32 s75, 0
    s_cbranch_scc1 sk_10
    s_barrier
    s_add_u32 s96, s25, 12
    s_and_b32 s96, s96, 15
    s_lshl_b32 s96, s96, 17
    s_add_u32 m0, s101, 49152
    s_nop 0
    buffer_load_dwordx4 v243, s[8:11], s96 offen lds
sk_10:
    s_cmp_eq_u32 s74, 1
    s_cbranch_scc1 a0_6_e0
    s_cmp_eq_u32 s74, 2
    s_cbranch_scc1 a0_6_t1
    s_waitcnt lgkmcnt(3)
    v_mfma_f32_32x32x16_bf16 v[56:71], v[104:107], v[4:7], v[24:39]
    ds_read_b128 v[104:107], v23 offset:12288
    v_exp_f32 v72, v72
    v_exp_f32 v73, v73
    v_exp_f32 v74, v74
    v_mfma_f32_32x32x16_bf16 v[88:103], v[124:127], v[140:143], v[88:103]
    ds_read_b128 v[124:127], v23 offset:11264
    v_exp_f32 v75, v75
    v_exp_f32 v76, v76
    v_exp_f32 v77, v77
    s_waitcnt lgkmcnt(2)
    v_mfma_f32_32x32x16_bf16 v[56:71], v[108:111], v[8:11], v[56:71]
    ds_read_b128 v[108:111], v23 offset:13312
    v_exp_f32 v78, v78
    v_exp_f32 v79, v79
    v_cvt_pk_bf16_f32 v136, v72, v73
    v_cvt_pk_bf16_f32 v137, v74, v75
    v_mfma_f32_16x16x32_bf16 v[44:47], v[40:43], v[140:143], v[44:47]
    v_cvt_pk_bf16_f32 v138, v76, v77
    v_cvt_pk_bf16_f32 v139, v78, v79
    v_exp_f32 v80, v80
    v_exp_f32 v81, v81
    v_mfma_f32_32x32x16_bf16 v[88:103], v[120:123], v[136:139], v[88:103]
    ds_read_b128 v[120:123], v23 offset:10240
    s_cmp_eq_u32 s75, 0
    s_cbranch_scc1 sk_11
    s_add_u32 s96, s25, 13
    s_and_b32 s96, s96, 15
    s_lshl_b32 s96, s96, 17
    s_add_u32 m0, s101, 53248
    s_nop 0
    buffer_load_dwordx4 v243, s[8:11], s96 offen lds
sk_11:
    v_exp_f32 v82, v82
    v_exp_f32 v83, v83
    v_exp_f32 v84, v84
    v_exp_f32 v85, v85
    v_mfma_f32_16x16x32_bf16 v[44:47], v[40:43], v[136:139], v[44:47]
    v_exp_f32 v86, v86
    v_exp_f32 v87, v87
    v_cvt_pk_bf16_f32 v140, v80, v81
    v_cvt_pk_bf16_f32 v141, v82, v83
    v_cvt_pk_bf16_f32 v142, v84, v85
    v_cvt_pk_bf16_f32 v143, v86, v87
    s_cmp_eq_u32 s75, 0
    s_cbranch_scc1 sk_12
    s_add_u32 s96, s25, 14
    s_and_b32 s96, s96, 15
    s_lshl_b32 s96, s96, 17
    s_add_u32 m0, s101, 57344
    s_nop 0
    buffer_load_dwordx4 v243, s[8:11], s96 offen lds
sk_12:
    s_cmp_eq_u32 s74, 3
    s_cbranch_scc1 a0_6_t0
    s_waitcnt lgkmcnt(3)
    v_mfma_f32_32x32x16_bf16 v[72:87], v[104:107], v[4:7], v[24:39]
    ds_read_b128 v[104:107], v23 offset:16384
    v_exp_f32 v56, v56
    v_exp_f32 v57, v57
    v_exp_f32 v58, v58
    v_mfma_f32_32x32x16_bf16 v[88:103], v[128:131], v[140:143], v[88:103]
    ds_read_b128 v[128:131], v23 offset:15360
    v_exp_f32 v59, v59
    v_exp_f32 v60, v60
    v_exp_f32 v61, v61
    s_waitcnt lgkmcnt(2)
    v_mfma_f32_32x32x16_bf16 v[72:87], v[108:111], v[8:11], v[72:87]
    ds_read_b128 v[108:111], v23 offset:17408
    v_exp_f32 v62, v62
    v_exp_f32 v63, v63
    v_cvt_pk_bf16_f32 v136, v56, v57
    v_cvt_pk_bf16_f32 v137, v58, v59
    v_mfma_f32_16x16x32_bf16 v[44:47], v[40:43], v[140:143], v[44:47]
    v_cvt_pk_bf16_f32 v138, v60, v61
    v_cvt_pk_bf16_f32 v139, v62, v63
    v_exp_f32 v64, v64
    v_exp_f32 v65, v65
    v_mfma_f32_32x32x16_bf16 v[88:103], v[120:123], v[136:139], v[88:103]
    ds_read_b128 v[120:123], v23 offset:14336
    s_cmp_eq_u32 s75, 0
    s_cbranch_scc1 sk_13
    s_add_u32 s96, s25, 15
    s_and_b32 s96, s96, 15
    s_lshl_b32 s96, s96, 17
    s_add_u32 m0, s101, 61440
    s_nop 0
    buffer_load_dwordx4 v243, s[8:11], s96 offen lds
sk_13:
    v_exp_f32 v66, v66
    v_exp_f32 v67, v67
    v_exp_f32 v68, v68
    v_exp_f32 v69, v69
    v_mfma_f32_16x16x32_bf16 v[44:47], v[40:43], v[136:139], v[44:47]
    v_exp_f32 v70, v70
    v_exp_f32 v71, v71
    v_cvt_pk_bf16_f32 v140, v64, v65
    v_cvt_pk_bf16_f32 v141, v66, v67
    v_cvt_pk_bf16_f32 v142, v68, v69
    v_cvt_pk_bf16_f32 v143, v70, v71
    s_cmp_eq_u32 s74, 4
    s_cbranch_scc1 a0_6_t1
    s_waitcnt lgkmcnt(3)
    v_mfma_f32_32x32x16_bf16 v[56:71], v[104:107], v[4:7], v[24:39]
    ds_read_b128 v[104:107], v23 offset:20480
    v_exp_f32 v72, v72
    v_exp_f32 v73, v73
    v_exp_f32 v74, v74
    v_mfma_f32_32x32x16_bf16 v[88:103], v[124:127], v[140:143], v[88:103]
    ds_read_b128 v[124:127], v23 offset:19456
    v_exp_f32 v75, v75
    v_exp_f32 v76, v76
    v_exp_f32 v77, v77
    s_waitcnt lgkmcnt(2)
    v_mfma_f32_32x32x16_bf16 v[56:71], v[108:111], v[8:11], v[56:71]
    ds_read_b128 v[108:111], v23 offset:21504
    v_exp_f32 v78, v78
    v_exp_f32 v79, v79
    v_cvt_pk_bf16_f32 v136, v72, v73
    v_cvt_pk_bf16_f32 v137, v74, v75
    v_mfma_f32_16x16x32_bf16 v[44:47], v[40:43], v[140:143], v[44:47]
    v_cvt_pk_bf16_f32 v138, v76, v77
    v_cvt_pk_bf16_f32 v139, v78, v79
    v_exp_f32 v80, v80
    v_exp_f32 v81, v81
    v_mfma_f32_32x32x16_bf16 v[88:103], v[120:123], v[136:139], v[88:103]
    ds_read_b128 v[120:123], v23 offset:18432
    v_exp_f32 v82, v82
    v_exp_f32 v83, v83
    v_exp_f32 v84, v84
    v_exp_f32 v85, v85
    v_mfma_f32_16x16x32_bf16 v[44:47], v[40:43], v[136:139], v[44:47]
    v_exp_f32 v86, v86
    v_exp_f32 v87, v87
    v_cvt_pk_bf16_f32 v140, v80, v81
    v_cvt_pk_bf16_f32 v141, v82, v83
    v_cvt_pk_bf16_f32 v142, v84, v85
    v_cvt_pk_bf16_f32 v143, v86, v87
    s_cmp_eq_u32 s74, 5
    s_cbranch_scc1 a0_6_t0
    s_waitcnt lgkmcnt(3)
    v_mfma_f32_32x32x16_bf16 v[72:87], v[104:107], v[4:7], v[24:39]
    ds_read_b128 v[104:107], v23 offset:24576
    v_exp_f32 v56, v56
    v_exp_f32 v57, v57
    v_exp_f32 v58, v58
    v_mfma_f32_32x32x16_bf16 v[88:103], v[128:131], v[140:143], v[88:103]
    ds_read_b128 v[128:131], v23 offset:23552
    v_exp_f32 v59, v59
    v_exp_f32 v60, v60
    v_exp_f32 v61, v61
    s_waitcnt lgkmcnt(2)
    v_mfma_f32_32x32x16_bf16 v[72:87], v[108:111], v[8:11], v[72:87]
    ds_read_b128 v[108:111], v23 offset:25600
    v_exp_f32 v62, v62
    v_exp_f32 v63, v63
    v_cvt_pk_bf16_f32 v136, v56, v57
    v_cvt_pk_bf16_f32 v137, v58, v59
    v_mfma_f32_16x16x32_bf16 v[44:47], v[40:43], v[140:143], v[44:47]
    v_cvt_pk_bf16_f32 v138, v60, v61
    v_cvt_pk_bf16_f32 v139, v62, v63
    v_exp_f32 v64, v64
    v_exp_f32 v65, v65
    v_mfma_f32_32x32x16_bf16 v[88:103], v[120:123], v[136:139], v[88:103]
    ds_read_b128 v[120:123], v23 offset:22528
    v_exp_f32 v66, v66
    v_exp_f32 v67, v67
    v_exp_f32 v68, v68
    v_exp_f32 v69, v69
    v_mfma_f32_16x16x32_bf16 v[44:47], v[40:43], v[136:139], v[44:47]
    v_exp_f32 v70, v70
    v_exp_f32 v71, v71
    v_cvt_pk_bf16_f32 v140, v64, v65
    v_cvt_pk_bf16_f32 v141, v66, v67
    v_cvt_pk_bf16_f32 v142, v68, v69
    v_cvt_pk_bf16_f32 v143, v70, v71
    s_cmp_eq_u32 s74, 6
    s_cbranch_scc1 a0_6_t1
    s_waitcnt lgkmcnt(3)
    v_mfma_f32_32x32x16_bf16 v[56:71], v[104:107], v[4:7], v[24:39]
    ds_read_b128 v[104:107], v23 offset:28672
    v_exp_f32 v72, v72
    v_exp_f32 v73, v73
    v_exp_f32 v74, v74
    v_mfma_f32_32x32x16_bf16 v[88:103], v[124:127], v[140:143], v[88:103]
    ds_read_b128 v[124:127], v23 offset:27648
    v_exp_f32 v75, v75
    v_exp_f32 v76, v76
    v_exp_f32 v77, v77
    s_waitcnt lgkmcnt(2)
    v_mfma_f32_32x32x16_bf16 v[56:71], v[108:111], v[8:11], v[56:71]
    ds_read_b128 v[108:111], v23 offset:29696
    v_exp_f32 v78, v78
    v_exp_f32 v79, v79
    v_cvt_pk_bf16_f32 v136, v72, v73
    v_cvt_pk_bf16_f32 v137, v74, v75
    v_mfma_f32_16x16x32_bf16 v[44:47], v[40:43], v[140:143], v[44:47]
    v_cvt_pk_bf16_f32 v138, v76, v77
    v_cvt_pk_bf16_f32 v139, v78, v79
    v_exp_f32 v80, v80
    v_exp_f32 v81, v81
    v_mfma_f32_32x32x16_bf16 v[88:103], v[120:123], v[136:139], v[88:103]
    ds_read_b128 v[120:123], v23 offset:26624
    v_exp_f32 v82, v82
    v_exp_f32 v83, v83
    v_exp_f32 v84, v84
    v_exp_f32 v85, v85
    v_mfma_f32_16x16x32_bf16 v[44:47], v[40:43], v[136:139], v[44:47]
    v_exp_f32 v86, v86
    v_exp_f32 v87, v87
    v_cvt_pk_bf16_f32 v140, v80, v81
    v_cvt_pk_bf16_f32 v141, v82, v83
    v_cvt_pk_bf16_f32 v142, v84, v85
    v_cvt_pk_bf16_f32 v143, v86, v87
    s_cmp_eq_u32 s74, 7
    s_cbranch_scc1 a0_6_t0
    s_waitcnt lgkmcnt(3)
    v_mfma_f32_32x32x16_bf16 v[72:87], v[104:107], v[4:7], v[24:39]
    ds_read_b128 v[104:107], v23 offset:24576
    v_exp_f32 v56, v56
    v_exp_f32 v57, v57
    v_exp_f32 v58, v58
    v_mfma_f32_32x32x16_bf16 v[88:103], v[128:131], v[140:143], v[88:103]
    ds_read_b128 v[128:131], v23 offset:31744
    v_exp_f32 v59, v59
    v_exp_f32 v60, v60
    v_exp_f32 v61, v61
    s_waitcnt lgkmcnt(2)
    v_mfma_f32_32x32x16_bf16 v[72:87], v[108:111], v[8:11], v[72:87]
    ds_read_b128 v[108:111], v23 offset:25600
    v_exp_f32 v62, v62
    v_exp_f32 v63, v63
    v_cvt_pk_bf16_f32 v136, v56, v57
    v_cvt_pk_bf16_f32 v137, v58, v59
    v_mfma_f32_16x16x32_bf16 v[44:47], v[40:43], v[140:143], v[44:47]
    v_cvt_pk_bf16_f32 v138, v60, v61
    v_cvt_pk_bf16_f32 v139, v62, v63
    v_exp_f32 v64, v64
    v_exp_f32 v65, v65
    v_mfma_f32_32x32x16_bf16 v[88:103], v[120:123], v[136:139], v[88:103]
    ds_read_b128 v[120:123], v23 offset:30720
    v_exp_f32 v66, v66
    v_exp_f32 v67, v67
    v_exp_f32 v68, v68
    v_exp_f32 v69, v69
    v_mfma_f32_16x16x32_bf16 v[44:47], v[40:43], v[136:139], v[44:47]
    v_exp_f32 v70, v70
    v_exp_f32 v71, v71
    v_cvt_pk_bf16_f32 v140, v64, v65
    v_cvt_pk_bf16_f32 v141, v66, v67
    v_cvt_pk_bf16_f32 v142, v68, v69
    v_cvt_pk_bf16_f32 v143, v70, v71
a0_6_t1:
    v_exp_f32 v72, v72
    v_exp_f32 v73, v73
    v_exp_f32 v74, v74
    v_mfma_f32_32x32x16_bf16 v[88:103], v[124:127], v[140:143], v[88:103]
    v_exp_f32 v75, v75
    v_exp_f32 v76, v76
    v_exp_f32 v77, v77
    v_exp_f32 v78, v78
    v_exp_f32 v79, v79
    v_cvt_pk_bf16_f32 v136, v72, v73
    v_cvt_pk_bf16_f32 v137, v74, v75
    v_mfma_f32_16x16x32_bf16 v[44:47], v[40:43], v[140:143], v[44:47]
    v_cvt_pk_bf16_f32 v138, v76, v77
    v_cvt_pk_bf16_f32 v139, v78, v79
    v_exp_f32 v80, v80
    v_exp_f32 v81, v81
    s_waitcnt lgkmcnt(0)
    v_mfma_f32_32x32x16_bf16 v[88:103], v[120:123], v[136:139], v[88:103]
    v_exp_f32 v82, v82
    v_exp_f32 v83, v83
    v_exp_f32 v84, v84
    v_exp_f32 v85, v85
    v_mfma_f32_16x16x32_bf16 v[44:47], v[40:43], v[136:139], v[44:47]
    v_exp_f32 v86, v86
    v_exp_f32 v87, v87
    v_cvt_pk_bf16_f32 v140, v80, v81
    v_cvt_pk_bf16_f32 v141, v82, v83
    v_cvt_pk_bf16_f32 v142, v84, v85
    v_cvt_pk_bf16_f32 v143, v86, v87
a0_6_e1:
    s_cmp_eq_u32 s75, 0
    s_nop 0
    v_mfma_f32_16x16x32_bf16 v[44:47], v[40:43], v[140:143], v[44:47]
    v_mfma_f32_32x32x16_bf16 v[88:103], v[128:131], v[140:143], v[88:103]
    s_cbranch_scc1 a0_6_mid
    s_branch a0_6_fin
a0_6_t0:
    v_exp_f32 v56, v56
    v_exp_f32 v57, v57
    v_exp_f32 v58, v58
    v_mfma_f32_32x32x16_bf16 v[88:103], v[128:131], v[140:143], v[88:103]
    v_exp_f32 v59, v59
    v_exp_f32 v60, v60
    v_exp_f32 v61, v61
    v_exp_f32 v62, v62
    v_exp_f32 v63, v63
    v_cvt_pk_bf16_f32 v136, v56, v57
    v_cvt_pk_bf16_f32 v137, v58, v59
    v_mfma_f32_16x16x32_bf16 v[44:47], v[40:43], v[140:143], v[44:47]
    v_cvt_pk_bf16_f32 v138, v60, v61
    v_cvt_pk_bf16_f32 v139, v62, v63
    v_exp_f32 v64, v64
    v_exp_f32 v65, v65
    s_waitcnt lgkmcnt(0)
    v_mfma_f32_32x32x16_bf16 v[88:103], v[120:123], v[136:139], v[88:103]
    v_exp_f32 v66, v66
    v_exp_f32 v67, v67
    v_exp_f32 v68, v68
    v_exp_f32 v69, v69
    v_mfma_f32_16x16x32_bf16 v[44:47], v[40:43], v[136:139], v[44:47]
    v_exp_f32 v70, v70
    v_exp_f32 v71, v71
    v_cvt_pk_bf16_f32 v140, v64, v65
    v_cvt_pk_bf16_f32 v141, v66, v67
    v_cvt_pk_bf16_f32 v142, v68, v69
    v_cvt_pk_bf16_f32 v143, v70, v71
a0_6_e0:
    s_cmp_eq_u32 s75, 0
    s_nop 0
    v_mfma_f32_16x16x32_bf16 v[44:47], v[40:43], v[140:143], v[44:47]
    v_mfma_f32_32x32x16_bf16 v[88:103], v[124:127], v[140:143], v[88:103]
    s_cbranch_scc1 a0_6_mid
    s_branch a0_6_fin
a0_6_none:
    s_add_u32 s96, s25, 0
    s_and_b32 s96, s96, 15
    s_lshl_b32 s96, s96, 17
    s_add_u32 m0, s101, 0
    s_nop 0
    buffer_load_dwordx4 v243, s[8:11], s96 offen lds
    s_barrier
    s_add_u32 s96, s25, 12
    s_and_b32 s96, s96, 15
    s_lshl_b32 s96, s96, 17
    s_add_u32 m0, s101, 49152
    s_nop 0
    buffer_load_dwordx4 v243, s[8:11], s96 offen lds
    s_add_u32 s96, s25, 13
    s_and_b32 s96, s96, 15
    s_lshl_b32 s96, s96, 17
    s_add_u32 m0, s101, 53248
    s_nop 0
    buffer_load_dwordx4 v243, s[8:11], s96 offen lds
    s_add_u32 s96, s25, 14
    s_and_b32 s96, s96, 15
    s_lshl_b32 s96, s96, 17
    s_add_u32 m0, s101, 57344
    s_nop 0
    buffer_load_dwordx4 v243, s[8:11], s96 offen lds
    s_add_u32 s96, s25, 15
    s_and_b32 s96, s96, 15
    s_lshl_b32 s96, s96, 17
    s_add_u32 m0, s101, 61440
    s_nop 0
    buffer_load_dwordx4 v243, s[8:11], s96 offen lds
a0_6_fin:
    s_lshl_b32 s36, s76, 16
    s_add_u32 s36, s36, 0x800000
    s_lshl_b32 s33, s25, 11
    s_add_u32 s33, s33, s36
    s_lshl_b32 s30, s24, 9
    s_and_b32 s31, s76, 3
    s_lshl_b32 s31, s31, 6
    s_add_u32 s30, s30, s31
    s_add_u32 s30, s30, s26
    s_add_u32 s30, s30, 0xdd2000
    s_lshl_b32 s31, s25, 2
    s_add_u32 s31, s31, s30
    v_cmp_ngt_f32 vcc, 0x5d800000, v44
    v_rcp_f32 v22, v44
    s_cbranch_vccnz att_exact0
att_ret0:
    s_nop 3
    v_pk_mul_f32 v[88:89], v[88:89], v[22:23] op_sel_hi:[1,0]
    v_pk_mul_f32 v[90:91], v[90:91], v[22:23] op_sel_hi:[1,0]
    v_pk_mul_f32 v[92:93], v[92:93], v[22:23] op_sel_hi:[1,0]
    v_pk_mul_f32 v[94:95], v[94:95], v[22:23] op_sel_hi:[1,0]
    v_pk_mul_f32 v[96:97], v[96:97], v[22:23] op_sel_hi:[1,0]
    v_pk_mul_f32 v[98:99], v[98:99], v[22:23] op_sel_hi:[1,0]
    v_pk_mul_f32 v[100:101], v[100:101], v[22:23] op_sel_hi:[1,0]
    v_pk_mul_f32 v[102:103], v[102:103], v[22:23] op_sel_hi:[1,0]
    v_cvt_pk_bf16_f32 v88, v88, v89
    v_cvt_pk_bf16_f32 v89, v90, v91
    v_cvt_pk_bf16_f32 v90, v92, v93
    v_cvt_pk_bf16_f32 v91, v94, v95
    v_cvt_pk_bf16_f32 v92, v96, v97
    v_cvt_pk_bf16_f32 v93, v98, v99
    v_cvt_pk_bf16_f32 v94, v100, v101
    v_cvt_pk_bf16_f32 v95, v102, v103
    s_cmp_lg_u32 s77, 0
    s_cbranch_scc1 lc_14
    buffer_store_dwordx4 v[88:91], v253, s[20:23], s33 offen sc1
    buffer_store_dwordx4 v[92:95], v253, s[20:23], s33 offen offset:1024 sc1
    s_branch lc_15
lc_14:
    buffer_store_dwordx4 v[88:91], v253, s[20:23], s33 offen
    buffer_store_dwordx4 v[92:95], v253, s[20:23], s33 offen offset:1024
lc_15:
    v_bfe_u32 v33, v252, 2, 2
    v_lshrrev_b32 v32, 5, v252
    v_lshl_add_u32 v34, v32, 3, v33
    v_lshlrev_b32 v34, 7, v34
    v_lshrrev_b32 v33, 1, v33
    v_lshl_add_u32 v34, v33, 6, v34
    v_bfe_u32 v33, v252, 4, 1
    v_lshl_add_u32 v34, v33, 5, v34
    v_and_b32 v33, 3, v252
    v_lshl_add_u32 v56, v33, 3, v34
    v_xor_b32 v57, 64, v56
    v_add_u32 v58, 0x10000, v56
    v_add_u32 v59, 0x10000, v57
    v_and_b32 v60, 15, v252
    v_lshlrev_b32 v60, 2, v60
    s_waitcnt vmcnt(2)
    s_and_b32 s35, s99, 3
    s_cmp_lg_u32 s35, 0
    s_cbranch_scc1 sk_16
    s_barrier
sk_16:
    v_lshlrev_b32 v0, 16, v208
    v_and_b32 v1, 0xffff0000, v208
    v_lshlrev_b32 v2, 16, v209
    v_and_b32 v3, 0xffff0000, v209
    v_lshlrev_b32 v4, 16, v210
    v_and_b32 v5, 0xffff0000, v210
    v_lshlrev_b32 v6, 16, v211
    v_and_b32 v7, 0xffff0000, v211
    v_lshlrev_b32 v8, 16, v212
    v_and_b32 v9, 0xffff0000, v212
    v_lshlrev_b32 v10, 16, v213
    v_and_b32 v11, 0xffff0000, v213
    v_lshlrev_b32 v12, 16, v214
    v_and_b32 v13, 0xffff0000, v214
    v_lshlrev_b32 v14, 16, v215
    v_and_b32 v15, 0xffff0000, v215
    v_lshlrev_b32 v16, 16, v216
    v_and_b32 v17, 0xffff0000, v216
    v_lshlrev_b32 v18, 16, v217
    v_and_b32 v19, 0xffff0000, v217
    v_lshlrev_b32 v20, 16, v218
    v_and_b32 v21, 0xffff0000, v218
    v_lshlrev_b32 v22, 16, v219
    v_and_b32 v23, 0xffff0000, v219
    v_lshlrev_b32 v24, 16, v220
    v_and_b32 v25, 0xffff0000, v220
    v_lshlrev_b32 v26, 16, v221
    v_and_b32 v27, 0xffff0000, v221
    v_lshlrev_b32 v28, 16, v222
    v_and_b32 v29, 0xffff0000, v222
    v_lshlrev_b32 v30, 16, v223
    v_and_b32 v31, 0xffff0000, v223
    v_pk_fma_f32 v[0:1], v[0:1], v[240:241], v[240:241] op_sel:[0,0,1] op_sel_hi:[1,0,1]
    v_pk_fma_f32 v[2:3], v[2:3], v[240:241], v[240:241] op_sel:[0,0,1] op_sel_hi:[1,0,1]
    v_pk_fma_f32 v[4:5], v[4:5], v[240:241], v[240:241] op_sel:[0,0,1] op_sel_hi:[1,0,1]
    v_pk_fma_f32 v[6:7], v[6:7], v[240:241], v[240:241] op_sel:[0,0,1] op_sel_hi:[1,0,1]
    v_pk_fma_f32 v[8:9], v[8:9], v[240:241], v[240:241] op_sel:[0,0,1] op_sel_hi:[1,0,1]
    v_pk_fma_f32 v[10:11], v[10:11], v[240:241], v[240:241] op_sel:[0,0,1] op_sel_hi:[1,0,1]
    v_pk_fma_f32 v[12:13], v[12:13], v[240:241], v[240:241] op_sel:[0,0,1] op_sel_hi:[1,0,1]
    v_pk_fma_f32 v[14:15], v[14:15], v[240:241], v[240:241] op_sel:[0,0,1] op_sel_hi:[1,0,1]
    v_pk_fma_f32 v[16:17], v[16:17], v[240:241], v[240:241] op_sel:[0,0,1] op_sel_hi:[1,0,1]
    v_pk_fma_f32 v[18:19], v[18:19], v[240:241], v[240:241] op_sel:[0,0,1] op_sel_hi:[1,0,1]
    v_pk_fma_f32 v[20:21], v[20:21], v[240:241], v[240:241] op_sel:[0,0,1] op_sel_hi:[1,0,1]
    v_pk_fma_f32 v[22:23], v[22:23], v[240:241], v[240:241] op_sel:[0,0,1] op_sel_hi:[1,0,1]
    v_pk_fma_f32 v[24:25], v[24:25], v[240:241], v[240:241] op_sel:[0,0,1] op_sel_hi:[1,0,1]
    v_pk_fma_f32 v[26:27], v[26:27], v[240:241], v[240:241] op_sel:[0,0,1] op_sel_hi:[1,0,1]
    v_pk_fma_f32 v[28:29], v[28:29], v[240:241], v[240:241] op_sel:[0,0,1] op_sel_hi:[1,0,1]
    v_pk_fma_f32 v[30:31], v[30:31], v[240:241], v[240:241] op_sel:[0,0,1] op_sel_hi:[1,0,1]
    v_mov_b32 v154, s88
    s_mov_b64 exec, 1
    s_waitcnt vmcnt(0)
    s_cmp_lg_u32 s77, 0
    s_cbranch_scc1 lc_17
    buffer_store_dword v154, v253, s[20:23], s31 offen sc1
    s_branch lc_18
lc_17:
    buffer_store_dword v154, v253, s[20:23], s31 offen
lc_18:
    s_mov_b64 exec, -1
    s_cmp_eq_u32 s35, 0
    s_cbranch_scc1 sk_19
    s_barrier
sk_19:
    s_add_u32 s96, s25, 0
    s_and_b32 s96, s96, 15
    s_lshl_b32 s96, s96, 17
    s_add_u32 s96, s96, 65536
    s_add_u32 m0, s101, 65536
    s_nop 0
    buffer_load_dwordx4 v243, s[8:11], s96 offen lds
    s_add_u32 s96, s25, 1
    s_and_b32 s96, s96, 15
    s_lshl_b32 s96, s96, 17
    s_add_u32 s96, s96, 65536
    s_add_u32 m0, s101, 69632
    s_nop 0
    buffer_load_dwordx4 v243, s[8:11], s96 offen lds
    s_add_u32 s96, s25, 2
    s_and_b32 s96, s96, 15
    s_lshl_b32 s96, s96, 17
    s_add_u32 s96, s96, 65536
    s_add_u32 m0, s101, 73728
    s_nop 0
    buffer_load_dwordx4 v243, s[8:11], s96 offen lds
    s_add_u32 s96, s25, 3
    s_and_b32 s96, s96, 15
    s_lshl_b32 s96, s96, 17
    s_add_u32 s96, s96, 65536
    s_add_u32 m0, s101, 77824
    s_nop 0
    buffer_load_dwordx4 v243, s[8:11], s96 offen lds
    s_add_u32 s96, s25, 4
    s_and_b32 s96, s96, 15
    s_lshl_b32 s96, s96, 17
    s_add_u32 s96, s96, 65536
    s_add_u32 m0, s101, 81920
    s_nop 0
    buffer_load_dwordx4 v243, s[8:11], s96 offen lds
    s_add_u32 s96, s25, 5
    s_and_b32 s96, s96, 15
    s_lshl_b32 s96, s96, 17
    s_add_u32 s96, s96, 65536
    s_add_u32 m0, s101, 86016
    s_nop 0
    buffer_load_dwordx4 v243, s[8:11], s96 offen lds
    s_add_u32 s96, s25, 6
    s_and_b32 s96, s96, 15
    s_lshl_b32 s96, s96, 17
    s_add_u32 s96, s96, 65536
    s_add_u32 m0, s101, 90112
    s_nop 0
    buffer_load_dwordx4 v243, s[8:11], s96 offen lds
    s_add_u32 s96, s25, 7
    s_and_b32 s96, s96, 15
    s_lshl_b32 s96, s96, 17
    s_add_u32 s96, s96, 65536
    s_add_u32 m0, s101, 94208
    s_nop 0
    buffer_load_dwordx4 v243, s[8:11], s96 offen lds
    s_add_u32 s96, s25, 8
    s_and_b32 s96, s96, 15
    s_lshl_b32 s96, s96, 17
    s_add_u32 s96, s96, 65536
    s_add_u32 m0, s101, 98304
    s_nop 0
    buffer_load_dwordx4 v243, s[8:11], s96 offen lds
    s_add_u32 s96, s25, 9
    s_and_b32 s96, s96, 15
    s_lshl_b32 s96, s96, 17
    s_add_u32 s96, s96, 65536
    s_add_u32 m0, s101, 102400
    s_nop 0
    buffer_load_dwordx4 v243, s[8:11], s96 offen lds
    s_add_u32 s96, s25, 10
    s_and_b32 s96, s96, 15
    s_lshl_b32 s96, s96, 17
    s_add_u32 s96, s96, 65536
    s_add_u32 m0, s101, 106496
    s_nop 0
    buffer_load_dwordx4 v243, s[8:11], s96 offen lds
    s_add_u32 s96, s25, 11
    s_and_b32 s96, s96, 15
    s_lshl_b32 s96, s96, 17
    s_add_u32 s96, s96, 65536
    s_add_u32 m0, s101, 110592
    s_nop 0
    buffer_load_dwordx4 v243, s[8:11], s96 offen lds
    v_bfe_u32 v100, v252, 4, 1
    v_lshlrev_b32 v100, 11, v100
    v_lshrrev_b32 v101, 5, v252
    v_lshl_add_u32 v100, v101, 8, v100
    v_and_b32 v101, 15, v252
    v_lshl_add_u32 v100, v101, 4, v100
    s_lshl_b32 s34, s28, 12
    s_add_u32 s34, s34, 147456
    v_add_u32 v101, s34, v100
    s_lshl_b32 s37, s25, 11
    ds_read_b64_tr_b16 v[32:33], v56 offset:0
    ds_read_b64_tr_b16 v[34:35], v56 offset:512
    ds_read_b64_tr_b16 v[36:37], v57 offset:0
    ds_read_b64_tr_b16 v[38:39], v57 offset:512
    ds_read_b64_tr_b16 v[40:41], v56 offset:2048
    ds_read_b64_tr_b16 v[42:43], v56 offset:2560
    ds_read_b64_tr_b16 v[44:45], v57 offset:2048
    ds_read_b64_tr_b16 v[46:47], v57 offset:2560
    s_mov_b32 s78, s27
pl_20:
    buffer_load_dword v61, v60, s[20:23], s30 offen offset:0 sc1
    s_waitcnt vmcnt(0)
pc_21:
    v_cmp_ne_u32 vcc, s88, v61
    s_cbranch_vccz pd_22
    s_sub_u32 s78, s78, 1
    s_cmp_lg_u32 s78, 0
    s_cbranch_scc1 pl_20
    s_mov_b32 s27, 1
pd_22:
    s_add_u32 s38, s36, s37
    buffer_load_dwordx4 v[104:107], v253, s[20:23], s38 offen offset:0 sc1
    s_add_u32 s37, s37, 2048
    s_and_b32 s37, s37, 0x7800
    buffer_load_dwordx4 v[108:111], v253, s[20:23], s38 offen offset:1024 sc1
    s_add_u32 s38, s36, s37
    buffer_load_dwordx4 v[112:115], v253, s[20:23], s38 offen offset:0 sc1
    s_add_u32 s37, s37, 2048
    s_and_b32 s37, s37, 0x7800
    buffer_load_dwordx4 v[116:119], v253, s[20:23], s38 offen offset:1024 sc1
    s_add_u32 s38, s36, s37
    buffer_load_dwordx4 v[120:123], v253, s[20:23], s38 offen offset:0 sc1
    s_add_u32 s37, s37, 2048
    s_and_b32 s37, s37, 0x7800
    buffer_load_dwordx4 v[124:127], v253, s[20:23], s38 offen offset:1024 sc1
    s_add_u32 s38, s36, s37
    buffer_load_dwordx4 v[128:131], v253, s[20:23], s38 offen offset:0 sc1
    s_add_u32 s37, s37, 2048
    s_and_b32 s37, s37, 0x7800
    buffer_load_dwordx4 v[132:135], v253, s[20:23], s38 offen offset:1024 sc1
    s_waitcnt vmcnt(7) lgkmcnt(4)
    v_mfma_f32_32x32x16_bf16 v[0:15], v[32:35], v[104:107], v[0:15]
    s_add_u32 s38, s36, s37
    buffer_load_dwordx4 v[136:139], v253, s[20:23], s38 offen offset:0 sc1
    ds_read_b64_tr_b16 v[48:49], v56 offset:4096
    ds_read_b64_tr_b16 v[50:51], v56 offset:4608
    v_mfma_f32_32x32x16_bf16 v[16:31], v[36:39], v[104:107], v[16:31]
    ds_read_b64_tr_b16 v[52:53], v57 offset:4096
    ds_read_b64_tr_b16 v[54:55], v57 offset:4608
    s_waitcnt vmcnt(7) lgkmcnt(4)
    v_mfma_f32_32x32x16_bf16 v[0:15], v[40:43], v[108:111], v[0:15]
    s_add_u32 s37, s37, 2048
    s_and_b32 s37, s37, 0x7800
    buffer_load_dwordx4 v[104:107], v253, s[20:23], s38 offen offset:1024 sc1
    ds_read_b64_tr_b16 v[32:33], v56 offset:6144
    ds_read_b64_tr_b16 v[34:35], v56 offset:6656
    v_mfma_f32_32x32x16_bf16 v[16:31], v[44:47], v[108:111], v[16:31]
    ds_read_b64_tr_b16 v[36:37], v57 offset:6144
    ds_read_b64_tr_b16 v[38:39], v57 offset:6656
    s_waitcnt vmcnt(7) lgkmcnt(4)
    v_mfma_f32_32x32x16_bf16 v[0:15], v[48:51], v[112:115], v[0:15]
    s_add_u32 s38, s36, s37
    buffer_load_dwordx4 v[108:111], v253, s[20:23], s38 offen offset:0 sc1
    ds_read_b64_tr_b16 v[40:41], v56 offset:8192
    ds_read_b64_tr_b16 v[42:43], v56 offset:8704
    v_mfma_f32_32x32x16_bf16 v[16:31], v[52:55], v[112:115], v[16:31]
    ds_read_b64_tr_b16 v[44:45], v57 offset:8192
    ds_read_b64_tr_b16 v[46:47], v57 offset:8704
    s_waitcnt vmcnt(7) lgkmcnt(4)
    v_mfma_f32_32x32x16_bf16 v[0:15], v[32:35], v[116:119], v[0:15]
    s_add_u32 s37, s37, 2048
    s_and_b32 s37, s37, 0x7800
    buffer_load_dwordx4 v[112:115], v253, s[20:23], s38 offen offset:1024 sc1
    ds_read_b64_tr_b16 v[48:49], v56 offset:10240
    ds_read_b64_tr_b16 v[50:51], v56 offset:10752
    v_mfma_f32_32x32x16_bf16 v[16:31], v[36:39], v[116:119], v[16:31]
    ds_read_b64_tr_b16 v[52:53], v57 offset:10240
    ds_read_b64_tr_b16 v[54:55], v57 offset:10752
    s_waitcnt vmcnt(7) lgkmcnt(4)
    v_mfma_f32_32x32x16_bf16 v[0:15], v[40:43], v[120:123], v[0:15]
    s_add_u32 s38, s36, s37
    buffer_load_dwordx4 v[116:119], v253, s[20:23], s38 offen offset:0 sc1
    ds_read_b64_tr_b16 v[32:33], v56 offset:12288
    ds_read_b64_tr_b16 v[34:35], v56 offset:12800
    v_mfma_f32_32x32x16_bf16 v[16:31], v[44:47], v[120:123], v[16:31]
    ds_read_b64_tr_b16 v[36:37], v57 offset:12288
    ds_read_b64_tr_b16 v[38:39], v57 offset:12800
    s_waitcnt vmcnt(7) lgkmcnt(4)
    v_mfma_f32_32x32x16_bf16 v[0:15], v[48:51], v[124:127], v[0:15]
    s_add_u32 s37, s37, 2048
    s_and_b32 s37, s37, 0x7800
    buffer_load_dwordx4 v[120:123], v253, s[20:23], s38 offen offset:1024 sc1
    ds_read_b64_tr_b16 v[40:41], v56 offset:14336
    ds_read_b64_tr_b16 v[42:43], v56 offset:14848
    v_mfma_f32_32x32x16_bf16 v[16:31], v[52:55], v[124:127], v[16:31]
    ds_read_b64_tr_b16 v[44:45], v57 offset:14336
    ds_read_b64_tr_b16 v[46:47], v57 offset:14848
    s_waitcnt vmcnt(7) lgkmcnt(4)
    v_mfma_f32_32x32x16_bf16 v[0:15], v[32:35], v[128:131], v[0:15]
    s_add_u32 s38, s36, s37
    buffer_load_dwordx4 v[124:127], v253, s[20:23], s38 offen offset:0 sc1
    ds_read_b64_tr_b16 v[48:49], v56 offset:16384
    ds_read_b64_tr_b16 v[50:51], v56 offset:16896
    v_mfma_f32_32x32x16_bf16 v[16:31], v[36:39], v[128:131], v[16:31]
    ds_read_b64_tr_b16 v[52:53], v57 offset:16384
    ds_read_b64_tr_b16 v[54:55], v57 offset:16896
    s_waitcnt vmcnt(7) lgkmcnt(4)
    v_mfma_f32_32x32x16_bf16 v[0:15], v[40:43], v[132:135], v[0:15]
    s_add_u32 s37, s37, 2048
    s_and_b32 s37, s37, 0x7800
    buffer_load_dwordx4 v[128:131], v253, s[20:23], s38 offen offset:1024 sc1
    ds_read_b64_tr_b16 v[32:33], v56 offset:18432
    ds_read_b64_tr_b16 v[34:35], v56 offset:18944
    v_mfma_f32_32x32x16_bf16 v[16:31], v[44:47], v[132:135], v[16:31]
    ds_read_b64_tr_b16 v[36:37], v57 offset:18432
    ds_read_b64_tr_b16 v[38:39], v57 offset:18944
    s_waitcnt vmcnt(7) lgkmcnt(4)
    v_mfma_f32_32x32x16_bf16 v[0:15], v[48:51], v[136:139], v[0:15]
    s_add_u32 s38, s36, s37
    buffer_load_dwordx4 v[132:135], v253, s[20:23], s38 offen offset:0 sc1
    ds_read_b64_tr_b16 v[40:41], v56 offset:20480
    ds_read_b64_tr_b16 v[42:43], v56 offset:20992
    v_mfma_f32_32x32x16_bf16 v[16:31], v[52:55], v[136:139], v[16:31]
    ds_read_b64_tr_b16 v[44:45], v57 offset:20480
    ds_read_b64_tr_b16 v[46:47], v57 offset:20992
    s_waitcnt vmcnt(7) lgkmcnt(4)
    v_mfma_f32_32x32x16_bf16 v[0:15], v[32:35], v[104:107], v[0:15]
    s_add_u32 s37, s37, 2048
    s_and_b32 s37, s37, 0x7800
    buffer_load_dwordx4 v[136:139], v253, s[20:23], s38 offen offset:1024 sc1
    ds_read_b64_tr_b16 v[48:49], v56 offset:22528
    ds_read_b64_tr_b16 v[50:51], v56 offset:23040
    v_mfma_f32_32x32x16_bf16 v[16:31], v[36:39], v[104:107], v[16:31]
    ds_read_b64_tr_b16 v[52:53], v57 offset:22528
    ds_read_b64_tr_b16 v[54:55], v57 offset:23040
    s_waitcnt vmcnt(7) lgkmcnt(4)
    v_mfma_f32_32x32x16_bf16 v[0:15], v[40:43], v[108:111], v[0:15]
    s_add_u32 s38, s36, s37
    buffer_load_dwordx4 v[104:107], v253, s[20:23], s38 offen offset:0 sc1
    ds_read_b64_tr_b16 v[32:33], v56 offset:24576
    ds_read_b64_tr_b16 v[34:35], v56 offset:25088
    v_mfma_f32_32x32x16_bf16 v[16:31], v[44:47], v[108:111], v[16:31]
    ds_read_b64_tr_b16 v[36:37], v57 offset:24576
    ds_read_b64_tr_b16 v[38:39], v57 offset:25088
    s_waitcnt vmcnt(7) lgkmcnt(4)
    v_mfma_f32_32x32x16_bf16 v[0:15], v[48:51], v[112:115], v[0:15]
    s_add_u32 s37, s37, 2048
    s_and_b32 s37, s37, 0x7800
    buffer_load_dwordx4 v[108:111], v253, s[20:23], s38 offen offset:1024 sc1
    ds_read_b64_tr_b16 v[40:41], v56 offset:26624
    ds_read_b64_tr_b16 v[42:43], v56 offset:27136
    v_mfma_f32_32x32x16_bf16 v[16:31], v[52:55], v[112:115], v[16:31]
    ds_read_b64_tr_b16 v[44:45], v57 offset:26624
    ds_read_b64_tr_b16 v[46:47], v57 offset:27136
    s_waitcnt vmcnt(7) lgkmcnt(4)
    v_mfma_f32_32x32x16_bf16 v[0:15], v[32:35], v[116:119], v[0:15]
    s_add_u32 s38, s36, s37
    buffer_load_dwordx4 v[112:115], v253, s[20:23], s38 offen offset:0 sc1
    ds_read_b64_tr_b16 v[48:49], v56 offset:28672
    ds_read_b64_tr_b16 v[50:51], v56 offset:29184
    v_mfma_f32_32x32x16_bf16 v[16:31], v[36:39], v[116:119], v[16:31]
    ds_read_b64_tr_b16 v[52:53], v57 offset:28672
    ds_read_b64_tr_b16 v[54:55], v57 offset:29184
    s_waitcnt vmcnt(7) lgkmcnt(4)
    v_mfma_f32_32x32x16_bf16 v[0:15], v[40:43], v[120:123], v[0:15]
    s_add_u32 s37, s37, 2048
    s_and_b32 s37, s37, 0x7800
    buffer_load_dwordx4 v[116:119], v253, s[20:23], s38 offen offset:1024 sc1
    ds_read_b64_tr_b16 v[32:33], v56 offset:30720
    ds_read_b64_tr_b16 v[34:35], v56 offset:31232
    v_mfma_f32_32x32x16_bf16 v[16:31], v[44:47], v[120:123], v[16:31]
    ds_read_b64_tr_b16 v[36:37], v57 offset:30720
    ds_read_b64_tr_b16 v[38:39], v57 offset:31232
    s_waitcnt vmcnt(7) lgkmcnt(4)
    v_mfma_f32_32x32x16_bf16 v[0:15], v[48:51], v[124:127], v[0:15]
    s_add_u32 s38, s36, s37
    buffer_load_dwordx4 v[120:123], v253, s[20:23], s38 offen offset:0 sc1
    ds_read_b64_tr_b16 v[40:41], v56 offset:32768
    ds_read_b64_tr_b16 v[42:43], v56 offset:33280
    v_mfma_f32_32x32x16_bf16 v[16:31], v[52:55], v[124:127], v[16:31]
    ds_read_b64_tr_b16 v[44:45], v57 offset:32768
    ds_read_b64_tr_b16 v[46:47], v57 offset:33280
    s_waitcnt vmcnt(7) lgkmcnt(4)
    v_mfma_f32_32x32x16_bf16 v[0:15], v[32:35], v[128:131], v[0:15]
    s_add_u32 s37, s37, 2048
    s_and_b32 s37, s37, 0x7800
    buffer_load_dwordx4 v[124:127], v253, s[20:23], s38 offen offset:1024 sc1
    ds_read_b64_tr_b16 v[48:49], v56 offset:34816
    ds_read_b64_tr_b16 v[50:51], v56 offset:35328
    v_mfma_f32_32x32x16_bf16 v[16:31], v[36:39], v[128:131], v[16:31]
    ds_read_b64_tr_b16 v[52:53], v57 offset:34816
    ds_read_b64_tr_b16 v[54:55], v57 offset:35328
    s_waitcnt vmcnt(7) lgkmcnt(4)
    v_mfma_f32_32x32x16_bf16 v[0:15], v[40:43], v[132:135], v[0:15]
    s_add_u32 s38, s36, s37
    buffer_load_dwordx4 v[128:131], v253, s[20:23], s38 offen offset:0 sc1
    ds_read_b64_tr_b16 v[32:33], v56 offset:36864
    ds_read_b64_tr_b16 v[34:35], v56 offset:37376
    v_mfma_f32_32x32x16_bf16 v[16:31], v[44:47], v[132:135], v[16:31]
    ds_read_b64_tr_b16 v[36:37], v57 offset:36864
    ds_read_b64_tr_b16 v[38:39], v57 offset:37376
    s_waitcnt vmcnt(7) lgkmcnt(4)
    v_mfma_f32_32x32x16_bf16 v[0:15], v[48:51], v[136:139], v[0:15]
    s_add_u32 s37, s37, 2048
    s_and_b32 s37, s37, 0x7800
    buffer_load_dwordx4 v[132:135], v253, s[20:23], s38 offen offset:1024 sc1
    ds_read_b64_tr_b16 v[40:41], v56 offset:38912
    ds_read_b64_tr_b16 v[42:43], v56 offset:39424
    v_mfma_f32_32x32x16_bf16 v[16:31], v[52:55], v[136:139], v[16:31]
    ds_read_b64_tr_b16 v[44:45], v57 offset:38912
    ds_read_b64_tr_b16 v[46:47], v57 offset:39424
    s_waitcnt vmcnt(7) lgkmcnt(4)
    v_mfma_f32_32x32x16_bf16 v[0:15], v[32:35], v[104:107], v[0:15]
    s_add_u32 s38, s36, s37
    buffer_load_dwordx4 v[136:139], v253, s[20:23], s38 offen offset:0 sc1
    ds_read_b64_tr_b16 v[48:49], v56 offset:40960
    ds_read_b64_tr_b16 v[50:51], v56 offset:41472
    v_mfma_f32_32x32x16_bf16 v[16:31], v[36:39], v[104:107], v[16:31]
    ds_read_b64_tr_b16 v[52:53], v57 offset:40960
    ds_read_b64_tr_b16 v[54:55], v57 offset:41472
    s_waitcnt vmcnt(7) lgkmcnt(4)
    v_mfma_f32_32x32x16_bf16 v[0:15], v[40:43], v[108:111], v[0:15]
    s_add_u32 s37, s37, 2048
    s_and_b32 s37, s37, 0x7800
    buffer_load_dwordx4 v[104:107], v253, s[20:23], s38 offen offset:1024 sc1
    ds_read_b64_tr_b16 v[32:33], v56 offset:43008
    ds_read_b64_tr_b16 v[34:35], v56 offset:43520
    v_mfma_f32_32x32x16_bf16 v[16:31], v[44:47], v[108:111], v[16:31]
    ds_read_b64_tr_b16 v[36:37], v57 offset:43008
    ds_read_b64_tr_b16 v[38:39], v57 offset:43520
    s_waitcnt vmcnt(7) lgkmcnt(4)
    v_mfma_f32_32x32x16_bf16 v[0:15], v[48:51], v[112:115], v[0:15]
    buffer_load_dword v61, v60, s[20:23], s30 offen offset:256 sc1
    s_add_u32 s38, s36, s37
    buffer_load_dwordx4 v[108:111], v253, s[20:23], s38 offen offset:0 sc1
    ds_read_b64_tr_b16 v[40:41], v56 offset:45056
    ds_read_b64_tr_b16 v[42:43], v56 offset:45568
    v_mfma_f32_32x32x16_bf16 v[16:31], v[52:55], v[112:115], v[16:31]
    ds_read_b64_tr_b16 v[44:45], v57 offset:45056
    ds_read_b64_tr_b16 v[46:47], v57 offset:45568
    s_waitcnt vmcnt(8) lgkmcnt(4)
    v_mfma_f32_32x32x16_bf16 v[0:15], v[32:35], v[116:119], v[0:15]
    s_add_u32 s37, s37, 2048
    s_and_b32 s37, s37, 0x7800
    buffer_load_dwordx4 v[112:115], v253, s[20:23], s38 offen offset:1024 sc1
    ds_read_b64_tr_b16 v[48:49], v56 offset:47104
    ds_read_b64_tr_b16 v[50:51], v56 offset:47616
    v_mfma_f32_32x32x16_bf16 v[16:31], v[36:39], v[116:119], v[16:31]
    ds_read_b64_tr_b16 v[52:53], v57 offset:47104
    ds_read_b64_tr_b16 v[54:55], v57 offset:47616
    s_waitcnt vmcnt(8) lgkmcnt(4)
    v_mfma_f32_32x32x16_bf16 v[0:15], v[40:43], v[120:123], v[0:15]
    s_add_u32 s38, s36, s37
    buffer_load_dwordx4 v[116:119], v253, s[20:23], s38 offen offset:0 sc1
    ds_read_b64_tr_b16 v[32:33], v56 offset:49152
    ds_read_b64_tr_b16 v[34:35], v56 offset:49664
    v_mfma_f32_32x32x16_bf16 v[16:31], v[44:47], v[120:123], v[16:31]
    ds_read_b64_tr_b16 v[36:37], v57 offset:49152
    ds_read_b64_tr_b16 v[38:39], v57 offset:49664
    s_waitcnt vmcnt(8) lgkmcnt(4)
    v_mfma_f32_32x32x16_bf16 v[0:15], v[48:51], v[124:127], v[0:15]
    s_add_u32 s37, s37, 2048
    s_and_b32 s37, s37, 0x7800
    buffer_load_dwordx4 v[120:123], v253, s[20:23], s38 offen offset:1024 sc1
    ds_read_b64_tr_b16 v[40:41], v56 offset:51200
    ds_read_b64_tr_b16 v[42:43], v56 offset:51712
    v_mfma_f32_32x32x16_bf16 v[16:31], v[52:55], v[124:127], v[16:31]
    ds_read_b64_tr_b16 v[44:45], v57 offset:51200
    ds_read_b64_tr_b16 v[46:47], v57 offset:51712
    s_waitcnt vmcnt(8) lgkmcnt(4)
    v_mfma_f32_32x32x16_bf16 v[0:15], v[32:35], v[128:131], v[0:15]
    s_mov_b32 s78, s27
    s_waitcnt vmcnt(4)
    s_branch pc_24
pl_23:
    buffer_load_dword v61, v60, s[20:23], s30 offen offset:256 sc1
    s_waitcnt vmcnt(0)
pc_24:
    v_cmp_ne_u32 vcc, s88, v61
    s_cbranch_vccz pd_25
    s_sub_u32 s78, s78, 1
    s_cmp_lg_u32 s78, 0
    s_cbranch_scc1 pl_23
    s_mov_b32 s27, 1
pd_25:
    s_add_u32 s36, s36, 32768
    s_add_u32 s38, s36, s37
    buffer_load_dwordx4 v[124:127], v253, s[20:23], s38 offen offset:0 sc1
    ds_read_b64_tr_b16 v[48:49], v56 offset:53248
    ds_read_b64_tr_b16 v[50:51], v56 offset:53760
    v_mfma_f32_32x32x16_bf16 v[16:31], v[36:39], v[128:131], v[16:31]
    ds_read_b64_tr_b16 v[52:53], v57 offset:53248
    ds_read_b64_tr_b16 v[54:55], v57 offset:53760
    s_waitcnt vmcnt(8) lgkmcnt(4)
    v_mfma_f32_32x32x16_bf16 v[0:15], v[40:43], v[132:135], v[0:15]
    s_add_u32 s37, s37, 2048
    s_and_b32 s37, s37, 0x7800
    buffer_load_dwordx4 v[128:131], v253, s[20:23], s38 offen offset:1024 sc1
    ds_read_b64_tr_b16 v[32:33], v56 offset:55296
    ds_read_b64_tr_b16 v[34:35], v56 offset:55808
    v_mfma_f32_32x32x16_bf16 v[16:31], v[44:47], v[132:135], v[16:31]
    ds_read_b64_tr_b16 v[36:37], v57 offset:55296
    ds_read_b64_tr_b16 v[38:39], v57 offset:55808
    s_waitcnt vmcnt(8) lgkmcnt(4)
    v_mfma_f32_32x32x16_bf16 v[0:15], v[48:51], v[136:139], v[0:15]
    s_add_u32 s38, s36, s37
    buffer_load_dwordx4 v[132:135], v253, s[20:23], s38 offen offset:0 sc1
    ds_read_b64_tr_b16 v[40:41], v56 offset:57344
    ds_read_b64_tr_b16 v[42:43], v56 offset:57856
    v_mfma_f32_32x32x16_bf16 v[16:31], v[52:55], v[136:139], v[16:31]
    ds_read_b64_tr_b16 v[44:45], v57 offset:57344
    ds_read_b64_tr_b16 v[46:47], v57 offset:57856
    s_waitcnt vmcnt(8) lgkmcnt(4)
    v_mfma_f32_32x32x16_bf16 v[0:15], v[32:35], v[104:107], v[0:15]
    s_add_u32 s37, s37, 2048
    s_and_b32 s37, s37, 0x7800
    buffer_load_dwordx4 v[136:139], v253, s[20:23], s38 offen offset:1024 sc1
    ds_read_b64_tr_b16 v[48:49], v56 offset:59392
    ds_read_b64_tr_b16 v[50:51], v56 offset:59904
    v_mfma_f32_32x32x16_bf16 v[16:31], v[36:39], v[104:107], v[16:31]
    ds_read_b64_tr_b16 v[52:53], v57 offset:59392
    ds_read_b64_tr_b16 v[54:55], v57 offset:59904
    s_waitcnt vmcnt(7) lgkmcnt(4)
    v_mfma_f32_32x32x16_bf16 v[0:15], v[40:43], v[108:111], v[0:15]
    s_add_u32 s38, s36, s37
    buffer_load_dwordx4 v[104:107], v253, s[20:23], s38 offen offset:0 sc1
    ds_read_b64_tr_b16 v[32:33], v56 offset:61440
    ds_read_b64_tr_b16 v[34:35], v56 offset:61952
    v_mfma_f32_32x32x16_bf16 v[16:31], v[44:47], v[108:111], v[16:31]
    ds_read_b64_tr_b16 v[36:37], v57 offset:61440
    ds_read_b64_tr_b16 v[38:39], v57 offset:61952
    s_waitcnt vmcnt(7) lgkmcnt(4)
    v_mfma_f32_32x32x16_bf16 v[0:15], v[48:51], v[112:115], v[0:15]
    s_add_u32 s37, s37, 2048
    s_and_b32 s37, s37, 0x7800
    buffer_load_dwordx4 v[108:111], v253, s[20:23], s38 offen offset:1024 sc1
    ds_read_b64_tr_b16 v[40:41], v56 offset:63488
    ds_read_b64_tr_b16 v[42:43], v56 offset:64000
    v_mfma_f32_32x32x16_bf16 v[16:31], v[52:55], v[112:115], v[16:31]
    ds_read_b64_tr_b16 v[44:45], v57 offset:63488
    ds_read_b64_tr_b16 v[46:47], v57 offset:64000
    s_barrier
    s_waitcnt vmcnt(7) lgkmcnt(4)
    v_mfma_f32_32x32x16_bf16 v[0:15], v[32:35], v[116:119], v[0:15]
    s_add_u32 s38, s36, s37
    buffer_load_dwordx4 v[112:115], v253, s[20:23], s38 offen offset:0 sc1
    ds_read_b64_tr_b16 v[48:49], v58 offset:0
    ds_read_b64_tr_b16 v[50:51], v58 offset:512
    v_mfma_f32_32x32x16_bf16 v[16:31], v[36:39], v[116:119], v[16:31]
    ds_read_b64_tr_b16 v[52:53], v59 offset:0
    ds_read_b64_tr_b16 v[54:55], v59 offset:512
    s_waitcnt vmcnt(7) lgkmcnt(4)
    v_mfma_f32_32x32x16_bf16 v[0:15], v[40:43], v[120:123], v[0:15]
    s_add_u32 s37, s37, 2048
    s_and_b32 s37, s37, 0x7800
    buffer_load_dwordx4 v[116:119], v253, s[20:23], s38 offen offset:1024 sc1
    ds_read_b64_tr_b16 v[32:33], v58 offset:2048
    ds_read_b64_tr_b16 v[34:35], v58 offset:2560
    v_mfma_f32_32x32x16_bf16 v[16:31], v[44:47], v[120:123], v[16:31]
    ds_read_b64_tr_b16 v[36:37], v59 offset:2048
    ds_read_b64_tr_b16 v[38:39], v59 offset:2560
    s_waitcnt vmcnt(7) lgkmcnt(4)
    v_mfma_f32_32x32x16_bf16 v[0:15], v[48:51], v[124:127], v[0:15]
    s_add_u32 s38, s36, s37
    buffer_load_dwordx4 v[120:123], v253, s[20:23], s38 offen offset:0 sc1
    ds_read_b64_tr_b16 v[40:41], v58 offset:4096
    ds_read_b64_tr_b16 v[42:43], v58 offset:4608
    v_mfma_f32_32x32x16_bf16 v[16:31], v[52:55], v[124:127], v[16:31]
    ds_read_b64_tr_b16 v[44:45], v59 offset:4096
    ds_read_b64_tr_b16 v[46:47], v59 offset:4608
    s_waitcnt vmcnt(7) lgkmcnt(4)
    v_mfma_f32_32x32x16_bf16 v[0:15], v[32:35], v[128:131], v[0:15]
    s_add_u32 s37, s37, 2048
    s_and_b32 s37, s37, 0x7800
    buffer_load_dwordx4 v[124:127], v253, s[20:23], s38 offen offset:1024 sc1
    ds_read_b64_tr_b16 v[48:49], v58 offset:6144
    ds_read_b64_tr_b16 v[50:51], v58 offset:6656
    v_mfma_f32_32x32x16_bf16 v[16:31], v[36:39], v[128:131], v[16:31]
    ds_read_b64_tr_b16 v[52:53], v59 offset:6144
    ds_read_b64_tr_b16 v[54:55], v59 offset:6656
    s_waitcnt vmcnt(7) lgkmcnt(4)
    v_mfma_f32_32x32x16_bf16 v[0:15], v[40:43], v[132:135], v[0:15]
    s_add_u32 s38, s36, s37
    buffer_load_dwordx4 v[128:131], v253, s[20:23], s38 offen offset:0 sc1
    ds_read_b64_tr_b16 v[32:33], v58 offset:8192
    ds_read_b64_tr_b16 v[34:35], v58 offset:8704
    v_mfma_f32_32x32x16_bf16 v[16:31], v[44:47], v[132:135], v[16:31]
    ds_read_b64_tr_b16 v[36:37], v59 offset:8192
    ds_read_b64_tr_b16 v[38:39], v59 offset:8704
    s_waitcnt vmcnt(7) lgkmcnt(4)
    v_mfma_f32_32x32x16_bf16 v[0:15], v[48:51], v[136:139], v[0:15]
    s_add_u32 s37, s37, 2048
    s_and_b32 s37, s37, 0x7800
    buffer_load_dwordx4 v[132:135], v253, s[20:23], s38 offen offset:1024 sc1
    ds_read_b64_tr_b16 v[40:41], v58 offset:10240
    ds_read_b64_tr_b16 v[42:43], v58 offset:10752
    v_mfma_f32_32x32x16_bf16 v[16:31], v[52:55], v[136:139], v[16:31]
    ds_read_b64_tr_b16 v[44:45], v59 offset:10240
    ds_read_b64_tr_b16 v[46:47], v59 offset:10752
    s_waitcnt vmcnt(7) lgkmcnt(4)
    v_mfma_f32_32x32x16_bf16 v[0:15], v[32:35], v[104:107], v[0:15]
    s_add_u32 s38, s36, s37
    buffer_load_dwordx4 v[136:139], v253, s[20:23], s38 offen offset:0 sc1
    ds_read_b64_tr_b16 v[48:49], v58 offset:12288
    ds_read_b64_tr_b16 v[50:51], v58 offset:12800
    v_mfma_f32_32x32x16_bf16 v[16:31], v[36:39], v[104:107], v[16:31]
    ds_read_b64_tr_b16 v[52:53], v59 offset:12288
    ds_read_b64_tr_b16 v[54:55], v59 offset:12800
    s_waitcnt vmcnt(7) lgkmcnt(4)
    v_mfma_f32_32x32x16_bf16 v[0:15], v[40:43], v[108:111], v[0:15]
    s_add_u32 s37, s37, 2048
    s_and_b32 s37, s37, 0x7800
    buffer_load_dwordx4 v[104:107], v253, s[20:23], s38 offen offset:1024 sc1
    ds_read_b64_tr_b16 v[32:33], v58 offset:14336
    ds_read_b64_tr_b16 v[34:35], v58 offset:14848
    v_mfma_f32_32x32x16_bf16 v[16:31], v[44:47], v[108:111], v[16:31]
    ds_read_b64_tr_b16 v[36:37], v59 offset:14336
    ds_read_b64_tr_b16 v[38:39], v59 offset:14848
    s_waitcnt vmcnt(7) lgkmcnt(4)
    v_mfma_f32_32x32x16_bf16 v[0:15], v[48:51], v[112:115], v[0:15]
    s_add_u32 s38, s36, s37
    buffer_load_dwordx4 v[108:111], v253, s[20:23], s38 offen offset:0 sc1
    ds_read_b64_tr_b16 v[40:41], v58 offset:16384
    ds_read_b64_tr_b16 v[42:43], v58 offset:16896
    v_mfma_f32_32x32x16_bf16 v[16:31], v[52:55], v[112:115], v[16:31]
    ds_read_b64_tr_b16 v[44:45], v59 offset:16384
    ds_read_b64_tr_b16 v[46:47], v59 offset:16896
    s_waitcnt vmcnt(7) lgkmcnt(4)
    v_mfma_f32_32x32x16_bf16 v[0:15], v[32:35], v[116:119], v[0:15]
    s_add_u32 s37, s37, 2048
    s_and_b32 s37, s37, 0x7800
    buffer_load_dwordx4 v[112:115], v253, s[20:23], s38 offen offset:1024 sc1
    ds_read_b64_tr_b16 v[48:49], v58 offset:18432
    ds_read_b64_tr_b16 v[50:51], v58 offset:18944
    v_mfma_f32_32x32x16_bf16 v[16:31], v[36:39], v[116:119], v[16:31]
    ds_read_b64_tr_b16 v[52:53], v59 offset:18432
    ds_read_b64_tr_b16 v[54:55], v59 offset:18944
    s_waitcnt vmcnt(7) lgkmcnt(4)
    v_mfma_f32_32x32x16_bf16 v[0:15], v[40:43], v[120:123], v[0:15]
    s_add_u32 s38, s36, s37
    buffer_load_dwordx4 v[116:119], v253, s[20:23], s38 offen offset:0 sc1
    ds_read_b64_tr_b16 v[32:33], v58 offset:20480
    ds_read_b64_tr_b16 v[34:35], v58 offset:20992
    v_mfma_f32_32x32x16_bf16 v[16:31], v[44:47], v[120:123], v[16:31]
    ds_read_b64_tr_b16 v[36:37], v59 offset:20480
    ds_read_b64_tr_b16 v[38:39], v59 offset:20992
    s_waitcnt vmcnt(7) lgkmcnt(4)
    v_mfma_f32_32x32x16_bf16 v[0:15], v[48:51], v[124:127], v[0:15]
    s_add_u32 s37, s37, 2048
    s_and_b32 s37, s37, 0x7800
    buffer_load_dwordx4 v[120:123], v253, s[20:23], s38 offen offset:1024 sc1
    ds_read_b64_tr_b16 v[40:41], v58 offset:22528
    ds_read_b64_tr_b16 v[42:43], v58 offset:23040
    v_mfma_f32_32x32x16_bf16 v[16:31], v[52:55], v[124:127], v[16:31]
    ds_read_b64_tr_b16 v[44:45], v59 offset:22528
    ds_read_b64_tr_b16 v[46:47], v59 offset:23040
    s_waitcnt vmcnt(7) lgkmcnt(4)
    v_mfma_f32_32x32x16_bf16 v[0:15], v[32:35], v[128:131], v[0:15]
    s_add_u32 s38, s36, s37
    buffer_load_dwordx4 v[124:127], v253, s[20:23], s38 offen offset:0 sc1
    ds_read_b64_tr_b16 v[48:49], v58 offset:24576
    ds_read_b64_tr_b16 v[50:51], v58 offset:25088
    v_mfma_f32_32x32x16_bf16 v[16:31], v[36:39], v[128:131], v[16:31]
    ds_read_b64_tr_b16 v[52:53], v59 offset:24576
    ds_read_b64_tr_b16 v[54:55], v59 offset:25088
    s_waitcnt vmcnt(7) lgkmcnt(4)
    v_mfma_f32_32x32x16_bf16 v[0:15], v[40:43], v[132:135], v[0:15]
    s_add_u32 s37, s37, 2048
    s_and_b32 s37, s37, 0x7800
    buffer_load_dwordx4 v[128:131], v253, s[20:23], s38 offen offset:1024 sc1
    ds_read_b64_tr_b16 v[32:33], v58 offset:26624
    ds_read_b64_tr_b16 v[34:35], v58 offset:27136
    v_mfma_f32_32x32x16_bf16 v[16:31], v[44:47], v[132:135], v[16:31]
    ds_read_b64_tr_b16 v[36:37], v59 offset:26624
    ds_read_b64_tr_b16 v[38:39], v59 offset:27136
    s_waitcnt vmcnt(7) lgkmcnt(4)
    v_mfma_f32_32x32x16_bf16 v[0:15], v[48:51], v[136:139], v[0:15]
    s_add_u32 s38, s36, s37
    buffer_load_dwordx4 v[132:135], v253, s[20:23], s38 offen offset:0 sc1
    ds_read_b64_tr_b16 v[40:41], v58 offset:28672
    ds_read_b64_tr_b16 v[42:43], v58 offset:29184
    v_mfma_f32_32x32x16_bf16 v[16:31], v[52:55], v[136:139], v[16:31]
    ds_read_b64_tr_b16 v[44:45], v59 offset:28672
    ds_read_b64_tr_b16 v[46:47], v59 offset:29184
    s_waitcnt vmcnt(7) lgkmcnt(4)
    v_mfma_f32_32x32x16_bf16 v[0:15], v[32:35], v[104:107], v[0:15]
    s_add_u32 s37, s37, 2048
    s_and_b32 s37, s37, 0x7800
    buffer_load_dwordx4 v[136:139], v253, s[20:23], s38 offen offset:1024 sc1
    ds_read_b64_tr_b16 v[48:49], v58 offset:30720
    ds_read_b64_tr_b16 v[50:51], v58 offset:31232
    v_mfma_f32_32x32x16_bf16 v[16:31], v[36:39], v[104:107], v[16:31]
    ds_read_b64_tr_b16 v[52:53], v59 offset:30720
    ds_read_b64_tr_b16 v[54:55], v59 offset:31232
    s_waitcnt vmcnt(7) lgkmcnt(4)
    v_mfma_f32_32x32x16_bf16 v[0:15], v[40:43], v[108:111], v[0:15]
    s_add_u32 s38, s36, s37
    buffer_load_dwordx4 v[104:107], v253, s[20:23], s38 offen offset:0 sc1
    ds_read_b64_tr_b16 v[32:33], v58 offset:32768
    ds_read_b64_tr_b16 v[34:35], v58 offset:33280
    v_mfma_f32_32x32x16_bf16 v[16:31], v[44:47], v[108:111], v[16:31]
    ds_read_b64_tr_b16 v[36:37], v59 offset:32768
    ds_read_b64_tr_b16 v[38:39], v59 offset:33280
    s_waitcnt vmcnt(7) lgkmcnt(4)
    v_mfma_f32_32x32x16_bf16 v[0:15], v[48:51], v[112:115], v[0:15]
    s_add_u32 s37, s37, 2048
    s_and_b32 s37, s37, 0x7800
    buffer_load_dwordx4 v[108:111], v253, s[20:23], s38 offen offset:1024 sc1
    ds_read_b64_tr_b16 v[40:41], v58 offset:34816
    ds_read_b64_tr_b16 v[42:43], v58 offset:35328
    v_mfma_f32_32x32x16_bf16 v[16:31], v[52:55], v[112:115], v[16:31]
    ds_read_b64_tr_b16 v[44:45], v59 offset:34816
    ds_read_b64_tr_b16 v[46:47], v59 offset:35328
    s_waitcnt vmcnt(7) lgkmcnt(4)
    v_mfma_f32_32x32x16_bf16 v[0:15], v[32:35], v[116:119], v[0:15]
    s_add_u32 s38, s36, s37
    buffer_load_dwordx4 v[112:115], v253, s[20:23], s38 offen offset:0 sc1
    ds_read_b64_tr_b16 v[48:49], v58 offset:36864
    ds_read_b64_tr_b16 v[50:51], v58 offset:37376
    v_mfma_f32_32x32x16_bf16 v[16:31], v[36:39], v[116:119], v[16:31]
    ds_read_b64_tr_b16 v[52:53], v59 offset:36864
    ds_read_b64_tr_b16 v[54:55], v59 offset:37376
    s_waitcnt vmcnt(7) lgkmcnt(4)
    v_mfma_f32_32x32x16_bf16 v[0:15], v[40:43], v[120:123], v[0:15]
    s_add_u32 s37, s37, 2048
    s_and_b32 s37, s37, 0x7800
    buffer_load_dwordx4 v[116:119], v253, s[20:23], s38 offen offset:1024 sc1
    ds_read_b64_tr_b16 v[32:33], v58 offset:38912
    ds_read_b64_tr_b16 v[34:35], v58 offset:39424
    v_mfma_f32_32x32x16_bf16 v[16:31], v[44:47], v[120:123], v[16:31]
    ds_read_b64_tr_b16 v[36:37], v59 offset:38912
    ds_read_b64_tr_b16 v[38:39], v59 offset:39424
    s_waitcnt vmcnt(7) lgkmcnt(4)
    v_mfma_f32_32x32x16_bf16 v[0:15], v[48:51], v[124:127], v[0:15]
    s_add_u32 s38, s36, s37
    buffer_load_dwordx4 v[120:123], v253, s[20:23], s38 offen offset:0 sc1
    ds_read_b64_tr_b16 v[40:41], v58 offset:40960
    ds_read_b64_tr_b16 v[42:43], v58 offset:41472
    v_mfma_f32_32x32x16_bf16 v[16:31], v[52:55], v[124:127], v[16:31]
    ds_read_b64_tr_b16 v[44:45], v59 offset:40960
    ds_read_b64_tr_b16 v[46:47], v59 offset:41472
    s_waitcnt vmcnt(7) lgkmcnt(4)
    v_mfma_f32_32x32x16_bf16 v[0:15], v[32:35], v[128:131], v[0:15]
    s_add_u32 s37, s37, 2048
    s_and_b32 s37, s37, 0x7800
    buffer_load_dwordx4 v[124:127], v253, s[20:23], s38 offen offset:1024 sc1
    ds_read_b64_tr_b16 v[48:49], v58 offset:43008
    ds_read_b64_tr_b16 v[50:51], v58 offset:43520
    v_mfma_f32_32x32x16_bf16 v[16:31], v[36:39], v[128:131], v[16:31]
    ds_read_b64_tr_b16 v[52:53], v59 offset:43008
    ds_read_b64_tr_b16 v[54:55], v59 offset:43520
    s_waitcnt vmcnt(7) lgkmcnt(4)
    v_mfma_f32_32x32x16_bf16 v[0:15], v[40:43], v[132:135], v[0:15]
    s_add_u32 s38, s36, s37
    buffer_load_dwordx4 v[128:131], v253, s[20:23], s38 offen offset:0 sc1
    ds_read_b64_tr_b16 v[32:33], v58 offset:45056
    ds_read_b64_tr_b16 v[34:35], v58 offset:45568
    v_mfma_f32_32x32x16_bf16 v[16:31], v[44:47], v[132:135], v[16:31]
    ds_read_b64_tr_b16 v[36:37], v59 offset:45056
    ds_read_b64_tr_b16 v[38:39], v59 offset:45568
    s_waitcnt vmcnt(7) lgkmcnt(4)
    v_mfma_f32_32x32x16_bf16 v[0:15], v[48:51], v[136:139], v[0:15]
    s_add_u32 s37, s37, 2048
    s_and_b32 s37, s37, 0x7800
    buffer_load_dwordx4 v[132:135], v253, s[20:23], s38 offen offset:1024 sc1
    ds_read_b64_tr_b16 v[40:41], v58 offset:47104
    ds_read_b64_tr_b16 v[42:43], v58 offset:47616
    v_mfma_f32_32x32x16_bf16 v[16:31], v[52:55], v[136:139], v[16:31]
    ds_read_b64_tr_b16 v[44:45], v59 offset:47104
    ds_read_b64_tr_b16 v[46:47], v59 offset:47616
    s_barrier
    s_waitcnt vmcnt(7) lgkmcnt(4)
    v_mfma_f32_32x32x16_bf16 v[0:15], v[32:35], v[104:107], v[0:15]
    s_add_u32 s38, s36, s37
    buffer_load_dwordx4 v[136:139], v253, s[20:23], s38 offen offset:0 sc1
    ds_read_b64_tr_b16 v[48:49], v58 offset:49152
    ds_read_b64_tr_b16 v[50:51], v58 offset:49664
    v_mfma_f32_32x32x16_bf16 v[16:31], v[36:39], v[104:107], v[16:31]
    ds_read_b64_tr_b16 v[52:53], v59 offset:49152
    ds_read_b64_tr_b16 v[54:55], v59 offset:49664
    s_waitcnt vmcnt(7) lgkmcnt(4)
    v_mfma_f32_32x32x16_bf16 v[0:15], v[40:43], v[108:111], v[0:15]
    s_add_u32 s37, s37, 2048
    s_and_b32 s37, s37, 0x7800
    buffer_load_dwordx4 v[104:107], v253, s[20:23], s38 offen offset:1024 sc1
    ds_read_b64_tr_b16 v[32:33], v58 offset:51200
    ds_read_b64_tr_b16 v[34:35], v58 offset:51712
    v_mfma_f32_32x32x16_bf16 v[16:31], v[44:47], v[108:111], v[16:31]
    ds_read_b64_tr_b16 v[36:37], v59 offset:51200
    ds_read_b64_tr_b16 v[38:39], v59 offset:51712
    s_waitcnt vmcnt(7) lgkmcnt(4)
    v_mfma_f32_32x32x16_bf16 v[0:15], v[48:51], v[112:115], v[0:15]
    ds_read_b64_tr_b16 v[40:41], v58 offset:53248
    ds_read_b64_tr_b16 v[42:43], v58 offset:53760
    v_mfma_f32_32x32x16_bf16 v[16:31], v[52:55], v[112:115], v[16:31]
    ds_read_b64_tr_b16 v[44:45], v59 offset:53248
    ds_read_b64_tr_b16 v[46:47], v59 offset:53760
    s_waitcnt vmcnt(6) lgkmcnt(4)
    v_mfma_f32_32x32x16_bf16 v[0:15], v[32:35], v[116:119], v[0:15]
    ds_read_b64_tr_b16 v[48:49], v58 offset:55296
    ds_read_b64_tr_b16 v[50:51], v58 offset:55808
    v_mfma_f32_32x32x16_bf16 v[16:31], v[36:39], v[116:119], v[16:31]
    ds_read_b64_tr_b16 v[52:53], v59 offset:55296
    ds_read_b64_tr_b16 v[54:55], v59 offset:55808
    s_waitcnt vmcnt(5) lgkmcnt(4)
    v_mfma_f32_32x32x16_bf16 v[0:15], v[40:43], v[120:123], v[0:15]
    ds_read_b64_tr_b16 v[32:33], v58 offset:57344
    ds_read_b64_tr_b16 v[34:35], v58 offset:57856
    v_mfma_f32_32x32x16_bf16 v[16:31], v[44:47], v[120:123], v[16:31]
    ds_read_b64_tr_b16 v[36:37], v59 offset:57344
    ds_read_b64_tr_b16 v[38:39], v59 offset:57856
    s_waitcnt vmcnt(4) lgkmcnt(4)
    v_mfma_f32_32x32x16_bf16 v[0:15], v[48:51], v[124:127], v[0:15]
    ds_read_b64_tr_b16 v[40:41], v58 offset:59392
    ds_read_b64_tr_b16 v[42:43], v58 offset:59904
    v_mfma_f32_32x32x16_bf16 v[16:31], v[52:55], v[124:127], v[16:31]
    ds_read_b64_tr_b16 v[44:45], v59 offset:59392
    ds_read_b64_tr_b16 v[46:47], v59 offset:59904
    s_waitcnt vmcnt(3) lgkmcnt(4)
    v_mfma_f32_32x32x16_bf16 v[0:15], v[32:35], v[128:131], v[0:15]
    ds_read_b64_tr_b16 v[48:49], v58 offset:61440
    ds_read_b64_tr_b16 v[50:51], v58 offset:61952
    v_mfma_f32_32x32x16_bf16 v[16:31], v[36:39], v[128:131], v[16:31]
    ds_read_b64_tr_b16 v[52:53], v59 offset:61440
    ds_read_b64_tr_b16 v[54:55], v59 offset:61952
    s_waitcnt vmcnt(2) lgkmcnt(4)
    v_mfma_f32_32x32x16_bf16 v[0:15], v[40:43], v[132:135], v[0:15]
    ds_read_b64_tr_b16 v[32:33], v58 offset:63488
    ds_read_b64_tr_b16 v[34:35], v58 offset:64000
    v_mfma_f32_32x32x16_bf16 v[16:31], v[44:47], v[132:135], v[16:31]
    ds_read_b64_tr_b16 v[36:37], v59 offset:63488
    ds_read_b64_tr_b16 v[38:39], v59 offset:64000
    s_waitcnt vmcnt(1) lgkmcnt(4)
    v_mfma_f32_32x32x16_bf16 v[0:15], v[48:51], v[136:139], v[0:15]
    v_mfma_f32_32x32x16_bf16 v[16:31], v[52:55], v[136:139], v[16:31]
    s_waitcnt vmcnt(0) lgkmcnt(0)
    v_mfma_f32_32x32x16_bf16 v[0:15], v[32:35], v[104:107], v[0:15]
    v_mfma_f32_32x32x16_bf16 v[16:31], v[36:39], v[104:107], v[16:31]
    s_lshl_b32 s35, s24, 4
    s_add_u32 s35, s35, s98
    s_lshl_b32 s35, s35, 14
    s_lshl_b32 s34, s3, 12
    s_add_u32 s35, s35, s34
    s_add_u32 s35, s35, 0x2000000
    s_lshl_b32 s30, s99, 13
    s_add_u32 s30, s30, s26
    s_add_u32 s30, s30, 0xc00000
    s_lshl_b32 s31, s98, 9
    s_add_u32 s31, s31, s30
    v_mov_b32 v96, 0
    v_mov_b32 v97, 0
    v_mov_b32 v98, 0
    v_mov_b32 v99, v242
    v_cvt_pk_bf16_f32 v208, v0, v1
    v_cvt_pk_bf16_f32 v209, v2, v3
    v_cvt_pk_bf16_f32 v210, v4, v5
    v_cvt_pk_bf16_f32 v211, v6, v7
    v_cvt_pk_bf16_f32 v212, v8, v9
    v_cvt_pk_bf16_f32 v213, v10, v11
    v_cvt_pk_bf16_f32 v214, v12, v13
    v_cvt_pk_bf16_f32 v215, v14, v15
    v_cvt_pk_bf16_f32 v216, v16, v17
    v_cvt_pk_bf16_f32 v217, v18, v19
    v_cvt_pk_bf16_f32 v218, v20, v21
    v_cvt_pk_bf16_f32 v219, v22, v23
    v_cvt_pk_bf16_f32 v220, v24, v25
    v_cvt_pk_bf16_f32 v221, v26, v27
    v_cvt_pk_bf16_f32 v222, v28, v29
    v_cvt_pk_bf16_f32 v223, v30, v31
    s_cmp_lg_u32 s26, 0
    s_cbranch_scc1 sk_26
    s_cmp_lg_u32 s77, 0
    s_cbranch_scc1 lc_27
    buffer_store_dwordx4 v[208:211], v100, s[20:23], s35 offen offset:0 sc1
    buffer_store_dwordx4 v[212:215], v100, s[20:23], s35 offen offset:512 sc1
    buffer_store_dwordx4 v[216:219], v100, s[20:23], s35 offen offset:1024 sc1
    buffer_store_dwordx4 v[220:223], v100, s[20:23], s35 offen offset:1536 sc1
    s_branch lc_28
lc_27:
    buffer_store_dwordx4 v[208:211], v100, s[20:23], s35 offen offset:0
    buffer_store_dwordx4 v[212:215], v100, s[20:23], s35 offen offset:512
    buffer_store_dwordx4 v[216:219], v100, s[20:23], s35 offen offset:1024
    buffer_store_dwordx4 v[220:223], v100, s[20:23], s35 offen offset:1536
lc_28:
    ds_write_b128 v101, v[208:211] offset:0
    ds_write_b128 v101, v[212:215] offset:512
    ds_write_b128 v101, v[216:219] offset:1024
    ds_write_b128 v101, v[220:223] offset:1536
sk_26:
    v_dot2c_f32_bf16 v96, 0x3f803f80, v208
    v_dot2c_f32_bf16 v97, v208, v208
    v_dot2c_f32_bf16 v98, v224, v208
    v_dot2c_f32_bf16 v96, 0x3f803f80, v209
    v_dot2c_f32_bf16 v97, v209, v209
    v_dot2c_f32_bf16 v98, v225, v209
    v_dot2c_f32_bf16 v96, 0x3f803f80, v210
    v_dot2c_f32_bf16 v97, v210, v210
    v_dot2c_f32_bf16 v98, v226, v210
    v_dot2c_f32_bf16 v96, 0x3f803f80, v211
    v_dot2c_f32_bf16 v97, v211, v211
    v_dot2c_f32_bf16 v98, v227, v211
    v_dot2c_f32_bf16 v96, 0x3f803f80, v212
    v_dot2c_f32_bf16 v97, v212, v212
    v_dot2c_f32_bf16 v98, v228, v212
    v_dot2c_f32_bf16 v96, 0x3f803f80, v213
    v_dot2c_f32_bf16 v97, v213, v213
    v_dot2c_f32_bf16 v98, v229, v213
    v_dot2c_f32_bf16 v96, 0x3f803f80, v214
    v_dot2c_f32_bf16 v97, v214, v214
    v_dot2c_f32_bf16 v98, v230, v214
    v_dot2c_f32_bf16 v96, 0x3f803f80, v215
    v_dot2c_f32_bf16 v97, v215, v215
    v_dot2c_f32_bf16 v98, v231, v215
    v_dot2c_f32_bf16 v96, 0x3f803f80, v216
    v_dot2c_f32_bf16 v97, v216, v216
    v_dot2c_f32_bf16 v98, v232, v216
    v_dot2c_f32_bf16 v96, 0x3f803f80, v217
    v_dot2c_f32_bf16 v97, v217, v217
    v_dot2c_f32_bf16 v98, v233, v217
    v_dot2c_f32_bf16 v96, 0x3f803f80, v218
    v_dot2c_f32_bf16 v97, v218, v218
    v_dot2c_f32_bf16 v98, v234, v218
    v_dot2c_f32_bf16 v96, 0x3f803f80, v219
    v_dot2c_f32_bf16 v97, v219, v219
    v_dot2c_f32_bf16 v98, v235, v219
    v_dot2c_f32_bf16 v96, 0x3f803f80, v220
    v_dot2c_f32_bf16 v97, v220, v220
    v_dot2c_f32_bf16 v98, v236, v220
    v_dot2c_f32_bf16 v96, 0x3f803f80, v221
    v_dot2c_f32_bf16 v97, v221, v221
    v_dot2c_f32_bf16 v98, v237, v221
    v_dot2c_f32_bf16 v96, 0x3f803f80, v222
    v_dot2c_f32_bf16 v97, v222, v222
    v_dot2c_f32_bf16 v98, v238, v222
    v_dot2c_f32_bf16 v96, 0x3f803f80, v223
    v_dot2c_f32_bf16 v97, v223, v223
    v_dot2c_f32_bf16 v98, v239, v223
    s_nop 0
    v_mov_b32 v48, v96
    v_mov_b32 v49, v97
    v_mov_b32 v50, v98
    v_mov_b32 v51, v99
    v_permlane32_swap_b32 v96, v48
    v_permlane32_swap_b32 v97, v49
    v_permlane32_swap_b32 v98, v50
    v_permlane32_swap_b32 v99, v51
    v_add_f32 v96, v96, v48
    v_add_f32 v97, v97, v49
    v_add_f32 v98, v98, v50
    v_add_f32 v99, v99, v51
    s_mov_b32 exec_hi, 0
    s_waitcnt vmcnt(0)
    s_cmp_lg_u32 s77, 0
    s_cbranch_scc1 lc_29
    buffer_store_dwordx4 v[96:99], v253, s[20:23], s31 offen sc1
    s_branch lc_30
lc_29:
    buffer_store_dwordx4 v[96:99], v253, s[20:23], s31 offen
lc_30:
    s_mov_b64 exec, -1
    s_cmp_lg_u32 s26, 0
    s_cbranch_scc1 e_final
    s_mov_b32 s26, 16777216
    s_and_b32 s30, s3, 1
    s_lshl_b32 s30, s30, 13
    v_add_u32 v176, s30, v253
    v_add_u32 v177, 1024, v176
    s_lshr_b32 s30, s16, 7
    s_sub_u32 s30, 3, s30
    s_and_b32 s30, s30, 7
    s_and_b32 s31, s24, 1
    s_lshl_b32 s31, s31, 3
    s_add_u32 s30, s30, s31
    s_and_b32 s31, s24, 14
    s_add_u32 s84, s31, s30
    s_lshl_b32 s31, s25, 2
    s_add_u32 s31, s31, s28
    s_mul_i32 s31, s31, 6144
    s_lshl_b32 s30, s30, 7
    s_add_u32 s30, s30, s31
    v_min_u32 v190, 2, v252
    v_lshl_add_u32 v190, v190, 11, s30
    s_add_u32 s84, s84, 14
    v_mov_b32 v0, 0
    v_mov_b32 v1, 0
    v_mov_b32 v2, 0
    v_mov_b32 v3, 0
    v_mov_b32 v4, 0
    v_mov_b32 v5, 0
    v_mov_b32 v6, 0
    v_mov_b32 v7, 0
    v_mov_b32 v8, 0
    v_mov_b32 v9, 0
    v_mov_b32 v10, 0
    v_mov_b32 v11, 0
    v_mov_b32 v12, 0
    v_mov_b32 v13, 0
    v_mov_b32 v14, 0
    v_mov_b32 v15, 0
    v_mov_b32 v16, 0
    v_mov_b32 v17, 0
    v_mov_b32 v18, 0
    v_mov_b32 v19, 0
    v_mov_b32 v20, 0
    v_mov_b32 v21, 0
    v_mov_b32 v22, 0
    v_mov_b32 v23, 0
    v_mov_b32 v24, 0
    v_mov_b32 v25, 0
    v_mov_b32 v26, 0
    v_mov_b32 v27, 0
    v_mov_b32 v28, 0
    v_mov_b32 v29, 0
    v_mov_b32 v30, 0
    v_mov_b32 v31, 0
    v_mov_b32 v32, 0
    v_mov_b32 v33, 0
    v_mov_b32 v34, 0
    v_mov_b32 v35, 0
    v_mov_b32 v36, 0
    v_mov_b32 v37, 0
    v_mov_b32 v38, 0
    v_mov_b32 v39, 0
    v_mov_b32 v40, 0
    v_mov_b32 v41, 0
    v_mov_b32 v42, 0
    v_mov_b32 v43, 0
    v_mov_b32 v44, 0
    v_mov_b32 v45, 0
    v_mov_b32 v46, 0
    v_mov_b32 v47, 0
    v_mov_b32 v48, 0
    v_mov_b32 v49, 0
    v_mov_b32 v50, 0
    v_mov_b32 v51, 0
    v_mov_b32 v52, 0
    v_mov_b32 v53, 0
    v_mov_b32 v54, 0
    v_mov_b32 v55, 0
    v_mov_b32 v56, 0
    v_mov_b32 v57, 0
    v_mov_b32 v58, 0
    v_mov_b32 v59, 0
    v_mov_b32 v60, 0
    v_mov_b32 v61, 0
    v_mov_b32 v62, 0
    v_mov_b32 v63, 0
    v_mov_b32 v64, 0
    v_mov_b32 v65, 0
    v_mov_b32 v66, 0
    v_mov_b32 v67, 0
    v_mov_b32 v68, 0
    v_mov_b32 v69, 0
    v_mov_b32 v70, 0
    v_mov_b32 v71, 0
    v_mov_b32 v72, 0
    v_mov_b32 v73, 0
    v_mov_b32 v74, 0
    v_mov_b32 v75, 0
    v_mov_b32 v76, 0
    v_mov_b32 v77, 0
    v_mov_b32 v78, 0
    v_mov_b32 v79, 0
    v_mov_b32 v80, 0
    v_mov_b32 v81, 0
    v_mov_b32 v82, 0
    v_mov_b32 v83, 0
    v_mov_b32 v84, 0
    v_mov_b32 v85, 0
    v_mov_b32 v86, 0
    v_mov_b32 v87, 0
    v_mov_b32 v88, 0
    v_mov_b32 v89, 0
    v_mov_b32 v90, 0
    v_mov_b32 v91, 0
    v_mov_b32 v92, 0
    v_mov_b32 v93, 0
    v_mov_b32 v94, 0
    v_mov_b32 v95, 0
    s_waitcnt lgkmcnt(0)
    s_branch e_q
e_fpf:
    s_bitset0_b32 s86, s36
    s_bfm_b64 exec, 56, 0
    global_load_dword v191, v[196:197], off
    v_add_co_u32 v196, vcc, v196, v198
    s_nop 1
    v_addc_co_u32 v197, vcc, 0, v197, vcc
    s_mov_b64 exec, -1
    s_branch e_fpf_ret
e_arr:
    s_mov_b64 exec, 3
    s_mov_b32 s89, 0xdd9000
    buffer_store_dwordx2 v[250:251], v249, s[20:23], s89 offen sc1
    s_mov_b64 exec, -1
    s_branch e_arr_ret
e_final:
    s_mov_b32 s78, s27
pl_31:
    s_lshl_b32 s30, s99, 13
    s_add_u32 s30, s30, 0x1c00000
    s_add_u32 s31, s30, 4096
    buffer_load_dwordx4 v[64:67], v253, s[20:23], s30 offen offset:0 sc1
    buffer_load_dwordx4 v[68:71], v253, s[20:23], s30 offen offset:1024 sc1
    buffer_load_dwordx4 v[72:75], v253, s[20:23], s30 offen offset:2048 sc1
    buffer_load_dwordx4 v[76:79], v253, s[20:23], s30 offen offset:3072 sc1
    buffer_load_dwordx4 v[80:83], v253, s[20:23], s31 offen offset:0 sc1
    buffer_load_dwordx4 v[84:87], v253, s[20:23], s31 offen offset:1024 sc1
    buffer_load_dwordx4 v[88:91], v253, s[20:23], s31 offen offset:2048 sc1
    buffer_load_dwordx4 v[92:95], v253, s[20:23], s31 offen offset:3072 sc1
    s_waitcnt vmcnt(0)
pc_32:
    v_max3_u32 v48, v64, v68, v72
    v_max3_u32 v48, v48, v76, v80
    v_max3_u32 v48, v48, v84, v88
    v_max_u32 v48, v48, v92
    v_cmp_eq_u32 vcc, -1, v48
    s_cbranch_vccz pd_33
    s_sub_u32 s78, s78, 1
    s_cmp_lg_u32 s78, 0
    s_cbranch_scc1 pl_31
    s_mov_b32 s27, 1
pd_33:
    v_pk_add_f32 v[64:65], v[64:65], v[68:69]
    v_pk_add_f32 v[66:67], v[66:67], v[70:71]
    v_pk_add_f32 v[64:65], v[64:65], v[72:73]
    v_pk_add_f32 v[66:67], v[66:67], v[74:75]
    v_pk_add_f32 v[64:65], v[64:65], v[76:77]
    v_pk_add_f32 v[66:67], v[66:67], v[78:79]
    v_pk_add_f32 v[64:65], v[64:65], v[80:81]
    v_pk_add_f32 v[66:67], v[66:67], v[82:83]
    v_pk_add_f32 v[64:65], v[64:65], v[84:85]
    v_pk_add_f32 v[66:67], v[66:67], v[86:87]
    v_pk_add_f32 v[64:65], v[64:65], v[88:89]
    v_pk_add_f32 v[66:67], v[66:67], v[90:91]
    v_pk_add_f32 v[64:65], v[64:65], v[92:93]
    v_pk_add_f32 v[66:67], v[66:67], v[94:95]
    v_mov_b32 v48, v64
    v_mov_b32 v49, v65
    v_mov_b32 v50, v66
    v_mov_b32 v51, v67
    v_permlane32_swap_b32 v64, v48
    v_permlane32_swap_b32 v65, v49
    v_permlane32_swap_b32 v66, v50
    v_permlane32_swap_b32 v67, v51
    v_add_f32 v64, v64, v48
    v_add_f32 v65, v65, v49
    v_add_f32 v66, v66, v50
    v_add_f32 v67, v67, v51
    v_mul_f32 v54, 0x3a800000, v64
    v_mul_f32 v65, 0x3a800000, v65
    v_fma_f32 v65, -v54, v54, v65
    v_max_f32 v65, 0, v65
    v_add_f32 v55, 0x3727c5ac, v65
    v_rsq_f32 v55, v55
    v_fma_f32 v52, -v54, v67, v66
    v_and_b32 v53, 31, v252
    v_mul_f32 v52, v52, v55
    s_lshl_b32 s32, s99, 5
    v_add_u32 v53, s32, v53
    v_mov_b32 v48, v52
    s_nop 1
    v_max_f32_dpp v48, v48, v48 quad_perm:[1,0,3,2] row_mask:0xf bank_mask:0xf
    s_nop 1
    v_max_f32_dpp v48, v48, v48 quad_perm:[2,3,0,1] row_mask:0xf bank_mask:0xf
    s_nop 1
    v_max_f32_dpp v48, v48, v48 row_half_mirror row_mask:0xf bank_mask:0xf
    s_nop 1
    v_max_f32_dpp v48, v48, v48 row_mirror row_mask:0xf bank_mask:0xf
    v_mov_b32 v49, v48
    s_nop 1
    v_permlane16_swap_b32 v48, v49
    v_max_f32 v48, v48, v49
    v_cmp_eq_f32 vcc, v48, v52
    v_lshrrev_b32 v50, 5, v252
    v_lshlrev_b32 v50, 4, v50
    s_lshl_b32 s32, s99, 11
    s_lshl_b32 s33, s98, 7
    s_add_u32 s32, s32, s33
    s_add_u32 s32, s32, 0x1d60000
    s_lshl_b32 s34, s99, 4
    s_add_u32 s34, s34, 0x1dc0000
    s_ff1_i32_b32 s35, vcc_lo
    s_lshl_b32 s35, 1, s35
    s_cmp_eq_u32 s25, 0
    s_cselect_b32 exec_lo, s35, 0
    s_mov_b32 exec_hi, 0
    buffer_store_dwordx4 v[52:55], v50, s[20:23], s34 offen sc1
    s_mov_b32 exec_lo, s35
    s_mov_b32 exec_hi, s35
    buffer_store_dwordx4 v[208:211], v50, s[20:23], s32 offen offset:0 sc1
    buffer_store_dwordx4 v[212:215], v50, s[20:23], s32 offen offset:32 sc1
    buffer_store_dwordx4 v[216:219], v50, s[20:23], s32 offen offset:64 sc1
    buffer_store_dwordx4 v[220:223], v50, s[20:23], s32 offen offset:96 sc1
    s_mov_b64 exec, -1
    v_add_f32 v240, 1.0, v55
    v_mul_f32 v241, v54, v55
    v_sub_f32 v241, 0, v241
    v_pk_fma_f32 v[0:1], v[0:1], v[240:241], v[240:241] op_sel:[0,0,1] op_sel_hi:[1,0,1]
    v_pk_fma_f32 v[2:3], v[2:3], v[240:241], v[240:241] op_sel:[0,0,1] op_sel_hi:[1,0,1]
    v_pk_fma_f32 v[4:5], v[4:5], v[240:241], v[240:241] op_sel:[0,0,1] op_sel_hi:[1,0,1]
    v_pk_fma_f32 v[6:7], v[6:7], v[240:241], v[240:241] op_sel:[0,0,1] op_sel_hi:[1,0,1]
    v_pk_fma_f32 v[8:9], v[8:9], v[240:241], v[240:241] op_sel:[0,0,1] op_sel_hi:[1,0,1]
    v_pk_fma_f32 v[10:11], v[10:11], v[240:241], v[240:241] op_sel:[0,0,1] op_sel_hi:[1,0,1]
    v_pk_fma_f32 v[12:13], v[12:13], v[240:241], v[240:241] op_sel:[0,0,1] op_sel_hi:[1,0,1]
    v_pk_fma_f32 v[14:15], v[14:15], v[240:241], v[240:241] op_sel:[0,0,1] op_sel_hi:[1,0,1]
    v_pk_fma_f32 v[16:17], v[16:17], v[240:241], v[240:241] op_sel:[0,0,1] op_sel_hi:[1,0,1]
    v_pk_fma_f32 v[18:19], v[18:19], v[240:241], v[240:241] op_sel:[0,0,1] op_sel_hi:[1,0,1]
    v_pk_fma_f32 v[20:21], v[20:21], v[240:241], v[240:241] op_sel:[0,0,1] op_sel_hi:[1,0,1]
    v_pk_fma_f32 v[22:23], v[22:23], v[240:241], v[240:241] op_sel:[0,0,1] op_sel_hi:[1,0,1]
    v_pk_fma_f32 v[24:25], v[24:25], v[240:241], v[240:241] op_sel:[0,0,1] op_sel_hi:[1,0,1]
    v_pk_fma_f32 v[26:27], v[26:27], v[240:241], v[240:241] op_sel:[0,0,1] op_sel_hi:[1,0,1]
    v_pk_fma_f32 v[28:29], v[28:29], v[240:241], v[240:241] op_sel:[0,0,1] op_sel_hi:[1,0,1]
    v_pk_fma_f32 v[30:31], v[30:31], v[240:241], v[240:241] op_sel:[0,0,1] op_sel_hi:[1,0,1]
    v_cvt_pk_bf16_f32 v64, v0, v1
    v_cvt_pk_bf16_f32 v65, v2, v3
    v_cvt_pk_bf16_f32 v66, v4, v5
    v_cvt_pk_bf16_f32 v67, v6, v7
    v_cvt_pk_bf16_f32 v68, v8, v9
    v_cvt_pk_bf16_f32 v69, v10, v11
    v_cvt_pk_bf16_f32 v70, v12, v13
    v_cvt_pk_bf16_f32 v71, v14, v15
    v_cvt_pk_bf16_f32 v72, v16, v17
    v_cvt_pk_bf16_f32 v73, v18, v19
    v_cvt_pk_bf16_f32 v74, v20, v21
    v_cvt_pk_bf16_f32 v75, v22, v23
    v_cvt_pk_bf16_f32 v76, v24, v25
    v_cvt_pk_bf16_f32 v77, v26, v27
    v_cvt_pk_bf16_f32 v78, v28, v29
    v_cvt_pk_bf16_f32 v79, v30, v31
    v_permlane32_swap_b32 v64, v66
    v_permlane32_swap_b32 v65, v67
    v_permlane32_swap_b32 v68, v70
    v_permlane32_swap_b32 v69, v71
    v_permlane32_swap_b32 v72, v74
    v_permlane32_swap_b32 v73, v75
    v_permlane32_swap_b32 v76, v78
    v_permlane32_swap_b32 v77, v79
    v_lshl_add_u32 v50, v53, 11, v50
    s_mov_b32 s79, s26
    s_cmp_lg_u32 s3, 0
    s_cbranch_scc1 sk_35
    s_mov_b32 s78, s27
pl_36:
    s_add_u32 s32, s79, 0xdc0000
    buffer_load_dwordx4 v[0:3], v253, s[20:23], s32 offen sc1
    s_waitcnt vmcnt(0)
pc_37:
    v_max3_u32 v4, v0, v1, v2
    v_max_u32 v4, v4, v3
    v_cmp_eq_u32 vcc, -1, v4
    s_cbranch_vccz pd_38
    s_sub_u32 s78, s78, 1
    s_cmp_lg_u32 s78, 0
    s_cbranch_scc1 pl_36
    s_mov_b32 s27, 1
pd_38:
    v_mov_b32 v4, v0
    s_nop 1
    v_max_f32_dpp v4, v4, v4 quad_perm:[1,0,3,2] row_mask:0xf bank_mask:0xf
    s_nop 1
    v_max_f32_dpp v4, v4, v4 quad_perm:[2,3,0,1] row_mask:0xf bank_mask:0xf
    s_nop 1
    v_max_f32_dpp v4, v4, v4 row_half_mirror row_mask:0xf bank_mask:0xf
    s_nop 1
    v_max_f32_dpp v4, v4, v4 row_mirror row_mask:0xf bank_mask:0xf
    v_mov_b32 v5, v4
    s_nop 1
    v_permlane16_swap_b32 v4, v5
    v_max_f32 v4, v4, v5
    v_mov_b32 v5, v4
    s_nop 1
    v_permlane32_swap_b32 v4, v5
    v_max_f32 v4, v4, v5
    v_cmp_eq_f32 vcc, v4, v0
    s_ff1_i32_b64 s32, vcc
    s_and_b32 s32, s32, 63
    s_lshl_b64 exec, 1, s32
    ds_write_b128 v189, v[0:3] offset:3072
    s_mov_b64 exec, -1
sk_35:
    s_waitcnt lgkmcnt(0)
    s_barrier
    ds_read_b32 v0, v189 offset:3076
    s_waitcnt lgkmcnt(0)
    v_and_b32 v0, 0x7ff, v0
    v_cmp_ne_u32 vcc, v0, v53
    s_mov_b64 exec, vcc
    buffer_store_dwordx4 v[64:67], v50, s[12:15], s33 offen offset:0
    buffer_store_dwordx4 v[68:71], v50, s[12:15], s33 offen offset:32
    buffer_store_dwordx4 v[72:75], v50, s[12:15], s33 offen offset:64
    buffer_store_dwordx4 v[76:79], v50, s[12:15], s33 offen offset:96
    s_mov_b64 exec, -1
    s_branch k_end
l_start:
    v_lshrrev_b32 v21, 3, v252
    v_lshrrev_b32 v20, 4, v252
    v_xor_b32 v20, v20, v252
    v_and_b32 v20, 7, v20
    v_lshlrev_b32 v20, 4, v20
    v_lshl_add_u32 v4, v21, 11, v20
    v_xor_b32 v5, 64, v4
    v_add_u32 v5, 15360, v5
    v_add_u32 v6, 30720, v4
    v_add_u32 v7, 30720, v5
    s_lshl_b32 s84, s99, 16
    s_lshl_b32 s85, s25, 7
    s_lshl_b32 s86, s28, 12
    s_mul_i32 s87, s28, 6144
    v_and_b32 v20, 4, v21
    v_add_u32 v20, v20, v21
    v_mul_u32_u24 v20, 6144, v20
    v_and_b32 v21, 6, v21
    v_xor_b32 v21, v21, v252
    v_and_b32 v21, 7, v21
    v_lshl_add_u32 v20, v21, 4, v20
    s_mul_i32 s32, s28, 3
    s_bfe_u32 s33, s32, 0x10001
    s_mul_i32 s33, s33, 196608
    s_and_b32 s34, s32, 1
    s_mul_i32 s34, s34, 24576
    s_add_u32 s33, s33, s34
    s_lshr_b32 s34, s32, 2
    s_lshl_b32 s34, s34, 11
    s_add_u32 s33, s33, s34
    v_add_u32 v8, s33, v20
    v_add_u32 v9, 97280, v8
    s_add_u32 s32, s32, 1
    s_bfe_u32 s33, s32, 0x10001
    s_mul_i32 s33, s33, 196608
    s_and_b32 s34, s32, 1
    s_mul_i32 s34, s34, 24576
    s_add_u32 s33, s33, s34
    s_lshr_b32 s34, s32, 2
    s_lshl_b32 s34, s34, 11
    s_add_u32 s33, s33, s34
    s_sub_u32 s33, s33, 2048
    v_add_u32 v10, s33, v20
    v_add_u32 v11, 97280, v10
    s_add_u32 s32, s32, 1
    s_bfe_u32 s33, s32, 0x10001
    s_mul_i32 s33, s33, 196608
    s_and_b32 s34, s32, 1
    s_mul_i32 s34, s34, 24576
    s_add_u32 s33, s33, s34
    s_lshr_b32 s34, s32, 2
    s_lshl_b32 s34, s34, 11
    s_add_u32 s33, s33, s34
    v_add_u32 v12, s33, v20
    v_add_u32 v13, 97280, v12
    s_waitcnt lgkmcnt(0)
    s_mov_b32 s88, 0xdd8000
    s_load_dword s88, s[20:21], s88
    s_mov_b64 s[16:17], s[6:7]
    s_mov_b32 s6, 0x400000
    s_mov_b32 s7, 0x20000
    s_add_u32 s96, s94, 0
    s_and_b32 s96, s96, 15
    s_lshl_b32 s97, s96, 7
    s_add_u32 s97, s97, s84
    s_add_u32 m0, s86, 147456
    s_nop 0
    buffer_load_dwordx4 v4, s[4:7], s97 offen offset:0 lds
    buffer_load_dwordx4 v5, s[4:7], s97 offen offset:1024 lds
    buffer_load_dwordx4 v6, s[4:7], s97 offen offset:2048 lds
    buffer_load_dwordx4 v7, s[4:7], s97 offen offset:3072 lds
    s_add_u32 s96, s94, 0
    s_and_b32 s96, s96, 15
    s_mul_i32 s96, s96, 393216
    s_add_u32 s96, s96, s85
    s_add_u32 m0, s87, 40960
    s_nop 0
    buffer_load_dwordx4 v8, s[16:19], s96 offen offset:0 lds
    buffer_load_dwordx4 v9, s[16:19], s96 offen offset:1024 lds
    buffer_load_dwordx4 v10, s[16:19], s96 offen offset:2048 lds
    buffer_load_dwordx4 v11, s[16:19], s96 offen offset:3072 lds
    s_mov_b32 s40, 0xffffffff
    s_mov_b32 s41, 0xfffffff0
    s_mov_b32 s42, 0xfffffffe
    s_mov_b32 s43, 0xffffffe0
    s_mov_b32 s44, 0xfffffffc
    s_mov_b32 s45, 0xffffffc0
    s_mov_b32 s46, 0xfffffff8
    s_mov_b32 s47, 0xffffff80
    s_mov_b32 s48, 0xffff0000
    s_mov_b32 s49, 0xfff00000
    s_mov_b32 s50, 0xfffe0000
    s_mov_b32 s51, 0xffe00000
    s_mov_b32 s52, 0xfffc0000
    s_mov_b32 s53, 0xffc00000
    s_mov_b32 s54, 0xfff80000
    s_mov_b32 s55, 0xff800000
    s_mov_b32 s56, 0xffffff00
    s_mov_b32 s57, 0xfffff000
    s_mov_b32 s58, 0xfffffe00
    s_mov_b32 s59, 0xffffe000
    s_mov_b32 s60, 0xfffffc00
    s_mov_b32 s61, 0xffffc000
    s_mov_b32 s62, 0xfffff800
    s_mov_b32 s63, 0xffff8000
    s_mov_b32 s64, 0xff000000
    s_mov_b32 s65, 0xf0000000
    s_mov_b32 s66, 0xfe000000
    s_mov_b32 s67, 0xe0000000
    s_mov_b32 s68, 0xfc000000
    s_mov_b32 s69, 0xc0000000
    s_mov_b32 s70, 0xf8000000
    s_mov_b32 s71, 0x80000000
    v_bfe_u32 v20, v252, 3, 2
    v_lshrrev_b32 v21, 5, v252
    v_lshl_add_u32 v20, v21, 3, v20
    s_lshr_b32 s32, s28, 1
    s_lshl_b32 s32, s32, 4
    s_and_b32 s33, s28, 1
    s_lshl_b32 s33, s33, 2
    s_add_u32 s32, s32, s33
    v_add_u32 v20, s32, v20
    v_lshlrev_b32 v20, 11, v20
    v_lshrrev_b32 v21, 2, v252
    v_and_b32 v21, 4, v21
    v_xor_b32 v21, v21, v252
    v_and_b32 v21, 7, v21
    v_lshl_add_u32 v20, v21, 4, v20
    s_lshl_b32 s32, s98, 7
    v_add_u32 v14, s32, v20
    v_lshrrev_b32 v20, 2, v252
    v_lshlrev_b32 v20, 2, v20
    v_bfe_u32 v21, v252, 1, 1
    v_add_u32 v20, v20, v21
    v_mul_u32_u24 v20, 28672, v20
    v_and_b32 v21, 1, v252
    v_lshl_add_u32 v20, v21, 4, v20
    s_mul_i32 s30, s28, 1835008
    s_lshl_b32 s31, s29, 5
    s_add_u32 s30, s30, s31
    v_add_u32 v155, s30, v20
    v_lshlrev_b32 v21, 14, v21
    v_lshrrev_b32 v20, 1, v252
    v_lshl_add_u32 v20, v20, 4, v21
    s_lshl_b32 s30, s28, 9
    s_lshl_b32 s31, s29, 15
    s_add_u32 s30, s30, s31
    v_add_u32 v153, s30, v20
    s_load_dwordx2 s[80:81], s[0:1], 40
    s_cmp_lt_u32 s29, 224
    s_cselect_b32 s82, 0x700000, 0
    s_mov_b32 s83, 0x20000
    s_load_dwordx2 s[12:13], s[0:1], 56
    s_cmp_lt_u32 s29, 224
    s_cselect_b32 s14, 0x700000, 0
    s_mov_b32 s15, 0x20000
    s_mov_b32 s73, -1
    s_mov_b32 s100, 0
    s_sub_u32 s30, s25, s24
    s_add_u32 s30, s30, 31
    v_and_b32 v15, 16, v252
    v_mul_u32_u24 v15, s30, v15
    v_and_b32 v20, 31, v252
    v_add_lshl_u32 v15, v15, v20, 3
    s_lshl_b32 s30, s24, 7
    s_add_u32 s30, s30, 0xdd9000
    v_add_u32 v15, s30, v15
    s_add_u32 m0, s87, 45056
    s_nop 0
    buffer_load_dwordx4 v12, s[16:19], s96 offen offset:0 lds
    buffer_load_dwordx4 v13, s[16:19], s96 offen offset:1024 lds
    s_add_u32 s96, s95, 1
    s_and_b32 s96, s96, 15
    s_lshl_b32 s97, s96, 7
    s_add_u32 s97, s97, s84
    s_add_u32 m0, s86, 131072
    s_nop 0
    buffer_load_dwordx4 v4, s[4:7], s97 offen offset:0 lds
    buffer_load_dwordx4 v5, s[4:7], s97 offen offset:1024 lds
    buffer_load_dwordx4 v6, s[4:7], s97 offen offset:2048 lds
    buffer_load_dwordx4 v7, s[4:7], s97 offen offset:3072 lds
    s_add_u32 s96, s95, 1
    s_and_b32 s96, s96, 15
    s_mul_i32 s96, s96, 393216
    s_add_u32 s96, s96, s85
    s_add_u32 m0, s87, 65536
    s_nop 0
    buffer_load_dwordx4 v8, s[16:19], s96 offen offset:0 lds
    buffer_load_dwordx4 v9, s[16:19], s96 offen offset:1024 lds
    buffer_load_dwordx4 v10, s[16:19], s96 offen offset:2048 lds
    s_waitcnt vmcnt(7) lgkmcnt(0)
    s_add_u32 s88, s88, 0x9e3779b9
    s_barrier
    buffer_load_dwordx4 v11, s[16:19], s96 offen offset:3072 lds
    s_add_u32 m0, s87, 69632
    s_nop 0
    buffer_load_dwordx4 v12, s[16:19], s96 offen offset:0 lds
    buffer_load_dwordx4 v13, s[16:19], s96 offen offset:1024 lds
    s_add_u32 s96, s94, 2
    s_and_b32 s96, s96, 15
    s_lshl_b32 s97, s96, 7
    s_add_u32 s97, s97, s84
    s_add_u32 m0, s86, 114688
    s_nop 0
    buffer_load_dwordx4 v4, s[4:7], s97 offen offset:0 lds
    buffer_load_dwordx4 v5, s[4:7], s97 offen offset:1024 lds
    buffer_load_dwordx4 v6, s[4:7], s97 offen offset:2048 lds
    buffer_load_dwordx4 v7, s[4:7], s97 offen offset:3072 lds
    s_add_u32 s96, s94, 2
    s_and_b32 s96, s96, 15
    s_mul_i32 s96, s96, 393216
    s_add_u32 s96, s96, s85
    s_add_u32 m0, s87, 90112
    s_nop 0
    buffer_load_dwordx4 v8, s[16:19], s96 offen offset:0 lds
    buffer_load_dwordx4 v9, s[16:19], s96 offen offset:1024 lds
    buffer_load_dwordx4 v10, s[16:19], s96 offen offset:2048 lds
    buffer_load_dwordx4 v11, s[16:19], s96 offen offset:3072 lds
    s_add_u32 m0, s87, 94208
    s_nop 0
    buffer_load_dwordx4 v12, s[16:19], s96 offen offset:0 lds
    buffer_load_dwordx4 v13, s[16:19], s96 offen offset:1024 lds
    s_waitcnt vmcnt(10) lgkmcnt(0)
    s_barrier
    s_add_u32 s96, s95, 3
    s_and_b32 s96, s96, 15
    s_lshl_b32 s97, s96, 7
    s_add_u32 s97, s97, s84
    s_add_u32 m0, s86, 147456
    s_nop 0
    buffer_load_dwordx4 v4, s[4:7], s97 offen offset:0 lds
    buffer_load_dwordx4 v5, s[4:7], s97 offen offset:1024 lds
    v_and_b32 v28, 31, v252
    v_bfe_u32 v29, v28, 1, 3
    v_lshrrev_b32 v30, 5, v252
    v_xor_b32 v29, v29, v30
    v_lshlrev_b32 v29, 4, v29
    v_lshl_add_u32 v28, v28, 7, v29
    s_add_u32 s30, s86, 131072
    buffer_load_dwordx4 v6, s[4:7], s97 offen offset:2048 lds
    v_add_u32 v28, s30, v28
    v_xor_b32 v29, 32, v28
    v_xor_b32 v30, 64, v28
    v_xor_b32 v31, 96, v28
    ds_read_b128 v[32:35], v28
    ds_read_b128 v[36:39], v29
    ds_read_b128 v[40:43], v30
    buffer_load_dwordx4 v7, s[4:7], s97 offen offset:3072 lds
    ds_read_b128 v[44:47], v31
    s_min_u32 s30, s28, 2
    s_lshl_b32 s30, s30, 13
    s_add_u32 s30, s30, 65536
    v_lshrrev_b32 v20, 2, v252
    v_bfe_u32 v21, v20, 1, 2
    v_lshlrev_b32 v20, 7, v20
    s_add_u32 s96, s95, 3
    s_and_b32 s96, s96, 15
    s_mul_i32 s96, s96, 393216
    s_add_u32 s96, s96, s85
    s_add_u32 m0, s87, 40960
    s_nop 0
    buffer_load_dwordx4 v8, s[16:19], s96 offen offset:0 lds
    v_lshl_add_u32 v20, v21, 5, v20
    v_and_b32 v21, 3, v252
    v_lshl_add_u32 v20, v21, 3, v20
    v_add_u32 v144, s30, v20
    v_xor_b32 v145, 32, v144
    v_xor_b32 v146, 64, v144
    v_xor_b32 v147, 96, v144
    buffer_load_dwordx4 v9, s[16:19], s96 offen offset:1024 lds
    ds_read_b64_tr_b16 v[100:101], v144 offset:0
    ds_read_b64_tr_b16 v[102:103], v144 offset:2048
    ds_read_b64_tr_b16 v[104:105], v144 offset:4096
    ds_read_b64_tr_b16 v[106:107], v144 offset:6144
    ds_read_b64_tr_b16 v[108:109], v145 offset:0
    ds_read_b64_tr_b16 v[110:111], v145 offset:2048
    ds_read_b64_tr_b16 v[112:113], v145 offset:4096
    buffer_load_dwordx4 v10, s[16:19], s96 offen offset:2048 lds
    ds_read_b64_tr_b16 v[114:115], v145 offset:6144
    ds_read_b64_tr_b16 v[116:117], v146 offset:0
    ds_read_b64_tr_b16 v[118:119], v146 offset:2048
    ds_read_b64_tr_b16 v[120:121], v146 offset:4096
    ds_read_b64_tr_b16 v[122:123], v146 offset:6144
    ds_read_b64_tr_b16 v[124:125], v147 offset:0
    ds_read_b64_tr_b16 v[126:127], v147 offset:2048
    buffer_load_dwordx4 v11, s[16:19], s96 offen offset:3072 lds
    ds_read_b64_tr_b16 v[128:129], v147 offset:4096
    ds_read_b64_tr_b16 v[130:131], v147 offset:6144
    v_mov_b32 v16, -1
    v_mov_b32 v17, -1
    v_mov_b32 v18, -1
    v_mov_b32 v19, -1
    s_lshr_b32 s30, s28, 1
    s_add_u32 m0, s87, 45056
    s_nop 0
    buffer_load_dwordx4 v12, s[16:19], s96 offen offset:0 lds
    s_mul_i32 s30, s30, 16777216
    s_and_b32 s31, s28, 1
    s_lshl_b32 s32, s31, 20
    s_lshl_b32 s33, s72, 10
    s_add_u32 s32, s32, s33
    s_add_u32 s32, s32, s30
    s_add_u32 s32, s32, 0xc00000
    buffer_load_dwordx4 v13, s[16:19], s96 offen offset:1024 lds
    buffer_store_dwordx4 v[16:19], v253, s[20:23], s32 offen sc1
    s_add_u32 s32, s32, 262144
    buffer_store_dwordx4 v[16:19], v253, s[20:23], s32 offen sc1
    s_add_u32 s32, s32, 262144
    buffer_store_dwordx4 v[16:19], v253, s[20:23], s32 offen sc1
    s_add_u32 s32, s32, 262144
    s_lshl_b32 s33, s72, 7
    s_add_u32 s33, s33, s30
    s_add_u32 s33, s33, 0xdc0000
    s_cmp_eq_u32 s31, 0
    s_cselect_b32 s32, s32, s33
    s_cselect_b64 exec, -1, 0xff
    buffer_store_dwordx4 v[16:19], v253, s[20:23], s32 offen sc1
    s_mov_b64 exec, -1
    s_waitcnt vmcnt(14) lgkmcnt(0)
    s_barrier
    s_add_u32 s96, s94, 4
    s_and_b32 s96, s96, 15
    s_lshl_b32 s97, s96, 7
    s_add_u32 s97, s97, s84
    s_add_u32 m0, s86, 131072
    s_nop 0
    buffer_load_dwordx4 v4, s[4:7], s97 offen offset:0 lds
    buffer_load_dwordx4 v5, s[4:7], s97 offen offset:1024 lds
    v_mov_b32 v48, 0
    buffer_load_dwordx4 v6, s[4:7], s97 offen offset:2048 lds
    v_mov_b32 v49, 0
    buffer_load_dwordx4 v7, s[4:7], s97 offen offset:3072 lds
    v_mov_b32 v50, 0
    s_add_u32 s96, s94, 4
    s_and_b32 s96, s96, 15
    s_mul_i32 s96, s96, 393216
    s_add_u32 s96, s96, s85
    s_add_u32 m0, s87, 65536
    s_nop 0
    buffer_load_dwordx4 v8, s[16:19], s96 offen offset:0 lds
    v_mov_b32 v51, 0
    buffer_load_dwordx4 v9, s[16:19], s96 offen offset:1024 lds
    v_mov_b32 v140, 0
    buffer_load_dwordx4 v10, s[16:19], s96 offen offset:2048 lds
    v_mov_b32 v141, 0
    buffer_load_dwordx4 v11, s[16:19], s96 offen offset:3072 lds
    v_mov_b32 v142, 0
    s_add_u32 m0, s87, 69632
    s_nop 0
    buffer_load_dwordx4 v12, s[16:19], s96 offen offset:0 lds
    v_mov_b32 v143, 0
    buffer_load_dwordx4 v13, s[16:19], s96 offen offset:1024 lds
    v_dot2c_f32_bf16 v140, 0x3f803f80, v100
    v_dot2c_f32_bf16 v141, 0x3f803f80, v108
    v_dot2c_f32_bf16 v142, 0x3f803f80, v116
    v_dot2c_f32_bf16 v143, 0x3f803f80, v124
    v_dot2c_f32_bf16 v140, 0x3f803f80, v101
    v_dot2c_f32_bf16 v141, 0x3f803f80, v109
    v_dot2c_f32_bf16 v142, 0x3f803f80, v117
    v_dot2c_f32_bf16 v143, 0x3f803f80, v125
    v_dot2c_f32_bf16 v140, 0x3f803f80, v102
    v_dot2c_f32_bf16 v141, 0x3f803f80, v110
    v_dot2c_f32_bf16 v142, 0x3f803f80, v118
    v_dot2c_f32_bf16 v143, 0x3f803f80, v126
    v_dot2c_f32_bf16 v140, 0x3f803f80, v103
    v_dot2c_f32_bf16 v141, 0x3f803f80, v111
    v_dot2c_f32_bf16 v142, 0x3f803f80, v119
    v_dot2c_f32_bf16 v143, 0x3f803f80, v127
    v_dot2c_f32_bf16 v140, 0x3f803f80, v104
    v_dot2c_f32_bf16 v141, 0x3f803f80, v112
    v_dot2c_f32_bf16 v142, 0x3f803f80, v120
    v_dot2c_f32_bf16 v143, 0x3f803f80, v128
    v_dot2c_f32_bf16 v140, 0x3f803f80, v105
    v_dot2c_f32_bf16 v141, 0x3f803f80, v113
    v_dot2c_f32_bf16 v142, 0x3f803f80, v121
    v_dot2c_f32_bf16 v143, 0x3f803f80, v129
    v_dot2c_f32_bf16 v140, 0x3f803f80, v106
    v_dot2c_f32_bf16 v141, 0x3f803f80, v114
    v_dot2c_f32_bf16 v142, 0x3f803f80, v122
    v_dot2c_f32_bf16 v143, 0x3f803f80, v130
    v_dot2c_f32_bf16 v140, 0x3f803f80, v107
    v_dot2c_f32_bf16 v141, 0x3f803f80, v115
    v_dot2c_f32_bf16 v142, 0x3f803f80, v123
    v_dot2c_f32_bf16 v143, 0x3f803f80, v131
    v_dot2c_f32_bf16 v48, 0x3f803f80, v32
    v_dot2c_f32_bf16 v49, v32, v32
    v_dot2c_f32_bf16 v50, 0x3f803f80, v33
    v_dot2c_f32_bf16 v51, v33, v33
    v_dot2c_f32_bf16 v48, 0x3f803f80, v34
    v_dot2c_f32_bf16 v49, v34, v34
    v_dot2c_f32_bf16 v50, 0x3f803f80, v35
    v_dot2c_f32_bf16 v51, v35, v35
    v_dot2c_f32_bf16 v48, 0x3f803f80, v36
    v_dot2c_f32_bf16 v49, v36, v36
    v_dot2c_f32_bf16 v50, 0x3f803f80, v37
    v_dot2c_f32_bf16 v51, v37, v37
    v_dot2c_f32_bf16 v48, 0x3f803f80, v38
    v_dot2c_f32_bf16 v49, v38, v38
    v_dot2c_f32_bf16 v50, 0x3f803f80, v39
    v_dot2c_f32_bf16 v51, v39, v39
    v_dot2c_f32_bf16 v48, 0x3f803f80, v40
    v_dot2c_f32_bf16 v49, v40, v40
    v_dot2c_f32_bf16 v50, 0x3f803f80, v41
    v_dot2c_f32_bf16 v51, v41, v41
    v_dot2c_f32_bf16 v48, 0x3f803f80, v42
    v_dot2c_f32_bf16 v49, v42, v42
    v_dot2c_f32_bf16 v50, 0x3f803f80, v43
    v_dot2c_f32_bf16 v51, v43, v43
    v_dot2c_f32_bf16 v48, 0x3f803f80, v44
    v_dot2c_f32_bf16 v49, v44, v44
    v_dot2c_f32_bf16 v50, 0x3f803f80, v45
    v_dot2c_f32_bf16 v51, v45, v45
    v_dot2c_f32_bf16 v48, 0x3f803f80, v46
    v_dot2c_f32_bf16 v49, v46, v46
    v_dot2c_f32_bf16 v50, 0x3f803f80, v47
    v_dot2c_f32_bf16 v51, v47, v47
    s_waitcnt vmcnt(14) lgkmcnt(0)
    s_barrier
    s_add_u32 s96, s95, 5
    s_and_b32 s96, s96, 15
    s_lshl_b32 s97, s96, 7
    s_add_u32 s97, s97, s84
    s_add_u32 m0, s86, 114688
    s_nop 0
    buffer_load_dwordx4 v4, s[4:7], s97 offen offset:0 lds
    buffer_load_dwordx4 v5, s[4:7], s97 offen offset:1024 lds
    s_lshl_b32 s30, s99, 12
    s_lshl_b32 s31, s25, 8
    buffer_load_dwordx4 v6, s[4:7], s97 offen offset:2048 lds
    s_add_u32 s30, s30, s31
    s_add_u32 s30, s30, 0x2400000
    buffer_load_dwordx4 v7, s[4:7], s97 offen offset:3072 lds
    v_lshlrev_b32 v28, 3, v252
    s_add_u32 s96, s95, 5
    s_and_b32 s96, s96, 15
    s_mul_i32 s96, s96, 393216
    s_add_u32 s96, s96, s85
    s_add_u32 m0, s87, 90112
    s_nop 0
    buffer_load_dwordx4 v8, s[16:19], s96 offen offset:0 lds
    v_add_f32 v48, v48, v50
    v_add_f32 v49, v49, v51
    buffer_load_dwordx4 v9, s[16:19], s96 offen offset:1024 lds
    v_mov_b32 v50, v48
    v_mov_b32 v51, v49
    buffer_load_dwordx4 v10, s[16:19], s96 offen offset:2048 lds
    v_permlane32_swap_b32 v48, v50
    buffer_load_dwordx4 v11, s[16:19], s96 offen offset:3072 lds
    v_permlane32_swap_b32 v49, v51
    v_add_f32 v48, v48, v50
    s_add_u32 m0, s87, 94208
    s_nop 0
    buffer_load_dwordx4 v12, s[16:19], s96 offen offset:0 lds
    v_add_f32 v49, v49, v51
    buffer_load_dwordx4 v13, s[16:19], s96 offen offset:1024 lds
    s_mov_b32 exec_hi, 0
    buffer_store_dwordx2 v[48:49], v28, s[20:23], s30 offen sc1
    s_mov_b64 exec, -1
    s_min_u32 s32, s28, 2
    s_lshl_b32 s32, s32, 12
    s_lshl_b32 s33, s25, 14
    s_add_u32 s32, s32, s33
    s_add_u32 s32, s32, 0x2500000
    s_lshl_b32 s33, s24, 8
    s_add_u32 s32, s32, s33
    v_lshlrev_b32 v20, 2, v252
    v_permlane32_swap_b32 v140, v142
    v_permlane32_swap_b32 v141, v143
    v_add_f32 v140, v140, v142
    v_add_f32 v141, v141, v143
    s_nop 1
    v_permlane16_swap_b32 v140, v141
    v_add_f32 v140, v140, v141
    buffer_store_dword v140, v20, s[20:23], s32 offen sc1
    s_waitcnt vmcnt(12) lgkmcnt(0)
    s_barrier
    s_add_u32 s96, s94, 6
    s_and_b32 s96, s96, 15
    s_lshl_b32 s97, s96, 7
    s_add_u32 s97, s97, s84
    s_add_u32 m0, s86, 147456
    s_nop 0
    buffer_load_dwordx4 v4, s[4:7], s97 offen offset:0 lds
    buffer_load_dwordx4 v5, s[4:7], s97 offen offset:1024 lds
    buffer_load_dwordx4 v6, s[4:7], s97 offen offset:2048 lds
    buffer_load_dwordx4 v7, s[4:7], s97 offen offset:3072 lds
    s_add_u32 s96, s94, 6
    s_and_b32 s96, s96, 15
    s_mul_i32 s96, s96, 393216
    s_add_u32 s96, s96, s85
    s_add_u32 m0, s87, 40960
    s_nop 0
    buffer_load_dwordx4 v8, s[16:19], s96 offen offset:0 lds
    buffer_load_dwordx4 v9, s[16:19], s96 offen offset:1024 lds
    buffer_load_dwordx4 v10, s[16:19], s96 offen offset:2048 lds
    buffer_load_dwordx4 v11, s[16:19], s96 offen offset:3072 lds
    s_add_u32 m0, s87, 45056
    s_nop 0
    buffer_load_dwordx4 v12, s[16:19], s96 offen offset:0 lds
    buffer_load_dwordx4 v13, s[16:19], s96 offen offset:1024 lds
    s_waitcnt vmcnt(10) lgkmcnt(0)
    s_barrier
    s_add_u32 s96, s95, 7
    s_and_b32 s96, s96, 15
    s_lshl_b32 s97, s96, 7
    s_add_u32 s97, s97, s84
    s_add_u32 m0, s86, 131072
    s_nop 0
    buffer_load_dwordx4 v4, s[4:7], s97 offen offset:0 lds
    buffer_load_dwordx4 v5, s[4:7], s97 offen offset:1024 lds
    buffer_load_dwordx4 v6, s[4:7], s97 offen offset:2048 lds
    buffer_load_dwordx4 v7, s[4:7], s97 offen offset:3072 lds
    s_add_u32 s96, s95, 7
    s_and_b32 s96, s96, 15
    s_mul_i32 s96, s96, 393216
    s_add_u32 s96, s96, s85
    s_add_u32 m0, s87, 65536
    s_nop 0
    buffer_load_dwordx4 v8, s[16:19], s96 offen offset:0 lds
    buffer_load_dwordx4 v9, s[16:19], s96 offen offset:1024 lds
    buffer_load_dwordx4 v10, s[16:19], s96 offen offset:2048 lds
    buffer_load_dwordx4 v11, s[16:19], s96 offen offset:3072 lds
    s_add_u32 m0, s87, 69632
    s_nop 0
    buffer_load_dwordx4 v12, s[16:19], s96 offen offset:0 lds
    buffer_load_dwordx4 v13, s[16:19], s96 offen offset:1024 lds
    s_waitcnt vmcnt(10) lgkmcnt(0)
    s_barrier
    s_add_u32 s96, s94, 8
    s_and_b32 s96, s96, 15
    s_lshl_b32 s97, s96, 7
    s_add_u32 s97, s97, s84
    s_add_u32 m0, s86, 114688
    s_nop 0
    buffer_load_dwordx4 v4, s[4:7], s97 offen offset:0 lds
    buffer_load_dwordx4 v5, s[4:7], s97 offen offset:1024 lds
    buffer_load_dwordx4 v6, s[4:7], s97 offen offset:2048 lds
    buffer_load_dwordx4 v7, s[4:7], s97 offen offset:3072 lds
    s_add_u32 s96, s94, 8
    s_and_b32 s96, s96, 15
    s_mul_i32 s96, s96, 393216
    s_add_u32 s96, s96, s85
    s_add_u32 m0, s87, 90112
    s_nop 0
    buffer_load_dwordx4 v8, s[16:19], s96 offen offset:0 lds
    buffer_load_dwordx4 v9, s[16:19], s96 offen offset:1024 lds
    buffer_load_dwordx4 v10, s[16:19], s96 offen offset:2048 lds
    buffer_load_dwordx4 v11, s[16:19], s96 offen offset:3072 lds
    s_add_u32 m0, s87, 94208
    s_nop 0
    buffer_load_dwordx4 v12, s[16:19], s96 offen offset:0 lds
    buffer_load_dwordx4 v13, s[16:19], s96 offen offset:1024 lds
    s_waitcnt vmcnt(10) lgkmcnt(0)
    s_barrier
    s_add_u32 s96, s95, 9
    s_and_b32 s96, s96, 15
    s_lshl_b32 s97, s96, 7
    s_add_u32 s97, s97, s84
    s_add_u32 m0, s86, 147456
    s_nop 0
    buffer_load_dwordx4 v4, s[4:7], s97 offen offset:0 lds
    buffer_load_dwordx4 v5, s[4:7], s97 offen offset:1024 lds
    buffer_load_dwordx4 v6, s[4:7], s97 offen offset:2048 lds
    buffer_load_dwordx4 v7, s[4:7], s97 offen offset:3072 lds
    s_add_u32 s96, s95, 9
    s_and_b32 s96, s96, 15
    s_mul_i32 s96, s96, 393216
    s_add_u32 s96, s96, s85
    s_add_u32 m0, s87, 40960
    s_nop 0
    buffer_load_dwordx4 v8, s[16:19], s96 offen offset:0 lds
    buffer_load_dwordx4 v9, s[16:19], s96 offen offset:1024 lds
    buffer_load_dwordx4 v10, s[16:19], s96 offen offset:2048 lds
    buffer_load_dwordx4 v11, s[16:19], s96 offen offset:3072 lds
    s_add_u32 m0, s87, 45056
    s_nop 0
    buffer_load_dwordx4 v12, s[16:19], s96 offen offset:0 lds
    buffer_load_dwordx4 v13, s[16:19], s96 offen offset:1024 lds
    s_waitcnt vmcnt(10) lgkmcnt(0)
    s_barrier
    s_add_u32 s96, s94, 10
    s_and_b32 s96, s96, 15
    s_lshl_b32 s97, s96, 7
    s_add_u32 s97, s97, s84
    s_add_u32 m0, s86, 131072
    s_nop 0
    buffer_load_dwordx4 v4, s[4:7], s97 offen offset:0 lds
    buffer_load_dwordx4 v5, s[4:7], s97 offen offset:1024 lds
    buffer_load_dwordx4 v6, s[4:7], s97 offen offset:2048 lds
    buffer_load_dwordx4 v7, s[4:7], s97 offen offset:3072 lds
    s_add_u32 s96, s94, 10
    s_and_b32 s96, s96, 15
    s_mul_i32 s96, s96, 393216
    s_add_u32 s96, s96, s85
    s_add_u32 m0, s87, 65536
    s_nop 0
    buffer_load_dwordx4 v8, s[16:19], s96 offen offset:0 lds
    buffer_load_dwordx4 v9, s[16:19], s96 offen offset:1024 lds
    buffer_load_dwordx4 v10, s[16:19], s96 offen offset:2048 lds
    buffer_load_dwordx4 v11, s[16:19], s96 offen offset:3072 lds
    s_add_u32 m0, s87, 69632
    s_nop 0
    buffer_load_dwordx4 v12, s[16:19], s96 offen offset:0 lds
    buffer_load_dwordx4 v13, s[16:19], s96 offen offset:1024 lds
    s_waitcnt vmcnt(10) lgkmcnt(0)
    s_barrier
    s_add_u32 s96, s95, 11
    s_and_b32 s96, s96, 15
    s_lshl_b32 s97, s96, 7
    s_add_u32 s97, s97, s84
    s_add_u32 m0, s86, 114688
    s_nop 0
    buffer_load_dwordx4 v4, s[4:7], s97 offen offset:0 lds
    buffer_load_dwordx4 v5, s[4:7], s97 offen offset:1024 lds
    buffer_load_dwordx4 v6, s[4:7], s97 offen offset:2048 lds
    buffer_load_dwordx4 v7, s[4:7], s97 offen offset:3072 lds
    s_add_u32 s96, s95, 11
    s_and_b32 s96, s96, 15
    s_mul_i32 s96, s96, 393216
    s_add_u32 s96, s96, s85
    s_add_u32 m0, s87, 90112
    s_nop 0
    buffer_load_dwordx4 v8, s[16:19], s96 offen offset:0 lds
    buffer_load_dwordx4 v9, s[16:19], s96 offen offset:1024 lds
    buffer_load_dwordx4 v10, s[16:19], s96 offen offset:2048 lds
    buffer_load_dwordx4 v11, s[16:19], s96 offen offset:3072 lds
    s_add_u32 m0, s87, 94208
    s_nop 0
    buffer_load_dwordx4 v12, s[16:19], s96 offen offset:0 lds
    buffer_load_dwordx4 v13, s[16:19], s96 offen offset:1024 lds
    s_waitcnt vmcnt(10) lgkmcnt(0)
    s_barrier
    s_add_u32 s96, s94, 12
    s_and_b32 s96, s96, 15
    s_lshl_b32 s97, s96, 7
    s_add_u32 s97, s97, s84
    s_add_u32 m0, s86, 147456
    s_nop 0
    buffer_load_dwordx4 v4, s[4:7], s97 offen offset:0 lds
    buffer_load_dwordx4 v5, s[4:7], s97 offen offset:1024 lds
    s_getpc_b64 s[32:33]
pc_39:
    buffer_load_dwordx4 v6, s[4:7], s97 offen offset:2048 lds
    s_sub_u32 s32, s32, pc_39-interleave_layers__sliding_block__moe_arch_mod__prompt_kernel
    s_subb_u32 s33, s33, 0
    buffer_load_dwordx4 v7, s[4:7], s97 offen offset:3072 lds
    s_lshr_b32 s34, s2, 3
    s_add_u32 s96, s94, 12
    s_and_b32 s96, s96, 15
    s_mul_i32 s96, s96, 393216
    s_add_u32 s96, s96, s85
    s_add_u32 m0, s87, 40960
    s_nop 0
    buffer_load_dwordx4 v8, s[16:19], s96 offen offset:0 lds
    s_lshl_b32 s34, s34, 2
    buffer_load_dwordx4 v9, s[16:19], s96 offen offset:1024 lds
    s_add_u32 s34, s34, s28
    s_and_b32 s34, s34, 127
    buffer_load_dwordx4 v10, s[16:19], s96 offen offset:2048 lds
    s_lshl_b32 s34, s34, 7
    buffer_load_dwordx4 v11, s[16:19], s96 offen offset:3072 lds
    v_lshl_add_u32 v154, v252, 14, s34
    s_mov_b32 s34, k_exit-interleave_layers__sliding_block__moe_arch_mod__prompt_kernel
    s_add_u32 m0, s87, 45056
    s_nop 0
    buffer_load_dwordx4 v12, s[16:19], s96 offen offset:0 lds
    s_mov_b32 s35, 0x20000
    buffer_load_dwordx4 v13, s[16:19], s96 offen offset:1024 lds
    buffer_load_dword v154, v154, s[32:35], 0 offen
    s_waitcnt vmcnt(11) lgkmcnt(0)
    s_barrier
    buffer_load_dwordx2 v[16:17], v15, s[20:23], 0 offen sc1
    s_add_u32 s96, s95, 13
    s_and_b32 s96, s96, 15
    s_lshl_b32 s97, s96, 7
    s_add_u32 s97, s97, s84
    s_add_u32 m0, s86, 131072
    s_nop 0
    buffer_load_dwordx4 v4, s[4:7], s97 offen offset:0 lds
    buffer_load_dwordx4 v5, s[4:7], s97 offen offset:1024 lds
    buffer_load_dwordx4 v6, s[4:7], s97 offen offset:2048 lds
    buffer_load_dwordx4 v7, s[4:7], s97 offen offset:3072 lds
    s_add_u32 s96, s95, 13
    s_and_b32 s96, s96, 15
    s_mul_i32 s96, s96, 393216
    s_add_u32 s96, s96, s85
    s_add_u32 m0, s87, 65536
    s_nop 0
    buffer_load_dwordx4 v8, s[16:19], s96 offen offset:0 lds
    buffer_load_dwordx4 v9, s[16:19], s96 offen offset:1024 lds
    buffer_load_dwordx4 v10, s[16:19], s96 offen offset:2048 lds
    buffer_load_dwordx4 v11, s[16:19], s96 offen offset:3072 lds
    s_add_u32 m0, s87, 69632
    s_nop 0
    buffer_load_dwordx4 v12, s[16:19], s96 offen offset:0 lds
    buffer_load_dwordx4 v13, s[16:19], s96 offen offset:1024 lds
    s_waitcnt vmcnt(12) lgkmcnt(0)
    s_barrier
    s_add_u32 s96, s94, 14
    s_and_b32 s96, s96, 15
    s_lshl_b32 s97, s96, 7
    s_add_u32 s97, s97, s84
    s_add_u32 m0, s86, 114688
    s_nop 0
    buffer_load_dwordx4 v4, s[4:7], s97 offen offset:0 lds
    buffer_load_dwordx4 v5, s[4:7], s97 offen offset:1024 lds
    buffer_load_dwordx4 v6, s[4:7], s97 offen offset:2048 lds
    buffer_load_dwordx4 v7, s[4:7], s97 offen offset:3072 lds
    s_add_u32 s96, s94, 14
    s_and_b32 s96, s96, 15
    s_mul_i32 s96, s96, 393216
    s_add_u32 s96, s96, s85
    s_add_u32 m0, s87, 90112
    s_nop 0
    buffer_load_dwordx4 v8, s[16:19], s96 offen offset:0 lds
    buffer_load_dwordx4 v9, s[16:19], s96 offen offset:1024 lds
    buffer_load_dwordx4 v10, s[16:19], s96 offen offset:2048 lds
    buffer_load_dwordx4 v11, s[16:19], s96 offen offset:3072 lds
    s_add_u32 m0, s87, 94208
    s_nop 0
    buffer_load_dwordx4 v12, s[16:19], s96 offen offset:0 lds
    buffer_load_dwordx4 v13, s[16:19], s96 offen offset:1024 lds
    s_mov_b32 s78, s27
    s_waitcnt vmcnt(20)
    s_branch pc_41
pl_40:
    buffer_load_dwordx2 v[16:17], v15, s[20:23], 0 offen sc1
    s_waitcnt vmcnt(0)
pc_41:
    v_cmp_ne_u32 vcc, s88, v16
    s_cbranch_vccz pd_42
    s_sub_u32 s78, s78, 1
    s_cmp_lg_u32 s78, 0
    s_cbranch_scc1 pl_40
    s_mov_b32 s27, 1
pd_42:
    s_getreg_b32 s30, hwreg(HW_REG_XCC_ID, 0, 4)
    v_cmp_ne_u32 vcc, s30, v17
    s_and_b32 s30, vcc_lo, 0xffff
    s_cselect_b32 s77, 0, 1
    v_mov_b32 v20, s73
    v_mov_b32 v21, s77
    v_mov_b32 v19, 0
    ds_write_b64 v19, v[20:21] offset:3072
    s_waitcnt vmcnt(10) lgkmcnt(0)
    s_barrier
    s_add_u32 s96, s95, 15
    s_and_b32 s96, s96, 15
    s_lshl_b32 s97, s96, 7
    s_add_u32 s97, s97, s84
    s_add_u32 m0, s86, 147456
    s_nop 0
    buffer_load_dwordx4 v4, s[4:7], s97 offen offset:0 lds
    buffer_load_dwordx4 v5, s[4:7], s97 offen offset:1024 lds
    buffer_load_dwordx4 v6, s[4:7], s97 offen offset:2048 lds
    buffer_load_dwordx4 v7, s[4:7], s97 offen offset:3072 lds
    s_add_u32 s96, s95, 15
    s_and_b32 s96, s96, 15
    s_mul_i32 s96, s96, 393216
    s_add_u32 s96, s96, s85
    s_add_u32 m0, s87, 40960
    s_nop 0
    buffer_load_dwordx4 v8, s[16:19], s96 offen offset:0 lds
    buffer_load_dwordx4 v9, s[16:19], s96 offen offset:1024 lds
    buffer_load_dwordx4 v10, s[16:19], s96 offen offset:2048 lds
    buffer_load_dwordx4 v11, s[16:19], s96 offen offset:3072 lds
    s_add_u32 m0, s87, 45056
    s_nop 0
    buffer_load_dwordx4 v12, s[16:19], s96 offen offset:0 lds
    buffer_load_dwordx4 v13, s[16:19], s96 offen offset:1024 lds
    s_waitcnt vmcnt(10) lgkmcnt(0)
    s_barrier
    s_load_dwordx2 s[4:5], s[0:1], 48
    s_cmp_lt_u32 s29, 224
    s_cselect_b32 s6, 0x700000, 0
    s_mov_b32 s7, 0x20000
    s_lshl_b32 s30, s99, 12
    s_add_u32 s30, s30, 0x2400000
    buffer_load_dwordx4 v[64:67], v253, s[20:23], s30 offen offset:0 sc1
    buffer_load_dwordx4 v[68:71], v253, s[20:23], s30 offen offset:1024 sc1
    buffer_load_dwordx4 v[72:75], v253, s[20:23], s30 offen offset:2048 sc1
    buffer_load_dwordx4 v[76:79], v253, s[20:23], s30 offen offset:3072 sc1
    s_min_u32 s32, s28, 2
    s_lshl_b32 s32, s32, 12
    s_lshl_b32 s33, s25, 14
    s_add_u32 s32, s32, s33
    s_add_u32 s32, s32, 0x2500000
    buffer_load_dwordx4 v[32:35], v253, s[20:23], s32 offen offset:0 sc1
    buffer_load_dwordx4 v[36:39], v253, s[20:23], s32 offen offset:1024 sc1
    buffer_load_dwordx4 v[40:43], v253, s[20:23], s32 offen offset:2048 sc1
    buffer_load_dwordx4 v[44:47], v253, s[20:23], s32 offen offset:3072 sc1
    s_add_u32 s96, s25, 1
    s_and_b32 s96, s96, 15
    s_lshl_b32 s96, s96, 17
    s_add_u32 m0, s101, 4096
    s_nop 0
    buffer_load_dwordx4 v14, s[8:11], s96 offen lds
    s_add_u32 s96, s25, 2
    s_and_b32 s96, s96, 15
    s_lshl_b32 s96, s96, 17
    s_add_u32 m0, s101, 8192
    s_nop 0
    buffer_load_dwordx4 v14, s[8:11], s96 offen lds
    s_add_u32 s96, s25, 3
    s_and_b32 s96, s96, 15
    s_lshl_b32 s96, s96, 17
    s_add_u32 m0, s101, 12288
    s_nop 0
    buffer_load_dwordx4 v14, s[8:11], s96 offen lds
    s_waitcnt vmcnt(11) lgkmcnt(0)
    s_barrier
    s_waitcnt vmcnt(3)
    v_add_f32 v64, v64, v68
    v_add_f32 v65, v65, v69
    v_add_f32 v66, v66, v70
    v_add_f32 v67, v67, v71
    v_add_f32 v64, v64, v72
    v_add_f32 v65, v65, v73
    v_add_f32 v66, v66, v74
    v_add_f32 v67, v67, v75
    v_add_f32 v64, v64, v76
    v_add_f32 v65, v65, v77
    v_add_f32 v66, v66, v78
    v_add_f32 v67, v67, v79
    s_nop 0
    v_permlane32_swap_b32 v64, v66
    v_permlane32_swap_b32 v65, v67
    v_add_f32 v64, v64, v66
    v_add_f32 v65, v65, v67
    v_mov_b32 v48, v64
    v_mov_b32 v49, v65
    s_nop 0
    v_permlane16_swap_b32 v64, v48
    v_permlane16_swap_b32 v65, v49
    v_add_f32 v64, v64, v48
    v_add_f32 v65, v65, v49
    v_mul_f32 v54, 0x3a800000, v64
    v_mul_f32 v65, 0x3a800000, v65
    v_fma_f32 v65, -v54, v54, v65
    v_max_f32 v65, 0, v65
    v_add_f32 v55, 0x3727c5ac, v65
    v_rsq_f32 v55, v55
    v_add_f32 v32, v32, v36
    v_add_f32 v33, v33, v37
    v_add_f32 v34, v34, v38
    v_add_f32 v35, v35, v39
    v_add_f32 v32, v32, v40
    v_add_f32 v33, v33, v41
    v_add_f32 v34, v34, v42
    v_add_f32 v35, v35, v43
    v_add_f32 v32, v32, v44
    v_add_f32 v33, v33, v45
    v_add_f32 v34, v34, v46
    v_add_f32 v35, v35, v47
    s_nop 0
    v_permlane32_swap_b32 v32, v34
    v_permlane32_swap_b32 v33, v35
    v_add_f32 v32, v32, v34
    v_add_f32 v33, v33, v35
    s_nop 1
    v_permlane16_swap_b32 v32, v33
    v_add_f32 v32, v32, v33
    v_mov_b32 v2, v32
    v_and_b32 v48, 15, v252
    v_lshrrev_b32 v49, 5, v252
    v_lshl_add_u32 v48, v48, 1, v49
    v_bfe_u32 v49, v252, 4, 1
    v_cmp_eq_u32 vcc, 0, v49
    v_lshlrev_b32 v49, 9, v49
    v_lshl_add_u32 v48, v48, 2, v49
    s_lshl_b32 s32, s28, 7
    v_add_u32 v48, s32, v48
    v_cndmask_b32 v49, v54, v55, vcc
    v_cndmask_b32 v50, 0, 1.0, vcc
    ds_write_b32 v48, v49 offset:0
    ds_write_b32 v48, v50 offset:2048
    v_and_b32 v48, 15, v252
    v_lshrrev_b32 v51, 4, v252
    v_lshl_add_u32 v48, v48, 2, v51
    s_min_u32 s32, s28, 2
    s_lshl_b32 s32, s32, 8
    v_lshl_add_u32 v48, v48, 2, s32
    ds_write_b32 v48, v2 offset:1024
    s_waitcnt lgkmcnt(0)
    s_barrier
l_att:
    s_add_u32 s96, s25, 10
    s_and_b32 s96, s96, 15
    s_lshl_b32 s96, s96, 17
    s_add_u32 m0, s101, 40960
    s_nop 0
    buffer_load_dwordx4 v14, s[8:11], s96 offen lds
    s_add_u32 s96, s25, 11
    s_and_b32 s96, s96, 15
    s_lshl_b32 s96, s96, 17
    s_add_u32 m0, s101, 45056
    s_nop 0
    buffer_load_dwordx4 v14, s[8:11], s96 offen lds
    s_cmp_lg_u32 s26, 0
    s_cbranch_scc1 sk_43
    s_add_u32 s96, s25, 4
    s_and_b32 s96, s96, 15
    s_lshl_b32 s96, s96, 17
    s_add_u32 m0, s101, 16384
    s_nop 0
    buffer_load_dwordx4 v14, s[8:11], s96 offen lds
    s_add_u32 s96, s25, 5
    s_and_b32 s96, s96, 15
    s_lshl_b32 s96, s96, 17
    s_add_u32 m0, s101, 20480
    s_nop 0
    buffer_load_dwordx4 v14, s[8:11], s96 offen lds
    s_add_u32 s96, s25, 6
    s_and_b32 s96, s96, 15
    s_lshl_b32 s96, s96, 17
    s_add_u32 m0, s101, 24576
    s_nop 0
    buffer_load_dwordx4 v14, s[8:11], s96 offen lds
    s_add_u32 s96, s25, 7
    s_and_b32 s96, s96, 15
    s_lshl_b32 s96, s96, 17
    s_add_u32 m0, s101, 28672
    s_nop 0
    buffer_load_dwordx4 v14, s[8:11], s96 offen lds
    s_add_u32 s96, s25, 8
    s_and_b32 s96, s96, 15
    s_lshl_b32 s96, s96, 17
    s_add_u32 m0, s101, 32768
    s_nop 0
    buffer_load_dwordx4 v14, s[8:11], s96 offen lds
    s_add_u32 s96, s25, 9
    s_and_b32 s96, s96, 15
    s_lshl_b32 s96, s96, 17
    s_add_u32 m0, s101, 36864
    s_nop 0
    buffer_load_dwordx4 v14, s[8:11], s96 offen lds
sk_43:
    v_mov_b32 v20, 0xffff
    v_mov_b32 v21, 0xffff0000
    v_cndmask_b32 v22, 0, v20, s[40:41]
    v_cndmask_b32 v23, 0, v21, s[42:43]
    v_or_b32 v12, v22, v23
    v_cndmask_b32 v22, 0, v20, s[44:45]
    v_cndmask_b32 v23, 0, v21, s[46:47]
    v_or_b32 v13, v22, v23
    v_cndmask_b32 v22, 0, v20, s[48:49]
    v_cndmask_b32 v23, 0, v21, s[50:51]
    v_or_b32 v14, v22, v23
    v_cndmask_b32 v22, 0, v20, s[52:53]
    v_cndmask_b32 v23, 0, v21, s[54:55]
    v_or_b32 v15, v22, v23
    v_cndmask_b32 v22, 0, v20, s[56:57]
    v_cndmask_b32 v23, 0, v21, s[58:59]
    v_or_b32 v16, v22, v23
    v_cndmask_b32 v22, 0, v20, s[60:61]
    v_cndmask_b32 v23, 0, v21, s[62:63]
    v_or_b32 v17, v22, v23
    v_cndmask_b32 v22, 0, v20, s[64:65]
    v_cndmask_b32 v23, 0, v21, s[66:67]
    v_or_b32 v18, v22, v23
    v_cndmask_b32 v22, 0, v20, s[68:69]
    v_cndmask_b32 v23, 0, v21, s[70:71]
    v_or_b32 v19, v22, v23
    s_xor_b32 s76, s99, 3
    s_and_b32 s34, s76, 3
    s_lshl_b32 s33, s34, 12
    s_add_u32 s33, s33, 114688
    v_add_u32 v20, s33, v253
    v_add_u32 v22, 32768, v20
    v_add_u32 v23, 143360, v253
    s_add_u32 s74, s34, 1
    s_mov_b32 s75, 0
    s_lshl_b32 s34, s34, 11
    s_add_u32 s34, s34, 57344
    v_add_u32 v3, s34, v253
    v_mov_b32 v21, 0xf149f2ca
    v_cndmask_b32 v24, v21, 0, s[40:41]
    v_cndmask_b32 v25, v21, 0, s[42:43]
    v_cndmask_b32 v26, v21, 0, s[44:45]
    v_cndmask_b32 v27, v21, 0, s[46:47]
    v_cndmask_b32 v28, v21, 0, s[48:49]
    v_cndmask_b32 v29, v21, 0, s[50:51]
    v_cndmask_b32 v30, v21, 0, s[52:53]
    v_cndmask_b32 v31, v21, 0, s[54:55]
    v_cndmask_b32 v32, v21, 0, s[56:57]
    v_cndmask_b32 v33, v21, 0, s[58:59]
    v_cndmask_b32 v34, v21, 0, s[60:61]
    v_cndmask_b32 v35, v21, 0, s[62:63]
    v_cndmask_b32 v36, v21, 0, s[64:65]
    v_cndmask_b32 v37, v21, 0, s[66:67]
    v_cndmask_b32 v38, v21, 0, s[68:69]
    v_cndmask_b32 v39, v21, 0, s[70:71]
    v_lshrrev_b32 v40, 2, v252
    v_xor_b32 v40, v40, v252
    v_bfe_u32 v40, v40, 2, 1
    v_add_u32 v40, -1, v40
    v_and_b32 v40, 0x3f803f80, v40
    v_mov_b32 v41, v40
    v_mov_b32 v42, v40
    v_mov_b32 v43, v40
    v_mov_b32 v44, 0
    v_mov_b32 v45, 0
    v_mov_b32 v46, 0
    v_mov_b32 v47, 0
    v_mov_b32 v88, 0
    v_mov_b32 v89, 0
    v_mov_b32 v90, 0
    v_mov_b32 v91, 0
    v_mov_b32 v92, 0
    v_mov_b32 v93, 0
    v_mov_b32 v94, 0
    v_mov_b32 v95, 0
    v_mov_b32 v96, 0
    v_mov_b32 v97, 0
    v_mov_b32 v98, 0
    v_mov_b32 v99, 0
    v_mov_b32 v100, 0
    v_mov_b32 v101, 0
    v_mov_b32 v102, 0
    v_mov_b32 v103, 0
    s_lshr_b32 s36, s28, 1
    s_add_u32 s36, s36, s24
    s_sub_u32 s36, s36, 2
    s_and_b32 s34, s28, 1
    s_lshl_b32 s35, s25, 7
    s_lshl_b32 s30, s36, 2
    s_add_u32 s35, s35, s30
    s_lshl_b32 s30, s34, 1
    s_add_u32 s35, s35, s30
    s_lshl_b32 s35, s35, 12
    s_add_u32 s35, s35, s26
    s_lshl_b32 s30, s25, 8
    s_lshl_b32 s31, s36, 4
    s_add_u32 s30, s30, s31
    s_lshl_b32 s31, s34, 3
    s_add_u32 s30, s30, s31
    s_add_u32 s30, s30, s26
    s_add_u32 s30, s30, 0xdd0000
    v_and_b32 v48, 4, v252
    s_cmp_eq_u32 s100, 2
    s_cbranch_scc1 sk_44
    s_barrier
sk_44:
    s_cmp_lg_u32 s100, 0
    s_cbranch_scc1 l_patch
l_patched:
    ds_read_b128 v[4:7], v3
    ds_read_b128 v[8:11], v3 offset:1024
    ds_read_b128 v[112:115], v22 offset:0
    ds_read_b128 v[116:119], v22 offset:1024
    s_waitcnt lgkmcnt(0)
    v_mfma_f32_32x32x16_bf16 v[56:71], v[112:115], v[4:7], v[24:39]
    v_mfma_f32_32x32x16_bf16 v[56:71], v[116:119], v[8:11], v[56:71]
    ds_read_b128 v[104:107], v23 offset:4096
    ds_read_b128 v[124:127], v22 offset:3072
    ds_read_b128 v[108:111], v23 offset:5120
    ds_read_b128 v[120:123], v22 offset:2048
    s_cmp_lg_u32 s26, 0
    s_cbranch_scc1 sk_46
    s_xor_b32 s96, s29, 0
    s_and_b32 s97, s96, 2
    s_and_b32 s96, s96, 3
    s_mul_i32 s97, s97, 14336
    s_mul_i32 s96, s96, 14336
    s_add_u32 s96, s96, s97
    buffer_load_dwordx4 v[156:159], v155, s[80:83], s96 offen
    s_xor_b32 s96, s29, 0
    s_and_b32 s97, s96, 2
    s_and_b32 s96, s96, 3
    s_mul_i32 s97, s97, 14336
    s_mul_i32 s96, s96, 14336
    s_add_u32 s96, s96, s97
    s_add_u32 s96, s96, 7168
    buffer_load_dwordx4 v[160:163], v155, s[80:83], s96 offen
    s_xor_b32 s96, s29, 1
    s_and_b32 s97, s96, 2
    s_and_b32 s96, s96, 3
    s_mul_i32 s97, s97, 14336
    s_mul_i32 s96, s96, 14336
    s_add_u32 s96, s96, s97
    buffer_load_dwordx4 v[164:167], v155, s[80:83], s96 offen
    s_xor_b32 s96, s29, 1
    s_and_b32 s97, s96, 2
    s_and_b32 s96, s96, 3
    s_mul_i32 s97, s97, 14336
    s_mul_i32 s96, s96, 14336
    s_add_u32 s96, s96, s97
    s_add_u32 s96, s96, 7168
    buffer_load_dwordx4 v[168:171], v155, s[80:83], s96 offen
    s_xor_b32 s96, s29, 2
    s_and_b32 s97, s96, 2
    s_and_b32 s96, s96, 3
    s_mul_i32 s97, s97, 14336
    s_mul_i32 s96, s96, 14336
    s_add_u32 s96, s96, s97
    buffer_load_dwordx4 v[172:175], v155, s[80:83], s96 offen
    s_xor_b32 s96, s29, 2
    s_and_b32 s97, s96, 2
    s_and_b32 s96, s96, 3
    s_mul_i32 s97, s97, 14336
    s_mul_i32 s96, s96, 14336
    s_add_u32 s96, s96, s97
    s_add_u32 s96, s96, 7168
    buffer_load_dwordx4 v[176:179], v155, s[80:83], s96 offen
    s_xor_b32 s96, s29, 3
    s_and_b32 s97, s96, 2
    s_and_b32 s96, s96, 3
    s_mul_i32 s97, s97, 14336
    s_mul_i32 s96, s96, 14336
    s_add_u32 s96, s96, s97
    buffer_load_dwordx4 v[180:183], v155, s[80:83], s96 offen
    s_xor_b32 s96, s29, 3
    s_and_b32 s97, s96, 2
    s_and_b32 s96, s96, 3
    s_mul_i32 s97, s97, 14336
    s_mul_i32 s96, s96, 14336
    s_add_u32 s96, s96, s97
    s_add_u32 s96, s96, 7168
    buffer_load_dwordx4 v[184:187], v155, s[80:83], s96 offen
sk_46:
    s_nop 5
    v_max3_f32 v21, v56, v57, v58
    v_max3_f32 v152, v59, v60, v61
    v_max3_f32 v21, v21, v62, v63
    v_max3_f32 v152, v152, v64, v65
    v_max3_f32 v21, v21, v66, v67
    v_max3_f32 v152, v152, v68, v69
    v_max3_f32 v21, v21, v70, v71
    v_max_f32 v21, v21, v152
    v_mov_b32 v152, v21
    s_nop 1
    v_permlane32_swap_b32 v21, v152
    v_max_f32 v21, v21, v152
    v_sub_f32 v24, 0, v21
    v_sub_f32 v25, 0, v21
    v_sub_f32 v26, 0, v21
    v_sub_f32 v27, 0, v21
    v_sub_f32 v28, 0, v21
    v_sub_f32 v29, 0, v21
    v_sub_f32 v30, 0, v21
    v_sub_f32 v31, 0, v21
    v_sub_f32 v32, 0, v21
    v_sub_f32 v33, 0, v21
    v_sub_f32 v34, 0, v21
    v_sub_f32 v35, 0, v21
    v_sub_f32 v36, 0, v21
    v_sub_f32 v37, 0, v21
    v_sub_f32 v38, 0, v21
    v_sub_f32 v39, 0, v21
    s_branch a1_45_go
a1_45_mid:
    s_cmp_ge_u32 s76, 8
    s_cselect_b32 s33, 0, -1
    v_not_b32 v12, v12
    v_or_b32 v12, s33, v12
    v_not_b32 v13, v13
    v_or_b32 v13, s33, v13
    v_not_b32 v14, v14
    v_or_b32 v14, s33, v14
    v_not_b32 v15, v15
    v_or_b32 v15, s33, v15
    v_not_b32 v16, v16
    v_or_b32 v16, s33, v16
    v_not_b32 v17, v17
    v_or_b32 v17, s33, v17
    v_not_b32 v18, v18
    v_or_b32 v18, s33, v18
    v_not_b32 v19, v19
    v_or_b32 v19, s33, v19
    s_and_b32 s32, s76, 3
    s_cmp_ge_u32 s76, 8
    s_cselect_b32 s32, s32, 4
    s_sub_u32 s74, 8, s32
    s_lshl_b32 s32, s32, 12
    s_add_u32 s32, s32, 114688
    v_add_u32 v22, s32, v253
    v_add_u32 v23, s32, v253
    s_cmp_eq_u32 s26, 0
    s_cselect_b32 s75, 2, 1
    s_cmp_lt_i32 s36, 0
    s_cbranch_scc1 sk_47
    s_mov_b32 s78, s27
pl_48:
    buffer_load_dword v49, v48, s[20:23], s30 offen sc1
    s_waitcnt vmcnt(0)
pc_49:
    v_cmp_ne_u32 vcc, s88, v49
    s_cbranch_vccz pd_50
    s_sub_u32 s78, s78, 1
    s_cmp_lg_u32 s78, 0
    s_cbranch_scc1 pl_48
    s_mov_b32 s27, 1
pd_50:
    s_mov_b32 s36, -1
    s_lshl_b32 s30, s28, 13
    s_add_u32 m0, s30, 65536
    s_add_u32 s31, s35, 0
    buffer_load_dwordx4 v253, s[20:23], s31 offen offset:0 sc1 lds
    buffer_load_dwordx4 v253, s[20:23], s31 offen offset:1024 sc1 lds
    buffer_load_dwordx4 v253, s[20:23], s31 offen offset:2048 sc1 lds
    buffer_load_dwordx4 v253, s[20:23], s31 offen offset:3072 sc1 lds
    s_add_u32 m0, s30, 69632
    s_add_u32 s31, s35, 4096
    buffer_load_dwordx4 v253, s[20:23], s31 offen offset:0 sc1 lds
    buffer_load_dwordx4 v253, s[20:23], s31 offen offset:1024 sc1 lds
    buffer_load_dwordx4 v253, s[20:23], s31 offen offset:2048 sc1 lds
    buffer_load_dwordx4 v253, s[20:23], s31 offen offset:3072 sc1 lds
    s_add_u32 m0, s30, 114688
    s_add_u32 s31, s35, 262144
    buffer_load_dwordx4 v253, s[20:23], s31 offen offset:0 sc1 lds
    buffer_load_dwordx4 v253, s[20:23], s31 offen offset:1024 sc1 lds
    buffer_load_dwordx4 v253, s[20:23], s31 offen offset:2048 sc1 lds
    buffer_load_dwordx4 v253, s[20:23], s31 offen offset:3072 sc1 lds
    s_add_u32 m0, s30, 118784
    s_add_u32 s31, s35, 266240
    buffer_load_dwordx4 v253, s[20:23], s31 offen offset:0 sc1 lds
    buffer_load_dwordx4 v253, s[20:23], s31 offen offset:1024 sc1 lds
    buffer_load_dwordx4 v253, s[20:23], s31 offen offset:2048 sc1 lds
    buffer_load_dwordx4 v253, s[20:23], s31 offen offset:3072 sc1 lds
sk_47:
    s_waitcnt vmcnt(8)
    s_cmp_eq_u32 s100, 1
    s_cbranch_scc1 sk_51
    s_barrier
sk_51:
    s_waitcnt vmcnt(0)
    s_cmp_lg_u32 s100, 1
    s_cbranch_scc1 sk_52
    s_cmp_lg_u32 s38, 0
    s_barrier
    s_cselect_b64 exec, -1, 0
    ds_write_b16 v0, v1
    s_mov_b64 exec, -1
    s_waitcnt lgkmcnt(0)
    s_barrier
sk_52:
    s_barrier
    s_cmp_lt_u32 s76, 4
    s_cbranch_scc1 a1_45_none
    ds_read_b128 v[112:115], v22 offset:0
    ds_read_b128 v[116:119], v22 offset:1024
    ds_read_b128 v[104:107], v23 offset:4096
    ds_read_b128 v[124:127], v22 offset:3072
    ds_read_b128 v[108:111], v23 offset:5120
    ds_read_b128 v[120:123], v22 offset:2048
    s_waitcnt lgkmcnt(4)
a1_45_go:
    s_nop 0
    v_mfma_f32_32x32x16_bf16 v[56:71], v[112:115], v[4:7], v[24:39]
    v_mfma_f32_32x32x16_bf16 v[56:71], v[116:119], v[8:11], v[56:71]
    s_waitcnt lgkmcnt(3)
    v_mfma_f32_32x32x16_bf16 v[72:87], v[104:107], v[4:7], v[24:39]
    ds_read_b128 v[104:107], v23 offset:8192
    s_nop 8
    v_exp_f32 v56, v56
    v_exp_f32 v57, v57
    v_exp_f32 v58, v58
    ds_read_b128 v[128:131], v23 offset:7168
    v_exp_f32 v59, v59
    v_exp_f32 v60, v60
    v_exp_f32 v61, v61
    s_waitcnt lgkmcnt(2)
    v_mfma_f32_32x32x16_bf16 v[72:87], v[108:111], v[8:11], v[72:87]
    ds_read_b128 v[108:111], v23 offset:9216
    v_exp_f32 v62, v62
    v_exp_f32 v63, v63
    v_cvt_pk_bf16_f32 v136, v56, v57
    v_cvt_pk_bf16_f32 v137, v58, v59
    v_cvt_pk_bf16_f32 v138, v60, v61
    v_cvt_pk_bf16_f32 v139, v62, v63
    v_and_b32 v136, v136, v12
    v_and_b32 v137, v137, v13
    v_and_b32 v138, v138, v14
    v_and_b32 v139, v139, v15
    v_exp_f32 v64, v64
    v_exp_f32 v65, v65
    v_mfma_f32_32x32x16_bf16 v[88:103], v[120:123], v[136:139], v[88:103]
    ds_read_b128 v[120:123], v23 offset:6144
    s_cmp_eq_u32 s75, 0
    s_cbranch_scc1 sk_54
    s_cmp_lg_u32 s26, 0
    s_cbranch_scc1 sk_53
    s_xor_b32 s96, s29, 0
    s_and_b32 s97, s96, 2
    s_and_b32 s96, s96, 3
    s_mul_i32 s97, s97, 14336
    s_mul_i32 s96, s96, 14336
    s_add_u32 s96, s96, s97
    buffer_load_dwordx4 v[188:191], v155, s[4:7], s96 offen
    s_xor_b32 s96, s29, 0
    s_and_b32 s97, s96, 2
    s_and_b32 s96, s96, 3
    s_mul_i32 s97, s97, 14336
    s_mul_i32 s96, s96, 14336
    s_add_u32 s96, s96, s97
    s_add_u32 s96, s96, 7168
    buffer_load_dwordx4 v[192:195], v155, s[4:7], s96 offen
sk_53:
sk_54:
    v_exp_f32 v66, v66
    v_exp_f32 v67, v67
    v_exp_f32 v68, v68
    v_exp_f32 v69, v69
    v_mfma_f32_16x16x32_bf16 v[44:47], v[40:43], v[136:139], v[44:47]
    v_exp_f32 v70, v70
    v_exp_f32 v71, v71
    v_cvt_pk_bf16_f32 v140, v64, v65
    v_cvt_pk_bf16_f32 v141, v66, v67
    v_cvt_pk_bf16_f32 v142, v68, v69
    v_cvt_pk_bf16_f32 v143, v70, v71
    v_and_b32 v140, v140, v16
    v_and_b32 v141, v141, v17
    v_and_b32 v142, v142, v18
    v_and_b32 v143, v143, v19
    s_cmp_eq_u32 s75, 0
    s_cbranch_scc1 sk_56
    s_cmp_lg_u32 s26, 0
    s_cbranch_scc1 sk_55
    s_xor_b32 s96, s29, 1
    s_and_b32 s97, s96, 2
    s_and_b32 s96, s96, 3
    s_mul_i32 s97, s97, 14336
    s_mul_i32 s96, s96, 14336
    s_add_u32 s96, s96, s97
    buffer_load_dwordx4 v[196:199], v155, s[4:7], s96 offen
    s_xor_b32 s96, s29, 1
    s_and_b32 s97, s96, 2
    s_and_b32 s96, s96, 3
    s_mul_i32 s97, s97, 14336
    s_mul_i32 s96, s96, 14336
    s_add_u32 s96, s96, s97
    s_add_u32 s96, s96, 7168
    buffer_load_dwordx4 v[200:203], v155, s[4:7], s96 offen
sk_55:
sk_56:
    s_cmp_eq_u32 s74, 1
    s_cbranch_scc1 a1_45_e0
    s_cmp_eq_u32 s74, 2
    s_cbranch_scc1 a1_45_t1
    s_waitcnt lgkmcnt(3)
    v_mfma_f32_32x32x16_bf16 v[56:71], v[104:107], v[4:7], v[24:39]
    ds_read_b128 v[104:107], v23 offset:12288
    v_exp_f32 v72, v72
    v_exp_f32 v73, v73
    v_exp_f32 v74, v74
    v_mfma_f32_32x32x16_bf16 v[88:103], v[124:127], v[140:143], v[88:103]
    ds_read_b128 v[124:127], v23 offset:11264
    v_exp_f32 v75, v75
    v_exp_f32 v76, v76
    v_exp_f32 v77, v77
    s_waitcnt lgkmcnt(2)
    v_mfma_f32_32x32x16_bf16 v[56:71], v[108:111], v[8:11], v[56:71]
    ds_read_b128 v[108:111], v23 offset:13312
    v_exp_f32 v78, v78
    v_exp_f32 v79, v79
    v_cvt_pk_bf16_f32 v136, v72, v73
    v_cvt_pk_bf16_f32 v137, v74, v75
    v_mfma_f32_16x16x32_bf16 v[44:47], v[40:43], v[140:143], v[44:47]
    v_cvt_pk_bf16_f32 v138, v76, v77
    v_cvt_pk_bf16_f32 v139, v78, v79
    v_exp_f32 v80, v80
    v_exp_f32 v81, v81
    v_mfma_f32_32x32x16_bf16 v[88:103], v[120:123], v[136:139], v[88:103]
    ds_read_b128 v[120:123], v23 offset:10240
    s_cmp_eq_u32 s75, 0
    s_cbranch_scc1 sk_58
    s_cmp_lg_u32 s26, 0
    s_cbranch_scc1 sk_57
    s_xor_b32 s96, s29, 2
    s_and_b32 s97, s96, 2
    s_and_b32 s96, s96, 3
    s_mul_i32 s97, s97, 14336
    s_mul_i32 s96, s96, 14336
    s_add_u32 s96, s96, s97
    buffer_load_dwordx4 v[204:207], v155, s[4:7], s96 offen
sk_57:
sk_58:
    v_exp_f32 v82, v82
    v_exp_f32 v83, v83
    v_exp_f32 v84, v84
    v_exp_f32 v85, v85
    v_mfma_f32_16x16x32_bf16 v[44:47], v[40:43], v[136:139], v[44:47]
    v_exp_f32 v86, v86
    v_exp_f32 v87, v87
    v_cvt_pk_bf16_f32 v140, v80, v81
    v_cvt_pk_bf16_f32 v141, v82, v83
    v_cvt_pk_bf16_f32 v142, v84, v85
    v_cvt_pk_bf16_f32 v143, v86, v87
    s_cmp_eq_u32 s75, 0
    s_cbranch_scc1 sk_60
    s_cmp_lg_u32 s26, 0
    s_cbranch_scc1 sk_59
    s_xor_b32 s96, s29, 2
    s_and_b32 s97, s96, 2
    s_and_b32 s96, s96, 3
    s_mul_i32 s97, s97, 14336
    s_mul_i32 s96, s96, 14336
    s_add_u32 s96, s96, s97
    s_add_u32 s96, s96, 7168
    buffer_load_dwordx4 v[208:211], v155, s[4:7], s96 offen
sk_59:
sk_60:
    s_cmp_eq_u32 s74, 3
    s_cbranch_scc1 a1_45_t0
    s_waitcnt lgkmcnt(3)
    v_mfma_f32_32x32x16_bf16 v[72:87], v[104:107], v[4:7], v[24:39]
    ds_read_b128 v[104:107], v23 offset:16384
    v_exp_f32 v56, v56
    v_exp_f32 v57, v57
    v_exp_f32 v58, v58
    v_mfma_f32_32x32x16_bf16 v[88:103], v[128:131], v[140:143], v[88:103]
    ds_read_b128 v[128:131], v23 offset:15360
    v_exp_f32 v59, v59
    v_exp_f32 v60, v60
    v_exp_f32 v61, v61
    s_waitcnt lgkmcnt(2)
    v_mfma_f32_32x32x16_bf16 v[72:87], v[108:111], v[8:11], v[72:87]
    ds_read_b128 v[108:111], v23 offset:17408
    v_exp_f32 v62, v62
    v_exp_f32 v63, v63
    v_cvt_pk_bf16_f32 v136, v56, v57
    v_cvt_pk_bf16_f32 v137, v58, v59
    v_mfma_f32_16x16x32_bf16 v[44:47], v[40:43], v[140:143], v[44:47]
    v_cvt_pk_bf16_f32 v138, v60, v61
    v_cvt_pk_bf16_f32 v139, v62, v63
    v_exp_f32 v64, v64
    v_exp_f32 v65, v65
    v_mfma_f32_32x32x16_bf16 v[88:103], v[120:123], v[136:139], v[88:103]
    ds_read_b128 v[120:123], v23 offset:14336
    s_cmp_eq_u32 s75, 0
    s_cbranch_scc1 sk_62
    s_cmp_lg_u32 s26, 0
    s_cbranch_scc1 sk_61
    s_xor_b32 s96, s29, 3
    s_and_b32 s97, s96, 2
    s_and_b32 s96, s96, 3
    s_mul_i32 s97, s97, 14336
    s_mul_i32 s96, s96, 14336
    s_add_u32 s96, s96, s97
    buffer_load_dwordx4 v[212:215], v155, s[4:7], s96 offen
sk_61:
sk_62:
    v_exp_f32 v66, v66
    v_exp_f32 v67, v67
    v_exp_f32 v68, v68
    v_exp_f32 v69, v69
    v_mfma_f32_16x16x32_bf16 v[44:47], v[40:43], v[136:139], v[44:47]
    v_exp_f32 v70, v70
    v_exp_f32 v71, v71
    v_cvt_pk_bf16_f32 v140, v64, v65
    v_cvt_pk_bf16_f32 v141, v66, v67
    v_cvt_pk_bf16_f32 v142, v68, v69
    v_cvt_pk_bf16_f32 v143, v70, v71
    s_cmp_eq_u32 s75, 0
    s_cbranch_scc1 sk_64
    s_barrier
    s_cmp_lg_u32 s26, 0
    s_cbranch_scc1 sk_63
    s_xor_b32 s96, s29, 3
    s_and_b32 s97, s96, 2
    s_and_b32 s96, s96, 3
    s_mul_i32 s97, s97, 14336
    s_mul_i32 s96, s96, 14336
    s_add_u32 s96, s96, s97
    s_add_u32 s96, s96, 7168
    buffer_load_dwordx4 v[216:219], v155, s[4:7], s96 offen
sk_63:
sk_64:
    s_cmp_eq_u32 s74, 4
    s_cbranch_scc1 a1_45_t1
    s_waitcnt lgkmcnt(3)
    v_mfma_f32_32x32x16_bf16 v[56:71], v[104:107], v[4:7], v[24:39]
    ds_read_b128 v[104:107], v23 offset:20480
    v_exp_f32 v72, v72
    v_exp_f32 v73, v73
    v_exp_f32 v74, v74
    v_mfma_f32_32x32x16_bf16 v[88:103], v[124:127], v[140:143], v[88:103]
    ds_read_b128 v[124:127], v23 offset:19456
    v_exp_f32 v75, v75
    v_exp_f32 v76, v76
    v_exp_f32 v77, v77
    s_waitcnt lgkmcnt(2)
    v_mfma_f32_32x32x16_bf16 v[56:71], v[108:111], v[8:11], v[56:71]
    ds_read_b128 v[108:111], v23 offset:21504
    v_exp_f32 v78, v78
    v_exp_f32 v79, v79
    v_cvt_pk_bf16_f32 v136, v72, v73
    v_cvt_pk_bf16_f32 v137, v74, v75
    v_mfma_f32_16x16x32_bf16 v[44:47], v[40:43], v[140:143], v[44:47]
    v_cvt_pk_bf16_f32 v138, v76, v77
    v_cvt_pk_bf16_f32 v139, v78, v79
    v_exp_f32 v80, v80
    v_exp_f32 v81, v81
    v_mfma_f32_32x32x16_bf16 v[88:103], v[120:123], v[136:139], v[88:103]
    ds_read_b128 v[120:123], v23 offset:18432
    v_exp_f32 v82, v82
    v_exp_f32 v83, v83
    v_exp_f32 v84, v84
    v_exp_f32 v85, v85
    v_mfma_f32_16x16x32_bf16 v[44:47], v[40:43], v[136:139], v[44:47]
    v_exp_f32 v86, v86
    v_exp_f32 v87, v87
    v_cvt_pk_bf16_f32 v140, v80, v81
    v_cvt_pk_bf16_f32 v141, v82, v83
    v_cvt_pk_bf16_f32 v142, v84, v85
    v_cvt_pk_bf16_f32 v143, v86, v87
    s_cmp_eq_u32 s74, 5
    s_cbranch_scc1 a1_45_t0
    s_waitcnt lgkmcnt(3)
    v_mfma_f32_32x32x16_bf16 v[72:87], v[104:107], v[4:7], v[24:39]
    ds_read_b128 v[104:107], v23 offset:24576
    v_exp_f32 v56, v56
    v_exp_f32 v57, v57
    v_exp_f32 v58, v58
    v_mfma_f32_32x32x16_bf16 v[88:103], v[128:131], v[140:143], v[88:103]
    ds_read_b128 v[128:131], v23 offset:23552
    v_exp_f32 v59, v59
    v_exp_f32 v60, v60
    v_exp_f32 v61, v61
    s_waitcnt lgkmcnt(2)
    v_mfma_f32_32x32x16_bf16 v[72:87], v[108:111], v[8:11], v[72:87]
    ds_read_b128 v[108:111], v23 offset:25600
    v_exp_f32 v62, v62
    v_exp_f32 v63, v63
    v_cvt_pk_bf16_f32 v136, v56, v57
    v_cvt_pk_bf16_f32 v137, v58, v59
    v_mfma_f32_16x16x32_bf16 v[44:47], v[40:43], v[140:143], v[44:47]
    v_cvt_pk_bf16_f32 v138, v60, v61
    v_cvt_pk_bf16_f32 v139, v62, v63
    v_exp_f32 v64, v64
    v_exp_f32 v65, v65
    v_mfma_f32_32x32x16_bf16 v[88:103], v[120:123], v[136:139], v[88:103]
    ds_read_b128 v[120:123], v23 offset:22528
    v_exp_f32 v66, v66
    v_exp_f32 v67, v67
    v_exp_f32 v68, v68
    v_exp_f32 v69, v69
    v_mfma_f32_16x16x32_bf16 v[44:47], v[40:43], v[136:139], v[44:47]
    v_exp_f32 v70, v70
    v_exp_f32 v71, v71
    v_cvt_pk_bf16_f32 v140, v64, v65
    v_cvt_pk_bf16_f32 v141, v66, v67
    v_cvt_pk_bf16_f32 v142, v68, v69
    v_cvt_pk_bf16_f32 v143, v70, v71
    s_cmp_eq_u32 s74, 6
    s_cbranch_scc1 a1_45_t1
    s_waitcnt lgkmcnt(3)
    v_mfma_f32_32x32x16_bf16 v[56:71], v[104:107], v[4:7], v[24:39]
    ds_read_b128 v[104:107], v23 offset:28672
    v_exp_f32 v72, v72
    v_exp_f32 v73, v73
    v_exp_f32 v74, v74
    v_mfma_f32_32x32x16_bf16 v[88:103], v[124:127], v[140:143], v[88:103]
    ds_read_b128 v[124:127], v23 offset:27648
    v_exp_f32 v75, v75
    v_exp_f32 v76, v76
    v_exp_f32 v77, v77
    s_waitcnt lgkmcnt(2)
    v_mfma_f32_32x32x16_bf16 v[56:71], v[108:111], v[8:11], v[56:71]
    ds_read_b128 v[108:111], v23 offset:29696
    v_exp_f32 v78, v78
    v_exp_f32 v79, v79
    v_cvt_pk_bf16_f32 v136, v72, v73
    v_cvt_pk_bf16_f32 v137, v74, v75
    v_mfma_f32_16x16x32_bf16 v[44:47], v[40:43], v[140:143], v[44:47]
    v_cvt_pk_bf16_f32 v138, v76, v77
    v_cvt_pk_bf16_f32 v139, v78, v79
    v_exp_f32 v80, v80
    v_exp_f32 v81, v81
    v_mfma_f32_32x32x16_bf16 v[88:103], v[120:123], v[136:139], v[88:103]
    ds_read_b128 v[120:123], v23 offset:26624
    v_exp_f32 v82, v82
    v_exp_f32 v83, v83
    v_exp_f32 v84, v84
    v_exp_f32 v85, v85
    v_mfma_f32_16x16x32_bf16 v[44:47], v[40:43], v[136:139], v[44:47]
    v_exp_f32 v86, v86
    v_exp_f32 v87, v87
    v_cvt_pk_bf16_f32 v140, v80, v81
    v_cvt_pk_bf16_f32 v141, v82, v83
    v_cvt_pk_bf16_f32 v142, v84, v85
    v_cvt_pk_bf16_f32 v143, v86, v87
    s_cmp_eq_u32 s74, 7
    s_cbranch_scc1 a1_45_t0
    s_waitcnt lgkmcnt(3)
    v_mfma_f32_32x32x16_bf16 v[72:87], v[104:107], v[4:7], v[24:39]
    ds_read_b128 v[104:107], v23 offset:24576
    v_exp_f32 v56, v56
    v_exp_f32 v57, v57
    v_exp_f32 v58, v58
    v_mfma_f32_32x32x16_bf16 v[88:103], v[128:131], v[140:143], v[88:103]
    ds_read_b128 v[128:131], v23 offset:31744
    v_exp_f32 v59, v59
    v_exp_f32 v60, v60
    v_exp_f32 v61, v61
    s_waitcnt lgkmcnt(2)
    v_mfma_f32_32x32x16_bf16 v[72:87], v[108:111], v[8:11], v[72:87]
    ds_read_b128 v[108:111], v23 offset:25600
    v_exp_f32 v62, v62
    v_exp_f32 v63, v63
    v_cvt_pk_bf16_f32 v136, v56, v57
    v_cvt_pk_bf16_f32 v137, v58, v59
    v_mfma_f32_16x16x32_bf16 v[44:47], v[40:43], v[140:143], v[44:47]
    v_cvt_pk_bf16_f32 v138, v60, v61
    v_cvt_pk_bf16_f32 v139, v62, v63
    v_exp_f32 v64, v64
    v_exp_f32 v65, v65
    v_mfma_f32_32x32x16_bf16 v[88:103], v[120:123], v[136:139], v[88:103]
    ds_read_b128 v[120:123], v23 offset:30720
    v_exp_f32 v66, v66
    v_exp_f32 v67, v67
    v_exp_f32 v68, v68
    v_exp_f32 v69, v69
    v_mfma_f32_16x16x32_bf16 v[44:47], v[40:43], v[136:139], v[44:47]
    v_exp_f32 v70, v70
    v_exp_f32 v71, v71
    v_cvt_pk_bf16_f32 v140, v64, v65
    v_cvt_pk_bf16_f32 v141, v66, v67
    v_cvt_pk_bf16_f32 v142, v68, v69
    v_cvt_pk_bf16_f32 v143, v70, v71
a1_45_t1:
    v_exp_f32 v72, v72
    v_exp_f32 v73, v73
    v_exp_f32 v74, v74
    v_mfma_f32_32x32x16_bf16 v[88:103], v[124:127], v[140:143], v[88:103]
    v_exp_f32 v75, v75
    v_exp_f32 v76, v76
    v_exp_f32 v77, v77
    v_exp_f32 v78, v78
    v_exp_f32 v79, v79
    v_cvt_pk_bf16_f32 v136, v72, v73
    v_cvt_pk_bf16_f32 v137, v74, v75
    v_mfma_f32_16x16x32_bf16 v[44:47], v[40:43], v[140:143], v[44:47]
    v_cvt_pk_bf16_f32 v138, v76, v77
    v_cvt_pk_bf16_f32 v139, v78, v79
    v_exp_f32 v80, v80
    v_exp_f32 v81, v81
    s_waitcnt lgkmcnt(0)
    v_mfma_f32_32x32x16_bf16 v[88:103], v[120:123], v[136:139], v[88:103]
    v_exp_f32 v82, v82
    v_exp_f32 v83, v83
    v_exp_f32 v84, v84
    v_exp_f32 v85, v85
    v_mfma_f32_16x16x32_bf16 v[44:47], v[40:43], v[136:139], v[44:47]
    v_exp_f32 v86, v86
    v_exp_f32 v87, v87
    v_cvt_pk_bf16_f32 v140, v80, v81
    v_cvt_pk_bf16_f32 v141, v82, v83
    v_cvt_pk_bf16_f32 v142, v84, v85
    v_cvt_pk_bf16_f32 v143, v86, v87
a1_45_e1:
    s_cmp_eq_u32 s75, 0
    s_nop 0
    v_mfma_f32_16x16x32_bf16 v[44:47], v[40:43], v[140:143], v[44:47]
    v_mfma_f32_32x32x16_bf16 v[88:103], v[128:131], v[140:143], v[88:103]
    s_cbranch_scc1 a1_45_mid
    s_branch a1_45_fin
a1_45_t0:
    v_exp_f32 v56, v56
    v_exp_f32 v57, v57
    v_exp_f32 v58, v58
    v_mfma_f32_32x32x16_bf16 v[88:103], v[128:131], v[140:143], v[88:103]
    v_exp_f32 v59, v59
    v_exp_f32 v60, v60
    v_exp_f32 v61, v61
    v_exp_f32 v62, v62
    v_exp_f32 v63, v63
    v_cvt_pk_bf16_f32 v136, v56, v57
    v_cvt_pk_bf16_f32 v137, v58, v59
    v_mfma_f32_16x16x32_bf16 v[44:47], v[40:43], v[140:143], v[44:47]
    v_cvt_pk_bf16_f32 v138, v60, v61
    v_cvt_pk_bf16_f32 v139, v62, v63
    v_exp_f32 v64, v64
    v_exp_f32 v65, v65
    s_waitcnt lgkmcnt(0)
    v_mfma_f32_32x32x16_bf16 v[88:103], v[120:123], v[136:139], v[88:103]
    v_exp_f32 v66, v66
    v_exp_f32 v67, v67
    v_exp_f32 v68, v68
    v_exp_f32 v69, v69
    v_mfma_f32_16x16x32_bf16 v[44:47], v[40:43], v[136:139], v[44:47]
    v_exp_f32 v70, v70
    v_exp_f32 v71, v71
    v_cvt_pk_bf16_f32 v140, v64, v65
    v_cvt_pk_bf16_f32 v141, v66, v67
    v_cvt_pk_bf16_f32 v142, v68, v69
    v_cvt_pk_bf16_f32 v143, v70, v71
a1_45_e0:
    s_cmp_eq_u32 s75, 0
    s_nop 0
    v_mfma_f32_16x16x32_bf16 v[44:47], v[40:43], v[140:143], v[44:47]
    v_mfma_f32_32x32x16_bf16 v[88:103], v[124:127], v[140:143], v[88:103]
    s_cbranch_scc1 a1_45_mid
    s_branch a1_45_fin
a1_45_none:
    s_cmp_lg_u32 s26, 0
    s_cbranch_scc1 sk_65
    s_xor_b32 s96, s29, 0
    s_and_b32 s97, s96, 2
    s_and_b32 s96, s96, 3
    s_mul_i32 s97, s97, 14336
    s_mul_i32 s96, s96, 14336
    s_add_u32 s96, s96, s97
    buffer_load_dwordx4 v[188:191], v155, s[4:7], s96 offen
    s_xor_b32 s96, s29, 0
    s_and_b32 s97, s96, 2
    s_and_b32 s96, s96, 3
    s_mul_i32 s97, s97, 14336
    s_mul_i32 s96, s96, 14336
    s_add_u32 s96, s96, s97
    s_add_u32 s96, s96, 7168
    buffer_load_dwordx4 v[192:195], v155, s[4:7], s96 offen
sk_65:
    s_cmp_lg_u32 s26, 0
    s_cbranch_scc1 sk_66
    s_xor_b32 s96, s29, 1
    s_and_b32 s97, s96, 2
    s_and_b32 s96, s96, 3
    s_mul_i32 s97, s97, 14336
    s_mul_i32 s96, s96, 14336
    s_add_u32 s96, s96, s97
    buffer_load_dwordx4 v[196:199], v155, s[4:7], s96 offen
    s_xor_b32 s96, s29, 1
    s_and_b32 s97, s96, 2
    s_and_b32 s96, s96, 3
    s_mul_i32 s97, s97, 14336
    s_mul_i32 s96, s96, 14336
    s_add_u32 s96, s96, s97
    s_add_u32 s96, s96, 7168
    buffer_load_dwordx4 v[200:203], v155, s[4:7], s96 offen
sk_66:
    s_cmp_lg_u32 s26, 0
    s_cbranch_scc1 sk_67
    s_xor_b32 s96, s29, 2
    s_and_b32 s97, s96, 2
    s_and_b32 s96, s96, 3
    s_mul_i32 s97, s97, 14336
    s_mul_i32 s96, s96, 14336
    s_add_u32 s96, s96, s97
    buffer_load_dwordx4 v[204:207], v155, s[4:7], s96 offen
sk_67:
    s_cmp_lg_u32 s26, 0
    s_cbranch_scc1 sk_68
    s_xor_b32 s96, s29, 2
    s_and_b32 s97, s96, 2
    s_and_b32 s96, s96, 3
    s_mul_i32 s97, s97, 14336
    s_mul_i32 s96, s96, 14336
    s_add_u32 s96, s96, s97
    s_add_u32 s96, s96, 7168
    buffer_load_dwordx4 v[208:211], v155, s[4:7], s96 offen
sk_68:
    s_cmp_lg_u32 s26, 0
    s_cbranch_scc1 sk_69
    s_xor_b32 s96, s29, 3
    s_and_b32 s97, s96, 2
    s_and_b32 s96, s96, 3
    s_mul_i32 s97, s97, 14336
    s_mul_i32 s96, s96, 14336
    s_add_u32 s96, s96, s97
    buffer_load_dwordx4 v[212:215], v155, s[4:7], s96 offen
sk_69:
    s_barrier
    s_cmp_lg_u32 s26, 0
    s_cbranch_scc1 sk_70
    s_xor_b32 s96, s29, 3
    s_and_b32 s97, s96, 2
    s_and_b32 s96, s96, 3
    s_mul_i32 s97, s97, 14336
    s_mul_i32 s96, s96, 14336
    s_add_u32 s96, s96, s97
    s_add_u32 s96, s96, 7168
    buffer_load_dwordx4 v[216:219], v155, s[4:7], s96 offen
sk_70:
a1_45_fin:
    s_lshl_b32 s36, s76, 16
    s_add_u32 s36, s36, 0x808000
    s_lshl_b32 s33, s25, 11
    s_add_u32 s33, s33, s36
    s_lshl_b32 s30, s24, 9
    s_and_b32 s31, s76, 3
    s_lshl_b32 s31, s31, 6
    s_add_u32 s30, s30, s31
    s_add_u32 s30, s30, s26
    s_add_u32 s30, s30, 0xdd2100
    s_lshl_b32 s31, s25, 2
    s_add_u32 s31, s31, s30
    v_cmp_ngt_f32 vcc, 0x5d800000, v44
    v_rcp_f32 v22, v44
    s_cbranch_vccnz att_exact1
att_ret1:
    s_nop 3
    v_pk_mul_f32 v[88:89], v[88:89], v[22:23] op_sel_hi:[1,0]
    v_pk_mul_f32 v[90:91], v[90:91], v[22:23] op_sel_hi:[1,0]
    v_pk_mul_f32 v[92:93], v[92:93], v[22:23] op_sel_hi:[1,0]
    v_pk_mul_f32 v[94:95], v[94:95], v[22:23] op_sel_hi:[1,0]
    v_pk_mul_f32 v[96:97], v[96:97], v[22:23] op_sel_hi:[1,0]
    v_pk_mul_f32 v[98:99], v[98:99], v[22:23] op_sel_hi:[1,0]
    v_pk_mul_f32 v[100:101], v[100:101], v[22:23] op_sel_hi:[1,0]
    v_pk_mul_f32 v[102:103], v[102:103], v[22:23] op_sel_hi:[1,0]
    v_cvt_pk_bf16_f32 v88, v88, v89
    v_cvt_pk_bf16_f32 v89, v90, v91
    v_cvt_pk_bf16_f32 v90, v92, v93
    v_cvt_pk_bf16_f32 v91, v94, v95
    v_cvt_pk_bf16_f32 v92, v96, v97
    v_cvt_pk_bf16_f32 v93, v98, v99
    v_cvt_pk_bf16_f32 v94, v100, v101
    v_cvt_pk_bf16_f32 v95, v102, v103
    s_cmp_lg_u32 s77, 0
    s_cbranch_scc1 lc_71
    buffer_store_dwordx4 v[88:91], v253, s[20:23], s33 offen sc1
    buffer_store_dwordx4 v[92:95], v253, s[20:23], s33 offen offset:1024 sc1
    s_branch lc_72
lc_71:
    buffer_store_dwordx4 v[88:91], v253, s[20:23], s33 offen
    buffer_store_dwordx4 v[92:95], v253, s[20:23], s33 offen offset:1024
lc_72:
    v_mov_b32 v154, s88
    s_mov_b64 exec, 1
    s_waitcnt vmcnt(0)
    s_cmp_lg_u32 s77, 0
    s_cbranch_scc1 lc_73
    buffer_store_dword v154, v253, s[20:23], s31 offen sc1
    s_branch lc_74
lc_73:
    buffer_store_dword v154, v253, s[20:23], s31 offen
lc_74:
    s_mov_b64 exec, -1
    s_cmp_lg_u32 s26, 0
    s_cbranch_scc1 sk_75
    s_mov_b32 s96, 0
    buffer_load_dwordx4 v[220:223], v153, s[12:15], s96 offen
    s_mov_b32 s96, 2048
    buffer_load_dwordx4 v[224:227], v153, s[12:15], s96 offen
    s_mov_b32 s96, 4096
    buffer_load_dwordx4 v[228:231], v153, s[12:15], s96 offen
    s_mov_b32 s96, 6144
    buffer_load_dwordx4 v[232:235], v153, s[12:15], s96 offen
    s_mov_b32 s96, 8192
    buffer_load_dwordx4 v[236:239], v153, s[12:15], s96 offen
    s_mov_b32 s96, 10240
    buffer_load_dwordx4 v[240:243], v153, s[12:15], s96 offen
    s_mov_b32 s96, 12288
    buffer_load_dwordx4 v[244:247], v153, s[12:15], s96 offen
    s_mov_b32 s96, 14336
    buffer_load_dwordx4 v[248:251], v153, s[12:15], s96 offen
sk_75:
    v_bfe_u32 v20, v252, 3, 2
    v_lshrrev_b32 v21, 5, v252
    v_lshl_add_u32 v20, v21, 3, v20
    s_lshr_b32 s32, s28, 1
    s_lshl_b32 s32, s32, 4
    s_and_b32 s33, s28, 1
    s_lshl_b32 s33, s33, 2
    s_add_u32 s32, s32, s33
    v_add_u32 v20, s32, v20
    v_lshlrev_b32 v20, 11, v20
    v_lshrrev_b32 v21, 2, v252
    v_and_b32 v21, 4, v21
    v_xor_b32 v21, v21, v252
    v_and_b32 v21, 7, v21
    v_lshl_add_u32 v20, v21, 4, v20
    s_lshl_b32 s32, s98, 7
    v_add_u32 v14, s32, v20
    s_lshl_b32 s32, s28, 9
    s_sub_u32 s34, s29, 224
    s_lshl_b32 s34, s34, 1
    s_add_u32 s89, s34, s28
    s_and_b32 s35, s28, 1
    s_add_u32 s34, s34, s35
    s_lshl_b32 s34, s34, 5
    v_lshrrev_b32 v22, 1, v252
    v_and_b32 v23, 1, v252
    s_cmp_lt_u32 s29, 224
    s_cselect_b32 s32, s32, s34
    s_cselect_b64 vcc, -1, 0
    v_cndmask_b32 v22, v23, v22, vcc
    v_lshl_add_u32 v22, v22, 4, s32
    s_mov_b32 s79, s26
    s_cmp_lg_u32 s26, 0
    s_cbranch_scc1 sk_76
    s_waitcnt vmcnt(0)
    s_getpc_b64 s[32:33]
pc_77:
    s_sub_u32 s32, s32, pc_77-interleave_layers__sliding_block__moe_arch_mod__prompt_kernel
    s_subb_u32 s33, s33, 0
    s_lshr_b32 s34, s2, 3
    s_lshl_b32 s34, s34, 2
    s_add_u32 s34, s34, s28
    s_and_b32 s34, s34, 127
    s_lshl_b32 s34, s34, 7
    v_lshl_add_u32 v19, v252, 14, s34
    s_mov_b32 s34, k_exit-interleave_layers__sliding_block__moe_arch_mod__prompt_kernel
    s_mov_b32 s35, 0x20000
    buffer_load_dword v19, v19, s[32:35], 0 offen
    s_lshr_b32 s30, s16, 7
    s_sub_u32 s30, 3, s30
    s_and_b32 s30, s30, 7
    s_and_b32 s31, s24, 1
    s_lshl_b32 s31, s31, 3
    s_add_u32 s30, s30, s31
    s_and_b32 s31, s24, 14
    s_add_u32 s35, s31, s30
    s_lshl_b32 s31, s25, 2
    s_add_u32 s31, s31, s28
    s_mul_i32 s31, s31, 6144
    s_lshl_b32 s30, s30, 7
    s_add_u32 s30, s30, s31
    v_min_u32 v18, 2, v252
    v_lshl_add_u32 v18, v18, 11, s30
    s_add_u32 s30, s35, 14
    s_and_b32 s30, s30, 15
    s_mul_i32 s30, s30, 393216
    buffer_load_dword v19, v18, s[16:19], s30 offen
    s_add_u32 s30, s35, 15
    s_and_b32 s30, s30, 15
    s_mul_i32 s30, s30, 393216
    buffer_load_dword v19, v18, s[16:19], s30 offen
    s_add_u32 s30, s35, 0
    s_and_b32 s30, s30, 15
    s_mul_i32 s30, s30, 393216
    buffer_load_dword v19, v18, s[16:19], s30 offen
    s_add_u32 s30, s35, 1
    s_and_b32 s30, s30, 15
    s_mul_i32 s30, s30, 393216
    buffer_load_dword v19, v18, s[16:19], s30 offen
    s_add_u32 s30, s35, 2
    s_and_b32 s30, s30, 15
    s_mul_i32 s30, s30, 393216
    buffer_load_dword v19, v18, s[16:19], s30 offen
    s_add_u32 s30, s35, 3
    s_and_b32 s30, s30, 15
    s_mul_i32 s30, s30, 393216
    buffer_load_dword v19, v18, s[16:19], s30 offen
    s_mov_b32 s30, 0x05040100
    s_mov_b32 s31, 0x07060302
    v_perm_b32 v155, v160, v156, s30
    v_perm_b32 v160, v160, v156, s31
    v_perm_b32 v156, v161, v157, s30
    v_perm_b32 v161, v161, v157, s31
    v_perm_b32 v157, v162, v158, s30
    v_perm_b32 v162, v162, v158, s31
    v_perm_b32 v158, v163, v159, s30
    v_perm_b32 v163, v163, v159, s31
    v_perm_b32 v159, v168, v164, s30
    v_perm_b32 v168, v168, v164, s31
    v_perm_b32 v164, v169, v165, s30
    v_perm_b32 v169, v169, v165, s31
    v_perm_b32 v165, v170, v166, s30
    v_perm_b32 v170, v170, v166, s31
    v_perm_b32 v166, v171, v167, s30
    v_perm_b32 v171, v171, v167, s31
    v_perm_b32 v167, v176, v172, s30
    v_perm_b32 v176, v176, v172, s31
    v_perm_b32 v172, v177, v173, s30
    v_perm_b32 v177, v177, v173, s31
    v_perm_b32 v173, v178, v174, s30
    v_perm_b32 v178, v178, v174, s31
    v_perm_b32 v174, v179, v175, s30
    v_perm_b32 v179, v179, v175, s31
    v_perm_b32 v175, v184, v180, s30
    v_perm_b32 v184, v184, v180, s31
    v_perm_b32 v180, v185, v181, s30
    v_perm_b32 v185, v185, v181, s31
    v_perm_b32 v181, v186, v182, s30
    v_perm_b32 v186, v186, v182, s31
    v_perm_b32 v182, v187, v183, s30
    v_perm_b32 v187, v187, v183, s31
    v_perm_b32 v183, v192, v188, s30
    v_perm_b32 v192, v192, v188, s31
    v_perm_b32 v188, v193, v189, s30
    v_perm_b32 v193, v193, v189, s31
    v_perm_b32 v189, v194, v190, s30
    v_perm_b32 v194, v194, v190, s31
    v_perm_b32 v190, v195, v191, s30
    v_perm_b32 v195, v195, v191, s31
    v_perm_b32 v191, v200, v196, s30
    v_perm_b32 v200, v200, v196, s31
    v_perm_b32 v196, v201, v197, s30
    v_perm_b32 v201, v201, v197, s31
    v_perm_b32 v197, v202, v198, s30
    v_perm_b32 v202, v202, v198, s31
    v_perm_b32 v198, v203, v199, s30
    v_perm_b32 v203, v203, v199, s31
    v_perm_b32 v199, v208, v204, s30
    v_perm_b32 v208, v208, v204, s31
    v_perm_b32 v204, v209, v205, s30
    v_perm_b32 v209, v209, v205, s31
    v_perm_b32 v205, v210, v206, s30
    v_perm_b32 v210, v210, v206, s31
    v_perm_b32 v206, v211, v207, s30
    v_perm_b32 v211, v211, v207, s31
    v_perm_b32 v207, v216, v212, s30
    v_perm_b32 v216, v216, v212, s31
    v_perm_b32 v212, v217, v213, s30
    v_perm_b32 v217, v217, v213, s31
    v_perm_b32 v213, v218, v214, s30
    v_perm_b32 v218, v218, v214, s31
    v_perm_b32 v214, v219, v215, s30
    v_perm_b32 v219, v219, v215, s31
    v_perm_b32 v215, v224, v220, s30
    v_perm_b32 v224, v224, v220, s31
    v_perm_b32 v220, v225, v221, s30
    v_perm_b32 v225, v225, v221, s31
    v_perm_b32 v221, v226, v222, s30
    v_perm_b32 v226, v226, v222, s31
    v_perm_b32 v222, v227, v223, s30
    v_perm_b32 v227, v227, v223, s31
    v_perm_b32 v223, v232, v228, s30
    v_perm_b32 v232, v232, v228, s31
    v_perm_b32 v228, v233, v229, s30
    v_perm_b32 v233, v233, v229, s31
    v_perm_b32 v229, v234, v230, s30
    v_perm_b32 v234, v234, v230, s31
    v_perm_b32 v230, v235, v231, s30
    v_perm_b32 v235, v235, v231, s31
    v_perm_b32 v231, v240, v236, s30
    v_perm_b32 v240, v240, v236, s31
    v_perm_b32 v236, v241, v237, s30
    v_perm_b32 v241, v241, v237, s31
    v_perm_b32 v237, v242, v238, s30
    v_perm_b32 v242, v242, v238, s31
    v_perm_b32 v238, v243, v239, s30
    v_perm_b32 v243, v243, v239, s31
    v_perm_b32 v239, v248, v244, s30
    v_perm_b32 v248, v248, v244, s31
    v_perm_b32 v244, v249, v245, s30
    v_perm_b32 v249, v249, v245, s31
    v_perm_b32 v245, v250, v246, s30
    v_perm_b32 v250, v250, v246, s31
    v_perm_b32 v246, v251, v247, s30
    v_perm_b32 v251, v251, v247, s31
    v_lshrrev_b32 v21, 3, v252
    s_lshl_b32 s84, s24, 18
    s_add_u32 s84, s84, s86
    s_add_u32 s84, s84, 0x2000000
    v_mul_u32_u24 v20, 6144, v21
    v_and_b32 v21, 6, v21
    v_xor_b32 v21, v21, v252
    v_and_b32 v21, 7, v21
    v_lshl_add_u32 v20, v21, 4, v20
    s_mul_i32 s32, s28, 3
    s_bfe_u32 s33, s32, 0x10001
    s_mul_i32 s33, s33, 196608
    s_and_b32 s34, s32, 1
    s_mul_i32 s34, s34, 49152
    s_add_u32 s33, s33, s34
    s_lshr_b32 s34, s32, 2
    s_lshl_b32 s34, s34, 11
    s_add_u32 s33, s33, s34
    v_add_u32 v8, s33, v20
    v_add_u32 v9, 97280, v8
    s_add_u32 s32, s32, 1
    s_bfe_u32 s33, s32, 0x10001
    s_mul_i32 s33, s33, 196608
    s_and_b32 s34, s32, 1
    s_mul_i32 s34, s34, 49152
    s_add_u32 s33, s33, s34
    s_lshr_b32 s34, s32, 2
    s_lshl_b32 s34, s34, 11
    s_add_u32 s33, s33, s34
    s_sub_u32 s33, s33, 2048
    v_add_u32 v10, s33, v20
    v_add_u32 v11, 97280, v10
    s_add_u32 s32, s32, 1
    s_bfe_u32 s33, s32, 0x10001
    s_mul_i32 s33, s33, 196608
    s_and_b32 s34, s32, 1
    s_mul_i32 s34, s34, 49152
    s_add_u32 s33, s33, s34
    s_lshr_b32 s34, s32, 2
    s_lshl_b32 s34, s34, 11
    s_add_u32 s33, s33, s34
    v_add_u32 v12, s33, v20
    v_add_u32 v13, 97280, v12
    s_sub_u32 s30, s95, 1
    s_sub_u32 s95, s94, 3
    s_mov_b32 s94, s30
    v_bfe_u32 v116, v252, 4, 1
    v_lshlrev_b32 v116, 11, v116
    v_lshrrev_b32 v117, 5, v252
    v_lshl_add_u32 v116, v117, 8, v116
    v_and_b32 v117, 15, v252
    v_lshl_add_u32 v116, v117, 4, v116
    s_lshl_b32 s34, s28, 12
    s_add_u32 s34, s34, 147456
    v_add_u32 v117, s34, v116
    v_and_b32 v16, 15, v252
    v_lshlrev_b32 v16, 9, v16
    s_load_dwordx2 s[12:13], s[0:1], 64
    s_mov_b32 s14, 0x400000
    s_mov_b32 s15, 0x20000
    s_waitcnt lgkmcnt(0)
sk_76:
    s_barrier
    s_add_u32 s96, s25, 12
    s_and_b32 s96, s96, 15
    s_lshl_b32 s96, s96, 17
    s_add_u32 s96, s96, 65536
    s_add_u32 m0, s101, 114688
    s_nop 0
    buffer_load_dwordx4 v14, s[8:11], s96 offen lds
    s_add_u32 s96, s25, 13
    s_and_b32 s96, s96, 15
    s_lshl_b32 s96, s96, 17
    s_add_u32 s96, s96, 65536
    s_add_u32 m0, s101, 118784
    s_nop 0
    buffer_load_dwordx4 v14, s[8:11], s96 offen lds
    s_add_u32 s96, s25, 14
    s_and_b32 s96, s96, 15
    s_lshl_b32 s96, s96, 17
    s_add_u32 s96, s96, 65536
    s_add_u32 m0, s101, 122880
    s_nop 0
    buffer_load_dwordx4 v14, s[8:11], s96 offen lds
    s_add_u32 s96, s25, 15
    s_and_b32 s96, s96, 15
    s_lshl_b32 s96, s96, 17
    s_add_u32 s96, s96, 65536
    s_add_u32 m0, s101, 126976
    s_nop 0
    buffer_load_dwordx4 v14, s[8:11], s96 offen lds
    s_waitcnt vmcnt(0)
    s_barrier
    s_cmp_lg_u32 s26, 0
    s_cbranch_scc1 l_tail
    s_mov_b32 s26, 16777216
    s_mov_b32 s36, 0
    s_add_u32 s96, s94, 0
    s_and_b32 s96, s96, 15
    s_mul_i32 s96, s96, 393216
    s_add_u32 s96, s96, s85
    s_add_u32 m0, s87, 40960
    s_nop 0
    buffer_load_dwordx4 v8, s[16:19], s96 offen offset:0 lds
    buffer_load_dwordx4 v9, s[16:19], s96 offen offset:1024 lds
    buffer_load_dwordx4 v10, s[16:19], s96 offen offset:2048 lds
    buffer_load_dwordx4 v11, s[16:19], s96 offen offset:3072 lds
    s_add_u32 m0, s87, 45056
    s_nop 0
    buffer_load_dwordx4 v12, s[16:19], s96 offen offset:0 lds
    buffer_load_dwordx4 v13, s[16:19], s96 offen offset:1024 lds
    s_add_u32 s96, s95, 1
    s_and_b32 s96, s96, 15
    s_mul_i32 s96, s96, 393216
    s_add_u32 s96, s96, s85
    s_add_u32 m0, s87, 65536
    s_nop 0
    buffer_load_dwordx4 v8, s[16:19], s96 offen offset:0 lds
    buffer_load_dwordx4 v9, s[16:19], s96 offen offset:1024 lds
    buffer_load_dwordx4 v10, s[16:19], s96 offen offset:2048 lds
    buffer_load_dwordx4 v11, s[16:19], s96 offen offset:3072 lds
    s_add_u32 m0, s87, 69632
    s_nop 0
    buffer_load_dwordx4 v12, s[16:19], s96 offen offset:0 lds
    buffer_load_dwordx4 v13, s[16:19], s96 offen offset:1024 lds
    s_add_u32 s96, s95, 1
    s_and_b32 s96, s96, 15
    s_bitcmp1_b32 s36, s96
    s_cbranch_scc1 sk_78
    s_lshl_b32 s30, s99, 13
    s_add_u32 s30, s30, 0xc00000
    s_mov_b32 s78, s27
pl_79:
    buffer_load_dword v17, v16, s[20:23], s30 offen sc1
    s_waitcnt vmcnt(0)
pc_80:
    v_cmp_ne_u32 vcc, -1, v17
    s_mov_b32 s36, vcc_lo
    s_bitcmp0_b32 s36, s96
    s_cselect_b64 vcc, -1, 0
    s_cbranch_vccz pd_81
    s_sub_u32 s78, s78, 1
    s_cmp_lg_u32 s78, 0
    s_cbranch_scc1 pl_79
    s_mov_b32 s27, 1
pd_81:
sk_78:
    s_add_u32 s96, s95, 1
    s_and_b32 s96, s96, 15
    s_lshl_b32 s97, s96, 14
    s_add_u32 s97, s97, s84
    s_add_u32 m0, s86, 131072
    s_nop 0
    buffer_load_dwordx4 v253, s[20:23], s97 offen offset:0 sc1 lds
    buffer_load_dwordx4 v253, s[20:23], s97 offen offset:1024 sc1 lds
    buffer_load_dwordx4 v253, s[20:23], s97 offen offset:2048 sc1 lds
    buffer_load_dwordx4 v253, s[20:23], s97 offen offset:3072 sc1 lds
    s_waitcnt vmcnt(10)
    s_barrier
    s_add_u32 s96, s94, 2
    s_and_b32 s96, s96, 15
    s_mul_i32 s96, s96, 393216
    s_add_u32 s96, s96, s85
    s_add_u32 m0, s87, 90112
    s_nop 0
    buffer_load_dwordx4 v8, s[16:19], s96 offen offset:0 lds
    buffer_load_dwordx4 v9, s[16:19], s96 offen offset:1024 lds
    buffer_load_dwordx4 v10, s[16:19], s96 offen offset:2048 lds
    buffer_load_dwordx4 v11, s[16:19], s96 offen offset:3072 lds
    s_add_u32 m0, s87, 94208
    s_nop 0
    buffer_load_dwordx4 v12, s[16:19], s96 offen offset:0 lds
    buffer_load_dwordx4 v13, s[16:19], s96 offen offset:1024 lds
    ds_read_b128 v[32:35], v117 offset:0
    ds_read_b128 v[36:39], v117 offset:512
    ds_read_b128 v[40:43], v117 offset:1024
    ds_read_b128 v[44:47], v117 offset:1536
    s_add_u32 s96, s94, 2
    s_and_b32 s96, s96, 15
    s_bitcmp1_b32 s36, s96
    s_cbranch_scc1 sk_82
    s_lshl_b32 s30, s99, 13
    s_add_u32 s30, s30, 0xc00000
    s_mov_b32 s78, s27
pl_83:
    buffer_load_dword v17, v16, s[20:23], s30 offen sc1
    s_waitcnt vmcnt(0)
pc_84:
    v_cmp_ne_u32 vcc, -1, v17
    s_mov_b32 s36, vcc_lo
    s_bitcmp0_b32 s36, s96
    s_cselect_b64 vcc, -1, 0
    s_cbranch_vccz pd_85
    s_sub_u32 s78, s78, 1
    s_cmp_lg_u32 s78, 0
    s_cbranch_scc1 pl_83
    s_mov_b32 s27, 1
pd_85:
sk_82:
    s_add_u32 s96, s94, 2
    s_and_b32 s96, s96, 15
    s_lshl_b32 s97, s96, 14
    s_add_u32 s97, s97, s84
    s_add_u32 m0, s86, 114688
    s_nop 0
    buffer_load_dwordx4 v253, s[20:23], s97 offen offset:0 sc1 lds
    buffer_load_dwordx4 v253, s[20:23], s97 offen offset:1024 sc1 lds
    buffer_load_dwordx4 v253, s[20:23], s97 offen offset:2048 sc1 lds
    buffer_load_dwordx4 v253, s[20:23], s97 offen offset:3072 sc1 lds
    s_waitcnt vmcnt(10) lgkmcnt(0)
    s_barrier
    s_lshl_b32 s30, s99, 13
    s_add_u32 s30, s30, 0xc00000
    s_add_u32 s31, s30, 4096
    buffer_load_dwordx4 v[64:67], v253, s[20:23], s30 offen offset:0 sc1
    buffer_load_dwordx4 v[68:71], v253, s[20:23], s30 offen offset:1024 sc1
    buffer_load_dwordx4 v[72:75], v253, s[20:23], s30 offen offset:2048 sc1
    buffer_load_dwordx4 v[76:79], v253, s[20:23], s30 offen offset:3072 sc1
    buffer_load_dwordx4 v[80:83], v253, s[20:23], s31 offen offset:0 sc1
    buffer_load_dwordx4 v[84:87], v253, s[20:23], s31 offen offset:1024 sc1
    buffer_load_dwordx4 v[88:91], v253, s[20:23], s31 offen offset:2048 sc1
    buffer_load_dwordx4 v[92:95], v253, s[20:23], s31 offen offset:3072 sc1
    s_add_u32 s96, s95, 3
    s_and_b32 s96, s96, 15
    s_bitcmp1_b32 s36, s96
    s_cbranch_scc1 sk_96
    s_lshl_b32 s30, s99, 13
    s_add_u32 s30, s30, 0xc00000
    s_mov_b32 s78, s27
pl_97:
    buffer_load_dword v17, v16, s[20:23], s30 offen sc1
    s_waitcnt vmcnt(0)
pc_98:
    v_cmp_ne_u32 vcc, -1, v17
    s_mov_b32 s36, vcc_lo
    s_bitcmp0_b32 s36, s96
    s_cselect_b64 vcc, -1, 0
    s_cbranch_vccz pd_99
    s_sub_u32 s78, s78, 1
    s_cmp_lg_u32 s78, 0
    s_cbranch_scc1 pl_97
    s_mov_b32 s27, 1
pd_99:
sk_96:
    s_add_u32 s96, s95, 3
    s_and_b32 s96, s96, 15
    s_lshl_b32 s97, s96, 14
    s_add_u32 s97, s97, s84
    s_add_u32 m0, s86, 147456
    s_nop 0
    buffer_load_dwordx4 v253, s[20:23], s97 offen offset:0 sc1 lds
    buffer_load_dwordx4 v253, s[20:23], s97 offen offset:1024 sc1 lds
    s_mov_b32 s78, s27
    s_waitcnt vmcnt(2)
    s_branch pc_101
pl_100:
    s_lshl_b32 s30, s99, 13
    s_add_u32 s30, s30, 0xc00000
    s_add_u32 s31, s30, 4096
    buffer_load_dwordx4 v[64:67], v253, s[20:23], s30 offen offset:0 sc1
    buffer_load_dwordx4 v[68:71], v253, s[20:23], s30 offen offset:1024 sc1
    buffer_load_dwordx4 v[72:75], v253, s[20:23], s30 offen offset:2048 sc1
    buffer_load_dwordx4 v[76:79], v253, s[20:23], s30 offen offset:3072 sc1
    buffer_load_dwordx4 v[80:83], v253, s[20:23], s31 offen offset:0 sc1
    buffer_load_dwordx4 v[84:87], v253, s[20:23], s31 offen offset:1024 sc1
    buffer_load_dwordx4 v[88:91], v253, s[20:23], s31 offen offset:2048 sc1
    buffer_load_dwordx4 v[92:95], v253, s[20:23], s31 offen offset:3072 sc1
    s_waitcnt vmcnt(0)
pc_101:
    v_max3_u32 v48, v64, v68, v72
    v_max3_u32 v48, v48, v76, v80
    v_max3_u32 v48, v48, v84, v88
    v_max_u32 v48, v48, v92
    v_cmp_eq_u32 vcc, -1, v48
    s_cbranch_vccz pd_102
    s_sub_u32 s78, s78, 1
    s_cmp_lg_u32 s78, 0
    s_cbranch_scc1 pl_100
    s_mov_b32 s27, 1
pd_102:
    buffer_load_dwordx4 v253, s[20:23], s97 offen offset:2048 sc1 lds
    buffer_load_dwordx4 v253, s[20:23], s97 offen offset:3072 sc1 lds
    v_add_f32 v64, v64, v68
    v_add_f32 v65, v65, v69
    v_add_f32 v66, v66, v70
    v_add_f32 v67, v67, v71
    v_add_f32 v64, v64, v72
    v_add_f32 v65, v65, v73
    v_add_f32 v66, v66, v74
    v_add_f32 v67, v67, v75
    s_add_u32 s96, s95, 3
    s_and_b32 s96, s96, 15
    s_mul_i32 s96, s96, 393216
    s_add_u32 s96, s96, s85
    s_add_u32 m0, s87, 40960
    s_nop 0
    buffer_load_dwordx4 v8, s[16:19], s96 offen offset:0 lds
    v_add_f32 v64, v64, v76
    v_add_f32 v65, v65, v77
    v_add_f32 v66, v66, v78
    v_add_f32 v67, v67, v79
    v_add_f32 v64, v64, v80
    v_add_f32 v65, v65, v81
    v_add_f32 v66, v66, v82
    v_add_f32 v67, v67, v83
    v_add_f32 v64, v64, v84
    v_add_f32 v65, v65, v85
    v_add_f32 v66, v66, v86
    v_add_f32 v67, v67, v87
    buffer_load_dwordx4 v9, s[16:19], s96 offen offset:1024 lds
    v_add_f32 v64, v64, v88
    v_add_f32 v65, v65, v89
    v_add_f32 v66, v66, v90
    v_add_f32 v67, v67, v91
    v_add_f32 v64, v64, v92
    v_add_f32 v65, v65, v93
    v_add_f32 v66, v66, v94
    v_add_f32 v67, v67, v95
    v_mov_b32 v48, v64
    v_mov_b32 v49, v65
    v_mov_b32 v50, v66
    v_mov_b32 v51, v67
    v_permlane32_swap_b32 v64, v48
    buffer_load_dwordx4 v10, s[16:19], s96 offen offset:2048 lds
    v_permlane32_swap_b32 v65, v49
    v_permlane32_swap_b32 v66, v50
    v_permlane32_swap_b32 v67, v51
    v_add_f32 v64, v64, v48
    v_add_f32 v65, v65, v49
    v_add_f32 v66, v66, v50
    v_add_f32 v67, v67, v51
    v_mul_f32 v54, 0x3a800000, v64
    v_mul_f32 v65, 0x3a800000, v65
    v_fma_f32 v65, -v54, v54, v65
    v_max_f32 v65, 0, v65
    v_add_f32 v55, 0x3727c5ac, v65
    buffer_load_dwordx4 v11, s[16:19], s96 offen offset:3072 lds
    v_rsq_f32 v55, v55
    v_fma_f32 v52, -v54, v67, v66
    v_and_b32 v53, 31, v252
    v_mul_f32 v52, v52, v55
    s_lshl_b32 s32, s99, 5
    v_add_u32 v53, s32, v53
    v_mov_b32 v48, v52
    s_nop 1
    v_max_f32_dpp v48, v48, v48 quad_perm:[1,0,3,2] row_mask:0xf bank_mask:0xf
    s_nop 1
    v_max_f32_dpp v48, v48, v48 quad_perm:[2,3,0,1] row_mask:0xf bank_mask:0xf
    s_nop 1
    v_max_f32_dpp v48, v48, v48 row_half_mirror row_mask:0xf bank_mask:0xf
    s_nop 1
    v_max_f32_dpp v48, v48, v48 row_mirror row_mask:0xf bank_mask:0xf
    v_mov_b32 v49, v48
    s_nop 1
    v_permlane16_swap_b32 v48, v49
    s_add_u32 m0, s87, 45056
    s_nop 0
    buffer_load_dwordx4 v12, s[16:19], s96 offen offset:0 lds
    v_max_f32 v48, v48, v49
    v_cmp_eq_f32 vcc, v48, v52
    v_lshrrev_b32 v50, 5, v252
    v_lshlrev_b32 v50, 4, v50
    s_lshl_b32 s32, s99, 11
    s_lshl_b32 s33, s98, 7
    s_add_u32 s32, s32, s33
    s_add_u32 s32, s32, 0xd60000
    s_lshl_b32 s34, s99, 4
    s_add_u32 s34, s34, 0xdc0000
    s_ff1_i32_b32 s35, vcc_lo
    s_lshl_b32 s35, 1, s35
    buffer_load_dwordx4 v13, s[16:19], s96 offen offset:1024 lds
    s_cmp_eq_u32 s25, 0
    s_cselect_b32 exec_lo, s35, 0
    s_mov_b32 exec_hi, 0
    buffer_store_dwordx4 v[52:55], v50, s[20:23], s34 offen sc1
    s_mov_b32 exec_lo, s35
    s_mov_b32 exec_hi, s35
    buffer_store_dwordx4 v[32:35], v50, s[20:23], s32 offen offset:0 sc1
    buffer_store_dwordx4 v[36:39], v50, s[20:23], s32 offen offset:32 sc1
    buffer_store_dwordx4 v[40:43], v50, s[20:23], s32 offen offset:64 sc1
    buffer_store_dwordx4 v[44:47], v50, s[20:23], s32 offen offset:96 sc1
    s_mov_b64 exec, -1
    s_waitcnt vmcnt(22) lgkmcnt(0)
    s_barrier
    s_add_u32 s96, s94, 4
    s_and_b32 s96, s96, 15
    s_lshl_b32 s97, s96, 14
    s_add_u32 s97, s97, s84
    s_add_u32 m0, s86, 131072
    s_nop 0
    buffer_load_dwordx4 v253, s[20:23], s97 offen offset:0 sc1 lds
    buffer_load_dwordx4 v253, s[20:23], s97 offen offset:1024 sc1 lds
    v_add_f32 v56, 1.0, v55
    v_mul_f32 v57, v54, v55
    v_mul_f32 v58, v56, v56
    buffer_load_dwordx4 v253, s[20:23], s97 offen offset:2048 sc1 lds
    v_sub_f32 v57, 0, v57
    v_mul_f32 v58, v58, v65
    v_add_f32 v58, 0x3727c5ac, v58
    buffer_load_dwordx4 v253, s[20:23], s97 offen offset:3072 sc1 lds
    v_rsq_f32 v58, v58
    s_nop 0
    v_mul_f32 v58, v58, v56
    v_and_b32 v48, 31, v252
    s_add_u32 s96, s94, 4
    s_and_b32 s96, s96, 15
    s_mul_i32 s96, s96, 393216
    s_add_u32 s96, s96, s85
    s_add_u32 m0, s87, 65536
    s_nop 0
    buffer_load_dwordx4 v8, s[16:19], s96 offen offset:0 lds
    v_lshrrev_b32 v49, 5, v252
    v_cmp_eq_u32 vcc, 0, v49
    v_lshlrev_b32 v49, 9, v49
    buffer_load_dwordx4 v9, s[16:19], s96 offen offset:1024 lds
    v_lshl_add_u32 v48, v48, 2, v49
    s_lshl_b32 s32, s28, 7
    v_add_u32 v48, s32, v48
    buffer_load_dwordx4 v10, s[16:19], s96 offen offset:2048 lds
    v_cndmask_b32 v49, v54, v58, vcc
    v_cndmask_b32 v50, v57, v56, vcc
    ds_write_b32 v48, v49 offset:0
    buffer_load_dwordx4 v11, s[16:19], s96 offen offset:3072 lds
    ds_write_b32 v48, v50 offset:2048
    v_and_b32 v48, 15, v252
    v_lshrrev_b32 v51, 4, v252
    s_add_u32 m0, s87, 69632
    s_nop 0
    buffer_load_dwordx4 v12, s[16:19], s96 offen offset:0 lds
    v_lshl_add_u32 v48, v48, 2, v51
    s_min_u32 s32, s28, 2
    s_lshl_b32 s32, s32, 8
    buffer_load_dwordx4 v13, s[16:19], s96 offen offset:1024 lds
    v_lshl_add_u32 v48, v48, 2, s32
    ds_write_b32 v48, v2 offset:1024
    s_waitcnt vmcnt(14) lgkmcnt(0)
    s_barrier
    s_add_u32 s96, s95, 5
    s_and_b32 s96, s96, 15
    s_lshl_b32 s97, s96, 14
    s_add_u32 s97, s97, s84
    s_add_u32 m0, s86, 114688
    s_nop 0
    buffer_load_dwordx4 v253, s[20:23], s97 offen offset:0 sc1 lds
    buffer_load_dwordx4 v253, s[20:23], s97 offen offset:1024 sc1 lds
    buffer_load_dwordx4 v253, s[20:23], s97 offen offset:2048 sc1 lds
    buffer_load_dwordx4 v253, s[20:23], s97 offen offset:3072 sc1 lds
    s_add_u32 s96, s95, 5
    s_and_b32 s96, s96, 15
    s_mul_i32 s96, s96, 393216
    s_add_u32 s96, s96, s85
    s_add_u32 m0, s87, 90112
    s_nop 0
    buffer_load_dwordx4 v8, s[16:19], s96 offen offset:0 lds
    buffer_load_dwordx4 v9, s[16:19], s96 offen offset:1024 lds
    buffer_load_dwordx4 v10, s[16:19], s96 offen offset:2048 lds
    buffer_load_dwordx4 v11, s[16:19], s96 offen offset:3072 lds
    s_add_u32 m0, s87, 94208
    s_nop 0
    buffer_load_dwordx4 v12, s[16:19], s96 offen offset:0 lds
    buffer_load_dwordx4 v13, s[16:19], s96 offen offset:1024 lds
    s_waitcnt vmcnt(10) lgkmcnt(0)
    s_barrier
    s_add_u32 s32, s79, 0xdc0000
    buffer_load_dwordx4 v[16:19], v253, s[20:23], s32 offen sc1
    s_add_u32 s96, s94, 6
    s_and_b32 s96, s96, 15
    s_lshl_b32 s97, s96, 14
    s_add_u32 s97, s97, s84
    s_add_u32 m0, s86, 147456
    s_nop 0
    buffer_load_dwordx4 v253, s[20:23], s97 offen offset:0 sc1 lds
    buffer_load_dwordx4 v253, s[20:23], s97 offen offset:1024 sc1 lds
    buffer_load_dwordx4 v253, s[20:23], s97 offen offset:2048 sc1 lds
    buffer_load_dwordx4 v253, s[20:23], s97 offen offset:3072 sc1 lds
    s_add_u32 s96, s94, 6
    s_and_b32 s96, s96, 15
    s_mul_i32 s96, s96, 393216
    s_add_u32 s96, s96, s85
    s_add_u32 m0, s87, 40960
    s_nop 0
    buffer_load_dwordx4 v8, s[16:19], s96 offen offset:0 lds
    buffer_load_dwordx4 v9, s[16:19], s96 offen offset:1024 lds
    buffer_load_dwordx4 v10, s[16:19], s96 offen offset:2048 lds
    buffer_load_dwordx4 v11, s[16:19], s96 offen offset:3072 lds
    s_add_u32 m0, s87, 45056
    s_nop 0
    buffer_load_dwordx4 v12, s[16:19], s96 offen offset:0 lds
    buffer_load_dwordx4 v13, s[16:19], s96 offen offset:1024 lds
    s_waitcnt vmcnt(11) lgkmcnt(0)
    s_barrier
    s_add_u32 s96, s95, 7
    s_and_b32 s96, s96, 15
    s_lshl_b32 s97, s96, 14
    s_add_u32 s97, s97, s84
    s_add_u32 m0, s86, 131072
    s_nop 0
    buffer_load_dwordx4 v253, s[20:23], s97 offen offset:0 sc1 lds
    buffer_load_dwordx4 v253, s[20:23], s97 offen offset:1024 sc1 lds
    s_mov_b32 s78, s27
    s_waitcnt vmcnt(12)
    s_branch pc_105
pl_104:
    s_add_u32 s32, s79, 0xdc0000
    buffer_load_dwordx4 v[16:19], v253, s[20:23], s32 offen sc1
    s_waitcnt vmcnt(0)
pc_105:
    v_max3_u32 v20, v16, v17, v18
    v_max_u32 v20, v20, v19
    v_cmp_eq_u32 vcc, -1, v20
    s_cbranch_vccz pd_106
    s_sub_u32 s78, s78, 1
    s_cmp_lg_u32 s78, 0
    s_cbranch_scc1 pl_104
    s_mov_b32 s27, 1
pd_106:
    buffer_load_dwordx4 v253, s[20:23], s97 offen offset:2048 sc1 lds
    buffer_load_dwordx4 v253, s[20:23], s97 offen offset:3072 sc1 lds
    s_add_u32 s96, s95, 7
    s_and_b32 s96, s96, 15
    s_mul_i32 s96, s96, 393216
    s_add_u32 s96, s96, s85
    s_add_u32 m0, s87, 65536
    s_nop 0
    buffer_load_dwordx4 v8, s[16:19], s96 offen offset:0 lds
    v_mov_b32 v20, v16
    s_nop 1
    v_max_f32_dpp v20, v20, v20 quad_perm:[1,0,3,2] row_mask:0xf bank_mask:0xf
    s_nop 1
    v_max_f32_dpp v20, v20, v20 quad_perm:[2,3,0,1] row_mask:0xf bank_mask:0xf
    s_nop 1
    v_max_f32_dpp v20, v20, v20 row_half_mirror row_mask:0xf bank_mask:0xf
    s_nop 1
    v_max_f32_dpp v20, v20, v20 row_mirror row_mask:0xf bank_mask:0xf
    v_mov_b32 v21, v20
    buffer_load_dwordx4 v9, s[16:19], s96 offen offset:1024 lds
    s_nop 0
    v_permlane16_swap_b32 v20, v21
    v_max_f32 v20, v20, v21
    v_mov_b32 v21, v20
    s_nop 1
    v_permlane32_swap_b32 v20, v21
    v_max_f32 v20, v20, v21
    v_cmp_eq_f32 vcc, v20, v16
    buffer_load_dwordx4 v10, s[16:19], s96 offen offset:2048 lds
    s_ff1_i32_b64 s32, vcc
    s_and_b32 s32, s32, 63
    v_readlane_b32 s74, v16, s32
    v_readlane_b32 s73, v17, s32
    v_readlane_b32 s75, v18, s32
    v_readlane_b32 s76, v19, s32
    buffer_load_dwordx4 v11, s[16:19], s96 offen offset:3072 lds
    s_and_b32 s73, s73, 2047
    s_lshr_b32 s33, s73, 5
    s_lshl_b32 s33, s33, 11
    s_add_u32 s33, s33, s79
    s_add_u32 s33, s33, 0xd60000
    buffer_load_dwordx4 v[24:27], v22, s[20:23], s33 offen sc1
    s_add_u32 m0, s87, 69632
    s_nop 0
    buffer_load_dwordx4 v12, s[16:19], s96 offen offset:0 lds
    v_mov_b32 v20, s73
    v_mov_b32 v21, s77
    v_mov_b32 v19, 0
    ds_write_b64 v19, v[20:21] offset:3072
    s_lshr_b32 s39, s73, 5
    s_lshl_b32 s34, s24, 2
    buffer_load_dwordx4 v13, s[16:19], s96 offen offset:1024 lds
    s_sub_u32 s39, s39, s34
    s_add_u32 s39, s39, 8
    s_lshr_b32 s34, s39, 3
    s_add_u32 s34, s34, 1
    s_cmp_lt_u32 s39, 12
    s_cselect_b32 s100, s34, 0
    s_waitcnt vmcnt(11) lgkmcnt(0)
    s_barrier
    s_add_u32 s96, s94, 8
    s_and_b32 s96, s96, 15
    s_lshl_b32 s97, s96, 14
    s_add_u32 s97, s97, s84
    s_add_u32 m0, s86, 114688
    s_nop 0
    buffer_load_dwordx4 v253, s[20:23], s97 offen offset:0 sc1 lds
    buffer_load_dwordx4 v253, s[20:23], s97 offen offset:1024 sc1 lds
    s_mov_b32 s78, s27
    s_waitcnt vmcnt(4)
    s_branch pc_87
pl_86:
    s_lshr_b32 s33, s73, 5
    s_lshl_b32 s33, s33, 11
    s_add_u32 s33, s33, s79
    s_add_u32 s33, s33, 0xd60000
    buffer_load_dwordx4 v[24:27], v22, s[20:23], s33 offen sc1
    s_waitcnt vmcnt(0)
pc_87:
    v_max3_u32 v30, v24, v25, v26
    v_max_u32 v30, v30, v27
    v_cmp_eq_u32 vcc, -1, v30
    s_cbranch_vccz pd_88
    s_sub_u32 s78, s78, 1
    s_cmp_lg_u32 s78, 0
    s_cbranch_scc1 pl_86
    s_mov_b32 s27, 1
pd_88:
    buffer_load_dwordx4 v253, s[20:23], s97 offen offset:2048 sc1 lds
    buffer_load_dwordx4 v253, s[20:23], s97 offen offset:3072 sc1 lds
    s_cmp_lt_u32 s29, 224
    s_cbranch_scc1 sk_89
    s_cmp_ge_u32 s28, 2
    s_cbranch_scc1 sk_89
    v_and_b32 v30, 2, v252
    v_cmp_eq_u32 vcc, 2, v30
    v_mov_b32 v28, s76
    v_mul_f32 v29, s75, v28
    v_add_f32 v28, 1.0, v28
    v_cndmask_b32 v30, v24, v26, vcc
    v_cndmask_b32 v31, v25, v27, vcc
    v_lshlrev_b32 v92, 16, v30
    v_and_b32 v93, 0xffff0000, v30
    v_lshlrev_b32 v94, 16, v31
    v_and_b32 v95, 0xffff0000, v31
    v_fma_f32 v92, v92, v28, -v29
    v_fma_f32 v93, v93, v28, -v29
    v_fma_f32 v94, v94, v28, -v29
    v_fma_f32 v95, v95, v28, -v29
    v_mov_b32 v96, 0xbfb8aa3b
    v_mul_f32 v96, s74, v96
    v_exp_f32 v96, v96
    s_nop 0
    v_add_f32 v96, 1.0, v96
    v_rcp_f32 v96, v96
sk_89:
    s_add_u32 s96, s94, 8
    s_and_b32 s96, s96, 15
    s_mul_i32 s96, s96, 393216
    s_add_u32 s96, s96, s85
    s_add_u32 m0, s87, 90112
    s_nop 0
    buffer_load_dwordx4 v8, s[16:19], s96 offen offset:0 lds
    buffer_load_dwordx4 v9, s[16:19], s96 offen offset:1024 lds
    v_mov_b32 v28, s76
    v_mul_f32 v29, s75, v28
    v_lshlrev_b32 v30, 16, v24
    v_and_b32 v31, 0xffff0000, v24
    v_fma_f32 v30, v30, v28, -v29
    buffer_load_dwordx4 v10, s[16:19], s96 offen offset:2048 lds
    v_fma_f32 v31, v31, v28, -v29
    v_cvt_pk_bf16_f32 v24, v30, v31
    v_lshlrev_b32 v30, 16, v25
    v_and_b32 v31, 0xffff0000, v25
    v_fma_f32 v30, v30, v28, -v29
    v_fma_f32 v31, v31, v28, -v29
    v_cvt_pk_bf16_f32 v25, v30, v31
    v_lshlrev_b32 v30, 16, v26
    v_and_b32 v31, 0xffff0000, v26
    v_fma_f32 v30, v30, v28, -v29
    buffer_load_dwordx4 v11, s[16:19], s96 offen offset:3072 lds
    v_fma_f32 v31, v31, v28, -v29
    v_cvt_pk_bf16_f32 v26, v30, v31
    v_lshlrev_b32 v30, 16, v27
    v_and_b32 v31, 0xffff0000, v27
    v_fma_f32 v30, v30, v28, -v29
    v_fma_f32 v31, v31, v28, -v29
    v_cvt_pk_bf16_f32 v27, v30, v31
    s_bitcmp0_b32 s29, 0
    s_cbranch_scc1 sk_90
    v_swap_b32 v24, v25
    v_swap_b32 v26, v27
sk_90:
    s_add_u32 m0, s87, 94208
    s_nop 0
    buffer_load_dwordx4 v12, s[16:19], s96 offen offset:0 lds
    s_bitcmp0_b32 s29, 1
    s_cbranch_scc1 sk_91
    v_swap_b32 v24, v26
    v_swap_b32 v25, v27
sk_91:
    buffer_load_dwordx4 v13, s[16:19], s96 offen offset:1024 lds
    v_dot2_f32_bf16 v32, v155, v24, 0
    v_dot2_f32_bf16 v33, v160, v24, 0
    v_dot2_f32_bf16 v34, v156, v24, 0
    v_dot2_f32_bf16 v35, v161, v24, 0
    v_dot2_f32_bf16 v36, v157, v24, 0
    v_dot2_f32_bf16 v37, v162, v24, 0
    v_dot2_f32_bf16 v38, v158, v24, 0
    v_dot2_f32_bf16 v39, v163, v24, 0
    v_dot2_f32_bf16 v40, v183, v24, 0
    v_dot2_f32_bf16 v41, v192, v24, 0
    v_dot2_f32_bf16 v42, v188, v24, 0
    v_dot2_f32_bf16 v43, v193, v24, 0
    v_dot2_f32_bf16 v44, v189, v24, 0
    v_dot2_f32_bf16 v45, v194, v24, 0
    v_dot2_f32_bf16 v46, v190, v24, 0
    v_dot2_f32_bf16 v47, v195, v24, 0
    v_dot2_f32_bf16 v32, v159, v25, v32
    v_dot2_f32_bf16 v33, v168, v25, v33
    v_dot2_f32_bf16 v34, v164, v25, v34
    v_dot2_f32_bf16 v35, v169, v25, v35
    v_dot2_f32_bf16 v36, v165, v25, v36
    v_dot2_f32_bf16 v37, v170, v25, v37
    v_dot2_f32_bf16 v38, v166, v25, v38
    v_dot2_f32_bf16 v39, v171, v25, v39
    v_dot2_f32_bf16 v40, v191, v25, v40
    v_dot2_f32_bf16 v41, v200, v25, v41
    v_dot2_f32_bf16 v42, v196, v25, v42
    v_dot2_f32_bf16 v43, v201, v25, v43
    v_dot2_f32_bf16 v44, v197, v25, v44
    v_dot2_f32_bf16 v45, v202, v25, v45
    v_dot2_f32_bf16 v46, v198, v25, v46
    v_dot2_f32_bf16 v47, v203, v25, v47
    v_dot2_f32_bf16 v32, v167, v26, v32
    v_dot2_f32_bf16 v33, v176, v26, v33
    v_dot2_f32_bf16 v34, v172, v26, v34
    v_dot2_f32_bf16 v35, v177, v26, v35
    v_dot2_f32_bf16 v36, v173, v26, v36
    v_dot2_f32_bf16 v37, v178, v26, v37
    v_dot2_f32_bf16 v38, v174, v26, v38
    v_dot2_f32_bf16 v39, v179, v26, v39
    v_dot2_f32_bf16 v40, v199, v26, v40
    v_dot2_f32_bf16 v41, v208, v26, v41
    v_dot2_f32_bf16 v42, v204, v26, v42
    v_dot2_f32_bf16 v43, v209, v26, v43
    v_dot2_f32_bf16 v44, v205, v26, v44
    v_dot2_f32_bf16 v45, v210, v26, v45
    v_dot2_f32_bf16 v46, v206, v26, v46
    v_dot2_f32_bf16 v47, v211, v26, v47
    v_dot2_f32_bf16 v32, v175, v27, v32
    v_dot2_f32_bf16 v33, v184, v27, v33
    v_dot2_f32_bf16 v34, v180, v27, v34
    v_dot2_f32_bf16 v35, v185, v27, v35
    v_dot2_f32_bf16 v36, v181, v27, v36
    v_dot2_f32_bf16 v37, v186, v27, v37
    v_dot2_f32_bf16 v38, v182, v27, v38
    v_dot2_f32_bf16 v39, v187, v27, v39
    v_dot2_f32_bf16 v40, v207, v27, v40
    v_dot2_f32_bf16 v41, v216, v27, v41
    v_dot2_f32_bf16 v42, v212, v27, v42
    v_dot2_f32_bf16 v43, v217, v27, v43
    v_dot2_f32_bf16 v44, v213, v27, v44
    v_dot2_f32_bf16 v45, v218, v27, v45
    v_dot2_f32_bf16 v46, v214, v27, v46
    v_dot2_f32_bf16 v47, v219, v27, v47
    s_waitcnt vmcnt(10) lgkmcnt(0)
    s_barrier
    s_add_u32 s96, s95, 9
    s_and_b32 s96, s96, 15
    s_lshl_b32 s97, s96, 14
    s_add_u32 s97, s97, s84
    s_add_u32 m0, s86, 147456
    s_nop 0
    buffer_load_dwordx4 v253, s[20:23], s97 offen offset:0 sc1 lds
    buffer_load_dwordx4 v253, s[20:23], s97 offen offset:1024 sc1 lds
    v_lshrrev_b32 v31, 5, v252
    v_lshlrev_b32 v30, 6, v31
    v_permlane32_swap_b32 v32, v40
    v_permlane32_swap_b32 v33, v41
    v_permlane32_swap_b32 v34, v42
    v_permlane32_swap_b32 v35, v43
    buffer_load_dwordx4 v253, s[20:23], s97 offen offset:2048 sc1 lds
    v_permlane32_swap_b32 v36, v44
    v_permlane32_swap_b32 v37, v45
    v_permlane32_swap_b32 v38, v46
    v_permlane32_swap_b32 v39, v47
    v_add_f32 v32, v32, v40
    buffer_load_dwordx4 v253, s[20:23], s97 offen offset:3072 sc1 lds
    v_add_f32 v33, v33, v41
    v_add_f32 v34, v34, v42
    v_add_f32 v35, v35, v43
    v_add_f32 v36, v36, v44
    v_add_f32 v37, v37, v45
    s_add_u32 s96, s95, 9
    s_and_b32 s96, s96, 15
    s_mul_i32 s96, s96, 393216
    s_add_u32 s96, s96, s85
    s_add_u32 m0, s87, 40960
    s_nop 0
    buffer_load_dwordx4 v8, s[16:19], s96 offen offset:0 lds
    v_add_f32 v38, v38, v46
    v_add_f32 v39, v39, v47
    v_and_b32 v31, 1, v252
    v_lshl_add_u32 v30, v31, 5, v30
    v_permlane16_swap_b32 v32, v36
    buffer_load_dwordx4 v9, s[16:19], s96 offen offset:1024 lds
    v_permlane16_swap_b32 v33, v37
    v_permlane16_swap_b32 v34, v38
    v_permlane16_swap_b32 v35, v39
    v_add_f32 v32, v32, v36
    v_add_f32 v33, v33, v37
    v_add_f32 v34, v34, v38
    buffer_load_dwordx4 v10, s[16:19], s96 offen offset:2048 lds
    v_add_f32 v35, v35, v39
    v_and_b32 v31, 16, v252
    s_lshl_b32 s32, s28, 7
    v_add3_u32 v30, v31, v30, s32
    v_add_f32_dpp v32, v32, v32 quad_perm:[2,3,0,1] row_mask:0xf bank_mask:0xf
    buffer_load_dwordx4 v11, s[16:19], s96 offen offset:3072 lds
    v_add_f32_dpp v33, v33, v33 quad_perm:[2,3,0,1] row_mask:0xf bank_mask:0xf
    v_add_f32_dpp v34, v34, v34 quad_perm:[2,3,0,1] row_mask:0xf bank_mask:0xf
    v_add_f32_dpp v35, v35, v35 quad_perm:[2,3,0,1] row_mask:0xf bank_mask:0xf
    v_add_f32_dpp v32, v32, v32 row_ror:4 row_mask:0xf bank_mask:0xf
    v_add_f32_dpp v33, v33, v33 row_ror:4 row_mask:0xf bank_mask:0xf
    s_add_u32 m0, s87, 45056
    s_nop 0
    buffer_load_dwordx4 v12, s[16:19], s96 offen offset:0 lds
    v_add_f32_dpp v34, v34, v34 row_ror:4 row_mask:0xf bank_mask:0xf
    v_add_f32_dpp v35, v35, v35 row_ror:4 row_mask:0xf bank_mask:0xf
    v_add_f32_dpp v32, v32, v32 row_ror:8 row_mask:0xf bank_mask:0xf
    v_add_f32_dpp v33, v33, v33 row_ror:8 row_mask:0xf bank_mask:0xf
    v_add_f32_dpp v34, v34, v34 row_ror:8 row_mask:0xf bank_mask:0xf
    buffer_load_dwordx4 v13, s[16:19], s96 offen offset:1024 lds
    v_add_f32_dpp v35, v35, v35 row_ror:8 row_mask:0xf bank_mask:0xf
    s_mov_b32 exec_lo, 0x00030003
    s_mov_b32 exec_hi, 0x00030003
    ds_write_b128 v30, v[32:35] offset:3328
    s_mov_b64 exec, -1
    s_waitcnt vmcnt(10) lgkmcnt(0)
    s_barrier
    s_add_u32 s96, s94, 10
    s_and_b32 s96, s96, 15
    s_lshl_b32 s97, s96, 14
    s_add_u32 s97, s97, s84
    s_add_u32 m0, s86, 131072
    s_nop 0
    buffer_load_dwordx4 v253, s[20:23], s97 offen offset:0 sc1 lds
    buffer_load_dwordx4 v253, s[20:23], s97 offen offset:1024 sc1 lds
    v_and_b32 v30, 1, v252
    v_bfe_u32 v31, v252, 1, 3
    v_lshl_add_u32 v30, v30, 3, v31
    v_lshlrev_b32 v30, 2, v30
    v_add_u32 v30, 3328, v30
    buffer_load_dwordx4 v253, s[20:23], s97 offen offset:2048 sc1 lds
    ds_read2_b32 v[32:33], v30 offset0:0 offset1:16
    ds_read2_b32 v[34:35], v30 offset0:32 offset1:48
    ds_read2_b32 v[36:37], v30 offset0:64 offset1:80
    ds_read2_b32 v[38:39], v30 offset0:96 offset1:112
    v_lshrrev_b32 v30, 2, v252
    buffer_load_dwordx4 v253, s[20:23], s97 offen offset:3072 sc1 lds
    v_mul_u32_u24 v30, 14336, v30
    v_and_b32 v31, 3, v252
    v_lshl_add_u32 v30, v31, 4, v30
    v_and_b32 v31, 1, v252
    v_cmp_eq_u32 vcc, 1, v31
    s_add_u32 s96, s94, 10
    s_and_b32 s96, s96, 15
    s_mul_i32 s96, s96, 393216
    s_add_u32 s96, s96, s85
    s_add_u32 m0, s87, 65536
    s_nop 0
    buffer_load_dwordx4 v8, s[16:19], s96 offen offset:0 lds
    s_mul_i32 s32, s28, 229376
    s_lshl_b32 s33, s29, 6
    s_add_u32 s32, s32, s33
    s_add_u32 s32, s32, s79
    s_add_u32 s32, s32, 0xc80000
    buffer_load_dwordx4 v9, s[16:19], s96 offen offset:1024 lds
    s_waitcnt lgkmcnt(0)
    v_add_f32 v32, v32, v34
    v_add_f32 v33, v33, v35
    v_add_f32 v36, v36, v38
    v_add_f32 v37, v37, v39
    buffer_load_dwordx4 v10, s[16:19], s96 offen offset:2048 lds
    v_add_f32 v32, v32, v36
    v_add_f32 v33, v33, v37
    v_mul_f32 v34, 0xbfb8aa3b, v32
    v_exp_f32 v34, v34
    v_mul_f32 v32, v32, v33
    buffer_load_dwordx4 v11, s[16:19], s96 offen offset:3072 lds
    v_add_f32 v34, 1.0, v34
    v_rcp_f32 v34, v34
    s_nop 0
    v_mul_f32 v32, v32, v34
    s_nop 1
    v_mov_b32_dpp v33, v32 quad_perm:[2,3,2,3] row_mask:0xf bank_mask:0xf
    v_cvt_pk_bf16_f32 v32, v32, v33
    s_add_u32 m0, s87, 69632
    s_nop 0
    buffer_load_dwordx4 v12, s[16:19], s96 offen offset:0 lds
    ds_swizzle_b32 v36, v32 offset:0x1
    ds_swizzle_b32 v37, v32 offset:0x81
    ds_swizzle_b32 v38, v32 offset:0x101
    ds_swizzle_b32 v39, v32 offset:0x181
    s_waitcnt lgkmcnt(0)
    buffer_load_dwordx4 v13, s[16:19], s96 offen offset:1024 lds
    v_dot2_f32_bf16 v40, v215, v36, 0
    v_dot2_f32_bf16 v41, v224, v36, 0
    v_dot2_f32_bf16 v42, v220, v36, 0
    v_dot2_f32_bf16 v43, v225, v36, 0
    v_dot2_f32_bf16 v44, v221, v36, 0
    v_dot2_f32_bf16 v45, v226, v36, 0
    v_dot2_f32_bf16 v46, v222, v36, 0
    v_dot2_f32_bf16 v47, v227, v36, 0
    v_dot2_f32_bf16 v40, v223, v37, v40
    v_dot2_f32_bf16 v41, v232, v37, v41
    v_dot2_f32_bf16 v42, v228, v37, v42
    v_dot2_f32_bf16 v43, v233, v37, v43
    v_dot2_f32_bf16 v44, v229, v37, v44
    v_dot2_f32_bf16 v45, v234, v37, v45
    v_dot2_f32_bf16 v46, v230, v37, v46
    v_dot2_f32_bf16 v47, v235, v37, v47
    v_dot2_f32_bf16 v40, v231, v38, v40
    v_dot2_f32_bf16 v41, v240, v38, v41
    v_dot2_f32_bf16 v42, v236, v38, v42
    v_dot2_f32_bf16 v43, v241, v38, v43
    v_dot2_f32_bf16 v44, v237, v38, v44
    v_dot2_f32_bf16 v45, v242, v38, v45
    v_dot2_f32_bf16 v46, v238, v38, v46
    v_dot2_f32_bf16 v47, v243, v38, v47
    v_dot2_f32_bf16 v40, v239, v39, v40
    v_dot2_f32_bf16 v41, v248, v39, v41
    v_dot2_f32_bf16 v42, v244, v39, v42
    v_dot2_f32_bf16 v43, v249, v39, v43
    v_dot2_f32_bf16 v44, v245, v39, v44
    v_dot2_f32_bf16 v45, v250, v39, v45
    v_dot2_f32_bf16 v46, v246, v39, v46
    v_dot2_f32_bf16 v47, v251, v39, v47
    v_add_f32_dpp v40, v40, v40 quad_perm:[1,0,3,2] row_mask:0xf bank_mask:0xf
    v_add_f32_dpp v41, v41, v41 quad_perm:[1,0,3,2] row_mask:0xf bank_mask:0xf
    v_add_f32_dpp v42, v42, v42 quad_perm:[1,0,3,2] row_mask:0xf bank_mask:0xf
    v_add_f32_dpp v43, v43, v43 quad_perm:[1,0,3,2] row_mask:0xf bank_mask:0xf
    v_add_f32_dpp v44, v44, v44 quad_perm:[1,0,3,2] row_mask:0xf bank_mask:0xf
    v_add_f32_dpp v45, v45, v45 quad_perm:[1,0,3,2] row_mask:0xf bank_mask:0xf
    v_add_f32_dpp v46, v46, v46 quad_perm:[1,0,3,2] row_mask:0xf bank_mask:0xf
    v_add_f32_dpp v47, v47, v47 quad_perm:[1,0,3,2] row_mask:0xf bank_mask:0xf
    v_cndmask_b32 v40, v40, v44, vcc
    v_cndmask_b32 v41, v41, v45, vcc
    v_cndmask_b32 v42, v42, v46, vcc
    v_cndmask_b32 v43, v43, v47, vcc
    s_cmp_lt_u32 s29, 224
    s_cselect_b64 exec, -1, 0
    buffer_store_dwordx4 v[40:43], v30, s[20:23], s32 offen sc1
    s_mov_b64 exec, -1
    s_waitcnt vmcnt(10) lgkmcnt(0)
    s_barrier
    s_add_u32 s96, s95, 11
    s_and_b32 s96, s96, 15
    s_lshl_b32 s97, s96, 14
    s_add_u32 s97, s97, s84
    s_add_u32 m0, s86, 114688
    s_nop 0
    buffer_load_dwordx4 v253, s[20:23], s97 offen offset:0 sc1 lds
    buffer_load_dwordx4 v253, s[20:23], s97 offen offset:1024 sc1 lds
    buffer_load_dwordx4 v253, s[20:23], s97 offen offset:2048 sc1 lds
    buffer_load_dwordx4 v253, s[20:23], s97 offen offset:3072 sc1 lds
    s_add_u32 s96, s95, 11
    s_and_b32 s96, s96, 15
    s_mul_i32 s96, s96, 393216
    s_add_u32 s96, s96, s85
    s_add_u32 m0, s87, 90112
    s_nop 0
    buffer_load_dwordx4 v8, s[16:19], s96 offen offset:0 lds
    buffer_load_dwordx4 v9, s[16:19], s96 offen offset:1024 lds
    buffer_load_dwordx4 v10, s[16:19], s96 offen offset:2048 lds
    buffer_load_dwordx4 v11, s[16:19], s96 offen offset:3072 lds
    s_add_u32 m0, s87, 94208
    s_nop 0
    buffer_load_dwordx4 v12, s[16:19], s96 offen offset:0 lds
    buffer_load_dwordx4 v13, s[16:19], s96 offen offset:1024 lds
    s_waitcnt vmcnt(10) lgkmcnt(0)
    s_barrier
    s_add_u32 s96, s94, 12
    s_and_b32 s96, s96, 15
    s_lshl_b32 s97, s96, 14
    s_add_u32 s97, s97, s84
    s_add_u32 m0, s86, 147456
    s_nop 0
    buffer_load_dwordx4 v253, s[20:23], s97 offen offset:0 sc1 lds
    buffer_load_dwordx4 v253, s[20:23], s97 offen offset:1024 sc1 lds
    buffer_load_dwordx4 v253, s[20:23], s97 offen offset:2048 sc1 lds
    buffer_load_dwordx4 v253, s[20:23], s97 offen offset:3072 sc1 lds
    s_add_u32 s96, s94, 12
    s_and_b32 s96, s96, 15
    s_mul_i32 s96, s96, 393216
    s_add_u32 s96, s96, s85
    s_add_u32 m0, s87, 40960
    s_nop 0
    buffer_load_dwordx4 v8, s[16:19], s96 offen offset:0 lds
    buffer_load_dwordx4 v9, s[16:19], s96 offen offset:1024 lds
    buffer_load_dwordx4 v10, s[16:19], s96 offen offset:2048 lds
    buffer_load_dwordx4 v11, s[16:19], s96 offen offset:3072 lds
    s_add_u32 m0, s87, 45056
    s_nop 0
    buffer_load_dwordx4 v12, s[16:19], s96 offen offset:0 lds
    buffer_load_dwordx4 v13, s[16:19], s96 offen offset:1024 lds
    s_waitcnt vmcnt(10) lgkmcnt(0)
    s_barrier
    s_cmp_lt_u32 s29, 224
    s_cbranch_scc1 sk_107
    s_cmp_ge_u32 s28, 2
    s_cbranch_scc1 sk_107
    s_mul_i32 s32, s89, 14336
    s_add_u32 s32, s32, s79
    s_add_u32 s32, s32, 0xc80000
    buffer_load_dwordx4 v[32:35], v253, s[20:23], s32 offen offset:0 sc1
    buffer_load_dwordx4 v[36:39], v253, s[20:23], s32 offen offset:1024 sc1
    buffer_load_dwordx4 v[40:43], v253, s[20:23], s32 offen offset:2048 sc1
    buffer_load_dwordx4 v[44:47], v253, s[20:23], s32 offen offset:3072 sc1
    s_add_u32 s32, s32, 4096
    buffer_load_dwordx4 v[48:51], v253, s[20:23], s32 offen offset:0 sc1
    buffer_load_dwordx4 v[52:55], v253, s[20:23], s32 offen offset:1024 sc1
    buffer_load_dwordx4 v[56:59], v253, s[20:23], s32 offen offset:2048 sc1
    buffer_load_dwordx4 v[60:63], v253, s[20:23], s32 offen offset:3072 sc1
    s_add_u32 s32, s32, 4096
    buffer_load_dwordx4 v[64:67], v253, s[20:23], s32 offen offset:0 sc1
    buffer_load_dwordx4 v[68:71], v253, s[20:23], s32 offen offset:1024 sc1
    buffer_load_dwordx4 v[72:75], v253, s[20:23], s32 offen offset:2048 sc1
    buffer_load_dwordx4 v[76:79], v253, s[20:23], s32 offen offset:3072 sc1
    s_add_u32 s32, s32, 4096
    buffer_load_dwordx4 v[80:83], v253, s[20:23], s32 offen offset:0 sc1
    buffer_load_dwordx4 v[84:87], v253, s[20:23], s32 offen offset:1024 sc1
sk_107:
    s_add_u32 s96, s95, 13
    s_and_b32 s96, s96, 15
    s_lshl_b32 s97, s96, 14
    s_add_u32 s97, s97, s84
    s_add_u32 m0, s86, 131072
    s_nop 0
    buffer_load_dwordx4 v253, s[20:23], s97 offen offset:0 sc1 lds
    buffer_load_dwordx4 v253, s[20:23], s97 offen offset:1024 sc1 lds
    buffer_load_dwordx4 v253, s[20:23], s97 offen offset:2048 sc1 lds
    buffer_load_dwordx4 v253, s[20:23], s97 offen offset:3072 sc1 lds
    s_add_u32 s96, s95, 13
    s_and_b32 s96, s96, 15
    s_mul_i32 s96, s96, 393216
    s_add_u32 s96, s96, s85
    s_add_u32 m0, s87, 65536
    s_nop 0
    buffer_load_dwordx4 v8, s[16:19], s96 offen offset:0 lds
    buffer_load_dwordx4 v9, s[16:19], s96 offen offset:1024 lds
    buffer_load_dwordx4 v10, s[16:19], s96 offen offset:2048 lds
    buffer_load_dwordx4 v11, s[16:19], s96 offen offset:3072 lds
    s_add_u32 m0, s87, 69632
    s_nop 0
    buffer_load_dwordx4 v12, s[16:19], s96 offen offset:0 lds
    buffer_load_dwordx4 v13, s[16:19], s96 offen offset:1024 lds
    s_waitcnt vmcnt(10) lgkmcnt(0)
    s_barrier
    s_add_u32 s96, s94, 14
    s_and_b32 s96, s96, 15
    s_lshl_b32 s97, s96, 14
    s_add_u32 s97, s97, s84
    s_add_u32 m0, s86, 114688
    s_nop 0
    buffer_load_dwordx4 v253, s[20:23], s97 offen offset:0 sc1 lds
    buffer_load_dwordx4 v253, s[20:23], s97 offen offset:1024 sc1 lds
    s_cmp_lt_u32 s29, 224
    s_cbranch_scc1 sk_108
    s_cmp_ge_u32 s28, 2
    s_cbranch_scc1 sk_108
    s_mov_b32 s78, s27
    s_waitcnt vmcnt(12)
    s_branch pc_94
pl_93:
    s_mul_i32 s32, s89, 14336
    s_add_u32 s32, s32, s79
    s_add_u32 s32, s32, 0xc80000
    buffer_load_dwordx4 v[32:35], v253, s[20:23], s32 offen offset:0 sc1
    buffer_load_dwordx4 v[36:39], v253, s[20:23], s32 offen offset:1024 sc1
    buffer_load_dwordx4 v[40:43], v253, s[20:23], s32 offen offset:2048 sc1
    buffer_load_dwordx4 v[44:47], v253, s[20:23], s32 offen offset:3072 sc1
    s_add_u32 s32, s32, 4096
    buffer_load_dwordx4 v[48:51], v253, s[20:23], s32 offen offset:0 sc1
    buffer_load_dwordx4 v[52:55], v253, s[20:23], s32 offen offset:1024 sc1
    buffer_load_dwordx4 v[56:59], v253, s[20:23], s32 offen offset:2048 sc1
    buffer_load_dwordx4 v[60:63], v253, s[20:23], s32 offen offset:3072 sc1
    s_add_u32 s32, s32, 4096
    buffer_load_dwordx4 v[64:67], v253, s[20:23], s32 offen offset:0 sc1
    buffer_load_dwordx4 v[68:71], v253, s[20:23], s32 offen offset:1024 sc1
    buffer_load_dwordx4 v[72:75], v253, s[20:23], s32 offen offset:2048 sc1
    buffer_load_dwordx4 v[76:79], v253, s[20:23], s32 offen offset:3072 sc1
    s_add_u32 s32, s32, 4096
    buffer_load_dwordx4 v[80:83], v253, s[20:23], s32 offen offset:0 sc1
    buffer_load_dwordx4 v[84:87], v253, s[20:23], s32 offen offset:1024 sc1
    s_waitcnt vmcnt(0)
pc_94:
    v_max3_u32 v30, v32, v36, v40
    v_max3_u32 v30, v30, v44, v48
    v_max3_u32 v30, v30, v52, v56
    v_max3_u32 v30, v30, v60, v64
    v_max3_u32 v30, v30, v68, v72
    v_max3_u32 v30, v30, v76, v80
    v_max_u32 v30, v30, v84
    v_cmp_eq_u32 vcc, -1, v30
    s_cbranch_vccz pd_95
    s_sub_u32 s78, s78, 1
    s_cmp_lg_u32 s78, 0
    s_cbranch_scc1 pl_93
    s_mov_b32 s27, 1
pd_95:
sk_108:
    buffer_load_dwordx4 v253, s[20:23], s97 offen offset:2048 sc1 lds
    buffer_load_dwordx4 v253, s[20:23], s97 offen offset:3072 sc1 lds
    s_cmp_lt_u32 s29, 224
    s_cbranch_scc1 sk_109
    s_cmp_ge_u32 s28, 2
    s_cbranch_scc1 sk_109
sk_109:
    s_cmp_lt_u32 s29, 224
    s_cbranch_scc1 sk_110
    s_cmp_ge_u32 s28, 2
    s_cbranch_scc1 sk_110
    v_add_f32 v32, v32, v36
    v_add_f32 v33, v33, v37
    v_add_f32 v34, v34, v38
    v_add_f32 v35, v35, v39
    v_add_f32 v32, v32, v40
    v_add_f32 v33, v33, v41
    v_add_f32 v34, v34, v42
    v_add_f32 v35, v35, v43
    v_add_f32 v32, v32, v44
    v_add_f32 v33, v33, v45
sk_110:
    s_add_u32 s96, s94, 14
    s_and_b32 s96, s96, 15
    s_mul_i32 s96, s96, 393216
    s_add_u32 s96, s96, s85
    s_add_u32 m0, s87, 90112
    s_nop 0
    buffer_load_dwordx4 v8, s[16:19], s96 offen offset:0 lds
    s_cmp_lt_u32 s29, 224
    s_cbranch_scc1 sk_111
    s_cmp_ge_u32 s28, 2
    s_cbranch_scc1 sk_111
    v_add_f32 v34, v34, v46
    v_add_f32 v35, v35, v47
    v_add_f32 v32, v32, v48
    v_add_f32 v33, v33, v49
    v_add_f32 v34, v34, v50
    v_add_f32 v35, v35, v51
    v_add_f32 v32, v32, v52
    v_add_f32 v33, v33, v53
    v_add_f32 v34, v34, v54
    v_add_f32 v35, v35, v55
    v_add_f32 v32, v32, v56
    v_add_f32 v33, v33, v57
    v_add_f32 v34, v34, v58
    v_add_f32 v35, v35, v59
    v_add_f32 v32, v32, v60
    v_add_f32 v33, v33, v61
    v_add_f32 v34, v34, v62
    v_add_f32 v35, v35, v63
sk_111:
    buffer_load_dwordx4 v9, s[16:19], s96 offen offset:1024 lds
    s_cmp_lt_u32 s29, 224
    s_cbranch_scc1 sk_112
    s_cmp_ge_u32 s28, 2
    s_cbranch_scc1 sk_112
    v_add_f32 v32, v32, v64
    v_add_f32 v33, v33, v65
    v_add_f32 v34, v34, v66
    v_add_f32 v35, v35, v67
    v_add_f32 v32, v32, v68
    v_add_f32 v33, v33, v69
    v_add_f32 v34, v34, v70
    v_add_f32 v35, v35, v71
    v_add_f32 v32, v32, v72
    v_add_f32 v33, v33, v73
    v_add_f32 v34, v34, v74
    v_add_f32 v35, v35, v75
    v_add_f32 v32, v32, v76
    v_add_f32 v33, v33, v77
    v_add_f32 v34, v34, v78
    v_add_f32 v35, v35, v79
    v_add_f32 v32, v32, v80
sk_112:
    buffer_load_dwordx4 v10, s[16:19], s96 offen offset:2048 lds
    s_cmp_lt_u32 s29, 224
    s_cbranch_scc1 sk_113
    s_cmp_ge_u32 s28, 2
    s_cbranch_scc1 sk_113
    v_add_f32 v33, v33, v81
    v_add_f32 v34, v34, v82
    v_add_f32 v35, v35, v83
    v_add_f32 v32, v32, v84
    v_add_f32 v33, v33, v85
    v_add_f32 v34, v34, v86
    v_add_f32 v35, v35, v87
    v_add_f32_dpp v32, v32, v32 row_ror:4 row_mask:0xf bank_mask:0xf
    v_add_f32_dpp v33, v33, v33 row_ror:4 row_mask:0xf bank_mask:0xf
    v_add_f32_dpp v34, v34, v34 row_ror:4 row_mask:0xf bank_mask:0xf
    v_add_f32_dpp v35, v35, v35 row_ror:4 row_mask:0xf bank_mask:0xf
    v_add_f32_dpp v32, v32, v32 row_ror:8 row_mask:0xf bank_mask:0xf
    v_add_f32_dpp v33, v33, v33 row_ror:8 row_mask:0xf bank_mask:0xf
    v_add_f32_dpp v34, v34, v34 row_ror:8 row_mask:0xf bank_mask:0xf
    v_add_f32_dpp v35, v35, v35 row_ror:8 row_mask:0xf bank_mask:0xf
    v_mov_b32 v36, v32
    v_mov_b32 v37, v33
    v_mov_b32 v38, v34
sk_113:
    buffer_load_dwordx4 v11, s[16:19], s96 offen offset:3072 lds
    s_cmp_lt_u32 s29, 224
    s_cbranch_scc1 sk_114
    s_cmp_ge_u32 s28, 2
    s_cbranch_scc1 sk_114
    v_mov_b32 v39, v35
    v_permlane16_swap_b32 v32, v36
    v_permlane16_swap_b32 v33, v37
    v_permlane16_swap_b32 v34, v38
    v_permlane16_swap_b32 v35, v39
    v_add_f32 v32, v32, v36
    v_add_f32 v33, v33, v37
    v_add_f32 v34, v34, v38
    v_add_f32 v35, v35, v39
    v_mov_b32 v36, v32
    v_mov_b32 v37, v33
    v_mov_b32 v38, v34
    v_mov_b32 v39, v35
    v_permlane32_swap_b32 v32, v36
    v_permlane32_swap_b32 v33, v37
    v_permlane32_swap_b32 v34, v38
    v_permlane32_swap_b32 v35, v39
    v_add_f32 v32, v32, v36
sk_114:
    s_add_u32 m0, s87, 94208
    s_nop 0
    buffer_load_dwordx4 v12, s[16:19], s96 offen offset:0 lds
    buffer_load_dwordx4 v13, s[16:19], s96 offen offset:1024 lds
    s_cmp_lt_u32 s29, 224
    s_cbranch_scc1 sk_115
    s_cmp_ge_u32 s28, 2
    s_cbranch_scc1 sk_115
    v_add_f32 v33, v33, v37
    v_add_f32 v34, v34, v38
    v_add_f32 v35, v35, v39
    v_fma_f32 v32, v32, v96, v92
    v_fma_f32 v33, v33, v96, v93
    v_fma_f32 v34, v34, v96, v94
    v_fma_f32 v35, v35, v96, v95
    v_cvt_pk_bf16_f32 v32, v32, v33
    v_cvt_pk_bf16_f32 v33, v34, v35
    s_lshl_b32 s32, s89, 5
    s_add_u32 s32, s32, 0xdc4000
    v_and_b32 v30, 1, v252
    v_bfe_u32 v31, v252, 1, 1
    v_lshlrev_b32 v30, 4, v30
    v_lshl_add_u32 v30, v31, 3, v30
    s_mov_b64 exec, 15
    buffer_store_dwordx2 v[32:33], v30, s[20:23], s32 offen sc1
    s_mov_b64 exec, -1
sk_115:
    s_waitcnt vmcnt(10) lgkmcnt(0)
    s_barrier
    s_add_u32 s96, s95, 15
    s_and_b32 s96, s96, 15
    s_lshl_b32 s97, s96, 14
    s_add_u32 s97, s97, s84
    s_add_u32 m0, s86, 147456
    s_nop 0
    buffer_load_dwordx4 v253, s[20:23], s97 offen offset:0 sc1 lds
    buffer_load_dwordx4 v253, s[20:23], s97 offen offset:1024 sc1 lds
    buffer_load_dwordx4 v253, s[20:23], s97 offen offset:2048 sc1 lds
    buffer_load_dwordx4 v253, s[20:23], s97 offen offset:3072 sc1 lds
    s_add_u32 s96, s95, 15
    s_and_b32 s96, s96, 15
    s_mul_i32 s96, s96, 393216
    s_add_u32 s96, s96, s85
    s_add_u32 m0, s87, 40960
    s_nop 0
    buffer_load_dwordx4 v8, s[16:19], s96 offen offset:0 lds
    buffer_load_dwordx4 v9, s[16:19], s96 offen offset:1024 lds
    buffer_load_dwordx4 v10, s[16:19], s96 offen offset:2048 lds
    buffer_load_dwordx4 v11, s[16:19], s96 offen offset:3072 lds
    s_add_u32 m0, s87, 45056
    s_nop 0
    buffer_load_dwordx4 v12, s[16:19], s96 offen offset:0 lds
    buffer_load_dwordx4 v13, s[16:19], s96 offen offset:1024 lds
    s_waitcnt vmcnt(10) lgkmcnt(0)
    s_barrier
    s_min_u32 s30, s28, 2
    s_lshl_b32 s30, s30, 13
    s_add_u32 s30, s30, 90112
    v_lshrrev_b32 v20, 2, v252
    v_bfe_u32 v21, v20, 1, 2
    v_lshlrev_b32 v20, 7, v20
    v_lshl_add_u32 v20, v21, 5, v20
    v_and_b32 v21, 3, v252
    v_lshl_add_u32 v20, v21, 3, v20
    v_add_u32 v144, s30, v20
    v_xor_b32 v145, 32, v144
    v_xor_b32 v146, 64, v144
    v_xor_b32 v147, 96, v144
    ds_read_b64_tr_b16 v[100:101], v144 offset:0
    ds_read_b64_tr_b16 v[102:103], v144 offset:2048
    ds_read_b64_tr_b16 v[104:105], v144 offset:4096
    ds_read_b64_tr_b16 v[106:107], v144 offset:6144
    ds_read_b64_tr_b16 v[108:109], v145 offset:0
    ds_read_b64_tr_b16 v[110:111], v145 offset:2048
    ds_read_b64_tr_b16 v[112:113], v145 offset:4096
    ds_read_b64_tr_b16 v[114:115], v145 offset:6144
    ds_read_b64_tr_b16 v[116:117], v146 offset:0
    ds_read_b64_tr_b16 v[118:119], v146 offset:2048
    ds_read_b64_tr_b16 v[120:121], v146 offset:4096
    ds_read_b64_tr_b16 v[122:123], v146 offset:6144
    ds_read_b64_tr_b16 v[124:125], v147 offset:0
    ds_read_b64_tr_b16 v[126:127], v147 offset:2048
    ds_read_b64_tr_b16 v[128:129], v147 offset:4096
    ds_read_b64_tr_b16 v[130:131], v147 offset:6144
    s_getpc_b64 s[32:33]
pc_116:
    s_sub_u32 s32, s32, pc_116-interleave_layers__sliding_block__moe_arch_mod__prompt_kernel
    s_subb_u32 s33, s33, 0
    s_lshr_b32 s34, s2, 3
    s_lshl_b32 s34, s34, 2
    s_add_u32 s34, s34, s28
    s_and_b32 s34, s34, 127
    s_lshl_b32 s34, s34, 7
    v_lshl_add_u32 v154, v252, 14, s34
    s_mov_b32 s34, k_exit-interleave_layers__sliding_block__moe_arch_mod__prompt_kernel
    s_mov_b32 s35, 0x20000
    buffer_load_dword v154, v154, s[32:35], 0 offen
    s_waitcnt vmcnt(1) lgkmcnt(0)
    s_barrier
    s_add_u32 s35, s94, 14
    s_and_b32 s35, s35, 15
    s_lshl_b32 s35, s35, 7
    s_add_u32 s35, s35, 0xdc4000
    v_and_b32 v19, 48, v252
    buffer_load_dwordx4 v[132:135], v19, s[20:23], s35 offen offset:0 sc1
    buffer_load_dwordx4 v[136:139], v19, s[20:23], s35 offen offset:64 sc1
    s_cmp_eq_u32 s100, 0
    s_cbranch_scc1 sk_117
    v_and_b32 v20, 7, v252
    v_lshrrev_b32 v21, 4, v252
    v_lshl_add_u32 v21, v20, 2, v21
    s_and_b32 s34, s73, 31
    s_and_b32 s32, s34, 7
    s_and_b32 s33, s34, 8
    s_lshl_b32 s33, s33, 1
    s_add_u32 s32, s32, s33
    s_lshr_b32 s33, s34, 4
    s_lshl_b32 s33, s33, 3
    s_add_u32 s32, s32, s33
    s_cmp_eq_u32 s28, 1
    s_cselect_b32 s34, s32, s34
    v_mov_b32 v20, s34
    s_cmp_ge_u32 s28, 2
    s_cselect_b64 vcc, -1, 0
    s_cselect_b32 s32, 2048, 0
    v_cndmask_b32 v30, v20, v21, vcc
    v_cndmask_b32 v31, v21, v20, vcc
    v_lshlrev_b32 v0, 4, v30
    v_bfe_u32 v20, v31, 2, 2
    v_lshl_add_u32 v0, v20, 9, v0
    v_lshrrev_b32 v20, 4, v31
    v_lshl_add_u32 v0, v20, 3, v0
    v_and_b32 v20, 3, v31
    v_lshl_add_u32 v0, v20, 1, v0
    s_lshl_b32 s33, s39, 12
    s_add_u32 s33, s33, s32
    s_add_u32 s33, s33, 65536
    s_lshl_b32 s34, s39, 11
    s_add_u32 s34, s34, 32768
    s_cmp_ge_u32 s39, 8
    s_cselect_b32 s38, 1, 0
    s_movk_i32 s32, 8192
    s_cmp_eq_u32 s28, 0
    s_cselect_b32 s33, s34, s33
    s_cselect_b32 s32, s32, 49152
    s_cselect_b32 s38, s38, 1
    s_cselect_b32 s37, 0x3e8293ee, 1.0
    v_bfe_u32 v20, v252, 3, 1
    v_mul_u32_u24 v20, s32, v20
    v_add3_u32 v0, v0, v20, s33
sk_117:
    s_waitcnt lgkmcnt(0)
    s_barrier
    s_mov_b32 s78, s27
    s_waitcnt vmcnt(0)
    s_branch pc_119
pl_118:
    s_add_u32 s35, s94, 14
    s_and_b32 s35, s35, 15
    s_lshl_b32 s35, s35, 7
    s_add_u32 s35, s35, 0xdc4000
    v_and_b32 v19, 48, v252
    buffer_load_dwordx4 v[132:135], v19, s[20:23], s35 offen offset:0 sc1
    buffer_load_dwordx4 v[136:139], v19, s[20:23], s35 offen offset:64 sc1
    s_waitcnt vmcnt(0)
pc_119:
    v_max3_u32 v30, v132, v133, v134
    v_max3_u32 v30, v30, v135, v136
    v_max3_u32 v30, v30, v137, v138
    v_max_u32 v30, v30, v139
    v_cmp_eq_u32 vcc, -1, v30
    s_cbranch_vccz pd_120
    s_sub_u32 s78, s78, 1
    s_cmp_lg_u32 s78, 0
    s_cbranch_scc1 pl_118
    s_mov_b32 s27, 1
pd_120:
    v_mov_b32 v140, 0
    v_mov_b32 v141, 0
    v_mov_b32 v142, 0
    v_mov_b32 v143, 0
    v_dot2c_f32_bf16 v140, v132, v100
    v_dot2c_f32_bf16 v141, v132, v108
    v_dot2c_f32_bf16 v142, v132, v116
    v_dot2c_f32_bf16 v143, v132, v124
    v_dot2c_f32_bf16 v140, v133, v101
    v_dot2c_f32_bf16 v141, v133, v109
    v_dot2c_f32_bf16 v142, v133, v117
    v_dot2c_f32_bf16 v143, v133, v125
    v_dot2c_f32_bf16 v140, v134, v102
    v_dot2c_f32_bf16 v141, v134, v110
    v_dot2c_f32_bf16 v142, v134, v118
    v_dot2c_f32_bf16 v143, v134, v126
    v_dot2c_f32_bf16 v140, v135, v103
    v_dot2c_f32_bf16 v141, v135, v111
    v_dot2c_f32_bf16 v142, v135, v119
    v_dot2c_f32_bf16 v143, v135, v127
    v_dot2c_f32_bf16 v140, v136, v104
    v_dot2c_f32_bf16 v141, v136, v112
    v_dot2c_f32_bf16 v142, v136, v120
    v_dot2c_f32_bf16 v143, v136, v128
    v_dot2c_f32_bf16 v140, v137, v105
    v_dot2c_f32_bf16 v141, v137, v113
    v_dot2c_f32_bf16 v142, v137, v121
    v_dot2c_f32_bf16 v143, v137, v129
    v_dot2c_f32_bf16 v140, v138, v106
    v_dot2c_f32_bf16 v141, v138, v114
    v_dot2c_f32_bf16 v142, v138, v122
    v_dot2c_f32_bf16 v143, v138, v130
    v_dot2c_f32_bf16 v140, v139, v107
    v_dot2c_f32_bf16 v141, v139, v115
    v_dot2c_f32_bf16 v142, v139, v123
    v_dot2c_f32_bf16 v143, v139, v131
    s_min_u32 s32, s28, 2
    s_lshl_b32 s32, s32, 12
    s_lshl_b32 s33, s25, 14
    s_add_u32 s32, s32, s33
    s_add_u32 s32, s32, 0x1d80000
    s_lshl_b32 s33, s24, 8
    s_add_u32 s32, s32, s33
    v_lshlrev_b32 v20, 2, v252
    v_permlane32_swap_b32 v140, v142
    v_permlane32_swap_b32 v141, v143
    v_add_f32 v140, v140, v142
    v_add_f32 v141, v141, v143
    s_nop 1
    v_permlane16_swap_b32 v140, v141
    v_add_f32 v140, v140, v141
    buffer_store_dword v140, v20, s[20:23], s32 offen sc1
    s_branch l_att
l_patch:
    s_mov_b32 s78, s27
pl_121:
    s_min_u32 s32, s28, 2
    s_lshl_b32 s32, s32, 12
    s_lshl_b32 s33, s25, 14
    s_add_u32 s32, s32, s33
    s_add_u32 s32, s32, 0x1d80000
    buffer_load_dwordx4 v[56:59], v253, s[20:23], s32 offen offset:0 sc1
    buffer_load_dwordx4 v[60:63], v253, s[20:23], s32 offen offset:1024 sc1
    buffer_load_dwordx4 v[64:67], v253, s[20:23], s32 offen offset:2048 sc1
    buffer_load_dwordx4 v[68:71], v253, s[20:23], s32 offen offset:3072 sc1
    s_mov_b32 s32, 0xdc4000
    buffer_load_dwordx4 v[72:75], v253, s[20:23], s32 offen offset:0 sc1
    buffer_load_dwordx4 v[76:79], v253, s[20:23], s32 offen offset:1024 sc1
    buffer_load_dword v49, v48, s[20:23], s30 offen sc1
    s_waitcnt vmcnt(0)
pc_122:
    v_cmp_ne_u32 vcc, s88, v49
    s_ashr_i32 s34, s36, 31
    s_or_b32 s34, s34, vcc_lo
    v_max3_u32 v82, v56, v57, v58
    v_max3_u32 v82, v82, v59, v60
    v_max3_u32 v82, v82, v61, v62
    v_max3_u32 v82, v82, v63, v64
    v_max3_u32 v82, v82, v65, v66
    v_max3_u32 v82, v82, v67, v68
    v_max3_u32 v82, v82, v69, v70
    v_max3_u32 v82, v82, v71, v72
    v_max3_u32 v82, v82, v73, v74
    v_max3_u32 v82, v82, v75, v76
    v_max3_u32 v82, v82, v77, v78
    v_max_u32 v82, v82, v79
    v_cmp_eq_u32 vcc, -1, v82
    s_cbranch_vccz l_zok
    s_cmp_lg_u32 s34, 0
    s_cselect_b64 vcc, -1, 0
    s_cbranch_vccz pd_123
    s_sub_u32 s78, s78, 1
    s_cmp_lg_u32 s78, 0
    s_cbranch_scc1 pl_121
    s_mov_b32 s27, 1
pd_123:
    s_cmp_lg_u32 s34, 0
    s_cbranch_scc1 l_zok
    s_min_u32 s32, s28, 2
    s_lshl_b32 s32, s32, 12
    s_lshl_b32 s33, s25, 14
    s_add_u32 s32, s32, s33
    s_add_u32 s32, s32, 0x1d80000
    buffer_load_dwordx4 v[56:59], v253, s[20:23], s32 offen offset:0 sc1
    buffer_load_dwordx4 v[60:63], v253, s[20:23], s32 offen offset:1024 sc1
    buffer_load_dwordx4 v[64:67], v253, s[20:23], s32 offen offset:2048 sc1
    buffer_load_dwordx4 v[68:71], v253, s[20:23], s32 offen offset:3072 sc1
    s_mov_b32 s32, 0xdc4000
    buffer_load_dwordx4 v[72:75], v253, s[20:23], s32 offen offset:0 sc1
    buffer_load_dwordx4 v[76:79], v253, s[20:23], s32 offen offset:1024 sc1
    s_mov_b32 s36, -1
    s_lshl_b32 s30, s28, 13
    s_add_u32 m0, s30, 65536
    s_add_u32 s31, s35, 0
    buffer_load_dwordx4 v253, s[20:23], s31 offen offset:0 sc1 lds
    buffer_load_dwordx4 v253, s[20:23], s31 offen offset:1024 sc1 lds
    buffer_load_dwordx4 v253, s[20:23], s31 offen offset:2048 sc1 lds
    buffer_load_dwordx4 v253, s[20:23], s31 offen offset:3072 sc1 lds
    s_add_u32 m0, s30, 69632
    s_add_u32 s31, s35, 4096
    buffer_load_dwordx4 v253, s[20:23], s31 offen offset:0 sc1 lds
    buffer_load_dwordx4 v253, s[20:23], s31 offen offset:1024 sc1 lds
    buffer_load_dwordx4 v253, s[20:23], s31 offen offset:2048 sc1 lds
    buffer_load_dwordx4 v253, s[20:23], s31 offen offset:3072 sc1 lds
    s_add_u32 m0, s30, 114688
    s_add_u32 s31, s35, 262144
    buffer_load_dwordx4 v253, s[20:23], s31 offen offset:0 sc1 lds
    buffer_load_dwordx4 v253, s[20:23], s31 offen offset:1024 sc1 lds
    buffer_load_dwordx4 v253, s[20:23], s31 offen offset:2048 sc1 lds
    buffer_load_dwordx4 v253, s[20:23], s31 offen offset:3072 sc1 lds
    s_add_u32 m0, s30, 118784
    s_add_u32 s31, s35, 266240
    buffer_load_dwordx4 v253, s[20:23], s31 offen offset:0 sc1 lds
    buffer_load_dwordx4 v253, s[20:23], s31 offen offset:1024 sc1 lds
    buffer_load_dwordx4 v253, s[20:23], s31 offen offset:2048 sc1 lds
    buffer_load_dwordx4 v253, s[20:23], s31 offen offset:3072 sc1 lds
    s_mov_b32 s34, -1
    s_mov_b32 s78, s27
    s_waitcnt vmcnt(16)
    s_branch pc_125
pl_124:
    s_min_u32 s32, s28, 2
    s_lshl_b32 s32, s32, 12
    s_lshl_b32 s33, s25, 14
    s_add_u32 s32, s32, s33
    s_add_u32 s32, s32, 0x1d80000
    buffer_load_dwordx4 v[56:59], v253, s[20:23], s32 offen offset:0 sc1
    buffer_load_dwordx4 v[60:63], v253, s[20:23], s32 offen offset:1024 sc1
    buffer_load_dwordx4 v[64:67], v253, s[20:23], s32 offen offset:2048 sc1
    buffer_load_dwordx4 v[68:71], v253, s[20:23], s32 offen offset:3072 sc1
    s_mov_b32 s32, 0xdc4000
    buffer_load_dwordx4 v[72:75], v253, s[20:23], s32 offen offset:0 sc1
    buffer_load_dwordx4 v[76:79], v253, s[20:23], s32 offen offset:1024 sc1
    s_waitcnt vmcnt(0)
pc_125:
    v_max3_u32 v82, v56, v57, v58
    v_max3_u32 v82, v82, v59, v60
    v_max3_u32 v82, v82, v61, v62
    v_max3_u32 v82, v82, v63, v64
    v_max3_u32 v82, v82, v65, v66
    v_max3_u32 v82, v82, v67, v68
    v_max3_u32 v82, v82, v69, v70
    v_max3_u32 v82, v82, v71, v72
    v_max3_u32 v82, v82, v73, v74
    v_max3_u32 v82, v82, v75, v76
    v_max3_u32 v82, v82, v77, v78
    v_max_u32 v82, v82, v79
    v_cmp_eq_u32 vcc, -1, v82
    s_cbranch_vccz pd_126
    s_sub_u32 s78, s78, 1
    s_cmp_lg_u32 s78, 0
    s_cbranch_scc1 pl_124
    s_mov_b32 s27, 1
pd_126:
l_zok:
    v_mov_b32 v80, 0
    v_mov_b32 v81, 0
    v_dot2c_f32_bf16 v80, 0x3f803f80, v72
    v_dot2c_f32_bf16 v81, v72, v72
    v_dot2c_f32_bf16 v80, 0x3f803f80, v73
    v_dot2c_f32_bf16 v81, v73, v73
    v_dot2c_f32_bf16 v80, 0x3f803f80, v74
    v_dot2c_f32_bf16 v81, v74, v74
    v_dot2c_f32_bf16 v80, 0x3f803f80, v75
    v_dot2c_f32_bf16 v81, v75, v75
    v_dot2c_f32_bf16 v80, 0x3f803f80, v76
    v_dot2c_f32_bf16 v81, v76, v76
    v_dot2c_f32_bf16 v80, 0x3f803f80, v77
    v_dot2c_f32_bf16 v81, v77, v77
    v_dot2c_f32_bf16 v80, 0x3f803f80, v78
    v_dot2c_f32_bf16 v81, v78, v78
    v_dot2c_f32_bf16 v80, 0x3f803f80, v79
    v_dot2c_f32_bf16 v81, v79, v79
    v_pk_add_f32 v[56:57], v[56:57], v[60:61]
    v_pk_add_f32 v[58:59], v[58:59], v[62:63]
    v_pk_add_f32 v[56:57], v[56:57], v[64:65]
    v_pk_add_f32 v[58:59], v[58:59], v[66:67]
    v_pk_add_f32 v[56:57], v[56:57], v[68:69]
    v_pk_add_f32 v[58:59], v[58:59], v[70:71]
    s_nop 1
    v_permlane32_swap_b32 v56, v58
    v_permlane32_swap_b32 v57, v59
    v_add_f32 v56, v56, v58
    v_add_f32 v57, v57, v59
    s_nop 1
    v_permlane16_swap_b32 v56, v57
    v_add_f32 v56, v56, v57
    v_add_f32_dpp v80, v80, v80 quad_perm:[1,0,3,2] row_mask:0xf bank_mask:0xf
    v_add_f32_dpp v81, v81, v81 quad_perm:[1,0,3,2] row_mask:0xf bank_mask:0xf
    s_nop 0
    v_add_f32_dpp v80, v80, v80 quad_perm:[2,3,0,1] row_mask:0xf bank_mask:0xf
    v_add_f32_dpp v81, v81, v81 quad_perm:[2,3,0,1] row_mask:0xf bank_mask:0xf
    s_nop 0
    v_add_f32_dpp v80, v80, v80 row_half_mirror row_mask:0xf bank_mask:0xf
    v_add_f32_dpp v81, v81, v81 row_half_mirror row_mask:0xf bank_mask:0xf
    s_nop 0
    v_add_f32_dpp v80, v80, v80 row_mirror row_mask:0xf bank_mask:0xf
    v_add_f32_dpp v81, v81, v81 row_mirror row_mask:0xf bank_mask:0xf
    v_mov_b32 v82, v80
    v_mov_b32 v83, v81
    s_nop 0
    v_permlane16_swap_b32 v80, v82
    v_permlane16_swap_b32 v81, v83
    v_add_f32 v80, v80, v82
    v_add_f32 v81, v81, v83
    v_mov_b32 v82, v80
    v_mov_b32 v83, v81
    s_nop 0
    v_permlane32_swap_b32 v80, v82
    v_permlane32_swap_b32 v81, v83
    v_add_f32 v80, v80, v82
    v_add_f32 v81, v81, v83
    v_mul_f32 v80, 0x3a800000, v80
    v_mul_f32 v81, 0x3a800000, v81
    v_fma_f32 v81, -v80, v80, v81
    v_max_f32 v81, 0, v81
    v_add_f32 v81, 0x3727c5ac, v81
    v_rsq_f32 v81, v81
    v_fma_f32 v56, -v80, v2, v56
    v_mul_f32 v81, s37, v81
    v_mul_f32 v56, v56, v81
    v_cvt_pk_bf16_f32 v1, v56, v56
    s_cmp_lg_u32 s100, 2
    s_cbranch_scc1 sk_127
    s_cmp_lg_u32 s38, 0
    s_barrier
    s_cselect_b64 exec, -1, 0
    ds_write_b16 v0, v1
    s_mov_b64 exec, -1
    s_waitcnt lgkmcnt(0)
    s_barrier
sk_127:
    s_cmp_lg_u32 s34, 0
    s_cbranch_scc1 sk_128
    s_mov_b32 s36, -1
    s_lshl_b32 s30, s28, 13
    s_add_u32 m0, s30, 65536
    s_add_u32 s31, s35, 0
    buffer_load_dwordx4 v253, s[20:23], s31 offen offset:0 sc1 lds
    buffer_load_dwordx4 v253, s[20:23], s31 offen offset:1024 sc1 lds
    buffer_load_dwordx4 v253, s[20:23], s31 offen offset:2048 sc1 lds
    buffer_load_dwordx4 v253, s[20:23], s31 offen offset:3072 sc1 lds
    s_add_u32 m0, s30, 69632
    s_add_u32 s31, s35, 4096
    buffer_load_dwordx4 v253, s[20:23], s31 offen offset:0 sc1 lds
    buffer_load_dwordx4 v253, s[20:23], s31 offen offset:1024 sc1 lds
    buffer_load_dwordx4 v253, s[20:23], s31 offen offset:2048 sc1 lds
    buffer_load_dwordx4 v253, s[20:23], s31 offen offset:3072 sc1 lds
    s_add_u32 m0, s30, 114688
    s_add_u32 s31, s35, 262144
    buffer_load_dwordx4 v253, s[20:23], s31 offen offset:0 sc1 lds
    buffer_load_dwordx4 v253, s[20:23], s31 offen offset:1024 sc1 lds
    buffer_load_dwordx4 v253, s[20:23], s31 offen offset:2048 sc1 lds
    buffer_load_dwordx4 v253, s[20:23], s31 offen offset:3072 sc1 lds
    s_add_u32 m0, s30, 118784
    s_add_u32 s31, s35, 266240
    buffer_load_dwordx4 v253, s[20:23], s31 offen offset:0 sc1 lds
    buffer_load_dwordx4 v253, s[20:23], s31 offen offset:1024 sc1 lds
    buffer_load_dwordx4 v253, s[20:23], s31 offen offset:2048 sc1 lds
    buffer_load_dwordx4 v253, s[20:23], s31 offen offset:3072 sc1 lds
sk_128:
    s_branch l_patched
l_tail:
    v_mov_b32 v20, 0
    s_or_b32 s34, s72, s28
    s_cmp_lg_u32 s34, 0
    s_cbranch_scc1 sk_129
    s_mov_b32 s34, 0xdd8000
    v_mov_b32 v154, s88
    s_mov_b64 exec, 1
    s_waitcnt vmcnt(0)
    buffer_store_dword v154, v253, s[20:23], s34 offen sc1
    s_mov_b64 exec, -1
sk_129:
    s_barrier
    ds_read_b128 v[16:19], v20 offset:3072
    s_waitcnt lgkmcnt(0)
    v_readlane_b32 s74, v16, 0
    v_readlane_b32 s73, v17, 0
    v_readlane_b32 s75, v18, 0
    v_readlane_b32 s76, v19, 0
    s_and_b32 s73, s73, 2047
    s_mov_b32 s78, s27
pl_130:
    s_lshr_b32 s33, s73, 5
    s_lshl_b32 s33, s33, 11
    s_add_u32 s33, s33, s79
    s_add_u32 s33, s33, 0xd60000
    buffer_load_dwordx4 v[24:27], v22, s[20:23], s33 offen sc1
    s_waitcnt vmcnt(0)
pc_131:
    v_max3_u32 v30, v24, v25, v26
    v_max_u32 v30, v30, v27
    v_cmp_eq_u32 vcc, -1, v30
    s_cbranch_vccz pd_132
    s_sub_u32 s78, s78, 1
    s_cmp_lg_u32 s78, 0
    s_cbranch_scc1 pl_130
    s_mov_b32 s27, 1
pd_132:
    s_cmp_ge_u32 s29, 224
    s_cbranch_scc1 l_tred
    v_mov_b32 v28, s76
    v_mul_f32 v29, s75, v28
    v_lshlrev_b32 v30, 16, v24
    v_and_b32 v31, 0xffff0000, v24
    v_fma_f32 v30, v30, v28, -v29
    v_fma_f32 v31, v31, v28, -v29
    v_cvt_pk_bf16_f32 v24, v30, v31
    v_lshlrev_b32 v30, 16, v25
    v_and_b32 v31, 0xffff0000, v25
    v_fma_f32 v30, v30, v28, -v29
    v_fma_f32 v31, v31, v28, -v29
    v_cvt_pk_bf16_f32 v25, v30, v31
    v_lshlrev_b32 v30, 16, v26
    v_and_b32 v31, 0xffff0000, v26
    v_fma_f32 v30, v30, v28, -v29
    v_fma_f32 v31, v31, v28, -v29
    v_cvt_pk_bf16_f32 v26, v30, v31
    v_lshlrev_b32 v30, 16, v27
    v_and_b32 v31, 0xffff0000, v27
    v_fma_f32 v30, v30, v28, -v29
    v_fma_f32 v31, v31, v28, -v29
    v_cvt_pk_bf16_f32 v27, v30, v31
    s_bitcmp0_b32 s29, 0
    s_cbranch_scc1 sk_133
    v_swap_b32 v24, v25
    v_swap_b32 v26, v27
sk_133:
    s_bitcmp0_b32 s29, 1
    s_cbranch_scc1 sk_134
    v_swap_b32 v24, v26
    v_swap_b32 v25, v27
sk_134:
    v_dot2_f32_bf16 v32, v155, v24, 0
    v_dot2_f32_bf16 v33, v160, v24, 0
    v_dot2_f32_bf16 v34, v156, v24, 0
    v_dot2_f32_bf16 v35, v161, v24, 0
    v_dot2_f32_bf16 v36, v157, v24, 0
    v_dot2_f32_bf16 v37, v162, v24, 0
    v_dot2_f32_bf16 v38, v158, v24, 0
    v_dot2_f32_bf16 v39, v163, v24, 0
    v_dot2_f32_bf16 v40, v183, v24, 0
    v_dot2_f32_bf16 v41, v192, v24, 0
    v_dot2_f32_bf16 v42, v188, v24, 0
    v_dot2_f32_bf16 v43, v193, v24, 0
    v_dot2_f32_bf16 v44, v189, v24, 0
    v_dot2_f32_bf16 v45, v194, v24, 0
    v_dot2_f32_bf16 v46, v190, v24, 0
    v_dot2_f32_bf16 v47, v195, v24, 0
    v_dot2_f32_bf16 v32, v159, v25, v32
    v_dot2_f32_bf16 v33, v168, v25, v33
    v_dot2_f32_bf16 v34, v164, v25, v34
    v_dot2_f32_bf16 v35, v169, v25, v35
    v_dot2_f32_bf16 v36, v165, v25, v36
    v_dot2_f32_bf16 v37, v170, v25, v37
    v_dot2_f32_bf16 v38, v166, v25, v38
    v_dot2_f32_bf16 v39, v171, v25, v39
    v_dot2_f32_bf16 v40, v191, v25, v40
    v_dot2_f32_bf16 v41, v200, v25, v41
    v_dot2_f32_bf16 v42, v196, v25, v42
    v_dot2_f32_bf16 v43, v201, v25, v43
    v_dot2_f32_bf16 v44, v197, v25, v44
    v_dot2_f32_bf16 v45, v202, v25, v45
    v_dot2_f32_bf16 v46, v198, v25, v46
    v_dot2_f32_bf16 v47, v203, v25, v47
    v_dot2_f32_bf16 v32, v167, v26, v32
    v_dot2_f32_bf16 v33, v176, v26, v33
    v_dot2_f32_bf16 v34, v172, v26, v34
    v_dot2_f32_bf16 v35, v177, v26, v35
    v_dot2_f32_bf16 v36, v173, v26, v36
    v_dot2_f32_bf16 v37, v178, v26, v37
    v_dot2_f32_bf16 v38, v174, v26, v38
    v_dot2_f32_bf16 v39, v179, v26, v39
    v_dot2_f32_bf16 v40, v199, v26, v40
    v_dot2_f32_bf16 v41, v208, v26, v41
    v_dot2_f32_bf16 v42, v204, v26, v42
    v_dot2_f32_bf16 v43, v209, v26, v43
    v_dot2_f32_bf16 v44, v205, v26, v44
    v_dot2_f32_bf16 v45, v210, v26, v45
    v_dot2_f32_bf16 v46, v206, v26, v46
    v_dot2_f32_bf16 v47, v211, v26, v47
    v_dot2_f32_bf16 v32, v175, v27, v32
    v_dot2_f32_bf16 v33, v184, v27, v33
    v_dot2_f32_bf16 v34, v180, v27, v34
    v_dot2_f32_bf16 v35, v185, v27, v35
    v_dot2_f32_bf16 v36, v181, v27, v36
    v_dot2_f32_bf16 v37, v186, v27, v37
    v_dot2_f32_bf16 v38, v182, v27, v38
    v_dot2_f32_bf16 v39, v187, v27, v39
    v_dot2_f32_bf16 v40, v207, v27, v40
    v_dot2_f32_bf16 v41, v216, v27, v41
    v_dot2_f32_bf16 v42, v212, v27, v42
    v_dot2_f32_bf16 v43, v217, v27, v43
    v_dot2_f32_bf16 v44, v213, v27, v44
    v_dot2_f32_bf16 v45, v218, v27, v45
    v_dot2_f32_bf16 v46, v214, v27, v46
    v_dot2_f32_bf16 v47, v219, v27, v47
    v_lshrrev_b32 v31, 5, v252
    v_lshlrev_b32 v30, 6, v31
    v_permlane32_swap_b32 v32, v40
    v_permlane32_swap_b32 v33, v41
    v_permlane32_swap_b32 v34, v42
    v_permlane32_swap_b32 v35, v43
    v_permlane32_swap_b32 v36, v44
    v_permlane32_swap_b32 v37, v45
    v_permlane32_swap_b32 v38, v46
    v_permlane32_swap_b32 v39, v47
    v_add_f32 v32, v32, v40
    v_add_f32 v33, v33, v41
    v_add_f32 v34, v34, v42
    v_add_f32 v35, v35, v43
    v_add_f32 v36, v36, v44
    v_add_f32 v37, v37, v45
    v_add_f32 v38, v38, v46
    v_add_f32 v39, v39, v47
    v_and_b32 v31, 1, v252
    v_lshl_add_u32 v30, v31, 5, v30
    v_permlane16_swap_b32 v32, v36
    v_permlane16_swap_b32 v33, v37
    v_permlane16_swap_b32 v34, v38
    v_permlane16_swap_b32 v35, v39
    v_add_f32 v32, v32, v36
    v_add_f32 v33, v33, v37
    v_add_f32 v34, v34, v38
    v_add_f32 v35, v35, v39
    v_and_b32 v31, 16, v252
    s_lshl_b32 s32, s28, 7
    v_add3_u32 v30, v31, v30, s32
    v_add_f32_dpp v32, v32, v32 quad_perm:[2,3,0,1] row_mask:0xf bank_mask:0xf
    v_add_f32_dpp v33, v33, v33 quad_perm:[2,3,0,1] row_mask:0xf bank_mask:0xf
    v_add_f32_dpp v34, v34, v34 quad_perm:[2,3,0,1] row_mask:0xf bank_mask:0xf
    v_add_f32_dpp v35, v35, v35 quad_perm:[2,3,0,1] row_mask:0xf bank_mask:0xf
    v_add_f32_dpp v32, v32, v32 row_ror:4 row_mask:0xf bank_mask:0xf
    v_add_f32_dpp v33, v33, v33 row_ror:4 row_mask:0xf bank_mask:0xf
    v_add_f32_dpp v34, v34, v34 row_ror:4 row_mask:0xf bank_mask:0xf
    v_add_f32_dpp v35, v35, v35 row_ror:4 row_mask:0xf bank_mask:0xf
    v_add_f32_dpp v32, v32, v32 row_ror:8 row_mask:0xf bank_mask:0xf
    v_add_f32_dpp v33, v33, v33 row_ror:8 row_mask:0xf bank_mask:0xf
    v_add_f32_dpp v34, v34, v34 row_ror:8 row_mask:0xf bank_mask:0xf
    v_add_f32_dpp v35, v35, v35 row_ror:8 row_mask:0xf bank_mask:0xf
    s_mov_b32 exec_lo, 0x00030003
    s_mov_b32 exec_hi, 0x00030003
    ds_write_b128 v30, v[32:35] offset:3328
    s_mov_b64 exec, -1
    s_waitcnt lgkmcnt(0)
    s_barrier
    v_and_b32 v30, 1, v252
    v_bfe_u32 v31, v252, 1, 3
    v_lshl_add_u32 v30, v30, 3, v31
    v_lshlrev_b32 v30, 2, v30
    v_add_u32 v30, 3328, v30
    ds_read2_b32 v[32:33], v30 offset0:0 offset1:16
    ds_read2_b32 v[34:35], v30 offset0:32 offset1:48
    ds_read2_b32 v[36:37], v30 offset0:64 offset1:80
    ds_read2_b32 v[38:39], v30 offset0:96 offset1:112
    v_lshrrev_b32 v30, 2, v252
    v_mul_u32_u24 v30, 14336, v30
    v_and_b32 v31, 3, v252
    v_lshl_add_u32 v30, v31, 4, v30
    v_and_b32 v31, 1, v252
    v_cmp_eq_u32 vcc, 1, v31
    s_mul_i32 s32, s28, 229376
    s_lshl_b32 s33, s29, 6
    s_add_u32 s32, s32, s33
    s_add_u32 s32, s32, s79
    s_add_u32 s32, s32, 0xc80000
    s_waitcnt lgkmcnt(0)
    v_pk_add_f32 v[32:33], v[32:33], v[34:35]
    v_pk_add_f32 v[36:37], v[36:37], v[38:39]
    v_pk_add_f32 v[32:33], v[32:33], v[36:37]
    v_mul_f32 v34, 0xbfb8aa3b, v32
    v_exp_f32 v34, v34
    v_mul_f32 v32, v32, v33
    v_add_f32 v34, 1.0, v34
    v_rcp_f32 v34, v34
    s_nop 0
    v_mul_f32 v32, v32, v34
    s_nop 1
    v_mov_b32_dpp v33, v32 quad_perm:[2,3,2,3] row_mask:0xf bank_mask:0xf
    v_cvt_pk_bf16_f32 v32, v32, v33
    ds_swizzle_b32 v36, v32 offset:0x1
    ds_swizzle_b32 v37, v32 offset:0x81
    ds_swizzle_b32 v38, v32 offset:0x101
    ds_swizzle_b32 v39, v32 offset:0x181
    s_waitcnt lgkmcnt(0)
    v_dot2_f32_bf16 v40, v215, v36, 0
    v_dot2_f32_bf16 v41, v224, v36, 0
    v_dot2_f32_bf16 v42, v220, v36, 0
    v_dot2_f32_bf16 v43, v225, v36, 0
    v_dot2_f32_bf16 v44, v221, v36, 0
    v_dot2_f32_bf16 v45, v226, v36, 0
    v_dot2_f32_bf16 v46, v222, v36, 0
    v_dot2_f32_bf16 v47, v227, v36, 0
    v_dot2_f32_bf16 v40, v223, v37, v40
    v_dot2_f32_bf16 v41, v232, v37, v41
    v_dot2_f32_bf16 v42, v228, v37, v42
    v_dot2_f32_bf16 v43, v233, v37, v43
    v_dot2_f32_bf16 v44, v229, v37, v44
    v_dot2_f32_bf16 v45, v234, v37, v45
    v_dot2_f32_bf16 v46, v230, v37, v46
    v_dot2_f32_bf16 v47, v235, v37, v47
    v_dot2_f32_bf16 v40, v231, v38, v40
    v_dot2_f32_bf16 v41, v240, v38, v41
    v_dot2_f32_bf16 v42, v236, v38, v42
    v_dot2_f32_bf16 v43, v241, v38, v43
    v_dot2_f32_bf16 v44, v237, v38, v44
    v_dot2_f32_bf16 v45, v242, v38, v45
    v_dot2_f32_bf16 v46, v238, v38, v46
    v_dot2_f32_bf16 v47, v243, v38, v47
    v_dot2_f32_bf16 v40, v239, v39, v40
    v_dot2_f32_bf16 v41, v248, v39, v41
    v_dot2_f32_bf16 v42, v244, v39, v42
    v_dot2_f32_bf16 v43, v249, v39, v43
    v_dot2_f32_bf16 v44, v245, v39, v44
    v_dot2_f32_bf16 v45, v250, v39, v45
    v_dot2_f32_bf16 v46, v246, v39, v46
    v_dot2_f32_bf16 v47, v251, v39, v47
    v_add_f32_dpp v40, v40, v40 quad_perm:[1,0,3,2] row_mask:0xf bank_mask:0xf
    v_add_f32_dpp v41, v41, v41 quad_perm:[1,0,3,2] row_mask:0xf bank_mask:0xf
    v_add_f32_dpp v42, v42, v42 quad_perm:[1,0,3,2] row_mask:0xf bank_mask:0xf
    v_add_f32_dpp v43, v43, v43 quad_perm:[1,0,3,2] row_mask:0xf bank_mask:0xf
    v_add_f32_dpp v44, v44, v44 quad_perm:[1,0,3,2] row_mask:0xf bank_mask:0xf
    v_add_f32_dpp v45, v45, v45 quad_perm:[1,0,3,2] row_mask:0xf bank_mask:0xf
    v_add_f32_dpp v46, v46, v46 quad_perm:[1,0,3,2] row_mask:0xf bank_mask:0xf
    v_add_f32_dpp v47, v47, v47 quad_perm:[1,0,3,2] row_mask:0xf bank_mask:0xf
    v_cndmask_b32 v40, v40, v44, vcc
    v_cndmask_b32 v41, v41, v45, vcc
    v_cndmask_b32 v42, v42, v46, vcc
    v_cndmask_b32 v43, v43, v47, vcc
    s_cmp_lt_u32 s29, 224
    s_cselect_b64 exec, -1, 0
    buffer_store_dwordx4 v[40:43], v30, s[20:23], s32 offen sc1
    s_mov_b64 exec, -1
    s_branch k_end
l_tred:
    s_cmp_ge_u32 s28, 2
    s_cbranch_scc1 k_end
    v_and_b32 v30, 2, v252
    v_cmp_eq_u32 vcc, 2, v30
    v_mov_b32 v28, s76
    v_mul_f32 v29, s75, v28
    v_add_f32 v28, 1.0, v28
    v_cndmask_b32 v30, v24, v26, vcc
    v_cndmask_b32 v31, v25, v27, vcc
    v_lshlrev_b32 v92, 16, v30
    v_and_b32 v93, 0xffff0000, v30
    v_lshlrev_b32 v94, 16, v31
    v_and_b32 v95, 0xffff0000, v31
    v_fma_f32 v92, v92, v28, -v29
    v_fma_f32 v93, v93, v28, -v29
    v_fma_f32 v94, v94, v28, -v29
    v_fma_f32 v95, v95, v28, -v29
    v_mov_b32 v96, 0xbfb8aa3b
    v_mul_f32 v96, s74, v96
    v_exp_f32 v96, v96
    s_nop 0
    v_add_f32 v96, 1.0, v96
    v_rcp_f32 v96, v96
    s_mov_b32 s78, s27
pl_136:
    s_mul_i32 s32, s89, 14336
    s_add_u32 s32, s32, s79
    s_add_u32 s32, s32, 0xc80000
    buffer_load_dwordx4 v[32:35], v253, s[20:23], s32 offen offset:0 sc1
    buffer_load_dwordx4 v[36:39], v253, s[20:23], s32 offen offset:1024 sc1
    buffer_load_dwordx4 v[40:43], v253, s[20:23], s32 offen offset:2048 sc1
    buffer_load_dwordx4 v[44:47], v253, s[20:23], s32 offen offset:3072 sc1
    s_add_u32 s32, s32, 4096
    buffer_load_dwordx4 v[48:51], v253, s[20:23], s32 offen offset:0 sc1
    buffer_load_dwordx4 v[52:55], v253, s[20:23], s32 offen offset:1024 sc1
    buffer_load_dwordx4 v[56:59], v253, s[20:23], s32 offen offset:2048 sc1
    buffer_load_dwordx4 v[60:63], v253, s[20:23], s32 offen offset:3072 sc1
    s_add_u32 s32, s32, 4096
    buffer_load_dwordx4 v[64:67], v253, s[20:23], s32 offen offset:0 sc1
    buffer_load_dwordx4 v[68:71], v253, s[20:23], s32 offen offset:1024 sc1
    buffer_load_dwordx4 v[72:75], v253, s[20:23], s32 offen offset:2048 sc1
    buffer_load_dwordx4 v[76:79], v253, s[20:23], s32 offen offset:3072 sc1
    s_add_u32 s32, s32, 4096
    buffer_load_dwordx4 v[80:83], v253, s[20:23], s32 offen offset:0 sc1
    buffer_load_dwordx4 v[84:87], v253, s[20:23], s32 offen offset:1024 sc1
    s_waitcnt vmcnt(0)
pc_137:
    v_max3_u32 v30, v32, v36, v40
    v_max3_u32 v30, v30, v44, v48
    v_max3_u32 v30, v30, v52, v56
    v_max3_u32 v30, v30, v60, v64
    v_max3_u32 v30, v30, v68, v72
    v_max3_u32 v30, v30, v76, v80
    v_max_u32 v30, v30, v84
    v_cmp_eq_u32 vcc, -1, v30
    s_cbranch_vccz pd_138
    s_sub_u32 s78, s78, 1
    s_cmp_lg_u32 s78, 0
    s_cbranch_scc1 pl_136
    s_mov_b32 s27, 1
pd_138:
    v_pk_add_f32 v[32:33], v[32:33], v[36:37]
    v_pk_add_f32 v[34:35], v[34:35], v[38:39]
    v_pk_add_f32 v[32:33], v[32:33], v[40:41]
    v_pk_add_f32 v[34:35], v[34:35], v[42:43]
    v_pk_add_f32 v[32:33], v[32:33], v[44:45]
    v_pk_add_f32 v[34:35], v[34:35], v[46:47]
    v_pk_add_f32 v[32:33], v[32:33], v[48:49]
    v_pk_add_f32 v[34:35], v[34:35], v[50:51]
    v_pk_add_f32 v[32:33], v[32:33], v[52:53]
    v_pk_add_f32 v[34:35], v[34:35], v[54:55]
    v_pk_add_f32 v[32:33], v[32:33], v[56:57]
    v_pk_add_f32 v[34:35], v[34:35], v[58:59]
    v_pk_add_f32 v[32:33], v[32:33], v[60:61]
    v_pk_add_f32 v[34:35], v[34:35], v[62:63]
    v_pk_add_f32 v[32:33], v[32:33], v[64:65]
    v_pk_add_f32 v[34:35], v[34:35], v[66:67]
    v_pk_add_f32 v[32:33], v[32:33], v[68:69]
    v_pk_add_f32 v[34:35], v[34:35], v[70:71]
    v_pk_add_f32 v[32:33], v[32:33], v[72:73]
    v_pk_add_f32 v[34:35], v[34:35], v[74:75]
    v_pk_add_f32 v[32:33], v[32:33], v[76:77]
    v_pk_add_f32 v[34:35], v[34:35], v[78:79]
    v_pk_add_f32 v[32:33], v[32:33], v[80:81]
    v_pk_add_f32 v[34:35], v[34:35], v[82:83]
    v_pk_add_f32 v[32:33], v[32:33], v[84:85]
    v_pk_add_f32 v[34:35], v[34:35], v[86:87]
    s_nop 0
    v_add_f32_dpp v32, v32, v32 row_ror:4 row_mask:0xf bank_mask:0xf
    v_add_f32_dpp v33, v33, v33 row_ror:4 row_mask:0xf bank_mask:0xf
    v_add_f32_dpp v34, v34, v34 row_ror:4 row_mask:0xf bank_mask:0xf
    v_add_f32_dpp v35, v35, v35 row_ror:4 row_mask:0xf bank_mask:0xf
    v_add_f32_dpp v32, v32, v32 row_ror:8 row_mask:0xf bank_mask:0xf
    v_add_f32_dpp v33, v33, v33 row_ror:8 row_mask:0xf bank_mask:0xf
    v_add_f32_dpp v34, v34, v34 row_ror:8 row_mask:0xf bank_mask:0xf
    v_add_f32_dpp v35, v35, v35 row_ror:8 row_mask:0xf bank_mask:0xf
    v_mov_b32 v36, v32
    v_mov_b32 v37, v33
    v_mov_b32 v38, v34
    v_mov_b32 v39, v35
    v_permlane16_swap_b32 v32, v36
    v_permlane16_swap_b32 v33, v37
    v_permlane16_swap_b32 v34, v38
    v_permlane16_swap_b32 v35, v39
    v_add_f32 v32, v32, v36
    v_add_f32 v33, v33, v37
    v_add_f32 v34, v34, v38
    v_add_f32 v35, v35, v39
    v_mov_b32 v36, v32
    v_mov_b32 v37, v33
    v_mov_b32 v38, v34
    v_mov_b32 v39, v35
    v_permlane32_swap_b32 v32, v36
    v_permlane32_swap_b32 v33, v37
    v_permlane32_swap_b32 v34, v38
    v_permlane32_swap_b32 v35, v39
    v_add_f32 v32, v32, v36
    v_add_f32 v33, v33, v37
    v_add_f32 v34, v34, v38
    v_add_f32 v35, v35, v39
    v_fma_f32 v32, v32, v96, v92
    v_fma_f32 v33, v33, v96, v93
    v_fma_f32 v34, v34, v96, v94
    v_fma_f32 v35, v35, v96, v95
    v_cvt_pk_bf16_f32 v32, v32, v33
    v_cvt_pk_bf16_f32 v33, v34, v35
    s_lshl_b32 s32, s73, 11
    s_lshl_b32 s33, s89, 5
    s_add_u32 s32, s32, s33
    v_lshlrev_b32 v30, 3, v252
    s_mov_b64 exec, 15
    buffer_store_dwordx2 v[32:33], v30, s[12:15], s32 offen sc1
    s_mov_b64 exec, -1
k_end:
k_exit:
    s_endpgm
att_exact0:
    s_waitcnt lgkmcnt(0)
    v_mov_b32 v20, 0xffff
    v_mov_b32 v21, 0xffff0000
    v_cndmask_b32 v22, 0, v20, s[40:41]
    v_cndmask_b32 v23, 0, v21, s[42:43]
    v_or_b32 v12, v22, v23
    v_cndmask_b32 v22, 0, v20, s[44:45]
    v_cndmask_b32 v23, 0, v21, s[46:47]
    v_or_b32 v13, v22, v23
    v_cndmask_b32 v22, 0, v20, s[48:49]
    v_cndmask_b32 v23, 0, v21, s[50:51]
    v_or_b32 v14, v22, v23
    v_cndmask_b32 v22, 0, v20, s[52:53]
    v_cndmask_b32 v23, 0, v21, s[54:55]
    v_or_b32 v15, v22, v23
    v_cndmask_b32 v22, 0, v20, s[56:57]
    v_cndmask_b32 v23, 0, v21, s[58:59]
    v_or_b32 v16, v22, v23
    v_cndmask_b32 v22, 0, v20, s[60:61]
    v_cndmask_b32 v23, 0, v21, s[62:63]
    v_or_b32 v17, v22, v23
    v_cndmask_b32 v22, 0, v20, s[64:65]
    v_cndmask_b32 v23, 0, v21, s[66:67]
    v_or_b32 v18, v22, v23
    v_cndmask_b32 v22, 0, v20, s[68:69]
    v_cndmask_b32 v23, 0, v21, s[70:71]
    v_or_b32 v19, v22, v23
    s_and_b32 s34, s76, 3
    s_lshl_b32 s33, s34, 12
    s_add_u32 s33, s33, 65536
    v_add_u32 v20, s33, v253
    v_mov_b32 v24, 0
    v_mov_b32 v25, 0
    v_mov_b32 v26, 0
    v_mov_b32 v27, 0
    v_mov_b32 v28, 0
    v_mov_b32 v29, 0
    v_mov_b32 v30, 0
    v_mov_b32 v31, 0
    v_mov_b32 v32, 0
    v_mov_b32 v33, 0
    v_mov_b32 v34, 0
    v_mov_b32 v35, 0
    v_mov_b32 v36, 0
    v_mov_b32 v37, 0
    v_mov_b32 v38, 0
    v_mov_b32 v39, 0
    ds_read_b128 v[104:107], v20 offset:32768
    ds_read_b128 v[108:111], v20 offset:33792
    ds_read_b128 v[112:115], v20 offset:28672
    ds_read_b128 v[116:119], v20 offset:29696
    s_waitcnt lgkmcnt(2)
    v_mfma_f32_32x32x16_bf16 v[40:55], v[104:107], v[4:7], 0
    v_mfma_f32_32x32x16_bf16 v[40:55], v[108:111], v[8:11], v[40:55]
    ds_read_b128 v[104:107], v20 offset:24576
    ds_read_b128 v[108:111], v20 offset:25600
    s_cmp_eq_u32 s76, 0
    s_cbranch_scc0 ng_139
    v_mov_b32 v24, 0xf149f2ca
    v_mov_b32 v25, 0xf149f2ca
    v_mov_b32 v26, 0xf149f2ca
    v_mov_b32 v27, 0xf149f2ca
    v_mov_b32 v28, 0xf149f2ca
    v_mov_b32 v29, 0xf149f2ca
    v_mov_b32 v30, 0xf149f2ca
    v_mov_b32 v31, 0xf149f2ca
    v_mov_b32 v32, 0xf149f2ca
    v_mov_b32 v33, 0xf149f2ca
    v_mov_b32 v34, 0xf149f2ca
    v_mov_b32 v35, 0xf149f2ca
    v_mov_b32 v36, 0xf149f2ca
    v_mov_b32 v37, 0xf149f2ca
    v_mov_b32 v38, 0xf149f2ca
    v_mov_b32 v39, 0xf149f2ca
ng_139:
    s_waitcnt lgkmcnt(2)
    s_nop 0
    v_mfma_f32_32x32x16_bf16 v[72:87], v[112:115], v[4:7], v[24:39]
    v_mfma_f32_32x32x16_bf16 v[72:87], v[116:119], v[8:11], v[72:87]
    ds_read_b128 v[112:115], v20 offset:20480
    ds_read_b128 v[116:119], v20 offset:21504
    s_cmp_eq_u32 s76, 1
    s_cbranch_scc0 ng_140
    s_nop 1
    v_mov_b32 v24, 0xf149f2ca
    v_mov_b32 v25, 0xf149f2ca
    v_mov_b32 v26, 0xf149f2ca
    v_mov_b32 v27, 0xf149f2ca
    v_mov_b32 v28, 0xf149f2ca
    v_mov_b32 v29, 0xf149f2ca
    v_mov_b32 v30, 0xf149f2ca
    v_mov_b32 v31, 0xf149f2ca
    v_mov_b32 v32, 0xf149f2ca
    v_mov_b32 v33, 0xf149f2ca
    v_mov_b32 v34, 0xf149f2ca
    v_mov_b32 v35, 0xf149f2ca
    v_mov_b32 v36, 0xf149f2ca
    v_mov_b32 v37, 0xf149f2ca
    v_mov_b32 v38, 0xf149f2ca
    v_mov_b32 v39, 0xf149f2ca
ng_140:
    s_waitcnt lgkmcnt(2)
    s_nop 0
    v_mfma_f32_32x32x16_bf16 v[56:71], v[104:107], v[4:7], v[24:39]
    v_mfma_f32_32x32x16_bf16 v[56:71], v[108:111], v[8:11], v[56:71]
    s_nop 3
    v_max_f32 v21, v72, v73
    v_max3_f32 v21, v21, v74, v75
    v_max3_f32 v21, v21, v76, v77
    v_max3_f32 v21, v21, v78, v79
    v_max3_f32 v21, v21, v80, v81
    v_max3_f32 v21, v21, v82, v83
    v_max3_f32 v21, v21, v84, v85
    v_max3_f32 v21, v21, v86, v87
    ds_read_b128 v[104:107], v20 offset:16384
    ds_read_b128 v[108:111], v20 offset:17408
    s_cmp_eq_u32 s76, 2
    s_cbranch_scc0 ng_141
    v_mov_b32 v24, 0xf149f2ca
    v_mov_b32 v25, 0xf149f2ca
    v_mov_b32 v26, 0xf149f2ca
    v_mov_b32 v27, 0xf149f2ca
    v_mov_b32 v28, 0xf149f2ca
    v_mov_b32 v29, 0xf149f2ca
    v_mov_b32 v30, 0xf149f2ca
    v_mov_b32 v31, 0xf149f2ca
    v_mov_b32 v32, 0xf149f2ca
    v_mov_b32 v33, 0xf149f2ca
    v_mov_b32 v34, 0xf149f2ca
    v_mov_b32 v35, 0xf149f2ca
    v_mov_b32 v36, 0xf149f2ca
    v_mov_b32 v37, 0xf149f2ca
    v_mov_b32 v38, 0xf149f2ca
    v_mov_b32 v39, 0xf149f2ca
ng_141:
    s_waitcnt lgkmcnt(2)
    s_nop 0
    v_mfma_f32_32x32x16_bf16 v[72:87], v[112:115], v[4:7], v[24:39]
    v_mfma_f32_32x32x16_bf16 v[72:87], v[116:119], v[8:11], v[72:87]
    v_max3_f32 v21, v21, v56, v57
    v_max3_f32 v21, v21, v58, v59
    v_max3_f32 v21, v21, v60, v61
    v_max3_f32 v21, v21, v62, v63
    v_max3_f32 v21, v21, v64, v65
    v_max3_f32 v21, v21, v66, v67
    v_max3_f32 v21, v21, v68, v69
    v_max3_f32 v21, v21, v70, v71
    ds_read_b128 v[112:115], v20 offset:12288
    ds_read_b128 v[116:119], v20 offset:13312
    s_cmp_eq_u32 s76, 3
    s_cbranch_scc0 ng_142
    v_mov_b32 v24, 0xf149f2ca
    v_mov_b32 v25, 0xf149f2ca
    v_mov_b32 v26, 0xf149f2ca
    v_mov_b32 v27, 0xf149f2ca
    v_mov_b32 v28, 0xf149f2ca
    v_mov_b32 v29, 0xf149f2ca
    v_mov_b32 v30, 0xf149f2ca
    v_mov_b32 v31, 0xf149f2ca
    v_mov_b32 v32, 0xf149f2ca
    v_mov_b32 v33, 0xf149f2ca
    v_mov_b32 v34, 0xf149f2ca
    v_mov_b32 v35, 0xf149f2ca
    v_mov_b32 v36, 0xf149f2ca
    v_mov_b32 v37, 0xf149f2ca
    v_mov_b32 v38, 0xf149f2ca
    v_mov_b32 v39, 0xf149f2ca
ng_142:
    s_waitcnt lgkmcnt(2)
    s_nop 0
    v_mfma_f32_32x32x16_bf16 v[56:71], v[104:107], v[4:7], v[24:39]
    v_mfma_f32_32x32x16_bf16 v[56:71], v[108:111], v[8:11], v[56:71]
    v_max3_f32 v21, v21, v72, v73
    v_max3_f32 v21, v21, v74, v75
    v_max3_f32 v21, v21, v76, v77
    v_max3_f32 v21, v21, v78, v79
    v_max3_f32 v21, v21, v80, v81
    v_max3_f32 v21, v21, v82, v83
    v_max3_f32 v21, v21, v84, v85
    v_max3_f32 v21, v21, v86, v87
    ds_read_b128 v[104:107], v20 offset:8192
    ds_read_b128 v[108:111], v20 offset:9216
    s_cmp_eq_u32 s76, 4
    s_cbranch_scc0 ng_143
    v_mov_b32 v24, 0xf149f2ca
    v_mov_b32 v25, 0xf149f2ca
    v_mov_b32 v26, 0xf149f2ca
    v_mov_b32 v27, 0xf149f2ca
    v_mov_b32 v28, 0xf149f2ca
    v_mov_b32 v29, 0xf149f2ca
    v_mov_b32 v30, 0xf149f2ca
    v_mov_b32 v31, 0xf149f2ca
    v_mov_b32 v32, 0xf149f2ca
    v_mov_b32 v33, 0xf149f2ca
    v_mov_b32 v34, 0xf149f2ca
    v_mov_b32 v35, 0xf149f2ca
    v_mov_b32 v36, 0xf149f2ca
    v_mov_b32 v37, 0xf149f2ca
    v_mov_b32 v38, 0xf149f2ca
    v_mov_b32 v39, 0xf149f2ca
ng_143:
    s_waitcnt lgkmcnt(2)
    s_nop 0
    v_mfma_f32_32x32x16_bf16 v[72:87], v[112:115], v[4:7], v[24:39]
    v_mfma_f32_32x32x16_bf16 v[72:87], v[116:119], v[8:11], v[72:87]
    v_max3_f32 v21, v21, v56, v57
    v_max3_f32 v21, v21, v58, v59
    v_max3_f32 v21, v21, v60, v61
    v_max3_f32 v21, v21, v62, v63
    v_max3_f32 v21, v21, v64, v65
    v_max3_f32 v21, v21, v66, v67
    v_max3_f32 v21, v21, v68, v69
    v_max3_f32 v21, v21, v70, v71
    ds_read_b128 v[112:115], v20 offset:4096
    ds_read_b128 v[116:119], v20 offset:5120
    s_cmp_eq_u32 s76, 5
    s_cbranch_scc0 ng_144
    v_mov_b32 v24, 0xf149f2ca
    v_mov_b32 v25, 0xf149f2ca
    v_mov_b32 v26, 0xf149f2ca
    v_mov_b32 v27, 0xf149f2ca
    v_mov_b32 v28, 0xf149f2ca
    v_mov_b32 v29, 0xf149f2ca
    v_mov_b32 v30, 0xf149f2ca
    v_mov_b32 v31, 0xf149f2ca
    v_mov_b32 v32, 0xf149f2ca
    v_mov_b32 v33, 0xf149f2ca
    v_mov_b32 v34, 0xf149f2ca
    v_mov_b32 v35, 0xf149f2ca
    v_mov_b32 v36, 0xf149f2ca
    v_mov_b32 v37, 0xf149f2ca
    v_mov_b32 v38, 0xf149f2ca
    v_mov_b32 v39, 0xf149f2ca
ng_144:
    s_waitcnt lgkmcnt(2)
    s_nop 0
    v_mfma_f32_32x32x16_bf16 v[56:71], v[104:107], v[4:7], v[24:39]
    v_mfma_f32_32x32x16_bf16 v[56:71], v[108:111], v[8:11], v[56:71]
    v_max3_f32 v21, v21, v72, v73
    v_max3_f32 v21, v21, v74, v75
    v_max3_f32 v21, v21, v76, v77
    v_max3_f32 v21, v21, v78, v79
    v_max3_f32 v21, v21, v80, v81
    v_max3_f32 v21, v21, v82, v83
    v_max3_f32 v21, v21, v84, v85
    v_max3_f32 v21, v21, v86, v87
    ds_read_b128 v[104:107], v20 offset:0
    ds_read_b128 v[108:111], v20 offset:1024
    s_cmp_eq_u32 s76, 6
    s_cbranch_scc0 ng_145
    v_mov_b32 v24, 0xf149f2ca
    v_mov_b32 v25, 0xf149f2ca
    v_mov_b32 v26, 0xf149f2ca
    v_mov_b32 v27, 0xf149f2ca
    v_mov_b32 v28, 0xf149f2ca
    v_mov_b32 v29, 0xf149f2ca
    v_mov_b32 v30, 0xf149f2ca
    v_mov_b32 v31, 0xf149f2ca
    v_mov_b32 v32, 0xf149f2ca
    v_mov_b32 v33, 0xf149f2ca
    v_mov_b32 v34, 0xf149f2ca
    v_mov_b32 v35, 0xf149f2ca
    v_mov_b32 v36, 0xf149f2ca
    v_mov_b32 v37, 0xf149f2ca
    v_mov_b32 v38, 0xf149f2ca
    v_mov_b32 v39, 0xf149f2ca
ng_145:
    s_waitcnt lgkmcnt(2)
    s_nop 0
    v_mfma_f32_32x32x16_bf16 v[72:87], v[112:115], v[4:7], v[24:39]
    v_mfma_f32_32x32x16_bf16 v[72:87], v[116:119], v[8:11], v[72:87]
    v_max3_f32 v21, v21, v56, v57
    v_max3_f32 v21, v21, v58, v59
    v_max3_f32 v21, v21, v60, v61
    v_max3_f32 v21, v21, v62, v63
    v_max3_f32 v21, v21, v64, v65
    v_max3_f32 v21, v21, v66, v67
    v_max3_f32 v21, v21, v68, v69
    v_max3_f32 v21, v21, v70, v71
    s_cmp_eq_u32 s76, 7
    s_cbranch_scc0 ng_146
    v_mov_b32 v24, 0xf149f2ca
    v_mov_b32 v25, 0xf149f2ca
    v_mov_b32 v26, 0xf149f2ca
    v_mov_b32 v27, 0xf149f2ca
    v_mov_b32 v28, 0xf149f2ca
    v_mov_b32 v29, 0xf149f2ca
    v_mov_b32 v30, 0xf149f2ca
    v_mov_b32 v31, 0xf149f2ca
    v_mov_b32 v32, 0xf149f2ca
    v_mov_b32 v33, 0xf149f2ca
    v_mov_b32 v34, 0xf149f2ca
    v_mov_b32 v35, 0xf149f2ca
    v_mov_b32 v36, 0xf149f2ca
    v_mov_b32 v37, 0xf149f2ca
    v_mov_b32 v38, 0xf149f2ca
    v_mov_b32 v39, 0xf149f2ca
ng_146:
    s_waitcnt lgkmcnt(0)
    s_nop 0
    v_mfma_f32_32x32x16_bf16 v[56:71], v[104:107], v[4:7], v[24:39]
    v_mfma_f32_32x32x16_bf16 v[56:71], v[108:111], v[8:11], v[56:71]
    v_max3_f32 v21, v21, v72, v73
    v_max3_f32 v21, v21, v74, v75
    v_max3_f32 v21, v21, v76, v77
    v_max3_f32 v21, v21, v78, v79
    v_max3_f32 v21, v21, v80, v81
    v_max3_f32 v21, v21, v82, v83
    v_max3_f32 v21, v21, v84, v85
    v_max3_f32 v21, v21, v86, v87
    ds_read_b128 v[112:115], v20 offset:28672
    ds_read_b128 v[116:119], v20 offset:29696
    ds_read_b128 v[120:123], v20 offset:34816
    ds_read_b128 v[124:127], v20 offset:35840
    ds_read_b128 v[128:131], v20 offset:2048
    ds_read_b128 v[132:135], v20 offset:3072
    v_cndmask_b32 v40, v56, v40, s[40:41]
    v_cndmask_b32 v41, v57, v41, s[42:43]
    v_cndmask_b32 v42, v58, v42, s[44:45]
    v_cndmask_b32 v43, v59, v43, s[46:47]
    v_cndmask_b32 v44, v60, v44, s[48:49]
    v_cndmask_b32 v45, v61, v45, s[50:51]
    v_cndmask_b32 v46, v62, v46, s[52:53]
    v_cndmask_b32 v47, v63, v47, s[54:55]
    v_cndmask_b32 v48, v64, v48, s[56:57]
    v_cndmask_b32 v49, v65, v49, s[58:59]
    v_cndmask_b32 v50, v66, v50, s[60:61]
    v_cndmask_b32 v51, v67, v51, s[62:63]
    v_cndmask_b32 v52, v68, v52, s[64:65]
    v_cndmask_b32 v53, v69, v53, s[66:67]
    v_cndmask_b32 v54, v70, v54, s[68:69]
    v_cndmask_b32 v55, v71, v55, s[70:71]
    v_max3_f32 v21, v21, v40, v41
    v_max3_f32 v21, v21, v42, v43
    v_max3_f32 v21, v21, v44, v45
    v_max3_f32 v21, v21, v46, v47
    v_max3_f32 v21, v21, v48, v49
    v_max3_f32 v21, v21, v50, v51
    v_max3_f32 v21, v21, v52, v53
    v_max3_f32 v21, v21, v54, v55
    v_mov_b32 v152, v21
    s_nop 1
    v_permlane32_swap_b32 v21, v152
    v_max_f32 v21, v21, v152
    v_sub_f32 v24, 0, v21
    v_sub_f32 v25, 0, v21
    v_sub_f32 v26, 0, v21
    v_sub_f32 v27, 0, v21
    v_sub_f32 v28, 0, v21
    v_sub_f32 v29, 0, v21
    v_sub_f32 v30, 0, v21
    v_sub_f32 v31, 0, v21
    v_sub_f32 v32, 0, v21
    v_sub_f32 v33, 0, v21
    v_sub_f32 v34, 0, v21
    v_sub_f32 v35, 0, v21
    v_sub_f32 v36, 0, v21
    v_sub_f32 v37, 0, v21
    v_sub_f32 v38, 0, v21
    v_sub_f32 v39, 0, v21
    s_cmp_eq_u32 s76, 0
    s_cbranch_scc0 ng_147
    v_mov_b32 v24, 0xf149f2ca
    v_mov_b32 v25, 0xf149f2ca
    v_mov_b32 v26, 0xf149f2ca
    v_mov_b32 v27, 0xf149f2ca
    v_mov_b32 v28, 0xf149f2ca
    v_mov_b32 v29, 0xf149f2ca
    v_mov_b32 v30, 0xf149f2ca
    v_mov_b32 v31, 0xf149f2ca
    v_mov_b32 v32, 0xf149f2ca
    v_mov_b32 v33, 0xf149f2ca
    v_mov_b32 v34, 0xf149f2ca
    v_mov_b32 v35, 0xf149f2ca
    v_mov_b32 v36, 0xf149f2ca
    v_mov_b32 v37, 0xf149f2ca
    v_mov_b32 v38, 0xf149f2ca
    v_mov_b32 v39, 0xf149f2ca
ng_147:
    s_waitcnt lgkmcnt(4)
    s_nop 0
    v_mfma_f32_32x32x16_bf16 v[72:87], v[112:115], v[4:7], v[24:39]
    v_mfma_f32_32x32x16_bf16 v[72:87], v[116:119], v[8:11], v[72:87]
    ds_read_b128 v[104:107], v20 offset:24576
    ds_read_b128 v[108:111], v20 offset:25600
    v_sub_f32 v40, v40, v21
    v_sub_f32 v41, v41, v21
    v_sub_f32 v42, v42, v21
    v_sub_f32 v43, v43, v21
    v_sub_f32 v44, v44, v21
    v_sub_f32 v45, v45, v21
    v_sub_f32 v46, v46, v21
    v_sub_f32 v47, v47, v21
    v_sub_f32 v48, v48, v21
    v_sub_f32 v49, v49, v21
    v_sub_f32 v50, v50, v21
    v_sub_f32 v51, v51, v21
    v_sub_f32 v52, v52, v21
    v_sub_f32 v53, v53, v21
    v_sub_f32 v54, v54, v21
    v_sub_f32 v55, v55, v21
    v_exp_f32 v40, v40
    v_exp_f32 v41, v41
    v_exp_f32 v42, v42
    v_exp_f32 v43, v43
    v_exp_f32 v44, v44
    v_exp_f32 v45, v45
    v_exp_f32 v46, v46
    v_exp_f32 v47, v47
    v_exp_f32 v48, v48
    v_exp_f32 v49, v49
    v_exp_f32 v50, v50
    v_exp_f32 v51, v51
    v_exp_f32 v52, v52
    v_exp_f32 v53, v53
    v_exp_f32 v54, v54
    v_exp_f32 v55, v55
    v_add_f32 v22, v40, v41
    v_add_f32 v23, v42, v43
    v_add_f32 v22, v22, v44
    v_add_f32 v23, v23, v45
    v_add_f32 v22, v22, v46
    v_add_f32 v23, v23, v47
    v_add_f32 v22, v22, v48
    v_add_f32 v23, v23, v49
    v_add_f32 v22, v22, v50
    v_add_f32 v23, v23, v51
    v_add_f32 v22, v22, v52
    v_add_f32 v23, v23, v53
    v_add_f32 v22, v22, v54
    v_add_f32 v23, v23, v55
    v_cvt_pk_bf16_f32 v144, v40, v41
    v_cvt_pk_bf16_f32 v145, v42, v43
    v_cvt_pk_bf16_f32 v146, v44, v45
    v_cvt_pk_bf16_f32 v147, v46, v47
    v_cvt_pk_bf16_f32 v148, v48, v49
    v_cvt_pk_bf16_f32 v149, v50, v51
    v_cvt_pk_bf16_f32 v150, v52, v53
    v_cvt_pk_bf16_f32 v151, v54, v55
    v_and_b32 v136, v144, v12
    v_and_b32 v137, v145, v13
    v_and_b32 v138, v146, v14
    v_and_b32 v139, v147, v15
    v_and_b32 v140, v148, v16
    v_and_b32 v141, v149, v17
    v_and_b32 v142, v150, v18
    v_and_b32 v143, v151, v19
    v_xor_b32 v144, v144, v136
    v_xor_b32 v145, v145, v137
    v_xor_b32 v146, v146, v138
    v_xor_b32 v147, v147, v139
    v_xor_b32 v148, v148, v140
    v_xor_b32 v149, v149, v141
    v_xor_b32 v150, v150, v142
    v_xor_b32 v151, v151, v143
    s_waitcnt lgkmcnt(2)
    v_mfma_f32_32x32x16_bf16 v[88:103], v[120:123], v[136:139], 0
    v_mfma_f32_32x32x16_bf16 v[88:103], v[124:127], v[140:143], v[88:103]
    v_mfma_f32_32x32x16_bf16 v[88:103], v[128:131], v[144:147], v[88:103]
    v_mfma_f32_32x32x16_bf16 v[88:103], v[132:135], v[148:151], v[88:103]
    ds_read_b128 v[128:131], v20 offset:30720
    ds_read_b128 v[132:135], v20 offset:31744
    s_cmp_eq_u32 s76, 1
    s_cbranch_scc0 ng_148
    v_mov_b32 v24, 0xf149f2ca
    v_mov_b32 v25, 0xf149f2ca
    v_mov_b32 v26, 0xf149f2ca
    v_mov_b32 v27, 0xf149f2ca
    v_mov_b32 v28, 0xf149f2ca
    v_mov_b32 v29, 0xf149f2ca
    v_mov_b32 v30, 0xf149f2ca
    v_mov_b32 v31, 0xf149f2ca
    v_mov_b32 v32, 0xf149f2ca
    v_mov_b32 v33, 0xf149f2ca
    v_mov_b32 v34, 0xf149f2ca
    v_mov_b32 v35, 0xf149f2ca
    v_mov_b32 v36, 0xf149f2ca
    v_mov_b32 v37, 0xf149f2ca
    v_mov_b32 v38, 0xf149f2ca
    v_mov_b32 v39, 0xf149f2ca
ng_148:
    s_waitcnt lgkmcnt(2)
    s_nop 0
    v_mfma_f32_32x32x16_bf16 v[56:71], v[104:107], v[4:7], v[24:39]
    v_mfma_f32_32x32x16_bf16 v[56:71], v[108:111], v[8:11], v[56:71]
    ds_read_b128 v[112:115], v20 offset:20480
    ds_read_b128 v[116:119], v20 offset:21504
    v_exp_f32 v72, v72
    v_exp_f32 v73, v73
    v_exp_f32 v74, v74
    v_exp_f32 v75, v75
    v_exp_f32 v76, v76
    v_exp_f32 v77, v77
    v_exp_f32 v78, v78
    v_exp_f32 v79, v79
    v_exp_f32 v80, v80
    v_exp_f32 v81, v81
    v_exp_f32 v82, v82
    v_exp_f32 v83, v83
    v_exp_f32 v84, v84
    v_exp_f32 v85, v85
    v_exp_f32 v86, v86
    v_exp_f32 v87, v87
    v_add_f32 v22, v22, v72
    v_add_f32 v23, v23, v73
    v_add_f32 v22, v22, v74
    v_add_f32 v23, v23, v75
    v_add_f32 v22, v22, v76
    v_add_f32 v23, v23, v77
    v_add_f32 v22, v22, v78
    v_add_f32 v23, v23, v79
    v_add_f32 v22, v22, v80
    v_add_f32 v23, v23, v81
    v_add_f32 v22, v22, v82
    v_add_f32 v23, v23, v83
    v_add_f32 v22, v22, v84
    v_add_f32 v23, v23, v85
    v_add_f32 v22, v22, v86
    v_add_f32 v23, v23, v87
    v_cvt_pk_bf16_f32 v144, v72, v73
    v_cvt_pk_bf16_f32 v145, v74, v75
    v_cvt_pk_bf16_f32 v146, v76, v77
    v_cvt_pk_bf16_f32 v147, v78, v79
    v_cvt_pk_bf16_f32 v148, v80, v81
    v_cvt_pk_bf16_f32 v149, v82, v83
    v_cvt_pk_bf16_f32 v150, v84, v85
    v_cvt_pk_bf16_f32 v151, v86, v87
    s_waitcnt lgkmcnt(2)
    v_mfma_f32_32x32x16_bf16 v[88:103], v[128:131], v[144:147], v[88:103]
    v_mfma_f32_32x32x16_bf16 v[88:103], v[132:135], v[148:151], v[88:103]
    ds_read_b128 v[120:123], v20 offset:26624
    ds_read_b128 v[124:127], v20 offset:27648
    s_cmp_eq_u32 s76, 2
    s_cbranch_scc0 ng_149
    v_mov_b32 v24, 0xf149f2ca
    v_mov_b32 v25, 0xf149f2ca
    v_mov_b32 v26, 0xf149f2ca
    v_mov_b32 v27, 0xf149f2ca
    v_mov_b32 v28, 0xf149f2ca
    v_mov_b32 v29, 0xf149f2ca
    v_mov_b32 v30, 0xf149f2ca
    v_mov_b32 v31, 0xf149f2ca
    v_mov_b32 v32, 0xf149f2ca
    v_mov_b32 v33, 0xf149f2ca
    v_mov_b32 v34, 0xf149f2ca
    v_mov_b32 v35, 0xf149f2ca
    v_mov_b32 v36, 0xf149f2ca
    v_mov_b32 v37, 0xf149f2ca
    v_mov_b32 v38, 0xf149f2ca
    v_mov_b32 v39, 0xf149f2ca
ng_149:
    s_waitcnt lgkmcnt(2)
    s_nop 0
    v_mfma_f32_32x32x16_bf16 v[72:87], v[112:115], v[4:7], v[24:39]
    v_mfma_f32_32x32x16_bf16 v[72:87], v[116:119], v[8:11], v[72:87]
    ds_read_b128 v[104:107], v20 offset:16384
    ds_read_b128 v[108:111], v20 offset:17408
    v_exp_f32 v56, v56
    v_exp_f32 v57, v57
    v_exp_f32 v58, v58
    v_exp_f32 v59, v59
    v_exp_f32 v60, v60
    v_exp_f32 v61, v61
    v_exp_f32 v62, v62
    v_exp_f32 v63, v63
    v_exp_f32 v64, v64
    v_exp_f32 v65, v65
    v_exp_f32 v66, v66
    v_exp_f32 v67, v67
    v_exp_f32 v68, v68
    v_exp_f32 v69, v69
    v_exp_f32 v70, v70
    v_exp_f32 v71, v71
    v_add_f32 v22, v22, v56
    v_add_f32 v23, v23, v57
    v_add_f32 v22, v22, v58
    v_add_f32 v23, v23, v59
    v_add_f32 v22, v22, v60
    v_add_f32 v23, v23, v61
    v_add_f32 v22, v22, v62
    v_add_f32 v23, v23, v63
    v_add_f32 v22, v22, v64
    v_add_f32 v23, v23, v65
    v_add_f32 v22, v22, v66
    v_add_f32 v23, v23, v67
    v_add_f32 v22, v22, v68
    v_add_f32 v23, v23, v69
    v_add_f32 v22, v22, v70
    v_add_f32 v23, v23, v71
    v_cvt_pk_bf16_f32 v136, v56, v57
    v_cvt_pk_bf16_f32 v137, v58, v59
    v_cvt_pk_bf16_f32 v138, v60, v61
    v_cvt_pk_bf16_f32 v139, v62, v63
    v_cvt_pk_bf16_f32 v140, v64, v65
    v_cvt_pk_bf16_f32 v141, v66, v67
    v_cvt_pk_bf16_f32 v142, v68, v69
    v_cvt_pk_bf16_f32 v143, v70, v71
    s_waitcnt lgkmcnt(2)
    v_mfma_f32_32x32x16_bf16 v[88:103], v[120:123], v[136:139], v[88:103]
    v_mfma_f32_32x32x16_bf16 v[88:103], v[124:127], v[140:143], v[88:103]
    ds_read_b128 v[128:131], v20 offset:22528
    ds_read_b128 v[132:135], v20 offset:23552
    s_cmp_eq_u32 s76, 3
    s_cbranch_scc0 ng_150
    v_mov_b32 v24, 0xf149f2ca
    v_mov_b32 v25, 0xf149f2ca
    v_mov_b32 v26, 0xf149f2ca
    v_mov_b32 v27, 0xf149f2ca
    v_mov_b32 v28, 0xf149f2ca
    v_mov_b32 v29, 0xf149f2ca
    v_mov_b32 v30, 0xf149f2ca
    v_mov_b32 v31, 0xf149f2ca
    v_mov_b32 v32, 0xf149f2ca
    v_mov_b32 v33, 0xf149f2ca
    v_mov_b32 v34, 0xf149f2ca
    v_mov_b32 v35, 0xf149f2ca
    v_mov_b32 v36, 0xf149f2ca
    v_mov_b32 v37, 0xf149f2ca
    v_mov_b32 v38, 0xf149f2ca
    v_mov_b32 v39, 0xf149f2ca
ng_150:
    s_waitcnt lgkmcnt(2)
    s_nop 0
    v_mfma_f32_32x32x16_bf16 v[56:71], v[104:107], v[4:7], v[24:39]
    v_mfma_f32_32x32x16_bf16 v[56:71], v[108:111], v[8:11], v[56:71]
    ds_read_b128 v[112:115], v20 offset:12288
    ds_read_b128 v[116:119], v20 offset:13312
    v_exp_f32 v72, v72
    v_exp_f32 v73, v73
    v_exp_f32 v74, v74
    v_exp_f32 v75, v75
    v_exp_f32 v76, v76
    v_exp_f32 v77, v77
    v_exp_f32 v78, v78
    v_exp_f32 v79, v79
    v_exp_f32 v80, v80
    v_exp_f32 v81, v81
    v_exp_f32 v82, v82
    v_exp_f32 v83, v83
    v_exp_f32 v84, v84
    v_exp_f32 v85, v85
    v_exp_f32 v86, v86
    v_exp_f32 v87, v87
    v_add_f32 v22, v22, v72
    v_add_f32 v23, v23, v73
    v_add_f32 v22, v22, v74
    v_add_f32 v23, v23, v75
    v_add_f32 v22, v22, v76
    v_add_f32 v23, v23, v77
    v_add_f32 v22, v22, v78
    v_add_f32 v23, v23, v79
    v_add_f32 v22, v22, v80
    v_add_f32 v23, v23, v81
    v_add_f32 v22, v22, v82
    v_add_f32 v23, v23, v83
    v_add_f32 v22, v22, v84
    v_add_f32 v23, v23, v85
    v_add_f32 v22, v22, v86
    v_add_f32 v23, v23, v87
    v_cvt_pk_bf16_f32 v144, v72, v73
    v_cvt_pk_bf16_f32 v145, v74, v75
    v_cvt_pk_bf16_f32 v146, v76, v77
    v_cvt_pk_bf16_f32 v147, v78, v79
    v_cvt_pk_bf16_f32 v148, v80, v81
    v_cvt_pk_bf16_f32 v149, v82, v83
    v_cvt_pk_bf16_f32 v150, v84, v85
    v_cvt_pk_bf16_f32 v151, v86, v87
    s_waitcnt lgkmcnt(2)
    v_mfma_f32_32x32x16_bf16 v[88:103], v[128:131], v[144:147], v[88:103]
    v_mfma_f32_32x32x16_bf16 v[88:103], v[132:135], v[148:151], v[88:103]
    ds_read_b128 v[120:123], v20 offset:18432
    ds_read_b128 v[124:127], v20 offset:19456
    s_cmp_eq_u32 s76, 4
    s_cbranch_scc0 ng_151
    v_mov_b32 v24, 0xf149f2ca
    v_mov_b32 v25, 0xf149f2ca
    v_mov_b32 v26, 0xf149f2ca
    v_mov_b32 v27, 0xf149f2ca
    v_mov_b32 v28, 0xf149f2ca
    v_mov_b32 v29, 0xf149f2ca
    v_mov_b32 v30, 0xf149f2ca
    v_mov_b32 v31, 0xf149f2ca
    v_mov_b32 v32, 0xf149f2ca
    v_mov_b32 v33, 0xf149f2ca
    v_mov_b32 v34, 0xf149f2ca
    v_mov_b32 v35, 0xf149f2ca
    v_mov_b32 v36, 0xf149f2ca
    v_mov_b32 v37, 0xf149f2ca
    v_mov_b32 v38, 0xf149f2ca
    v_mov_b32 v39, 0xf149f2ca
ng_151:
    s_waitcnt lgkmcnt(2)
    s_nop 0
    v_mfma_f32_32x32x16_bf16 v[72:87], v[112:115], v[4:7], v[24:39]
    v_mfma_f32_32x32x16_bf16 v[72:87], v[116:119], v[8:11], v[72:87]
    ds_read_b128 v[104:107], v20 offset:8192
    ds_read_b128 v[108:111], v20 offset:9216
    v_exp_f32 v56, v56
    v_exp_f32 v57, v57
    v_exp_f32 v58, v58
    v_exp_f32 v59, v59
    v_exp_f32 v60, v60
    v_exp_f32 v61, v61
    v_exp_f32 v62, v62
    v_exp_f32 v63, v63
    v_exp_f32 v64, v64
    v_exp_f32 v65, v65
    v_exp_f32 v66, v66
    v_exp_f32 v67, v67
    v_exp_f32 v68, v68
    v_exp_f32 v69, v69
    v_exp_f32 v70, v70
    v_exp_f32 v71, v71
    v_add_f32 v22, v22, v56
    v_add_f32 v23, v23, v57
    v_add_f32 v22, v22, v58
    v_add_f32 v23, v23, v59
    v_add_f32 v22, v22, v60
    v_add_f32 v23, v23, v61
    v_add_f32 v22, v22, v62
    v_add_f32 v23, v23, v63
    v_add_f32 v22, v22, v64
    v_add_f32 v23, v23, v65
    v_add_f32 v22, v22, v66
    v_add_f32 v23, v23, v67
    v_add_f32 v22, v22, v68
    v_add_f32 v23, v23, v69
    v_add_f32 v22, v22, v70
    v_add_f32 v23, v23, v71
    v_cvt_pk_bf16_f32 v136, v56, v57
    v_cvt_pk_bf16_f32 v137, v58, v59
    v_cvt_pk_bf16_f32 v138, v60, v61
    v_cvt_pk_bf16_f32 v139, v62, v63
    v_cvt_pk_bf16_f32 v140, v64, v65
    v_cvt_pk_bf16_f32 v141, v66, v67
    v_cvt_pk_bf16_f32 v142, v68, v69
    v_cvt_pk_bf16_f32 v143, v70, v71
    s_waitcnt lgkmcnt(2)
    v_mfma_f32_32x32x16_bf16 v[88:103], v[120:123], v[136:139], v[88:103]
    v_mfma_f32_32x32x16_bf16 v[88:103], v[124:127], v[140:143], v[88:103]
    ds_read_b128 v[128:131], v20 offset:14336
    ds_read_b128 v[132:135], v20 offset:15360
    s_cmp_eq_u32 s76, 5
    s_cbranch_scc0 ng_152
    v_mov_b32 v24, 0xf149f2ca
    v_mov_b32 v25, 0xf149f2ca
    v_mov_b32 v26, 0xf149f2ca
    v_mov_b32 v27, 0xf149f2ca
    v_mov_b32 v28, 0xf149f2ca
    v_mov_b32 v29, 0xf149f2ca
    v_mov_b32 v30, 0xf149f2ca
    v_mov_b32 v31, 0xf149f2ca
    v_mov_b32 v32, 0xf149f2ca
    v_mov_b32 v33, 0xf149f2ca
    v_mov_b32 v34, 0xf149f2ca
    v_mov_b32 v35, 0xf149f2ca
    v_mov_b32 v36, 0xf149f2ca
    v_mov_b32 v37, 0xf149f2ca
    v_mov_b32 v38, 0xf149f2ca
    v_mov_b32 v39, 0xf149f2ca
ng_152:
    s_waitcnt lgkmcnt(2)
    s_nop 0
    v_mfma_f32_32x32x16_bf16 v[56:71], v[104:107], v[4:7], v[24:39]
    v_mfma_f32_32x32x16_bf16 v[56:71], v[108:111], v[8:11], v[56:71]
    ds_read_b128 v[112:115], v20 offset:4096
    ds_read_b128 v[116:119], v20 offset:5120
    v_exp_f32 v72, v72
    v_exp_f32 v73, v73
    v_exp_f32 v74, v74
    v_exp_f32 v75, v75
    v_exp_f32 v76, v76
    v_exp_f32 v77, v77
    v_exp_f32 v78, v78
    v_exp_f32 v79, v79
    v_exp_f32 v80, v80
    v_exp_f32 v81, v81
    v_exp_f32 v82, v82
    v_exp_f32 v83, v83
    v_exp_f32 v84, v84
    v_exp_f32 v85, v85
    v_exp_f32 v86, v86
    v_exp_f32 v87, v87
    v_add_f32 v22, v22, v72
    v_add_f32 v23, v23, v73
    v_add_f32 v22, v22, v74
    v_add_f32 v23, v23, v75
    v_add_f32 v22, v22, v76
    v_add_f32 v23, v23, v77
    v_add_f32 v22, v22, v78
    v_add_f32 v23, v23, v79
    v_add_f32 v22, v22, v80
    v_add_f32 v23, v23, v81
    v_add_f32 v22, v22, v82
    v_add_f32 v23, v23, v83
    v_add_f32 v22, v22, v84
    v_add_f32 v23, v23, v85
    v_add_f32 v22, v22, v86
    v_add_f32 v23, v23, v87
    v_cvt_pk_bf16_f32 v144, v72, v73
    v_cvt_pk_bf16_f32 v145, v74, v75
    v_cvt_pk_bf16_f32 v146, v76, v77
    v_cvt_pk_bf16_f32 v147, v78, v79
    v_cvt_pk_bf16_f32 v148, v80, v81
    v_cvt_pk_bf16_f32 v149, v82, v83
    v_cvt_pk_bf16_f32 v150, v84, v85
    v_cvt_pk_bf16_f32 v151, v86, v87
    s_waitcnt lgkmcnt(2)
    v_mfma_f32_32x32x16_bf16 v[88:103], v[128:131], v[144:147], v[88:103]
    v_mfma_f32_32x32x16_bf16 v[88:103], v[132:135], v[148:151], v[88:103]
    ds_read_b128 v[120:123], v20 offset:10240
    ds_read_b128 v[124:127], v20 offset:11264
    s_cmp_eq_u32 s76, 6
    s_cbranch_scc0 ng_153
    v_mov_b32 v24, 0xf149f2ca
    v_mov_b32 v25, 0xf149f2ca
    v_mov_b32 v26, 0xf149f2ca
    v_mov_b32 v27, 0xf149f2ca
    v_mov_b32 v28, 0xf149f2ca
    v_mov_b32 v29, 0xf149f2ca
    v_mov_b32 v30, 0xf149f2ca
    v_mov_b32 v31, 0xf149f2ca
    v_mov_b32 v32, 0xf149f2ca
    v_mov_b32 v33, 0xf149f2ca
    v_mov_b32 v34, 0xf149f2ca
    v_mov_b32 v35, 0xf149f2ca
    v_mov_b32 v36, 0xf149f2ca
    v_mov_b32 v37, 0xf149f2ca
    v_mov_b32 v38, 0xf149f2ca
    v_mov_b32 v39, 0xf149f2ca
ng_153:
    s_waitcnt lgkmcnt(2)
    s_nop 0
    v_mfma_f32_32x32x16_bf16 v[72:87], v[112:115], v[4:7], v[24:39]
    v_mfma_f32_32x32x16_bf16 v[72:87], v[116:119], v[8:11], v[72:87]
    v_exp_f32 v56, v56
    v_exp_f32 v57, v57
    v_exp_f32 v58, v58
    v_exp_f32 v59, v59
    v_exp_f32 v60, v60
    v_exp_f32 v61, v61
    v_exp_f32 v62, v62
    v_exp_f32 v63, v63
    v_exp_f32 v64, v64
    v_exp_f32 v65, v65
    v_exp_f32 v66, v66
    v_exp_f32 v67, v67
    v_exp_f32 v68, v68
    v_exp_f32 v69, v69
    v_exp_f32 v70, v70
    v_exp_f32 v71, v71
    v_add_f32 v22, v22, v56
    v_add_f32 v23, v23, v57
    v_add_f32 v22, v22, v58
    v_add_f32 v23, v23, v59
    v_add_f32 v22, v22, v60
    v_add_f32 v23, v23, v61
    v_add_f32 v22, v22, v62
    v_add_f32 v23, v23, v63
    v_add_f32 v22, v22, v64
    v_add_f32 v23, v23, v65
    v_add_f32 v22, v22, v66
    v_add_f32 v23, v23, v67
    v_add_f32 v22, v22, v68
    v_add_f32 v23, v23, v69
    v_add_f32 v22, v22, v70
    v_add_f32 v23, v23, v71
    v_cvt_pk_bf16_f32 v136, v56, v57
    v_cvt_pk_bf16_f32 v137, v58, v59
    v_cvt_pk_bf16_f32 v138, v60, v61
    v_cvt_pk_bf16_f32 v139, v62, v63
    v_cvt_pk_bf16_f32 v140, v64, v65
    v_cvt_pk_bf16_f32 v141, v66, v67
    v_cvt_pk_bf16_f32 v142, v68, v69
    v_cvt_pk_bf16_f32 v143, v70, v71
    s_waitcnt lgkmcnt(0)
    v_mfma_f32_32x32x16_bf16 v[88:103], v[120:123], v[136:139], v[88:103]
    v_mfma_f32_32x32x16_bf16 v[88:103], v[124:127], v[140:143], v[88:103]
    ds_read_b128 v[128:131], v20 offset:6144
    ds_read_b128 v[132:135], v20 offset:7168
    v_exp_f32 v72, v72
    v_exp_f32 v73, v73
    v_exp_f32 v74, v74
    v_exp_f32 v75, v75
    v_exp_f32 v76, v76
    v_exp_f32 v77, v77
    v_exp_f32 v78, v78
    v_exp_f32 v79, v79
    v_exp_f32 v80, v80
    v_exp_f32 v81, v81
    v_exp_f32 v82, v82
    v_exp_f32 v83, v83
    v_exp_f32 v84, v84
    v_exp_f32 v85, v85
    v_exp_f32 v86, v86
    v_exp_f32 v87, v87
    v_add_f32 v22, v22, v72
    v_add_f32 v23, v23, v73
    v_add_f32 v22, v22, v74
    v_add_f32 v23, v23, v75
    v_add_f32 v22, v22, v76
    v_add_f32 v23, v23, v77
    v_add_f32 v22, v22, v78
    v_add_f32 v23, v23, v79
    v_add_f32 v22, v22, v80
    v_add_f32 v23, v23, v81
    v_add_f32 v22, v22, v82
    v_add_f32 v23, v23, v83
    v_add_f32 v22, v22, v84
    v_add_f32 v23, v23, v85
    v_add_f32 v22, v22, v86
    v_add_f32 v23, v23, v87
    v_cvt_pk_bf16_f32 v144, v72, v73
    v_cvt_pk_bf16_f32 v145, v74, v75
    v_cvt_pk_bf16_f32 v146, v76, v77
    v_cvt_pk_bf16_f32 v147, v78, v79
    v_cvt_pk_bf16_f32 v148, v80, v81
    v_cvt_pk_bf16_f32 v149, v82, v83
    v_cvt_pk_bf16_f32 v150, v84, v85
    v_cvt_pk_bf16_f32 v151, v86, v87
    s_waitcnt lgkmcnt(0)
    v_mfma_f32_32x32x16_bf16 v[88:103], v[128:131], v[144:147], v[88:103]
    v_mfma_f32_32x32x16_bf16 v[88:103], v[132:135], v[148:151], v[88:103]
    v_add_f32 v22, v22, v23
    v_mov_b32 v152, v22
    s_nop 1
    v_permlane32_swap_b32 v22, v152
    v_add_f32 v22, v22, v152
    v_rcp_f32 v22, v22
    s_lshl_b32 s33, s25, 11
    s_add_u32 s33, s33, s36
    s_branch att_ret0
att_exact1:
    s_waitcnt lgkmcnt(0)
    v_mov_b32 v20, 0xffff
    v_mov_b32 v21, 0xffff0000
    v_cndmask_b32 v22, 0, v20, s[40:41]
    v_cndmask_b32 v23, 0, v21, s[42:43]
    v_or_b32 v12, v22, v23
    v_cndmask_b32 v22, 0, v20, s[44:45]
    v_cndmask_b32 v23, 0, v21, s[46:47]
    v_or_b32 v13, v22, v23
    v_cndmask_b32 v22, 0, v20, s[48:49]
    v_cndmask_b32 v23, 0, v21, s[50:51]
    v_or_b32 v14, v22, v23
    v_cndmask_b32 v22, 0, v20, s[52:53]
    v_cndmask_b32 v23, 0, v21, s[54:55]
    v_or_b32 v15, v22, v23
    v_cndmask_b32 v22, 0, v20, s[56:57]
    v_cndmask_b32 v23, 0, v21, s[58:59]
    v_or_b32 v16, v22, v23
    v_cndmask_b32 v22, 0, v20, s[60:61]
    v_cndmask_b32 v23, 0, v21, s[62:63]
    v_or_b32 v17, v22, v23
    v_cndmask_b32 v22, 0, v20, s[64:65]
    v_cndmask_b32 v23, 0, v21, s[66:67]
    v_or_b32 v18, v22, v23
    v_cndmask_b32 v22, 0, v20, s[68:69]
    v_cndmask_b32 v23, 0, v21, s[70:71]
    v_or_b32 v19, v22, v23
    s_and_b32 s34, s76, 3
    s_lshl_b32 s33, s34, 12
    s_add_u32 s33, s33, 114688
    v_add_u32 v20, s33, v253
    v_mov_b32 v24, 0
    v_mov_b32 v25, 0
    v_mov_b32 v26, 0
    v_mov_b32 v27, 0
    v_mov_b32 v28, 0
    v_mov_b32 v29, 0
    v_mov_b32 v30, 0
    v_mov_b32 v31, 0
    v_mov_b32 v32, 0
    v_mov_b32 v33, 0
    v_mov_b32 v34, 0
    v_mov_b32 v35, 0
    v_mov_b32 v36, 0
    v_mov_b32 v37, 0
    v_mov_b32 v38, 0
    v_mov_b32 v39, 0
    ds_read_b128 v[104:107], v20 offset:32768
    ds_read_b128 v[108:111], v20 offset:33792
    ds_read_b128 v[112:115], v20 offset:28672
    ds_read_b128 v[116:119], v20 offset:29696
    s_waitcnt lgkmcnt(2)
    v_mfma_f32_32x32x16_bf16 v[40:55], v[104:107], v[4:7], 0
    v_mfma_f32_32x32x16_bf16 v[40:55], v[108:111], v[8:11], v[40:55]
    ds_read_b128 v[104:107], v20 offset:24576
    ds_read_b128 v[108:111], v20 offset:25600
    s_cmp_eq_u32 s76, 0
    s_cbranch_scc0 ng_154
    v_mov_b32 v24, 0xf149f2ca
    v_mov_b32 v25, 0xf149f2ca
    v_mov_b32 v26, 0xf149f2ca
    v_mov_b32 v27, 0xf149f2ca
    v_mov_b32 v28, 0xf149f2ca
    v_mov_b32 v29, 0xf149f2ca
    v_mov_b32 v30, 0xf149f2ca
    v_mov_b32 v31, 0xf149f2ca
    v_mov_b32 v32, 0xf149f2ca
    v_mov_b32 v33, 0xf149f2ca
    v_mov_b32 v34, 0xf149f2ca
    v_mov_b32 v35, 0xf149f2ca
    v_mov_b32 v36, 0xf149f2ca
    v_mov_b32 v37, 0xf149f2ca
    v_mov_b32 v38, 0xf149f2ca
    v_mov_b32 v39, 0xf149f2ca
ng_154:
    s_waitcnt lgkmcnt(2)
    s_nop 0
    v_mfma_f32_32x32x16_bf16 v[72:87], v[112:115], v[4:7], v[24:39]
    v_mfma_f32_32x32x16_bf16 v[72:87], v[116:119], v[8:11], v[72:87]
    ds_read_b128 v[112:115], v20 offset:20480
    ds_read_b128 v[116:119], v20 offset:21504
    s_cmp_eq_u32 s76, 1
    s_cbranch_scc0 ng_155
    s_nop 1
    v_mov_b32 v24, 0xf149f2ca
    v_mov_b32 v25, 0xf149f2ca
    v_mov_b32 v26, 0xf149f2ca
    v_mov_b32 v27, 0xf149f2ca
    v_mov_b32 v28, 0xf149f2ca
    v_mov_b32 v29, 0xf149f2ca
    v_mov_b32 v30, 0xf149f2ca
    v_mov_b32 v31, 0xf149f2ca
    v_mov_b32 v32, 0xf149f2ca
    v_mov_b32 v33, 0xf149f2ca
    v_mov_b32 v34, 0xf149f2ca
    v_mov_b32 v35, 0xf149f2ca
    v_mov_b32 v36, 0xf149f2ca
    v_mov_b32 v37, 0xf149f2ca
    v_mov_b32 v38, 0xf149f2ca
    v_mov_b32 v39, 0xf149f2ca
ng_155:
    s_waitcnt lgkmcnt(2)
    s_nop 0
    v_mfma_f32_32x32x16_bf16 v[56:71], v[104:107], v[4:7], v[24:39]
    v_mfma_f32_32x32x16_bf16 v[56:71], v[108:111], v[8:11], v[56:71]
    s_nop 3
    v_max_f32 v21, v72, v73
    v_max3_f32 v21, v21, v74, v75
    v_max3_f32 v21, v21, v76, v77
    v_max3_f32 v21, v21, v78, v79
    v_max3_f32 v21, v21, v80, v81
    v_max3_f32 v21, v21, v82, v83
    v_max3_f32 v21, v21, v84, v85
    v_max3_f32 v21, v21, v86, v87
    ds_read_b128 v[104:107], v20 offset:16384
    ds_read_b128 v[108:111], v20 offset:17408
    s_cmp_eq_u32 s76, 2
    s_cbranch_scc0 ng_156
    v_mov_b32 v24, 0xf149f2ca
    v_mov_b32 v25, 0xf149f2ca
    v_mov_b32 v26, 0xf149f2ca
    v_mov_b32 v27, 0xf149f2ca
    v_mov_b32 v28, 0xf149f2ca
    v_mov_b32 v29, 0xf149f2ca
    v_mov_b32 v30, 0xf149f2ca
    v_mov_b32 v31, 0xf149f2ca
    v_mov_b32 v32, 0xf149f2ca
    v_mov_b32 v33, 0xf149f2ca
    v_mov_b32 v34, 0xf149f2ca
    v_mov_b32 v35, 0xf149f2ca
    v_mov_b32 v36, 0xf149f2ca
    v_mov_b32 v37, 0xf149f2ca
    v_mov_b32 v38, 0xf149f2ca
    v_mov_b32 v39, 0xf149f2ca
ng_156:
    s_waitcnt lgkmcnt(2)
    s_nop 0
    v_mfma_f32_32x32x16_bf16 v[72:87], v[112:115], v[4:7], v[24:39]
    v_mfma_f32_32x32x16_bf16 v[72:87], v[116:119], v[8:11], v[72:87]
    v_max3_f32 v21, v21, v56, v57
    v_max3_f32 v21, v21, v58, v59
    v_max3_f32 v21, v21, v60, v61
    v_max3_f32 v21, v21, v62, v63
    v_max3_f32 v21, v21, v64, v65
    v_max3_f32 v21, v21, v66, v67
    v_max3_f32 v21, v21, v68, v69
    v_max3_f32 v21, v21, v70, v71
    ds_read_b128 v[112:115], v20 offset:12288
    ds_read_b128 v[116:119], v20 offset:13312
    s_cmp_eq_u32 s76, 3
    s_cbranch_scc0 ng_157
    v_mov_b32 v24, 0xf149f2ca
    v_mov_b32 v25, 0xf149f2ca
    v_mov_b32 v26, 0xf149f2ca
    v_mov_b32 v27, 0xf149f2ca
    v_mov_b32 v28, 0xf149f2ca
    v_mov_b32 v29, 0xf149f2ca
    v_mov_b32 v30, 0xf149f2ca
    v_mov_b32 v31, 0xf149f2ca
    v_mov_b32 v32, 0xf149f2ca
    v_mov_b32 v33, 0xf149f2ca
    v_mov_b32 v34, 0xf149f2ca
    v_mov_b32 v35, 0xf149f2ca
    v_mov_b32 v36, 0xf149f2ca
    v_mov_b32 v37, 0xf149f2ca
    v_mov_b32 v38, 0xf149f2ca
    v_mov_b32 v39, 0xf149f2ca
ng_157:
    s_waitcnt lgkmcnt(2)
    s_nop 0
    v_mfma_f32_32x32x16_bf16 v[56:71], v[104:107], v[4:7], v[24:39]
    v_mfma_f32_32x32x16_bf16 v[56:71], v[108:111], v[8:11], v[56:71]
    v_max3_f32 v21, v21, v72, v73
    v_max3_f32 v21, v21, v74, v75
    v_max3_f32 v21, v21, v76, v77
    v_max3_f32 v21, v21, v78, v79
    v_max3_f32 v21, v21, v80, v81
    v_max3_f32 v21, v21, v82, v83
    v_max3_f32 v21, v21, v84, v85
    v_max3_f32 v21, v21, v86, v87
    ds_read_b128 v[104:107], v20 offset:8192
    ds_read_b128 v[108:111], v20 offset:9216
    s_cmp_eq_u32 s76, 4
    s_cbranch_scc0 ng_158
    v_mov_b32 v24, 0xf149f2ca
    v_mov_b32 v25, 0xf149f2ca
    v_mov_b32 v26, 0xf149f2ca
    v_mov_b32 v27, 0xf149f2ca
    v_mov_b32 v28, 0xf149f2ca
    v_mov_b32 v29, 0xf149f2ca
    v_mov_b32 v30, 0xf149f2ca
    v_mov_b32 v31, 0xf149f2ca
    v_mov_b32 v32, 0xf149f2ca
    v_mov_b32 v33, 0xf149f2ca
    v_mov_b32 v34, 0xf149f2ca
    v_mov_b32 v35, 0xf149f2ca
    v_mov_b32 v36, 0xf149f2ca
    v_mov_b32 v37, 0xf149f2ca
    v_mov_b32 v38, 0xf149f2ca
    v_mov_b32 v39, 0xf149f2ca
ng_158:
    s_waitcnt lgkmcnt(2)
    s_nop 0
    v_mfma_f32_32x32x16_bf16 v[72:87], v[112:115], v[4:7], v[24:39]
    v_mfma_f32_32x32x16_bf16 v[72:87], v[116:119], v[8:11], v[72:87]
    v_max3_f32 v21, v21, v56, v57
    v_max3_f32 v21, v21, v58, v59
    v_max3_f32 v21, v21, v60, v61
    v_max3_f32 v21, v21, v62, v63
    v_max3_f32 v21, v21, v64, v65
    v_max3_f32 v21, v21, v66, v67
    v_max3_f32 v21, v21, v68, v69
    v_max3_f32 v21, v21, v70, v71
    ds_read_b128 v[112:115], v20 offset:4096
    ds_read_b128 v[116:119], v20 offset:5120
    s_cmp_eq_u32 s76, 5
    s_cbranch_scc0 ng_159
    v_mov_b32 v24, 0xf149f2ca
    v_mov_b32 v25, 0xf149f2ca
    v_mov_b32 v26, 0xf149f2ca
    v_mov_b32 v27, 0xf149f2ca
    v_mov_b32 v28, 0xf149f2ca
    v_mov_b32 v29, 0xf149f2ca
    v_mov_b32 v30, 0xf149f2ca
    v_mov_b32 v31, 0xf149f2ca
    v_mov_b32 v32, 0xf149f2ca
    v_mov_b32 v33, 0xf149f2ca
    v_mov_b32 v34, 0xf149f2ca
    v_mov_b32 v35, 0xf149f2ca
    v_mov_b32 v36, 0xf149f2ca
    v_mov_b32 v37, 0xf149f2ca
    v_mov_b32 v38, 0xf149f2ca
    v_mov_b32 v39, 0xf149f2ca
ng_159:
    s_waitcnt lgkmcnt(2)
    s_nop 0
    v_mfma_f32_32x32x16_bf16 v[56:71], v[104:107], v[4:7], v[24:39]
    v_mfma_f32_32x32x16_bf16 v[56:71], v[108:111], v[8:11], v[56:71]
    v_max3_f32 v21, v21, v72, v73
    v_max3_f32 v21, v21, v74, v75
    v_max3_f32 v21, v21, v76, v77
    v_max3_f32 v21, v21, v78, v79
    v_max3_f32 v21, v21, v80, v81
    v_max3_f32 v21, v21, v82, v83
    v_max3_f32 v21, v21, v84, v85
    v_max3_f32 v21, v21, v86, v87
    ds_read_b128 v[104:107], v20 offset:0
    ds_read_b128 v[108:111], v20 offset:1024
    s_cmp_eq_u32 s76, 6
    s_cbranch_scc0 ng_160
    v_mov_b32 v24, 0xf149f2ca
    v_mov_b32 v25, 0xf149f2ca
    v_mov_b32 v26, 0xf149f2ca
    v_mov_b32 v27, 0xf149f2ca
    v_mov_b32 v28, 0xf149f2ca
    v_mov_b32 v29, 0xf149f2ca
    v_mov_b32 v30, 0xf149f2ca
    v_mov_b32 v31, 0xf149f2ca
    v_mov_b32 v32, 0xf149f2ca
    v_mov_b32 v33, 0xf149f2ca
    v_mov_b32 v34, 0xf149f2ca
    v_mov_b32 v35, 0xf149f2ca
    v_mov_b32 v36, 0xf149f2ca
    v_mov_b32 v37, 0xf149f2ca
    v_mov_b32 v38, 0xf149f2ca
    v_mov_b32 v39, 0xf149f2ca
ng_160:
    s_waitcnt lgkmcnt(2)
    s_nop 0
    v_mfma_f32_32x32x16_bf16 v[72:87], v[112:115], v[4:7], v[24:39]
    v_mfma_f32_32x32x16_bf16 v[72:87], v[116:119], v[8:11], v[72:87]
    v_max3_f32 v21, v21, v56, v57
    v_max3_f32 v21, v21, v58, v59
    v_max3_f32 v21, v21, v60, v61
    v_max3_f32 v21, v21, v62, v63
    v_max3_f32 v21, v21, v64, v65
    v_max3_f32 v21, v21, v66, v67
    v_max3_f32 v21, v21, v68, v69
    v_max3_f32 v21, v21, v70, v71
    s_cmp_eq_u32 s76, 7
    s_cbranch_scc0 ng_161
    v_mov_b32 v24, 0xf149f2ca
    v_mov_b32 v25, 0xf149f2ca
    v_mov_b32 v26, 0xf149f2ca
    v_mov_b32 v27, 0xf149f2ca
    v_mov_b32 v28, 0xf149f2ca
    v_mov_b32 v29, 0xf149f2ca
    v_mov_b32 v30, 0xf149f2ca
    v_mov_b32 v31, 0xf149f2ca
    v_mov_b32 v32, 0xf149f2ca
    v_mov_b32 v33, 0xf149f2ca
    v_mov_b32 v34, 0xf149f2ca
    v_mov_b32 v35, 0xf149f2ca
    v_mov_b32 v36, 0xf149f2ca
    v_mov_b32 v37, 0xf149f2ca
    v_mov_b32 v38, 0xf149f2ca
    v_mov_b32 v39, 0xf149f2ca
ng_161:
    s_waitcnt lgkmcnt(0)
    s_nop 0
    v_mfma_f32_32x32x16_bf16 v[56:71], v[104:107], v[4:7], v[24:39]
    v_mfma_f32_32x32x16_bf16 v[56:71], v[108:111], v[8:11], v[56:71]
    v_max3_f32 v21, v21, v72, v73
    v_max3_f32 v21, v21, v74, v75
    v_max3_f32 v21, v21, v76, v77
    v_max3_f32 v21, v21, v78, v79
    v_max3_f32 v21, v21, v80, v81
    v_max3_f32 v21, v21, v82, v83
    v_max3_f32 v21, v21, v84, v85
    v_max3_f32 v21, v21, v86, v87
    ds_read_b128 v[112:115], v20 offset:28672
    ds_read_b128 v[116:119], v20 offset:29696
    ds_read_b128 v[120:123], v20 offset:34816
    ds_read_b128 v[124:127], v20 offset:35840
    ds_read_b128 v[128:131], v20 offset:2048
    ds_read_b128 v[132:135], v20 offset:3072
    v_cndmask_b32 v40, v56, v40, s[40:41]
    v_cndmask_b32 v41, v57, v41, s[42:43]
    v_cndmask_b32 v42, v58, v42, s[44:45]
    v_cndmask_b32 v43, v59, v43, s[46:47]
    v_cndmask_b32 v44, v60, v44, s[48:49]
    v_cndmask_b32 v45, v61, v45, s[50:51]
    v_cndmask_b32 v46, v62, v46, s[52:53]
    v_cndmask_b32 v47, v63, v47, s[54:55]
    v_cndmask_b32 v48, v64, v48, s[56:57]
    v_cndmask_b32 v49, v65, v49, s[58:59]
    v_cndmask_b32 v50, v66, v50, s[60:61]
    v_cndmask_b32 v51, v67, v51, s[62:63]
    v_cndmask_b32 v52, v68, v52, s[64:65]
    v_cndmask_b32 v53, v69, v53, s[66:67]
    v_cndmask_b32 v54, v70, v54, s[68:69]
    v_cndmask_b32 v55, v71, v55, s[70:71]
    v_max3_f32 v21, v21, v40, v41
    v_max3_f32 v21, v21, v42, v43
    v_max3_f32 v21, v21, v44, v45
    v_max3_f32 v21, v21, v46, v47
    v_max3_f32 v21, v21, v48, v49
    v_max3_f32 v21, v21, v50, v51
    v_max3_f32 v21, v21, v52, v53
    v_max3_f32 v21, v21, v54, v55
    v_mov_b32 v152, v21
    s_nop 1
    v_permlane32_swap_b32 v21, v152
    v_max_f32 v21, v21, v152
    v_sub_f32 v24, 0, v21
    v_sub_f32 v25, 0, v21
    v_sub_f32 v26, 0, v21
    v_sub_f32 v27, 0, v21
    v_sub_f32 v28, 0, v21
    v_sub_f32 v29, 0, v21
    v_sub_f32 v30, 0, v21
    v_sub_f32 v31, 0, v21
    v_sub_f32 v32, 0, v21
    v_sub_f32 v33, 0, v21
    v_sub_f32 v34, 0, v21
    v_sub_f32 v35, 0, v21
    v_sub_f32 v36, 0, v21
    v_sub_f32 v37, 0, v21
    v_sub_f32 v38, 0, v21
    v_sub_f32 v39, 0, v21
    s_cmp_eq_u32 s76, 0
    s_cbranch_scc0 ng_162
    v_mov_b32 v24, 0xf149f2ca
    v_mov_b32 v25, 0xf149f2ca
    v_mov_b32 v26, 0xf149f2ca
    v_mov_b32 v27, 0xf149f2ca
    v_mov_b32 v28, 0xf149f2ca
    v_mov_b32 v29, 0xf149f2ca
    v_mov_b32 v30, 0xf149f2ca
    v_mov_b32 v31, 0xf149f2ca
    v_mov_b32 v32, 0xf149f2ca
    v_mov_b32 v33, 0xf149f2ca
    v_mov_b32 v34, 0xf149f2ca
    v_mov_b32 v35, 0xf149f2ca
    v_mov_b32 v36, 0xf149f2ca
    v_mov_b32 v37, 0xf149f2ca
    v_mov_b32 v38, 0xf149f2ca
    v_mov_b32 v39, 0xf149f2ca
ng_162:
    s_waitcnt lgkmcnt(4)
    s_nop 0
    v_mfma_f32_32x32x16_bf16 v[72:87], v[112:115], v[4:7], v[24:39]
    v_mfma_f32_32x32x16_bf16 v[72:87], v[116:119], v[8:11], v[72:87]
    ds_read_b128 v[104:107], v20 offset:24576
    ds_read_b128 v[108:111], v20 offset:25600
    v_sub_f32 v40, v40, v21
    v_sub_f32 v41, v41, v21
    v_sub_f32 v42, v42, v21
    v_sub_f32 v43, v43, v21
    v_sub_f32 v44, v44, v21
    v_sub_f32 v45, v45, v21
    v_sub_f32 v46, v46, v21
    v_sub_f32 v47, v47, v21
    v_sub_f32 v48, v48, v21
    v_sub_f32 v49, v49, v21
    v_sub_f32 v50, v50, v21
    v_sub_f32 v51, v51, v21
    v_sub_f32 v52, v52, v21
    v_sub_f32 v53, v53, v21
    v_sub_f32 v54, v54, v21
    v_sub_f32 v55, v55, v21
    v_exp_f32 v40, v40
    v_exp_f32 v41, v41
    v_exp_f32 v42, v42
    v_exp_f32 v43, v43
    v_exp_f32 v44, v44
    v_exp_f32 v45, v45
    v_exp_f32 v46, v46
    v_exp_f32 v47, v47
    v_exp_f32 v48, v48
    v_exp_f32 v49, v49
    v_exp_f32 v50, v50
    v_exp_f32 v51, v51
    v_exp_f32 v52, v52
    v_exp_f32 v53, v53
    v_exp_f32 v54, v54
    v_exp_f32 v55, v55
    v_add_f32 v22, v40, v41
    v_add_f32 v23, v42, v43
    v_add_f32 v22, v22, v44
    v_add_f32 v23, v23, v45
    v_add_f32 v22, v22, v46
    v_add_f32 v23, v23, v47
    v_add_f32 v22, v22, v48
    v_add_f32 v23, v23, v49
    v_add_f32 v22, v22, v50
    v_add_f32 v23, v23, v51
    v_add_f32 v22, v22, v52
    v_add_f32 v23, v23, v53
    v_add_f32 v22, v22, v54
    v_add_f32 v23, v23, v55
    v_cvt_pk_bf16_f32 v144, v40, v41
    v_cvt_pk_bf16_f32 v145, v42, v43
    v_cvt_pk_bf16_f32 v146, v44, v45
    v_cvt_pk_bf16_f32 v147, v46, v47
    v_cvt_pk_bf16_f32 v148, v48, v49
    v_cvt_pk_bf16_f32 v149, v50, v51
    v_cvt_pk_bf16_f32 v150, v52, v53
    v_cvt_pk_bf16_f32 v151, v54, v55
    v_and_b32 v136, v144, v12
    v_and_b32 v137, v145, v13
    v_and_b32 v138, v146, v14
    v_and_b32 v139, v147, v15
    v_and_b32 v140, v148, v16
    v_and_b32 v141, v149, v17
    v_and_b32 v142, v150, v18
    v_and_b32 v143, v151, v19
    v_xor_b32 v144, v144, v136
    v_xor_b32 v145, v145, v137
    v_xor_b32 v146, v146, v138
    v_xor_b32 v147, v147, v139
    v_xor_b32 v148, v148, v140
    v_xor_b32 v149, v149, v141
    v_xor_b32 v150, v150, v142
    v_xor_b32 v151, v151, v143
    s_waitcnt lgkmcnt(2)
    v_mfma_f32_32x32x16_bf16 v[88:103], v[120:123], v[136:139], 0
    v_mfma_f32_32x32x16_bf16 v[88:103], v[124:127], v[140:143], v[88:103]
    v_mfma_f32_32x32x16_bf16 v[88:103], v[128:131], v[144:147], v[88:103]
    v_mfma_f32_32x32x16_bf16 v[88:103], v[132:135], v[148:151], v[88:103]
    ds_read_b128 v[128:131], v20 offset:30720
    ds_read_b128 v[132:135], v20 offset:31744
    s_cmp_eq_u32 s76, 1
    s_cbranch_scc0 ng_163
    v_mov_b32 v24, 0xf149f2ca
    v_mov_b32 v25, 0xf149f2ca
    v_mov_b32 v26, 0xf149f2ca
    v_mov_b32 v27, 0xf149f2ca
    v_mov_b32 v28, 0xf149f2ca
    v_mov_b32 v29, 0xf149f2ca
    v_mov_b32 v30, 0xf149f2ca
    v_mov_b32 v31, 0xf149f2ca
    v_mov_b32 v32, 0xf149f2ca
    v_mov_b32 v33, 0xf149f2ca
    v_mov_b32 v34, 0xf149f2ca
    v_mov_b32 v35, 0xf149f2ca
    v_mov_b32 v36, 0xf149f2ca
    v_mov_b32 v37, 0xf149f2ca
    v_mov_b32 v38, 0xf149f2ca
    v_mov_b32 v39, 0xf149f2ca
ng_163:
    s_waitcnt lgkmcnt(2)
    s_nop 0
    v_mfma_f32_32x32x16_bf16 v[56:71], v[104:107], v[4:7], v[24:39]
    v_mfma_f32_32x32x16_bf16 v[56:71], v[108:111], v[8:11], v[56:71]
    ds_read_b128 v[112:115], v20 offset:20480
    ds_read_b128 v[116:119], v20 offset:21504
    v_exp_f32 v72, v72
    v_exp_f32 v73, v73
    v_exp_f32 v74, v74
    v_exp_f32 v75, v75
    v_exp_f32 v76, v76
    v_exp_f32 v77, v77
    v_exp_f32 v78, v78
    v_exp_f32 v79, v79
    v_exp_f32 v80, v80
    v_exp_f32 v81, v81
    v_exp_f32 v82, v82
    v_exp_f32 v83, v83
    v_exp_f32 v84, v84
    v_exp_f32 v85, v85
    v_exp_f32 v86, v86
    v_exp_f32 v87, v87
    v_add_f32 v22, v22, v72
    v_add_f32 v23, v23, v73
    v_add_f32 v22, v22, v74
    v_add_f32 v23, v23, v75
    v_add_f32 v22, v22, v76
    v_add_f32 v23, v23, v77
    v_add_f32 v22, v22, v78
    v_add_f32 v23, v23, v79
    v_add_f32 v22, v22, v80
    v_add_f32 v23, v23, v81
    v_add_f32 v22, v22, v82
    v_add_f32 v23, v23, v83
    v_add_f32 v22, v22, v84
    v_add_f32 v23, v23, v85
    v_add_f32 v22, v22, v86
    v_add_f32 v23, v23, v87
    v_cvt_pk_bf16_f32 v144, v72, v73
    v_cvt_pk_bf16_f32 v145, v74, v75
    v_cvt_pk_bf16_f32 v146, v76, v77
    v_cvt_pk_bf16_f32 v147, v78, v79
    v_cvt_pk_bf16_f32 v148, v80, v81
    v_cvt_pk_bf16_f32 v149, v82, v83
    v_cvt_pk_bf16_f32 v150, v84, v85
    v_cvt_pk_bf16_f32 v151, v86, v87
    s_waitcnt lgkmcnt(2)
    v_mfma_f32_32x32x16_bf16 v[88:103], v[128:131], v[144:147], v[88:103]
    v_mfma_f32_32x32x16_bf16 v[88:103], v[132:135], v[148:151], v[88:103]
    ds_read_b128 v[120:123], v20 offset:26624
    ds_read_b128 v[124:127], v20 offset:27648
    s_cmp_eq_u32 s76, 2
    s_cbranch_scc0 ng_164
    v_mov_b32 v24, 0xf149f2ca
    v_mov_b32 v25, 0xf149f2ca
    v_mov_b32 v26, 0xf149f2ca
    v_mov_b32 v27, 0xf149f2ca
    v_mov_b32 v28, 0xf149f2ca
    v_mov_b32 v29, 0xf149f2ca
    v_mov_b32 v30, 0xf149f2ca
    v_mov_b32 v31, 0xf149f2ca
    v_mov_b32 v32, 0xf149f2ca
    v_mov_b32 v33, 0xf149f2ca
    v_mov_b32 v34, 0xf149f2ca
    v_mov_b32 v35, 0xf149f2ca
    v_mov_b32 v36, 0xf149f2ca
    v_mov_b32 v37, 0xf149f2ca
    v_mov_b32 v38, 0xf149f2ca
    v_mov_b32 v39, 0xf149f2ca
ng_164:
    s_waitcnt lgkmcnt(2)
    s_nop 0
    v_mfma_f32_32x32x16_bf16 v[72:87], v[112:115], v[4:7], v[24:39]
    v_mfma_f32_32x32x16_bf16 v[72:87], v[116:119], v[8:11], v[72:87]
    ds_read_b128 v[104:107], v20 offset:16384
    ds_read_b128 v[108:111], v20 offset:17408
    v_exp_f32 v56, v56
    v_exp_f32 v57, v57
    v_exp_f32 v58, v58
    v_exp_f32 v59, v59
    v_exp_f32 v60, v60
    v_exp_f32 v61, v61
    v_exp_f32 v62, v62
    v_exp_f32 v63, v63
    v_exp_f32 v64, v64
    v_exp_f32 v65, v65
    v_exp_f32 v66, v66
    v_exp_f32 v67, v67
    v_exp_f32 v68, v68
    v_exp_f32 v69, v69
    v_exp_f32 v70, v70
    v_exp_f32 v71, v71
    v_add_f32 v22, v22, v56
    v_add_f32 v23, v23, v57
    v_add_f32 v22, v22, v58
    v_add_f32 v23, v23, v59
    v_add_f32 v22, v22, v60
    v_add_f32 v23, v23, v61
    v_add_f32 v22, v22, v62
    v_add_f32 v23, v23, v63
    v_add_f32 v22, v22, v64
    v_add_f32 v23, v23, v65
    v_add_f32 v22, v22, v66
    v_add_f32 v23, v23, v67
    v_add_f32 v22, v22, v68
    v_add_f32 v23, v23, v69
    v_add_f32 v22, v22, v70
    v_add_f32 v23, v23, v71
    v_cvt_pk_bf16_f32 v136, v56, v57
    v_cvt_pk_bf16_f32 v137, v58, v59
    v_cvt_pk_bf16_f32 v138, v60, v61
    v_cvt_pk_bf16_f32 v139, v62, v63
    v_cvt_pk_bf16_f32 v140, v64, v65
    v_cvt_pk_bf16_f32 v141, v66, v67
    v_cvt_pk_bf16_f32 v142, v68, v69
    v_cvt_pk_bf16_f32 v143, v70, v71
    s_waitcnt lgkmcnt(2)
    v_mfma_f32_32x32x16_bf16 v[88:103], v[120:123], v[136:139], v[88:103]
    v_mfma_f32_32x32x16_bf16 v[88:103], v[124:127], v[140:143], v[88:103]
    ds_read_b128 v[128:131], v20 offset:22528
    ds_read_b128 v[132:135], v20 offset:23552
    s_cmp_eq_u32 s76, 3
    s_cbranch_scc0 ng_165
    v_mov_b32 v24, 0xf149f2ca
    v_mov_b32 v25, 0xf149f2ca
    v_mov_b32 v26, 0xf149f2ca
    v_mov_b32 v27, 0xf149f2ca
    v_mov_b32 v28, 0xf149f2ca
    v_mov_b32 v29, 0xf149f2ca
    v_mov_b32 v30, 0xf149f2ca
    v_mov_b32 v31, 0xf149f2ca
    v_mov_b32 v32, 0xf149f2ca
    v_mov_b32 v33, 0xf149f2ca
    v_mov_b32 v34, 0xf149f2ca
    v_mov_b32 v35, 0xf149f2ca
    v_mov_b32 v36, 0xf149f2ca
    v_mov_b32 v37, 0xf149f2ca
    v_mov_b32 v38, 0xf149f2ca
    v_mov_b32 v39, 0xf149f2ca
ng_165:
    s_waitcnt lgkmcnt(2)
    s_nop 0
    v_mfma_f32_32x32x16_bf16 v[56:71], v[104:107], v[4:7], v[24:39]
    v_mfma_f32_32x32x16_bf16 v[56:71], v[108:111], v[8:11], v[56:71]
    ds_read_b128 v[112:115], v20 offset:12288
    ds_read_b128 v[116:119], v20 offset:13312
    v_exp_f32 v72, v72
    v_exp_f32 v73, v73
    v_exp_f32 v74, v74
    v_exp_f32 v75, v75
    v_exp_f32 v76, v76
    v_exp_f32 v77, v77
    v_exp_f32 v78, v78
    v_exp_f32 v79, v79
    v_exp_f32 v80, v80
    v_exp_f32 v81, v81
    v_exp_f32 v82, v82
    v_exp_f32 v83, v83
    v_exp_f32 v84, v84
    v_exp_f32 v85, v85
    v_exp_f32 v86, v86
    v_exp_f32 v87, v87
    v_add_f32 v22, v22, v72
    v_add_f32 v23, v23, v73
    v_add_f32 v22, v22, v74
    v_add_f32 v23, v23, v75
    v_add_f32 v22, v22, v76
    v_add_f32 v23, v23, v77
    v_add_f32 v22, v22, v78
    v_add_f32 v23, v23, v79
    v_add_f32 v22, v22, v80
    v_add_f32 v23, v23, v81
    v_add_f32 v22, v22, v82
    v_add_f32 v23, v23, v83
    v_add_f32 v22, v22, v84
    v_add_f32 v23, v23, v85
    v_add_f32 v22, v22, v86
    v_add_f32 v23, v23, v87
    v_cvt_pk_bf16_f32 v144, v72, v73
    v_cvt_pk_bf16_f32 v145, v74, v75
    v_cvt_pk_bf16_f32 v146, v76, v77
    v_cvt_pk_bf16_f32 v147, v78, v79
    v_cvt_pk_bf16_f32 v148, v80, v81
    v_cvt_pk_bf16_f32 v149, v82, v83
    v_cvt_pk_bf16_f32 v150, v84, v85
    v_cvt_pk_bf16_f32 v151, v86, v87
    s_waitcnt lgkmcnt(2)
    v_mfma_f32_32x32x16_bf16 v[88:103], v[128:131], v[144:147], v[88:103]
    v_mfma_f32_32x32x16_bf16 v[88:103], v[132:135], v[148:151], v[88:103]
    ds_read_b128 v[120:123], v20 offset:18432
    ds_read_b128 v[124:127], v20 offset:19456
    s_cmp_eq_u32 s76, 4
    s_cbranch_scc0 ng_166
    v_mov_b32 v24, 0xf149f2ca
    v_mov_b32 v25, 0xf149f2ca
    v_mov_b32 v26, 0xf149f2ca
    v_mov_b32 v27, 0xf149f2ca
    v_mov_b32 v28, 0xf149f2ca
    v_mov_b32 v29, 0xf149f2ca
    v_mov_b32 v30, 0xf149f2ca
    v_mov_b32 v31, 0xf149f2ca
    v_mov_b32 v32, 0xf149f2ca
    v_mov_b32 v33, 0xf149f2ca
    v_mov_b32 v34, 0xf149f2ca
    v_mov_b32 v35, 0xf149f2ca
    v_mov_b32 v36, 0xf149f2ca
    v_mov_b32 v37, 0xf149f2ca
    v_mov_b32 v38, 0xf149f2ca
    v_mov_b32 v39, 0xf149f2ca
ng_166:
    s_waitcnt lgkmcnt(2)
    s_nop 0
    v_mfma_f32_32x32x16_bf16 v[72:87], v[112:115], v[4:7], v[24:39]
    v_mfma_f32_32x32x16_bf16 v[72:87], v[116:119], v[8:11], v[72:87]
    ds_read_b128 v[104:107], v20 offset:8192
    ds_read_b128 v[108:111], v20 offset:9216
    v_exp_f32 v56, v56
    v_exp_f32 v57, v57
    v_exp_f32 v58, v58
    v_exp_f32 v59, v59
    v_exp_f32 v60, v60
    v_exp_f32 v61, v61
    v_exp_f32 v62, v62
    v_exp_f32 v63, v63
    v_exp_f32 v64, v64
    v_exp_f32 v65, v65
    v_exp_f32 v66, v66
    v_exp_f32 v67, v67
    v_exp_f32 v68, v68
    v_exp_f32 v69, v69
    v_exp_f32 v70, v70
    v_exp_f32 v71, v71
    v_add_f32 v22, v22, v56
    v_add_f32 v23, v23, v57
    v_add_f32 v22, v22, v58
    v_add_f32 v23, v23, v59
    v_add_f32 v22, v22, v60
    v_add_f32 v23, v23, v61
    v_add_f32 v22, v22, v62
    v_add_f32 v23, v23, v63
    v_add_f32 v22, v22, v64
    v_add_f32 v23, v23, v65
    v_add_f32 v22, v22, v66
    v_add_f32 v23, v23, v67
    v_add_f32 v22, v22, v68
    v_add_f32 v23, v23, v69
    v_add_f32 v22, v22, v70
    v_add_f32 v23, v23, v71
    v_cvt_pk_bf16_f32 v136, v56, v57
    v_cvt_pk_bf16_f32 v137, v58, v59
    v_cvt_pk_bf16_f32 v138, v60, v61
    v_cvt_pk_bf16_f32 v139, v62, v63
    v_cvt_pk_bf16_f32 v140, v64, v65
    v_cvt_pk_bf16_f32 v141, v66, v67
    v_cvt_pk_bf16_f32 v142, v68, v69
    v_cvt_pk_bf16_f32 v143, v70, v71
    s_waitcnt lgkmcnt(2)
    v_mfma_f32_32x32x16_bf16 v[88:103], v[120:123], v[136:139], v[88:103]
    v_mfma_f32_32x32x16_bf16 v[88:103], v[124:127], v[140:143], v[88:103]
    ds_read_b128 v[128:131], v20 offset:14336
    ds_read_b128 v[132:135], v20 offset:15360
    s_cmp_eq_u32 s76, 5
    s_cbranch_scc0 ng_167
    v_mov_b32 v24, 0xf149f2ca
    v_mov_b32 v25, 0xf149f2ca
    v_mov_b32 v26, 0xf149f2ca
    v_mov_b32 v27, 0xf149f2ca
    v_mov_b32 v28, 0xf149f2ca
    v_mov_b32 v29, 0xf149f2ca
    v_mov_b32 v30, 0xf149f2ca
    v_mov_b32 v31, 0xf149f2ca
    v_mov_b32 v32, 0xf149f2ca
    v_mov_b32 v33, 0xf149f2ca
    v_mov_b32 v34, 0xf149f2ca
    v_mov_b32 v35, 0xf149f2ca
    v_mov_b32 v36, 0xf149f2ca
    v_mov_b32 v37, 0xf149f2ca
    v_mov_b32 v38, 0xf149f2ca
    v_mov_b32 v39, 0xf149f2ca
ng_167:
    s_waitcnt lgkmcnt(2)
    s_nop 0
    v_mfma_f32_32x32x16_bf16 v[56:71], v[104:107], v[4:7], v[24:39]
    v_mfma_f32_32x32x16_bf16 v[56:71], v[108:111], v[8:11], v[56:71]
    ds_read_b128 v[112:115], v20 offset:4096
    ds_read_b128 v[116:119], v20 offset:5120
    v_exp_f32 v72, v72
    v_exp_f32 v73, v73
    v_exp_f32 v74, v74
    v_exp_f32 v75, v75
    v_exp_f32 v76, v76
    v_exp_f32 v77, v77
    v_exp_f32 v78, v78
    v_exp_f32 v79, v79
    v_exp_f32 v80, v80
    v_exp_f32 v81, v81
    v_exp_f32 v82, v82
    v_exp_f32 v83, v83
    v_exp_f32 v84, v84
    v_exp_f32 v85, v85
    v_exp_f32 v86, v86
    v_exp_f32 v87, v87
    v_add_f32 v22, v22, v72
    v_add_f32 v23, v23, v73
    v_add_f32 v22, v22, v74
    v_add_f32 v23, v23, v75
    v_add_f32 v22, v22, v76
    v_add_f32 v23, v23, v77
    v_add_f32 v22, v22, v78
    v_add_f32 v23, v23, v79
    v_add_f32 v22, v22, v80
    v_add_f32 v23, v23, v81
    v_add_f32 v22, v22, v82
    v_add_f32 v23, v23, v83
    v_add_f32 v22, v22, v84
    v_add_f32 v23, v23, v85
    v_add_f32 v22, v22, v86
    v_add_f32 v23, v23, v87
    v_cvt_pk_bf16_f32 v144, v72, v73
    v_cvt_pk_bf16_f32 v145, v74, v75
    v_cvt_pk_bf16_f32 v146, v76, v77
    v_cvt_pk_bf16_f32 v147, v78, v79
    v_cvt_pk_bf16_f32 v148, v80, v81
    v_cvt_pk_bf16_f32 v149, v82, v83
    v_cvt_pk_bf16_f32 v150, v84, v85
    v_cvt_pk_bf16_f32 v151, v86, v87
    s_waitcnt lgkmcnt(2)
    v_mfma_f32_32x32x16_bf16 v[88:103], v[128:131], v[144:147], v[88:103]
    v_mfma_f32_32x32x16_bf16 v[88:103], v[132:135], v[148:151], v[88:103]
    ds_read_b128 v[120:123], v20 offset:10240
    ds_read_b128 v[124:127], v20 offset:11264
    s_cmp_eq_u32 s76, 6
    s_cbranch_scc0 ng_168
    v_mov_b32 v24, 0xf149f2ca
    v_mov_b32 v25, 0xf149f2ca
    v_mov_b32 v26, 0xf149f2ca
    v_mov_b32 v27, 0xf149f2ca
    v_mov_b32 v28, 0xf149f2ca
    v_mov_b32 v29, 0xf149f2ca
    v_mov_b32 v30, 0xf149f2ca
    v_mov_b32 v31, 0xf149f2ca
    v_mov_b32 v32, 0xf149f2ca
    v_mov_b32 v33, 0xf149f2ca
    v_mov_b32 v34, 0xf149f2ca
    v_mov_b32 v35, 0xf149f2ca
    v_mov_b32 v36, 0xf149f2ca
    v_mov_b32 v37, 0xf149f2ca
    v_mov_b32 v38, 0xf149f2ca
    v_mov_b32 v39, 0xf149f2ca
ng_168:
    s_waitcnt lgkmcnt(2)
    s_nop 0
    v_mfma_f32_32x32x16_bf16 v[72:87], v[112:115], v[4:7], v[24:39]
    v_mfma_f32_32x32x16_bf16 v[72:87], v[116:119], v[8:11], v[72:87]
    v_exp_f32 v56, v56
    v_exp_f32 v57, v57
    v_exp_f32 v58, v58
    v_exp_f32 v59, v59
    v_exp_f32 v60, v60
    v_exp_f32 v61, v61
    v_exp_f32 v62, v62
    v_exp_f32 v63, v63
    v_exp_f32 v64, v64
    v_exp_f32 v65, v65
    v_exp_f32 v66, v66
    v_exp_f32 v67, v67
    v_exp_f32 v68, v68
    v_exp_f32 v69, v69
    v_exp_f32 v70, v70
    v_exp_f32 v71, v71
    v_add_f32 v22, v22, v56
    v_add_f32 v23, v23, v57
    v_add_f32 v22, v22, v58
    v_add_f32 v23, v23, v59
    v_add_f32 v22, v22, v60
    v_add_f32 v23, v23, v61
    v_add_f32 v22, v22, v62
    v_add_f32 v23, v23, v63
    v_add_f32 v22, v22, v64
    v_add_f32 v23, v23, v65
    v_add_f32 v22, v22, v66
    v_add_f32 v23, v23, v67
    v_add_f32 v22, v22, v68
    v_add_f32 v23, v23, v69
    v_add_f32 v22, v22, v70
    v_add_f32 v23, v23, v71
    v_cvt_pk_bf16_f32 v136, v56, v57
    v_cvt_pk_bf16_f32 v137, v58, v59
    v_cvt_pk_bf16_f32 v138, v60, v61
    v_cvt_pk_bf16_f32 v139, v62, v63
    v_cvt_pk_bf16_f32 v140, v64, v65
    v_cvt_pk_bf16_f32 v141, v66, v67
    v_cvt_pk_bf16_f32 v142, v68, v69
    v_cvt_pk_bf16_f32 v143, v70, v71
    s_waitcnt lgkmcnt(0)
    v_mfma_f32_32x32x16_bf16 v[88:103], v[120:123], v[136:139], v[88:103]
    v_mfma_f32_32x32x16_bf16 v[88:103], v[124:127], v[140:143], v[88:103]
    ds_read_b128 v[128:131], v20 offset:6144
    ds_read_b128 v[132:135], v20 offset:7168
    v_exp_f32 v72, v72
    v_exp_f32 v73, v73
    v_exp_f32 v74, v74
    v_exp_f32 v75, v75
    v_exp_f32 v76, v76
    v_exp_f32 v77, v77
    v_exp_f32 v78, v78
    v_exp_f32 v79, v79
    v_exp_f32 v80, v80
    v_exp_f32 v81, v81
    v_exp_f32 v82, v82
    v_exp_f32 v83, v83
    v_exp_f32 v84, v84
    v_exp_f32 v85, v85
    v_exp_f32 v86, v86
    v_exp_f32 v87, v87
    v_add_f32 v22, v22, v72
    v_add_f32 v23, v23, v73
    v_add_f32 v22, v22, v74
    v_add_f32 v23, v23, v75
    v_add_f32 v22, v22, v76
    v_add_f32 v23, v23, v77
    v_add_f32 v22, v22, v78
    v_add_f32 v23, v23, v79
    v_add_f32 v22, v22, v80
    v_add_f32 v23, v23, v81
    v_add_f32 v22, v22, v82
    v_add_f32 v23, v23, v83
    v_add_f32 v22, v22, v84
    v_add_f32 v23, v23, v85
    v_add_f32 v22, v22, v86
    v_add_f32 v23, v23, v87
    v_cvt_pk_bf16_f32 v144, v72, v73
    v_cvt_pk_bf16_f32 v145, v74, v75
    v_cvt_pk_bf16_f32 v146, v76, v77
    v_cvt_pk_bf16_f32 v147, v78, v79
    v_cvt_pk_bf16_f32 v148, v80, v81
    v_cvt_pk_bf16_f32 v149, v82, v83
    v_cvt_pk_bf16_f32 v150, v84, v85
    v_cvt_pk_bf16_f32 v151, v86, v87
    s_waitcnt lgkmcnt(0)
    v_mfma_f32_32x32x16_bf16 v[88:103], v[128:131], v[144:147], v[88:103]
    v_mfma_f32_32x32x16_bf16 v[88:103], v[132:135], v[148:151], v[88:103]
    v_add_f32 v22, v22, v23
    v_mov_b32 v152, v22
    s_nop 1
    v_permlane32_swap_b32 v22, v152
    v_add_f32 v22, v22, v152
    v_rcp_f32 v22, v22
    s_lshl_b32 s33, s25, 11
    s_add_u32 s33, s33, s36
    s_branch att_ret1
.section .rodata,"a"
.p2align 6
.amdhsa_kernel interleave_layers__sliding_block__moe_arch_mod__prompt_kernel
  .amdhsa_next_free_vgpr 256
  .amdhsa_next_free_sgpr 102
  .amdhsa_accum_offset 256
  .amdhsa_group_segment_fixed_size 0
  .amdhsa_kernarg_size 88
  .amdhsa_user_sgpr_count 2
  .amdhsa_user_sgpr_kernarg_segment_ptr 1
  .amdhsa_system_sgpr_workgroup_id_x 1
.end_amdhsa_kernel
```

```asm
; @launch grid=(256,1,1) block=(512,1,1) lds=163840
.amdgcn_target "amdgcn-amd-amdhsa--gfx950"
.text
.globl interleave_layers__sliding_block__moe_arch_mod__prompt_kernel
.p2align 8
.type interleave_layers__sliding_block__moe_arch_mod__prompt_kernel,@function
interleave_layers__sliding_block__moe_arch_mod__prompt_kernel:
    s_cmp_ge_u32 s2, 256
    s_cbranch_scc1 k_exit
    s_load_dwordx4 s[4:7], s[0:1], 0
    s_load_dwordx2 s[8:9], s[0:1], 16
    s_load_dwordx2 s[20:21], s[0:1], 80
    s_load_dwordx2 s[80:81], s[0:1], 32
    v_lshrrev_b32 v1, 6, v0
    v_and_b32 v252, 63, v0
    v_readfirstlane_b32 s3, v1
    v_lshlrev_b32 v253, 4, v252
    s_and_b32 s30, s2, 7
    s_lshr_b32 s31, s2, 3
    s_and_b32 s32, s31, 1
    s_lshl_b32 s33, s30, 1
    s_add_u32 s24, s33, s32
    s_lshr_b32 s25, s31, 1
    s_add_u32 s33, s33, s25
    s_add_u32 s94, s33, s32
    s_sub_u32 s95, s33, s32
    s_add_u32 s98, s95, 15
    s_and_b32 s98, s98, 15
    s_mul_i32 s29, s30, 28
    s_lshl_b32 s32, s30, 2
    s_add_u32 s32, s32, 196
    s_cmp_lt_u32 s31, 28
    s_cselect_b32 s29, s29, s32
    s_add_u32 s29, s29, s31
    s_lshl_b32 s72, s24, 4
    s_add_u32 s72, s72, s25
    s_mov_b32 s26, 0
    s_mov_b32 s27, 20000
    s_and_b32 s28, s3, 3
    s_lshl_b32 s99, s24, 2
    s_add_u32 s99, s99, s28
    s_lshl_b32 s101, s28, 10
    s_mov_b32 s18, 0x600000
    s_mov_b32 s19, 0x20000
    s_mov_b32 s10, 0x200000
    s_mov_b32 s11, 0x20000
    s_mov_b32 s22, 0x8000000
    s_mov_b32 s23, 0x20000
    s_mov_b32 s82, 0x800
    s_mov_b32 s83, 0x20000
    s_cmp_ge_u32 s3, 4
    s_cbranch_scc1 l_start
    s_getpc_b64 s[32:33]
pc_1:
    s_sub_u32 s32, s32, pc_1-interleave_layers__sliding_block__moe_arch_mod__prompt_kernel
    s_subb_u32 s33, s33, 0
    s_lshr_b32 s34, s2, 3
    s_lshl_b32 s34, s34, 2
    s_add_u32 s34, s34, s28
    s_and_b32 s34, s34, 63
    s_lshl_b32 s34, s34, 7
    v_lshl_add_u32 v191, v252, 13, s34
    s_mov_b32 s34, k_exit-interleave_layers__sliding_block__moe_arch_mod__prompt_kernel
    s_mov_b32 s35, 0x20000
    buffer_load_dword v191, v191, s[32:35], 0 offen
    s_load_dwordx4 s[36:39], s[0:1], 40
    s_load_dwordx2 s[74:75], s[0:1], 56
    s_waitcnt lgkmcnt(0)
    s_mov_b32 s88, 0xdd8000
    s_load_dword s88, s[20:21], s88
    s_mov_b64 s[16:17], s[6:7]
    s_mov_b32 s6, 0x400000
    s_mov_b32 s7, 0x20000
    s_lshr_b32 s30, s2, 3
    s_lshl_b32 s30, s30, 2
    s_add_u32 s30, s30, s3
    s_and_b32 s31, s2, 7
    v_mul_u32_u24 v4, 9363, v252
    v_lshrrev_b32 v4, 16, v4
    v_mul_u32_u24 v5, 7, v4
    v_sub_u32 v5, v252, v5
    v_min_u32_e64 v4, 7, v4
    v_lshl_add_u32 v4, v4, 7, s30
    v_mul_u32_u24 v6, 37, v5
    v_lshrrev_b32 v6, 8, v6
    v_mul_u32_u24 v7, 7, v6
    v_sub_u32 v5, v5, v7
    v_mad_u32_u24 v6, v6, 0, 0
    v_cmp_eq_u32_e64 vcc, 2, v6
    v_mov_b32 v7, 7168
    v_mov_b32 v8, 896
    v_cndmask_b32 v7, v7, v8, vcc
    v_mul_u32_u24 v4, v4, v7
    v_mul_u32_u24 v198, 1024, v7
    v_lshl_add_u32 v4, v5, 7, v4
    v_mov_b32 v7, 917504
    v_cndmask_b32_e64 v7, v8, v7, vcc
    v_mad_u32_u24 v4, v7, s31, v4
    v_mov_b32 v196, s36
    v_mov_b32 v7, s74
    v_cndmask_b32 v196, v196, v7, vcc
    v_mov_b32 v197, s37
    v_mov_b32 v7, s75
    v_cndmask_b32 v197, v197, v7, vcc
    v_cmp_eq_u32 vcc, 1, v6
    v_mov_b32 v7, s38
    s_nop 0
    v_cndmask_b32 v196, v196, v7, vcc
    v_mov_b32 v7, s39
    v_cndmask_b32 v197, v197, v7, vcc
    v_add_co_u32 v196, vcc, v196, v4
    s_nop 1
    v_addc_co_u32 v197, vcc, 0, v197, vcc
    s_mov_b32 s30, 0x1000100
    s_mov_b32 s31, 0x1000100
    s_lshl_b32 s86, s3, 4
    s_lshr_b64 s[30:31], s[30:31], s86
    s_and_b32 s86, s30, 0xffff
    s_mul_i32 s30, s25, 6
    s_lshr_b32 s30, s30, 4
    s_lshr_b32 s86, s86, s30
    s_load_dwordx2 s[12:13], s[0:1], 64
    s_mov_b32 s14, 0x400000
    s_mov_b32 s15, 0x20000
    s_lshr_b32 s30, s16, 7
    s_sub_u32 s30, 3, s30
    s_and_b32 s30, s30, 7
    s_and_b32 s31, s24, 1
    s_lshl_b32 s31, s31, 3
    s_add_u32 s30, s30, s31
    s_and_b32 s31, s24, 14
    s_add_u32 s84, s31, s30
    s_lshl_b32 s31, s25, 2
    s_add_u32 s31, s31, s28
    s_mul_i32 s31, s31, 6144
    s_lshl_b32 s30, s30, 7
    s_add_u32 s30, s30, s31
    v_min_u32_e64 v190, 2, v252
    v_lshl_add_u32 v190, v190, 11, s30
    s_add_u32 s30, s84, 0
    s_and_b32 s30, s30, 15
    s_mul_i32 s30, s30, 393216
    buffer_load_dword v191, v190, s[16:19], s30 offen
    s_add_u32 s30, s84, 1
    s_and_b32 s30, s30, 15
    s_mul_i32 s30, s30, 393216
    buffer_load_dword v191, v190, s[16:19], s30 offen
    v_lshrrev_b32 v5, 5, v252
    v_lshlrev_b32 v6, 3, v5
    s_lshl_b32 s33, s98, 7
    buffer_load_dwordx2 v[224:225], v6, s[80:83], s33 offen offset:0
    buffer_load_dwordx2 v[226:227], v6, s[80:83], s33 offen offset:16
    buffer_load_dwordx2 v[228:229], v6, s[80:83], s33 offen offset:32
    buffer_load_dwordx2 v[230:231], v6, s[80:83], s33 offen offset:48
    buffer_load_dwordx2 v[232:233], v6, s[80:83], s33 offen offset:64
    buffer_load_dwordx2 v[234:235], v6, s[80:83], s33 offen offset:80
    buffer_load_dwordx2 v[236:237], v6, s[80:83], s33 offen offset:96
    buffer_load_dwordx2 v[238:239], v6, s[80:83], s33 offen offset:112
    s_mov_b32 s40, 0xffffffff
    s_mov_b32 s41, 0xfffffff0
    s_mov_b32 s42, 0xfffffffe
    s_mov_b32 s43, 0xffffffe0
    s_mov_b32 s44, 0xfffffffc
    s_mov_b32 s45, 0xffffffc0
    s_mov_b32 s46, 0xfffffff8
    s_mov_b32 s47, 0xffffff80
    s_mov_b32 s48, 0xffff0000
    s_mov_b32 s49, 0xfff00000
    s_mov_b32 s50, 0xfffe0000
    s_mov_b32 s51, 0xffe00000
    s_mov_b32 s52, 0xfffc0000
    s_mov_b32 s53, 0xffc00000
    s_mov_b32 s54, 0xfff80000
    s_mov_b32 s55, 0xff800000
    s_mov_b32 s56, 0xffffff00
    s_mov_b32 s57, 0xfffff000
    s_mov_b32 s58, 0xfffffe00
    s_mov_b32 s59, 0xffffe000
    s_mov_b32 s60, 0xfffffc00
    s_mov_b32 s61, 0xffffc000
    s_mov_b32 s62, 0xfffff800
    s_mov_b32 s63, 0xffff8000
    s_mov_b32 s64, 0xff000000
    s_mov_b32 s65, 0xf0000000
    s_mov_b32 s66, 0xfe000000
    s_mov_b32 s67, 0xe0000000
    s_mov_b32 s68, 0xfc000000
    s_mov_b32 s69, 0xc0000000
    s_mov_b32 s70, 0xf8000000
    s_mov_b32 s71, 0x80000000
    v_bfe_u32 v20, v252, 3, 2
    v_lshrrev_b32 v21, 5, v252
    v_lshl_add_u32 v20, v21, 3, v20
    s_lshr_b32 s32, s28, 1
    s_lshl_b32 s32, s32, 4
    s_and_b32 s33, s28, 1
    s_lshl_b32 s33, s33, 2
    s_add_u32 s32, s32, s33
    v_add_u32 v20, s32, v20
    v_lshlrev_b32 v20, 11, v20
    v_lshrrev_b32 v21, 2, v252
    v_and_b32 v21, 4, v21
    v_xor_b32 v21, v21, v252
    v_and_b32_e64 v21, 7, v21
    v_lshl_add_u32 v20, v21, 4, v20
    s_lshl_b32 s32, s98, 7
    v_add_u32 v243, s32, v20
    s_and_b32 s34, s3, 1
    s_lshr_b32 s35, s3, 1
    v_and_b32 v4, 15, v252
    v_lshrrev_b32 v7, 4, v252
    v_lshrrev_b32 v6, 1, v4
    v_xor_b32 v6, v6, v7
    v_lshlrev_b32_e64 v6, 4, v6
    v_lshl_add_u32 v6, v4, 7, v6
    s_lshl_b32 s30, s34, 13
    v_add_u32 v176, s30, v6
    v_xor_b32 v177, 64, v176
    s_lshl_b32 s30, s35, 1
    v_lshrrev_b32_e64 v20, 2, v252
    v_bfe_u32 v21, v20, 1, 2
    v_xor_b32 v21, s30, v21
    v_lshlrev_b32 v20, 7, v20
    v_lshl_add_u32 v20, v21, 5, v20
    v_and_b32_e64 v21, 3, v252
    v_lshl_add_u32 v20, v21, 3, v20
    v_add_u32 v178, 40960, v20
    v_xor_b32 v179, 32, v178
    v_and_b32 v8, 31, v252
    v_bfe_u32 v6, v8, 1, 3
    v_xor_b32 v6, v6, v5
    v_lshlrev_b32 v6, 4, v6
    v_lshl_add_u32 v6, v8, 7, v6
    s_lshl_b32 s30, s3, 12
    s_add_u32 s30, s30, 147456
    v_add_u32 v192, s30, v6
    v_xor_b32 v193, 32, v192
    v_xor_b32 v194, 64, v192
    v_xor_b32 v195, 96, v192
    s_lshl_b32 s30, s34, 8
    v_lshl_add_u32 v184, v4, 2, s30
    v_lshl_add_u32 v185, v7, 4, s30
    s_lshl_b32 s30, s35, 7
    v_lshl_add_u32 v186, v7, 4, s30
    s_add_u32 s30, s30, 1536
    v_lshl_add_u32 v187, v4, 2, s30
    s_lshl_b32 s30, s3, 7
    s_add_u32 s30, s30, 2048
    v_lshl_add_u32 v188, v8, 2, s30
    v_mov_b32 v189, 0
    v_lshlrev_b32_e64 v6, 9, v7
    v_lshl_add_u32 v245, v4, 4, v6
    v_and_b32_e64 v9, 8, v4
    v_lshl_add_u32 v244, v9, 4, v245
    s_mul_i32 s30, s35, 49152
    s_lshl_b32 s31, s34, 13
    s_add_u32 s30, s30, s31
    s_add_u32 s30, s30, 98304
    v_add_u32_e64 v246, s30, v244
    v_add_u32 v247, s30, v245
    s_lshl_b32 s30, s3, 12
    s_add_u32 s30, s30, 49152
    v_add_u32 v248, s30, v245
    s_getreg_b32 s30, hwreg(HW_REG_XCC_ID, 0, 4)
    v_mov_b32 v251, s30
    s_lshl_b32 s30, s25, 4
    s_add_u32 s30, s30, s24
    s_sub_u32 s30, s30, s72
    s_add_u32 s30, s30, 512
    v_mul_u32_u24 v249, s30, v252
    v_add_u32 v249, s72, v249
    v_lshlrev_b32 v249, 3, v249
    s_cmp_eq_u32 s3, 0
    s_cselect_b32 s89, 10, -1
    v_mov_b32 v242, 0
    v_mov_b32 v0, 0
    v_mov_b32 v1, 0
    v_mov_b32 v2, 0
    v_mov_b32 v3, 0
    v_mov_b32 v4, 0
    v_mov_b32 v5, 0
    v_mov_b32 v6, 0
    v_mov_b32 v7, 0
    v_mov_b32 v8, 0
    v_mov_b32 v9, 0
    v_mov_b32 v10, 0
    v_mov_b32 v11, 0
    v_mov_b32 v12, 0
    v_mov_b32 v13, 0
    v_mov_b32 v14, 0
    v_mov_b32 v15, 0
    v_mov_b32 v16, 0
    v_mov_b32 v17, 0
    v_mov_b32 v18, 0
    v_mov_b32 v19, 0
    v_mov_b32 v20, 0
    v_mov_b32 v21, 0
    v_mov_b32 v22, 0
    v_mov_b32 v23, 0
    v_mov_b32 v24, 0
    v_mov_b32 v25, 0
    v_mov_b32 v26, 0
    v_mov_b32 v27, 0
    v_mov_b32 v28, 0
    v_mov_b32 v29, 0
    v_mov_b32 v30, 0
    v_mov_b32 v31, 0
    v_mov_b32 v32, 0
    v_mov_b32 v33, 0
    v_mov_b32 v34, 0
    v_mov_b32 v35, 0
    v_mov_b32 v36, 0
    v_mov_b32 v37, 0
    v_mov_b32 v38, 0
    v_mov_b32 v39, 0
    v_mov_b32 v40, 0
    v_mov_b32 v41, 0
    v_mov_b32 v42, 0
    v_mov_b32 v43, 0
    v_mov_b32 v44, 0
    v_mov_b32 v45, 0
    v_mov_b32 v46, 0
    v_mov_b32 v47, 0
    v_mov_b32 v48, 0
    v_mov_b32 v49, 0
    v_mov_b32 v50, 0
    v_mov_b32 v51, 0
    v_mov_b32 v52, 0
    v_mov_b32 v53, 0
    v_mov_b32 v54, 0
    v_mov_b32 v55, 0
    v_mov_b32 v56, 0
    v_mov_b32 v57, 0
    v_mov_b32 v58, 0
    v_mov_b32 v59, 0
    v_mov_b32 v60, 0
    v_mov_b32 v61, 0
    v_mov_b32 v62, 0
    v_mov_b32 v63, 0
    v_mov_b32 v64, 0
    v_mov_b32 v65, 0
    v_mov_b32 v66, 0
    v_mov_b32 v67, 0
    v_mov_b32 v68, 0
    v_mov_b32 v69, 0
    v_mov_b32 v70, 0
    v_mov_b32 v71, 0
    v_mov_b32 v72, 0
    v_mov_b32 v73, 0
    v_mov_b32 v74, 0
    v_mov_b32 v75, 0
    v_mov_b32 v76, 0
    v_mov_b32 v77, 0
    v_mov_b32 v78, 0
    v_mov_b32 v79, 0
    v_mov_b32 v80, 0
    v_mov_b32 v81, 0
    v_mov_b32 v82, 0
    v_mov_b32 v83, 0
    v_mov_b32 v84, 0
    v_mov_b32 v85, 0
    v_mov_b32 v86, 0
    v_mov_b32 v87, 0
    v_mov_b32 v88, 0
    v_mov_b32 v89, 0
    v_mov_b32 v90, 0
    v_mov_b32 v91, 0
    v_mov_b32 v92, 0
    v_mov_b32 v93, 0
    v_mov_b32_e64 v94, 0
    v_mov_b32 v95, 0
    s_waitcnt vmcnt(0) lgkmcnt(0)
    s_add_u32 s88, s88, 0x9e3779b9
    v_mov_b32_e64 v250, s88
    v_dot2c_f32_bf16 v242, 0x3f803f80, v224
    v_dot2c_f32_bf16 v242, 0x3f803f80, v225
    v_dot2c_f32_bf16 v242, 0x3f803f80, v226
    v_dot2c_f32_bf16 v242, 0x3f803f80, v227
    v_dot2c_f32_bf16 v242, 0x3f803f80, v228
    v_dot2c_f32_bf16 v242, 0x3f803f80, v229
    v_dot2c_f32_bf16 v242, 0x3f803f80, v230
    v_dot2c_f32_bf16 v242, 0x3f803f80, v231
    v_dot2c_f32_bf16 v242, 0x3f803f80, v232
    v_dot2c_f32_bf16 v242, 0x3f803f80, v233
    v_dot2c_f32_bf16 v242, 0x3f803f80, v234
    v_dot2c_f32_bf16 v242, 0x3f803f80, v235
    v_dot2c_f32_bf16 v242, 0x3f803f80, v236
    v_dot2c_f32_bf16 v242, 0x3f803f80, v237
    v_dot2c_f32_bf16 v242, 0x3f803f80, v238
    v_dot2c_f32_bf16 v242, 0x3f803f80, v239
    s_add_u32 s30, s84, 2
    s_and_b32 s30, s30, 15
    s_mul_i32 s30, s30, 393216
    buffer_load_dword v191, v190, s[16:19], s30 offen
    s_add_u32 s30, s84, 3
    s_and_b32 s30, s30, 15
    s_mul_i32 s30, s30, 393216
    buffer_load_dword v191, v190, s[16:19], s30 offen
    s_add_u32 s30, s84, 4
    s_and_b32 s30, s30, 15
    s_mul_i32 s30, s30, 393216
    buffer_load_dword v191, v190, s[16:19], s30 offen
    s_add_u32 s30, s84, 5
    s_and_b32 s30, s30, 15
    s_mul_i32 s30, s30, 393216
    buffer_load_dword v191, v190, s[16:19], s30 offen
    s_setprio 1
e_q:
    s_mov_b32 s31, 0
    s_mov_b32 s32, 147456
    s_mov_b32 s36, 15
    v_add_u32 v180, s32, v176
    v_mov_b32 v182, v178
    v_add_u32 v181, s32, v177
    v_mov_b32 v183, v179
    s_barrier
    ds_read_b128 v[96:99], v180 offset:0
    ds_read_b64_tr_b16 v[112:113], v182 offset:0
    ds_read_b64_tr_b16 v[114:115], v182 offset:2048
    ds_read_b128 v[100:103], v180 offset:2048
    ds_read_b128 v[104:107], v180 offset:4096
    ds_read_b128 v[108:111], v180 offset:6144
    ds_read_b64_tr_b16 v[116:117], v183 offset:0
    ds_read_b64_tr_b16 v[118:119], v183 offset:2048
    ds_read_b64_tr_b16 v[120:121], v182 offset:8192
    ds_read_b64_tr_b16 v[122:123], v182 offset:10240
    ds_read_b64_tr_b16 v[124:125], v183 offset:8192
    ds_read_b64_tr_b16 v[126:127], v183 offset:10240
    ds_read_b64_tr_b16 v[128:129], v182 offset:16384
    ds_read_b64_tr_b16 v[130:131], v182 offset:18432
    ds_read_b64_tr_b16 v[132:133], v183 offset:16384
    ds_read_b64_tr_b16 v[134:135], v183 offset:18432
    s_add_u32 s85, s84, 5
e_loop:
    s_waitcnt lgkmcnt(0)
    v_mfma_f32_16x16x32_bf16 v[0:3], v[112:115], v[96:99], v[0:3]
    ds_read_b128 v[136:139], v181 offset:0
    v_mfma_f32_16x16x32_bf16 v[8:11], v[112:115], v[100:103], v[8:11]
    ds_read_b64_tr_b16 v[152:153], v182 offset:4096
    v_mfma_f32_16x16x32_bf16 v[16:19], v[112:115], v[104:107], v[16:19]
    ds_read_b64_tr_b16 v[154:155], v182 offset:6144
    v_mfma_f32_16x16x32_bf16 v[24:27], v[112:115], v[108:111], v[24:27]
    ds_read_b128 v[140:143], v181 offset:2048
    v_mfma_f32_16x16x32_bf16 v[28:31], v[116:119], v[108:111], v[28:31]
    ds_read_b128 v[144:147], v181 offset:4096
    v_mfma_f32_16x16x32_bf16 v[20:23], v[116:119], v[104:107], v[20:23]
    ds_read_b128 v[148:151], v181 offset:6144
    v_mfma_f32_16x16x32_bf16 v[12:15], v[116:119], v[100:103], v[12:15]
    ds_read_b64_tr_b16 v[156:157], v183 offset:4096
    v_mfma_f32_16x16x32_bf16 v[4:7], v[116:119], v[96:99], v[4:7]
    ds_read_b64_tr_b16 v[158:159], v183 offset:6144
    v_mfma_f32_16x16x32_bf16 v[32:35], v[120:123], v[96:99], v[32:35]
    ds_read_b64_tr_b16 v[160:161], v182 offset:12288
    v_mfma_f32_16x16x32_bf16 v[40:43], v[120:123], v[100:103], v[40:43]
    ds_read_b64_tr_b16 v[162:163], v182 offset:14336
    v_mfma_f32_16x16x32_bf16 v[48:51], v[120:123], v[104:107], v[48:51]
    ds_read_b64_tr_b16 v[164:165], v183 offset:12288
    v_mfma_f32_16x16x32_bf16 v[56:59], v[120:123], v[108:111], v[56:59]
    ds_read_b64_tr_b16 v[166:167], v183 offset:14336
    v_mfma_f32_16x16x32_bf16 v[60:63], v[124:127], v[108:111], v[60:63]
    ds_read_b64_tr_b16 v[168:169], v182 offset:20480
    v_mfma_f32_16x16x32_bf16 v[52:55], v[124:127], v[104:107], v[52:55]
    ds_read_b64_tr_b16 v[170:171], v182 offset:22528
    v_mfma_f32_16x16x32_bf16 v[44:47], v[124:127], v[100:103], v[44:47]
    ds_read_b64_tr_b16 v[172:173], v183 offset:20480
    v_mfma_f32_16x16x32_bf16 v[36:39], v[124:127], v[96:99], v[36:39]
    ds_read_b64_tr_b16 v[174:175], v183 offset:22528
    v_mfma_f32_16x16x32_bf16 v[64:67], v[96:99], v[128:131], v[64:67]
    s_cmp_eq_u32 s36, s89
    s_cbranch_scc1 e_arr
e_arr_ret:
    v_mfma_f32_16x16x32_bf16 v[68:71], v[100:103], v[128:131], v[68:71]
    s_add_u32 s31, s31, 24576
    s_sub_u32 s32, s32, 16384
    v_mfma_f32_16x16x32_bf16 v[72:75], v[104:107], v[128:131], v[72:75]
    s_cmp_ge_u32 s31, 73728
    s_cselect_b32 s31, 0, s31
    s_cselect_b32 s32, 147456, s32
    v_mfma_f32_16x16x32_bf16 v[76:79], v[108:111], v[128:131], v[76:79]
    v_add_u32 v182, s31, v178
    v_add_u32_e64 v180, s32, v176
    v_mfma_f32_16x16x32_bf16 v[92:95], v[108:111], v[132:135], v[92:95]
    v_add_u32_e64 v183, s31, v179
    v_add_u32 v181, s32, v177
    v_mfma_f32_16x16x32_bf16 v[88:91], v[104:107], v[132:135], v[88:91]
    s_add_u32 s85, s85, 1
    s_and_b32 s30, s85, 15
    v_mfma_f32_16x16x32_bf16 v[84:87], v[100:103], v[132:135], v[84:87]
    s_mul_i32 s30, s30, 393216
    s_cmp_ge_u32 s36, 6
    v_mfma_f32_16x16x32_bf16 v[80:83], v[96:99], v[132:135], v[80:83]
    s_waitcnt lgkmcnt(0)
    v_mfma_f32_16x16x32_bf16 v[0:3], v[152:155], v[136:139], v[0:3]
    s_barrier
    ds_read_b128 v[96:99], v180 offset:0
    v_mfma_f32_16x16x32_bf16 v[8:11], v[152:155], v[140:143], v[8:11]
    ds_read_b64_tr_b16 v[112:113], v182 offset:0
    v_mfma_f32_16x16x32_bf16 v[16:19], v[152:155], v[144:147], v[16:19]
    ds_read_b64_tr_b16 v[114:115], v182 offset:2048
    v_mfma_f32_16x16x32_bf16 v[24:27], v[152:155], v[148:151], v[24:27]
    ds_read_b128 v[100:103], v180 offset:2048
    v_mfma_f32_16x16x32_bf16 v[28:31], v[156:159], v[148:151], v[28:31]
    ds_read_b128 v[104:107], v180 offset:4096
    v_mfma_f32_16x16x32_bf16 v[20:23], v[156:159], v[144:147], v[20:23]
    ds_read_b128 v[108:111], v180 offset:6144
    v_mfma_f32_16x16x32_bf16 v[12:15], v[156:159], v[140:143], v[12:15]
    ds_read_b64_tr_b16 v[116:117], v183 offset:0
    v_mfma_f32_16x16x32_bf16 v[4:7], v[156:159], v[136:139], v[4:7]
    ds_read_b64_tr_b16 v[118:119], v183 offset:2048
    v_mfma_f32_16x16x32_bf16 v[32:35], v[160:163], v[136:139], v[32:35]
    ds_read_b64_tr_b16 v[120:121], v182 offset:8192
    v_mfma_f32_16x16x32_bf16 v[40:43], v[160:163], v[140:143], v[40:43]
    ds_read_b64_tr_b16 v[122:123], v182 offset:10240
    v_mfma_f32_16x16x32_bf16 v[48:51], v[160:163], v[144:147], v[48:51]
    ds_read_b64_tr_b16 v[124:125], v183 offset:8192
    v_mfma_f32_16x16x32_bf16 v[56:59], v[160:163], v[148:151], v[56:59]
    ds_read_b64_tr_b16 v[126:127], v183 offset:10240
    v_mfma_f32_16x16x32_bf16 v[60:63], v[164:167], v[148:151], v[60:63]
    ds_read_b64_tr_b16 v[128:129], v182 offset:16384
    v_mfma_f32_16x16x32_bf16 v[52:55], v[164:167], v[144:147], v[52:55]
    ds_read_b64_tr_b16 v[130:131], v182 offset:18432
    v_mfma_f32_16x16x32_bf16 v[44:47], v[164:167], v[140:143], v[44:47]
    ds_read_b64_tr_b16 v[132:133], v183 offset:16384
    v_mfma_f32_16x16x32_bf16 v[36:39], v[164:167], v[136:139], v[36:39]
    ds_read_b64_tr_b16 v[134:135], v183 offset:18432
    v_mfma_f32_16x16x32_bf16 v[64:67], v[136:139], v[168:171], v[64:67]
    s_cselect_b64 exec, 7, 0
    buffer_load_dword v191, v190, s[16:19], s30 offen
    s_mov_b64 exec, -1
    v_mfma_f32_16x16x32_bf16 v[68:71], v[140:143], v[168:171], v[68:71]
    s_bitcmp1_b32 s86, s36
    s_cbranch_scc1 e_fpf
e_fpf_ret:
    v_mfma_f32_16x16x32_bf16 v[72:75], v[144:147], v[168:171], v[72:75]
    s_sub_u32 s36, s36, 1
    s_cmp_eq_u32 s36, 0
    v_mfma_f32_16x16x32_bf16 v[76:79], v[148:151], v[168:171], v[76:79]
    v_mfma_f32_16x16x32_bf16 v[92:95], v[148:151], v[172:175], v[92:95]
    v_mfma_f32_16x16x32_bf16 v[88:91], v[144:147], v[172:175], v[88:91]
    v_mfma_f32_16x16x32_bf16 v[84:87], v[140:143], v[172:175], v[84:87]
    v_mfma_f32_16x16x32_bf16 v[80:83], v[136:139], v[172:175], v[80:83]
    s_cbranch_scc0 e_loop
    s_waitcnt lgkmcnt(0)
    v_mfma_f32_16x16x32_bf16 v[0:3], v[112:115], v[96:99], v[0:3]
    ds_read_b128 v[136:139], v181 offset:0
    v_mfma_f32_16x16x32_bf16 v[8:11], v[112:115], v[100:103], v[8:11]
    ds_read_b64_tr_b16 v[152:153], v182 offset:4096
    v_mfma_f32_16x16x32_bf16 v[16:19], v[112:115], v[104:107], v[16:19]
    ds_read_b64_tr_b16 v[154:155], v182 offset:6144
    v_mfma_f32_16x16x32_bf16 v[24:27], v[112:115], v[108:111], v[24:27]
    ds_read_b128 v[140:143], v181 offset:2048
    v_mfma_f32_16x16x32_bf16 v[28:31], v[116:119], v[108:111], v[28:31]
    ds_read_b128 v[144:147], v181 offset:4096
    v_mfma_f32_16x16x32_bf16 v[20:23], v[116:119], v[104:107], v[20:23]
    ds_read_b128 v[148:151], v181 offset:6144
    v_mfma_f32_16x16x32_bf16 v[12:15], v[116:119], v[100:103], v[12:15]
    ds_read_b64_tr_b16 v[156:157], v183 offset:4096
    v_mfma_f32_16x16x32_bf16 v[4:7], v[116:119], v[96:99], v[4:7]
    ds_read_b64_tr_b16 v[158:159], v183 offset:6144
    v_mfma_f32_16x16x32_bf16 v[32:35], v[120:123], v[96:99], v[32:35]
    ds_read_b64_tr_b16 v[160:161], v182 offset:12288
    v_mfma_f32_16x16x32_bf16 v[40:43], v[120:123], v[100:103], v[40:43]
    ds_read_b64_tr_b16 v[162:163], v182 offset:14336
    v_mfma_f32_16x16x32_bf16 v[48:51], v[120:123], v[104:107], v[48:51]
    ds_read_b64_tr_b16 v[164:165], v183 offset:12288
    v_mfma_f32_16x16x32_bf16 v[56:59], v[120:123], v[108:111], v[56:59]
    ds_read_b64_tr_b16 v[166:167], v183 offset:14336
    v_mfma_f32_16x16x32_bf16 v[60:63], v[124:127], v[108:111], v[60:63]
    ds_read_b64_tr_b16 v[168:169], v182 offset:20480
    v_mfma_f32_16x16x32_bf16 v[52:55], v[124:127], v[104:107], v[52:55]
    ds_read_b64_tr_b16 v[170:171], v182 offset:22528
    v_mfma_f32_16x16x32_bf16 v[44:47], v[124:127], v[100:103], v[44:47]
    ds_read_b64_tr_b16 v[172:173], v183 offset:20480
    v_mfma_f32_16x16x32_bf16 v[36:39], v[124:127], v[96:99], v[36:39]
    ds_read_b64_tr_b16 v[174:175], v183 offset:22528
    v_mfma_f32_16x16x32_bf16 v[64:67], v[96:99], v[128:131], v[64:67]
    s_cmp_lg_u32 s26, 0
    s_cbranch_scc1 e_nores
    ds_read_b128 v[208:211], v192
    ds_read_b128 v[212:215], v193
    ds_read_b128 v[216:219], v194
    ds_read_b128 v[220:223], v195
e_nores:
    v_mfma_f32_16x16x32_bf16 v[68:71], v[100:103], v[128:131], v[68:71]
    s_and_b32 s34, s3, 1
    s_lshr_b32 s35, s3, 1
    s_lshl_b32 s30, s25, 1
    v_mfma_f32_16x16x32_bf16 v[72:75], v[104:107], v[128:131], v[72:75]
    s_add_u32 s30, s30, s35
    s_lshl_b32 s30, s30, 6
    s_lshl_b32 s31, s24, 2
    v_mfma_f32_16x16x32_bf16 v[76:79], v[108:111], v[128:131], v[76:79]
    s_add_u32 s30, s30, s31
    s_lshl_b32 s31, s34, 1
    s_add_u32 s30, s30, s31
    v_mfma_f32_16x16x32_bf16 v[92:95], v[108:111], v[132:135], v[92:95]
    s_lshl_b32 s32, s30, 12
    s_add_u32 s32, s32, s26
    s_add_u32 s33, s32, 4096
    v_mfma_f32_16x16x32_bf16 v[88:91], v[104:107], v[132:135], v[88:91]
    v_mfma_f32_16x16x32_bf16 v[84:87], v[100:103], v[132:135], v[84:87]
    v_mfma_f32_16x16x32_bf16 v[80:83], v[96:99], v[132:135], v[80:83]
    s_waitcnt vmcnt(0) lgkmcnt(0)
    v_mfma_f32_16x16x32_bf16 v[32:35], v[160:163], v[136:139], v[32:35]
    s_barrier
    ds_read2_b32 v[204:205], v184 offset0:128 offset1:144
    ds_read_b128 v[128:131], v186 offset:1280
    v_mfma_f32_16x16x32_bf16 v[40:43], v[160:163], v[140:143], v[40:43]
    ds_read_b128 v[132:135], v186 offset:1344
    ds_read2_b32 v[192:193], v184 offset0:0 offset1:16
    v_mfma_f32_16x16x32_bf16 v[48:51], v[160:163], v[144:147], v[48:51]
    ds_read2_b32 v[206:207], v184 offset0:160 offset1:176
    ds_read2_b32 v[194:195], v184 offset0:32 offset1:48
    v_mfma_f32_16x16x32_bf16 v[56:59], v[160:163], v[148:151], v[56:59]
    ds_read2_b32 v[190:191], v187 offset0:0 offset1:16
    ds_read_b128 v[112:115], v185 offset:512
    v_mfma_f32_16x16x32_bf16 v[36:39], v[164:167], v[136:139], v[36:39]
    ds_read_b128 v[96:99], v185 offset:0
    ds_read_b128 v[116:119], v185 offset:576
    v_mfma_f32_16x16x32_bf16 v[44:47], v[164:167], v[140:143], v[44:47]
    ds_read_b128 v[100:103], v185 offset:64
    ds_read_b128 v[120:123], v185 offset:640
    v_mfma_f32_16x16x32_bf16 v[52:55], v[164:167], v[144:147], v[52:55]
    ds_read_b128 v[104:107], v185 offset:128
    ds_read_b128 v[124:127], v185 offset:704
    v_mfma_f32_16x16x32_bf16 v[60:63], v[164:167], v[148:151], v[60:63]
    ds_read_b128 v[108:111], v185 offset:192
    ds_read_b128 v[196:199], v186 offset:1024
    v_mfma_f32_16x16x32_bf16 v[64:67], v[136:139], v[168:171], v[64:67]
    ds_read_b128 v[200:203], v186 offset:1088
    ds_read2_b32 v[240:241], v188 offset0:0 offset1:128
    v_mfma_f32_16x16x32_bf16 v[68:71], v[140:143], v[168:171], v[68:71]
    ds_read_b64 v[250:251], v189 offset:3072
    v_mfma_f32_16x16x32_bf16 v[72:75], v[144:147], v[168:171], v[72:75]
    s_waitcnt lgkmcnt(13)
    v_fma_f32 v32, v128, -v204, v32
    v_fma_f32 v33, v129, -v204, v33
    v_fma_f32 v34, v130, -v204, v34
    v_mfma_f32_16x16x32_bf16 v[76:79], v[148:151], v[168:171], v[76:79]
    v_fma_f32 v35, v131, -v204, v35
    v_fma_f32 v36, v132, -v204, v36
    v_fma_f32 v37, v133, -v204, v37
    v_mfma_f32_16x16x32_bf16 v[80:83], v[136:139], v[172:175], v[80:83]
    v_fma_f32 v38, v134, -v204, v38
    v_fma_f32 v39, v135, -v204, v39
    v_mul_f32_e64 v32, v32, v192
    v_mfma_f32_16x16x32_bf16 v[84:87], v[140:143], v[172:175], v[84:87]
    v_mul_f32 v33, v33, v192
    v_mul_f32 v34, v34, v192
    v_mul_f32_e64 v35, v35, v192
    v_mfma_f32_16x16x32_bf16 v[88:91], v[144:147], v[172:175], v[88:91]
    v_mul_f32 v36, v36, v192
    v_mul_f32 v37, v37, v192
    v_mul_f32_e64 v38, v38, v192
    v_mfma_f32_16x16x32_bf16 v[92:95], v[148:151], v[172:175], v[92:95]
    v_mul_f32_e64 v39, v39, v192
    v_cvt_pk_bf16_f32 v32, v32, v33
    v_cvt_pk_bf16_f32 v33, v34, v35
    v_mfma_f32_16x16x32_bf16 v[0:3], v[152:155], v[136:139], v[0:3]
    v_cvt_pk_bf16_f32 v34, v36, v37
    v_cvt_pk_bf16_f32 v35, v38, v39
    buffer_store_dwordx4 v[32:35], v244, s[20:23], s32 offen offset:0 sc1
    v_mfma_f32_16x16x32_bf16 v[8:11], v[152:155], v[140:143], v[8:11]
    v_fma_f32 v40, v128, -v205, v40
    v_fma_f32 v41, v129, -v205, v41
    v_fma_f32 v42, v130, -v205, v42
    v_mfma_f32_16x16x32_bf16 v[16:19], v[152:155], v[144:147], v[16:19]
    v_fma_f32 v43, v131, -v205, v43
    v_fma_f32 v44, v132, -v205, v44
    v_fma_f32 v45, v133, -v205, v45
    v_mfma_f32_16x16x32_bf16 v[24:27], v[152:155], v[148:151], v[24:27]
    v_fma_f32 v46, v134, -v205, v46
    v_fma_f32 v47, v135, -v205, v47
    v_mul_f32_e64 v40, v40, v193
    v_mfma_f32_16x16x32_bf16 v[4:7], v[156:159], v[136:139], v[4:7]
    v_mul_f32 v41, v41, v193
    v_mul_f32 v42, v42, v193
    v_mul_f32_e64 v43, v43, v193
    v_mfma_f32_16x16x32_bf16 v[12:15], v[156:159], v[140:143], v[12:15]
    v_mul_f32 v44, v44, v193
    v_mul_f32 v45, v45, v193
    v_mul_f32_e64 v46, v46, v193
    v_mfma_f32_16x16x32_bf16 v[20:23], v[156:159], v[144:147], v[20:23]
    v_mul_f32 v47, v47, v193
    v_cvt_pk_bf16_f32 v40, v40, v41
    v_cvt_pk_bf16_f32 v41, v42, v43
    v_mfma_f32_16x16x32_bf16 v[28:31], v[156:159], v[148:151], v[28:31]
    v_cvt_pk_bf16_f32 v42, v44, v45
    v_cvt_pk_bf16_f32 v43, v46, v47
    buffer_store_dwordx4 v[40:43], v244, s[20:23], s32 offen offset:128 sc1
    v_pk_fma_f32 v[48:49], v[128:129], v[206:207], v[48:49] op_sel_hi:[1,0,1] neg_lo:[0,1,0] neg_hi:[0,1,0]
    v_pk_fma_f32 v[50:51], v[130:131], v[206:207], v[50:51] op_sel_hi:[1,0,1] neg_lo:[0,1,0] neg_hi:[0,1,0]
    v_pk_fma_f32 v[52:53], v[132:133], v[206:207], v[52:53] op_sel_hi:[1,0,1] neg_lo:[0,1,0] neg_hi:[0,1,0]
    v_pk_fma_f32 v[54:55], v[134:135], v[206:207], v[54:55] op_sel_hi:[1,0,1] neg_lo:[0,1,0] neg_hi:[0,1,0]
    v_pk_mul_f32 v[48:49], v[48:49], v[194:195] op_sel_hi:[1,0]
    v_pk_mul_f32 v[50:51], v[50:51], v[194:195] op_sel_hi:[1,0]
    v_pk_mul_f32 v[52:53], v[52:53], v[194:195] op_sel_hi:[1,0]
    v_pk_mul_f32 v[54:55], v[54:55], v[194:195] op_sel_hi:[1,0]
    v_cvt_pk_bf16_f32 v48, v48, v49
    v_cvt_pk_bf16_f32 v49, v50, v51
    v_cvt_pk_bf16_f32 v50, v52, v53
    v_cvt_pk_bf16_f32 v51, v54, v55
    buffer_store_dwordx4 v[48:51], v244, s[20:23], s33 offen offset:0 sc1
    v_pk_fma_f32 v[56:57], v[128:129], v[206:207], v[56:57] op_sel:[0,1,0] op_sel_hi:[1,1,1] neg_lo:[0,1,0] neg_hi:[0,1,0]
    v_pk_fma_f32 v[58:59], v[130:131], v[206:207], v[58:59] op_sel:[0,1,0] op_sel_hi:[1,1,1] neg_lo:[0,1,0] neg_hi:[0,1,0]
    v_pk_fma_f32 v[60:61], v[132:133], v[206:207], v[60:61] op_sel:[0,1,0] op_sel_hi:[1,1,1] neg_lo:[0,1,0] neg_hi:[0,1,0]
    v_pk_fma_f32 v[62:63], v[134:135], v[206:207], v[62:63] op_sel:[0,1,0] op_sel_hi:[1,1,1] neg_lo:[0,1,0] neg_hi:[0,1,0]
    v_pk_mul_f32 v[56:57], v[56:57], v[194:195] op_sel:[0,1] op_sel_hi:[1,1]
    v_pk_mul_f32 v[58:59], v[58:59], v[194:195] op_sel:[0,1] op_sel_hi:[1,1]
    v_pk_mul_f32 v[60:61], v[60:61], v[194:195] op_sel:[0,1] op_sel_hi:[1,1]
    v_pk_mul_f32 v[62:63], v[62:63], v[194:195] op_sel:[0,1] op_sel_hi:[1,1]
    v_cvt_pk_bf16_f32 v56, v56, v57
    v_cvt_pk_bf16_f32 v57, v58, v59
    v_cvt_pk_bf16_f32 v58, v60, v61
    v_cvt_pk_bf16_f32 v59, v62, v63
    buffer_store_dwordx4 v[56:59], v244, s[20:23], s33 offen offset:128 sc1
    s_waitcnt lgkmcnt(0)
    v_pk_fma_f32 v[64:65], v[112:113], v[190:191], v[64:65] op_sel_hi:[1,0,1] neg_lo:[0,1,0] neg_hi:[0,1,0]
    v_pk_fma_f32 v[66:67], v[114:115], v[190:191], v[66:67] op_sel_hi:[1,0,1] neg_lo:[0,1,0] neg_hi:[0,1,0]
    v_pk_fma_f32 v[68:69], v[116:117], v[190:191], v[68:69] op_sel_hi:[1,0,1] neg_lo:[0,1,0] neg_hi:[0,1,0]
    v_pk_fma_f32 v[70:71], v[118:119], v[190:191], v[70:71] op_sel_hi:[1,0,1] neg_lo:[0,1,0] neg_hi:[0,1,0]
    v_pk_mul_f32 v[64:65], v[64:65], v[96:97]
    v_pk_mul_f32 v[66:67], v[66:67], v[98:99]
    v_pk_mul_f32 v[68:69], v[68:69], v[100:101]
    v_pk_mul_f32 v[70:71], v[70:71], v[102:103]
    v_cvt_pk_bf16_f32 v64, v64, v65
    v_cvt_pk_bf16_f32 v65, v66, v67
    v_cvt_pk_bf16_f32 v66, v68, v69
    v_cvt_pk_bf16_f32 v67, v70, v71
    buffer_store_dwordx4 v[64:67], v245, s[20:23], s32 offen offset:2048 sc1
    v_pk_fma_f32 v[80:81], v[112:113], v[190:191], v[80:81] op_sel:[0,1,0] op_sel_hi:[1,1,1] neg_lo:[0,1,0] neg_hi:[0,1,0]
    v_pk_fma_f32 v[82:83], v[114:115], v[190:191], v[82:83] op_sel:[0,1,0] op_sel_hi:[1,1,1] neg_lo:[0,1,0] neg_hi:[0,1,0]
    v_pk_fma_f32 v[84:85], v[116:117], v[190:191], v[84:85] op_sel:[0,1,0] op_sel_hi:[1,1,1] neg_lo:[0,1,0] neg_hi:[0,1,0]
    v_pk_fma_f32 v[86:87], v[118:119], v[190:191], v[86:87] op_sel:[0,1,0] op_sel_hi:[1,1,1] neg_lo:[0,1,0] neg_hi:[0,1,0]
    v_pk_mul_f32 v[80:81], v[80:81], v[96:97]
    v_pk_mul_f32 v[82:83], v[82:83], v[98:99]
    v_pk_mul_f32 v[84:85], v[84:85], v[100:101]
    v_pk_mul_f32 v[86:87], v[86:87], v[102:103]
    v_cvt_pk_bf16_f32 v80, v80, v81
    v_cvt_pk_bf16_f32 v81, v82, v83
    v_cvt_pk_bf16_f32 v82, v84, v85
    v_cvt_pk_bf16_f32 v83, v86, v87
    buffer_store_dwordx4 v[80:83], v245, s[20:23], s32 offen offset:2304 sc1
    v_pk_fma_f32 v[72:73], v[120:121], v[190:191], v[72:73] op_sel_hi:[1,0,1] neg_lo:[0,1,0] neg_hi:[0,1,0]
    v_pk_fma_f32 v[74:75], v[122:123], v[190:191], v[74:75] op_sel_hi:[1,0,1] neg_lo:[0,1,0] neg_hi:[0,1,0]
    v_pk_fma_f32 v[76:77], v[124:125], v[190:191], v[76:77] op_sel_hi:[1,0,1] neg_lo:[0,1,0] neg_hi:[0,1,0]
    v_pk_fma_f32 v[78:79], v[126:127], v[190:191], v[78:79] op_sel_hi:[1,0,1] neg_lo:[0,1,0] neg_hi:[0,1,0]
    v_pk_mul_f32 v[72:73], v[72:73], v[104:105]
    v_pk_mul_f32 v[74:75], v[74:75], v[106:107]
    v_pk_mul_f32 v[76:77], v[76:77], v[108:109]
    v_pk_mul_f32 v[78:79], v[78:79], v[110:111]
    v_cvt_pk_bf16_f32 v72, v72, v73
    v_cvt_pk_bf16_f32 v73, v74, v75
    v_cvt_pk_bf16_f32 v74, v76, v77
    v_cvt_pk_bf16_f32 v75, v78, v79
    buffer_store_dwordx4 v[72:75], v245, s[20:23], s33 offen offset:2048 sc1
    v_pk_fma_f32 v[88:89], v[120:121], v[190:191], v[88:89] op_sel:[0,1,0] op_sel_hi:[1,1,1] neg_lo:[0,1,0] neg_hi:[0,1,0]
    v_pk_fma_f32 v[90:91], v[122:123], v[190:191], v[90:91] op_sel:[0,1,0] op_sel_hi:[1,1,1] neg_lo:[0,1,0] neg_hi:[0,1,0]
    v_pk_fma_f32 v[92:93], v[124:125], v[190:191], v[92:93] op_sel:[0,1,0] op_sel_hi:[1,1,1] neg_lo:[0,1,0] neg_hi:[0,1,0]
    v_pk_fma_f32 v[94:95], v[126:127], v[190:191], v[94:95] op_sel:[0,1,0] op_sel_hi:[1,1,1] neg_lo:[0,1,0] neg_hi:[0,1,0]
    v_pk_mul_f32 v[88:89], v[88:89], v[104:105]
    v_pk_mul_f32 v[90:91], v[90:91], v[106:107]
    v_pk_mul_f32 v[92:93], v[92:93], v[108:109]
    v_pk_mul_f32 v[94:95], v[94:95], v[110:111]
    v_cvt_pk_bf16_f32 v88, v88, v89
    v_cvt_pk_bf16_f32 v89, v90, v91
    v_cvt_pk_bf16_f32 v90, v92, v93
    v_cvt_pk_bf16_f32 v91, v94, v95
    buffer_store_dwordx4 v[88:91], v245, s[20:23], s33 offen offset:2304 sc1
    ds_write_b128 v246, v[32:35] offset:0
    v_mul_f32 v192, 0x3e8293ee, v192
    ds_write_b128 v246, v[40:43] offset:128
    v_mul_f32 v193, 0x3e8293ee, v193
    ds_write_b128 v246, v[48:51] offset:4096
    v_mul_f32 v194, 0x3e8293ee, v194
    ds_write_b128 v246, v[56:59] offset:4224
    v_mul_f32 v195, 0x3e8293ee, v195
    v_pk_fma_f32 v[0:1], v[196:197], v[204:205], v[0:1] op_sel_hi:[1,0,1] neg_lo:[0,1,0] neg_hi:[0,1,0]
    v_pk_fma_f32 v[2:3], v[198:199], v[204:205], v[2:3] op_sel_hi:[1,0,1] neg_lo:[0,1,0] neg_hi:[0,1,0]
    v_pk_fma_f32 v[4:5], v[200:201], v[204:205], v[4:5] op_sel_hi:[1,0,1] neg_lo:[0,1,0] neg_hi:[0,1,0]
    v_pk_fma_f32 v[6:7], v[202:203], v[204:205], v[6:7] op_sel_hi:[1,0,1] neg_lo:[0,1,0] neg_hi:[0,1,0]
    v_pk_mul_f32 v[0:1], v[0:1], v[192:193] op_sel_hi:[1,0]
    v_pk_mul_f32 v[2:3], v[2:3], v[192:193] op_sel_hi:[1,0]
    v_pk_mul_f32 v[4:5], v[4:5], v[192:193] op_sel_hi:[1,0]
    v_pk_mul_f32 v[6:7], v[6:7], v[192:193] op_sel_hi:[1,0]
    v_cvt_pk_bf16_f32 v0, v0, v1
    v_cvt_pk_bf16_f32 v1, v2, v3
    v_cvt_pk_bf16_f32 v2, v4, v5
    v_cvt_pk_bf16_f32 v3, v6, v7
    ds_write_b128 v247, v[64:67] offset:2048
    ds_write_b128 v248, v[0:3] offset:0
    v_pk_fma_f32 v[8:9], v[196:197], v[204:205], v[8:9] op_sel:[0,1,0] op_sel_hi:[1,1,1] neg_lo:[0,1,0] neg_hi:[0,1,0]
    v_pk_fma_f32 v[10:11], v[198:199], v[204:205], v[10:11] op_sel:[0,1,0] op_sel_hi:[1,1,1] neg_lo:[0,1,0] neg_hi:[0,1,0]
    v_pk_fma_f32 v[12:13], v[200:201], v[204:205], v[12:13] op_sel:[0,1,0] op_sel_hi:[1,1,1] neg_lo:[0,1,0] neg_hi:[0,1,0]
    v_pk_fma_f32 v[14:15], v[202:203], v[204:205], v[14:15] op_sel:[0,1,0] op_sel_hi:[1,1,1] neg_lo:[0,1,0] neg_hi:[0,1,0]
    v_pk_mul_f32 v[8:9], v[8:9], v[192:193] op_sel:[0,1] op_sel_hi:[1,1]
    v_pk_mul_f32 v[10:11], v[10:11], v[192:193] op_sel:[0,1] op_sel_hi:[1,1]
    v_pk_mul_f32 v[12:13], v[12:13], v[192:193] op_sel:[0,1] op_sel_hi:[1,1]
    v_pk_mul_f32 v[14:15], v[14:15], v[192:193] op_sel:[0,1] op_sel_hi:[1,1]
    v_cvt_pk_bf16_f32 v8, v8, v9
    v_cvt_pk_bf16_f32 v9, v10, v11
    v_cvt_pk_bf16_f32 v10, v12, v13
    v_cvt_pk_bf16_f32 v11, v14, v15
    ds_write_b128 v247, v[80:83] offset:2304
    ds_write_b128 v248, v[8:11] offset:256
    v_pk_fma_f32 v[16:17], v[196:197], v[206:207], v[16:17] op_sel_hi:[1,0,1] neg_lo:[0,1,0] neg_hi:[0,1,0]
    v_pk_fma_f32 v[18:19], v[198:199], v[206:207], v[18:19] op_sel_hi:[1,0,1] neg_lo:[0,1,0] neg_hi:[0,1,0]
    v_pk_fma_f32 v[20:21], v[200:201], v[206:207], v[20:21] op_sel_hi:[1,0,1] neg_lo:[0,1,0] neg_hi:[0,1,0]
    v_pk_fma_f32 v[22:23], v[202:203], v[206:207], v[22:23] op_sel_hi:[1,0,1] neg_lo:[0,1,0] neg_hi:[0,1,0]
    v_pk_mul_f32 v[16:17], v[16:17], v[194:195] op_sel_hi:[1,0]
    v_pk_mul_f32 v[18:19], v[18:19], v[194:195] op_sel_hi:[1,0]
    v_pk_mul_f32 v[20:21], v[20:21], v[194:195] op_sel_hi:[1,0]
    v_pk_mul_f32 v[22:23], v[22:23], v[194:195] op_sel_hi:[1,0]
    v_cvt_pk_bf16_f32 v16, v16, v17
    v_cvt_pk_bf16_f32 v17, v18, v19
    v_cvt_pk_bf16_f32 v18, v20, v21
    v_cvt_pk_bf16_f32 v19, v22, v23
    ds_write_b128 v247, v[72:75] offset:6144
    ds_write_b128 v248, v[16:19] offset:2048
    v_pk_fma_f32 v[24:25], v[196:197], v[206:207], v[24:25] op_sel:[0,1,0] op_sel_hi:[1,1,1] neg_lo:[0,1,0] neg_hi:[0,1,0]
    v_pk_fma_f32 v[26:27], v[198:199], v[206:207], v[26:27] op_sel:[0,1,0] op_sel_hi:[1,1,1] neg_lo:[0,1,0] neg_hi:[0,1,0]
    v_pk_fma_f32 v[28:29], v[200:201], v[206:207], v[28:29] op_sel:[0,1,0] op_sel_hi:[1,1,1] neg_lo:[0,1,0] neg_hi:[0,1,0]
    v_pk_fma_f32 v[30:31], v[202:203], v[206:207], v[30:31] op_sel:[0,1,0] op_sel_hi:[1,1,1] neg_lo:[0,1,0] neg_hi:[0,1,0]
    v_pk_mul_f32 v[24:25], v[24:25], v[194:195] op_sel:[0,1] op_sel_hi:[1,1]
    v_pk_mul_f32 v[26:27], v[26:27], v[194:195] op_sel:[0,1] op_sel_hi:[1,1]
    v_pk_mul_f32 v[28:29], v[28:29], v[194:195] op_sel:[0,1] op_sel_hi:[1,1]
    v_pk_mul_f32 v[30:31], v[30:31], v[194:195] op_sel:[0,1] op_sel_hi:[1,1]
    v_cvt_pk_bf16_f32 v24, v24, v25
    v_cvt_pk_bf16_f32 v25, v26, v27
    v_cvt_pk_bf16_f32 v26, v28, v29
    v_cvt_pk_bf16_f32 v27, v30, v31
    ds_write_b128 v247, v[88:91] offset:6400
    ds_write_b128 v248, v[24:27] offset:2304
    s_lshl_b32 s30, s25, 8
    s_lshl_b32 s31, s24, 4
    s_add_u32 s30, s30, s31
    s_lshl_b32 s31, s34, 3
    s_add_u32 s30, s30, s31
    s_lshl_b32 s31, s35, 2
    s_add_u32 s30, s30, s31
    s_add_u32 s30, s30, s26
    s_add_u32 s30, s30, 0xdd0000
    v_readfirstlane_b32 s73, v250
    v_readfirstlane_b32 s77, v251
    s_lshr_b32 s39, s73, 5
    s_lshl_b32 s34, s24, 2
    s_sub_u32 s39, s39, s34
    s_add_u32 s39, s39, 8
    s_lshr_b32 s34, s39, 3
    s_add_u32 s34, s34, 1
    s_cmp_lt_u32 s39, 12
    s_cselect_b32 s100, s34, 0
    s_cmp_lg_u32 s26, 0
    s_cbranch_scc1 sk_2
    v_permlane32_swap_b32 v208, v210
    v_permlane32_swap_b32 v209, v211
    v_permlane32_swap_b32 v212, v214
    v_permlane32_swap_b32 v213, v215
    v_permlane32_swap_b32 v216, v218
    v_permlane32_swap_b32 v217, v219
    v_permlane32_swap_b32 v220, v222
    v_permlane32_swap_b32 v221, v223
sk_2:
    v_mov_b32 v20, 0xffff
    v_mov_b32 v21, 0xffff0000
    v_cndmask_b32 v22, 0, v20, s[40:41]
    v_cndmask_b32 v23, 0, v21, s[42:43]
    v_or_b32_e64 v12, v22, v23
    v_cndmask_b32 v22, 0, v20, s[44:45]
    v_cndmask_b32 v23, 0, v21, s[46:47]
    v_or_b32_e64 v13, v22, v23
    v_cndmask_b32 v22, 0, v20, s[48:49]
    v_cndmask_b32 v23, 0, v21, s[50:51]
    v_or_b32_e64 v14, v22, v23
    v_cndmask_b32 v22, 0, v20, s[52:53]
    v_cndmask_b32 v23, 0, v21, s[54:55]
    v_or_b32_e64 v15, v22, v23
    v_cndmask_b32 v22, 0, v20, s[56:57]
    v_cndmask_b32 v23, 0, v21, s[58:59]
    v_or_b32_e64 v16, v22, v23
    v_cndmask_b32 v22, 0, v20, s[60:61]
    v_cndmask_b32 v23, 0, v21, s[62:63]
    v_or_b32_e64 v17, v22, v23
    v_cndmask_b32 v22, 0, v20, s[64:65]
    v_cndmask_b32 v23, 0, v21, s[66:67]
    v_or_b32_e64 v18, v22, v23
    v_cndmask_b32 v22, 0, v20, s[68:69]
    v_cndmask_b32 v23, 0, v21, s[70:71]
    v_or_b32 v19, v22, v23
    s_xor_b32 s76, s99, 0
    s_and_b32 s34, s76, 3
    s_lshl_b32 s33, s34, 12
    s_add_u32 s33, s33, 65536
    v_add_u32_e64 v20, s33, v253
    v_add_u32 v22, 32768, v20
    v_add_u32 v23, 94208, v253
    s_add_u32 s74, s34, 1
    s_mov_b32 s75, 0
    s_lshl_b32 s34, s34, 11
    s_add_u32 s34, s34, 49152
    v_add_u32 v3, s34, v253
    v_mov_b32 v21, 0xf149f2ca
    v_cndmask_b32 v24, v21, 0, s[40:41]
    v_cndmask_b32 v25, v21, 0, s[42:43]
    v_cndmask_b32 v26, v21, 0, s[44:45]
    v_cndmask_b32 v27, v21, 0, s[46:47]
    v_cndmask_b32 v28, v21, 0, s[48:49]
    v_cndmask_b32 v29, v21, 0, s[50:51]
    v_cndmask_b32 v30, v21, 0, s[52:53]
    v_cndmask_b32 v31, v21, 0, s[54:55]
    v_cndmask_b32 v32, v21, 0, s[56:57]
    v_cndmask_b32 v33, v21, 0, s[58:59]
    v_cndmask_b32 v34, v21, 0, s[60:61]
    v_cndmask_b32 v35, v21, 0, s[62:63]
    v_cndmask_b32 v36, v21, 0, s[64:65]
    v_cndmask_b32 v37, v21, 0, s[66:67]
    v_cndmask_b32 v38, v21, 0, s[68:69]
    v_cndmask_b32 v39, v21, 0, s[70:71]
    v_lshrrev_b32 v40, 2, v252
    v_xor_b32 v40, v40, v252
    v_bfe_u32 v40, v40, 2, 1
    v_add_u32_e64 v40, -1, v40
    v_and_b32 v40, 0x3f803f80, v40
    v_mov_b32 v41, v40
    v_mov_b32 v42, v40
    v_mov_b32 v43, v40
    v_mov_b32 v44, 0
    v_mov_b32 v45, 0
    v_mov_b32 v46, 0
    v_mov_b32 v47, 0
    v_mov_b32 v88, 0
    v_mov_b32 v89, 0
    v_mov_b32 v90, 0
    v_mov_b32 v91, 0
    v_mov_b32 v92, 0
    v_mov_b32 v93, 0
    v_mov_b32 v94, 0
    v_mov_b32 v95, 0
    v_mov_b32 v96, 0
    v_mov_b32 v97, 0
    v_mov_b32 v98, 0
    v_mov_b32 v99, 0
    v_mov_b32 v100, 0
    v_mov_b32 v101, 0
    v_mov_b32 v102, 0
    v_mov_b32 v103, 0
    s_cmp_lg_u32 s100, 2
    s_cbranch_scc1 sk_3
    v_mov_b32 v154, s88
    s_mov_b64 exec, 1
    s_waitcnt vmcnt(0)
    buffer_store_dword v154, v253, s[20:23], s30 offen sc1
    s_mov_b64 exec, -1
sk_3:
    s_waitcnt lgkmcnt(0)
    s_barrier
    s_cmp_lg_u32 s100, 2
    s_cbranch_scc1 sk_4
    s_lshr_b32 s34, s73, 5
    s_cmp_lg_u32 s34, s99
    s_cbranch_scc1 sk_5
    s_and_b32 s32, s73, 31
    v_and_b32 v0, 31, v252
    v_cmp_eq_u32 vcc, s32, v0
    v_lshrrev_b32 v0, 5, v252
    v_lshlrev_b32_e64 v0, 3, v0
    s_lshl_b32 s34, s98, 7
    s_add_u32 s34, s34, 0xdc4000
    s_mov_b64 exec, vcc
    buffer_load_dwordx2 v[208:209], v0, s[20:23], s34 offen offset:0 sc1
    buffer_load_dwordx2 v[210:211], v0, s[20:23], s34 offen offset:16 sc1
    buffer_load_dwordx2 v[212:213], v0, s[20:23], s34 offen offset:32 sc1
    buffer_load_dwordx2 v[214:215], v0, s[20:23], s34 offen offset:48 sc1
    buffer_load_dwordx2 v[216:217], v0, s[20:23], s34 offen offset:64 sc1
    buffer_load_dwordx2 v[218:219], v0, s[20:23], s34 offen offset:80 sc1
    buffer_load_dwordx2 v[220:221], v0, s[20:23], s34 offen offset:96 sc1
    buffer_load_dwordx2 v[222:223], v0, s[20:23], s34 offen offset:112 sc1
    v_mov_b32_e64 v240, 1.0
    v_mov_b32 v241, 0
    s_mov_b64 exec, -1
sk_5:
    s_barrier
sk_4:
    ds_read_b128 v[4:7], v3
    ds_read_b128 v[8:11], v3 offset:1024
    ds_read_b128 v[112:115], v22 offset:0
    ds_read_b128 v[116:119], v22 offset:1024
    s_waitcnt lgkmcnt(0)
    v_mfma_f32_32x32x16_bf16 v[56:71], v[112:115], v[4:7], v[24:39]
    v_mfma_f32_32x32x16_bf16 v[56:71], v[116:119], v[8:11], v[56:71]
    ds_read_b128 v[104:107], v23 offset:4096
    ds_read_b128 v[124:127], v22 offset:3072
    ds_read_b128 v[108:111], v23 offset:5120
    ds_read_b128 v[120:123], v22 offset:2048
    s_cmp_eq_u32 s100, 2
    s_cbranch_scc1 sk_7
    v_mov_b32_e64 v154, s88
    s_mov_b64 exec, 1
    s_waitcnt vmcnt(0)
    buffer_store_dword v154, v253, s[20:23], s30 offen sc1
    s_mov_b64 exec, -1
sk_7:
    s_nop 5
    v_max3_f32 v21, v56, v57, v58
    v_max3_f32 v152, v59, v60, v61
    v_max3_f32 v21, v21, v62, v63
    v_max3_f32 v152, v152, v64, v65
    v_max3_f32 v21, v21, v66, v67
    v_max3_f32 v152, v152, v68, v69
    v_max3_f32 v21, v21, v70, v71
    v_max_f32 v21, v21, v152
    v_mov_b32 v152, v21
    s_nop 1
    v_permlane32_swap_b32 v21, v152
    v_max_f32 v21, v21, v152
    v_sub_f32 v24, 0, v21
    v_sub_f32 v25, 0, v21
    v_sub_f32 v26, 0, v21
    v_sub_f32 v27, 0, v21
    v_sub_f32 v28, 0, v21
    v_sub_f32 v29, 0, v21
    v_sub_f32 v30, 0, v21
    v_sub_f32 v31, 0, v21
    v_sub_f32 v32, 0, v21
    v_sub_f32 v33, 0, v21
    v_sub_f32 v34, 0, v21
    v_sub_f32 v35, 0, v21
    v_sub_f32 v36, 0, v21
    v_sub_f32 v37, 0, v21
    v_sub_f32 v38, 0, v21
    v_sub_f32 v39, 0, v21
    s_branch a0_6_go
    s_nop 0
a0_6_mid:
    s_cmp_ge_u32 s76, 8
    s_cselect_b32 s33, 0, -1
    v_not_b32 v12, v12
    v_or_b32 v12, s33, v12
    v_not_b32 v13, v13
    v_or_b32 v13, s33, v13
    v_not_b32 v14, v14
    v_or_b32 v14, s33, v14
    v_not_b32 v15, v15
    v_or_b32 v15, s33, v15
    v_not_b32 v16, v16
    v_or_b32 v16, s33, v16
    v_not_b32 v17, v17
    v_or_b32 v17, s33, v17
    v_not_b32 v18, v18
    v_or_b32 v18, s33, v18
    v_not_b32 v19, v19
    v_or_b32 v19, s33, v19
    s_and_b32 s32, s76, 3
    s_cmp_ge_u32 s76, 8
    s_cselect_b32 s32, s32, 4
    s_sub_u32 s74, 8, s32
    s_lshl_b32 s32, s32, 12
    s_add_u32 s32, s32, 65536
    v_add_u32 v22, s32, v253
    v_add_u32 v23, s32, v253
    s_cmp_eq_u32 s26, 0
    s_cselect_b32 s75, 2, 1
    s_barrier
    s_cmp_lg_u32 s100, 1
    s_cbranch_scc1 sk_8
    s_barrier
sk_8:
    s_cmp_lt_u32 s76, 4
    s_cbranch_scc1 a0_6_none
    ds_read_b128 v[112:115], v22 offset:0
    ds_read_b128 v[116:119], v22 offset:1024
    ds_read_b128 v[104:107], v23 offset:4096
    ds_read_b128 v[124:127], v22 offset:3072
    ds_read_b128 v[108:111], v23 offset:5120
    ds_read_b128 v[120:123], v22 offset:2048
    s_waitcnt lgkmcnt(4)
a0_6_go:
    s_nop 0
    v_mfma_f32_32x32x16_bf16 v[56:71], v[112:115], v[4:7], v[24:39]
    v_mfma_f32_32x32x16_bf16 v[56:71], v[116:119], v[8:11], v[56:71]
    s_waitcnt lgkmcnt(3)
    v_mfma_f32_32x32x16_bf16 v[72:87], v[104:107], v[4:7], v[24:39]
    ds_read_b128 v[104:107], v23 offset:8192
    s_nop 8
    v_exp_f32 v56, v56
    v_exp_f32 v57, v57
    v_exp_f32_e64 v58, v58
    ds_read_b128 v[128:131], v23 offset:7168
    v_exp_f32 v59, v59
    v_exp_f32 v60, v60
    v_exp_f32 v61, v61
    s_waitcnt lgkmcnt(2)
    v_mfma_f32_32x32x16_bf16 v[72:87], v[108:111], v[8:11], v[72:87]
    ds_read_b128 v[108:111], v23 offset:9216
    v_exp_f32 v62, v62
    v_exp_f32 v63, v63
    v_cvt_pk_bf16_f32 v136, v56, v57
    v_cvt_pk_bf16_f32 v137, v58, v59
    v_cvt_pk_bf16_f32 v138, v60, v61
    v_cvt_pk_bf16_f32 v139, v62, v63
    v_and_b32 v136, v136, v12
    v_and_b32 v137, v137, v13
    v_and_b32 v138, v138, v14
    v_and_b32 v139, v139, v15
    v_exp_f32 v64, v64
    v_exp_f32 v65, v65
    v_mfma_f32_32x32x16_bf16 v[88:103], v[120:123], v[136:139], v[88:103]
    ds_read_b128 v[120:123], v23 offset:6144
    s_cmp_eq_u32 s75, 0
    s_cbranch_scc1 sk_9
    s_add_u32 s96, s25, 0
    s_and_b32 s96, s96, 15
    s_lshl_b32 s96, s96, 17
    s_add_u32 m0, s101, 0
    s_nop 0
    buffer_load_dwordx4 v243, s[8:11], s96 offen lds
sk_9:
    v_exp_f32 v66, v66
    v_exp_f32 v67, v67
    v_exp_f32 v68, v68
    v_exp_f32_e64 v69, v69
    v_mfma_f32_16x16x32_bf16 v[44:47], v[40:43], v[136:139], v[44:47]
    v_exp_f32 v70, v70
    v_exp_f32 v71, v71
    v_cvt_pk_bf16_f32 v140, v64, v65
    v_cvt_pk_bf16_f32 v141, v66, v67
    v_cvt_pk_bf16_f32 v142, v68, v69
    v_cvt_pk_bf16_f32 v143, v70, v71
    v_and_b32 v140, v140, v16
    v_and_b32 v141, v141, v17
    v_and_b32 v142, v142, v18
    v_and_b32 v143, v143, v19
    s_cmp_eq_u32 s75, 0
    s_cbranch_scc1 sk_10
    s_barrier
    s_add_u32 s96, s25, 12
    s_and_b32 s96, s96, 15
    s_lshl_b32 s96, s96, 17
    s_add_u32 m0, s101, 49152
    s_nop 0
    buffer_load_dwordx4 v243, s[8:11], s96 offen lds
sk_10:
    s_cmp_eq_u32 s74, 1
    s_cbranch_scc1 a0_6_e0
    s_cmp_eq_u32 s74, 2
    s_cbranch_scc1 a0_6_t1
    s_waitcnt lgkmcnt(3)
    v_mfma_f32_32x32x16_bf16 v[56:71], v[104:107], v[4:7], v[24:39]
    ds_read_b128 v[104:107], v23 offset:12288
    v_exp_f32 v72, v72
    v_exp_f32 v73, v73
    v_exp_f32_e64 v74, v74
    v_mfma_f32_32x32x16_bf16 v[88:103], v[124:127], v[140:143], v[88:103]
    ds_read_b128 v[124:127], v23 offset:11264
    v_exp_f32 v75, v75
    v_exp_f32 v76, v76
    v_exp_f32 v77, v77
    s_waitcnt lgkmcnt(2)
    v_mfma_f32_32x32x16_bf16 v[56:71], v[108:111], v[8:11], v[56:71]
    ds_read_b128 v[108:111], v23 offset:13312
    v_exp_f32 v78, v78
    v_exp_f32 v79, v79
    v_cvt_pk_bf16_f32 v136, v72, v73
    v_cvt_pk_bf16_f32 v137, v74, v75
    v_mfma_f32_16x16x32_bf16 v[44:47], v[40:43], v[140:143], v[44:47]
    v_cvt_pk_bf16_f32 v138, v76, v77
    v_cvt_pk_bf16_f32 v139, v78, v79
    v_exp_f32 v80, v80
    v_exp_f32 v81, v81
    v_mfma_f32_32x32x16_bf16 v[88:103], v[120:123], v[136:139], v[88:103]
    ds_read_b128 v[120:123], v23 offset:10240
    s_cmp_eq_u32 s75, 0
    s_cbranch_scc1 sk_11
    s_add_u32 s96, s25, 13
    s_and_b32 s96, s96, 15
    s_lshl_b32 s96, s96, 17
    s_add_u32 m0, s101, 53248
    s_nop 0
    buffer_load_dwordx4 v243, s[8:11], s96 offen lds
sk_11:
    v_exp_f32 v82, v82
    v_exp_f32 v83, v83
    v_exp_f32 v84, v84
    v_exp_f32 v85, v85
    v_mfma_f32_16x16x32_bf16 v[44:47], v[40:43], v[136:139], v[44:47]
    v_exp_f32 v86, v86
    v_exp_f32 v87, v87
    v_cvt_pk_bf16_f32 v140, v80, v81
    v_cvt_pk_bf16_f32 v141, v82, v83
    v_cvt_pk_bf16_f32 v142, v84, v85
    v_cvt_pk_bf16_f32 v143, v86, v87
    s_cmp_eq_u32 s75, 0
    s_cbranch_scc1 sk_12
    s_add_u32 s96, s25, 14
    s_and_b32 s96, s96, 15
    s_lshl_b32 s96, s96, 17
    s_add_u32 m0, s101, 57344
    s_nop 0
    buffer_load_dwordx4 v243, s[8:11], s96 offen lds
sk_12:
    s_cmp_eq_u32 s74, 3
    s_cbranch_scc1 a0_6_t0
    s_waitcnt lgkmcnt(3)
    v_mfma_f32_32x32x16_bf16 v[72:87], v[104:107], v[4:7], v[24:39]
    ds_read_b128 v[104:107], v23 offset:16384
    v_exp_f32 v56, v56
    v_exp_f32 v57, v57
    v_exp_f32 v58, v58
    v_mfma_f32_32x32x16_bf16 v[88:103], v[128:131], v[140:143], v[88:103]
    ds_read_b128 v[128:131], v23 offset:15360
    v_exp_f32 v59, v59
    v_exp_f32 v60, v60
    v_exp_f32 v61, v61
    s_waitcnt lgkmcnt(2)
    v_mfma_f32_32x32x16_bf16 v[72:87], v[108:111], v[8:11], v[72:87]
    ds_read_b128 v[108:111], v23 offset:17408
    v_exp_f32 v62, v62
    v_exp_f32 v63, v63
    v_cvt_pk_bf16_f32 v136, v56, v57
    v_cvt_pk_bf16_f32 v137, v58, v59
    v_mfma_f32_16x16x32_bf16 v[44:47], v[40:43], v[140:143], v[44:47]
    v_cvt_pk_bf16_f32 v138, v60, v61
    v_cvt_pk_bf16_f32 v139, v62, v63
    v_exp_f32 v64, v64
    v_exp_f32 v65, v65
    v_mfma_f32_32x32x16_bf16 v[88:103], v[120:123], v[136:139], v[88:103]
    ds_read_b128 v[120:123], v23 offset:14336
    s_cmp_eq_u32 s75, 0
    s_cbranch_scc1 sk_13
    s_add_u32 s96, s25, 15
    s_and_b32 s96, s96, 15
    s_lshl_b32 s96, s96, 17
    s_add_u32 m0, s101, 61440
    s_nop 0
    buffer_load_dwordx4 v243, s[8:11], s96 offen lds
sk_13:
    v_exp_f32 v66, v66
    v_exp_f32 v67, v67
    v_exp_f32 v68, v68
    v_exp_f32 v69, v69
    v_mfma_f32_16x16x32_bf16 v[44:47], v[40:43], v[136:139], v[44:47]
    v_exp_f32 v70, v70
    v_exp_f32 v71, v71
    v_cvt_pk_bf16_f32 v140, v64, v65
    v_cvt_pk_bf16_f32 v141, v66, v67
    v_cvt_pk_bf16_f32 v142, v68, v69
    v_cvt_pk_bf16_f32 v143, v70, v71
    s_cmp_eq_u32 s74, 4
    s_cbranch_scc1 a0_6_t1
    s_waitcnt lgkmcnt(3)
    v_mfma_f32_32x32x16_bf16 v[56:71], v[104:107], v[4:7], v[24:39]
    ds_read_b128 v[104:107], v23 offset:20480
    v_exp_f32 v72, v72
    v_exp_f32 v73, v73
    v_exp_f32 v74, v74
    v_mfma_f32_32x32x16_bf16 v[88:103], v[124:127], v[140:143], v[88:103]
    ds_read_b128 v[124:127], v23 offset:19456
    v_exp_f32 v75, v75
    v_exp_f32 v76, v76
    v_exp_f32 v77, v77
    s_waitcnt lgkmcnt(2)
    v_mfma_f32_32x32x16_bf16 v[56:71], v[108:111], v[8:11], v[56:71]
    ds_read_b128 v[108:111], v23 offset:21504
    v_exp_f32 v78, v78
    v_exp_f32 v79, v79
    v_cvt_pk_bf16_f32 v136, v72, v73
    v_cvt_pk_bf16_f32 v137, v74, v75
    v_mfma_f32_16x16x32_bf16 v[44:47], v[40:43], v[140:143], v[44:47]
    v_cvt_pk_bf16_f32 v138, v76, v77
    v_cvt_pk_bf16_f32 v139, v78, v79
    v_exp_f32 v80, v80
    v_exp_f32 v81, v81
    v_mfma_f32_32x32x16_bf16 v[88:103], v[120:123], v[136:139], v[88:103]
    ds_read_b128 v[120:123], v23 offset:18432
    v_exp_f32 v82, v82
    v_exp_f32 v83, v83
    v_exp_f32 v84, v84
    v_exp_f32 v85, v85
    v_mfma_f32_16x16x32_bf16 v[44:47], v[40:43], v[136:139], v[44:47]
    v_exp_f32 v86, v86
    v_exp_f32 v87, v87
    v_cvt_pk_bf16_f32 v140, v80, v81
    v_cvt_pk_bf16_f32 v141, v82, v83
    v_cvt_pk_bf16_f32 v142, v84, v85
    v_cvt_pk_bf16_f32 v143, v86, v87
    s_cmp_eq_u32 s74, 5
    s_cbranch_scc1 a0_6_t0
    s_waitcnt lgkmcnt(3)
    v_mfma_f32_32x32x16_bf16 v[72:87], v[104:107], v[4:7], v[24:39]
    ds_read_b128 v[104:107], v23 offset:24576
    v_exp_f32 v56, v56
    v_exp_f32 v57, v57
    v_exp_f32 v58, v58
    v_mfma_f32_32x32x16_bf16 v[88:103], v[128:131], v[140:143], v[88:103]
    ds_read_b128 v[128:131], v23 offset:23552
    v_exp_f32 v59, v59
    v_exp_f32 v60, v60
    v_exp_f32 v61, v61
    s_waitcnt lgkmcnt(2)
    v_mfma_f32_32x32x16_bf16 v[72:87], v[108:111], v[8:11], v[72:87]
    ds_read_b128 v[108:111], v23 offset:25600
    v_exp_f32 v62, v62
    v_exp_f32 v63, v63
    v_cvt_pk_bf16_f32 v136, v56, v57
    v_cvt_pk_bf16_f32 v137, v58, v59
    v_mfma_f32_16x16x32_bf16 v[44:47], v[40:43], v[140:143], v[44:47]
    v_cvt_pk_bf16_f32 v138, v60, v61
    v_cvt_pk_bf16_f32 v139, v62, v63
    v_exp_f32 v64, v64
    v_exp_f32 v65, v65
    v_mfma_f32_32x32x16_bf16 v[88:103], v[120:123], v[136:139], v[88:103]
    ds_read_b128 v[120:123], v23 offset:22528
    v_exp_f32 v66, v66
    v_exp_f32 v67, v67
    v_exp_f32 v68, v68
    v_exp_f32 v69, v69
    v_mfma_f32_16x16x32_bf16 v[44:47], v[40:43], v[136:139], v[44:47]
    v_exp_f32 v70, v70
    v_exp_f32 v71, v71
    v_cvt_pk_bf16_f32 v140, v64, v65
    v_cvt_pk_bf16_f32 v141, v66, v67
    v_cvt_pk_bf16_f32 v142, v68, v69
    v_cvt_pk_bf16_f32 v143, v70, v71
    s_cmp_eq_u32 s74, 6
    s_cbranch_scc1 a0_6_t1
    s_waitcnt lgkmcnt(3)
    v_mfma_f32_32x32x16_bf16 v[56:71], v[104:107], v[4:7], v[24:39]
    ds_read_b128 v[104:107], v23 offset:28672
    v_exp_f32 v72, v72
    v_exp_f32 v73, v73
    v_exp_f32 v74, v74
    v_mfma_f32_32x32x16_bf16 v[88:103], v[124:127], v[140:143], v[88:103]
    ds_read_b128 v[124:127], v23 offset:27648
    v_exp_f32 v75, v75
    v_exp_f32 v76, v76
    v_exp_f32 v77, v77
    s_waitcnt lgkmcnt(2)
    v_mfma_f32_32x32x16_bf16 v[56:71], v[108:111], v[8:11], v[56:71]
    ds_read_b128 v[108:111], v23 offset:29696
    v_exp_f32 v78, v78
    v_exp_f32 v79, v79
    v_cvt_pk_bf16_f32 v136, v72, v73
    v_cvt_pk_bf16_f32 v137, v74, v75
    v_mfma_f32_16x16x32_bf16 v[44:47], v[40:43], v[140:143], v[44:47]
    v_cvt_pk_bf16_f32 v138, v76, v77
    v_cvt_pk_bf16_f32 v139, v78, v79
    v_exp_f32 v80, v80
    v_exp_f32 v81, v81
    v_mfma_f32_32x32x16_bf16 v[88:103], v[120:123], v[136:139], v[88:103]
    ds_read_b128 v[120:123], v23 offset:26624
    v_exp_f32 v82, v82
    v_exp_f32 v83, v83
    v_exp_f32 v84, v84
    v_exp_f32 v85, v85
    v_mfma_f32_16x16x32_bf16 v[44:47], v[40:43], v[136:139], v[44:47]
    v_exp_f32 v86, v86
    v_exp_f32 v87, v87
    v_cvt_pk_bf16_f32 v140, v80, v81
    v_cvt_pk_bf16_f32 v141, v82, v83
    v_cvt_pk_bf16_f32 v142, v84, v85
    v_cvt_pk_bf16_f32 v143, v86, v87
    s_cmp_eq_u32 s74, 7
    s_cbranch_scc1 a0_6_t0
    s_waitcnt lgkmcnt(3)
    v_mfma_f32_32x32x16_bf16 v[72:87], v[104:107], v[4:7], v[24:39]
    ds_read_b128 v[104:107], v23 offset:24576
    v_exp_f32 v56, v56
    v_exp_f32 v57, v57
    v_exp_f32 v58, v58
    v_mfma_f32_32x32x16_bf16 v[88:103], v[128:131], v[140:143], v[88:103]
    ds_read_b128 v[128:131], v23 offset:31744
    v_exp_f32 v59, v59
    v_exp_f32 v60, v60
    v_exp_f32 v61, v61
    s_waitcnt lgkmcnt(2)
    v_mfma_f32_32x32x16_bf16 v[72:87], v[108:111], v[8:11], v[72:87]
    ds_read_b128 v[108:111], v23 offset:25600
    v_exp_f32 v62, v62
    v_exp_f32 v63, v63
    v_cvt_pk_bf16_f32 v136, v56, v57
    v_cvt_pk_bf16_f32 v137, v58, v59
    v_mfma_f32_16x16x32_bf16 v[44:47], v[40:43], v[140:143], v[44:47]
    v_cvt_pk_bf16_f32 v138, v60, v61
    v_cvt_pk_bf16_f32 v139, v62, v63
    v_exp_f32 v64, v64
    v_exp_f32 v65, v65
    v_mfma_f32_32x32x16_bf16 v[88:103], v[120:123], v[136:139], v[88:103]
    ds_read_b128 v[120:123], v23 offset:30720
    v_exp_f32 v66, v66
    v_exp_f32 v67, v67
    v_exp_f32 v68, v68
    v_exp_f32 v69, v69
    v_mfma_f32_16x16x32_bf16 v[44:47], v[40:43], v[136:139], v[44:47]
    v_exp_f32 v70, v70
    v_exp_f32 v71, v71
    v_cvt_pk_bf16_f32 v140, v64, v65
    v_cvt_pk_bf16_f32 v141, v66, v67
    v_cvt_pk_bf16_f32 v142, v68, v69
    v_cvt_pk_bf16_f32 v143, v70, v71
a0_6_t1:
    v_exp_f32 v72, v72
    v_exp_f32 v73, v73
    v_exp_f32_e64 v74, v74
    v_mfma_f32_32x32x16_bf16 v[88:103], v[124:127], v[140:143], v[88:103]
    v_exp_f32 v75, v75
    v_exp_f32 v76, v76
    v_exp_f32 v77, v77
    v_exp_f32 v78, v78
    v_exp_f32_e64 v79, v79
    v_cvt_pk_bf16_f32 v136, v72, v73
    v_cvt_pk_bf16_f32 v137, v74, v75
    v_mfma_f32_16x16x32_bf16 v[44:47], v[40:43], v[140:143], v[44:47]
    v_cvt_pk_bf16_f32 v138, v76, v77
    v_cvt_pk_bf16_f32 v139, v78, v79
    v_exp_f32_e64 v80, v80
    v_exp_f32 v81, v81
    s_waitcnt lgkmcnt(0)
    v_mfma_f32_32x32x16_bf16 v[88:103], v[120:123], v[136:139], v[88:103]
    v_exp_f32 v82, v82
    v_exp_f32 v83, v83
    v_exp_f32 v84, v84
    v_exp_f32 v85, v85
    v_mfma_f32_16x16x32_bf16 v[44:47], v[40:43], v[136:139], v[44:47]
    v_exp_f32 v86, v86
    v_exp_f32 v87, v87
    v_cvt_pk_bf16_f32 v140, v80, v81
    v_cvt_pk_bf16_f32 v141, v82, v83
    v_cvt_pk_bf16_f32 v142, v84, v85
    v_cvt_pk_bf16_f32 v143, v86, v87
a0_6_e1:
    s_cmp_eq_u32 s75, 0
    s_nop 0
    v_mfma_f32_16x16x32_bf16 v[44:47], v[40:43], v[140:143], v[44:47]
    v_mfma_f32_32x32x16_bf16 v[88:103], v[128:131], v[140:143], v[88:103]
    s_cbranch_scc1 a0_6_mid
    s_branch a0_6_fin
    s_nop 0
a0_6_t0:
    v_exp_f32 v56, v56
    v_exp_f32 v57, v57
    v_exp_f32 v58, v58
    v_mfma_f32_32x32x16_bf16 v[88:103], v[128:131], v[140:143], v[88:103]
    v_exp_f32 v59, v59
    v_exp_f32 v60, v60
    v_exp_f32 v61, v61
    v_exp_f32 v62, v62
    v_exp_f32_e64 v63, v63
    v_cvt_pk_bf16_f32 v136, v56, v57
    v_cvt_pk_bf16_f32 v137, v58, v59
    v_mfma_f32_16x16x32_bf16 v[44:47], v[40:43], v[140:143], v[44:47]
    v_cvt_pk_bf16_f32 v138, v60, v61
    v_cvt_pk_bf16_f32 v139, v62, v63
    v_exp_f32_e64 v64, v64
    v_exp_f32 v65, v65
    s_waitcnt lgkmcnt(0)
    v_mfma_f32_32x32x16_bf16 v[88:103], v[120:123], v[136:139], v[88:103]
    v_exp_f32 v66, v66
    v_exp_f32 v67, v67
    v_exp_f32 v68, v68
    v_exp_f32 v69, v69
    v_mfma_f32_16x16x32_bf16 v[44:47], v[40:43], v[136:139], v[44:47]
    v_exp_f32 v70, v70
    v_exp_f32 v71, v71
    v_cvt_pk_bf16_f32 v140, v64, v65
    v_cvt_pk_bf16_f32 v141, v66, v67
    v_cvt_pk_bf16_f32 v142, v68, v69
    v_cvt_pk_bf16_f32 v143, v70, v71
a0_6_e0:
    s_cmp_eq_u32 s75, 0
    s_nop 0
    v_mfma_f32_16x16x32_bf16 v[44:47], v[40:43], v[140:143], v[44:47]
    v_mfma_f32_32x32x16_bf16 v[88:103], v[124:127], v[140:143], v[88:103]
    s_cbranch_scc1 a0_6_mid
    s_branch a0_6_fin
    s_nop 0
a0_6_none:
    s_add_u32 s96, s25, 0
    s_and_b32 s96, s96, 15
    s_lshl_b32 s96, s96, 17
    s_add_u32 m0, s101, 0
    s_nop 0
    buffer_load_dwordx4 v243, s[8:11], s96 offen lds
    s_barrier
    s_add_u32 s96, s25, 12
    s_and_b32 s96, s96, 15
    s_lshl_b32 s96, s96, 17
    s_add_u32 m0, s101, 49152
    s_nop 0
    buffer_load_dwordx4 v243, s[8:11], s96 offen lds
    s_add_u32 s96, s25, 13
    s_and_b32 s96, s96, 15
    s_lshl_b32 s96, s96, 17
    s_add_u32 m0, s101, 53248
    s_nop 0
    buffer_load_dwordx4 v243, s[8:11], s96 offen lds
    s_add_u32 s96, s25, 14
    s_and_b32 s96, s96, 15
    s_lshl_b32 s96, s96, 17
    s_add_u32 m0, s101, 57344
    s_nop 0
    buffer_load_dwordx4 v243, s[8:11], s96 offen lds
    s_add_u32 s96, s25, 15
    s_and_b32 s96, s96, 15
    s_lshl_b32 s96, s96, 17
    s_add_u32 m0, s101, 61440
    s_nop 0
    buffer_load_dwordx4 v243, s[8:11], s96 offen lds
a0_6_fin:
    s_lshl_b32 s36, s76, 16
    s_add_u32 s36, s36, 0x800000
    s_lshl_b32 s33, s25, 11
    s_add_u32 s33, s33, s36
    s_lshl_b32 s30, s24, 9
    s_and_b32 s31, s76, 3
    s_lshl_b32 s31, s31, 6
    s_add_u32 s30, s30, s31
    s_add_u32 s30, s30, s26
    s_add_u32 s30, s30, 0xdd2000
    s_lshl_b32 s31, s25, 2
    s_add_u32 s31, s31, s30
    v_cmp_ngt_f32 vcc, 0x5d800000, v44
    v_rcp_f32 v22, v44
    s_cbranch_vccnz att_exact0
att_ret0:
    s_nop 3
    v_pk_mul_f32 v[88:89], v[88:89], v[22:23] op_sel_hi:[1,0]
    v_pk_mul_f32 v[90:91], v[90:91], v[22:23] op_sel_hi:[1,0]
    v_pk_mul_f32 v[92:93], v[92:93], v[22:23] op_sel_hi:[1,0]
    v_pk_mul_f32 v[94:95], v[94:95], v[22:23] op_sel_hi:[1,0]
    v_pk_mul_f32 v[96:97], v[96:97], v[22:23] op_sel_hi:[1,0]
    v_pk_mul_f32 v[98:99], v[98:99], v[22:23] op_sel_hi:[1,0]
    v_pk_mul_f32 v[100:101], v[100:101], v[22:23] op_sel_hi:[1,0]
    v_pk_mul_f32 v[102:103], v[102:103], v[22:23] op_sel_hi:[1,0]
    v_cvt_pk_bf16_f32 v88, v88, v89
    v_cvt_pk_bf16_f32 v89, v90, v91
    v_cvt_pk_bf16_f32 v90, v92, v93
    v_cvt_pk_bf16_f32 v91, v94, v95
    v_cvt_pk_bf16_f32 v92, v96, v97
    v_cvt_pk_bf16_f32 v93, v98, v99
    v_cvt_pk_bf16_f32 v94, v100, v101
    v_cvt_pk_bf16_f32 v95, v102, v103
    s_cmp_lg_u32 s77, 0
    s_cbranch_scc1 lc_14
    buffer_store_dwordx4 v[88:91], v253, s[20:23], s33 offen sc1
    buffer_store_dwordx4 v[92:95], v253, s[20:23], s33 offen offset:1024 sc1
    s_branch lc_15
    s_nop 0
lc_14:
    buffer_store_dwordx4 v[88:91], v253, s[20:23], s33 offen
    buffer_store_dwordx4 v[92:95], v253, s[20:23], s33 offen offset:1024
lc_15:
    v_bfe_u32 v33, v252, 2, 2
    v_lshrrev_b32_e64 v32, 5, v252
    v_lshl_add_u32 v34, v32, 3, v33
    v_lshlrev_b32 v34, 7, v34
    v_lshrrev_b32 v33, 1, v33
    v_lshl_add_u32 v34, v33, 6, v34
    v_bfe_u32 v33, v252, 4, 1
    v_lshl_add_u32 v34, v33, 5, v34
    v_and_b32_e64 v33, 3, v252
    v_lshl_add_u32 v56, v33, 3, v34
    v_xor_b32_e64 v57, 64, v56
    v_add_u32 v58, 0x10000, v56
    v_add_u32 v59, 0x10000, v57
    v_and_b32 v60, 15, v252
    v_lshlrev_b32 v60, 2, v60
    s_waitcnt vmcnt(2)
    s_and_b32 s35, s99, 3
    s_cmp_lg_u32 s35, 0
    s_cbranch_scc1 sk_16
    s_barrier
sk_16:
    v_lshlrev_b32 v0, 16, v208
    v_and_b32 v1, 0xffff0000, v208
    v_lshlrev_b32_e64 v2, 16, v209
    v_and_b32 v3, 0xffff0000, v209
    v_lshlrev_b32_e64 v4, 16, v210
    v_and_b32 v5, 0xffff0000, v210
    v_lshlrev_b32_e64 v6, 16, v211
    v_and_b32 v7, 0xffff0000, v211
    v_lshlrev_b32_e64 v8, 16, v212
    v_and_b32 v9, 0xffff0000, v212
    v_lshlrev_b32_e64 v10, 16, v213
    v_and_b32 v11, 0xffff0000, v213
    v_lshlrev_b32_e64 v12, 16, v214
    v_and_b32 v13, 0xffff0000, v214
    v_lshlrev_b32_e64 v14, 16, v215
    v_and_b32 v15, 0xffff0000, v215
    v_lshlrev_b32_e64 v16, 16, v216
    v_and_b32 v17, 0xffff0000, v216
    v_lshlrev_b32_e64 v18, 16, v217
    v_and_b32 v19, 0xffff0000, v217
    v_lshlrev_b32_e64 v20, 16, v218
    v_and_b32 v21, 0xffff0000, v218
    v_lshlrev_b32_e64 v22, 16, v219
    v_and_b32 v23, 0xffff0000, v219
    v_lshlrev_b32_e64 v24, 16, v220
    v_and_b32 v25, 0xffff0000, v220
    v_lshlrev_b32_e64 v26, 16, v221
    v_and_b32 v27, 0xffff0000, v221
    v_lshlrev_b32_e64 v28, 16, v222
    v_and_b32 v29, 0xffff0000, v222
    v_lshlrev_b32_e64 v30, 16, v223
    v_and_b32 v31, 0xffff0000, v223
    v_pk_fma_f32 v[0:1], v[0:1], v[240:241], v[240:241] op_sel:[0,0,1] op_sel_hi:[1,0,1]
    v_pk_fma_f32 v[2:3], v[2:3], v[240:241], v[240:241] op_sel:[0,0,1] op_sel_hi:[1,0,1]
    v_pk_fma_f32 v[4:5], v[4:5], v[240:241], v[240:241] op_sel:[0,0,1] op_sel_hi:[1,0,1]
    v_pk_fma_f32 v[6:7], v[6:7], v[240:241], v[240:241] op_sel:[0,0,1] op_sel_hi:[1,0,1]
    v_pk_fma_f32 v[8:9], v[8:9], v[240:241], v[240:241] op_sel:[0,0,1] op_sel_hi:[1,0,1]
    v_pk_fma_f32 v[10:11], v[10:11], v[240:241], v[240:241] op_sel:[0,0,1] op_sel_hi:[1,0,1]
    v_pk_fma_f32 v[12:13], v[12:13], v[240:241], v[240:241] op_sel:[0,0,1] op_sel_hi:[1,0,1]
    v_pk_fma_f32 v[14:15], v[14:15], v[240:241], v[240:241] op_sel:[0,0,1] op_sel_hi:[1,0,1]
    v_pk_fma_f32 v[16:17], v[16:17], v[240:241], v[240:241] op_sel:[0,0,1] op_sel_hi:[1,0,1]
    v_pk_fma_f32 v[18:19], v[18:19], v[240:241], v[240:241] op_sel:[0,0,1] op_sel_hi:[1,0,1]
    v_pk_fma_f32 v[20:21], v[20:21], v[240:241], v[240:241] op_sel:[0,0,1] op_sel_hi:[1,0,1]
    v_pk_fma_f32 v[22:23], v[22:23], v[240:241], v[240:241] op_sel:[0,0,1] op_sel_hi:[1,0,1]
    v_pk_fma_f32 v[24:25], v[24:25], v[240:241], v[240:241] op_sel:[0,0,1] op_sel_hi:[1,0,1]
    v_pk_fma_f32 v[26:27], v[26:27], v[240:241], v[240:241] op_sel:[0,0,1] op_sel_hi:[1,0,1]
    v_pk_fma_f32 v[28:29], v[28:29], v[240:241], v[240:241] op_sel:[0,0,1] op_sel_hi:[1,0,1]
    v_pk_fma_f32 v[30:31], v[30:31], v[240:241], v[240:241] op_sel:[0,0,1] op_sel_hi:[1,0,1]
    v_mov_b32_e64 v154, s88
    s_mov_b64 exec, 1
    s_waitcnt vmcnt(0)
    s_cmp_lg_u32 s77, 0
    s_cbranch_scc1 lc_17
    buffer_store_dword v154, v253, s[20:23], s31 offen sc1
    s_branch lc_18
lc_17:
    buffer_store_dword v154, v253, s[20:23], s31 offen
lc_18:
    s_mov_b64 exec, -1
    s_cmp_eq_u32 s35, 0
    s_cbranch_scc1 sk_19
    s_barrier
sk_19:
    s_add_u32 s96, s25, 0
    s_and_b32 s96, s96, 15
    s_lshl_b32 s96, s96, 17
    s_add_u32 s96, s96, 65536
    s_add_u32 m0, s101, 65536
    s_nop 0
    buffer_load_dwordx4 v243, s[8:11], s96 offen lds
    s_add_u32 s96, s25, 1
    s_and_b32 s96, s96, 15
    s_lshl_b32 s96, s96, 17
    s_add_u32 s96, s96, 65536
    s_add_u32 m0, s101, 69632
    s_nop 0
    buffer_load_dwordx4 v243, s[8:11], s96 offen lds
    s_add_u32 s96, s25, 2
    s_and_b32 s96, s96, 15
    s_lshl_b32 s96, s96, 17
    s_add_u32 s96, s96, 65536
    s_add_u32 m0, s101, 73728
    s_nop 0
    buffer_load_dwordx4 v243, s[8:11], s96 offen lds
    s_add_u32 s96, s25, 3
    s_and_b32 s96, s96, 15
    s_lshl_b32 s96, s96, 17
    s_add_u32 s96, s96, 65536
    s_add_u32 m0, s101, 77824
    s_nop 0
    buffer_load_dwordx4 v243, s[8:11], s96 offen lds
    s_add_u32 s96, s25, 4
    s_and_b32 s96, s96, 15
    s_lshl_b32 s96, s96, 17
    s_add_u32 s96, s96, 65536
    s_add_u32 m0, s101, 81920
    s_nop 0
    buffer_load_dwordx4 v243, s[8:11], s96 offen lds
    s_add_u32 s96, s25, 5
    s_and_b32 s96, s96, 15
    s_lshl_b32 s96, s96, 17
    s_add_u32 s96, s96, 65536
    s_add_u32 m0, s101, 86016
    s_nop 0
    buffer_load_dwordx4 v243, s[8:11], s96 offen lds
    s_add_u32 s96, s25, 6
    s_and_b32 s96, s96, 15
    s_lshl_b32 s96, s96, 17
    s_add_u32 s96, s96, 65536
    s_add_u32 m0, s101, 90112
    s_nop 0
    buffer_load_dwordx4 v243, s[8:11], s96 offen lds
    s_add_u32 s96, s25, 7
    s_and_b32 s96, s96, 15
    s_lshl_b32 s96, s96, 17
    s_add_u32 s96, s96, 65536
    s_add_u32 m0, s101, 94208
    s_nop 0
    buffer_load_dwordx4 v243, s[8:11], s96 offen lds
    s_add_u32 s96, s25, 8
    s_and_b32 s96, s96, 15
    s_lshl_b32 s96, s96, 17
    s_add_u32 s96, s96, 65536
    s_add_u32 m0, s101, 98304
    s_nop 0
    buffer_load_dwordx4 v243, s[8:11], s96 offen lds
    s_add_u32 s96, s25, 9
    s_and_b32 s96, s96, 15
    s_lshl_b32 s96, s96, 17
    s_add_u32 s96, s96, 65536
    s_add_u32 m0, s101, 102400
    s_nop 0
    buffer_load_dwordx4 v243, s[8:11], s96 offen lds
    s_add_u32 s96, s25, 10
    s_and_b32 s96, s96, 15
    s_lshl_b32 s96, s96, 17
    s_add_u32 s96, s96, 65536
    s_add_u32 m0, s101, 106496
    s_nop 0
    buffer_load_dwordx4 v243, s[8:11], s96 offen lds
    s_add_u32 s96, s25, 11
    s_and_b32 s96, s96, 15
    s_lshl_b32 s96, s96, 17
    s_add_u32 s96, s96, 65536
    s_add_u32 m0, s101, 110592
    s_nop 0
    buffer_load_dwordx4 v243, s[8:11], s96 offen lds
    v_bfe_u32 v100, v252, 4, 1
    v_lshlrev_b32 v100, 11, v100
    v_lshrrev_b32_e64 v101, 5, v252
    v_lshl_add_u32 v100, v101, 8, v100
    v_and_b32 v101, 15, v252
    v_lshl_add_u32 v100, v101, 4, v100
    s_lshl_b32 s34, s28, 12
    s_add_u32 s34, s34, 147456
    v_add_u32 v101, s34, v100
    s_lshl_b32 s37, s25, 11
    ds_read_b64_tr_b16 v[32:33], v56 offset:0
    ds_read_b64_tr_b16 v[34:35], v56 offset:512
    ds_read_b64_tr_b16 v[36:37], v57 offset:0
    ds_read_b64_tr_b16 v[38:39], v57 offset:512
    ds_read_b64_tr_b16 v[40:41], v56 offset:2048
    ds_read_b64_tr_b16 v[42:43], v56 offset:2560
    ds_read_b64_tr_b16 v[44:45], v57 offset:2048
    ds_read_b64_tr_b16 v[46:47], v57 offset:2560
    s_mov_b32 s78, s27
pl_20:
    buffer_load_dword v61, v60, s[20:23], s30 offen offset:0 sc1
    s_waitcnt vmcnt(0)
pc_21:
    v_cmp_ne_u32_e64 vcc, s88, v61
    s_cbranch_vccz pd_22
    s_sub_u32 s78, s78, 1
    s_cmp_lg_u32 s78, 0
    s_cbranch_scc1 pl_20
    s_mov_b32 s27, 1
pd_22:
    s_add_u32 s38, s36, s37
    buffer_load_dwordx4 v[104:107], v253, s[20:23], s38 offen offset:0 sc1
    s_add_u32 s37, s37, 2048
    s_and_b32 s37, s37, 0x7800
    buffer_load_dwordx4 v[108:111], v253, s[20:23], s38 offen offset:1024 sc1
    s_add_u32 s38, s36, s37
    buffer_load_dwordx4 v[112:115], v253, s[20:23], s38 offen offset:0 sc1
    s_add_u32 s37, s37, 2048
    s_and_b32 s37, s37, 0x7800
    buffer_load_dwordx4 v[116:119], v253, s[20:23], s38 offen offset:1024 sc1
    s_add_u32 s38, s36, s37
    buffer_load_dwordx4 v[120:123], v253, s[20:23], s38 offen offset:0 sc1
    s_add_u32 s37, s37, 2048
    s_and_b32 s37, s37, 0x7800
    buffer_load_dwordx4 v[124:127], v253, s[20:23], s38 offen offset:1024 sc1
    s_add_u32 s38, s36, s37
    buffer_load_dwordx4 v[128:131], v253, s[20:23], s38 offen offset:0 sc1
    s_add_u32 s37, s37, 2048
    s_and_b32 s37, s37, 0x7800
    buffer_load_dwordx4 v[132:135], v253, s[20:23], s38 offen offset:1024 sc1
    s_waitcnt vmcnt(7) lgkmcnt(4)
    v_mfma_f32_32x32x16_bf16 v[0:15], v[32:35], v[104:107], v[0:15]
    s_add_u32 s38, s36, s37
    buffer_load_dwordx4 v[136:139], v253, s[20:23], s38 offen offset:0 sc1
    ds_read_b64_tr_b16 v[48:49], v56 offset:4096
    ds_read_b64_tr_b16 v[50:51], v56 offset:4608
    v_mfma_f32_32x32x16_bf16 v[16:31], v[36:39], v[104:107], v[16:31]
    ds_read_b64_tr_b16 v[52:53], v57 offset:4096
    ds_read_b64_tr_b16 v[54:55], v57 offset:4608
    s_waitcnt vmcnt(7) lgkmcnt(4)
    v_mfma_f32_32x32x16_bf16 v[0:15], v[40:43], v[108:111], v[0:15]
    s_add_u32 s37, s37, 2048
    s_and_b32 s37, s37, 0x7800
    buffer_load_dwordx4 v[104:107], v253, s[20:23], s38 offen offset:1024 sc1
    ds_read_b64_tr_b16 v[32:33], v56 offset:6144
    ds_read_b64_tr_b16 v[34:35], v56 offset:6656
    v_mfma_f32_32x32x16_bf16 v[16:31], v[44:47], v[108:111], v[16:31]
    ds_read_b64_tr_b16 v[36:37], v57 offset:6144
    ds_read_b64_tr_b16 v[38:39], v57 offset:6656
    s_waitcnt vmcnt(7) lgkmcnt(4)
    v_mfma_f32_32x32x16_bf16 v[0:15], v[48:51], v[112:115], v[0:15]
    s_add_u32 s38, s36, s37
    buffer_load_dwordx4 v[108:111], v253, s[20:23], s38 offen offset:0 sc1
    ds_read_b64_tr_b16 v[40:41], v56 offset:8192
    ds_read_b64_tr_b16 v[42:43], v56 offset:8704
    v_mfma_f32_32x32x16_bf16 v[16:31], v[52:55], v[112:115], v[16:31]
    ds_read_b64_tr_b16 v[44:45], v57 offset:8192
    ds_read_b64_tr_b16 v[46:47], v57 offset:8704
    s_waitcnt vmcnt(7) lgkmcnt(4)
    v_mfma_f32_32x32x16_bf16 v[0:15], v[32:35], v[116:119], v[0:15]
    s_add_u32 s37, s37, 2048
    s_and_b32 s37, s37, 0x7800
    buffer_load_dwordx4 v[112:115], v253, s[20:23], s38 offen offset:1024 sc1
    ds_read_b64_tr_b16 v[48:49], v56 offset:10240
    ds_read_b64_tr_b16 v[50:51], v56 offset:10752
    v_mfma_f32_32x32x16_bf16 v[16:31], v[36:39], v[116:119], v[16:31]
    ds_read_b64_tr_b16 v[52:53], v57 offset:10240
    ds_read_b64_tr_b16 v[54:55], v57 offset:10752
    s_waitcnt vmcnt(7) lgkmcnt(4)
    v_mfma_f32_32x32x16_bf16 v[0:15], v[40:43], v[120:123], v[0:15]
    s_add_u32 s38, s36, s37
    buffer_load_dwordx4 v[116:119], v253, s[20:23], s38 offen offset:0 sc1
    ds_read_b64_tr_b16 v[32:33], v56 offset:12288
    ds_read_b64_tr_b16 v[34:35], v56 offset:12800
    v_mfma_f32_32x32x16_bf16 v[16:31], v[44:47], v[120:123], v[16:31]
    ds_read_b64_tr_b16 v[36:37], v57 offset:12288
    ds_read_b64_tr_b16 v[38:39], v57 offset:12800
    s_waitcnt vmcnt(7) lgkmcnt(4)
    v_mfma_f32_32x32x16_bf16 v[0:15], v[48:51], v[124:127], v[0:15]
    s_add_u32 s37, s37, 2048
    s_and_b32 s37, s37, 0x7800
    buffer_load_dwordx4 v[120:123], v253, s[20:23], s38 offen offset:1024 sc1
    ds_read_b64_tr_b16 v[40:41], v56 offset:14336
    ds_read_b64_tr_b16 v[42:43], v56 offset:14848
    v_mfma_f32_32x32x16_bf16 v[16:31], v[52:55], v[124:127], v[16:31]
    ds_read_b64_tr_b16 v[44:45], v57 offset:14336
    ds_read_b64_tr_b16 v[46:47], v57 offset:14848
    s_waitcnt vmcnt(7) lgkmcnt(4)
    v_mfma_f32_32x32x16_bf16 v[0:15], v[32:35], v[128:131], v[0:15]
    s_add_u32 s38, s36, s37
    buffer_load_dwordx4 v[124:127], v253, s[20:23], s38 offen offset:0 sc1
    ds_read_b64_tr_b16 v[48:49], v56 offset:16384
    ds_read_b64_tr_b16 v[50:51], v56 offset:16896
    v_mfma_f32_32x32x16_bf16 v[16:31], v[36:39], v[128:131], v[16:31]
    ds_read_b64_tr_b16 v[52:53], v57 offset:16384
    ds_read_b64_tr_b16 v[54:55], v57 offset:16896
    s_waitcnt vmcnt(7) lgkmcnt(4)
    v_mfma_f32_32x32x16_bf16 v[0:15], v[40:43], v[132:135], v[0:15]
    s_add_u32 s37, s37, 2048
    s_and_b32 s37, s37, 0x7800
    buffer_load_dwordx4 v[128:131], v253, s[20:23], s38 offen offset:1024 sc1
    ds_read_b64_tr_b16 v[32:33], v56 offset:18432
    ds_read_b64_tr_b16 v[34:35], v56 offset:18944
    v_mfma_f32_32x32x16_bf16 v[16:31], v[44:47], v[132:135], v[16:31]
    ds_read_b64_tr_b16 v[36:37], v57 offset:18432
    ds_read_b64_tr_b16 v[38:39], v57 offset:18944
    s_waitcnt vmcnt(7) lgkmcnt(4)
    v_mfma_f32_32x32x16_bf16 v[0:15], v[48:51], v[136:139], v[0:15]
    s_add_u32 s38, s36, s37
    buffer_load_dwordx4 v[132:135], v253, s[20:23], s38 offen offset:0 sc1
    ds_read_b64_tr_b16 v[40:41], v56 offset:20480
    ds_read_b64_tr_b16 v[42:43], v56 offset:20992
    v_mfma_f32_32x32x16_bf16 v[16:31], v[52:55], v[136:139], v[16:31]
    ds_read_b64_tr_b16 v[44:45], v57 offset:20480
    ds_read_b64_tr_b16 v[46:47], v57 offset:20992
    s_waitcnt vmcnt(7) lgkmcnt(4)
    v_mfma_f32_32x32x16_bf16 v[0:15], v[32:35], v[104:107], v[0:15]
    s_add_u32 s37, s37, 2048
    s_and_b32 s37, s37, 0x7800
    buffer_load_dwordx4 v[136:139], v253, s[20:23], s38 offen offset:1024 sc1
    ds_read_b64_tr_b16 v[48:49], v56 offset:22528
    ds_read_b64_tr_b16 v[50:51], v56 offset:23040
    v_mfma_f32_32x32x16_bf16 v[16:31], v[36:39], v[104:107], v[16:31]
    ds_read_b64_tr_b16 v[52:53], v57 offset:22528
    ds_read_b64_tr_b16 v[54:55], v57 offset:23040
    s_waitcnt vmcnt(7) lgkmcnt(4)
    v_mfma_f32_32x32x16_bf16 v[0:15], v[40:43], v[108:111], v[0:15]
    s_add_u32 s38, s36, s37
    buffer_load_dwordx4 v[104:107], v253, s[20:23], s38 offen offset:0 sc1
    ds_read_b64_tr_b16 v[32:33], v56 offset:24576
    ds_read_b64_tr_b16 v[34:35], v56 offset:25088
    v_mfma_f32_32x32x16_bf16 v[16:31], v[44:47], v[108:111], v[16:31]
    ds_read_b64_tr_b16 v[36:37], v57 offset:24576
    ds_read_b64_tr_b16 v[38:39], v57 offset:25088
    s_waitcnt vmcnt(7) lgkmcnt(4)
    v_mfma_f32_32x32x16_bf16 v[0:15], v[48:51], v[112:115], v[0:15]
    s_add_u32 s37, s37, 2048
    s_and_b32 s37, s37, 0x7800
    buffer_load_dwordx4 v[108:111], v253, s[20:23], s38 offen offset:1024 sc1
    ds_read_b64_tr_b16 v[40:41], v56 offset:26624
    ds_read_b64_tr_b16 v[42:43], v56 offset:27136
    v_mfma_f32_32x32x16_bf16 v[16:31], v[52:55], v[112:115], v[16:31]
    ds_read_b64_tr_b16 v[44:45], v57 offset:26624
    ds_read_b64_tr_b16 v[46:47], v57 offset:27136
    s_waitcnt vmcnt(7) lgkmcnt(4)
    v_mfma_f32_32x32x16_bf16 v[0:15], v[32:35], v[116:119], v[0:15]
    s_add_u32 s38, s36, s37
    buffer_load_dwordx4 v[112:115], v253, s[20:23], s38 offen offset:0 sc1
    ds_read_b64_tr_b16 v[48:49], v56 offset:28672
    ds_read_b64_tr_b16 v[50:51], v56 offset:29184
    v_mfma_f32_32x32x16_bf16 v[16:31], v[36:39], v[116:119], v[16:31]
    ds_read_b64_tr_b16 v[52:53], v57 offset:28672
    ds_read_b64_tr_b16 v[54:55], v57 offset:29184
    s_waitcnt vmcnt(7) lgkmcnt(4)
    v_mfma_f32_32x32x16_bf16 v[0:15], v[40:43], v[120:123], v[0:15]
    s_add_u32 s37, s37, 2048
    s_and_b32 s37, s37, 0x7800
    buffer_load_dwordx4 v[116:119], v253, s[20:23], s38 offen offset:1024 sc1
    ds_read_b64_tr_b16 v[32:33], v56 offset:30720
    ds_read_b64_tr_b16 v[34:35], v56 offset:31232
    v_mfma_f32_32x32x16_bf16 v[16:31], v[44:47], v[120:123], v[16:31]
    ds_read_b64_tr_b16 v[36:37], v57 offset:30720
    ds_read_b64_tr_b16 v[38:39], v57 offset:31232
    s_waitcnt vmcnt(7) lgkmcnt(4)
    v_mfma_f32_32x32x16_bf16 v[0:15], v[48:51], v[124:127], v[0:15]
    s_add_u32 s38, s36, s37
    buffer_load_dwordx4 v[120:123], v253, s[20:23], s38 offen offset:0 sc1
    ds_read_b64_tr_b16 v[40:41], v56 offset:32768
    ds_read_b64_tr_b16 v[42:43], v56 offset:33280
    v_mfma_f32_32x32x16_bf16 v[16:31], v[52:55], v[124:127], v[16:31]
    ds_read_b64_tr_b16 v[44:45], v57 offset:32768
    ds_read_b64_tr_b16 v[46:47], v57 offset:33280
    s_waitcnt vmcnt(7) lgkmcnt(4)
    v_mfma_f32_32x32x16_bf16 v[0:15], v[32:35], v[128:131], v[0:15]
    s_add_u32 s37, s37, 2048
    s_and_b32 s37, s37, 0x7800
    buffer_load_dwordx4 v[124:127], v253, s[20:23], s38 offen offset:1024 sc1
    ds_read_b64_tr_b16 v[48:49], v56 offset:34816
    ds_read_b64_tr_b16 v[50:51], v56 offset:35328
    v_mfma_f32_32x32x16_bf16 v[16:31], v[36:39], v[128:131], v[16:31]
    ds_read_b64_tr_b16 v[52:53], v57 offset:34816
    ds_read_b64_tr_b16 v[54:55], v57 offset:35328
    s_waitcnt vmcnt(7) lgkmcnt(4)
    v_mfma_f32_32x32x16_bf16 v[0:15], v[40:43], v[132:135], v[0:15]
    s_add_u32 s38, s36, s37
    buffer_load_dwordx4 v[128:131], v253, s[20:23], s38 offen offset:0 sc1
    ds_read_b64_tr_b16 v[32:33], v56 offset:36864
    ds_read_b64_tr_b16 v[34:35], v56 offset:37376
    v_mfma_f32_32x32x16_bf16 v[16:31], v[44:47], v[132:135], v[16:31]
    ds_read_b64_tr_b16 v[36:37], v57 offset:36864
    ds_read_b64_tr_b16 v[38:39], v57 offset:37376
    s_waitcnt vmcnt(7) lgkmcnt(4)
    v_mfma_f32_32x32x16_bf16 v[0:15], v[48:51], v[136:139], v[0:15]
    s_add_u32 s37, s37, 2048
    s_and_b32 s37, s37, 0x7800
    buffer_load_dwordx4 v[132:135], v253, s[20:23], s38 offen offset:1024 sc1
    ds_read_b64_tr_b16 v[40:41], v56 offset:38912
    ds_read_b64_tr_b16 v[42:43], v56 offset:39424
    v_mfma_f32_32x32x16_bf16 v[16:31], v[52:55], v[136:139], v[16:31]
    ds_read_b64_tr_b16 v[44:45], v57 offset:38912
    ds_read_b64_tr_b16 v[46:47], v57 offset:39424
    s_waitcnt vmcnt(7) lgkmcnt(4)
    v_mfma_f32_32x32x16_bf16 v[0:15], v[32:35], v[104:107], v[0:15]
    s_add_u32 s38, s36, s37
    buffer_load_dwordx4 v[136:139], v253, s[20:23], s38 offen offset:0 sc1
    ds_read_b64_tr_b16 v[48:49], v56 offset:40960
    ds_read_b64_tr_b16 v[50:51], v56 offset:41472
    v_mfma_f32_32x32x16_bf16 v[16:31], v[36:39], v[104:107], v[16:31]
    ds_read_b64_tr_b16 v[52:53], v57 offset:40960
    ds_read_b64_tr_b16 v[54:55], v57 offset:41472
    s_waitcnt vmcnt(7) lgkmcnt(4)
    v_mfma_f32_32x32x16_bf16 v[0:15], v[40:43], v[108:111], v[0:15]
    s_add_u32 s37, s37, 2048
    s_and_b32 s37, s37, 0x7800
    buffer_load_dwordx4 v[104:107], v253, s[20:23], s38 offen offset:1024 sc1
    ds_read_b64_tr_b16 v[32:33], v56 offset:43008
    ds_read_b64_tr_b16 v[34:35], v56 offset:43520
    v_mfma_f32_32x32x16_bf16 v[16:31], v[44:47], v[108:111], v[16:31]
    ds_read_b64_tr_b16 v[36:37], v57 offset:43008
    ds_read_b64_tr_b16 v[38:39], v57 offset:43520
    s_waitcnt vmcnt(7) lgkmcnt(4)
    v_mfma_f32_32x32x16_bf16 v[0:15], v[48:51], v[112:115], v[0:15]
    buffer_load_dword v61, v60, s[20:23], s30 offen offset:256 sc1
    s_add_u32 s38, s36, s37
    buffer_load_dwordx4 v[108:111], v253, s[20:23], s38 offen offset:0 sc1
    ds_read_b64_tr_b16 v[40:41], v56 offset:45056
    ds_read_b64_tr_b16 v[42:43], v56 offset:45568
    v_mfma_f32_32x32x16_bf16 v[16:31], v[52:55], v[112:115], v[16:31]
    ds_read_b64_tr_b16 v[44:45], v57 offset:45056
    ds_read_b64_tr_b16 v[46:47], v57 offset:45568
    s_waitcnt vmcnt(8) lgkmcnt(4)
    v_mfma_f32_32x32x16_bf16 v[0:15], v[32:35], v[116:119], v[0:15]
    s_add_u32 s37, s37, 2048
    s_and_b32 s37, s37, 0x7800
    buffer_load_dwordx4 v[112:115], v253, s[20:23], s38 offen offset:1024 sc1
    ds_read_b64_tr_b16 v[48:49], v56 offset:47104
    ds_read_b64_tr_b16 v[50:51], v56 offset:47616
    v_mfma_f32_32x32x16_bf16 v[16:31], v[36:39], v[116:119], v[16:31]
    ds_read_b64_tr_b16 v[52:53], v57 offset:47104
    ds_read_b64_tr_b16 v[54:55], v57 offset:47616
    s_waitcnt vmcnt(8) lgkmcnt(4)
    v_mfma_f32_32x32x16_bf16 v[0:15], v[40:43], v[120:123], v[0:15]
    s_add_u32 s38, s36, s37
    buffer_load_dwordx4 v[116:119], v253, s[20:23], s38 offen offset:0 sc1
    ds_read_b64_tr_b16 v[32:33], v56 offset:49152
    ds_read_b64_tr_b16 v[34:35], v56 offset:49664
    v_mfma_f32_32x32x16_bf16 v[16:31], v[44:47], v[120:123], v[16:31]
    ds_read_b64_tr_b16 v[36:37], v57 offset:49152
    ds_read_b64_tr_b16 v[38:39], v57 offset:49664
    s_waitcnt vmcnt(8) lgkmcnt(4)
    v_mfma_f32_32x32x16_bf16 v[0:15], v[48:51], v[124:127], v[0:15]
    s_add_u32 s37, s37, 2048
    s_and_b32 s37, s37, 0x7800
    buffer_load_dwordx4 v[120:123], v253, s[20:23], s38 offen offset:1024 sc1
    ds_read_b64_tr_b16 v[40:41], v56 offset:51200
    ds_read_b64_tr_b16 v[42:43], v56 offset:51712
    v_mfma_f32_32x32x16_bf16 v[16:31], v[52:55], v[124:127], v[16:31]
    ds_read_b64_tr_b16 v[44:45], v57 offset:51200
    ds_read_b64_tr_b16 v[46:47], v57 offset:51712
    s_waitcnt vmcnt(8) lgkmcnt(4)
    v_mfma_f32_32x32x16_bf16 v[0:15], v[32:35], v[128:131], v[0:15]
    s_mov_b32 s78, s27
    s_waitcnt vmcnt(4)
    s_branch pc_24
pl_23:
    buffer_load_dword v61, v60, s[20:23], s30 offen offset:256 sc1
    s_waitcnt vmcnt(0)
pc_24:
    v_cmp_ne_u32 vcc, s88, v61
    s_cbranch_vccz pd_25
    s_sub_u32 s78, s78, 1
    s_cmp_lg_u32 s78, 0
    s_cbranch_scc1 pl_23
    s_mov_b32 s27, 1
pd_25:
    s_add_u32 s36, s36, 32768
    s_add_u32 s38, s36, s37
    buffer_load_dwordx4 v[124:127], v253, s[20:23], s38 offen offset:0 sc1
    ds_read_b64_tr_b16 v[48:49], v56 offset:53248
    ds_read_b64_tr_b16 v[50:51], v56 offset:53760
    v_mfma_f32_32x32x16_bf16 v[16:31], v[36:39], v[128:131], v[16:31]
    ds_read_b64_tr_b16 v[52:53], v57 offset:53248
    ds_read_b64_tr_b16 v[54:55], v57 offset:53760
    s_waitcnt vmcnt(8) lgkmcnt(4)
    v_mfma_f32_32x32x16_bf16 v[0:15], v[40:43], v[132:135], v[0:15]
    s_add_u32 s37, s37, 2048
    s_and_b32 s37, s37, 0x7800
    buffer_load_dwordx4 v[128:131], v253, s[20:23], s38 offen offset:1024 sc1
    ds_read_b64_tr_b16 v[32:33], v56 offset:55296
    ds_read_b64_tr_b16 v[34:35], v56 offset:55808
    v_mfma_f32_32x32x16_bf16 v[16:31], v[44:47], v[132:135], v[16:31]
    ds_read_b64_tr_b16 v[36:37], v57 offset:55296
    ds_read_b64_tr_b16 v[38:39], v57 offset:55808
    s_waitcnt vmcnt(8) lgkmcnt(4)
    v_mfma_f32_32x32x16_bf16 v[0:15], v[48:51], v[136:139], v[0:15]
    s_add_u32 s38, s36, s37
    buffer_load_dwordx4 v[132:135], v253, s[20:23], s38 offen offset:0 sc1
    ds_read_b64_tr_b16 v[40:41], v56 offset:57344
    ds_read_b64_tr_b16 v[42:43], v56 offset:57856
    v_mfma_f32_32x32x16_bf16 v[16:31], v[52:55], v[136:139], v[16:31]
    ds_read_b64_tr_b16 v[44:45], v57 offset:57344
    ds_read_b64_tr_b16 v[46:47], v57 offset:57856
    s_waitcnt vmcnt(8) lgkmcnt(4)
    v_mfma_f32_32x32x16_bf16 v[0:15], v[32:35], v[104:107], v[0:15]
    s_add_u32 s37, s37, 2048
    s_and_b32 s37, s37, 0x7800
    buffer_load_dwordx4 v[136:139], v253, s[20:23], s38 offen offset:1024 sc1
    ds_read_b64_tr_b16 v[48:49], v56 offset:59392
    ds_read_b64_tr_b16 v[50:51], v56 offset:59904
    v_mfma_f32_32x32x16_bf16 v[16:31], v[36:39], v[104:107], v[16:31]
    ds_read_b64_tr_b16 v[52:53], v57 offset:59392
    ds_read_b64_tr_b16 v[54:55], v57 offset:59904
    s_waitcnt vmcnt(7) lgkmcnt(4)
    v_mfma_f32_32x32x16_bf16 v[0:15], v[40:43], v[108:111], v[0:15]
    s_add_u32 s38, s36, s37
    buffer_load_dwordx4 v[104:107], v253, s[20:23], s38 offen offset:0 sc1
    ds_read_b64_tr_b16 v[32:33], v56 offset:61440
    ds_read_b64_tr_b16 v[34:35], v56 offset:61952
    v_mfma_f32_32x32x16_bf16 v[16:31], v[44:47], v[108:111], v[16:31]
    ds_read_b64_tr_b16 v[36:37], v57 offset:61440
    ds_read_b64_tr_b16 v[38:39], v57 offset:61952
    s_waitcnt vmcnt(7) lgkmcnt(4)
    v_mfma_f32_32x32x16_bf16 v[0:15], v[48:51], v[112:115], v[0:15]
    s_add_u32 s37, s37, 2048
    s_and_b32 s37, s37, 0x7800
    buffer_load_dwordx4 v[108:111], v253, s[20:23], s38 offen offset:1024 sc1
    ds_read_b64_tr_b16 v[40:41], v56 offset:63488
    ds_read_b64_tr_b16 v[42:43], v56 offset:64000
    v_mfma_f32_32x32x16_bf16 v[16:31], v[52:55], v[112:115], v[16:31]
    ds_read_b64_tr_b16 v[44:45], v57 offset:63488
    ds_read_b64_tr_b16 v[46:47], v57 offset:64000
    s_barrier
    s_waitcnt vmcnt(7) lgkmcnt(4)
    v_mfma_f32_32x32x16_bf16 v[0:15], v[32:35], v[116:119], v[0:15]
    s_add_u32 s38, s36, s37
    buffer_load_dwordx4 v[112:115], v253, s[20:23], s38 offen offset:0 sc1
    ds_read_b64_tr_b16 v[48:49], v58 offset:0
    ds_read_b64_tr_b16 v[50:51], v58 offset:512
    v_mfma_f32_32x32x16_bf16 v[16:31], v[36:39], v[116:119], v[16:31]
    ds_read_b64_tr_b16 v[52:53], v59 offset:0
    ds_read_b64_tr_b16 v[54:55], v59 offset:512
    s_waitcnt vmcnt(7) lgkmcnt(4)
    v_mfma_f32_32x32x16_bf16 v[0:15], v[40:43], v[120:123], v[0:15]
    s_add_u32 s37, s37, 2048
    s_and_b32 s37, s37, 0x7800
    buffer_load_dwordx4 v[116:119], v253, s[20:23], s38 offen offset:1024 sc1
    ds_read_b64_tr_b16 v[32:33], v58 offset:2048
    ds_read_b64_tr_b16 v[34:35], v58 offset:2560
    v_mfma_f32_32x32x16_bf16 v[16:31], v[44:47], v[120:123], v[16:31]
    ds_read_b64_tr_b16 v[36:37], v59 offset:2048
    ds_read_b64_tr_b16 v[38:39], v59 offset:2560
    s_waitcnt vmcnt(7) lgkmcnt(4)
    v_mfma_f32_32x32x16_bf16 v[0:15], v[48:51], v[124:127], v[0:15]
    s_add_u32 s38, s36, s37
    buffer_load_dwordx4 v[120:123], v253, s[20:23], s38 offen offset:0 sc1
    ds_read_b64_tr_b16 v[40:41], v58 offset:4096
    ds_read_b64_tr_b16 v[42:43], v58 offset:4608
    v_mfma_f32_32x32x16_bf16 v[16:31], v[52:55], v[124:127], v[16:31]
    ds_read_b64_tr_b16 v[44:45], v59 offset:4096
    ds_read_b64_tr_b16 v[46:47], v59 offset:4608
    s_waitcnt vmcnt(7) lgkmcnt(4)
    v_mfma_f32_32x32x16_bf16 v[0:15], v[32:35], v[128:131], v[0:15]
    s_add_u32 s37, s37, 2048
    s_and_b32 s37, s37, 0x7800
    buffer_load_dwordx4 v[124:127], v253, s[20:23], s38 offen offset:1024 sc1
    ds_read_b64_tr_b16 v[48:49], v58 offset:6144
    ds_read_b64_tr_b16 v[50:51], v58 offset:6656
    v_mfma_f32_32x32x16_bf16 v[16:31], v[36:39], v[128:131], v[16:31]
    ds_read_b64_tr_b16 v[52:53], v59 offset:6144
    ds_read_b64_tr_b16 v[54:55], v59 offset:6656
    s_waitcnt vmcnt(7) lgkmcnt(4)
    v_mfma_f32_32x32x16_bf16 v[0:15], v[40:43], v[132:135], v[0:15]
    s_add_u32 s38, s36, s37
    buffer_load_dwordx4 v[128:131], v253, s[20:23], s38 offen offset:0 sc1
    ds_read_b64_tr_b16 v[32:33], v58 offset:8192
    ds_read_b64_tr_b16 v[34:35], v58 offset:8704
    v_mfma_f32_32x32x16_bf16 v[16:31], v[44:47], v[132:135], v[16:31]
    ds_read_b64_tr_b16 v[36:37], v59 offset:8192
    ds_read_b64_tr_b16 v[38:39], v59 offset:8704
    s_waitcnt vmcnt(7) lgkmcnt(4)
    v_mfma_f32_32x32x16_bf16 v[0:15], v[48:51], v[136:139], v[0:15]
    s_add_u32 s37, s37, 2048
    s_and_b32 s37, s37, 0x7800
    buffer_load_dwordx4 v[132:135], v253, s[20:23], s38 offen offset:1024 sc1
    ds_read_b64_tr_b16 v[40:41], v58 offset:10240
    ds_read_b64_tr_b16 v[42:43], v58 offset:10752
    v_mfma_f32_32x32x16_bf16 v[16:31], v[52:55], v[136:139], v[16:31]
    ds_read_b64_tr_b16 v[44:45], v59 offset:10240
    ds_read_b64_tr_b16 v[46:47], v59 offset:10752
    s_waitcnt vmcnt(7) lgkmcnt(4)
    v_mfma_f32_32x32x16_bf16 v[0:15], v[32:35], v[104:107], v[0:15]
    s_add_u32 s38, s36, s37
    buffer_load_dwordx4 v[136:139], v253, s[20:23], s38 offen offset:0 sc1
    ds_read_b64_tr_b16 v[48:49], v58 offset:12288
    ds_read_b64_tr_b16 v[50:51], v58 offset:12800
    v_mfma_f32_32x32x16_bf16 v[16:31], v[36:39], v[104:107], v[16:31]
    ds_read_b64_tr_b16 v[52:53], v59 offset:12288
    ds_read_b64_tr_b16 v[54:55], v59 offset:12800
    s_waitcnt vmcnt(7) lgkmcnt(4)
    v_mfma_f32_32x32x16_bf16 v[0:15], v[40:43], v[108:111], v[0:15]
    s_add_u32 s37, s37, 2048
    s_and_b32 s37, s37, 0x7800
    buffer_load_dwordx4 v[104:107], v253, s[20:23], s38 offen offset:1024 sc1
    ds_read_b64_tr_b16 v[32:33], v58 offset:14336
    ds_read_b64_tr_b16 v[34:35], v58 offset:14848
    v_mfma_f32_32x32x16_bf16 v[16:31], v[44:47], v[108:111], v[16:31]
    ds_read_b64_tr_b16 v[36:37], v59 offset:14336
    ds_read_b64_tr_b16 v[38:39], v59 offset:14848
    s_waitcnt vmcnt(7) lgkmcnt(4)
    v_mfma_f32_32x32x16_bf16 v[0:15], v[48:51], v[112:115], v[0:15]
    s_add_u32 s38, s36, s37
    buffer_load_dwordx4 v[108:111], v253, s[20:23], s38 offen offset:0 sc1
    ds_read_b64_tr_b16 v[40:41], v58 offset:16384
    ds_read_b64_tr_b16 v[42:43], v58 offset:16896
    v_mfma_f32_32x32x16_bf16 v[16:31], v[52:55], v[112:115], v[16:31]
    ds_read_b64_tr_b16 v[44:45], v59 offset:16384
    ds_read_b64_tr_b16 v[46:47], v59 offset:16896
    s_waitcnt vmcnt(7) lgkmcnt(4)
    v_mfma_f32_32x32x16_bf16 v[0:15], v[32:35], v[116:119], v[0:15]
    s_add_u32 s37, s37, 2048
    s_and_b32 s37, s37, 0x7800
    buffer_load_dwordx4 v[112:115], v253, s[20:23], s38 offen offset:1024 sc1
    ds_read_b64_tr_b16 v[48:49], v58 offset:18432
    ds_read_b64_tr_b16 v[50:51], v58 offset:18944
    v_mfma_f32_32x32x16_bf16 v[16:31], v[36:39], v[116:119], v[16:31]
    ds_read_b64_tr_b16 v[52:53], v59 offset:18432
    ds_read_b64_tr_b16 v[54:55], v59 offset:18944
    s_waitcnt vmcnt(7) lgkmcnt(4)
    v_mfma_f32_32x32x16_bf16 v[0:15], v[40:43], v[120:123], v[0:15]
    s_add_u32 s38, s36, s37
    buffer_load_dwordx4 v[116:119], v253, s[20:23], s38 offen offset:0 sc1
    ds_read_b64_tr_b16 v[32:33], v58 offset:20480
    ds_read_b64_tr_b16 v[34:35], v58 offset:20992
    v_mfma_f32_32x32x16_bf16 v[16:31], v[44:47], v[120:123], v[16:31]
    ds_read_b64_tr_b16 v[36:37], v59 offset:20480
    ds_read_b64_tr_b16 v[38:39], v59 offset:20992
    s_waitcnt vmcnt(7) lgkmcnt(4)
    v_mfma_f32_32x32x16_bf16 v[0:15], v[48:51], v[124:127], v[0:15]
    s_add_u32 s37, s37, 2048
    s_and_b32 s37, s37, 0x7800
    buffer_load_dwordx4 v[120:123], v253, s[20:23], s38 offen offset:1024 sc1
    ds_read_b64_tr_b16 v[40:41], v58 offset:22528
    ds_read_b64_tr_b16 v[42:43], v58 offset:23040
    v_mfma_f32_32x32x16_bf16 v[16:31], v[52:55], v[124:127], v[16:31]
    ds_read_b64_tr_b16 v[44:45], v59 offset:22528
    ds_read_b64_tr_b16 v[46:47], v59 offset:23040
    s_waitcnt vmcnt(7) lgkmcnt(4)
    v_mfma_f32_32x32x16_bf16 v[0:15], v[32:35], v[128:131], v[0:15]
    s_add_u32 s38, s36, s37
    buffer_load_dwordx4 v[124:127], v253, s[20:23], s38 offen offset:0 sc1
    ds_read_b64_tr_b16 v[48:49], v58 offset:24576
    ds_read_b64_tr_b16 v[50:51], v58 offset:25088
    v_mfma_f32_32x32x16_bf16 v[16:31], v[36:39], v[128:131], v[16:31]
    ds_read_b64_tr_b16 v[52:53], v59 offset:24576
    ds_read_b64_tr_b16 v[54:55], v59 offset:25088
    s_waitcnt vmcnt(7) lgkmcnt(4)
    v_mfma_f32_32x32x16_bf16 v[0:15], v[40:43], v[132:135], v[0:15]
    s_add_u32 s37, s37, 2048
    s_and_b32 s37, s37, 0x7800
    buffer_load_dwordx4 v[128:131], v253, s[20:23], s38 offen offset:1024 sc1
    ds_read_b64_tr_b16 v[32:33], v58 offset:26624
    ds_read_b64_tr_b16 v[34:35], v58 offset:27136
    v_mfma_f32_32x32x16_bf16 v[16:31], v[44:47], v[132:135], v[16:31]
    ds_read_b64_tr_b16 v[36:37], v59 offset:26624
    ds_read_b64_tr_b16 v[38:39], v59 offset:27136
    s_waitcnt vmcnt(7) lgkmcnt(4)
    v_mfma_f32_32x32x16_bf16 v[0:15], v[48:51], v[136:139], v[0:15]
    s_add_u32 s38, s36, s37
    buffer_load_dwordx4 v[132:135], v253, s[20:23], s38 offen offset:0 sc1
    ds_read_b64_tr_b16 v[40:41], v58 offset:28672
    ds_read_b64_tr_b16 v[42:43], v58 offset:29184
    v_mfma_f32_32x32x16_bf16 v[16:31], v[52:55], v[136:139], v[16:31]
    ds_read_b64_tr_b16 v[44:45], v59 offset:28672
    ds_read_b64_tr_b16 v[46:47], v59 offset:29184
    s_waitcnt vmcnt(7) lgkmcnt(4)
    v_mfma_f32_32x32x16_bf16 v[0:15], v[32:35], v[104:107], v[0:15]
    s_add_u32 s37, s37, 2048
    s_and_b32 s37, s37, 0x7800
    buffer_load_dwordx4 v[136:139], v253, s[20:23], s38 offen offset:1024 sc1
    ds_read_b64_tr_b16 v[48:49], v58 offset:30720
    ds_read_b64_tr_b16 v[50:51], v58 offset:31232
    v_mfma_f32_32x32x16_bf16 v[16:31], v[36:39], v[104:107], v[16:31]
    ds_read_b64_tr_b16 v[52:53], v59 offset:30720
    ds_read_b64_tr_b16 v[54:55], v59 offset:31232
    s_waitcnt vmcnt(7) lgkmcnt(4)
    v_mfma_f32_32x32x16_bf16 v[0:15], v[40:43], v[108:111], v[0:15]
    s_add_u32 s38, s36, s37
    buffer_load_dwordx4 v[104:107], v253, s[20:23], s38 offen offset:0 sc1
    ds_read_b64_tr_b16 v[32:33], v58 offset:32768
    ds_read_b64_tr_b16 v[34:35], v58 offset:33280
    v_mfma_f32_32x32x16_bf16 v[16:31], v[44:47], v[108:111], v[16:31]
    ds_read_b64_tr_b16 v[36:37], v59 offset:32768
    ds_read_b64_tr_b16 v[38:39], v59 offset:33280
    s_waitcnt vmcnt(7) lgkmcnt(4)
    v_mfma_f32_32x32x16_bf16 v[0:15], v[48:51], v[112:115], v[0:15]
    s_add_u32 s37, s37, 2048
    s_and_b32 s37, s37, 0x7800
    buffer_load_dwordx4 v[108:111], v253, s[20:23], s38 offen offset:1024 sc1
    ds_read_b64_tr_b16 v[40:41], v58 offset:34816
    ds_read_b64_tr_b16 v[42:43], v58 offset:35328
    v_mfma_f32_32x32x16_bf16 v[16:31], v[52:55], v[112:115], v[16:31]
    ds_read_b64_tr_b16 v[44:45], v59 offset:34816
    ds_read_b64_tr_b16 v[46:47], v59 offset:35328
    s_waitcnt vmcnt(7) lgkmcnt(4)
    v_mfma_f32_32x32x16_bf16 v[0:15], v[32:35], v[116:119], v[0:15]
    s_add_u32 s38, s36, s37
    buffer_load_dwordx4 v[112:115], v253, s[20:23], s38 offen offset:0 sc1
    ds_read_b64_tr_b16 v[48:49], v58 offset:36864
    ds_read_b64_tr_b16 v[50:51], v58 offset:37376
    v_mfma_f32_32x32x16_bf16 v[16:31], v[36:39], v[116:119], v[16:31]
    ds_read_b64_tr_b16 v[52:53], v59 offset:36864
    ds_read_b64_tr_b16 v[54:55], v59 offset:37376
    s_waitcnt vmcnt(7) lgkmcnt(4)
    v_mfma_f32_32x32x16_bf16 v[0:15], v[40:43], v[120:123], v[0:15]
    s_add_u32 s37, s37, 2048
    s_and_b32 s37, s37, 0x7800
    buffer_load_dwordx4 v[116:119], v253, s[20:23], s38 offen offset:1024 sc1
    ds_read_b64_tr_b16 v[32:33], v58 offset:38912
    ds_read_b64_tr_b16 v[34:35], v58 offset:39424
    v_mfma_f32_32x32x16_bf16 v[16:31], v[44:47], v[120:123], v[16:31]
    ds_read_b64_tr_b16 v[36:37], v59 offset:38912
    ds_read_b64_tr_b16 v[38:39], v59 offset:39424
    s_waitcnt vmcnt(7) lgkmcnt(4)
    v_mfma_f32_32x32x16_bf16 v[0:15], v[48:51], v[124:127], v[0:15]
    s_add_u32 s38, s36, s37
    buffer_load_dwordx4 v[120:123], v253, s[20:23], s38 offen offset:0 sc1
    ds_read_b64_tr_b16 v[40:41], v58 offset:40960
    ds_read_b64_tr_b16 v[42:43], v58 offset:41472
    v_mfma_f32_32x32x16_bf16 v[16:31], v[52:55], v[124:127], v[16:31]
    ds_read_b64_tr_b16 v[44:45], v59 offset:40960
    ds_read_b64_tr_b16 v[46:47], v59 offset:41472
    s_waitcnt vmcnt(7) lgkmcnt(4)
    v_mfma_f32_32x32x16_bf16 v[0:15], v[32:35], v[128:131], v[0:15]
    s_add_u32 s37, s37, 2048
    s_and_b32 s37, s37, 0x7800
    buffer_load_dwordx4 v[124:127], v253, s[20:23], s38 offen offset:1024 sc1
    ds_read_b64_tr_b16 v[48:49], v58 offset:43008
    ds_read_b64_tr_b16 v[50:51], v58 offset:43520
    v_mfma_f32_32x32x16_bf16 v[16:31], v[36:39], v[128:131], v[16:31]
    ds_read_b64_tr_b16 v[52:53], v59 offset:43008
    ds_read_b64_tr_b16 v[54:55], v59 offset:43520
    s_waitcnt vmcnt(7) lgkmcnt(4)
    v_mfma_f32_32x32x16_bf16 v[0:15], v[40:43], v[132:135], v[0:15]
    s_add_u32 s38, s36, s37
    buffer_load_dwordx4 v[128:131], v253, s[20:23], s38 offen offset:0 sc1
    ds_read_b64_tr_b16 v[32:33], v58 offset:45056
    ds_read_b64_tr_b16 v[34:35], v58 offset:45568
    v_mfma_f32_32x32x16_bf16 v[16:31], v[44:47], v[132:135], v[16:31]
    ds_read_b64_tr_b16 v[36:37], v59 offset:45056
    ds_read_b64_tr_b16 v[38:39], v59 offset:45568
    s_waitcnt vmcnt(7) lgkmcnt(4)
    v_mfma_f32_32x32x16_bf16 v[0:15], v[48:51], v[136:139], v[0:15]
    s_add_u32 s37, s37, 2048
    s_and_b32 s37, s37, 0x7800
    buffer_load_dwordx4 v[132:135], v253, s[20:23], s38 offen offset:1024 sc1
    ds_read_b64_tr_b16 v[40:41], v58 offset:47104
    ds_read_b64_tr_b16 v[42:43], v58 offset:47616
    v_mfma_f32_32x32x16_bf16 v[16:31], v[52:55], v[136:139], v[16:31]
    ds_read_b64_tr_b16 v[44:45], v59 offset:47104
    ds_read_b64_tr_b16 v[46:47], v59 offset:47616
    s_barrier
    s_waitcnt vmcnt(7) lgkmcnt(4)
    v_mfma_f32_32x32x16_bf16 v[0:15], v[32:35], v[104:107], v[0:15]
    s_add_u32 s38, s36, s37
    buffer_load_dwordx4 v[136:139], v253, s[20:23], s38 offen offset:0 sc1
    ds_read_b64_tr_b16 v[48:49], v58 offset:49152
    ds_read_b64_tr_b16 v[50:51], v58 offset:49664
    v_mfma_f32_32x32x16_bf16 v[16:31], v[36:39], v[104:107], v[16:31]
    ds_read_b64_tr_b16 v[52:53], v59 offset:49152
    ds_read_b64_tr_b16 v[54:55], v59 offset:49664
    s_waitcnt vmcnt(7) lgkmcnt(4)
    v_mfma_f32_32x32x16_bf16 v[0:15], v[40:43], v[108:111], v[0:15]
    s_add_u32 s37, s37, 2048
    s_and_b32 s37, s37, 0x7800
    buffer_load_dwordx4 v[104:107], v253, s[20:23], s38 offen offset:1024 sc1
    ds_read_b64_tr_b16 v[32:33], v58 offset:51200
    ds_read_b64_tr_b16 v[34:35], v58 offset:51712
    v_mfma_f32_32x32x16_bf16 v[16:31], v[44:47], v[108:111], v[16:31]
    ds_read_b64_tr_b16 v[36:37], v59 offset:51200
    ds_read_b64_tr_b16 v[38:39], v59 offset:51712
    s_waitcnt vmcnt(7) lgkmcnt(4)
    v_mfma_f32_32x32x16_bf16 v[0:15], v[48:51], v[112:115], v[0:15]
    ds_read_b64_tr_b16 v[40:41], v58 offset:53248
    ds_read_b64_tr_b16 v[42:43], v58 offset:53760
    v_mfma_f32_32x32x16_bf16 v[16:31], v[52:55], v[112:115], v[16:31]
    ds_read_b64_tr_b16 v[44:45], v59 offset:53248
    ds_read_b64_tr_b16 v[46:47], v59 offset:53760
    s_waitcnt vmcnt(6) lgkmcnt(4)
    v_mfma_f32_32x32x16_bf16 v[0:15], v[32:35], v[116:119], v[0:15]
    ds_read_b64_tr_b16 v[48:49], v58 offset:55296
    ds_read_b64_tr_b16 v[50:51], v58 offset:55808
    v_mfma_f32_32x32x16_bf16 v[16:31], v[36:39], v[116:119], v[16:31]
    ds_read_b64_tr_b16 v[52:53], v59 offset:55296
    ds_read_b64_tr_b16 v[54:55], v59 offset:55808
    s_waitcnt vmcnt(5) lgkmcnt(4)
    v_mfma_f32_32x32x16_bf16 v[0:15], v[40:43], v[120:123], v[0:15]
    ds_read_b64_tr_b16 v[32:33], v58 offset:57344
    ds_read_b64_tr_b16 v[34:35], v58 offset:57856
    v_mfma_f32_32x32x16_bf16 v[16:31], v[44:47], v[120:123], v[16:31]
    ds_read_b64_tr_b16 v[36:37], v59 offset:57344
    ds_read_b64_tr_b16 v[38:39], v59 offset:57856
    s_waitcnt vmcnt(4) lgkmcnt(4)
    v_mfma_f32_32x32x16_bf16 v[0:15], v[48:51], v[124:127], v[0:15]
    ds_read_b64_tr_b16 v[40:41], v58 offset:59392
    ds_read_b64_tr_b16 v[42:43], v58 offset:59904
    v_mfma_f32_32x32x16_bf16 v[16:31], v[52:55], v[124:127], v[16:31]
    ds_read_b64_tr_b16 v[44:45], v59 offset:59392
    ds_read_b64_tr_b16 v[46:47], v59 offset:59904
    s_waitcnt vmcnt(3) lgkmcnt(4)
    v_mfma_f32_32x32x16_bf16 v[0:15], v[32:35], v[128:131], v[0:15]
    ds_read_b64_tr_b16 v[48:49], v58 offset:61440
    ds_read_b64_tr_b16 v[50:51], v58 offset:61952
    v_mfma_f32_32x32x16_bf16 v[16:31], v[36:39], v[128:131], v[16:31]
    ds_read_b64_tr_b16 v[52:53], v59 offset:61440
    ds_read_b64_tr_b16 v[54:55], v59 offset:61952
    s_waitcnt vmcnt(2) lgkmcnt(4)
    v_mfma_f32_32x32x16_bf16 v[0:15], v[40:43], v[132:135], v[0:15]
    ds_read_b64_tr_b16 v[32:33], v58 offset:63488
    ds_read_b64_tr_b16 v[34:35], v58 offset:64000
    v_mfma_f32_32x32x16_bf16 v[16:31], v[44:47], v[132:135], v[16:31]
    ds_read_b64_tr_b16 v[36:37], v59 offset:63488
    ds_read_b64_tr_b16 v[38:39], v59 offset:64000
    s_waitcnt vmcnt(1) lgkmcnt(4)
    v_mfma_f32_32x32x16_bf16 v[0:15], v[48:51], v[136:139], v[0:15]
    v_mfma_f32_32x32x16_bf16 v[16:31], v[52:55], v[136:139], v[16:31]
    s_waitcnt vmcnt(0) lgkmcnt(0)
    v_mfma_f32_32x32x16_bf16 v[0:15], v[32:35], v[104:107], v[0:15]
    v_mfma_f32_32x32x16_bf16 v[16:31], v[36:39], v[104:107], v[16:31]
    s_lshl_b32 s35, s24, 4
    s_add_u32 s35, s35, s98
    s_lshl_b32 s35, s35, 14
    s_lshl_b32 s34, s3, 12
    s_add_u32 s35, s35, s34
    s_add_u32 s35, s35, 0x2000000
    s_lshl_b32 s30, s99, 13
    s_add_u32 s30, s30, s26
    s_add_u32 s30, s30, 0xc00000
    s_lshl_b32 s31, s98, 9
    s_add_u32 s31, s31, s30
    v_mov_b32 v96, 0
    v_mov_b32 v97, 0
    v_mov_b32 v98, 0
    v_mov_b32 v99, v242
    v_cvt_pk_bf16_f32 v208, v0, v1
    v_cvt_pk_bf16_f32 v209, v2, v3
    v_cvt_pk_bf16_f32 v210, v4, v5
    v_cvt_pk_bf16_f32 v211, v6, v7
    v_cvt_pk_bf16_f32 v212, v8, v9
    v_cvt_pk_bf16_f32 v213, v10, v11
    v_cvt_pk_bf16_f32 v214, v12, v13
    v_cvt_pk_bf16_f32 v215, v14, v15
    v_cvt_pk_bf16_f32 v216, v16, v17
    v_cvt_pk_bf16_f32 v217, v18, v19
    v_cvt_pk_bf16_f32 v218, v20, v21
    v_cvt_pk_bf16_f32 v219, v22, v23
    v_cvt_pk_bf16_f32 v220, v24, v25
    v_cvt_pk_bf16_f32 v221, v26, v27
    v_cvt_pk_bf16_f32 v222, v28, v29
    v_cvt_pk_bf16_f32 v223, v30, v31
    s_cmp_lg_u32 s26, 0
    s_cbranch_scc1 sk_26
    s_cmp_lg_u32 s77, 0
    s_cbranch_scc1 lc_27
    buffer_store_dwordx4 v[208:211], v100, s[20:23], s35 offen offset:0 sc1
    buffer_store_dwordx4 v[212:215], v100, s[20:23], s35 offen offset:512 sc1
    buffer_store_dwordx4 v[216:219], v100, s[20:23], s35 offen offset:1024 sc1
    buffer_store_dwordx4 v[220:223], v100, s[20:23], s35 offen offset:1536 sc1
    s_branch lc_28
    s_nop 0
lc_27:
    buffer_store_dwordx4 v[208:211], v100, s[20:23], s35 offen offset:0
    buffer_store_dwordx4 v[212:215], v100, s[20:23], s35 offen offset:512
    buffer_store_dwordx4 v[216:219], v100, s[20:23], s35 offen offset:1024
    buffer_store_dwordx4 v[220:223], v100, s[20:23], s35 offen offset:1536
lc_28:
    ds_write_b128 v101, v[208:211] offset:0
    ds_write_b128 v101, v[212:215] offset:512
    ds_write_b128 v101, v[216:219] offset:1024
    ds_write_b128 v101, v[220:223] offset:1536
sk_26:
    v_dot2c_f32_bf16 v96, 0x3f803f80, v208
    v_dot2c_f32_bf16 v97, v208, v208
    v_dot2c_f32_bf16 v98, v224, v208
    v_dot2c_f32_bf16 v96, 0x3f803f80, v209
    v_dot2c_f32_bf16 v97, v209, v209
    v_dot2c_f32_bf16 v98, v225, v209
    v_dot2c_f32_bf16 v96, 0x3f803f80, v210
    v_dot2c_f32_bf16 v97, v210, v210
    v_dot2c_f32_bf16 v98, v226, v210
    v_dot2c_f32_bf16 v96, 0x3f803f80, v211
    v_dot2c_f32_bf16 v97, v211, v211
    v_dot2c_f32_bf16 v98, v227, v211
    v_dot2c_f32_bf16 v96, 0x3f803f80, v212
    v_dot2c_f32_bf16 v97, v212, v212
    v_dot2c_f32_bf16 v98, v228, v212
    v_dot2c_f32_bf16 v96, 0x3f803f80, v213
    v_dot2c_f32_bf16 v97, v213, v213
    v_dot2c_f32_bf16 v98, v229, v213
    v_dot2c_f32_bf16 v96, 0x3f803f80, v214
    v_dot2c_f32_bf16 v97, v214, v214
    v_dot2c_f32_bf16 v98, v230, v214
    v_dot2c_f32_bf16 v96, 0x3f803f80, v215
    v_dot2c_f32_bf16 v97, v215, v215
    v_dot2c_f32_bf16 v98, v231, v215
    v_dot2c_f32_bf16 v96, 0x3f803f80, v216
    v_dot2c_f32_bf16 v97, v216, v216
    v_dot2c_f32_bf16 v98, v232, v216
    v_dot2c_f32_bf16 v96, 0x3f803f80, v217
    v_dot2c_f32_bf16 v97, v217, v217
    v_dot2c_f32_bf16 v98, v233, v217
    v_dot2c_f32_bf16 v96, 0x3f803f80, v218
    v_dot2c_f32_bf16 v97, v218, v218
    v_dot2c_f32_bf16 v98, v234, v218
    v_dot2c_f32_bf16 v96, 0x3f803f80, v219
    v_dot2c_f32_bf16 v97, v219, v219
    v_dot2c_f32_bf16 v98, v235, v219
    v_dot2c_f32_bf16 v96, 0x3f803f80, v220
    v_dot2c_f32_bf16 v97, v220, v220
    v_dot2c_f32_bf16 v98, v236, v220
    v_dot2c_f32_bf16 v96, 0x3f803f80, v221
    v_dot2c_f32_bf16 v97, v221, v221
    v_dot2c_f32_bf16 v98, v237, v221
    v_dot2c_f32_bf16 v96, 0x3f803f80, v222
    v_dot2c_f32_bf16 v97, v222, v222
    v_dot2c_f32_bf16 v98, v238, v222
    v_dot2c_f32_bf16 v96, 0x3f803f80, v223
    v_dot2c_f32_bf16 v97, v223, v223
    v_dot2c_f32_bf16 v98, v239, v223
    s_nop 0
    v_mov_b32 v48, v96
    v_mov_b32 v49, v97
    v_mov_b32 v50, v98
    v_mov_b32 v51, v99
    v_permlane32_swap_b32 v96, v48
    v_permlane32_swap_b32 v97, v49
    v_permlane32_swap_b32 v98, v50
    v_permlane32_swap_b32 v99, v51
    v_add_f32 v96, v96, v48
    v_add_f32 v97, v97, v49
    v_add_f32 v98, v98, v50
    v_add_f32_e64 v99, v99, v51
    s_mov_b32 exec_hi, 0
    s_waitcnt vmcnt(0)
    s_cmp_lg_u32 s77, 0
    s_cbranch_scc1 lc_29
    buffer_store_dwordx4 v[96:99], v253, s[20:23], s31 offen sc1
    s_branch lc_30
    s_nop 0
lc_29:
    buffer_store_dwordx4 v[96:99], v253, s[20:23], s31 offen
lc_30:
    s_mov_b64 exec, -1
    s_cmp_lg_u32 s26, 0
    s_cbranch_scc1 e_final
    s_mov_b32 s26, 16777216
    s_and_b32 s30, s3, 1
    s_lshl_b32 s30, s30, 13
    v_add_u32 v176, s30, v253
    v_add_u32 v177, 1024, v176
    s_lshr_b32 s30, s16, 7
    s_sub_u32 s30, 3, s30
    s_and_b32 s30, s30, 7
    s_and_b32 s31, s24, 1
    s_lshl_b32 s31, s31, 3
    s_add_u32 s30, s30, s31
    s_and_b32 s31, s24, 14
    s_add_u32 s84, s31, s30
    s_lshl_b32 s31, s25, 2
    s_add_u32 s31, s31, s28
    s_mul_i32 s31, s31, 6144
    s_lshl_b32 s30, s30, 7
    s_add_u32 s30, s30, s31
    v_min_u32_e64 v190, 2, v252
    v_lshl_add_u32 v190, v190, 11, s30
    s_add_u32 s84, s84, 14
    v_mov_b32 v0, 0
    v_mov_b32 v1, 0
    v_mov_b32 v2, 0
    v_mov_b32 v3, 0
    v_mov_b32 v4, 0
    v_mov_b32 v5, 0
    v_mov_b32 v6, 0
    v_mov_b32 v7, 0
    v_mov_b32 v8, 0
    v_mov_b32 v9, 0
    v_mov_b32 v10, 0
    v_mov_b32 v11, 0
    v_mov_b32 v12, 0
    v_mov_b32 v13, 0
    v_mov_b32 v14, 0
    v_mov_b32 v15, 0
    v_mov_b32 v16, 0
    v_mov_b32 v17, 0
    v_mov_b32 v18, 0
    v_mov_b32 v19, 0
    v_mov_b32 v20, 0
    v_mov_b32 v21, 0
    v_mov_b32 v22, 0
    v_mov_b32 v23, 0
    v_mov_b32 v24, 0
    v_mov_b32 v25, 0
    v_mov_b32 v26, 0
    v_mov_b32 v27, 0
    v_mov_b32 v28, 0
    v_mov_b32 v29, 0
    v_mov_b32 v30, 0
    v_mov_b32 v31, 0
    v_mov_b32 v32, 0
    v_mov_b32 v33, 0
    v_mov_b32 v34, 0
    v_mov_b32 v35, 0
    v_mov_b32 v36, 0
    v_mov_b32 v37, 0
    v_mov_b32 v38, 0
    v_mov_b32 v39, 0
    v_mov_b32 v40, 0
    v_mov_b32 v41, 0
    v_mov_b32 v42, 0
    v_mov_b32 v43, 0
    v_mov_b32 v44, 0
    v_mov_b32 v45, 0
    v_mov_b32 v46, 0
    v_mov_b32 v47, 0
    v_mov_b32 v48, 0
    v_mov_b32 v49, 0
    v_mov_b32 v50, 0
    v_mov_b32 v51, 0
    v_mov_b32 v52, 0
    v_mov_b32 v53, 0
    v_mov_b32 v54, 0
    v_mov_b32 v55, 0
    v_mov_b32 v56, 0
    v_mov_b32 v57, 0
    v_mov_b32 v58, 0
    v_mov_b32 v59, 0
    v_mov_b32 v60, 0
    v_mov_b32 v61, 0
    v_mov_b32 v62, 0
    v_mov_b32 v63, 0
    v_mov_b32 v64, 0
    v_mov_b32 v65, 0
    v_mov_b32 v66, 0
    v_mov_b32 v67, 0
    v_mov_b32 v68, 0
    v_mov_b32 v69, 0
    v_mov_b32 v70, 0
    v_mov_b32 v71, 0
    v_mov_b32 v72, 0
    v_mov_b32 v73, 0
    v_mov_b32 v74, 0
    v_mov_b32 v75, 0
    v_mov_b32 v76, 0
    v_mov_b32 v77, 0
    v_mov_b32 v78, 0
    v_mov_b32 v79, 0
    v_mov_b32 v80, 0
    v_mov_b32 v81, 0
    v_mov_b32 v82, 0
    v_mov_b32 v83, 0
    v_mov_b32 v84, 0
    v_mov_b32 v85, 0
    v_mov_b32 v86, 0
    v_mov_b32 v87, 0
    v_mov_b32 v88, 0
    v_mov_b32 v89, 0
    v_mov_b32 v90, 0
    v_mov_b32 v91, 0
    v_mov_b32 v92, 0
    v_mov_b32 v93, 0
    v_mov_b32 v94, 0
    v_mov_b32 v95, 0
    s_waitcnt lgkmcnt(0)
    s_branch e_q
    s_nop 0
e_fpf:
    s_bitset0_b32 s86, s36
    s_bfm_b64 exec, 56, 0
    global_load_dword v191, v[196:197], off
    v_add_co_u32 v196, vcc, v196, v198
    s_nop 1
    v_addc_co_u32 v197, vcc, 0, v197, vcc
    s_mov_b64 exec, -1
    s_branch e_fpf_ret
e_arr:
    s_mov_b64 exec, 3
    s_mov_b32 s89, 0xdd9000
    buffer_store_dwordx2 v[250:251], v249, s[20:23], s89 offen sc1
    s_mov_b64 exec, -1
    s_branch e_arr_ret
e_final:
    s_mov_b32 s78, s27
pl_31:
    s_lshl_b32 s30, s99, 13
    s_add_u32 s30, s30, 0x1c00000
    s_add_u32 s31, s30, 4096
    buffer_load_dwordx4 v[64:67], v253, s[20:23], s30 offen offset:0 sc1
    buffer_load_dwordx4 v[68:71], v253, s[20:23], s30 offen offset:1024 sc1
    buffer_load_dwordx4 v[72:75], v253, s[20:23], s30 offen offset:2048 sc1
    buffer_load_dwordx4 v[76:79], v253, s[20:23], s30 offen offset:3072 sc1
    buffer_load_dwordx4 v[80:83], v253, s[20:23], s31 offen offset:0 sc1
    buffer_load_dwordx4 v[84:87], v253, s[20:23], s31 offen offset:1024 sc1
    buffer_load_dwordx4 v[88:91], v253, s[20:23], s31 offen offset:2048 sc1
    buffer_load_dwordx4 v[92:95], v253, s[20:23], s31 offen offset:3072 sc1
    s_waitcnt vmcnt(0)
pc_32:
    v_max3_u32 v48, v64, v68, v72
    v_max3_u32 v48, v48, v76, v80
    v_max3_u32 v48, v48, v84, v88
    v_max_u32 v48, v48, v92
    v_cmp_eq_u32 vcc, -1, v48
    s_cbranch_vccz pd_33
    s_sub_u32 s78, s78, 1
    s_cmp_lg_u32 s78, 0
    s_cbranch_scc1 pl_31
    s_mov_b32 s27, 1
pd_33:
    v_pk_add_f32 v[64:65], v[64:65], v[68:69]
    v_pk_add_f32 v[66:67], v[66:67], v[70:71]
    v_pk_add_f32 v[64:65], v[64:65], v[72:73]
    v_pk_add_f32 v[66:67], v[66:67], v[74:75]
    v_pk_add_f32 v[64:65], v[64:65], v[76:77]
    v_pk_add_f32 v[66:67], v[66:67], v[78:79]
    v_pk_add_f32 v[64:65], v[64:65], v[80:81]
    v_pk_add_f32 v[66:67], v[66:67], v[82:83]
    v_pk_add_f32 v[64:65], v[64:65], v[84:85]
    v_pk_add_f32 v[66:67], v[66:67], v[86:87]
    v_pk_add_f32 v[64:65], v[64:65], v[88:89]
    v_pk_add_f32 v[66:67], v[66:67], v[90:91]
    v_pk_add_f32 v[64:65], v[64:65], v[92:93]
    v_pk_add_f32 v[66:67], v[66:67], v[94:95]
    v_mov_b32 v48, v64
    v_mov_b32 v49, v65
    v_mov_b32 v50, v66
    v_mov_b32 v51, v67
    v_permlane32_swap_b32 v64, v48
    v_permlane32_swap_b32 v65, v49
    v_permlane32_swap_b32 v66, v50
    v_permlane32_swap_b32 v67, v51
    v_add_f32 v64, v64, v48
    v_add_f32 v65, v65, v49
    v_add_f32 v66, v66, v50
    v_add_f32 v67, v67, v51
    v_mul_f32 v54, 0x3a800000, v64
    v_mul_f32 v65, 0x3a800000, v65
    v_fma_f32 v65, -v54, v54, v65
    v_max_f32_e64 v65, 0, v65
    v_add_f32 v55, 0x3727c5ac, v65
    v_rsq_f32_e64 v55, v55
    v_fma_f32 v52, -v54, v67, v66
    v_and_b32 v53, 31, v252
    v_mul_f32 v52, v52, v55
    s_lshl_b32 s32, s99, 5
    v_add_u32 v53, s32, v53
    v_mov_b32 v48, v52
    s_nop 1
    v_max_f32_dpp v48, v48, v48 quad_perm:[1,0,3,2] row_mask:0xf bank_mask:0xf
    s_nop 1
    v_max_f32_dpp v48, v48, v48 quad_perm:[2,3,0,1] row_mask:0xf bank_mask:0xf
    s_nop 1
    v_max_f32_dpp v48, v48, v48 row_half_mirror row_mask:0xf bank_mask:0xf
    s_nop 1
    v_max_f32_dpp v48, v48, v48 row_mirror row_mask:0xf bank_mask:0xf
    v_mov_b32 v49, v48
    s_nop 1
    v_permlane16_swap_b32 v48, v49
    v_max_f32 v48, v48, v49
    v_cmp_eq_f32 vcc, v48, v52
    v_lshrrev_b32 v50, 5, v252
    v_lshlrev_b32 v50, 4, v50
    v_add_lshl_u32 v51, v50, s25, 27
    s_lshl_b32 s32, s99, 11
    s_lshl_b32 s33, s98, 7
    s_add_u32 s32, s32, s33
    s_add_u32 s32, s32, 0x1d60000
    s_lshl_b32 s34, s99, 4
    s_add_u32 s34, s34, 0x1dc0000
    s_ff1_i32_b32 s35, vcc_lo
    s_lshl_b32 s35, 1, s35
    s_mov_b32 exec_lo, s35
    s_mov_b32 exec_hi, s35
    buffer_store_dwordx4 v[52:55], v51, s[20:23], s34 offen sc1
    buffer_store_dwordx4 v[208:211], v50, s[20:23], s32 offen offset:0 sc1
    buffer_store_dwordx4 v[212:215], v50, s[20:23], s32 offen offset:32 sc1
    buffer_store_dwordx4 v[216:219], v50, s[20:23], s32 offen offset:64 sc1
    buffer_store_dwordx4 v[220:223], v50, s[20:23], s32 offen offset:96 sc1
    s_mov_b64 exec, -1
    v_add_f32 v240, 1.0, v55
    v_mul_f32 v241, v54, v55
    v_sub_f32 v241, 0, v241
    v_pk_fma_f32 v[0:1], v[0:1], v[240:241], v[240:241] op_sel:[0,0,1] op_sel_hi:[1,0,1]
    v_pk_fma_f32 v[2:3], v[2:3], v[240:241], v[240:241] op_sel:[0,0,1] op_sel_hi:[1,0,1]
    v_pk_fma_f32 v[4:5], v[4:5], v[240:241], v[240:241] op_sel:[0,0,1] op_sel_hi:[1,0,1]
    v_pk_fma_f32 v[6:7], v[6:7], v[240:241], v[240:241] op_sel:[0,0,1] op_sel_hi:[1,0,1]
    v_pk_fma_f32 v[8:9], v[8:9], v[240:241], v[240:241] op_sel:[0,0,1] op_sel_hi:[1,0,1]
    v_pk_fma_f32 v[10:11], v[10:11], v[240:241], v[240:241] op_sel:[0,0,1] op_sel_hi:[1,0,1]
    v_pk_fma_f32 v[12:13], v[12:13], v[240:241], v[240:241] op_sel:[0,0,1] op_sel_hi:[1,0,1]
    v_pk_fma_f32 v[14:15], v[14:15], v[240:241], v[240:241] op_sel:[0,0,1] op_sel_hi:[1,0,1]
    v_pk_fma_f32 v[16:17], v[16:17], v[240:241], v[240:241] op_sel:[0,0,1] op_sel_hi:[1,0,1]
    v_pk_fma_f32 v[18:19], v[18:19], v[240:241], v[240:241] op_sel:[0,0,1] op_sel_hi:[1,0,1]
    v_pk_fma_f32 v[20:21], v[20:21], v[240:241], v[240:241] op_sel:[0,0,1] op_sel_hi:[1,0,1]
    v_pk_fma_f32 v[22:23], v[22:23], v[240:241], v[240:241] op_sel:[0,0,1] op_sel_hi:[1,0,1]
    v_pk_fma_f32 v[24:25], v[24:25], v[240:241], v[240:241] op_sel:[0,0,1] op_sel_hi:[1,0,1]
    v_pk_fma_f32 v[26:27], v[26:27], v[240:241], v[240:241] op_sel:[0,0,1] op_sel_hi:[1,0,1]
    v_pk_fma_f32 v[28:29], v[28:29], v[240:241], v[240:241] op_sel:[0,0,1] op_sel_hi:[1,0,1]
    v_pk_fma_f32 v[30:31], v[30:31], v[240:241], v[240:241] op_sel:[0,0,1] op_sel_hi:[1,0,1]
    v_cvt_pk_bf16_f32 v64, v0, v1
    v_cvt_pk_bf16_f32 v65, v2, v3
    v_cvt_pk_bf16_f32 v66, v4, v5
    v_cvt_pk_bf16_f32 v67, v6, v7
    v_cvt_pk_bf16_f32 v68, v8, v9
    v_cvt_pk_bf16_f32 v69, v10, v11
    v_cvt_pk_bf16_f32 v70, v12, v13
    v_cvt_pk_bf16_f32 v71, v14, v15
    v_cvt_pk_bf16_f32 v72, v16, v17
    v_cvt_pk_bf16_f32 v73, v18, v19
    v_cvt_pk_bf16_f32 v74, v20, v21
    v_cvt_pk_bf16_f32 v75, v22, v23
    v_cvt_pk_bf16_f32 v76, v24, v25
    v_cvt_pk_bf16_f32 v77, v26, v27
    v_cvt_pk_bf16_f32 v78, v28, v29
    v_cvt_pk_bf16_f32 v79, v30, v31
    v_permlane32_swap_b32 v64, v66
    v_permlane32_swap_b32 v65, v67
    v_permlane32_swap_b32 v68, v70
    v_permlane32_swap_b32 v69, v71
    v_permlane32_swap_b32 v72, v74
    v_permlane32_swap_b32 v73, v75
    v_permlane32_swap_b32 v76, v78
    v_permlane32_swap_b32 v77, v79
    v_lshl_add_u32 v50, v53, 11, v50
    s_mov_b32 s79, s26
    s_cmp_lg_u32 s3, 0
    s_cbranch_scc1 sk_34
    s_mov_b32 s78, s27
pl_35:
    s_add_u32 s32, s79, 0xdc0000
    buffer_load_dwordx4 v[0:3], v253, s[20:23], s32 offen sc1
    s_waitcnt vmcnt(0)
pc_36:
    v_max3_u32 v4, v0, v1, v2
    v_max_u32 v4, v4, v3
    v_cmp_eq_u32 vcc, -1, v4
    s_cbranch_vccz pd_37
    s_sub_u32 s78, s78, 1
    s_cmp_lg_u32 s78, 0
    s_cbranch_scc1 pl_35
    s_mov_b32 s27, 1
pd_37:
    v_mov_b32 v4, v0
    s_nop 1
    v_max_f32_dpp v4, v4, v4 quad_perm:[1,0,3,2] row_mask:0xf bank_mask:0xf
    s_nop 1
    v_max_f32_dpp v4, v4, v4 quad_perm:[2,3,0,1] row_mask:0xf bank_mask:0xf
    s_nop 1
    v_max_f32_dpp v4, v4, v4 row_half_mirror row_mask:0xf bank_mask:0xf
    s_nop 1
    v_max_f32_dpp v4, v4, v4 row_mirror row_mask:0xf bank_mask:0xf
    v_mov_b32 v5, v4
    s_nop 1
    v_permlane16_swap_b32 v4, v5
    v_max_f32 v4, v4, v5
    v_mov_b32 v5, v4
    s_nop 1
    v_permlane32_swap_b32 v4, v5
    v_max_f32_e64 v4, v4, v5
    v_cmp_eq_f32 vcc, v4, v0
    s_ff1_i32_b64 s32, vcc
    s_and_b32 s32, s32, 63
    s_lshl_b64 exec, 1, s32
    ds_write_b128 v189, v[0:3] offset:3072
    s_mov_b64 exec, -1
sk_34:
    s_waitcnt lgkmcnt(0)
    s_barrier
    ds_read_b32 v0, v189 offset:3076
    s_waitcnt lgkmcnt(0)
    v_and_b32 v0, 0x7ff, v0
    v_cmp_ne_u32 vcc, v0, v53
    s_mov_b64 exec, vcc
    buffer_store_dwordx4 v[64:67], v50, s[12:15], s33 offen offset:0
    buffer_store_dwordx4 v[68:71], v50, s[12:15], s33 offen offset:32
    buffer_store_dwordx4 v[72:75], v50, s[12:15], s33 offen offset:64
    buffer_store_dwordx4 v[76:79], v50, s[12:15], s33 offen offset:96
    s_mov_b64 exec, -1
    s_branch k_end
    s_nop 0
l_start:
    v_lshrrev_b32 v21, 3, v252
    v_lshrrev_b32 v20, 4, v252
    v_xor_b32 v20, v20, v252
    v_and_b32 v20, 7, v20
    v_lshlrev_b32 v20, 4, v20
    v_lshl_add_u32 v4, v21, 11, v20
    v_xor_b32_e64 v5, 64, v4
    v_add_u32 v5, 15360, v5
    v_add_u32 v6, 30720, v4
    v_add_u32 v7, 30720, v5
    s_lshl_b32 s84, s99, 16
    s_lshl_b32 s85, s25, 7
    s_lshl_b32 s86, s28, 12
    s_mul_i32 s87, s28, 6144
    v_and_b32 v20, 4, v21
    v_add_u32_e64 v20, v20, v21
    v_mul_u32_u24 v20, 6144, v20
    v_and_b32 v21, 6, v21
    v_xor_b32 v21, v21, v252
    v_and_b32 v21, 7, v21
    v_lshl_add_u32 v20, v21, 4, v20
    s_mul_i32 s32, s28, 3
    s_bfe_u32 s33, s32, 0x10001
    s_mul_i32 s33, s33, 196608
    s_and_b32 s34, s32, 1
    s_mul_i32 s34, s34, 24576
    s_add_u32 s33, s33, s34
    s_lshr_b32 s34, s32, 2
    s_lshl_b32 s34, s34, 11
    s_add_u32 s33, s33, s34
    v_add_u32 v8, s33, v20
    v_add_u32 v9, 97280, v8
    s_add_u32 s32, s32, 1
    s_bfe_u32 s33, s32, 0x10001
    s_mul_i32 s33, s33, 196608
    s_and_b32 s34, s32, 1
    s_mul_i32 s34, s34, 24576
    s_add_u32 s33, s33, s34
    s_lshr_b32 s34, s32, 2
    s_lshl_b32 s34, s34, 11
    s_add_u32 s33, s33, s34
    s_sub_u32 s33, s33, 2048
    v_add_u32 v10, s33, v20
    v_add_u32 v11, 97280, v10
    s_add_u32 s32, s32, 1
    s_bfe_u32 s33, s32, 0x10001
    s_mul_i32 s33, s33, 196608
    s_and_b32 s34, s32, 1
    s_mul_i32 s34, s34, 24576
    s_add_u32 s33, s33, s34
    s_lshr_b32 s34, s32, 2
    s_lshl_b32 s34, s34, 11
    s_add_u32 s33, s33, s34
    v_add_u32 v12, s33, v20
    v_add_u32 v13, 97280, v12
    s_waitcnt lgkmcnt(0)
    s_mov_b32 s88, 0xdd8000
    s_load_dword s88, s[20:21], s88
    s_mov_b64 s[16:17], s[6:7]
    s_mov_b32 s6, 0x400000
    s_mov_b32 s7, 0x20000
    s_add_u32 s96, s94, 0
    s_and_b32 s96, s96, 15
    s_lshl_b32 s97, s96, 7
    s_add_u32 s97, s97, s84
    s_add_u32 m0, s86, 147456
    s_nop 0
    buffer_load_dwordx4 v4, s[4:7], s97 offen offset:0 lds
    buffer_load_dwordx4 v5, s[4:7], s97 offen offset:1024 lds
    buffer_load_dwordx4 v6, s[4:7], s97 offen offset:2048 lds
    buffer_load_dwordx4 v7, s[4:7], s97 offen offset:3072 lds
    s_add_u32 s96, s94, 0
    s_and_b32 s96, s96, 15
    s_mul_i32 s96, s96, 393216
    s_add_u32 s96, s96, s85
    s_add_u32 m0, s87, 40960
    s_nop 0
    buffer_load_dwordx4 v8, s[16:19], s96 offen offset:0 lds
    buffer_load_dwordx4 v9, s[16:19], s96 offen offset:1024 lds
    buffer_load_dwordx4 v10, s[16:19], s96 offen offset:2048 lds
    buffer_load_dwordx4 v11, s[16:19], s96 offen offset:3072 lds
    s_mov_b32 s40, 0xffffffff
    s_mov_b32 s41, 0xfffffff0
    s_mov_b32 s42, 0xfffffffe
    s_mov_b32 s43, 0xffffffe0
    s_mov_b32 s44, 0xfffffffc
    s_mov_b32 s45, 0xffffffc0
    s_mov_b32 s46, 0xfffffff8
    s_mov_b32 s47, 0xffffff80
    s_mov_b32 s48, 0xffff0000
    s_mov_b32 s49, 0xfff00000
    s_mov_b32 s50, 0xfffe0000
    s_mov_b32 s51, 0xffe00000
    s_mov_b32 s52, 0xfffc0000
    s_mov_b32 s53, 0xffc00000
    s_mov_b32 s54, 0xfff80000
    s_mov_b32 s55, 0xff800000
    s_mov_b32 s56, 0xffffff00
    s_mov_b32 s57, 0xfffff000
    s_mov_b32 s58, 0xfffffe00
    s_mov_b32 s59, 0xffffe000
    s_mov_b32 s60, 0xfffffc00
    s_mov_b32 s61, 0xffffc000
    s_mov_b32 s62, 0xfffff800
    s_mov_b32 s63, 0xffff8000
    s_mov_b32 s64, 0xff000000
    s_mov_b32 s65, 0xf0000000
    s_mov_b32 s66, 0xfe000000
    s_mov_b32 s67, 0xe0000000
    s_mov_b32 s68, 0xfc000000
    s_mov_b32 s69, 0xc0000000
    s_mov_b32 s70, 0xf8000000
    s_mov_b32 s71, 0x80000000
    v_bfe_u32 v20, v252, 3, 2
    v_lshrrev_b32 v21, 5, v252
    v_lshl_add_u32 v20, v21, 3, v20
    s_lshr_b32 s32, s28, 1
    s_lshl_b32 s32, s32, 4
    s_and_b32 s33, s28, 1
    s_lshl_b32 s33, s33, 2
    s_add_u32 s32, s32, s33
    v_add_u32 v20, s32, v20
    v_lshlrev_b32 v20, 11, v20
    v_lshrrev_b32 v21, 2, v252
    v_and_b32 v21, 4, v21
    v_xor_b32 v21, v21, v252
    v_and_b32_e64 v21, 7, v21
    v_lshl_add_u32 v20, v21, 4, v20
    s_lshl_b32 s32, s98, 7
    v_add_u32 v14, s32, v20
    v_lshrrev_b32 v20, 2, v252
    v_lshlrev_b32 v20, 2, v20
    v_bfe_u32 v21, v252, 1, 1
    v_add_u32_e64 v20, v20, v21
    v_mul_u32_u24 v20, 28672, v20
    v_and_b32_e64 v21, 1, v252
    v_lshl_add_u32 v20, v21, 4, v20
    s_mul_i32 s30, s28, 1835008
    s_lshl_b32 s31, s29, 5
    s_add_u32 s30, s30, s31
    v_add_u32 v155, s30, v20
    v_lshlrev_b32 v21, 14, v21
    v_lshrrev_b32_e64 v20, 1, v252
    v_lshl_add_u32 v20, v20, 4, v21
    s_lshl_b32 s30, s28, 9
    s_lshl_b32 s31, s29, 15
    s_add_u32 s30, s30, s31
    v_add_u32 v153, s30, v20
    s_load_dwordx2 s[80:81], s[0:1], 40
    s_cmp_lt_u32 s29, 224
    s_cselect_b32 s82, 0x700000, 0
    s_mov_b32 s83, 0x20000
    s_load_dwordx2 s[12:13], s[0:1], 56
    s_cmp_lt_u32 s29, 224
    s_cselect_b32 s14, 0x700000, 0
    s_mov_b32 s15, 0x20000
    s_mov_b32 s73, -1
    s_mov_b32 s100, 0
    s_sub_u32 s30, s25, s24
    s_add_u32 s30, s30, 31
    v_and_b32 v15, 16, v252
    v_mul_u32_u24 v15, s30, v15
    v_and_b32 v20, 31, v252
    v_add_lshl_u32 v15, v15, v20, 3
    s_lshl_b32 s30, s24, 7
    s_add_u32 s30, s30, 0xdd9000
    v_add_u32_e64 v15, s30, v15
    s_add_u32 m0, s87, 45056
    s_nop 0
    buffer_load_dwordx4 v12, s[16:19], s96 offen offset:0 lds
    buffer_load_dwordx4 v13, s[16:19], s96 offen offset:1024 lds
    s_add_u32 s96, s95, 1
    s_and_b32 s96, s96, 15
    s_lshl_b32 s97, s96, 7
    s_add_u32 s97, s97, s84
    s_add_u32 m0, s86, 131072
    s_nop 0
    buffer_load_dwordx4 v4, s[4:7], s97 offen offset:0 lds
    buffer_load_dwordx4 v5, s[4:7], s97 offen offset:1024 lds
    buffer_load_dwordx4 v6, s[4:7], s97 offen offset:2048 lds
    buffer_load_dwordx4 v7, s[4:7], s97 offen offset:3072 lds
    s_add_u32 s96, s95, 1
    s_and_b32 s96, s96, 15
    s_mul_i32 s96, s96, 393216
    s_add_u32 s96, s96, s85
    s_add_u32 m0, s87, 65536
    s_nop 0
    buffer_load_dwordx4 v8, s[16:19], s96 offen offset:0 lds
    buffer_load_dwordx4 v9, s[16:19], s96 offen offset:1024 lds
    buffer_load_dwordx4 v10, s[16:19], s96 offen offset:2048 lds
    s_waitcnt vmcnt(7) lgkmcnt(0)
    s_add_u32 s88, s88, 0x9e3779b9
    s_barrier
    buffer_load_dwordx4 v11, s[16:19], s96 offen offset:3072 lds
    s_add_u32 m0, s87, 69632
    s_nop 0
    buffer_load_dwordx4 v12, s[16:19], s96 offen offset:0 lds
    buffer_load_dwordx4 v13, s[16:19], s96 offen offset:1024 lds
    s_add_u32 s96, s94, 2
    s_and_b32 s96, s96, 15
    s_lshl_b32 s97, s96, 7
    s_add_u32 s97, s97, s84
    s_add_u32 m0, s86, 114688
    s_nop 0
    buffer_load_dwordx4 v4, s[4:7], s97 offen offset:0 lds
    buffer_load_dwordx4 v5, s[4:7], s97 offen offset:1024 lds
    buffer_load_dwordx4 v6, s[4:7], s97 offen offset:2048 lds
    buffer_load_dwordx4 v7, s[4:7], s97 offen offset:3072 lds
    s_add_u32 s96, s94, 2
    s_and_b32 s96, s96, 15
    s_mul_i32 s96, s96, 393216
    s_add_u32 s96, s96, s85
    s_add_u32 m0, s87, 90112
    s_nop 0
    buffer_load_dwordx4 v8, s[16:19], s96 offen offset:0 lds
    buffer_load_dwordx4 v9, s[16:19], s96 offen offset:1024 lds
    buffer_load_dwordx4 v10, s[16:19], s96 offen offset:2048 lds
    buffer_load_dwordx4 v11, s[16:19], s96 offen offset:3072 lds
    s_add_u32 m0, s87, 94208
    s_nop 0
    buffer_load_dwordx4 v12, s[16:19], s96 offen offset:0 lds
    buffer_load_dwordx4 v13, s[16:19], s96 offen offset:1024 lds
    s_waitcnt vmcnt(10) lgkmcnt(0)
    s_barrier
    s_add_u32 s96, s95, 3
    s_and_b32 s96, s96, 15
    s_lshl_b32 s97, s96, 7
    s_add_u32 s97, s97, s84
    s_add_u32 m0, s86, 147456
    s_nop 0
    buffer_load_dwordx4 v4, s[4:7], s97 offen offset:0 lds
    buffer_load_dwordx4 v5, s[4:7], s97 offen offset:1024 lds
    v_and_b32_e64 v28, 31, v252
    v_bfe_u32 v29, v28, 1, 3
    v_lshrrev_b32 v30, 5, v252
    v_xor_b32 v29, v29, v30
    v_lshlrev_b32_e64 v29, 4, v29
    v_lshl_add_u32 v28, v28, 7, v29
    s_add_u32 s30, s86, 131072
    buffer_load_dwordx4 v6, s[4:7], s97 offen offset:2048 lds
    v_add_u32 v28, s30, v28
    v_xor_b32 v29, 32, v28
    v_xor_b32_e64 v30, 64, v28
    v_xor_b32 v31, 96, v28
    ds_read_b128 v[32:35], v28
    ds_read_b128 v[36:39], v29
    ds_read_b128 v[40:43], v30
    buffer_load_dwordx4 v7, s[4:7], s97 offen offset:3072 lds
    ds_read_b128 v[44:47], v31
    s_min_u32 s30, s28, 2
    s_lshl_b32 s30, s30, 13
    s_add_u32 s30, s30, 65536
    v_lshrrev_b32_e64 v20, 2, v252
    v_bfe_u32 v21, v20, 1, 2
    v_lshlrev_b32_e64 v20, 7, v20
    s_add_u32 s96, s95, 3
    s_and_b32 s96, s96, 15
    s_mul_i32 s96, s96, 393216
    s_add_u32 s96, s96, s85
    s_add_u32 m0, s87, 40960
    s_nop 0
    buffer_load_dwordx4 v8, s[16:19], s96 offen offset:0 lds
    v_lshl_add_u32 v20, v21, 5, v20
    v_and_b32_e64 v21, 3, v252
    v_lshl_add_u32 v20, v21, 3, v20
    v_add_u32 v144, s30, v20
    v_xor_b32 v145, 32, v144
    v_xor_b32_e64 v146, 64, v144
    v_xor_b32 v147, 96, v144
    buffer_load_dwordx4 v9, s[16:19], s96 offen offset:1024 lds
    ds_read_b64_tr_b16 v[100:101], v144 offset:0
    ds_read_b64_tr_b16 v[102:103], v144 offset:2048
    ds_read_b64_tr_b16 v[104:105], v144 offset:4096
    ds_read_b64_tr_b16 v[106:107], v144 offset:6144
    ds_read_b64_tr_b16 v[108:109], v145 offset:0
    ds_read_b64_tr_b16 v[110:111], v145 offset:2048
    ds_read_b64_tr_b16 v[112:113], v145 offset:4096
    buffer_load_dwordx4 v10, s[16:19], s96 offen offset:2048 lds
    ds_read_b64_tr_b16 v[114:115], v145 offset:6144
    ds_read_b64_tr_b16 v[116:117], v146 offset:0
    ds_read_b64_tr_b16 v[118:119], v146 offset:2048
    ds_read_b64_tr_b16 v[120:121], v146 offset:4096
    ds_read_b64_tr_b16 v[122:123], v146 offset:6144
    ds_read_b64_tr_b16 v[124:125], v147 offset:0
    ds_read_b64_tr_b16 v[126:127], v147 offset:2048
    buffer_load_dwordx4 v11, s[16:19], s96 offen offset:3072 lds
    ds_read_b64_tr_b16 v[128:129], v147 offset:4096
    ds_read_b64_tr_b16 v[130:131], v147 offset:6144
    v_mov_b32 v16, -1
    v_mov_b32 v17, -1
    v_mov_b32_e64 v18, -1
    v_mov_b32 v19, -1
    s_lshr_b32 s30, s28, 1
    s_add_u32 m0, s87, 45056
    s_nop 0
    buffer_load_dwordx4 v12, s[16:19], s96 offen offset:0 lds
    s_mul_i32 s30, s30, 16777216
    s_and_b32 s31, s28, 1
    s_lshl_b32 s32, s31, 20
    s_lshl_b32 s33, s72, 10
    s_add_u32 s32, s32, s33
    s_add_u32 s32, s32, s30
    s_add_u32 s32, s32, 0xc00000
    buffer_load_dwordx4 v13, s[16:19], s96 offen offset:1024 lds
    buffer_store_dwordx4 v[16:19], v253, s[20:23], s32 offen sc1
    s_add_u32 s32, s32, 262144
    buffer_store_dwordx4 v[16:19], v253, s[20:23], s32 offen sc1
    s_add_u32 s32, s32, 262144
    buffer_store_dwordx4 v[16:19], v253, s[20:23], s32 offen sc1
    s_add_u32 s32, s32, 262144
    s_lshl_b32 s33, s72, 7
    s_add_u32 s33, s33, s30
    s_add_u32 s33, s33, 0xdc0000
    s_cmp_eq_u32 s31, 0
    s_cselect_b32 s32, s32, s33
    s_cselect_b64 exec, -1, 0xff
    buffer_store_dwordx4 v[16:19], v253, s[20:23], s32 offen sc1
    s_mov_b64 exec, -1
    s_waitcnt vmcnt(14) lgkmcnt(0)
    s_barrier
    s_add_u32 s96, s94, 4
    s_and_b32 s96, s96, 15
    s_lshl_b32 s97, s96, 7
    s_add_u32 s97, s97, s84
    s_add_u32 m0, s86, 131072
    s_nop 0
    buffer_load_dwordx4 v4, s[4:7], s97 offen offset:0 lds
    buffer_load_dwordx4 v5, s[4:7], s97 offen offset:1024 lds
    v_mov_b32_e64 v48, 0
    buffer_load_dwordx4 v6, s[4:7], s97 offen offset:2048 lds
    v_mov_b32_e64 v49, 0
    buffer_load_dwordx4 v7, s[4:7], s97 offen offset:3072 lds
    v_mov_b32_e64 v50, 0
    s_add_u32 s96, s94, 4
    s_and_b32 s96, s96, 15
    s_mul_i32 s96, s96, 393216
    s_add_u32 s96, s96, s85
    s_add_u32 m0, s87, 65536
    s_nop 0
    buffer_load_dwordx4 v8, s[16:19], s96 offen offset:0 lds
    v_mov_b32_e64 v51, 0
    buffer_load_dwordx4 v9, s[16:19], s96 offen offset:1024 lds
    v_mov_b32_e64 v140, 0
    buffer_load_dwordx4 v10, s[16:19], s96 offen offset:2048 lds
    v_mov_b32_e64 v141, 0
    buffer_load_dwordx4 v11, s[16:19], s96 offen offset:3072 lds
    v_mov_b32 v142, 0
    s_add_u32 m0, s87, 69632
    s_nop 0
    buffer_load_dwordx4 v12, s[16:19], s96 offen offset:0 lds
    v_mov_b32_e64 v143, 0
    buffer_load_dwordx4 v13, s[16:19], s96 offen offset:1024 lds
    v_dot2c_f32_bf16 v140, 0x3f803f80, v100
    v_dot2c_f32_bf16 v141, 0x3f803f80, v108
    v_dot2c_f32_bf16 v142, 0x3f803f80, v116
    v_dot2c_f32_bf16 v143, 0x3f803f80, v124
    v_dot2c_f32_bf16 v140, 0x3f803f80, v101
    v_dot2c_f32_bf16 v141, 0x3f803f80, v109
    v_dot2c_f32_bf16 v142, 0x3f803f80, v117
    v_dot2c_f32_bf16 v143, 0x3f803f80, v125
    v_dot2c_f32_bf16 v140, 0x3f803f80, v102
    v_dot2c_f32_bf16 v141, 0x3f803f80, v110
    v_dot2c_f32_bf16 v142, 0x3f803f80, v118
    v_dot2c_f32_bf16 v143, 0x3f803f80, v126
    v_dot2c_f32_bf16 v140, 0x3f803f80, v103
    v_dot2c_f32_bf16 v141, 0x3f803f80, v111
    v_dot2c_f32_bf16 v142, 0x3f803f80, v119
    v_dot2c_f32_bf16 v143, 0x3f803f80, v127
    v_dot2c_f32_bf16 v140, 0x3f803f80, v104
    v_dot2c_f32_bf16 v141, 0x3f803f80, v112
    v_dot2c_f32_bf16 v142, 0x3f803f80, v120
    v_dot2c_f32_bf16 v143, 0x3f803f80, v128
    v_dot2c_f32_bf16 v140, 0x3f803f80, v105
    v_dot2c_f32_bf16 v141, 0x3f803f80, v113
    v_dot2c_f32_bf16 v142, 0x3f803f80, v121
    v_dot2c_f32_bf16 v143, 0x3f803f80, v129
    v_dot2c_f32_bf16 v140, 0x3f803f80, v106
    v_dot2c_f32_bf16 v141, 0x3f803f80, v114
    v_dot2c_f32_bf16 v142, 0x3f803f80, v122
    v_dot2c_f32_bf16 v143, 0x3f803f80, v130
    v_dot2c_f32_bf16 v140, 0x3f803f80, v107
    v_dot2c_f32_bf16 v141, 0x3f803f80, v115
    v_dot2c_f32_bf16 v142, 0x3f803f80, v123
    v_dot2c_f32_bf16 v143, 0x3f803f80, v131
    v_dot2c_f32_bf16 v48, 0x3f803f80, v32
    v_dot2c_f32_bf16 v49, v32, v32
    v_dot2c_f32_bf16 v50, 0x3f803f80, v33
    v_dot2c_f32_bf16 v51, v33, v33
    v_dot2c_f32_bf16 v48, 0x3f803f80, v34
    v_dot2c_f32_bf16 v49, v34, v34
    v_dot2c_f32_bf16 v50, 0x3f803f80, v35
    v_dot2c_f32_bf16 v51, v35, v35
    v_dot2c_f32_bf16 v48, 0x3f803f80, v36
    v_dot2c_f32_bf16 v49, v36, v36
    v_dot2c_f32_bf16 v50, 0x3f803f80, v37
    v_dot2c_f32_bf16 v51, v37, v37
    v_dot2c_f32_bf16 v48, 0x3f803f80, v38
    v_dot2c_f32_bf16 v49, v38, v38
    v_dot2c_f32_bf16 v50, 0x3f803f80, v39
    v_dot2c_f32_bf16 v51, v39, v39
    v_dot2c_f32_bf16 v48, 0x3f803f80, v40
    v_dot2c_f32_bf16 v49, v40, v40
    v_dot2c_f32_bf16 v50, 0x3f803f80, v41
    v_dot2c_f32_bf16 v51, v41, v41
    v_dot2c_f32_bf16 v48, 0x3f803f80, v42
    v_dot2c_f32_bf16 v49, v42, v42
    v_dot2c_f32_bf16 v50, 0x3f803f80, v43
    v_dot2c_f32_bf16 v51, v43, v43
    v_dot2c_f32_bf16 v48, 0x3f803f80, v44
    v_dot2c_f32_bf16 v49, v44, v44
    v_dot2c_f32_bf16 v50, 0x3f803f80, v45
    v_dot2c_f32_bf16 v51, v45, v45
    v_dot2c_f32_bf16 v48, 0x3f803f80, v46
    v_dot2c_f32_bf16 v49, v46, v46
    v_dot2c_f32_bf16 v50, 0x3f803f80, v47
    v_dot2c_f32_bf16 v51, v47, v47
    s_waitcnt vmcnt(14) lgkmcnt(0)
    s_barrier
    s_add_u32 s96, s95, 5
    s_and_b32 s96, s96, 15
    s_lshl_b32 s97, s96, 7
    s_add_u32 s97, s97, s84
    s_add_u32 m0, s86, 114688
    s_nop 0
    buffer_load_dwordx4 v4, s[4:7], s97 offen offset:0 lds
    buffer_load_dwordx4 v5, s[4:7], s97 offen offset:1024 lds
    s_lshl_b32 s30, s99, 12
    s_lshl_b32 s31, s25, 8
    buffer_load_dwordx4 v6, s[4:7], s97 offen offset:2048 lds
    s_add_u32 s30, s30, s31
    s_add_u32 s30, s30, 0x2400000
    buffer_load_dwordx4 v7, s[4:7], s97 offen offset:3072 lds
    v_lshlrev_b32_e64 v28, 3, v252
    s_add_u32 s96, s95, 5
    s_and_b32 s96, s96, 15
    s_mul_i32 s96, s96, 393216
    s_add_u32 s96, s96, s85
    s_add_u32 m0, s87, 90112
    s_nop 0
    buffer_load_dwordx4 v8, s[16:19], s96 offen offset:0 lds
    v_add_f32 v48, v48, v50
    v_add_f32 v49, v49, v51
    buffer_load_dwordx4 v9, s[16:19], s96 offen offset:1024 lds
    v_mov_b32 v50, v48
    v_mov_b32 v51, v49
    buffer_load_dwordx4 v10, s[16:19], s96 offen offset:2048 lds
    v_permlane32_swap_b32_e64 v48, v50
    buffer_load_dwordx4 v11, s[16:19], s96 offen offset:3072 lds
    v_permlane32_swap_b32 v49, v51
    v_add_f32 v48, v48, v50
    s_add_u32 m0, s87, 94208
    s_nop 0
    buffer_load_dwordx4 v12, s[16:19], s96 offen offset:0 lds
    v_add_f32 v49, v49, v51
    buffer_load_dwordx4 v13, s[16:19], s96 offen offset:1024 lds
    s_mov_b32 exec_hi, 0
    buffer_store_dwordx2 v[48:49], v28, s[20:23], s30 offen sc1
    s_mov_b64 exec, -1
    s_min_u32 s32, s28, 2
    s_lshl_b32 s32, s32, 12
    s_lshl_b32 s33, s25, 14
    s_add_u32 s32, s32, s33
    s_add_u32 s32, s32, 0x2500000
    s_lshl_b32 s33, s24, 8
    s_add_u32 s32, s32, s33
    v_lshlrev_b32 v20, 2, v252
    v_permlane32_swap_b32 v140, v142
    v_permlane32_swap_b32 v141, v143
    v_add_f32 v140, v140, v142
    v_add_f32 v141, v141, v143
    s_nop 1
    v_permlane16_swap_b32_e64 v140, v141
    v_add_f32 v140, v140, v141
    buffer_store_dword v140, v20, s[20:23], s32 offen sc1
    s_waitcnt vmcnt(12) lgkmcnt(0)
    s_barrier
    s_add_u32 s96, s94, 6
    s_and_b32 s96, s96, 15
    s_lshl_b32 s97, s96, 7
    s_add_u32 s97, s97, s84
    s_add_u32 m0, s86, 147456
    s_nop 0
    buffer_load_dwordx4 v4, s[4:7], s97 offen offset:0 lds
    buffer_load_dwordx4 v5, s[4:7], s97 offen offset:1024 lds
    buffer_load_dwordx4 v6, s[4:7], s97 offen offset:2048 lds
    buffer_load_dwordx4 v7, s[4:7], s97 offen offset:3072 lds
    s_add_u32 s96, s94, 6
    s_and_b32 s96, s96, 15
    s_mul_i32 s96, s96, 393216
    s_add_u32 s96, s96, s85
    s_add_u32 m0, s87, 40960
    s_nop 0
    buffer_load_dwordx4 v8, s[16:19], s96 offen offset:0 lds
    buffer_load_dwordx4 v9, s[16:19], s96 offen offset:1024 lds
    buffer_load_dwordx4 v10, s[16:19], s96 offen offset:2048 lds
    buffer_load_dwordx4 v11, s[16:19], s96 offen offset:3072 lds
    s_add_u32 m0, s87, 45056
    s_nop 0
    buffer_load_dwordx4 v12, s[16:19], s96 offen offset:0 lds
    buffer_load_dwordx4 v13, s[16:19], s96 offen offset:1024 lds
    s_waitcnt vmcnt(10) lgkmcnt(0)
    s_barrier
    s_add_u32 s96, s95, 7
    s_and_b32 s96, s96, 15
    s_lshl_b32 s97, s96, 7
    s_add_u32 s97, s97, s84
    s_add_u32 m0, s86, 131072
    s_nop 0
    buffer_load_dwordx4 v4, s[4:7], s97 offen offset:0 lds
    buffer_load_dwordx4 v5, s[4:7], s97 offen offset:1024 lds
    buffer_load_dwordx4 v6, s[4:7], s97 offen offset:2048 lds
    buffer_load_dwordx4 v7, s[4:7], s97 offen offset:3072 lds
    s_add_u32 s96, s95, 7
    s_and_b32 s96, s96, 15
    s_mul_i32 s96, s96, 393216
    s_add_u32 s96, s96, s85
    s_add_u32 m0, s87, 65536
    s_nop 0
    buffer_load_dwordx4 v8, s[16:19], s96 offen offset:0 lds
    buffer_load_dwordx4 v9, s[16:19], s96 offen offset:1024 lds
    buffer_load_dwordx4 v10, s[16:19], s96 offen offset:2048 lds
    buffer_load_dwordx4 v11, s[16:19], s96 offen offset:3072 lds
    s_add_u32 m0, s87, 69632
    s_nop 0
    buffer_load_dwordx4 v12, s[16:19], s96 offen offset:0 lds
    buffer_load_dwordx4 v13, s[16:19], s96 offen offset:1024 lds
    s_waitcnt vmcnt(10) lgkmcnt(0)
    s_barrier
    s_add_u32 s96, s94, 8
    s_and_b32 s96, s96, 15
    s_lshl_b32 s97, s96, 7
    s_add_u32 s97, s97, s84
    s_add_u32 m0, s86, 114688
    s_nop 0
    buffer_load_dwordx4 v4, s[4:7], s97 offen offset:0 lds
    buffer_load_dwordx4 v5, s[4:7], s97 offen offset:1024 lds
    buffer_load_dwordx4 v6, s[4:7], s97 offen offset:2048 lds
    buffer_load_dwordx4 v7, s[4:7], s97 offen offset:3072 lds
    s_add_u32 s96, s94, 8
    s_and_b32 s96, s96, 15
    s_mul_i32 s96, s96, 393216
    s_add_u32 s96, s96, s85
    s_add_u32 m0, s87, 90112
    s_nop 0
    buffer_load_dwordx4 v8, s[16:19], s96 offen offset:0 lds
    buffer_load_dwordx4 v9, s[16:19], s96 offen offset:1024 lds
    buffer_load_dwordx4 v10, s[16:19], s96 offen offset:2048 lds
    buffer_load_dwordx4 v11, s[16:19], s96 offen offset:3072 lds
    s_add_u32 m0, s87, 94208
    s_nop 0
    buffer_load_dwordx4 v12, s[16:19], s96 offen offset:0 lds
    buffer_load_dwordx4 v13, s[16:19], s96 offen offset:1024 lds
    s_waitcnt vmcnt(10) lgkmcnt(0)
    s_barrier
    s_add_u32 s96, s95, 9
    s_and_b32 s96, s96, 15
    s_lshl_b32 s97, s96, 7
    s_add_u32 s97, s97, s84
    s_add_u32 m0, s86, 147456
    s_nop 0
    buffer_load_dwordx4 v4, s[4:7], s97 offen offset:0 lds
    buffer_load_dwordx4 v5, s[4:7], s97 offen offset:1024 lds
    buffer_load_dwordx4 v6, s[4:7], s97 offen offset:2048 lds
    buffer_load_dwordx4 v7, s[4:7], s97 offen offset:3072 lds
    s_add_u32 s96, s95, 9
    s_and_b32 s96, s96, 15
    s_mul_i32 s96, s96, 393216
    s_add_u32 s96, s96, s85
    s_add_u32 m0, s87, 40960
    s_nop 0
    buffer_load_dwordx4 v8, s[16:19], s96 offen offset:0 lds
    buffer_load_dwordx4 v9, s[16:19], s96 offen offset:1024 lds
    buffer_load_dwordx4 v10, s[16:19], s96 offen offset:2048 lds
    buffer_load_dwordx4 v11, s[16:19], s96 offen offset:3072 lds
    s_add_u32 m0, s87, 45056
    s_nop 0
    buffer_load_dwordx4 v12, s[16:19], s96 offen offset:0 lds
    buffer_load_dwordx4 v13, s[16:19], s96 offen offset:1024 lds
    s_waitcnt vmcnt(10) lgkmcnt(0)
    s_barrier
    s_add_u32 s96, s94, 10
    s_and_b32 s96, s96, 15
    s_lshl_b32 s97, s96, 7
    s_add_u32 s97, s97, s84
    s_add_u32 m0, s86, 131072
    s_nop 0
    buffer_load_dwordx4 v4, s[4:7], s97 offen offset:0 lds
    buffer_load_dwordx4 v5, s[4:7], s97 offen offset:1024 lds
    buffer_load_dwordx4 v6, s[4:7], s97 offen offset:2048 lds
    buffer_load_dwordx4 v7, s[4:7], s97 offen offset:3072 lds
    s_add_u32 s96, s94, 10
    s_and_b32 s96, s96, 15
    s_mul_i32 s96, s96, 393216
    s_add_u32 s96, s96, s85
    s_add_u32 m0, s87, 65536
    s_nop 0
    buffer_load_dwordx4 v8, s[16:19], s96 offen offset:0 lds
    buffer_load_dwordx4 v9, s[16:19], s96 offen offset:1024 lds
    buffer_load_dwordx4 v10, s[16:19], s96 offen offset:2048 lds
    buffer_load_dwordx4 v11, s[16:19], s96 offen offset:3072 lds
    s_add_u32 m0, s87, 69632
    s_nop 0
    buffer_load_dwordx4 v12, s[16:19], s96 offen offset:0 lds
    buffer_load_dwordx4 v13, s[16:19], s96 offen offset:1024 lds
    s_waitcnt vmcnt(10) lgkmcnt(0)
    s_barrier
    s_add_u32 s96, s95, 11
    s_and_b32 s96, s96, 15
    s_lshl_b32 s97, s96, 7
    s_add_u32 s97, s97, s84
    s_add_u32 m0, s86, 114688
    s_nop 0
    buffer_load_dwordx4 v4, s[4:7], s97 offen offset:0 lds
    buffer_load_dwordx4 v5, s[4:7], s97 offen offset:1024 lds
    buffer_load_dwordx4 v6, s[4:7], s97 offen offset:2048 lds
    buffer_load_dwordx4 v7, s[4:7], s97 offen offset:3072 lds
    s_add_u32 s96, s95, 11
    s_and_b32 s96, s96, 15
    s_mul_i32 s96, s96, 393216
    s_add_u32 s96, s96, s85
    s_add_u32 m0, s87, 90112
    s_nop 0
    buffer_load_dwordx4 v8, s[16:19], s96 offen offset:0 lds
    buffer_load_dwordx4 v9, s[16:19], s96 offen offset:1024 lds
    buffer_load_dwordx4 v10, s[16:19], s96 offen offset:2048 lds
    buffer_load_dwordx4 v11, s[16:19], s96 offen offset:3072 lds
    s_add_u32 m0, s87, 94208
    s_nop 0
    buffer_load_dwordx4 v12, s[16:19], s96 offen offset:0 lds
    buffer_load_dwordx4 v13, s[16:19], s96 offen offset:1024 lds
    s_waitcnt vmcnt(10) lgkmcnt(0)
    s_barrier
    s_add_u32 s96, s94, 12
    s_and_b32 s96, s96, 15
    s_lshl_b32 s97, s96, 7
    s_add_u32 s97, s97, s84
    s_add_u32 m0, s86, 147456
    s_nop 0
    buffer_load_dwordx4 v4, s[4:7], s97 offen offset:0 lds
    buffer_load_dwordx4 v5, s[4:7], s97 offen offset:1024 lds
    s_getpc_b64 s[32:33]
pc_38:
    buffer_load_dwordx4 v6, s[4:7], s97 offen offset:2048 lds
    s_sub_u32 s32, s32, pc_38-interleave_layers__sliding_block__moe_arch_mod__prompt_kernel
    s_subb_u32 s33, s33, 0
    buffer_load_dwordx4 v7, s[4:7], s97 offen offset:3072 lds
    s_lshr_b32 s34, s2, 3
    s_add_u32 s96, s94, 12
    s_and_b32 s96, s96, 15
    s_mul_i32 s96, s96, 393216
    s_add_u32 s96, s96, s85
    s_add_u32 m0, s87, 40960
    s_nop 0
    buffer_load_dwordx4 v8, s[16:19], s96 offen offset:0 lds
    s_lshl_b32 s34, s34, 2
    buffer_load_dwordx4 v9, s[16:19], s96 offen offset:1024 lds
    s_add_u32 s34, s34, s28
    s_and_b32 s34, s34, 127
    buffer_load_dwordx4 v10, s[16:19], s96 offen offset:2048 lds
    s_lshl_b32 s34, s34, 7
    buffer_load_dwordx4 v11, s[16:19], s96 offen offset:3072 lds
    v_lshl_add_u32 v154, v252, 14, s34
    s_mov_b32 s34, k_exit-interleave_layers__sliding_block__moe_arch_mod__prompt_kernel
    s_add_u32 m0, s87, 45056
    s_nop 0
    buffer_load_dwordx4 v12, s[16:19], s96 offen offset:0 lds
    s_mov_b32 s35, 0x20000
    buffer_load_dwordx4 v13, s[16:19], s96 offen offset:1024 lds
    buffer_load_dword v154, v154, s[32:35], 0 offen
    s_waitcnt vmcnt(11) lgkmcnt(0)
    s_barrier
    buffer_load_dwordx2 v[16:17], v15, s[20:23], 0 offen sc1
    s_add_u32 s96, s95, 13
    s_and_b32 s96, s96, 15
    s_lshl_b32 s97, s96, 7
    s_add_u32 s97, s97, s84
    s_add_u32 m0, s86, 131072
    s_nop 0
    buffer_load_dwordx4 v4, s[4:7], s97 offen offset:0 lds
    buffer_load_dwordx4 v5, s[4:7], s97 offen offset:1024 lds
    buffer_load_dwordx4 v6, s[4:7], s97 offen offset:2048 lds
    buffer_load_dwordx4 v7, s[4:7], s97 offen offset:3072 lds
    s_add_u32 s96, s95, 13
    s_and_b32 s96, s96, 15
    s_mul_i32 s96, s96, 393216
    s_add_u32 s96, s96, s85
    s_add_u32 m0, s87, 65536
    s_nop 0
    buffer_load_dwordx4 v8, s[16:19], s96 offen offset:0 lds
    buffer_load_dwordx4 v9, s[16:19], s96 offen offset:1024 lds
    buffer_load_dwordx4 v10, s[16:19], s96 offen offset:2048 lds
    buffer_load_dwordx4 v11, s[16:19], s96 offen offset:3072 lds
    s_add_u32 m0, s87, 69632
    s_nop 0
    buffer_load_dwordx4 v12, s[16:19], s96 offen offset:0 lds
    buffer_load_dwordx4 v13, s[16:19], s96 offen offset:1024 lds
    s_waitcnt vmcnt(12) lgkmcnt(0)
    s_barrier
    s_add_u32 s96, s94, 14
    s_and_b32 s96, s96, 15
    s_lshl_b32 s97, s96, 7
    s_add_u32 s97, s97, s84
    s_add_u32 m0, s86, 114688
    s_nop 0
    buffer_load_dwordx4 v4, s[4:7], s97 offen offset:0 lds
    buffer_load_dwordx4 v5, s[4:7], s97 offen offset:1024 lds
    buffer_load_dwordx4 v6, s[4:7], s97 offen offset:2048 lds
    buffer_load_dwordx4 v7, s[4:7], s97 offen offset:3072 lds
    s_add_u32 s96, s94, 14
    s_and_b32 s96, s96, 15
    s_mul_i32 s96, s96, 393216
    s_add_u32 s96, s96, s85
    s_add_u32 m0, s87, 90112
    s_nop 0
    buffer_load_dwordx4 v8, s[16:19], s96 offen offset:0 lds
    buffer_load_dwordx4 v9, s[16:19], s96 offen offset:1024 lds
    buffer_load_dwordx4 v10, s[16:19], s96 offen offset:2048 lds
    buffer_load_dwordx4 v11, s[16:19], s96 offen offset:3072 lds
    s_add_u32 m0, s87, 94208
    s_nop 0
    buffer_load_dwordx4 v12, s[16:19], s96 offen offset:0 lds
    buffer_load_dwordx4 v13, s[16:19], s96 offen offset:1024 lds
    s_mov_b32 s78, s27
    s_waitcnt vmcnt(20)
    s_branch pc_40
pl_39:
    buffer_load_dwordx2 v[16:17], v15, s[20:23], 0 offen sc1
    s_waitcnt vmcnt(0)
pc_40:
    v_cmp_ne_u32 vcc, s88, v16
    s_cbranch_vccz pd_41
    s_sub_u32 s78, s78, 1
    s_cmp_lg_u32 s78, 0
    s_cbranch_scc1 pl_39
    s_mov_b32 s27, 1
pd_41:
    s_getreg_b32 s30, hwreg(HW_REG_XCC_ID, 0, 4)
    v_cmp_ne_u32_e64 vcc, s30, v17
    s_and_b32 s30, vcc_lo, 0xffff
    s_cselect_b32 s77, 0, 1
    v_mov_b32 v20, s73
    v_mov_b32_e64 v21, s77
    v_mov_b32 v19, 0
    ds_write_b64 v19, v[20:21] offset:3072
    s_waitcnt vmcnt(10) lgkmcnt(0)
    s_barrier
    s_add_u32 s96, s95, 15
    s_and_b32 s96, s96, 15
    s_lshl_b32 s97, s96, 7
    s_add_u32 s97, s97, s84
    s_add_u32 m0, s86, 147456
    s_nop 0
    buffer_load_dwordx4 v4, s[4:7], s97 offen offset:0 lds
    buffer_load_dwordx4 v5, s[4:7], s97 offen offset:1024 lds
    buffer_load_dwordx4 v6, s[4:7], s97 offen offset:2048 lds
    buffer_load_dwordx4 v7, s[4:7], s97 offen offset:3072 lds
    s_add_u32 s96, s95, 15
    s_and_b32 s96, s96, 15
    s_mul_i32 s96, s96, 393216
    s_add_u32 s96, s96, s85
    s_add_u32 m0, s87, 40960
    s_nop 0
    buffer_load_dwordx4 v8, s[16:19], s96 offen offset:0 lds
    buffer_load_dwordx4 v9, s[16:19], s96 offen offset:1024 lds
    buffer_load_dwordx4 v10, s[16:19], s96 offen offset:2048 lds
    buffer_load_dwordx4 v11, s[16:19], s96 offen offset:3072 lds
    s_add_u32 m0, s87, 45056
    s_nop 0
    buffer_load_dwordx4 v12, s[16:19], s96 offen offset:0 lds
    buffer_load_dwordx4 v13, s[16:19], s96 offen offset:1024 lds
    s_waitcnt vmcnt(10) lgkmcnt(0)
    s_barrier
    s_load_dwordx2 s[4:5], s[0:1], 48
    s_cmp_lt_u32 s29, 224
    s_cselect_b32 s6, 0x700000, 0
    s_mov_b32 s7, 0x20000
    s_lshl_b32 s30, s99, 12
    s_add_u32 s30, s30, 0x2400000
    buffer_load_dwordx4 v[64:67], v253, s[20:23], s30 offen offset:0 sc1
    buffer_load_dwordx4 v[68:71], v253, s[20:23], s30 offen offset:1024 sc1
    buffer_load_dwordx4 v[72:75], v253, s[20:23], s30 offen offset:2048 sc1
    buffer_load_dwordx4 v[76:79], v253, s[20:23], s30 offen offset:3072 sc1
    s_min_u32 s32, s28, 2
    s_lshl_b32 s32, s32, 12
    s_lshl_b32 s33, s25, 14
    s_add_u32 s32, s32, s33
    s_add_u32 s32, s32, 0x2500000
    buffer_load_dwordx4 v[32:35], v253, s[20:23], s32 offen offset:0 sc1
    buffer_load_dwordx4 v[36:39], v253, s[20:23], s32 offen offset:1024 sc1
    buffer_load_dwordx4 v[40:43], v253, s[20:23], s32 offen offset:2048 sc1
    buffer_load_dwordx4 v[44:47], v253, s[20:23], s32 offen offset:3072 sc1
    s_add_u32 s96, s25, 1
    s_and_b32 s96, s96, 15
    s_lshl_b32 s96, s96, 17
    s_add_u32 m0, s101, 4096
    s_nop 0
    buffer_load_dwordx4 v14, s[8:11], s96 offen lds
    s_add_u32 s96, s25, 2
    s_and_b32 s96, s96, 15
    s_lshl_b32 s96, s96, 17
    s_add_u32 m0, s101, 8192
    s_nop 0
    buffer_load_dwordx4 v14, s[8:11], s96 offen lds
    s_add_u32 s96, s25, 3
    s_and_b32 s96, s96, 15
    s_lshl_b32 s96, s96, 17
    s_add_u32 m0, s101, 12288
    s_nop 0
    buffer_load_dwordx4 v14, s[8:11], s96 offen lds
    s_waitcnt vmcnt(11) lgkmcnt(0)
    s_barrier
    s_waitcnt vmcnt(3)
    v_add_f32 v64, v64, v68
    v_add_f32 v65, v65, v69
    v_add_f32 v66, v66, v70
    v_add_f32 v67, v67, v71
    v_add_f32 v64, v64, v72
    v_add_f32 v65, v65, v73
    v_add_f32 v66, v66, v74
    v_add_f32 v67, v67, v75
    v_add_f32 v64, v64, v76
    v_add_f32 v65, v65, v77
    v_add_f32 v66, v66, v78
    v_add_f32 v67, v67, v79
    s_nop 0
    v_permlane32_swap_b32 v64, v66
    v_permlane32_swap_b32 v65, v67
    v_add_f32 v64, v64, v66
    v_add_f32 v65, v65, v67
    v_mov_b32 v48, v64
    v_mov_b32 v49, v65
    s_nop 0
    v_permlane16_swap_b32 v64, v48
    v_permlane16_swap_b32 v65, v49
    v_add_f32 v64, v64, v48
    v_add_f32_e64 v65, v65, v49
    v_mul_f32 v54, 0x3a800000, v64
    v_mul_f32 v65, 0x3a800000, v65
    v_fma_f32 v65, -v54, v54, v65
    v_max_f32_e64 v65, 0, v65
    v_add_f32 v55, 0x3727c5ac, v65
    v_rsq_f32 v55, v55
    v_add_f32 v32, v32, v36
    v_add_f32 v33, v33, v37
    v_add_f32 v34, v34, v38
    v_add_f32 v35, v35, v39
    v_add_f32 v32, v32, v40
    v_add_f32 v33, v33, v41
    v_add_f32 v34, v34, v42
    v_add_f32 v35, v35, v43
    v_add_f32 v32, v32, v44
    v_add_f32 v33, v33, v45
    v_add_f32 v34, v34, v46
    v_add_f32 v35, v35, v47
    s_nop 0
    v_permlane32_swap_b32 v32, v34
    v_permlane32_swap_b32 v33, v35
    v_add_f32 v32, v32, v34
    v_add_f32 v33, v33, v35
    s_nop 1
    v_permlane16_swap_b32 v32, v33
    v_add_f32 v32, v32, v33
    v_mov_b32 v2, v32
    v_and_b32 v48, 15, v252
    v_lshrrev_b32 v49, 5, v252
    v_lshl_add_u32 v48, v48, 1, v49
    v_bfe_u32 v49, v252, 4, 1
    v_cmp_eq_u32 vcc, 0, v49
    v_lshlrev_b32 v49, 9, v49
    v_lshl_add_u32 v48, v48, 2, v49
    s_lshl_b32 s32, s28, 7
    v_add_u32 v48, s32, v48
    v_cndmask_b32_e64 v49, v54, v55, vcc
    v_cndmask_b32 v50, 0, 1.0, vcc
    ds_write_b32 v48, v49 offset:0
    ds_write_b32 v48, v50 offset:2048
    v_and_b32 v48, 15, v252
    v_lshrrev_b32 v51, 4, v252
    v_lshl_add_u32 v48, v48, 2, v51
    s_min_u32 s32, s28, 2
    s_lshl_b32 s32, s32, 8
    v_lshl_add_u32 v48, v48, 2, s32
    ds_write_b32 v48, v2 offset:1024
    s_waitcnt lgkmcnt(0)
    s_barrier
l_att:
    s_add_u32 s96, s25, 10
    s_and_b32 s96, s96, 15
    s_lshl_b32 s96, s96, 17
    s_add_u32 m0, s101, 40960
    s_nop 0
    buffer_load_dwordx4 v14, s[8:11], s96 offen lds
    s_add_u32 s96, s25, 11
    s_and_b32 s96, s96, 15
    s_lshl_b32 s96, s96, 17
    s_add_u32 m0, s101, 45056
    s_nop 0
    buffer_load_dwordx4 v14, s[8:11], s96 offen lds
    s_cmp_lg_u32 s26, 0
    s_cbranch_scc1 sk_42
    s_add_u32 s96, s25, 4
    s_and_b32 s96, s96, 15
    s_lshl_b32 s96, s96, 17
    s_add_u32 m0, s101, 16384
    s_nop 0
    buffer_load_dwordx4 v14, s[8:11], s96 offen lds
    s_add_u32 s96, s25, 5
    s_and_b32 s96, s96, 15
    s_lshl_b32 s96, s96, 17
    s_add_u32 m0, s101, 20480
    s_nop 0
    buffer_load_dwordx4 v14, s[8:11], s96 offen lds
    s_add_u32 s96, s25, 6
    s_and_b32 s96, s96, 15
    s_lshl_b32 s96, s96, 17
    s_add_u32 m0, s101, 24576
    s_nop 0
    buffer_load_dwordx4 v14, s[8:11], s96 offen lds
    s_add_u32 s96, s25, 7
    s_and_b32 s96, s96, 15
    s_lshl_b32 s96, s96, 17
    s_add_u32 m0, s101, 28672
    s_nop 0
    buffer_load_dwordx4 v14, s[8:11], s96 offen lds
    s_add_u32 s96, s25, 8
    s_and_b32 s96, s96, 15
    s_lshl_b32 s96, s96, 17
    s_add_u32 m0, s101, 32768
    s_nop 0
    buffer_load_dwordx4 v14, s[8:11], s96 offen lds
    s_add_u32 s96, s25, 9
    s_and_b32 s96, s96, 15
    s_lshl_b32 s96, s96, 17
    s_add_u32 m0, s101, 36864
    s_nop 0
    buffer_load_dwordx4 v14, s[8:11], s96 offen lds
sk_42:
    v_mov_b32 v20, 0xffff
    v_mov_b32 v21, 0xffff0000
    v_cndmask_b32 v22, 0, v20, s[40:41]
    v_cndmask_b32 v23, 0, v21, s[42:43]
    v_or_b32_e64 v12, v22, v23
    v_cndmask_b32 v22, 0, v20, s[44:45]
    v_cndmask_b32 v23, 0, v21, s[46:47]
    v_or_b32_e64 v13, v22, v23
    v_cndmask_b32 v22, 0, v20, s[48:49]
    v_cndmask_b32 v23, 0, v21, s[50:51]
    v_or_b32_e64 v14, v22, v23
    v_cndmask_b32 v22, 0, v20, s[52:53]
    v_cndmask_b32 v23, 0, v21, s[54:55]
    v_or_b32_e64 v15, v22, v23
    v_cndmask_b32 v22, 0, v20, s[56:57]
    v_cndmask_b32 v23, 0, v21, s[58:59]
    v_or_b32_e64 v16, v22, v23
    v_cndmask_b32 v22, 0, v20, s[60:61]
    v_cndmask_b32 v23, 0, v21, s[62:63]
    v_or_b32_e64 v17, v22, v23
    v_cndmask_b32 v22, 0, v20, s[64:65]
    v_cndmask_b32 v23, 0, v21, s[66:67]
    v_or_b32_e64 v18, v22, v23
    v_cndmask_b32 v22, 0, v20, s[68:69]
    v_cndmask_b32 v23, 0, v21, s[70:71]
    v_or_b32 v19, v22, v23
    s_xor_b32 s76, s99, 3
    s_and_b32 s34, s76, 3
    s_lshl_b32 s33, s34, 12
    s_add_u32 s33, s33, 114688
    v_add_u32_e64 v20, s33, v253
    v_add_u32 v22, 32768, v20
    v_add_u32 v23, 143360, v253
    s_add_u32 s74, s34, 1
    s_mov_b32 s75, 0
    s_lshl_b32 s34, s34, 11
    s_add_u32 s34, s34, 57344
    v_add_u32 v3, s34, v253
    v_mov_b32 v21, 0xf149f2ca
    v_cndmask_b32 v24, v21, 0, s[40:41]
    v_cndmask_b32 v25, v21, 0, s[42:43]
    v_cndmask_b32 v26, v21, 0, s[44:45]
    v_cndmask_b32 v27, v21, 0, s[46:47]
    v_cndmask_b32 v28, v21, 0, s[48:49]
    v_cndmask_b32 v29, v21, 0, s[50:51]
    v_cndmask_b32 v30, v21, 0, s[52:53]
    v_cndmask_b32 v31, v21, 0, s[54:55]
    v_cndmask_b32 v32, v21, 0, s[56:57]
    v_cndmask_b32 v33, v21, 0, s[58:59]
    v_cndmask_b32 v34, v21, 0, s[60:61]
    v_cndmask_b32 v35, v21, 0, s[62:63]
    v_cndmask_b32 v36, v21, 0, s[64:65]
    v_cndmask_b32 v37, v21, 0, s[66:67]
    v_cndmask_b32 v38, v21, 0, s[68:69]
    v_cndmask_b32 v39, v21, 0, s[70:71]
    v_lshrrev_b32 v40, 2, v252
    v_xor_b32 v40, v40, v252
    v_bfe_u32 v40, v40, 2, 1
    v_add_u32_e64 v40, -1, v40
    v_and_b32 v40, 0x3f803f80, v40
    v_mov_b32 v41, v40
    v_mov_b32 v42, v40
    v_mov_b32 v43, v40
    v_mov_b32 v44, 0
    v_mov_b32 v45, 0
    v_mov_b32 v46, 0
    v_mov_b32 v47, 0
    v_mov_b32 v88, 0
    v_mov_b32 v89, 0
    v_mov_b32 v90, 0
    v_mov_b32 v91, 0
    v_mov_b32 v92, 0
    v_mov_b32 v93, 0
    v_mov_b32 v94, 0
    v_mov_b32 v95, 0
    v_mov_b32 v96, 0
    v_mov_b32 v97, 0
    v_mov_b32 v98, 0
    v_mov_b32 v99, 0
    v_mov_b32 v100, 0
    v_mov_b32 v101, 0
    v_mov_b32 v102, 0
    v_mov_b32 v103, 0
    s_lshr_b32 s36, s28, 1
    s_add_u32 s36, s36, s24
    s_sub_u32 s36, s36, 2
    s_and_b32 s34, s28, 1
    s_lshl_b32 s35, s25, 7
    s_lshl_b32 s30, s36, 2
    s_add_u32 s35, s35, s30
    s_lshl_b32 s30, s34, 1
    s_add_u32 s35, s35, s30
    s_lshl_b32 s35, s35, 12
    s_add_u32 s35, s35, s26
    s_lshl_b32 s30, s25, 8
    s_lshl_b32 s31, s36, 4
    s_add_u32 s30, s30, s31
    s_lshl_b32 s31, s34, 3
    s_add_u32 s30, s30, s31
    s_add_u32 s30, s30, s26
    s_add_u32 s30, s30, 0xdd0000
    v_and_b32 v48, 4, v252
    s_cmp_eq_u32 s100, 2
    s_cbranch_scc1 sk_43
    s_barrier
sk_43:
    s_cmp_gt_u32 s100, 0
    s_cbranch_scc1 l_patch
l_patched:
    ds_read_b128 v[4:7], v3
    ds_read_b128 v[8:11], v3 offset:1024
    ds_read_b128 v[112:115], v22 offset:0
    ds_read_b128 v[116:119], v22 offset:1024
    s_waitcnt lgkmcnt(0)
    v_mfma_f32_32x32x16_bf16 v[56:71], v[112:115], v[4:7], v[24:39]
    v_mfma_f32_32x32x16_bf16 v[56:71], v[116:119], v[8:11], v[56:71]
    ds_read_b128 v[104:107], v23 offset:4096
    ds_read_b128 v[124:127], v22 offset:3072
    ds_read_b128 v[108:111], v23 offset:5120
    ds_read_b128 v[120:123], v22 offset:2048
    s_cmp_lg_u32 s26, 0
    s_cbranch_scc1 sk_45
    s_xor_b32 s96, s29, 0
    s_and_b32 s97, s96, 2
    s_and_b32 s96, s96, 3
    s_mul_i32 s97, s97, 14336
    s_mul_i32 s96, s96, 14336
    s_add_u32 s96, s96, s97
    buffer_load_dwordx4 v[156:159], v155, s[80:83], s96 offen
    s_xor_b32 s96, s29, 0
    s_and_b32 s97, s96, 2
    s_and_b32 s96, s96, 3
    s_mul_i32 s97, s97, 14336
    s_mul_i32 s96, s96, 14336
    s_add_u32 s96, s96, s97
    s_add_u32 s96, s96, 7168
    buffer_load_dwordx4 v[160:163], v155, s[80:83], s96 offen
    s_xor_b32 s96, s29, 1
    s_and_b32 s97, s96, 2
    s_and_b32 s96, s96, 3
    s_mul_i32 s97, s97, 14336
    s_mul_i32 s96, s96, 14336
    s_add_u32 s96, s96, s97
    buffer_load_dwordx4 v[164:167], v155, s[80:83], s96 offen
    s_xor_b32 s96, s29, 1
    s_and_b32 s97, s96, 2
    s_and_b32 s96, s96, 3
    s_mul_i32 s97, s97, 14336
    s_mul_i32 s96, s96, 14336
    s_add_u32 s96, s96, s97
    s_add_u32 s96, s96, 7168
    buffer_load_dwordx4 v[168:171], v155, s[80:83], s96 offen
    s_xor_b32 s96, s29, 2
    s_and_b32 s97, s96, 2
    s_and_b32 s96, s96, 3
    s_mul_i32 s97, s97, 14336
    s_mul_i32 s96, s96, 14336
    s_add_u32 s96, s96, s97
    buffer_load_dwordx4 v[172:175], v155, s[80:83], s96 offen
    s_xor_b32 s96, s29, 2
    s_and_b32 s97, s96, 2
    s_and_b32 s96, s96, 3
    s_mul_i32 s97, s97, 14336
    s_mul_i32 s96, s96, 14336
    s_add_u32 s96, s96, s97
    s_add_u32 s96, s96, 7168
    buffer_load_dwordx4 v[176:179], v155, s[80:83], s96 offen
    s_xor_b32 s96, s29, 3
    s_and_b32 s97, s96, 2
    s_and_b32 s96, s96, 3
    s_mul_i32 s97, s97, 14336
    s_mul_i32 s96, s96, 14336
    s_add_u32 s96, s96, s97
    buffer_load_dwordx4 v[180:183], v155, s[80:83], s96 offen
    s_xor_b32 s96, s29, 3
    s_and_b32 s97, s96, 2
    s_and_b32 s96, s96, 3
    s_mul_i32 s97, s97, 14336
    s_mul_i32 s96, s96, 14336
    s_add_u32 s96, s96, s97
    s_add_u32 s96, s96, 7168
    buffer_load_dwordx4 v[184:187], v155, s[80:83], s96 offen
sk_45:
    s_nop 5
    v_max3_f32 v21, v56, v57, v58
    v_max3_f32 v152, v59, v60, v61
    v_max3_f32 v21, v21, v62, v63
    v_max3_f32 v152, v152, v64, v65
    v_max3_f32 v21, v21, v66, v67
    v_max3_f32 v152, v152, v68, v69
    v_max3_f32 v21, v21, v70, v71
    v_max_f32 v21, v21, v152
    v_mov_b32 v152, v21
    s_nop 1
    v_permlane32_swap_b32 v21, v152
    v_max_f32 v21, v21, v152
    v_sub_f32 v24, 0, v21
    v_sub_f32 v25, 0, v21
    v_sub_f32 v26, 0, v21
    v_sub_f32 v27, 0, v21
    v_sub_f32 v28, 0, v21
    v_sub_f32 v29, 0, v21
    v_sub_f32 v30, 0, v21
    v_sub_f32 v31, 0, v21
    v_sub_f32 v32, 0, v21
    v_sub_f32 v33, 0, v21
    v_sub_f32 v34, 0, v21
    v_sub_f32 v35, 0, v21
    v_sub_f32 v36, 0, v21
    v_sub_f32 v37, 0, v21
    v_sub_f32 v38, 0, v21
    v_sub_f32 v39, 0, v21
    s_branch a1_44_go
    s_nop 0
a1_44_mid:
    s_cmp_ge_u32 s76, 8
    s_cselect_b32 s33, 0, -1
    v_not_b32 v12, v12
    v_or_b32 v12, s33, v12
    v_not_b32 v13, v13
    v_or_b32 v13, s33, v13
    v_not_b32 v14, v14
    v_or_b32 v14, s33, v14
    v_not_b32 v15, v15
    v_or_b32 v15, s33, v15
    v_not_b32 v16, v16
    v_or_b32 v16, s33, v16
    v_not_b32 v17, v17
    v_or_b32 v17, s33, v17
    v_not_b32 v18, v18
    v_or_b32 v18, s33, v18
    v_not_b32 v19, v19
    v_or_b32 v19, s33, v19
    s_and_b32 s32, s76, 3
    s_cmp_ge_u32 s76, 8
    s_cselect_b32 s32, s32, 4
    s_sub_u32 s74, 8, s32
    s_lshl_b32 s32, s32, 12
    s_add_u32 s32, s32, 114688
    v_add_u32_e64 v22, s32, v253
    v_add_u32 v23, s32, v253
    s_cmp_eq_u32 s26, 0
    s_cselect_b32 s75, 2, 1
    s_cmp_lt_i32 s36, 0
    s_cbranch_scc1 sk_46
    s_mov_b32 s78, s27
pl_47:
    buffer_load_dword v49, v48, s[20:23], s30 offen sc1
    s_waitcnt vmcnt(0)
pc_48:
    v_cmp_ne_u32 vcc, s88, v49
    s_cbranch_vccz pd_49
    s_sub_u32 s78, s78, 1
    s_cmp_lg_u32 s78, 0
    s_cbranch_scc1 pl_47
    s_mov_b32 s27, 1
pd_49:
    s_mov_b32 s36, -1
    s_lshl_b32 s30, s28, 13
    s_add_u32 m0, s30, 65536
    s_add_u32 s31, s35, 0
    buffer_load_dwordx4 v253, s[20:23], s31 offen offset:0 sc1 lds
    buffer_load_dwordx4 v253, s[20:23], s31 offen offset:1024 sc1 lds
    buffer_load_dwordx4 v253, s[20:23], s31 offen offset:2048 sc1 lds
    buffer_load_dwordx4 v253, s[20:23], s31 offen offset:3072 sc1 lds
    s_add_u32 m0, s30, 69632
    s_add_u32 s31, s35, 4096
    buffer_load_dwordx4 v253, s[20:23], s31 offen offset:0 sc1 lds
    buffer_load_dwordx4 v253, s[20:23], s31 offen offset:1024 sc1 lds
    buffer_load_dwordx4 v253, s[20:23], s31 offen offset:2048 sc1 lds
    buffer_load_dwordx4 v253, s[20:23], s31 offen offset:3072 sc1 lds
    s_add_u32 m0, s30, 114688
    s_add_u32 s31, s35, 262144
    buffer_load_dwordx4 v253, s[20:23], s31 offen offset:0 sc1 lds
    buffer_load_dwordx4 v253, s[20:23], s31 offen offset:1024 sc1 lds
    buffer_load_dwordx4 v253, s[20:23], s31 offen offset:2048 sc1 lds
    buffer_load_dwordx4 v253, s[20:23], s31 offen offset:3072 sc1 lds
    s_add_u32 m0, s30, 118784
    s_add_u32 s31, s35, 266240
    buffer_load_dwordx4 v253, s[20:23], s31 offen offset:0 sc1 lds
    buffer_load_dwordx4 v253, s[20:23], s31 offen offset:1024 sc1 lds
    buffer_load_dwordx4 v253, s[20:23], s31 offen offset:2048 sc1 lds
    buffer_load_dwordx4 v253, s[20:23], s31 offen offset:3072 sc1 lds
sk_46:
    s_waitcnt vmcnt(8)
    s_cmp_eq_u32 s100, 1
    s_cbranch_scc1 sk_50
    s_barrier
sk_50:
    s_waitcnt vmcnt(0)
    s_cmp_lg_u32 s100, 1
    s_cbranch_scc1 sk_51
    s_cmp_lg_u32 s38, 0
    s_barrier
    s_cselect_b64 exec, -1, 0
    ds_write_b16 v0, v1
    s_mov_b64 exec, -1
    s_waitcnt lgkmcnt(0)
    s_barrier
sk_51:
    s_barrier
    s_cmp_lt_u32 s76, 4
    s_cbranch_scc1 a1_44_none
    ds_read_b128 v[112:115], v22 offset:0
    ds_read_b128 v[116:119], v22 offset:1024
    ds_read_b128 v[104:107], v23 offset:4096
    ds_read_b128 v[124:127], v22 offset:3072
    ds_read_b128 v[108:111], v23 offset:5120
    ds_read_b128 v[120:123], v22 offset:2048
    s_waitcnt lgkmcnt(4)
a1_44_go:
    s_nop 0
    v_mfma_f32_32x32x16_bf16 v[56:71], v[112:115], v[4:7], v[24:39]
    v_mfma_f32_32x32x16_bf16 v[56:71], v[116:119], v[8:11], v[56:71]
    s_waitcnt lgkmcnt(3)
    v_mfma_f32_32x32x16_bf16 v[72:87], v[104:107], v[4:7], v[24:39]
    ds_read_b128 v[104:107], v23 offset:8192
    s_nop 8
    v_exp_f32 v56, v56
    v_exp_f32 v57, v57
    v_exp_f32_e64 v58, v58
    ds_read_b128 v[128:131], v23 offset:7168
    v_exp_f32 v59, v59
    v_exp_f32 v60, v60
    v_exp_f32 v61, v61
    s_waitcnt lgkmcnt(2)
    v_mfma_f32_32x32x16_bf16 v[72:87], v[108:111], v[8:11], v[72:87]
    ds_read_b128 v[108:111], v23 offset:9216
    v_exp_f32 v62, v62
    v_exp_f32 v63, v63
    v_cvt_pk_bf16_f32 v136, v56, v57
    v_cvt_pk_bf16_f32 v137, v58, v59
    v_cvt_pk_bf16_f32 v138, v60, v61
    v_cvt_pk_bf16_f32 v139, v62, v63
    v_and_b32 v136, v136, v12
    v_and_b32 v137, v137, v13
    v_and_b32 v138, v138, v14
    v_and_b32 v139, v139, v15
    v_exp_f32 v64, v64
    v_exp_f32 v65, v65
    v_mfma_f32_32x32x16_bf16 v[88:103], v[120:123], v[136:139], v[88:103]
    ds_read_b128 v[120:123], v23 offset:6144
    s_cmp_eq_u32 s75, 0
    s_cbranch_scc1 sk_53
    s_cmp_lg_u32 s26, 0
    s_cbranch_scc1 sk_52
    s_xor_b32 s96, s29, 0
    s_and_b32 s97, s96, 2
    s_and_b32 s96, s96, 3
    s_mul_i32 s97, s97, 14336
    s_mul_i32 s96, s96, 14336
    s_add_u32 s96, s96, s97
    buffer_load_dwordx4 v[188:191], v155, s[4:7], s96 offen
    s_xor_b32 s96, s29, 0
    s_and_b32 s97, s96, 2
    s_and_b32 s96, s96, 3
    s_mul_i32 s97, s97, 14336
    s_mul_i32 s96, s96, 14336
    s_add_u32 s96, s96, s97
    s_add_u32 s96, s96, 7168
    buffer_load_dwordx4 v[192:195], v155, s[4:7], s96 offen
sk_52:
sk_53:
    v_exp_f32 v66, v66
    v_exp_f32 v67, v67
    v_exp_f32 v68, v68
    v_exp_f32 v69, v69
    v_mfma_f32_16x16x32_bf16 v[44:47], v[40:43], v[136:139], v[44:47]
    v_exp_f32 v70, v70
    v_exp_f32 v71, v71
    v_cvt_pk_bf16_f32 v140, v64, v65
    v_cvt_pk_bf16_f32 v141, v66, v67
    v_cvt_pk_bf16_f32 v142, v68, v69
    v_cvt_pk_bf16_f32 v143, v70, v71
    v_and_b32 v140, v140, v16
    v_and_b32 v141, v141, v17
    v_and_b32_e64 v142, v142, v18
    v_and_b32 v143, v143, v19
    s_cmp_eq_u32 s75, 0
    s_cbranch_scc1 sk_55
    s_cmp_lg_u32 s26, 0
    s_cbranch_scc1 sk_54
    s_xor_b32 s96, s29, 1
    s_and_b32 s97, s96, 2
    s_and_b32 s96, s96, 3
    s_mul_i32 s97, s97, 14336
    s_mul_i32 s96, s96, 14336
    s_add_u32 s96, s96, s97
    buffer_load_dwordx4 v[196:199], v155, s[4:7], s96 offen
    s_xor_b32 s96, s29, 1
    s_and_b32 s97, s96, 2
    s_and_b32 s96, s96, 3
    s_mul_i32 s97, s97, 14336
    s_mul_i32 s96, s96, 14336
    s_add_u32 s96, s96, s97
    s_add_u32 s96, s96, 7168
    buffer_load_dwordx4 v[200:203], v155, s[4:7], s96 offen
sk_54:
sk_55:
    s_cmp_eq_u32 s74, 1
    s_cbranch_scc1 a1_44_e0
    s_cmp_eq_u32 s74, 2
    s_cbranch_scc1 a1_44_t1
    s_waitcnt lgkmcnt(3)
    v_mfma_f32_32x32x16_bf16 v[56:71], v[104:107], v[4:7], v[24:39]
    ds_read_b128 v[104:107], v23 offset:12288
    v_exp_f32 v72, v72
    v_exp_f32 v73, v73
    v_exp_f32_e64 v74, v74
    v_mfma_f32_32x32x16_bf16 v[88:103], v[124:127], v[140:143], v[88:103]
    ds_read_b128 v[124:127], v23 offset:11264
    v_exp_f32 v75, v75
    v_exp_f32 v76, v76
    v_exp_f32 v77, v77
    s_waitcnt lgkmcnt(2)
    v_mfma_f32_32x32x16_bf16 v[56:71], v[108:111], v[8:11], v[56:71]
    ds_read_b128 v[108:111], v23 offset:13312
    v_exp_f32 v78, v78
    v_exp_f32 v79, v79
    v_cvt_pk_bf16_f32 v136, v72, v73
    v_cvt_pk_bf16_f32 v137, v74, v75
    v_mfma_f32_16x16x32_bf16 v[44:47], v[40:43], v[140:143], v[44:47]
    v_cvt_pk_bf16_f32 v138, v76, v77
    v_cvt_pk_bf16_f32 v139, v78, v79
    v_exp_f32 v80, v80
    v_exp_f32 v81, v81
    v_mfma_f32_32x32x16_bf16 v[88:103], v[120:123], v[136:139], v[88:103]
    ds_read_b128 v[120:123], v23 offset:10240
    s_cmp_eq_u32 s75, 0
    s_cbranch_scc1 sk_57
    s_cmp_lg_u32 s26, 0
    s_cbranch_scc1 sk_56
    s_xor_b32 s96, s29, 2
    s_and_b32 s97, s96, 2
    s_and_b32 s96, s96, 3
    s_mul_i32 s97, s97, 14336
    s_mul_i32 s96, s96, 14336
    s_add_u32 s96, s96, s97
    buffer_load_dwordx4 v[204:207], v155, s[4:7], s96 offen
sk_56:
sk_57:
    v_exp_f32 v82, v82
    v_exp_f32 v83, v83
    v_exp_f32 v84, v84
    v_exp_f32 v85, v85
    v_mfma_f32_16x16x32_bf16 v[44:47], v[40:43], v[136:139], v[44:47]
    v_exp_f32 v86, v86
    v_exp_f32 v87, v87
    v_cvt_pk_bf16_f32 v140, v80, v81
    v_cvt_pk_bf16_f32 v141, v82, v83
    v_cvt_pk_bf16_f32 v142, v84, v85
    v_cvt_pk_bf16_f32 v143, v86, v87
    s_cmp_eq_u32 s75, 0
    s_cbranch_scc1 sk_59
    s_cmp_lg_u32 s26, 0
    s_cbranch_scc1 sk_58
    s_xor_b32 s96, s29, 2
    s_and_b32 s97, s96, 2
    s_and_b32 s96, s96, 3
    s_mul_i32 s97, s97, 14336
    s_mul_i32 s96, s96, 14336
    s_add_u32 s96, s96, s97
    s_add_u32 s96, s96, 7168
    buffer_load_dwordx4 v[208:211], v155, s[4:7], s96 offen
sk_58:
sk_59:
    s_cmp_eq_u32 s74, 3
    s_cbranch_scc1 a1_44_t0
    s_waitcnt lgkmcnt(3)
    v_mfma_f32_32x32x16_bf16 v[72:87], v[104:107], v[4:7], v[24:39]
    ds_read_b128 v[104:107], v23 offset:16384
    v_exp_f32 v56, v56
    v_exp_f32 v57, v57
    v_exp_f32 v58, v58
    v_mfma_f32_32x32x16_bf16 v[88:103], v[128:131], v[140:143], v[88:103]
    ds_read_b128 v[128:131], v23 offset:15360
    v_exp_f32 v59, v59
    v_exp_f32 v60, v60
    v_exp_f32 v61, v61
    s_waitcnt lgkmcnt(2)
    v_mfma_f32_32x32x16_bf16 v[72:87], v[108:111], v[8:11], v[72:87]
    ds_read_b128 v[108:111], v23 offset:17408
    v_exp_f32 v62, v62
    v_exp_f32 v63, v63
    v_cvt_pk_bf16_f32 v136, v56, v57
    v_cvt_pk_bf16_f32 v137, v58, v59
    v_mfma_f32_16x16x32_bf16 v[44:47], v[40:43], v[140:143], v[44:47]
    v_cvt_pk_bf16_f32 v138, v60, v61
    v_cvt_pk_bf16_f32 v139, v62, v63
    v_exp_f32 v64, v64
    v_exp_f32 v65, v65
    v_mfma_f32_32x32x16_bf16 v[88:103], v[120:123], v[136:139], v[88:103]
    ds_read_b128 v[120:123], v23 offset:14336
    s_cmp_eq_u32 s75, 0
    s_cbranch_scc1 sk_61
    s_cmp_lg_u32 s26, 0
    s_cbranch_scc1 sk_60
    s_xor_b32 s96, s29, 3
    s_and_b32 s97, s96, 2
    s_and_b32 s96, s96, 3
    s_mul_i32 s97, s97, 14336
    s_mul_i32 s96, s96, 14336
    s_add_u32 s96, s96, s97
    buffer_load_dwordx4 v[212:215], v155, s[4:7], s96 offen
sk_60:
sk_61:
    v_exp_f32 v66, v66
    v_exp_f32 v67, v67
    v_exp_f32 v68, v68
    v_exp_f32 v69, v69
    v_mfma_f32_16x16x32_bf16 v[44:47], v[40:43], v[136:139], v[44:47]
    v_exp_f32 v70, v70
    v_exp_f32 v71, v71
    v_cvt_pk_bf16_f32 v140, v64, v65
    v_cvt_pk_bf16_f32 v141, v66, v67
    v_cvt_pk_bf16_f32 v142, v68, v69
    v_cvt_pk_bf16_f32 v143, v70, v71
    s_cmp_eq_u32 s75, 0
    s_cbranch_scc1 sk_63
    s_barrier
    s_cmp_lg_u32 s26, 0
    s_cbranch_scc1 sk_62
    s_xor_b32 s96, s29, 3
    s_and_b32 s97, s96, 2
    s_and_b32 s96, s96, 3
    s_mul_i32 s97, s97, 14336
    s_mul_i32 s96, s96, 14336
    s_add_u32 s96, s96, s97
    s_add_u32 s96, s96, 7168
    buffer_load_dwordx4 v[216:219], v155, s[4:7], s96 offen
sk_62:
sk_63:
    s_cmp_eq_u32 s74, 4
    s_cbranch_scc1 a1_44_t1
    s_waitcnt lgkmcnt(3)
    v_mfma_f32_32x32x16_bf16 v[56:71], v[104:107], v[4:7], v[24:39]
    ds_read_b128 v[104:107], v23 offset:20480
    v_exp_f32 v72, v72
    v_exp_f32 v73, v73
    v_exp_f32_e64 v74, v74
    v_mfma_f32_32x32x16_bf16 v[88:103], v[124:127], v[140:143], v[88:103]
    ds_read_b128 v[124:127], v23 offset:19456
    v_exp_f32 v75, v75
    v_exp_f32 v76, v76
    v_exp_f32 v77, v77
    s_waitcnt lgkmcnt(2)
    v_mfma_f32_32x32x16_bf16 v[56:71], v[108:111], v[8:11], v[56:71]
    ds_read_b128 v[108:111], v23 offset:21504
    v_exp_f32 v78, v78
    v_exp_f32 v79, v79
    v_cvt_pk_bf16_f32 v136, v72, v73
    v_cvt_pk_bf16_f32 v137, v74, v75
    v_mfma_f32_16x16x32_bf16 v[44:47], v[40:43], v[140:143], v[44:47]
    v_cvt_pk_bf16_f32 v138, v76, v77
    v_cvt_pk_bf16_f32 v139, v78, v79
    v_exp_f32 v80, v80
    v_exp_f32 v81, v81
    v_mfma_f32_32x32x16_bf16 v[88:103], v[120:123], v[136:139], v[88:103]
    ds_read_b128 v[120:123], v23 offset:18432
    v_exp_f32 v82, v82
    v_exp_f32 v83, v83
    v_exp_f32 v84, v84
    v_exp_f32 v85, v85
    v_mfma_f32_16x16x32_bf16 v[44:47], v[40:43], v[136:139], v[44:47]
    v_exp_f32 v86, v86
    v_exp_f32 v87, v87
    v_cvt_pk_bf16_f32 v140, v80, v81
    v_cvt_pk_bf16_f32 v141, v82, v83
    v_cvt_pk_bf16_f32 v142, v84, v85
    v_cvt_pk_bf16_f32 v143, v86, v87
    s_cmp_eq_u32 s74, 5
    s_cbranch_scc1 a1_44_t0
    s_waitcnt lgkmcnt(3)
    v_mfma_f32_32x32x16_bf16 v[72:87], v[104:107], v[4:7], v[24:39]
    ds_read_b128 v[104:107], v23 offset:24576
    v_exp_f32 v56, v56
    v_exp_f32 v57, v57
    v_exp_f32 v58, v58
    v_mfma_f32_32x32x16_bf16 v[88:103], v[128:131], v[140:143], v[88:103]
    ds_read_b128 v[128:131], v23 offset:23552
    v_exp_f32 v59, v59
    v_exp_f32 v60, v60
    v_exp_f32 v61, v61
    s_waitcnt lgkmcnt(2)
    v_mfma_f32_32x32x16_bf16 v[72:87], v[108:111], v[8:11], v[72:87]
    ds_read_b128 v[108:111], v23 offset:25600
    v_exp_f32 v62, v62
    v_exp_f32 v63, v63
    v_cvt_pk_bf16_f32 v136, v56, v57
    v_cvt_pk_bf16_f32 v137, v58, v59
    v_mfma_f32_16x16x32_bf16 v[44:47], v[40:43], v[140:143], v[44:47]
    v_cvt_pk_bf16_f32 v138, v60, v61
    v_cvt_pk_bf16_f32 v139, v62, v63
    v_exp_f32 v64, v64
    v_exp_f32 v65, v65
    v_mfma_f32_32x32x16_bf16 v[88:103], v[120:123], v[136:139], v[88:103]
    ds_read_b128 v[120:123], v23 offset:22528
    v_exp_f32 v66, v66
    v_exp_f32 v67, v67
    v_exp_f32 v68, v68
    v_exp_f32 v69, v69
    v_mfma_f32_16x16x32_bf16 v[44:47], v[40:43], v[136:139], v[44:47]
    v_exp_f32 v70, v70
    v_exp_f32 v71, v71
    v_cvt_pk_bf16_f32 v140, v64, v65
    v_cvt_pk_bf16_f32 v141, v66, v67
    v_cvt_pk_bf16_f32 v142, v68, v69
    v_cvt_pk_bf16_f32 v143, v70, v71
    s_cmp_eq_u32 s74, 6
    s_cbranch_scc1 a1_44_t1
    s_waitcnt lgkmcnt(3)
    v_mfma_f32_32x32x16_bf16 v[56:71], v[104:107], v[4:7], v[24:39]
    ds_read_b128 v[104:107], v23 offset:28672
    v_exp_f32 v72, v72
    v_exp_f32 v73, v73
    v_exp_f32 v74, v74
    v_mfma_f32_32x32x16_bf16 v[88:103], v[124:127], v[140:143], v[88:103]
    ds_read_b128 v[124:127], v23 offset:27648
    v_exp_f32 v75, v75
    v_exp_f32 v76, v76
    v_exp_f32 v77, v77
    s_waitcnt lgkmcnt(2)
    v_mfma_f32_32x32x16_bf16 v[56:71], v[108:111], v[8:11], v[56:71]
    ds_read_b128 v[108:111], v23 offset:29696
    v_exp_f32 v78, v78
    v_exp_f32 v79, v79
    v_cvt_pk_bf16_f32 v136, v72, v73
    v_cvt_pk_bf16_f32 v137, v74, v75
    v_mfma_f32_16x16x32_bf16 v[44:47], v[40:43], v[140:143], v[44:47]
    v_cvt_pk_bf16_f32 v138, v76, v77
    v_cvt_pk_bf16_f32 v139, v78, v79
    v_exp_f32 v80, v80
    v_exp_f32 v81, v81
    v_mfma_f32_32x32x16_bf16 v[88:103], v[120:123], v[136:139], v[88:103]
    ds_read_b128 v[120:123], v23 offset:26624
    v_exp_f32 v82, v82
    v_exp_f32 v83, v83
    v_exp_f32 v84, v84
    v_exp_f32 v85, v85
    v_mfma_f32_16x16x32_bf16 v[44:47], v[40:43], v[136:139], v[44:47]
    v_exp_f32 v86, v86
    v_exp_f32 v87, v87
    v_cvt_pk_bf16_f32 v140, v80, v81
    v_cvt_pk_bf16_f32 v141, v82, v83
    v_cvt_pk_bf16_f32 v142, v84, v85
    v_cvt_pk_bf16_f32 v143, v86, v87
    s_cmp_eq_u32 s74, 7
    s_cbranch_scc1 a1_44_t0
    s_waitcnt lgkmcnt(3)
    v_mfma_f32_32x32x16_bf16 v[72:87], v[104:107], v[4:7], v[24:39]
    ds_read_b128 v[104:107], v23 offset:24576
    v_exp_f32 v56, v56
    v_exp_f32 v57, v57
    v_exp_f32 v58, v58
    v_mfma_f32_32x32x16_bf16 v[88:103], v[128:131], v[140:143], v[88:103]
    ds_read_b128 v[128:131], v23 offset:31744
    v_exp_f32 v59, v59
    v_exp_f32 v60, v60
    v_exp_f32 v61, v61
    s_waitcnt lgkmcnt(2)
    v_mfma_f32_32x32x16_bf16 v[72:87], v[108:111], v[8:11], v[72:87]
    ds_read_b128 v[108:111], v23 offset:25600
    v_exp_f32 v62, v62
    v_exp_f32 v63, v63
    v_cvt_pk_bf16_f32 v136, v56, v57
    v_cvt_pk_bf16_f32 v137, v58, v59
    v_mfma_f32_16x16x32_bf16 v[44:47], v[40:43], v[140:143], v[44:47]
    v_cvt_pk_bf16_f32 v138, v60, v61
    v_cvt_pk_bf16_f32 v139, v62, v63
    v_exp_f32 v64, v64
    v_exp_f32 v65, v65
    v_mfma_f32_32x32x16_bf16 v[88:103], v[120:123], v[136:139], v[88:103]
    ds_read_b128 v[120:123], v23 offset:30720
    v_exp_f32 v66, v66
    v_exp_f32 v67, v67
    v_exp_f32 v68, v68
    v_exp_f32 v69, v69
    v_mfma_f32_16x16x32_bf16 v[44:47], v[40:43], v[136:139], v[44:47]
    v_exp_f32 v70, v70
    v_exp_f32 v71, v71
    v_cvt_pk_bf16_f32 v140, v64, v65
    v_cvt_pk_bf16_f32 v141, v66, v67
    v_cvt_pk_bf16_f32 v142, v68, v69
    v_cvt_pk_bf16_f32 v143, v70, v71
a1_44_t1:
    v_exp_f32 v72, v72
    v_exp_f32 v73, v73
    v_exp_f32_e64 v74, v74
    v_mfma_f32_32x32x16_bf16 v[88:103], v[124:127], v[140:143], v[88:103]
    v_exp_f32 v75, v75
    v_exp_f32 v76, v76
    v_exp_f32 v77, v77
    v_exp_f32 v78, v78
    v_exp_f32_e64 v79, v79
    v_cvt_pk_bf16_f32 v136, v72, v73
    v_cvt_pk_bf16_f32 v137, v74, v75
    v_mfma_f32_16x16x32_bf16 v[44:47], v[40:43], v[140:143], v[44:47]
    v_cvt_pk_bf16_f32 v138, v76, v77
    v_cvt_pk_bf16_f32 v139, v78, v79
    v_exp_f32_e64 v80, v80
    v_exp_f32 v81, v81
    s_waitcnt lgkmcnt(0)
    v_mfma_f32_32x32x16_bf16 v[88:103], v[120:123], v[136:139], v[88:103]
    v_exp_f32 v82, v82
    v_exp_f32 v83, v83
    v_exp_f32 v84, v84
    v_exp_f32 v85, v85
    v_mfma_f32_16x16x32_bf16 v[44:47], v[40:43], v[136:139], v[44:47]
    v_exp_f32 v86, v86
    v_exp_f32 v87, v87
    v_cvt_pk_bf16_f32 v140, v80, v81
    v_cvt_pk_bf16_f32 v141, v82, v83
    v_cvt_pk_bf16_f32 v142, v84, v85
    v_cvt_pk_bf16_f32 v143, v86, v87
a1_44_e1:
    s_cmp_eq_u32 s75, 0
    s_nop 0
    v_mfma_f32_16x16x32_bf16 v[44:47], v[40:43], v[140:143], v[44:47]
    v_mfma_f32_32x32x16_bf16 v[88:103], v[128:131], v[140:143], v[88:103]
    s_cbranch_scc1 a1_44_mid
    s_branch a1_44_fin
    s_nop 0
a1_44_t0:
    v_exp_f32 v56, v56
    v_exp_f32 v57, v57
    v_exp_f32 v58, v58
    v_mfma_f32_32x32x16_bf16 v[88:103], v[128:131], v[140:143], v[88:103]
    v_exp_f32 v59, v59
    v_exp_f32 v60, v60
    v_exp_f32 v61, v61
    v_exp_f32 v62, v62
    v_exp_f32_e64 v63, v63
    v_cvt_pk_bf16_f32 v136, v56, v57
    v_cvt_pk_bf16_f32 v137, v58, v59
    v_mfma_f32_16x16x32_bf16 v[44:47], v[40:43], v[140:143], v[44:47]
    v_cvt_pk_bf16_f32 v138, v60, v61
    v_cvt_pk_bf16_f32 v139, v62, v63
    v_exp_f32_e64 v64, v64
    v_exp_f32 v65, v65
    s_waitcnt lgkmcnt(0)
    v_mfma_f32_32x32x16_bf16 v[88:103], v[120:123], v[136:139], v[88:103]
    v_exp_f32 v66, v66
    v_exp_f32 v67, v67
    v_exp_f32 v68, v68
    v_exp_f32 v69, v69
    v_mfma_f32_16x16x32_bf16 v[44:47], v[40:43], v[136:139], v[44:47]
    v_exp_f32 v70, v70
    v_exp_f32 v71, v71
    v_cvt_pk_bf16_f32 v140, v64, v65
    v_cvt_pk_bf16_f32 v141, v66, v67
    v_cvt_pk_bf16_f32 v142, v68, v69
    v_cvt_pk_bf16_f32 v143, v70, v71
a1_44_e0:
    s_cmp_eq_u32 s75, 0
    s_nop 0
    v_mfma_f32_16x16x32_bf16 v[44:47], v[40:43], v[140:143], v[44:47]
    v_mfma_f32_32x32x16_bf16 v[88:103], v[124:127], v[140:143], v[88:103]
    s_cbranch_scc1 a1_44_mid
    s_branch a1_44_fin
    s_nop 0
a1_44_none:
    s_cmp_lg_u32 s26, 0
    s_cbranch_scc1 sk_64
    s_xor_b32 s96, s29, 0
    s_and_b32 s97, s96, 2
    s_and_b32 s96, s96, 3
    s_mul_i32 s97, s97, 14336
    s_mul_i32 s96, s96, 14336
    s_add_u32 s96, s96, s97
    buffer_load_dwordx4 v[188:191], v155, s[4:7], s96 offen
    s_xor_b32 s96, s29, 0
    s_and_b32 s97, s96, 2
    s_and_b32 s96, s96, 3
    s_mul_i32 s97, s97, 14336
    s_mul_i32 s96, s96, 14336
    s_add_u32 s96, s96, s97
    s_add_u32 s96, s96, 7168
    buffer_load_dwordx4 v[192:195], v155, s[4:7], s96 offen
sk_64:
    s_cmp_lg_u32 s26, 0
    s_cbranch_scc1 sk_65
    s_xor_b32 s96, s29, 1
    s_and_b32 s97, s96, 2
    s_and_b32 s96, s96, 3
    s_mul_i32 s97, s97, 14336
    s_mul_i32 s96, s96, 14336
    s_add_u32 s96, s96, s97
    buffer_load_dwordx4 v[196:199], v155, s[4:7], s96 offen
    s_xor_b32 s96, s29, 1
    s_and_b32 s97, s96, 2
    s_and_b32 s96, s96, 3
    s_mul_i32 s97, s97, 14336
    s_mul_i32 s96, s96, 14336
    s_add_u32 s96, s96, s97
    s_add_u32 s96, s96, 7168
    buffer_load_dwordx4 v[200:203], v155, s[4:7], s96 offen
sk_65:
    s_cmp_lg_u32 s26, 0
    s_cbranch_scc1 sk_66
    s_xor_b32 s96, s29, 2
    s_and_b32 s97, s96, 2
    s_and_b32 s96, s96, 3
    s_mul_i32 s97, s97, 14336
    s_mul_i32 s96, s96, 14336
    s_add_u32 s96, s96, s97
    buffer_load_dwordx4 v[204:207], v155, s[4:7], s96 offen
sk_66:
    s_cmp_lg_u32 s26, 0
    s_cbranch_scc1 sk_67
    s_xor_b32 s96, s29, 2
    s_and_b32 s97, s96, 2
    s_and_b32 s96, s96, 3
    s_mul_i32 s97, s97, 14336
    s_mul_i32 s96, s96, 14336
    s_add_u32 s96, s96, s97
    s_add_u32 s96, s96, 7168
    buffer_load_dwordx4 v[208:211], v155, s[4:7], s96 offen
sk_67:
    s_cmp_lg_u32 s26, 0
    s_cbranch_scc1 sk_68
    s_xor_b32 s96, s29, 3
    s_and_b32 s97, s96, 2
    s_and_b32 s96, s96, 3
    s_mul_i32 s97, s97, 14336
    s_mul_i32 s96, s96, 14336
    s_add_u32 s96, s96, s97
    buffer_load_dwordx4 v[212:215], v155, s[4:7], s96 offen
sk_68:
    s_barrier
    s_cmp_lg_u32 s26, 0
    s_cbranch_scc1 sk_69
    s_xor_b32 s96, s29, 3
    s_and_b32 s97, s96, 2
    s_and_b32 s96, s96, 3
    s_mul_i32 s97, s97, 14336
    s_mul_i32 s96, s96, 14336
    s_add_u32 s96, s96, s97
    s_add_u32 s96, s96, 7168
    buffer_load_dwordx4 v[216:219], v155, s[4:7], s96 offen
sk_69:
a1_44_fin:
    s_lshl_b32 s36, s76, 16
    s_add_u32 s36, s36, 0x808000
    s_lshl_b32 s33, s25, 11
    s_add_u32 s33, s33, s36
    s_lshl_b32 s30, s24, 9
    s_and_b32 s31, s76, 3
    s_lshl_b32 s31, s31, 6
    s_add_u32 s30, s30, s31
    s_add_u32 s30, s30, s26
    s_add_u32 s30, s30, 0xdd2100
    s_lshl_b32 s31, s25, 2
    s_add_u32 s31, s31, s30
    v_cmp_ngt_f32 vcc, 0x5d800000, v44
    v_rcp_f32_e64 v22, v44
    s_cbranch_vccnz att_exact1
att_ret1:
    s_nop 3
    v_pk_mul_f32 v[88:89], v[88:89], v[22:23] op_sel_hi:[1,0]
    v_pk_mul_f32 v[90:91], v[90:91], v[22:23] op_sel_hi:[1,0]
    v_pk_mul_f32 v[92:93], v[92:93], v[22:23] op_sel_hi:[1,0]
    v_pk_mul_f32 v[94:95], v[94:95], v[22:23] op_sel_hi:[1,0]
    v_pk_mul_f32 v[96:97], v[96:97], v[22:23] op_sel_hi:[1,0]
    v_pk_mul_f32 v[98:99], v[98:99], v[22:23] op_sel_hi:[1,0]
    v_pk_mul_f32 v[100:101], v[100:101], v[22:23] op_sel_hi:[1,0]
    v_pk_mul_f32 v[102:103], v[102:103], v[22:23] op_sel_hi:[1,0]
    v_cvt_pk_bf16_f32 v88, v88, v89
    v_cvt_pk_bf16_f32 v89, v90, v91
    v_cvt_pk_bf16_f32 v90, v92, v93
    v_cvt_pk_bf16_f32 v91, v94, v95
    v_cvt_pk_bf16_f32 v92, v96, v97
    v_cvt_pk_bf16_f32 v93, v98, v99
    v_cvt_pk_bf16_f32 v94, v100, v101
    v_cvt_pk_bf16_f32 v95, v102, v103
    s_cmp_lg_u32 s77, 0
    s_cbranch_scc1 lc_70
    buffer_store_dwordx4 v[88:91], v253, s[20:23], s33 offen sc1
    buffer_store_dwordx4 v[92:95], v253, s[20:23], s33 offen offset:1024 sc1
    s_branch lc_71
    s_nop 0
lc_70:
    buffer_store_dwordx4 v[88:91], v253, s[20:23], s33 offen
    buffer_store_dwordx4 v[92:95], v253, s[20:23], s33 offen offset:1024
lc_71:
    v_mov_b32_e64 v154, s88
    s_mov_b64 exec, 1
    s_waitcnt vmcnt(0)
    s_cmp_lg_u32 s77, 0
    s_cbranch_scc1 lc_72
    buffer_store_dword v154, v253, s[20:23], s31 offen sc1
    s_branch lc_73
    s_nop 0
lc_72:
    buffer_store_dword v154, v253, s[20:23], s31 offen
lc_73:
    s_mov_b64 exec, -1
    s_cmp_lg_u32 s26, 0
    s_cbranch_scc1 sk_74
    s_mov_b32 s96, 0
    buffer_load_dwordx4 v[220:223], v153, s[12:15], s96 offen
    s_mov_b32 s96, 2048
    buffer_load_dwordx4 v[224:227], v153, s[12:15], s96 offen
    s_mov_b32 s96, 4096
    buffer_load_dwordx4 v[228:231], v153, s[12:15], s96 offen
    s_mov_b32 s96, 6144
    buffer_load_dwordx4 v[232:235], v153, s[12:15], s96 offen
    s_mov_b32 s96, 8192
    buffer_load_dwordx4 v[236:239], v153, s[12:15], s96 offen
    s_mov_b32 s96, 10240
    buffer_load_dwordx4 v[240:243], v153, s[12:15], s96 offen
    s_mov_b32 s96, 12288
    buffer_load_dwordx4 v[244:247], v153, s[12:15], s96 offen
    s_mov_b32 s96, 14336
    buffer_load_dwordx4 v[248:251], v153, s[12:15], s96 offen
sk_74:
    v_bfe_u32 v20, v252, 3, 2
    v_lshrrev_b32_e64 v21, 5, v252
    v_lshl_add_u32 v20, v21, 3, v20
    s_lshr_b32 s32, s28, 1
    s_lshl_b32 s32, s32, 4
    s_and_b32 s33, s28, 1
    s_lshl_b32 s33, s33, 2
    s_add_u32 s32, s32, s33
    v_add_u32 v20, s32, v20
    v_lshlrev_b32 v20, 11, v20
    v_lshrrev_b32 v21, 2, v252
    v_and_b32 v21, 4, v21
    v_xor_b32 v21, v21, v252
    v_and_b32 v21, 7, v21
    v_lshl_add_u32 v20, v21, 4, v20
    s_lshl_b32 s32, s98, 7
    v_add_u32 v14, s32, v20
    s_lshl_b32 s32, s28, 9
    s_sub_u32 s34, s29, 224
    s_lshl_b32 s34, s34, 2
    s_mul_i32 s35, s28, 2
    s_and_b32 s33, s35, 3
    s_add_u32 s34, s34, s33
    s_cmp_lt_u32 s35, 4
    s_cselect_b32 s89, s34, -1
    v_and_b32 v23, 1, v252
    v_add_u32 v23, s34, v23
    v_lshrrev_b32_e64 v22, 5, v252
    v_and_or_b32 v23, v23, -2, v22
    v_lshrrev_b32_e64 v22, 1, v252
    s_cmp_lt_u32 s29, 224
    s_cselect_b32 s32, s32, 0
    s_cselect_b64 vcc, -1, 0
    v_cndmask_b32_e64 v22, v23, v22, vcc
    v_lshl_add_u32 v22, v22, 4, s32
    s_mov_b32 s79, s26
    s_cmp_lg_u32 s26, 0
    s_cbranch_scc1 sk_75
    s_waitcnt vmcnt(0)
    s_getpc_b64 s[32:33]
pc_76:
    s_sub_u32 s32, s32, pc_76-interleave_layers__sliding_block__moe_arch_mod__prompt_kernel
    s_subb_u32 s33, s33, 0
    s_lshr_b32 s34, s2, 3
    s_lshl_b32 s34, s34, 2
    s_add_u32 s34, s34, s28
    s_and_b32 s34, s34, 127
    s_lshl_b32 s34, s34, 7
    v_lshl_add_u32 v19, v252, 14, s34
    s_mov_b32 s34, k_exit-interleave_layers__sliding_block__moe_arch_mod__prompt_kernel
    s_mov_b32 s35, 0x20000
    buffer_load_dword v19, v19, s[32:35], 0 offen
    s_lshr_b32 s30, s16, 7
    s_sub_u32 s30, 3, s30
    s_and_b32 s30, s30, 7
    s_and_b32 s31, s24, 1
    s_lshl_b32 s31, s31, 3
    s_add_u32 s30, s30, s31
    s_and_b32 s31, s24, 14
    s_add_u32 s35, s31, s30
    s_lshl_b32 s31, s25, 2
    s_add_u32 s31, s31, s28
    s_mul_i32 s31, s31, 6144
    s_lshl_b32 s30, s30, 7
    s_add_u32 s30, s30, s31
    v_min_u32_e64 v18, 2, v252
    v_lshl_add_u32 v18, v18, 11, s30
    s_add_u32 s30, s35, 14
    s_and_b32 s30, s30, 15
    s_mul_i32 s30, s30, 393216
    buffer_load_dword v19, v18, s[16:19], s30 offen
    s_add_u32 s30, s35, 15
    s_and_b32 s30, s30, 15
    s_mul_i32 s30, s30, 393216
    buffer_load_dword v19, v18, s[16:19], s30 offen
    s_add_u32 s30, s35, 0
    s_and_b32 s30, s30, 15
    s_mul_i32 s30, s30, 393216
    buffer_load_dword v19, v18, s[16:19], s30 offen
    s_add_u32 s30, s35, 1
    s_and_b32 s30, s30, 15
    s_mul_i32 s30, s30, 393216
    buffer_load_dword v19, v18, s[16:19], s30 offen
    s_add_u32 s30, s35, 2
    s_and_b32 s30, s30, 15
    s_mul_i32 s30, s30, 393216
    buffer_load_dword v19, v18, s[16:19], s30 offen
    s_add_u32 s30, s35, 3
    s_and_b32 s30, s30, 15
    s_mul_i32 s30, s30, 393216
    buffer_load_dword v19, v18, s[16:19], s30 offen
    s_mov_b32 s30, 0x05040100
    s_mov_b32 s31, 0x07060302
    v_perm_b32 v155, v160, v156, s30
    v_perm_b32 v160, v160, v156, s31
    v_perm_b32 v156, v161, v157, s30
    v_perm_b32 v161, v161, v157, s31
    v_perm_b32 v157, v162, v158, s30
    v_perm_b32 v162, v162, v158, s31
    v_perm_b32 v158, v163, v159, s30
    v_perm_b32 v163, v163, v159, s31
    v_perm_b32 v159, v168, v164, s30
    v_perm_b32 v168, v168, v164, s31
    v_perm_b32 v164, v169, v165, s30
    v_perm_b32 v169, v169, v165, s31
    v_perm_b32 v165, v170, v166, s30
    v_perm_b32 v170, v170, v166, s31
    v_perm_b32 v166, v171, v167, s30
    v_perm_b32 v171, v171, v167, s31
    v_perm_b32 v167, v176, v172, s30
    v_perm_b32 v176, v176, v172, s31
    v_perm_b32 v172, v177, v173, s30
    v_perm_b32 v177, v177, v173, s31
    v_perm_b32 v173, v178, v174, s30
    v_perm_b32 v178, v178, v174, s31
    v_perm_b32 v174, v179, v175, s30
    v_perm_b32 v179, v179, v175, s31
    v_perm_b32 v175, v184, v180, s30
    v_perm_b32 v184, v184, v180, s31
    v_perm_b32 v180, v185, v181, s30
    v_perm_b32 v185, v185, v181, s31
    v_perm_b32 v181, v186, v182, s30
    v_perm_b32 v186, v186, v182, s31
    v_perm_b32 v182, v187, v183, s30
    v_perm_b32 v187, v187, v183, s31
    v_perm_b32 v183, v192, v188, s30
    v_perm_b32 v192, v192, v188, s31
    v_perm_b32 v188, v193, v189, s30
    v_perm_b32 v193, v193, v189, s31
    v_perm_b32 v189, v194, v190, s30
    v_perm_b32 v194, v194, v190, s31
    v_perm_b32 v190, v195, v191, s30
    v_perm_b32 v195, v195, v191, s31
    v_perm_b32 v191, v200, v196, s30
    v_perm_b32 v200, v200, v196, s31
    v_perm_b32 v196, v201, v197, s30
    v_perm_b32 v201, v201, v197, s31
    v_perm_b32 v197, v202, v198, s30
    v_perm_b32 v202, v202, v198, s31
    v_perm_b32 v198, v203, v199, s30
    v_perm_b32 v203, v203, v199, s31
    v_perm_b32 v199, v208, v204, s30
    v_perm_b32 v208, v208, v204, s31
    v_perm_b32 v204, v209, v205, s30
    v_perm_b32 v209, v209, v205, s31
    v_perm_b32 v205, v210, v206, s30
    v_perm_b32 v210, v210, v206, s31
    v_perm_b32 v206, v211, v207, s30
    v_perm_b32 v211, v211, v207, s31
    v_perm_b32 v207, v216, v212, s30
    v_perm_b32 v216, v216, v212, s31
    v_perm_b32 v212, v217, v213, s30
    v_perm_b32 v217, v217, v213, s31
    v_perm_b32 v213, v218, v214, s30
    v_perm_b32 v218, v218, v214, s31
    v_perm_b32 v214, v219, v215, s30
    v_perm_b32 v219, v219, v215, s31
    v_perm_b32 v215, v224, v220, s30
    v_perm_b32 v224, v224, v220, s31
    v_perm_b32 v220, v225, v221, s30
    v_perm_b32 v225, v225, v221, s31
    v_perm_b32 v221, v226, v222, s30
    v_perm_b32 v226, v226, v222, s31
    v_perm_b32 v222, v227, v223, s30
    v_perm_b32 v227, v227, v223, s31
    v_perm_b32 v223, v232, v228, s30
    v_perm_b32 v232, v232, v228, s31
    v_perm_b32 v228, v233, v229, s30
    v_perm_b32 v233, v233, v229, s31
    v_perm_b32 v229, v234, v230, s30
    v_perm_b32 v234, v234, v230, s31
    v_perm_b32 v230, v235, v231, s30
    v_perm_b32 v235, v235, v231, s31
    v_perm_b32 v231, v240, v236, s30
    v_perm_b32 v240, v240, v236, s31
    v_perm_b32 v236, v241, v237, s30
    v_perm_b32 v241, v241, v237, s31
    v_perm_b32 v237, v242, v238, s30
    v_perm_b32 v242, v242, v238, s31
    v_perm_b32 v238, v243, v239, s30
    v_perm_b32 v243, v243, v239, s31
    v_perm_b32 v239, v248, v244, s30
    v_perm_b32 v248, v248, v244, s31
    v_perm_b32 v244, v249, v245, s30
    v_perm_b32 v249, v249, v245, s31
    v_perm_b32 v245, v250, v246, s30
    v_perm_b32 v250, v250, v246, s31
    v_perm_b32 v246, v251, v247, s30
    v_perm_b32 v251, v251, v247, s31
    v_lshrrev_b32_e64 v21, 3, v252
    s_lshl_b32 s84, s24, 18
    s_add_u32 s84, s84, s86
    s_add_u32 s84, s84, 0x2000000
    v_mul_u32_u24 v20, 6144, v21
    v_and_b32 v21, 6, v21
    v_xor_b32 v21, v21, v252
    v_and_b32 v21, 7, v21
    v_lshl_add_u32 v20, v21, 4, v20
    s_mul_i32 s32, s28, 3
    s_bfe_u32 s33, s32, 0x10001
    s_mul_i32 s33, s33, 196608
    s_and_b32 s34, s32, 1
    s_mul_i32 s34, s34, 49152
    s_add_u32 s33, s33, s34
    s_lshr_b32 s34, s32, 2
    s_lshl_b32 s34, s34, 11
    s_add_u32 s33, s33, s34
    v_add_u32 v8, s33, v20
    v_add_u32 v9, 97280, v8
    s_add_u32 s32, s32, 1
    s_bfe_u32 s33, s32, 0x10001
    s_mul_i32 s33, s33, 196608
    s_and_b32 s34, s32, 1
    s_mul_i32 s34, s34, 49152
    s_add_u32 s33, s33, s34
    s_lshr_b32 s34, s32, 2
    s_lshl_b32 s34, s34, 11
    s_add_u32 s33, s33, s34
    s_sub_u32 s33, s33, 2048
    v_add_u32 v10, s33, v20
    v_add_u32 v11, 97280, v10
    s_add_u32 s32, s32, 1
    s_bfe_u32 s33, s32, 0x10001
    s_mul_i32 s33, s33, 196608
    s_and_b32 s34, s32, 1
    s_mul_i32 s34, s34, 49152
    s_add_u32 s33, s33, s34
    s_lshr_b32 s34, s32, 2
    s_lshl_b32 s34, s34, 11
    s_add_u32 s33, s33, s34
    v_add_u32 v12, s33, v20
    v_add_u32 v13, 97280, v12
    s_sub_u32 s30, s95, 1
    s_sub_u32 s95, s94, 3
    s_mov_b32 s94, s30
    v_bfe_u32 v116, v252, 4, 1
    v_lshlrev_b32 v116, 11, v116
    v_lshrrev_b32_e64 v117, 5, v252
    v_lshl_add_u32 v116, v117, 8, v116
    v_and_b32 v117, 15, v252
    v_lshl_add_u32 v116, v117, 4, v116
    s_lshl_b32 s34, s28, 12
    s_add_u32 s34, s34, 147456
    v_add_u32 v117, s34, v116
    v_and_b32 v16, 15, v252
    v_lshlrev_b32 v16, 9, v16
    s_load_dwordx2 s[12:13], s[0:1], 64
    s_mov_b32 s14, 0x400000
    s_mov_b32 s15, 0x20000
    s_waitcnt lgkmcnt(0)
sk_75:
    s_barrier
    s_add_u32 s96, s25, 12
    s_and_b32 s96, s96, 15
    s_lshl_b32 s96, s96, 17
    s_add_u32 s96, s96, 65536
    s_add_u32 m0, s101, 114688
    s_nop 0
    buffer_load_dwordx4 v14, s[8:11], s96 offen lds
    s_add_u32 s96, s25, 13
    s_and_b32 s96, s96, 15
    s_lshl_b32 s96, s96, 17
    s_add_u32 s96, s96, 65536
    s_add_u32 m0, s101, 118784
    s_nop 0
    buffer_load_dwordx4 v14, s[8:11], s96 offen lds
    s_add_u32 s96, s25, 14
    s_and_b32 s96, s96, 15
    s_lshl_b32 s96, s96, 17
    s_add_u32 s96, s96, 65536
    s_add_u32 m0, s101, 122880
    s_nop 0
    buffer_load_dwordx4 v14, s[8:11], s96 offen lds
    s_add_u32 s96, s25, 15
    s_and_b32 s96, s96, 15
    s_lshl_b32 s96, s96, 17
    s_add_u32 s96, s96, 65536
    s_add_u32 m0, s101, 126976
    s_nop 0
    buffer_load_dwordx4 v14, s[8:11], s96 offen lds
    s_waitcnt vmcnt(0)
    s_barrier
    s_cmp_lg_u32 s26, 0
    s_cbranch_scc1 l_tail
    s_mov_b32 s26, 16777216
    s_mov_b32 s36, 0
    s_add_u32 s96, s94, 0
    s_and_b32 s96, s96, 15
    s_mul_i32 s96, s96, 393216
    s_add_u32 s96, s96, s85
    s_add_u32 m0, s87, 40960
    s_nop 0
    buffer_load_dwordx4 v8, s[16:19], s96 offen offset:0 lds
    buffer_load_dwordx4 v9, s[16:19], s96 offen offset:1024 lds
    buffer_load_dwordx4 v10, s[16:19], s96 offen offset:2048 lds
    buffer_load_dwordx4 v11, s[16:19], s96 offen offset:3072 lds
    s_add_u32 m0, s87, 45056
    s_nop 0
    buffer_load_dwordx4 v12, s[16:19], s96 offen offset:0 lds
    buffer_load_dwordx4 v13, s[16:19], s96 offen offset:1024 lds
    s_add_u32 s96, s95, 1
    s_and_b32 s96, s96, 15
    s_mul_i32 s96, s96, 393216
    s_add_u32 s96, s96, s85
    s_add_u32 m0, s87, 65536
    s_nop 0
    buffer_load_dwordx4 v8, s[16:19], s96 offen offset:0 lds
    buffer_load_dwordx4 v9, s[16:19], s96 offen offset:1024 lds
    buffer_load_dwordx4 v10, s[16:19], s96 offen offset:2048 lds
    buffer_load_dwordx4 v11, s[16:19], s96 offen offset:3072 lds
    s_add_u32 m0, s87, 69632
    s_nop 0
    buffer_load_dwordx4 v12, s[16:19], s96 offen offset:0 lds
    buffer_load_dwordx4 v13, s[16:19], s96 offen offset:1024 lds
    s_add_u32 s96, s95, 1
    s_and_b32 s96, s96, 15
    s_lshl_b32 s37, 1, s96
    s_lshl_b32 s38, 1, s98
    s_or_b32 s38, s38, s37
    s_lshl_b32 s30, s99, 13
    s_add_u32 s30, s30, 0xc00000
    s_mov_b32 s78, s27
pl_77:
    buffer_load_dword v17, v16, s[20:23], s30 offen sc1
    s_waitcnt vmcnt(0)
pc_78:
    v_cmp_ne_u32 vcc, -1, v17
    s_and_b32 s36, vcc_lo, s38
    s_cselect_b64 vcc, 0, -1
    s_cbranch_vccz pd_79
    s_sub_u32 s78, s78, 1
    s_cmp_lg_u32 s78, 0
    s_cbranch_scc1 pl_77
    s_mov_b32 s27, 1
pd_79:
    s_and_b32 s36, s36, s37
    s_cmp_eq_u32 s36, 0
    s_cbranch_scc1 sk_80
    s_add_u32 s96, s95, 1
    s_and_b32 s96, s96, 15
    s_lshl_b32 s97, s96, 14
    s_add_u32 s97, s97, s84
    s_add_u32 m0, s86, 131072
    s_nop 0
    buffer_load_dwordx4 v253, s[20:23], s97 offen offset:0 sc1 lds
    buffer_load_dwordx4 v253, s[20:23], s97 offen offset:1024 sc1 lds
    buffer_load_dwordx4 v253, s[20:23], s97 offen offset:2048 sc1 lds
    buffer_load_dwordx4 v253, s[20:23], s97 offen offset:3072 sc1 lds
sk_80:
    s_barrier
    s_lshl_b32 s30, s99, 13
    s_add_u32 s30, s30, 0xc00000
    s_add_u32 s31, s30, 4096
    buffer_load_dwordx4 v[64:67], v253, s[20:23], s30 offen offset:0 sc1
    buffer_load_dwordx4 v[68:71], v253, s[20:23], s30 offen offset:1024 sc1
    buffer_load_dwordx4 v[72:75], v253, s[20:23], s30 offen offset:2048 sc1
    buffer_load_dwordx4 v[76:79], v253, s[20:23], s30 offen offset:3072 sc1
    buffer_load_dwordx4 v[80:83], v253, s[20:23], s31 offen offset:0 sc1
    buffer_load_dwordx4 v[84:87], v253, s[20:23], s31 offen offset:1024 sc1
    buffer_load_dwordx4 v[88:91], v253, s[20:23], s31 offen offset:2048 sc1
    buffer_load_dwordx4 v[92:95], v253, s[20:23], s31 offen offset:3072 sc1
    s_add_u32 s96, s94, 2
    s_and_b32 s96, s96, 15
    s_mul_i32 s96, s96, 393216
    s_add_u32 s96, s96, s85
    s_add_u32 m0, s87, 90112
    s_nop 0
    buffer_load_dwordx4 v8, s[16:19], s96 offen offset:0 lds
    buffer_load_dwordx4 v9, s[16:19], s96 offen offset:1024 lds
    buffer_load_dwordx4 v10, s[16:19], s96 offen offset:2048 lds
    buffer_load_dwordx4 v11, s[16:19], s96 offen offset:3072 lds
    s_add_u32 m0, s87, 94208
    s_nop 0
    buffer_load_dwordx4 v12, s[16:19], s96 offen offset:0 lds
    buffer_load_dwordx4 v13, s[16:19], s96 offen offset:1024 lds
    ds_read_b128 v[32:35], v117 offset:0
    ds_read_b128 v[36:39], v117 offset:512
    ds_read_b128 v[40:43], v117 offset:1024
    ds_read_b128 v[44:47], v117 offset:1536
    s_mov_b32 s78, s27
    s_waitcnt vmcnt(6)
    s_branch pc_82
    s_nop 0
pl_81:
    s_lshl_b32 s30, s99, 13
    s_add_u32 s30, s30, 0xc00000
    s_add_u32 s31, s30, 4096
    buffer_load_dwordx4 v[64:67], v253, s[20:23], s30 offen offset:0 sc1
    buffer_load_dwordx4 v[68:71], v253, s[20:23], s30 offen offset:1024 sc1
    buffer_load_dwordx4 v[72:75], v253, s[20:23], s30 offen offset:2048 sc1
    buffer_load_dwordx4 v[76:79], v253, s[20:23], s30 offen offset:3072 sc1
    buffer_load_dwordx4 v[80:83], v253, s[20:23], s31 offen offset:0 sc1
    buffer_load_dwordx4 v[84:87], v253, s[20:23], s31 offen offset:1024 sc1
    buffer_load_dwordx4 v[88:91], v253, s[20:23], s31 offen offset:2048 sc1
    buffer_load_dwordx4 v[92:95], v253, s[20:23], s31 offen offset:3072 sc1
    s_waitcnt vmcnt(0)
pc_82:
    v_max3_u32 v48, v64, v68, v72
    v_max3_u32 v48, v48, v76, v80
    v_max3_u32 v48, v48, v84, v88
    v_max_u32 v48, v48, v92
    v_cmp_eq_u32_e64 vcc, -1, v48
    s_cbranch_vccz pd_83
    s_sub_u32 s78, s78, 1
    s_cmp_lg_u32 s78, 0
    s_cbranch_scc1 pl_81
    s_mov_b32 s27, 1
pd_83:
    s_cmp_lg_u32 s36, 0
    s_cbranch_scc1 sk_84
    s_add_u32 s96, s95, 1
    s_and_b32 s96, s96, 15
    s_lshl_b32 s97, s96, 14
    s_add_u32 s97, s97, s84
    s_add_u32 m0, s86, 131072
    s_nop 0
    buffer_load_dwordx4 v253, s[20:23], s97 offen offset:0 sc1 lds
    buffer_load_dwordx4 v253, s[20:23], s97 offen offset:1024 sc1 lds
    buffer_load_dwordx4 v253, s[20:23], s97 offen offset:2048 sc1 lds
    buffer_load_dwordx4 v253, s[20:23], s97 offen offset:3072 sc1 lds
sk_84:
    s_add_u32 s96, s94, 2
    s_and_b32 s96, s96, 15
    s_lshl_b32 s97, s96, 14
    s_add_u32 s97, s97, s84
    s_add_u32 m0, s86, 114688
    s_nop 0
    buffer_load_dwordx4 v253, s[20:23], s97 offen offset:0 sc1 lds
    v_add_f32 v64, v64, v68
    v_add_f32 v65, v65, v69
    v_add_f32 v66, v66, v70
    v_add_f32 v67, v67, v71
    v_add_f32 v64, v64, v72
    v_add_f32 v65, v65, v73
    v_add_f32 v66, v66, v74
    v_add_f32 v67, v67, v75
    v_add_f32 v64, v64, v76
    v_add_f32 v65, v65, v77
    v_add_f32 v66, v66, v78
    v_add_f32 v67, v67, v79
    v_add_f32 v64, v64, v80
    v_add_f32 v65, v65, v81
    v_add_f32 v66, v66, v82
    v_add_f32 v67, v67, v83
    v_add_f32 v64, v64, v84
    v_add_f32 v65, v65, v85
    v_add_f32 v66, v66, v86
    v_add_f32 v67, v67, v87
    v_add_f32 v64, v64, v88
    v_add_f32 v65, v65, v89
    v_add_f32 v66, v66, v90
    v_add_f32_e64 v67, v67, v91
    buffer_load_dwordx4 v253, s[20:23], s97 offen offset:1024 sc1 lds
    v_add_f32 v64, v64, v92
    v_add_f32 v65, v65, v93
    v_add_f32 v66, v66, v94
    v_add_f32 v67, v67, v95
    v_mov_b32 v48, v64
    v_mov_b32 v49, v65
    v_mov_b32 v50, v66
    v_mov_b32 v51, v67
    v_permlane32_swap_b32 v64, v48
    v_permlane32_swap_b32 v65, v49
    v_permlane32_swap_b32 v66, v50
    v_permlane32_swap_b32 v67, v51
    v_add_f32 v64, v64, v48
    v_add_f32 v65, v65, v49
    v_add_f32 v66, v66, v50
    v_add_f32 v67, v67, v51
    v_mul_f32 v54, 0x3a800000, v64
    v_mul_f32 v65, 0x3a800000, v65
    v_fma_f32 v65, -v54, v54, v65
    v_max_f32_e64 v65, 0, v65
    v_add_f32 v55, 0x3727c5ac, v65
    v_rsq_f32 v55, v55
    s_waitcnt lgkmcnt(0)
    v_fma_f32 v52, -v54, v67, v66
    buffer_load_dwordx4 v253, s[20:23], s97 offen offset:2048 sc1 lds
    v_and_b32 v53, 31, v252
    v_mul_f32 v52, v52, v55
    s_lshl_b32 s32, s99, 5
    v_add_u32 v53, s32, v53
    v_mov_b32 v48, v52
    s_nop 1
    v_max_f32_dpp v48, v48, v48 quad_perm:[1,0,3,2] row_mask:0xf bank_mask:0xf
    s_nop 1
    v_max_f32_dpp v48, v48, v48 quad_perm:[2,3,0,1] row_mask:0xf bank_mask:0xf
    s_nop 1
    v_max_f32_dpp v48, v48, v48 row_half_mirror row_mask:0xf bank_mask:0xf
    s_nop 1
    v_max_f32_dpp v48, v48, v48 row_mirror row_mask:0xf bank_mask:0xf
    v_mov_b32 v49, v48
    s_nop 1
    v_permlane16_swap_b32 v48, v49
    v_max_f32 v48, v48, v49
    v_cmp_eq_f32 vcc, v48, v52
    v_lshrrev_b32 v50, 5, v252
    v_lshlrev_b32 v50, 4, v50
    v_add_lshl_u32 v51, v50, s25, 27
    s_lshl_b32 s32, s99, 11
    s_lshl_b32 s33, s98, 7
    s_add_u32 s32, s32, s33
    s_add_u32 s32, s32, 0xd60000
    s_lshl_b32 s34, s99, 4
    s_add_u32 s34, s34, 0xdc0000
    s_ff1_i32_b32 s35, vcc_lo
    s_lshl_b32 s35, 1, s35
    buffer_load_dwordx4 v253, s[20:23], s97 offen offset:3072 sc1 lds
    s_mov_b32 exec_lo, s35
    s_mov_b32 exec_hi, s35
    buffer_store_dwordx4 v[52:55], v51, s[20:23], s34 offen sc1
    buffer_store_dwordx4 v[32:35], v50, s[20:23], s32 offen offset:0 sc1
    buffer_store_dwordx4 v[36:39], v50, s[20:23], s32 offen offset:32 sc1
    buffer_store_dwordx4 v[40:43], v50, s[20:23], s32 offen offset:64 sc1
    buffer_store_dwordx4 v[44:47], v50, s[20:23], s32 offen offset:96 sc1
    s_mov_b64 exec, -1
    s_waitcnt vmcnt(9) lgkmcnt(0)
    s_barrier
    s_add_u32 s96, s95, 3
    s_and_b32 s96, s96, 15
    s_lshl_b32 s97, s96, 14
    s_add_u32 s97, s97, s84
    s_add_u32 m0, s86, 147456
    s_nop 0
    buffer_load_dwordx4 v253, s[20:23], s97 offen offset:0 sc1 lds
    buffer_load_dwordx4 v253, s[20:23], s97 offen offset:1024 sc1 lds
    buffer_load_dwordx4 v253, s[20:23], s97 offen offset:2048 sc1 lds
    buffer_load_dwordx4 v253, s[20:23], s97 offen offset:3072 sc1 lds
    s_add_u32 s96, s95, 3
    s_and_b32 s96, s96, 15
    s_mul_i32 s96, s96, 393216
    s_add_u32 s96, s96, s85
    s_add_u32 m0, s87, 40960
    s_nop 0
    buffer_load_dwordx4 v8, s[16:19], s96 offen offset:0 lds
    buffer_load_dwordx4 v9, s[16:19], s96 offen offset:1024 lds
    buffer_load_dwordx4 v10, s[16:19], s96 offen offset:2048 lds
    buffer_load_dwordx4 v11, s[16:19], s96 offen offset:3072 lds
    s_add_u32 m0, s87, 45056
    s_nop 0
    buffer_load_dwordx4 v12, s[16:19], s96 offen offset:0 lds
    buffer_load_dwordx4 v13, s[16:19], s96 offen offset:1024 lds
    s_waitcnt vmcnt(15) lgkmcnt(0)
    s_barrier
    s_add_u32 s96, s94, 4
    s_and_b32 s96, s96, 15
    s_lshl_b32 s97, s96, 14
    s_add_u32 s97, s97, s84
    s_add_u32 m0, s86, 131072
    s_nop 0
    buffer_load_dwordx4 v253, s[20:23], s97 offen offset:0 sc1 lds
    buffer_load_dwordx4 v253, s[20:23], s97 offen offset:1024 sc1 lds
    v_add_f32 v56, 1.0, v55
    v_mul_f32 v57, v54, v55
    v_mul_f32_e64 v58, v56, v56
    buffer_load_dwordx4 v253, s[20:23], s97 offen offset:2048 sc1 lds
    v_sub_f32 v57, 0, v57
    v_mul_f32 v58, v58, v65
    v_add_f32 v58, 0x3727c5ac, v58
    buffer_load_dwordx4 v253, s[20:23], s97 offen offset:3072 sc1 lds
    v_rsq_f32 v58, v58
    s_nop 0
    v_mul_f32 v58, v58, v56
    v_and_b32 v48, 31, v252
    s_add_u32 s96, s94, 4
    s_and_b32 s96, s96, 15
    s_mul_i32 s96, s96, 393216
    s_add_u32 s96, s96, s85
    s_add_u32 m0, s87, 65536
    s_nop 0
    buffer_load_dwordx4 v8, s[16:19], s96 offen offset:0 lds
    v_lshrrev_b32 v49, 5, v252
    v_cmp_eq_u32 vcc, 0, v49
    v_lshlrev_b32_e64 v49, 9, v49
    buffer_load_dwordx4 v9, s[16:19], s96 offen offset:1024 lds
    v_lshl_add_u32 v48, v48, 2, v49
    s_lshl_b32 s32, s28, 7
    v_add_u32 v48, s32, v48
    buffer_load_dwordx4 v10, s[16:19], s96 offen offset:2048 lds
    v_cndmask_b32 v49, v54, v58, vcc
    v_cndmask_b32 v50, v57, v56, vcc
    ds_write_b32 v48, v49 offset:0
    buffer_load_dwordx4 v11, s[16:19], s96 offen offset:3072 lds
    ds_write_b32 v48, v50 offset:2048
    v_and_b32 v48, 15, v252
    v_lshrrev_b32 v51, 4, v252
    s_add_u32 m0, s87, 69632
    s_nop 0
    buffer_load_dwordx4 v12, s[16:19], s96 offen offset:0 lds
    v_lshl_add_u32 v48, v48, 2, v51
    s_min_u32 s32, s28, 2
    s_lshl_b32 s32, s32, 8
    buffer_load_dwordx4 v13, s[16:19], s96 offen offset:1024 lds
    v_lshl_add_u32 v48, v48, 2, s32
    ds_write_b32 v48, v2 offset:1024
    s_waitcnt vmcnt(10) lgkmcnt(0)
    s_barrier
    s_add_u32 s96, s95, 5
    s_and_b32 s96, s96, 15
    s_lshl_b32 s97, s96, 14
    s_add_u32 s97, s97, s84
    s_add_u32 m0, s86, 114688
    s_nop 0
    buffer_load_dwordx4 v253, s[20:23], s97 offen offset:0 sc1 lds
    buffer_load_dwordx4 v253, s[20:23], s97 offen offset:1024 sc1 lds
    buffer_load_dwordx4 v253, s[20:23], s97 offen offset:2048 sc1 lds
    buffer_load_dwordx4 v253, s[20:23], s97 offen offset:3072 sc1 lds
    s_add_u32 s96, s95, 5
    s_and_b32 s96, s96, 15
    s_mul_i32 s96, s96, 393216
    s_add_u32 s96, s96, s85
    s_add_u32 m0, s87, 90112
    s_nop 0
    buffer_load_dwordx4 v8, s[16:19], s96 offen offset:0 lds
    buffer_load_dwordx4 v9, s[16:19], s96 offen offset:1024 lds
    buffer_load_dwordx4 v10, s[16:19], s96 offen offset:2048 lds
    buffer_load_dwordx4 v11, s[16:19], s96 offen offset:3072 lds
    s_add_u32 m0, s87, 94208
    s_nop 0
    buffer_load_dwordx4 v12, s[16:19], s96 offen offset:0 lds
    buffer_load_dwordx4 v13, s[16:19], s96 offen offset:1024 lds
    s_waitcnt vmcnt(10) lgkmcnt(0)
    s_barrier
    s_add_u32 s32, s79, 0xdc0000
    buffer_load_dwordx4 v[16:19], v253, s[20:23], s32 offen sc1
    s_add_u32 s96, s94, 6
    s_and_b32 s96, s96, 15
    s_lshl_b32 s97, s96, 14
    s_add_u32 s97, s97, s84
    s_add_u32 m0, s86, 147456
    s_nop 0
    buffer_load_dwordx4 v253, s[20:23], s97 offen offset:0 sc1 lds
    buffer_load_dwordx4 v253, s[20:23], s97 offen offset:1024 sc1 lds
    buffer_load_dwordx4 v253, s[20:23], s97 offen offset:2048 sc1 lds
    buffer_load_dwordx4 v253, s[20:23], s97 offen offset:3072 sc1 lds
    s_add_u32 s96, s94, 6
    s_and_b32 s96, s96, 15
    s_mul_i32 s96, s96, 393216
    s_add_u32 s96, s96, s85
    s_add_u32 m0, s87, 40960
    s_nop 0
    buffer_load_dwordx4 v8, s[16:19], s96 offen offset:0 lds
    buffer_load_dwordx4 v9, s[16:19], s96 offen offset:1024 lds
    buffer_load_dwordx4 v10, s[16:19], s96 offen offset:2048 lds
    buffer_load_dwordx4 v11, s[16:19], s96 offen offset:3072 lds
    s_add_u32 m0, s87, 45056
    s_nop 0
    buffer_load_dwordx4 v12, s[16:19], s96 offen offset:0 lds
    buffer_load_dwordx4 v13, s[16:19], s96 offen offset:1024 lds
    s_waitcnt vmcnt(11) lgkmcnt(0)
    s_barrier
    s_add_u32 s96, s95, 7
    s_and_b32 s96, s96, 15
    s_lshl_b32 s97, s96, 14
    s_add_u32 s97, s97, s84
    s_add_u32 m0, s86, 131072
    s_nop 0
    buffer_load_dwordx4 v253, s[20:23], s97 offen offset:0 sc1 lds
    buffer_load_dwordx4 v253, s[20:23], s97 offen offset:1024 sc1 lds
    s_mov_b32 s78, s27
    s_waitcnt vmcnt(12)
    s_branch pc_97
    s_nop 0
pl_96:
    s_add_u32 s32, s79, 0xdc0000
    buffer_load_dwordx4 v[16:19], v253, s[20:23], s32 offen sc1
    s_waitcnt vmcnt(0)
pc_97:
    v_max3_u32 v20, v16, v17, v18
    v_max_u32 v20, v20, v19
    v_cmp_eq_u32 vcc, -1, v20
    s_cbranch_vccz pd_98
    s_sub_u32 s78, s78, 1
    s_cmp_lg_u32 s78, 0
    s_cbranch_scc1 pl_96
    s_mov_b32 s27, 1
pd_98:
    buffer_load_dwordx4 v253, s[20:23], s97 offen offset:2048 sc1 lds
    buffer_load_dwordx4 v253, s[20:23], s97 offen offset:3072 sc1 lds
    s_add_u32 s96, s95, 7
    s_and_b32 s96, s96, 15
    s_mul_i32 s96, s96, 393216
    s_add_u32 s96, s96, s85
    s_add_u32 m0, s87, 65536
    s_nop 0
    buffer_load_dwordx4 v8, s[16:19], s96 offen offset:0 lds
    v_mov_b32 v20, v16
    s_nop 1
    v_max_f32_dpp v20, v20, v20 quad_perm:[1,0,3,2] row_mask:0xf bank_mask:0xf
    s_nop 1
    v_max_f32_dpp v20, v20, v20 quad_perm:[2,3,0,1] row_mask:0xf bank_mask:0xf
    s_nop 1
    v_max_f32_dpp v20, v20, v20 row_half_mirror row_mask:0xf bank_mask:0xf
    s_nop 1
    v_max_f32_dpp v20, v20, v20 row_mirror row_mask:0xf bank_mask:0xf
    v_mov_b32 v21, v20
    buffer_load_dwordx4 v9, s[16:19], s96 offen offset:1024 lds
    s_nop 0
    v_permlane16_swap_b32 v20, v21
    v_max_f32 v20, v20, v21
    v_mov_b32 v21, v20
    s_nop 1
    v_permlane32_swap_b32 v20, v21
    v_max_f32 v20, v20, v21
    v_cmp_eq_f32 vcc, v20, v16
    buffer_load_dwordx4 v10, s[16:19], s96 offen offset:2048 lds
    s_ff1_i32_b64 s32, vcc
    s_and_b32 s32, s32, 63
    v_readlane_b32 s74, v16, s32
    v_readlane_b32 s73, v17, s32
    v_readlane_b32 s75, v18, s32
    v_readlane_b32 s76, v19, s32
    buffer_load_dwordx4 v11, s[16:19], s96 offen offset:3072 lds
    s_and_b32 s73, s73, 2047
    s_lshr_b32 s33, s73, 5
    s_lshl_b32 s33, s33, 11
    s_add_u32 s33, s33, s79
    s_add_u32 s33, s33, 0xd60000
    buffer_load_dwordx4 v[24:27], v22, s[20:23], s33 offen sc1
    s_add_u32 m0, s87, 69632
    s_nop 0
    buffer_load_dwordx4 v12, s[16:19], s96 offen offset:0 lds
    v_mov_b32 v20, s73
    v_mov_b32 v21, s77
    v_mov_b32_e64 v19, 0
    ds_write_b64 v19, v[20:21] offset:3072
    s_lshr_b32 s39, s73, 5
    s_lshl_b32 s34, s24, 2
    buffer_load_dwordx4 v13, s[16:19], s96 offen offset:1024 lds
    s_sub_u32 s39, s39, s34
    s_add_u32 s39, s39, 8
    s_lshr_b32 s34, s39, 3
    s_add_u32 s34, s34, 1
    s_cmp_lt_u32 s39, 12
    s_cselect_b32 s100, s34, 0
    s_waitcnt vmcnt(11) lgkmcnt(0)
    s_barrier
    s_add_u32 s96, s94, 8
    s_and_b32 s96, s96, 15
    s_lshl_b32 s97, s96, 14
    s_add_u32 s97, s97, s84
    s_add_u32 m0, s86, 114688
    s_nop 0
    buffer_load_dwordx4 v253, s[20:23], s97 offen offset:0 sc1 lds
    buffer_load_dwordx4 v253, s[20:23], s97 offen offset:1024 sc1 lds
    s_mov_b32 s78, s27
    s_waitcnt vmcnt(4)
    s_branch pc_86
    s_nop 0
pl_85:
    s_lshr_b32 s33, s73, 5
    s_lshl_b32 s33, s33, 11
    s_add_u32 s33, s33, s79
    s_add_u32 s33, s33, 0xd60000
    buffer_load_dwordx4 v[24:27], v22, s[20:23], s33 offen sc1
    s_waitcnt vmcnt(0)
pc_86:
    v_max3_u32 v30, v24, v25, v26
    v_max_u32 v30, v30, v27
    v_cmp_eq_u32 vcc, -1, v30
    s_cbranch_vccz pd_87
    s_sub_u32 s78, s78, 1
    s_cmp_lg_u32 s78, 0
    s_cbranch_scc1 pl_85
    s_mov_b32 s27, 1
pd_87:
    buffer_load_dwordx4 v253, s[20:23], s97 offen offset:2048 sc1 lds
    buffer_load_dwordx4 v253, s[20:23], s97 offen offset:3072 sc1 lds
    s_cmp_lt_i32 s89, 0
    s_cbranch_scc1 sk_88
    v_and_b32 v30, 16, v252
    v_cmp_eq_u32 vcc, 16, v30
    v_mov_b32 v28, s76
    v_mul_f32 v29, s75, v28
    v_add_f32 v28, 1.0, v28
    v_cndmask_b32 v30, v24, v25, vcc
    v_cndmask_b32_e64 v31, v26, v27, vcc
    s_mov_b32 vcc_lo, 0xaaaaaaaa
    s_mov_b32 vcc_hi, 0xaaaaaaaa
    v_mov_b32 v96, 0xbfb8aa3b
    v_mul_f32 v96, s74, v96
    v_exp_f32 v96, v96
    v_cndmask_b32 v30, v30, v31, vcc
    v_lshlrev_b32 v92, 16, v30
    v_and_b32 v93, 0xffff0000, v30
    v_fma_f32 v92, v92, v28, -v29
    v_fma_f32 v93, v93, v28, -v29
    v_add_f32 v96, 1.0, v96
    v_rcp_f32 v96, v96
sk_88:
    s_add_u32 s96, s94, 8
    s_and_b32 s96, s96, 15
    s_mul_i32 s96, s96, 393216
    s_add_u32 s96, s96, s85
    s_add_u32 m0, s87, 90112
    s_nop 0
    buffer_load_dwordx4 v8, s[16:19], s96 offen offset:0 lds
    buffer_load_dwordx4 v9, s[16:19], s96 offen offset:1024 lds
    v_mov_b32 v28, s76
    v_mul_f32 v29, s75, v28
    v_lshlrev_b32_e64 v30, 16, v24
    v_and_b32 v31, 0xffff0000, v24
    v_fma_f32 v30, v30, v28, -v29
    v_fma_f32 v31, v31, v28, -v29
    buffer_load_dwordx4 v10, s[16:19], s96 offen offset:2048 lds
    v_cvt_pk_bf16_f32 v24, v30, v31
    v_lshlrev_b32_e64 v30, 16, v25
    v_and_b32 v31, 0xffff0000, v25
    v_fma_f32 v30, v30, v28, -v29
    v_fma_f32 v31, v31, v28, -v29
    v_cvt_pk_bf16_f32 v25, v30, v31
    v_lshlrev_b32_e64 v30, 16, v26
    v_and_b32 v31, 0xffff0000, v26
    v_fma_f32 v30, v30, v28, -v29
    v_fma_f32 v31, v31, v28, -v29
    buffer_load_dwordx4 v11, s[16:19], s96 offen offset:3072 lds
    v_cvt_pk_bf16_f32 v26, v30, v31
    v_lshlrev_b32_e64 v30, 16, v27
    v_and_b32 v31, 0xffff0000, v27
    v_fma_f32 v30, v30, v28, -v29
    v_fma_f32 v31, v31, v28, -v29
    v_cvt_pk_bf16_f32 v27, v30, v31
    s_bitcmp0_b32 s29, 0
    s_cbranch_scc1 sk_89
    v_swap_b32 v24, v25
    v_swap_b32 v26, v27
sk_89:
    s_add_u32 m0, s87, 94208
    s_nop 0
    buffer_load_dwordx4 v12, s[16:19], s96 offen offset:0 lds
    s_bitcmp0_b32 s29, 1
    s_cbranch_scc1 sk_90
    v_swap_b32 v24, v26
    v_swap_b32 v25, v27
sk_90:
    buffer_load_dwordx4 v13, s[16:19], s96 offen offset:1024 lds
    s_cmp_ge_u32 s29, 224
    s_cbranch_scc1 sk_91
    v_dot2_f32_bf16 v32, v155, v24, 0
    v_dot2_f32_bf16 v33, v160, v24, 0
    v_dot2_f32_bf16 v34, v156, v24, 0
    v_dot2_f32_bf16 v35, v161, v24, 0
    v_dot2_f32_bf16 v36, v157, v24, 0
    v_dot2_f32_bf16 v37, v162, v24, 0
    v_dot2_f32_bf16 v38, v158, v24, 0
    v_dot2_f32_bf16 v39, v163, v24, 0
    v_dot2_f32_bf16 v40, v183, v24, 0
    v_dot2_f32_bf16 v41, v192, v24, 0
    v_dot2_f32_bf16 v42, v188, v24, 0
    v_dot2_f32_bf16 v43, v193, v24, 0
    v_dot2_f32_bf16 v44, v189, v24, 0
    v_dot2_f32_bf16 v45, v194, v24, 0
    v_dot2_f32_bf16 v46, v190, v24, 0
    v_dot2_f32_bf16 v47, v195, v24, 0
    v_dot2_f32_bf16 v32, v159, v25, v32
    v_dot2_f32_bf16 v33, v168, v25, v33
    v_dot2_f32_bf16 v34, v164, v25, v34
    v_dot2_f32_bf16 v35, v169, v25, v35
    v_dot2_f32_bf16 v36, v165, v25, v36
    v_dot2_f32_bf16 v37, v170, v25, v37
    v_dot2_f32_bf16 v38, v166, v25, v38
    v_dot2_f32_bf16 v39, v171, v25, v39
    v_dot2_f32_bf16 v40, v191, v25, v40
    v_dot2_f32_bf16 v41, v200, v25, v41
    v_dot2_f32_bf16 v42, v196, v25, v42
    v_dot2_f32_bf16 v43, v201, v25, v43
    v_dot2_f32_bf16 v44, v197, v25, v44
    v_dot2_f32_bf16 v45, v202, v25, v45
    v_dot2_f32_bf16 v46, v198, v25, v46
    v_dot2_f32_bf16 v47, v203, v25, v47
    v_dot2_f32_bf16 v32, v167, v26, v32
    v_dot2_f32_bf16 v33, v176, v26, v33
    v_dot2_f32_bf16 v34, v172, v26, v34
    v_dot2_f32_bf16 v35, v177, v26, v35
    v_dot2_f32_bf16 v36, v173, v26, v36
    v_dot2_f32_bf16 v37, v178, v26, v37
    v_dot2_f32_bf16 v38, v174, v26, v38
    v_dot2_f32_bf16 v39, v179, v26, v39
    v_dot2_f32_bf16 v40, v199, v26, v40
    v_dot2_f32_bf16 v41, v208, v26, v41
    v_dot2_f32_bf16 v42, v204, v26, v42
    v_dot2_f32_bf16 v43, v209, v26, v43
    v_dot2_f32_bf16 v44, v205, v26, v44
    v_dot2_f32_bf16 v45, v210, v26, v45
    v_dot2_f32_bf16 v46, v206, v26, v46
    v_dot2_f32_bf16 v47, v211, v26, v47
    v_dot2_f32_bf16 v32, v175, v27, v32
    v_dot2_f32_bf16 v33, v184, v27, v33
    v_dot2_f32_bf16 v34, v180, v27, v34
    v_dot2_f32_bf16 v35, v185, v27, v35
    v_dot2_f32_bf16 v36, v181, v27, v36
    v_dot2_f32_bf16 v37, v186, v27, v37
    v_dot2_f32_bf16 v38, v182, v27, v38
    v_dot2_f32_bf16 v39, v187, v27, v39
    v_dot2_f32_bf16 v40, v207, v27, v40
    v_dot2_f32_bf16 v41, v216, v27, v41
    v_dot2_f32_bf16 v42, v212, v27, v42
    v_dot2_f32_bf16 v43, v217, v27, v43
    v_dot2_f32_bf16 v44, v213, v27, v44
    v_dot2_f32_bf16 v45, v218, v27, v45
    v_dot2_f32_bf16 v46, v214, v27, v46
    v_dot2_f32_bf16 v47, v219, v27, v47
sk_91:
    s_waitcnt vmcnt(10) lgkmcnt(0)
    s_barrier
    s_add_u32 s96, s95, 9
    s_and_b32 s96, s96, 15
    s_lshl_b32 s97, s96, 14
    s_add_u32 s97, s97, s84
    s_add_u32 m0, s86, 147456
    s_nop 0
    buffer_load_dwordx4 v253, s[20:23], s97 offen offset:0 sc1 lds
    buffer_load_dwordx4 v253, s[20:23], s97 offen offset:1024 sc1 lds
    v_lshrrev_b32 v31, 5, v252
    v_lshlrev_b32 v30, 6, v31
    v_permlane32_swap_b32 v32, v40
    v_permlane32_swap_b32 v33, v41
    v_permlane32_swap_b32 v34, v42
    v_permlane32_swap_b32_e64 v35, v43
    buffer_load_dwordx4 v253, s[20:23], s97 offen offset:2048 sc1 lds
    v_permlane32_swap_b32 v36, v44
    v_permlane32_swap_b32 v37, v45
    v_permlane32_swap_b32 v38, v46
    v_permlane32_swap_b32 v39, v47
    v_add_f32_e64 v32, v32, v40
    buffer_load_dwordx4 v253, s[20:23], s97 offen offset:3072 sc1 lds
    v_add_f32 v33, v33, v41
    v_add_f32 v34, v34, v42
    v_add_f32 v35, v35, v43
    v_add_f32 v36, v36, v44
    v_add_f32_e64 v37, v37, v45
    s_add_u32 s96, s95, 9
    s_and_b32 s96, s96, 15
    s_mul_i32 s96, s96, 393216
    s_add_u32 s96, s96, s85
    s_add_u32 m0, s87, 40960
    s_nop 0
    buffer_load_dwordx4 v8, s[16:19], s96 offen offset:0 lds
    v_add_f32 v38, v38, v46
    v_add_f32 v39, v39, v47
    v_and_b32_e64 v31, 1, v252
    v_lshl_add_u32 v30, v31, 5, v30
    v_permlane16_swap_b32_e64 v32, v36
    buffer_load_dwordx4 v9, s[16:19], s96 offen offset:1024 lds
    v_permlane16_swap_b32 v33, v37
    v_permlane16_swap_b32 v34, v38
    v_permlane16_swap_b32 v35, v39
    v_add_f32 v32, v32, v36
    v_add_f32 v33, v33, v37
    v_add_f32 v34, v34, v38
    buffer_load_dwordx4 v10, s[16:19], s96 offen offset:2048 lds
    v_add_f32 v35, v35, v39
    v_and_b32 v31, 16, v252
    s_lshl_b32 s32, s28, 7
    v_add3_u32 v30, v31, v30, s32
    v_add_f32_dpp v32, v32, v32 quad_perm:[2,3,0,1] row_mask:0xf bank_mask:0xf
    buffer_load_dwordx4 v11, s[16:19], s96 offen offset:3072 lds
    v_add_f32_dpp v33, v33, v33 quad_perm:[2,3,0,1] row_mask:0xf bank_mask:0xf
    v_add_f32_dpp v34, v34, v34 quad_perm:[2,3,0,1] row_mask:0xf bank_mask:0xf
    v_add_f32_dpp v35, v35, v35 quad_perm:[2,3,0,1] row_mask:0xf bank_mask:0xf
    v_add_f32_dpp v32, v32, v32 row_ror:4 row_mask:0xf bank_mask:0xf
    v_add_f32_dpp v33, v33, v33 row_ror:4 row_mask:0xf bank_mask:0xf
    s_add_u32 m0, s87, 45056
    s_nop 0
    buffer_load_dwordx4 v12, s[16:19], s96 offen offset:0 lds
    v_add_f32_dpp v34, v34, v34 row_ror:4 row_mask:0xf bank_mask:0xf
    v_add_f32_dpp v35, v35, v35 row_ror:4 row_mask:0xf bank_mask:0xf
    v_add_f32_dpp v32, v32, v32 row_ror:8 row_mask:0xf bank_mask:0xf
    v_add_f32_dpp v33, v33, v33 row_ror:8 row_mask:0xf bank_mask:0xf
    v_add_f32_dpp v34, v34, v34 row_ror:8 row_mask:0xf bank_mask:0xf
    buffer_load_dwordx4 v13, s[16:19], s96 offen offset:1024 lds
    v_add_f32_dpp v35, v35, v35 row_ror:8 row_mask:0xf bank_mask:0xf
    s_mov_b32 exec_lo, 0x00030003
    s_mov_b32 exec_hi, 0x00030003
    ds_write_b128 v30, v[32:35] offset:3328
    s_mov_b64 exec, -1
    s_waitcnt vmcnt(10) lgkmcnt(0)
    s_barrier
    s_add_u32 s96, s94, 10
    s_and_b32 s96, s96, 15
    s_lshl_b32 s97, s96, 14
    s_add_u32 s97, s97, s84
    s_add_u32 m0, s86, 131072
    s_nop 0
    buffer_load_dwordx4 v253, s[20:23], s97 offen offset:0 sc1 lds
    buffer_load_dwordx4 v253, s[20:23], s97 offen offset:1024 sc1 lds
    v_and_b32_e64 v30, 1, v252
    v_bfe_u32 v31, v252, 1, 3
    v_lshl_add_u32 v30, v30, 3, v31
    v_lshlrev_b32_e64 v30, 2, v30
    v_add_u32 v30, 3328, v30
    ds_read2_b32 v[32:33], v30 offset0:0 offset1:16
    buffer_load_dwordx4 v253, s[20:23], s97 offen offset:2048 sc1 lds
    ds_read2_b32 v[34:35], v30 offset0:32 offset1:48
    ds_read2_b32 v[36:37], v30 offset0:64 offset1:80
    ds_read2_b32 v[38:39], v30 offset0:96 offset1:112
    v_lshrrev_b32_e64 v30, 2, v252
    v_mul_u32_u24 v30, 7168, v30
    buffer_load_dwordx4 v253, s[20:23], s97 offen offset:3072 sc1 lds
    v_and_b32_e64 v31, 2, v252
    v_lshl_add_u32 v30, v31, 3, v30
    s_add_u32 s32, s29, 32
    s_lshr_b32 s32, s32, 8
    v_lshl_add_u32 v30, s32, 31, v30
    s_add_u32 s96, s94, 10
    s_and_b32 s96, s96, 15
    s_mul_i32 s96, s96, 393216
    s_add_u32 s96, s96, s85
    s_add_u32 m0, s87, 65536
    s_nop 0
    buffer_load_dwordx4 v8, s[16:19], s96 offen offset:0 lds
    s_mul_i32 s32, s28, 114688
    s_mul_i32 s33, s29, 32
    s_add_u32 s32, s32, s33
    s_add_u32 s32, s32, s79
    s_add_u32 s32, s32, 0xc80000
    buffer_load_dwordx4 v9, s[16:19], s96 offen offset:1024 lds
    s_waitcnt lgkmcnt(0)
    v_add_f32 v32, v32, v34
    v_add_f32 v33, v33, v35
    v_add_f32 v36, v36, v38
    v_add_f32 v37, v37, v39
    buffer_load_dwordx4 v10, s[16:19], s96 offen offset:2048 lds
    v_add_f32 v32, v32, v36
    v_add_f32 v33, v33, v37
    v_mul_f32 v34, 0xbfb8aa3b, v32
    v_exp_f32 v34, v34
    v_mul_f32 v32, v32, v33
    buffer_load_dwordx4 v11, s[16:19], s96 offen offset:3072 lds
    v_add_f32 v34, 1.0, v34
    v_rcp_f32 v34, v34
    s_nop 0
    v_mul_f32 v32, v32, v34
    s_nop 1
    v_mov_b32_dpp v33, v32 quad_perm:[2,3,2,3] row_mask:0xf bank_mask:0xf
    v_cvt_pk_bf16_f32 v32, v32, v33
    s_add_u32 m0, s87, 69632
    s_nop 0
    buffer_load_dwordx4 v12, s[16:19], s96 offen offset:0 lds
    ds_swizzle_b32 v36, v32 offset:0x1
    ds_swizzle_b32 v37, v32 offset:0x81
    ds_swizzle_b32 v38, v32 offset:0x101
    ds_swizzle_b32 v39, v32 offset:0x181
    s_waitcnt lgkmcnt(0)
    buffer_load_dwordx4 v13, s[16:19], s96 offen offset:1024 lds
    s_cmp_ge_u32 s29, 224
    s_cbranch_scc1 sk_92
    v_dot2_f32_bf16 v40, v215, v36, 0
    v_dot2_f32_bf16 v41, v224, v36, 0
    v_dot2_f32_bf16 v42, v220, v36, 0
    v_dot2_f32_bf16 v43, v225, v36, 0
    v_dot2_f32_bf16 v44, v221, v36, 0
    v_dot2_f32_bf16 v45, v226, v36, 0
    v_dot2_f32_bf16 v46, v222, v36, 0
    v_dot2_f32_bf16 v47, v227, v36, 0
    v_dot2_f32_bf16 v40, v223, v37, v40
    v_dot2_f32_bf16 v41, v232, v37, v41
    v_dot2_f32_bf16 v42, v228, v37, v42
    v_dot2_f32_bf16 v43, v233, v37, v43
    v_dot2_f32_bf16 v44, v229, v37, v44
    v_dot2_f32_bf16 v45, v234, v37, v45
    v_dot2_f32_bf16 v46, v230, v37, v46
    v_dot2_f32_bf16 v47, v235, v37, v47
    v_dot2_f32_bf16 v40, v231, v38, v40
    v_dot2_f32_bf16 v41, v240, v38, v41
    v_dot2_f32_bf16 v42, v236, v38, v42
    v_dot2_f32_bf16 v43, v241, v38, v43
    v_dot2_f32_bf16 v44, v237, v38, v44
    v_dot2_f32_bf16 v45, v242, v38, v45
    v_dot2_f32_bf16 v46, v238, v38, v46
    v_dot2_f32_bf16 v47, v243, v38, v47
    v_dot2_f32_bf16 v40, v239, v39, v40
    v_dot2_f32_bf16 v41, v248, v39, v41
    v_dot2_f32_bf16 v42, v244, v39, v42
    v_dot2_f32_bf16 v43, v249, v39, v43
    v_dot2_f32_bf16 v44, v245, v39, v44
    v_dot2_f32_bf16 v45, v250, v39, v45
    v_dot2_f32_bf16 v46, v246, v39, v46
    v_dot2_f32_bf16 v47, v251, v39, v47
sk_92:
    v_add_f32_dpp v40, v40, v40 quad_perm:[1,0,3,2] row_mask:0xf bank_mask:0xf
    v_add_f32_dpp v41, v41, v41 quad_perm:[1,0,3,2] row_mask:0xf bank_mask:0xf
    v_add_f32_dpp v42, v42, v42 quad_perm:[1,0,3,2] row_mask:0xf bank_mask:0xf
    v_add_f32_dpp v43, v43, v43 quad_perm:[1,0,3,2] row_mask:0xf bank_mask:0xf
    v_add_f32_dpp v44, v44, v44 quad_perm:[1,0,3,2] row_mask:0xf bank_mask:0xf
    v_add_f32_dpp v45, v45, v45 quad_perm:[1,0,3,2] row_mask:0xf bank_mask:0xf
    v_add_f32_dpp v46, v46, v46 quad_perm:[1,0,3,2] row_mask:0xf bank_mask:0xf
    v_add_f32_dpp v47, v47, v47 quad_perm:[1,0,3,2] row_mask:0xf bank_mask:0xf
    s_mov_b32 exec_lo, 0x55555555
    s_mov_b32 exec_hi, 0x55555555
    v_cvt_pk_bf16_f32 v40, v40, v41
    v_cvt_pk_bf16_f32 v41, v42, v43
    v_cvt_pk_bf16_f32 v42, v44, v45
    v_cvt_pk_bf16_f32 v43, v46, v47
    buffer_store_dwordx4 v[40:43], v30, s[20:23], s32 offen sc1
    s_mov_b64 exec, -1
    s_waitcnt vmcnt(11) lgkmcnt(0)
    s_barrier
    s_add_u32 s96, s95, 11
    s_and_b32 s96, s96, 15
    s_lshl_b32 s97, s96, 14
    s_add_u32 s97, s97, s84
    s_add_u32 m0, s86, 114688
    s_nop 0
    buffer_load_dwordx4 v253, s[20:23], s97 offen offset:0 sc1 lds
    buffer_load_dwordx4 v253, s[20:23], s97 offen offset:1024 sc1 lds
    buffer_load_dwordx4 v253, s[20:23], s97 offen offset:2048 sc1 lds
    buffer_load_dwordx4 v253, s[20:23], s97 offen offset:3072 sc1 lds
    s_add_u32 s96, s95, 11
    s_and_b32 s96, s96, 15
    s_mul_i32 s96, s96, 393216
    s_add_u32 s96, s96, s85
    s_add_u32 m0, s87, 90112
    s_nop 0
    buffer_load_dwordx4 v8, s[16:19], s96 offen offset:0 lds
    buffer_load_dwordx4 v9, s[16:19], s96 offen offset:1024 lds
    buffer_load_dwordx4 v10, s[16:19], s96 offen offset:2048 lds
    buffer_load_dwordx4 v11, s[16:19], s96 offen offset:3072 lds
    s_add_u32 m0, s87, 94208
    s_nop 0
    buffer_load_dwordx4 v12, s[16:19], s96 offen offset:0 lds
    buffer_load_dwordx4 v13, s[16:19], s96 offen offset:1024 lds
    s_waitcnt vmcnt(11) lgkmcnt(0)
    s_barrier
    s_add_u32 s96, s94, 12
    s_and_b32 s96, s96, 15
    s_lshl_b32 s97, s96, 14
    s_add_u32 s97, s97, s84
    s_add_u32 m0, s86, 147456
    s_nop 0
    buffer_load_dwordx4 v253, s[20:23], s97 offen offset:0 sc1 lds
    buffer_load_dwordx4 v253, s[20:23], s97 offen offset:1024 sc1 lds
    buffer_load_dwordx4 v253, s[20:23], s97 offen offset:2048 sc1 lds
    buffer_load_dwordx4 v253, s[20:23], s97 offen offset:3072 sc1 lds
    s_add_u32 s96, s94, 12
    s_and_b32 s96, s96, 15
    s_mul_i32 s96, s96, 393216
    s_add_u32 s96, s96, s85
    s_add_u32 m0, s87, 40960
    s_nop 0
    buffer_load_dwordx4 v8, s[16:19], s96 offen offset:0 lds
    buffer_load_dwordx4 v9, s[16:19], s96 offen offset:1024 lds
    buffer_load_dwordx4 v10, s[16:19], s96 offen offset:2048 lds
    buffer_load_dwordx4 v11, s[16:19], s96 offen offset:3072 lds
    s_add_u32 m0, s87, 45056
    s_nop 0
    buffer_load_dwordx4 v12, s[16:19], s96 offen offset:0 lds
    buffer_load_dwordx4 v13, s[16:19], s96 offen offset:1024 lds
    s_waitcnt vmcnt(10) lgkmcnt(0)
    s_barrier
    s_cmp_lt_i32 s89, 0
    s_cbranch_scc1 sk_99
    s_mul_i32 s32, s89, 3584
    s_add_u32 s32, s32, s79
    s_add_u32 s32, s32, 0xc80000
    buffer_load_dwordx4 v[60:63], v253, s[20:23], s32 offen offset:0 sc1
    buffer_load_dwordx4 v[64:67], v253, s[20:23], s32 offen offset:1024 sc1
    buffer_load_dwordx4 v[68:71], v253, s[20:23], s32 offen offset:2048 sc1
    buffer_load_dwordx4 v[72:75], v253, s[20:23], s32 offen offset:3072 sc1
    s_add_u32 s32, s32, 4096
    buffer_load_dwordx4 v[76:79], v253, s[20:23], s32 offen offset:0 sc1
    buffer_load_dwordx4 v[80:83], v253, s[20:23], s32 offen offset:1024 sc1
    buffer_load_dwordx4 v[84:87], v253, s[20:23], s32 offen offset:2048 sc1
sk_99:
    s_add_u32 s96, s95, 13
    s_and_b32 s96, s96, 15
    s_lshl_b32 s97, s96, 14
    s_add_u32 s97, s97, s84
    s_add_u32 m0, s86, 131072
    s_nop 0
    buffer_load_dwordx4 v253, s[20:23], s97 offen offset:0 sc1 lds
    buffer_load_dwordx4 v253, s[20:23], s97 offen offset:1024 sc1 lds
    buffer_load_dwordx4 v253, s[20:23], s97 offen offset:2048 sc1 lds
    buffer_load_dwordx4 v253, s[20:23], s97 offen offset:3072 sc1 lds
    s_add_u32 s96, s95, 13
    s_and_b32 s96, s96, 15
    s_mul_i32 s96, s96, 393216
    s_add_u32 s96, s96, s85
    s_add_u32 m0, s87, 65536
    s_nop 0
    buffer_load_dwordx4 v8, s[16:19], s96 offen offset:0 lds
    buffer_load_dwordx4 v9, s[16:19], s96 offen offset:1024 lds
    buffer_load_dwordx4 v10, s[16:19], s96 offen offset:2048 lds
    buffer_load_dwordx4 v11, s[16:19], s96 offen offset:3072 lds
    s_add_u32 m0, s87, 69632
    s_nop 0
    buffer_load_dwordx4 v12, s[16:19], s96 offen offset:0 lds
    buffer_load_dwordx4 v13, s[16:19], s96 offen offset:1024 lds
    s_waitcnt vmcnt(10) lgkmcnt(0)
    s_barrier
    s_add_u32 s96, s94, 14
    s_and_b32 s96, s96, 15
    s_lshl_b32 s97, s96, 14
    s_add_u32 s97, s97, s84
    s_add_u32 m0, s86, 114688
    s_nop 0
    buffer_load_dwordx4 v253, s[20:23], s97 offen offset:0 sc1 lds
    buffer_load_dwordx4 v253, s[20:23], s97 offen offset:1024 sc1 lds
    s_cmp_lt_i32 s89, 0
    s_cbranch_scc1 sk_100
    s_mov_b32 s78, s27
    s_waitcnt vmcnt(12)
    s_branch pc_94
    s_nop 0
pl_93:
    s_mul_i32 s32, s89, 3584
    s_add_u32 s32, s32, s79
    s_add_u32 s32, s32, 0xc80000
    buffer_load_dwordx4 v[60:63], v253, s[20:23], s32 offen offset:0 sc1
    buffer_load_dwordx4 v[64:67], v253, s[20:23], s32 offen offset:1024 sc1
    buffer_load_dwordx4 v[68:71], v253, s[20:23], s32 offen offset:2048 sc1
    buffer_load_dwordx4 v[72:75], v253, s[20:23], s32 offen offset:3072 sc1
    s_add_u32 s32, s32, 4096
    buffer_load_dwordx4 v[76:79], v253, s[20:23], s32 offen offset:0 sc1
    buffer_load_dwordx4 v[80:83], v253, s[20:23], s32 offen offset:1024 sc1
    buffer_load_dwordx4 v[84:87], v253, s[20:23], s32 offen offset:2048 sc1
    s_waitcnt vmcnt(0)
pc_94:
    v_max3_u32 v30, v60, v64, v68
    v_max3_u32 v30, v30, v72, v76
    v_max3_u32 v30, v30, v80, v84
    v_cmp_eq_u32 vcc, -1, v30
    s_cbranch_vccz pd_95
    s_sub_u32 s78, s78, 1
    s_cmp_lg_u32 s78, 0
    s_cbranch_scc1 pl_93
    s_mov_b32 s27, 1
pd_95:
sk_100:
    buffer_load_dwordx4 v253, s[20:23], s97 offen offset:2048 sc1 lds
    s_cmp_lt_i32 s89, 0
    s_cbranch_scc1 sk_101
    v_lshlrev_b32 v24, 16, v60
    v_and_b32 v25, 0xffff0000, v60
    v_lshlrev_b32_e64 v26, 16, v61
    v_and_b32 v27, 0xffff0000, v61
    v_lshlrev_b32_e64 v28, 16, v62
    v_and_b32 v29, 0xffff0000, v62
    v_lshlrev_b32_e64 v30, 16, v63
    v_and_b32 v31, 0xffff0000, v63
    v_lshlrev_b32_e64 v88, 16, v64
    v_and_b32 v89, 0xffff0000, v64
    v_lshlrev_b32_e64 v90, 16, v65
sk_101:
    s_cmp_lt_i32 s89, 0
    s_cbranch_scc1 sk_102
    v_and_b32 v91, 0xffff0000, v65
    v_add_f32 v24, v24, v88
    v_add_f32 v25, v25, v89
    v_add_f32 v26, v26, v90
    v_add_f32 v27, v27, v91
    v_lshlrev_b32_e64 v88, 16, v66
    v_and_b32 v89, 0xffff0000, v66
    v_lshlrev_b32_e64 v90, 16, v67
    v_and_b32 v91, 0xffff0000, v67
    v_add_f32 v28, v28, v88
    v_add_f32 v29, v29, v89
    v_add_f32 v30, v30, v90
    v_add_f32 v31, v31, v91
    v_lshlrev_b32_e64 v88, 16, v68
    v_and_b32 v89, 0xffff0000, v68
    v_lshlrev_b32_e64 v90, 16, v69
    v_and_b32 v91, 0xffff0000, v69
    v_add_f32 v24, v24, v88
    v_add_f32 v25, v25, v89
    v_add_f32_e64 v26, v26, v90
sk_102:
    buffer_load_dwordx4 v253, s[20:23], s97 offen offset:3072 sc1 lds
    s_cmp_lt_i32 s89, 0
    s_cbranch_scc1 sk_103
    v_add_f32 v27, v27, v91
    v_lshlrev_b32 v88, 16, v70
    v_and_b32 v89, 0xffff0000, v70
    v_lshlrev_b32_e64 v90, 16, v71
    v_and_b32 v91, 0xffff0000, v71
    v_add_f32 v28, v28, v88
    v_add_f32 v29, v29, v89
    v_add_f32 v30, v30, v90
    v_add_f32 v31, v31, v91
    v_lshlrev_b32_e64 v88, 16, v72
    v_and_b32 v89, 0xffff0000, v72
    v_lshlrev_b32_e64 v90, 16, v73
    v_and_b32 v91, 0xffff0000, v73
    v_add_f32 v24, v24, v88
    v_add_f32 v25, v25, v89
    v_add_f32 v26, v26, v90
    v_add_f32 v27, v27, v91
    v_lshlrev_b32_e64 v88, 16, v74
    v_and_b32 v89, 0xffff0000, v74
    v_lshlrev_b32_e64 v90, 16, v75
sk_103:
    s_add_u32 s96, s94, 14
    s_and_b32 s96, s96, 15
    s_mul_i32 s96, s96, 393216
    s_add_u32 s96, s96, s85
    s_add_u32 m0, s87, 90112
    s_nop 0
    buffer_load_dwordx4 v8, s[16:19], s96 offen offset:0 lds
    s_cmp_lt_i32 s89, 0
    s_cbranch_scc1 sk_104
    v_and_b32 v91, 0xffff0000, v75
    v_add_f32 v28, v28, v88
    v_add_f32 v29, v29, v89
    v_add_f32 v30, v30, v90
    v_add_f32 v31, v31, v91
    v_lshlrev_b32_e64 v88, 16, v76
    v_and_b32 v89, 0xffff0000, v76
    v_lshlrev_b32_e64 v90, 16, v77
    v_and_b32 v91, 0xffff0000, v77
    v_add_f32 v24, v24, v88
    v_add_f32 v25, v25, v89
    v_add_f32 v26, v26, v90
    v_add_f32 v27, v27, v91
    v_lshlrev_b32_e64 v88, 16, v78
    v_and_b32 v89, 0xffff0000, v78
    v_lshlrev_b32_e64 v90, 16, v79
    v_and_b32 v91, 0xffff0000, v79
    v_add_f32 v28, v28, v88
    v_add_f32 v29, v29, v89
    v_add_f32_e64 v30, v30, v90
sk_104:
    buffer_load_dwordx4 v9, s[16:19], s96 offen offset:1024 lds
    s_cmp_lt_i32 s89, 0
    s_cbranch_scc1 sk_105
    v_add_f32 v31, v31, v91
    v_lshlrev_b32 v88, 16, v80
    v_and_b32 v89, 0xffff0000, v80
    v_lshlrev_b32_e64 v90, 16, v81
    v_and_b32 v91, 0xffff0000, v81
    v_add_f32 v24, v24, v88
    v_add_f32 v25, v25, v89
    v_add_f32 v26, v26, v90
    v_add_f32 v27, v27, v91
    v_lshlrev_b32_e64 v88, 16, v82
    v_and_b32 v89, 0xffff0000, v82
    v_lshlrev_b32_e64 v90, 16, v83
    v_and_b32 v91, 0xffff0000, v83
    v_add_f32 v28, v28, v88
    v_add_f32 v29, v29, v89
    v_add_f32 v30, v30, v90
    v_add_f32 v31, v31, v91
    v_lshlrev_b32_e64 v88, 16, v84
    v_and_b32 v89, 0xffff0000, v84
    v_lshlrev_b32_e64 v90, 16, v85
sk_105:
    buffer_load_dwordx4 v10, s[16:19], s96 offen offset:2048 lds
    s_cmp_lt_i32 s89, 0
    s_cbranch_scc1 sk_106
    v_and_b32 v91, 0xffff0000, v85
    v_add_f32 v24, v24, v88
    v_add_f32 v25, v25, v89
    v_add_f32 v26, v26, v90
    v_add_f32 v27, v27, v91
    v_lshlrev_b32_e64 v88, 16, v86
    v_and_b32 v89, 0xffff0000, v86
    v_lshlrev_b32_e64 v90, 16, v87
    v_and_b32 v91, 0xffff0000, v87
    v_add_f32 v28, v28, v88
    v_add_f32 v29, v29, v89
    v_add_f32 v30, v30, v90
    v_add_f32 v31, v31, v91
    v_permlane32_swap_b32 v24, v28
    v_permlane32_swap_b32 v25, v29
    v_permlane32_swap_b32 v26, v30
    v_permlane32_swap_b32 v27, v31
    v_add_f32 v24, v24, v28
    v_add_f32 v25, v25, v29
    v_add_f32_e64 v26, v26, v30
sk_106:
    buffer_load_dwordx4 v11, s[16:19], s96 offen offset:3072 lds
    s_cmp_lt_i32 s89, 0
    s_cbranch_scc1 sk_107
    v_add_f32 v27, v27, v31
    v_permlane16_swap_b32 v24, v26
    s_nop 0
    v_permlane16_swap_b32 v25, v27
    v_add_f32_e64 v24, v24, v26
    v_add_f32 v25, v25, v27
    s_nop 0
    v_add_f32_dpp v24, v24, v24 quad_perm:[2,3,0,1] row_mask:0xf bank_mask:0xf
    v_add_f32_dpp v25, v25, v25 quad_perm:[2,3,0,1] row_mask:0xf bank_mask:0xf
    s_nop 0
    v_add_f32_dpp v24, v24, v24 row_ror:4 row_mask:0xf bank_mask:0xf
    v_add_f32_dpp v25, v25, v25 row_ror:4 row_mask:0xf bank_mask:0xf
    s_nop 0
    v_add_f32_dpp v24, v24, v24 row_ror:8 row_mask:0xf bank_mask:0xf
    v_add_f32_dpp v25, v25, v25 row_ror:8 row_mask:0xf bank_mask:0xf
    v_fma_f32 v28, v24, v96, v92
    v_fma_f32 v29, v25, v96, v93
    v_cvt_pk_bf16_f32 v24, v28, v29
    v_cvt_pk_bf16_f32 v25, v28, v29
    v_cvt_pk_bf16_f32 v26, v28, v29
    v_cvt_pk_bf16_f32 v27, v28, v29
    v_permlane16_swap_b32 v24, v25
    s_nop 0
    v_permlane16_swap_b32 v26, v27
    s_nop 1
    v_permlane32_swap_b32 v24, v26
    v_permlane32_swap_b32 v25, v27
sk_107:
    s_add_u32 m0, s87, 94208
    s_nop 0
    buffer_load_dwordx4 v12, s[16:19], s96 offen offset:0 lds
    s_mov_b32 s32, 0xdc4000
    s_lshl_b32 s33, s89, 4
    v_or_b32 v88, s33, v253
    buffer_load_dwordx4 v13, s[16:19], s96 offen offset:1024 lds
    s_mov_b64 exec, 3
    buffer_store_dwordx4 v[24:27], v88, s[20:23], s32 offen sc1
    s_mov_b64 exec, -1
    s_waitcnt vmcnt(11) lgkmcnt(0)
    s_barrier
    s_add_u32 s96, s95, 15
    s_and_b32 s96, s96, 15
    s_lshl_b32 s97, s96, 14
    s_add_u32 s97, s97, s84
    s_add_u32 m0, s86, 147456
    s_nop 0
    buffer_load_dwordx4 v253, s[20:23], s97 offen offset:0 sc1 lds
    buffer_load_dwordx4 v253, s[20:23], s97 offen offset:1024 sc1 lds
    buffer_load_dwordx4 v253, s[20:23], s97 offen offset:2048 sc1 lds
    buffer_load_dwordx4 v253, s[20:23], s97 offen offset:3072 sc1 lds
    s_add_u32 s96, s95, 15
    s_and_b32 s96, s96, 15
    s_mul_i32 s96, s96, 393216
    s_add_u32 s96, s96, s85
    s_add_u32 m0, s87, 40960
    s_nop 0
    buffer_load_dwordx4 v8, s[16:19], s96 offen offset:0 lds
    buffer_load_dwordx4 v9, s[16:19], s96 offen offset:1024 lds
    buffer_load_dwordx4 v10, s[16:19], s96 offen offset:2048 lds
    buffer_load_dwordx4 v11, s[16:19], s96 offen offset:3072 lds
    s_add_u32 m0, s87, 45056
    s_nop 0
    buffer_load_dwordx4 v12, s[16:19], s96 offen offset:0 lds
    buffer_load_dwordx4 v13, s[16:19], s96 offen offset:1024 lds
    s_waitcnt vmcnt(11) lgkmcnt(0)
    s_barrier
    s_min_u32 s30, s28, 2
    s_lshl_b32 s30, s30, 13
    s_add_u32 s30, s30, 90112
    v_lshrrev_b32 v20, 2, v252
    v_bfe_u32 v21, v20, 1, 2
    v_lshlrev_b32_e64 v20, 7, v20
    v_lshl_add_u32 v20, v21, 5, v20
    v_and_b32_e64 v21, 3, v252
    v_lshl_add_u32 v20, v21, 3, v20
    v_add_u32 v144, s30, v20
    v_xor_b32 v145, 32, v144
    v_xor_b32_e64 v146, 64, v144
    v_xor_b32 v147, 96, v144
    ds_read_b64_tr_b16 v[100:101], v144 offset:0
    ds_read_b64_tr_b16 v[102:103], v144 offset:2048
    ds_read_b64_tr_b16 v[104:105], v144 offset:4096
    ds_read_b64_tr_b16 v[106:107], v144 offset:6144
    ds_read_b64_tr_b16 v[108:109], v145 offset:0
    ds_read_b64_tr_b16 v[110:111], v145 offset:2048
    ds_read_b64_tr_b16 v[112:113], v145 offset:4096
    ds_read_b64_tr_b16 v[114:115], v145 offset:6144
    ds_read_b64_tr_b16 v[116:117], v146 offset:0
    ds_read_b64_tr_b16 v[118:119], v146 offset:2048
    ds_read_b64_tr_b16 v[120:121], v146 offset:4096
    ds_read_b64_tr_b16 v[122:123], v146 offset:6144
    ds_read_b64_tr_b16 v[124:125], v147 offset:0
    ds_read_b64_tr_b16 v[126:127], v147 offset:2048
    ds_read_b64_tr_b16 v[128:129], v147 offset:4096
    ds_read_b64_tr_b16 v[130:131], v147 offset:6144
    s_getpc_b64 s[32:33]
pc_108:
    s_sub_u32 s32, s32, pc_108-interleave_layers__sliding_block__moe_arch_mod__prompt_kernel
    s_subb_u32 s33, s33, 0
    s_lshr_b32 s34, s2, 3
    s_lshl_b32 s34, s34, 2
    s_add_u32 s34, s34, s28
    s_and_b32 s34, s34, 127
    s_lshl_b32 s34, s34, 7
    v_lshl_add_u32 v154, v252, 14, s34
    s_mov_b32 s34, k_exit-interleave_layers__sliding_block__moe_arch_mod__prompt_kernel
    s_mov_b32 s35, 0x20000
    buffer_load_dword v154, v154, s[32:35], 0 offen
    s_waitcnt vmcnt(1) lgkmcnt(0)
    s_barrier
    s_add_u32 s35, s94, 14
    s_and_b32 s35, s35, 15
    s_lshl_b32 s35, s35, 7
    s_add_u32 s35, s35, 0xdc4000
    v_and_b32 v19, 32, v252
    v_bfe_u32 v18, v252, 4, 1
    v_lshl_add_u32 v19, v18, 3, v19
    buffer_load_dwordx2 v[132:133], v19, s[20:23], s35 offen offset:0 sc1
    buffer_load_dwordx2 v[134:135], v19, s[20:23], s35 offen offset:16 sc1
    buffer_load_dwordx2 v[136:137], v19, s[20:23], s35 offen offset:64 sc1
    buffer_load_dwordx2 v[138:139], v19, s[20:23], s35 offen offset:80 sc1
    s_cmp_eq_u32 s100, 0
    s_cbranch_scc1 sk_109
    v_and_b32 v20, 7, v252
    v_lshrrev_b32 v21, 4, v252
    v_lshl_add_u32 v21, v20, 2, v21
    s_and_b32 s34, s73, 31
    s_and_b32 s32, s34, 7
    s_and_b32 s33, s34, 8
    s_lshl_b32 s33, s33, 1
    s_add_u32 s32, s32, s33
    s_lshr_b32 s33, s34, 4
    s_lshl_b32 s33, s33, 3
    s_add_u32 s32, s32, s33
    s_cmp_eq_u32 s28, 1
    s_cselect_b32 s34, s32, s34
    v_mov_b32_e64 v20, s34
    s_cmp_ge_u32 s28, 2
    s_cselect_b64 vcc, -1, 0
    s_cselect_b32 s32, 2048, 0
    v_cndmask_b32 v30, v20, v21, vcc
    v_cndmask_b32 v31, v21, v20, vcc
    v_lshlrev_b32_e64 v0, 4, v30
    v_bfe_u32 v20, v31, 2, 2
    v_lshl_add_u32 v0, v20, 9, v0
    v_lshrrev_b32_e64 v20, 4, v31
    v_lshl_add_u32 v0, v20, 3, v0
    v_and_b32 v20, 3, v31
    v_lshl_add_u32 v0, v20, 1, v0
    s_lshl_b32 s33, s39, 12
    s_add_u32 s33, s33, s32
    s_add_u32 s33, s33, 65536
    s_lshl_b32 s34, s39, 11
    s_add_u32 s34, s34, 32768
    s_cmp_ge_u32 s39, 8
    s_cselect_b32 s38, 1, 0
    s_movk_i32 s32, 8192
    s_cmp_eq_u32 s28, 0
    s_cselect_b32 s33, s34, s33
    s_cselect_b32 s32, s32, 49152
    s_cselect_b32 s38, s38, 1
    s_cselect_b32 s37, 0x3e8293ee, 1.0
    v_bfe_u32 v20, v252, 3, 1
    v_mul_u32_u24_e64 v20, s32, v20
    v_add3_u32 v0, v0, v20, s33
sk_109:
    s_waitcnt lgkmcnt(0)
    s_barrier
    s_mov_b32 s78, s27
    s_waitcnt vmcnt(0)
    s_branch pc_111
pl_110:
    s_add_u32 s35, s94, 14
    s_and_b32 s35, s35, 15
    s_lshl_b32 s35, s35, 7
    s_add_u32 s35, s35, 0xdc4000
    v_and_b32_e64 v19, 32, v252
    v_bfe_u32 v18, v252, 4, 1
    v_lshl_add_u32 v19, v18, 3, v19
    buffer_load_dwordx2 v[132:133], v19, s[20:23], s35 offen offset:0 sc1
    buffer_load_dwordx2 v[134:135], v19, s[20:23], s35 offen offset:16 sc1
    buffer_load_dwordx2 v[136:137], v19, s[20:23], s35 offen offset:64 sc1
    buffer_load_dwordx2 v[138:139], v19, s[20:23], s35 offen offset:80 sc1
    s_waitcnt vmcnt(0)
pc_111:
    v_max3_u32 v30, v132, v133, v134
    v_max3_u32 v30, v30, v135, v136
    v_max3_u32 v30, v30, v137, v138
    v_max_u32 v30, v30, v139
    v_cmp_eq_u32 vcc, -1, v30
    s_cbranch_vccz pd_112
    s_sub_u32 s78, s78, 1
    s_cmp_lg_u32 s78, 0
    s_cbranch_scc1 pl_110
    s_mov_b32 s27, 1
pd_112:
    v_mov_b32 v140, 0
    v_mov_b32 v141, 0
    v_mov_b32 v142, 0
    v_mov_b32 v143, 0
    v_dot2c_f32_bf16 v140, v132, v100
    v_dot2c_f32_bf16 v141, v132, v108
    v_dot2c_f32_bf16 v142, v132, v116
    v_dot2c_f32_bf16 v143, v132, v124
    v_dot2c_f32_bf16 v140, v133, v101
    v_dot2c_f32_bf16 v141, v133, v109
    v_dot2c_f32_bf16 v142, v133, v117
    v_dot2c_f32_bf16 v143, v133, v125
    v_dot2c_f32_bf16 v140, v134, v102
    v_dot2c_f32_bf16 v141, v134, v110
    v_dot2c_f32_bf16 v142, v134, v118
    v_dot2c_f32_bf16 v143, v134, v126
    v_dot2c_f32_bf16 v140, v135, v103
    v_dot2c_f32_bf16 v141, v135, v111
    v_dot2c_f32_bf16 v142, v135, v119
    v_dot2c_f32_bf16 v143, v135, v127
    v_dot2c_f32_bf16 v140, v136, v104
    v_dot2c_f32_bf16 v141, v136, v112
    v_dot2c_f32_bf16 v142, v136, v120
    v_dot2c_f32_bf16 v143, v136, v128
    v_dot2c_f32_bf16 v140, v137, v105
    v_dot2c_f32_bf16 v141, v137, v113
    v_dot2c_f32_bf16 v142, v137, v121
    v_dot2c_f32_bf16 v143, v137, v129
    v_dot2c_f32_bf16 v140, v138, v106
    v_dot2c_f32_bf16 v141, v138, v114
    v_dot2c_f32_bf16 v142, v138, v122
    v_dot2c_f32_bf16 v143, v138, v130
    v_dot2c_f32_bf16 v140, v139, v107
    v_dot2c_f32_bf16 v141, v139, v115
    v_dot2c_f32_bf16 v142, v139, v123
    v_dot2c_f32_bf16 v143, v139, v131
    s_min_u32 s32, s28, 2
    s_lshl_b32 s32, s32, 12
    s_lshl_b32 s33, s25, 14
    s_add_u32 s32, s32, s33
    s_add_u32 s32, s32, 0x1d80000
    s_lshl_b32 s33, s24, 8
    s_add_u32 s32, s32, s33
    v_lshlrev_b32 v20, 2, v252
    v_permlane32_swap_b32 v140, v142
    v_permlane32_swap_b32 v141, v143
    v_add_f32 v140, v140, v142
    v_add_f32 v141, v141, v143
    s_nop 1
    v_permlane16_swap_b32 v140, v141
    v_add_f32 v140, v140, v141
    buffer_store_dword v140, v20, s[20:23], s32 offen sc1
    s_branch l_att
l_patch:
    s_mov_b32 s78, s27
pl_113:
    s_min_u32 s32, s28, 2
    s_lshl_b32 s32, s32, 12
    s_lshl_b32 s33, s25, 14
    s_add_u32 s32, s32, s33
    s_add_u32 s32, s32, 0x1d80000
    buffer_load_dwordx4 v[56:59], v253, s[20:23], s32 offen offset:0 sc1
    buffer_load_dwordx4 v[60:63], v253, s[20:23], s32 offen offset:1024 sc1
    buffer_load_dwordx4 v[64:67], v253, s[20:23], s32 offen offset:2048 sc1
    buffer_load_dwordx4 v[68:71], v253, s[20:23], s32 offen offset:3072 sc1
    s_mov_b32 s32, 0xdc4000
    buffer_load_dwordx4 v[72:75], v253, s[20:23], s32 offen offset:0 sc1
    buffer_load_dwordx4 v[76:79], v253, s[20:23], s32 offen offset:1024 sc1
    buffer_load_dword v49, v48, s[20:23], s30 offen sc1
    s_waitcnt vmcnt(0)
pc_114:
    v_cmp_ne_u32 vcc, s88, v49
    s_ashr_i32 s34, s36, 31
    s_or_b32 s34, s34, vcc_lo
    v_max3_u32 v82, v56, v57, v58
    v_max3_u32 v82, v82, v59, v60
    v_max3_u32 v82, v82, v61, v62
    v_max3_u32 v82, v82, v63, v64
    v_max3_u32 v82, v82, v65, v66
    v_max3_u32 v82, v82, v67, v68
    v_max3_u32 v82, v82, v69, v70
    v_max3_u32 v82, v82, v71, v72
    v_max3_u32 v82, v82, v73, v74
    v_max3_u32 v82, v82, v75, v76
    v_max3_u32 v82, v82, v77, v78
    v_max_u32_e64 v82, v82, v79
    v_cmp_eq_u32 vcc, -1, v82
    s_cbranch_vccz l_zok
    s_cmp_lg_u32 s34, 0
    s_cselect_b64 vcc, -1, 0
    s_cbranch_vccz pd_115
    s_sub_u32 s78, s78, 1
    s_cmp_lg_u32 s78, 0
    s_cbranch_scc1 pl_113
    s_mov_b32 s27, 1
pd_115:
    s_cmp_lg_u32 s34, 0
    s_cbranch_scc1 l_zok
    s_min_u32 s32, s28, 2
    s_lshl_b32 s32, s32, 12
    s_lshl_b32 s33, s25, 14
    s_add_u32 s32, s32, s33
    s_add_u32 s32, s32, 0x1d80000
    buffer_load_dwordx4 v[56:59], v253, s[20:23], s32 offen offset:0 sc1
    buffer_load_dwordx4 v[60:63], v253, s[20:23], s32 offen offset:1024 sc1
    buffer_load_dwordx4 v[64:67], v253, s[20:23], s32 offen offset:2048 sc1
    buffer_load_dwordx4 v[68:71], v253, s[20:23], s32 offen offset:3072 sc1
    s_mov_b32 s32, 0xdc4000
    buffer_load_dwordx4 v[72:75], v253, s[20:23], s32 offen offset:0 sc1
    buffer_load_dwordx4 v[76:79], v253, s[20:23], s32 offen offset:1024 sc1
    s_mov_b32 s36, -1
    s_lshl_b32 s30, s28, 13
    s_add_u32 m0, s30, 65536
    s_add_u32 s31, s35, 0
    buffer_load_dwordx4 v253, s[20:23], s31 offen offset:0 sc1 lds
    buffer_load_dwordx4 v253, s[20:23], s31 offen offset:1024 sc1 lds
    buffer_load_dwordx4 v253, s[20:23], s31 offen offset:2048 sc1 lds
    buffer_load_dwordx4 v253, s[20:23], s31 offen offset:3072 sc1 lds
    s_add_u32 m0, s30, 69632
    s_add_u32 s31, s35, 4096
    buffer_load_dwordx4 v253, s[20:23], s31 offen offset:0 sc1 lds
    buffer_load_dwordx4 v253, s[20:23], s31 offen offset:1024 sc1 lds
    buffer_load_dwordx4 v253, s[20:23], s31 offen offset:2048 sc1 lds
    buffer_load_dwordx4 v253, s[20:23], s31 offen offset:3072 sc1 lds
    s_add_u32 m0, s30, 114688
    s_add_u32 s31, s35, 262144
    buffer_load_dwordx4 v253, s[20:23], s31 offen offset:0 sc1 lds
    buffer_load_dwordx4 v253, s[20:23], s31 offen offset:1024 sc1 lds
    buffer_load_dwordx4 v253, s[20:23], s31 offen offset:2048 sc1 lds
    buffer_load_dwordx4 v253, s[20:23], s31 offen offset:3072 sc1 lds
    s_add_u32 m0, s30, 118784
    s_add_u32 s31, s35, 266240
    buffer_load_dwordx4 v253, s[20:23], s31 offen offset:0 sc1 lds
    buffer_load_dwordx4 v253, s[20:23], s31 offen offset:1024 sc1 lds
    buffer_load_dwordx4 v253, s[20:23], s31 offen offset:2048 sc1 lds
    buffer_load_dwordx4 v253, s[20:23], s31 offen offset:3072 sc1 lds
    s_mov_b32 s34, -1
    s_mov_b32 s78, s27
    s_waitcnt vmcnt(16)
    s_branch pc_117
    s_nop 0
pl_116:
    s_min_u32 s32, s28, 2
    s_lshl_b32 s32, s32, 12
    s_lshl_b32 s33, s25, 14
    s_add_u32 s32, s32, s33
    s_add_u32 s32, s32, 0x1d80000
    buffer_load_dwordx4 v[56:59], v253, s[20:23], s32 offen offset:0 sc1
    buffer_load_dwordx4 v[60:63], v253, s[20:23], s32 offen offset:1024 sc1
    buffer_load_dwordx4 v[64:67], v253, s[20:23], s32 offen offset:2048 sc1
    buffer_load_dwordx4 v[68:71], v253, s[20:23], s32 offen offset:3072 sc1
    s_mov_b32 s32, 0xdc4000
    buffer_load_dwordx4 v[72:75], v253, s[20:23], s32 offen offset:0 sc1
    buffer_load_dwordx4 v[76:79], v253, s[20:23], s32 offen offset:1024 sc1
    s_waitcnt vmcnt(0)
pc_117:
    v_max3_u32 v82, v56, v57, v58
    v_max3_u32 v82, v82, v59, v60
    v_max3_u32 v82, v82, v61, v62
    v_max3_u32 v82, v82, v63, v64
    v_max3_u32 v82, v82, v65, v66
    v_max3_u32 v82, v82, v67, v68
    v_max3_u32 v82, v82, v69, v70
    v_max3_u32 v82, v82, v71, v72
    v_max3_u32 v82, v82, v73, v74
    v_max3_u32 v82, v82, v75, v76
    v_max3_u32 v82, v82, v77, v78
    v_max_u32 v82, v82, v79
    v_cmp_eq_u32 vcc, -1, v82
    s_cbranch_vccz pd_118
    s_sub_u32 s78, s78, 1
    s_cmp_lg_u32 s78, 0
    s_cbranch_scc1 pl_116
    s_mov_b32 s27, 1
pd_118:
l_zok:
    v_mov_b32 v80, 0
    v_mov_b32_e64 v81, 0
    v_dot2c_f32_bf16 v80, 0x3f803f80, v72
    v_dot2c_f32_bf16 v81, v72, v72
    v_dot2c_f32_bf16 v80, 0x3f803f80, v73
    v_dot2c_f32_bf16 v81, v73, v73
    v_dot2c_f32_bf16 v80, 0x3f803f80, v74
    v_dot2c_f32_bf16 v81, v74, v74
    v_dot2c_f32_bf16 v80, 0x3f803f80, v75
    v_dot2c_f32_bf16 v81, v75, v75
    v_dot2c_f32_bf16 v80, 0x3f803f80, v76
    v_dot2c_f32_bf16 v81, v76, v76
    v_dot2c_f32_bf16 v80, 0x3f803f80, v77
    v_dot2c_f32_bf16 v81, v77, v77
    v_dot2c_f32_bf16 v80, 0x3f803f80, v78
    v_dot2c_f32_bf16 v81, v78, v78
    v_dot2c_f32_bf16 v80, 0x3f803f80, v79
    v_dot2c_f32_bf16 v81, v79, v79
    v_pk_add_f32 v[56:57], v[56:57], v[60:61]
    v_pk_add_f32 v[58:59], v[58:59], v[62:63]
    v_pk_add_f32 v[56:57], v[56:57], v[64:65]
    v_pk_add_f32 v[58:59], v[58:59], v[66:67]
    v_pk_add_f32 v[56:57], v[56:57], v[68:69]
    v_pk_add_f32 v[58:59], v[58:59], v[70:71]
    s_nop 1
    v_permlane32_swap_b32 v56, v58
    v_permlane32_swap_b32 v57, v59
    v_add_f32 v56, v56, v58
    v_add_f32 v57, v57, v59
    s_nop 1
    v_permlane16_swap_b32 v56, v57
    v_add_f32 v56, v56, v57
    v_add_f32_dpp v80, v80, v80 quad_perm:[1,0,3,2] row_mask:0xf bank_mask:0xf
    v_add_f32_dpp v81, v81, v81 quad_perm:[1,0,3,2] row_mask:0xf bank_mask:0xf
    s_nop 0
    v_add_f32_dpp v80, v80, v80 quad_perm:[2,3,0,1] row_mask:0xf bank_mask:0xf
    v_add_f32_dpp v81, v81, v81 quad_perm:[2,3,0,1] row_mask:0xf bank_mask:0xf
    s_nop 0
    v_add_f32_dpp v80, v80, v80 row_half_mirror row_mask:0xf bank_mask:0xf
    v_add_f32_dpp v81, v81, v81 row_half_mirror row_mask:0xf bank_mask:0xf
    s_nop 0
    v_add_f32_dpp v80, v80, v80 row_mirror row_mask:0xf bank_mask:0xf
    v_add_f32_dpp v81, v81, v81 row_mirror row_mask:0xf bank_mask:0xf
    v_mov_b32 v82, v80
    v_mov_b32 v83, v81
    s_nop 0
    v_permlane16_swap_b32 v80, v82
    v_permlane16_swap_b32 v81, v83
    v_add_f32 v80, v80, v82
    v_add_f32 v81, v81, v83
    v_mov_b32 v82, v80
    v_mov_b32 v83, v81
    s_nop 0
    v_permlane32_swap_b32 v80, v82
    v_permlane32_swap_b32 v81, v83
    v_add_f32 v80, v80, v82
    v_add_f32_e64 v81, v81, v83
    v_mul_f32 v80, 0x3a800000, v80
    v_mul_f32 v81, 0x3a800000, v81
    v_fma_f32 v81, -v80, v80, v81
    v_max_f32_e64 v81, 0, v81
    v_add_f32 v81, 0x3727c5ac, v81
    v_rsq_f32_e64 v81, v81
    v_fma_f32 v56, -v80, v2, v56
    v_mul_f32_e64 v81, s37, v81
    v_mul_f32 v56, v56, v81
    v_cvt_pk_bf16_f32 v1, v56, v56
    s_cmp_lg_u32 s100, 2
    s_cbranch_scc1 sk_119
    s_cmp_lg_u32 s38, 0
    s_barrier
    s_cselect_b64 exec, -1, 0
    ds_write_b16 v0, v1
    s_mov_b64 exec, -1
    s_waitcnt lgkmcnt(0)
    s_barrier
sk_119:
    s_cmp_lg_u32 s34, 0
    s_cbranch_scc1 sk_120
    s_mov_b32 s36, -1
    s_lshl_b32 s30, s28, 13
    s_add_u32 m0, s30, 65536
    s_add_u32 s31, s35, 0
    buffer_load_dwordx4 v253, s[20:23], s31 offen offset:0 sc1 lds
    buffer_load_dwordx4 v253, s[20:23], s31 offen offset:1024 sc1 lds
    buffer_load_dwordx4 v253, s[20:23], s31 offen offset:2048 sc1 lds
    buffer_load_dwordx4 v253, s[20:23], s31 offen offset:3072 sc1 lds
    s_add_u32 m0, s30, 69632
    s_add_u32 s31, s35, 4096
    buffer_load_dwordx4 v253, s[20:23], s31 offen offset:0 sc1 lds
    buffer_load_dwordx4 v253, s[20:23], s31 offen offset:1024 sc1 lds
    buffer_load_dwordx4 v253, s[20:23], s31 offen offset:2048 sc1 lds
    buffer_load_dwordx4 v253, s[20:23], s31 offen offset:3072 sc1 lds
    s_add_u32 m0, s30, 114688
    s_add_u32 s31, s35, 262144
    buffer_load_dwordx4 v253, s[20:23], s31 offen offset:0 sc1 lds
    buffer_load_dwordx4 v253, s[20:23], s31 offen offset:1024 sc1 lds
    buffer_load_dwordx4 v253, s[20:23], s31 offen offset:2048 sc1 lds
    buffer_load_dwordx4 v253, s[20:23], s31 offen offset:3072 sc1 lds
    s_add_u32 m0, s30, 118784
    s_add_u32 s31, s35, 266240
    buffer_load_dwordx4 v253, s[20:23], s31 offen offset:0 sc1 lds
    buffer_load_dwordx4 v253, s[20:23], s31 offen offset:1024 sc1 lds
    buffer_load_dwordx4 v253, s[20:23], s31 offen offset:2048 sc1 lds
    buffer_load_dwordx4 v253, s[20:23], s31 offen offset:3072 sc1 lds
sk_120:
    s_branch l_patched
    s_nop 0
l_tail:
    v_mov_b32 v20, 0
    s_or_b32 s34, s72, s28
    s_cmp_lg_u32 s34, 0
    s_cbranch_scc1 sk_121
    s_mov_b32 s34, 0xdd8000
    v_mov_b32 v154, s88
    s_mov_b64 exec, 1
    s_waitcnt vmcnt(0)
    buffer_store_dword v154, v253, s[20:23], s34 offen sc1
    s_mov_b64 exec, -1
sk_121:
    s_barrier
    ds_read_b128 v[16:19], v20 offset:3072
    s_waitcnt lgkmcnt(0)
    v_readlane_b32 s74, v16, 0
    v_readlane_b32 s73, v17, 0
    v_readlane_b32 s75, v18, 0
    v_readlane_b32 s76, v19, 0
    s_and_b32 s73, s73, 2047
    s_mov_b32 s78, s27
pl_122:
    s_lshr_b32 s33, s73, 5
    s_lshl_b32 s33, s33, 11
    s_add_u32 s33, s33, s79
    s_add_u32 s33, s33, 0xd60000
    buffer_load_dwordx4 v[24:27], v22, s[20:23], s33 offen sc1
    s_waitcnt vmcnt(0)
pc_123:
    v_max3_u32 v30, v24, v25, v26
    v_max_u32 v30, v30, v27
    v_cmp_eq_u32 vcc, -1, v30
    s_cbranch_vccz pd_124
    s_sub_u32 s78, s78, 1
    s_cmp_lg_u32 s78, 0
    s_cbranch_scc1 pl_122
    s_mov_b32 s27, 1
pd_124:
    s_cmp_ge_u32 s29, 224
    s_cbranch_scc1 l_tred
    v_mov_b32 v28, s76
    v_mul_f32 v29, s75, v28
    v_lshlrev_b32 v30, 16, v24
    v_and_b32 v31, 0xffff0000, v24
    v_fma_f32 v30, v30, v28, -v29
    v_fma_f32 v31, v31, v28, -v29
    v_cvt_pk_bf16_f32 v24, v30, v31
    v_lshlrev_b32_e64 v30, 16, v25
    v_and_b32 v31, 0xffff0000, v25
    v_fma_f32 v30, v30, v28, -v29
    v_fma_f32 v31, v31, v28, -v29
    v_cvt_pk_bf16_f32 v25, v30, v31
    v_lshlrev_b32_e64 v30, 16, v26
    v_and_b32 v31, 0xffff0000, v26
    v_fma_f32 v30, v30, v28, -v29
    v_fma_f32 v31, v31, v28, -v29
    v_cvt_pk_bf16_f32 v26, v30, v31
    v_lshlrev_b32 v30, 16, v27
    v_and_b32 v31, 0xffff0000, v27
    v_fma_f32 v30, v30, v28, -v29
    v_fma_f32 v31, v31, v28, -v29
    v_cvt_pk_bf16_f32 v27, v30, v31
    s_bitcmp0_b32 s29, 0
    s_cbranch_scc1 sk_125
    v_swap_b32 v24, v25
    v_swap_b32 v26, v27
sk_125:
    s_bitcmp0_b32 s29, 1
    s_cbranch_scc1 sk_126
    v_swap_b32 v24, v26
    v_swap_b32 v25, v27
sk_126:
    s_cmp_ge_u32 s29, 224
    s_cbranch_scc1 sk_127
    v_dot2_f32_bf16 v32, v155, v24, 0
    v_dot2_f32_bf16 v33, v160, v24, 0
    v_dot2_f32_bf16 v34, v156, v24, 0
    v_dot2_f32_bf16 v35, v161, v24, 0
    v_dot2_f32_bf16 v36, v157, v24, 0
    v_dot2_f32_bf16 v37, v162, v24, 0
    v_dot2_f32_bf16 v38, v158, v24, 0
    v_dot2_f32_bf16 v39, v163, v24, 0
    v_dot2_f32_bf16 v40, v183, v24, 0
    v_dot2_f32_bf16 v41, v192, v24, 0
    v_dot2_f32_bf16 v42, v188, v24, 0
    v_dot2_f32_bf16 v43, v193, v24, 0
    v_dot2_f32_bf16 v44, v189, v24, 0
    v_dot2_f32_bf16 v45, v194, v24, 0
    v_dot2_f32_bf16 v46, v190, v24, 0
    v_dot2_f32_bf16 v47, v195, v24, 0
    v_dot2_f32_bf16 v32, v159, v25, v32
    v_dot2_f32_bf16 v33, v168, v25, v33
    v_dot2_f32_bf16 v34, v164, v25, v34
    v_dot2_f32_bf16 v35, v169, v25, v35
    v_dot2_f32_bf16 v36, v165, v25, v36
    v_dot2_f32_bf16 v37, v170, v25, v37
    v_dot2_f32_bf16 v38, v166, v25, v38
    v_dot2_f32_bf16 v39, v171, v25, v39
    v_dot2_f32_bf16 v40, v191, v25, v40
    v_dot2_f32_bf16 v41, v200, v25, v41
    v_dot2_f32_bf16 v42, v196, v25, v42
    v_dot2_f32_bf16 v43, v201, v25, v43
    v_dot2_f32_bf16 v44, v197, v25, v44
    v_dot2_f32_bf16 v45, v202, v25, v45
    v_dot2_f32_bf16 v46, v198, v25, v46
    v_dot2_f32_bf16 v47, v203, v25, v47
    v_dot2_f32_bf16 v32, v167, v26, v32
    v_dot2_f32_bf16 v33, v176, v26, v33
    v_dot2_f32_bf16 v34, v172, v26, v34
    v_dot2_f32_bf16 v35, v177, v26, v35
    v_dot2_f32_bf16 v36, v173, v26, v36
    v_dot2_f32_bf16 v37, v178, v26, v37
    v_dot2_f32_bf16 v38, v174, v26, v38
    v_dot2_f32_bf16 v39, v179, v26, v39
    v_dot2_f32_bf16 v40, v199, v26, v40
    v_dot2_f32_bf16 v41, v208, v26, v41
    v_dot2_f32_bf16 v42, v204, v26, v42
    v_dot2_f32_bf16 v43, v209, v26, v43
    v_dot2_f32_bf16 v44, v205, v26, v44
    v_dot2_f32_bf16 v45, v210, v26, v45
    v_dot2_f32_bf16 v46, v206, v26, v46
    v_dot2_f32_bf16 v47, v211, v26, v47
    v_dot2_f32_bf16 v32, v175, v27, v32
    v_dot2_f32_bf16 v33, v184, v27, v33
    v_dot2_f32_bf16 v34, v180, v27, v34
    v_dot2_f32_bf16 v35, v185, v27, v35
    v_dot2_f32_bf16 v36, v181, v27, v36
    v_dot2_f32_bf16 v37, v186, v27, v37
    v_dot2_f32_bf16 v38, v182, v27, v38
    v_dot2_f32_bf16 v39, v187, v27, v39
    v_dot2_f32_bf16 v40, v207, v27, v40
    v_dot2_f32_bf16 v41, v216, v27, v41
    v_dot2_f32_bf16 v42, v212, v27, v42
    v_dot2_f32_bf16 v43, v217, v27, v43
    v_dot2_f32_bf16 v44, v213, v27, v44
    v_dot2_f32_bf16 v45, v218, v27, v45
    v_dot2_f32_bf16 v46, v214, v27, v46
    v_dot2_f32_bf16 v47, v219, v27, v47
sk_127:
    v_lshrrev_b32 v31, 5, v252
    v_lshlrev_b32 v30, 6, v31
    v_permlane32_swap_b32 v32, v40
    v_permlane32_swap_b32 v33, v41
    v_permlane32_swap_b32 v34, v42
    v_permlane32_swap_b32 v35, v43
    v_permlane32_swap_b32 v36, v44
    v_permlane32_swap_b32 v37, v45
    v_permlane32_swap_b32 v38, v46
    v_permlane32_swap_b32 v39, v47
    v_add_f32 v32, v32, v40
    v_add_f32 v33, v33, v41
    v_add_f32 v34, v34, v42
    v_add_f32 v35, v35, v43
    v_add_f32 v36, v36, v44
    v_add_f32 v37, v37, v45
    v_add_f32 v38, v38, v46
    v_add_f32 v39, v39, v47
    v_and_b32_e64 v31, 1, v252
    v_lshl_add_u32 v30, v31, 5, v30
    v_permlane16_swap_b32 v32, v36
    v_permlane16_swap_b32 v33, v37
    v_permlane16_swap_b32 v34, v38
    v_permlane16_swap_b32 v35, v39
    v_add_f32 v32, v32, v36
    v_add_f32 v33, v33, v37
    v_add_f32 v34, v34, v38
    v_add_f32 v35, v35, v39
    v_and_b32 v31, 16, v252
    s_lshl_b32 s32, s28, 7
    v_add3_u32 v30, v31, v30, s32
    v_add_f32_dpp v32, v32, v32 quad_perm:[2,3,0,1] row_mask:0xf bank_mask:0xf
    v_add_f32_dpp v33, v33, v33 quad_perm:[2,3,0,1] row_mask:0xf bank_mask:0xf
    v_add_f32_dpp v34, v34, v34 quad_perm:[2,3,0,1] row_mask:0xf bank_mask:0xf
    v_add_f32_dpp v35, v35, v35 quad_perm:[2,3,0,1] row_mask:0xf bank_mask:0xf
    v_add_f32_dpp v32, v32, v32 row_ror:4 row_mask:0xf bank_mask:0xf
    v_add_f32_dpp v33, v33, v33 row_ror:4 row_mask:0xf bank_mask:0xf
    v_add_f32_dpp v34, v34, v34 row_ror:4 row_mask:0xf bank_mask:0xf
    v_add_f32_dpp v35, v35, v35 row_ror:4 row_mask:0xf bank_mask:0xf
    v_add_f32_dpp v32, v32, v32 row_ror:8 row_mask:0xf bank_mask:0xf
    v_add_f32_dpp v33, v33, v33 row_ror:8 row_mask:0xf bank_mask:0xf
    v_add_f32_dpp v34, v34, v34 row_ror:8 row_mask:0xf bank_mask:0xf
    v_add_f32_dpp v35, v35, v35 row_ror:8 row_mask:0xf bank_mask:0xf
    s_mov_b32 exec_lo, 0x00030003
    s_mov_b32 exec_hi, 0x00030003
    ds_write_b128 v30, v[32:35] offset:3328
    s_mov_b64 exec, -1
    s_waitcnt lgkmcnt(0)
    s_barrier
    v_and_b32 v30, 1, v252
    v_bfe_u32 v31, v252, 1, 3
    v_lshl_add_u32 v30, v30, 3, v31
    v_lshlrev_b32_e64 v30, 2, v30
    v_add_u32 v30, 3328, v30
    ds_read2_b32 v[32:33], v30 offset0:0 offset1:16
    ds_read2_b32 v[34:35], v30 offset0:32 offset1:48
    ds_read2_b32 v[36:37], v30 offset0:64 offset1:80
    ds_read2_b32 v[38:39], v30 offset0:96 offset1:112
    v_lshrrev_b32_e64 v30, 2, v252
    v_mul_u32_u24 v30, 7168, v30
    v_and_b32_e64 v31, 2, v252
    v_lshl_add_u32 v30, v31, 3, v30
    s_add_u32 s32, s29, 32
    s_lshr_b32 s32, s32, 8
    v_lshl_add_u32 v30, s32, 31, v30
    s_mul_i32 s32, s28, 114688
    s_mul_i32 s33, s29, 32
    s_add_u32 s32, s32, s33
    s_add_u32 s32, s32, s79
    s_add_u32 s32, s32, 0xc80000
    s_waitcnt lgkmcnt(0)
    v_pk_add_f32 v[32:33], v[32:33], v[34:35]
    v_pk_add_f32 v[36:37], v[36:37], v[38:39]
    v_pk_add_f32 v[32:33], v[32:33], v[36:37]
    v_mul_f32 v34, 0xbfb8aa3b, v32
    v_exp_f32 v34, v34
    v_mul_f32 v32, v32, v33
    v_add_f32_e64 v34, 1.0, v34
    v_rcp_f32 v34, v34
    s_nop 0
    v_mul_f32 v32, v32, v34
    s_nop 1
    v_mov_b32_dpp v33, v32 quad_perm:[2,3,2,3] row_mask:0xf bank_mask:0xf
    v_cvt_pk_bf16_f32 v32, v32, v33
    ds_swizzle_b32 v36, v32 offset:0x1
    ds_swizzle_b32 v37, v32 offset:0x81
    ds_swizzle_b32 v38, v32 offset:0x101
    ds_swizzle_b32 v39, v32 offset:0x181
    s_waitcnt lgkmcnt(0)
    s_cmp_ge_u32 s29, 224
    s_cbranch_scc1 sk_128
    v_dot2_f32_bf16 v40, v215, v36, 0
    v_dot2_f32_bf16 v41, v224, v36, 0
    v_dot2_f32_bf16 v42, v220, v36, 0
    v_dot2_f32_bf16 v43, v225, v36, 0
    v_dot2_f32_bf16 v44, v221, v36, 0
    v_dot2_f32_bf16 v45, v226, v36, 0
    v_dot2_f32_bf16 v46, v222, v36, 0
    v_dot2_f32_bf16 v47, v227, v36, 0
    v_dot2_f32_bf16 v40, v223, v37, v40
    v_dot2_f32_bf16 v41, v232, v37, v41
    v_dot2_f32_bf16 v42, v228, v37, v42
    v_dot2_f32_bf16 v43, v233, v37, v43
    v_dot2_f32_bf16 v44, v229, v37, v44
    v_dot2_f32_bf16 v45, v234, v37, v45
    v_dot2_f32_bf16 v46, v230, v37, v46
    v_dot2_f32_bf16 v47, v235, v37, v47
    v_dot2_f32_bf16 v40, v231, v38, v40
    v_dot2_f32_bf16 v41, v240, v38, v41
    v_dot2_f32_bf16 v42, v236, v38, v42
    v_dot2_f32_bf16 v43, v241, v38, v43
    v_dot2_f32_bf16 v44, v237, v38, v44
    v_dot2_f32_bf16 v45, v242, v38, v45
    v_dot2_f32_bf16 v46, v238, v38, v46
    v_dot2_f32_bf16 v47, v243, v38, v47
    v_dot2_f32_bf16 v40, v239, v39, v40
    v_dot2_f32_bf16 v41, v248, v39, v41
    v_dot2_f32_bf16 v42, v244, v39, v42
    v_dot2_f32_bf16 v43, v249, v39, v43
    v_dot2_f32_bf16 v44, v245, v39, v44
    v_dot2_f32_bf16 v45, v250, v39, v45
    v_dot2_f32_bf16 v46, v246, v39, v46
    v_dot2_f32_bf16 v47, v251, v39, v47
sk_128:
    v_add_f32_dpp v40, v40, v40 quad_perm:[1,0,3,2] row_mask:0xf bank_mask:0xf
    v_add_f32_dpp v41, v41, v41 quad_perm:[1,0,3,2] row_mask:0xf bank_mask:0xf
    v_add_f32_dpp v42, v42, v42 quad_perm:[1,0,3,2] row_mask:0xf bank_mask:0xf
    v_add_f32_dpp v43, v43, v43 quad_perm:[1,0,3,2] row_mask:0xf bank_mask:0xf
    v_add_f32_dpp v44, v44, v44 quad_perm:[1,0,3,2] row_mask:0xf bank_mask:0xf
    v_add_f32_dpp v45, v45, v45 quad_perm:[1,0,3,2] row_mask:0xf bank_mask:0xf
    v_add_f32_dpp v46, v46, v46 quad_perm:[1,0,3,2] row_mask:0xf bank_mask:0xf
    v_add_f32_dpp v47, v47, v47 quad_perm:[1,0,3,2] row_mask:0xf bank_mask:0xf
    s_mov_b32 exec_lo, 0x55555555
    s_mov_b32 exec_hi, 0x55555555
    v_cvt_pk_bf16_f32 v40, v40, v41
    v_cvt_pk_bf16_f32 v41, v42, v43
    v_cvt_pk_bf16_f32 v42, v44, v45
    v_cvt_pk_bf16_f32 v43, v46, v47
    buffer_store_dwordx4 v[40:43], v30, s[20:23], s32 offen sc1
    s_mov_b64 exec, -1
    s_branch k_end
    s_nop 0
l_tred:
    s_cmp_lt_i32 s89, 0
    s_cbranch_scc1 k_end
    v_and_b32 v30, 16, v252
    v_cmp_eq_u32 vcc, 16, v30
    v_mov_b32 v28, s76
    v_mul_f32 v29, s75, v28
    v_add_f32 v28, 1.0, v28
    v_cndmask_b32 v30, v24, v25, vcc
    v_cndmask_b32 v31, v26, v27, vcc
    s_mov_b32 vcc_lo, 0xaaaaaaaa
    s_mov_b32 vcc_hi, 0xaaaaaaaa
    v_mov_b32 v96, 0xbfb8aa3b
    v_mul_f32 v96, s74, v96
    v_exp_f32 v96, v96
    v_cndmask_b32 v30, v30, v31, vcc
    v_lshlrev_b32 v92, 16, v30
    v_and_b32 v93, 0xffff0000, v30
    v_fma_f32 v92, v92, v28, -v29
    v_fma_f32 v93, v93, v28, -v29
    v_add_f32_e64 v96, 1.0, v96
    v_rcp_f32 v96, v96
    s_lshl_b32 s34, s73, 11
    s_lshl_b32 s33, s89, 4
    s_add_u32 s34, s34, s33
    s_mov_b32 s78, s27
pl_129:
    s_mul_i32 s32, s89, 3584
    s_add_u32 s32, s32, s79
    s_add_u32 s32, s32, 0xc80000
    buffer_load_dwordx4 v[60:63], v253, s[20:23], s32 offen offset:0 sc1
    buffer_load_dwordx4 v[64:67], v253, s[20:23], s32 offen offset:1024 sc1
    buffer_load_dwordx4 v[68:71], v253, s[20:23], s32 offen offset:2048 sc1
    buffer_load_dwordx4 v[72:75], v253, s[20:23], s32 offen offset:3072 sc1
    s_add_u32 s32, s32, 4096
    buffer_load_dwordx4 v[76:79], v253, s[20:23], s32 offen offset:0 sc1
    buffer_load_dwordx4 v[80:83], v253, s[20:23], s32 offen offset:1024 sc1
    buffer_load_dwordx4 v[84:87], v253, s[20:23], s32 offen offset:2048 sc1
    s_waitcnt vmcnt(0)
pc_130:
    v_max3_u32 v30, v60, v64, v68
    v_max3_u32 v30, v30, v72, v76
    v_max3_u32 v30, v30, v80, v84
    v_cmp_eq_u32 vcc, -1, v30
    s_cbranch_vccz pd_131
    s_sub_u32 s78, s78, 1
    s_cmp_lg_u32 s78, 0
    s_cbranch_scc1 pl_129
    s_mov_b32 s27, 1
pd_131:
    v_lshlrev_b32 v24, 16, v60
    v_and_b32 v25, 0xffff0000, v60
    v_lshlrev_b32_e64 v26, 16, v61
    v_and_b32 v27, 0xffff0000, v61
    v_lshlrev_b32_e64 v28, 16, v62
    v_and_b32 v29, 0xffff0000, v62
    v_lshlrev_b32_e64 v30, 16, v63
    v_and_b32 v31, 0xffff0000, v63
    v_lshlrev_b32_e64 v88, 16, v64
    v_and_b32 v89, 0xffff0000, v64
    v_lshlrev_b32_e64 v90, 16, v65
    v_and_b32 v91, 0xffff0000, v65
    v_pk_add_f32 v[24:25], v[24:25], v[88:89]
    v_pk_add_f32 v[26:27], v[26:27], v[90:91]
    v_lshlrev_b32_e64 v88, 16, v66
    v_and_b32 v89, 0xffff0000, v66
    v_lshlrev_b32_e64 v90, 16, v67
    v_and_b32 v91, 0xffff0000, v67
    v_pk_add_f32 v[28:29], v[28:29], v[88:89]
    v_pk_add_f32 v[30:31], v[30:31], v[90:91]
    v_lshlrev_b32_e64 v88, 16, v68
    v_and_b32 v89, 0xffff0000, v68
    v_lshlrev_b32_e64 v90, 16, v69
    v_and_b32 v91, 0xffff0000, v69
    v_pk_add_f32 v[24:25], v[24:25], v[88:89]
    v_pk_add_f32 v[26:27], v[26:27], v[90:91]
    v_lshlrev_b32_e64 v88, 16, v70
    v_and_b32 v89, 0xffff0000, v70
    v_lshlrev_b32_e64 v90, 16, v71
    v_and_b32 v91, 0xffff0000, v71
    v_pk_add_f32 v[28:29], v[28:29], v[88:89]
    v_pk_add_f32 v[30:31], v[30:31], v[90:91]
    v_lshlrev_b32_e64 v88, 16, v72
    v_and_b32 v89, 0xffff0000, v72
    v_lshlrev_b32_e64 v90, 16, v73
    v_and_b32 v91, 0xffff0000, v73
    v_pk_add_f32 v[24:25], v[24:25], v[88:89]
    v_pk_add_f32 v[26:27], v[26:27], v[90:91]
    v_lshlrev_b32_e64 v88, 16, v74
    v_and_b32 v89, 0xffff0000, v74
    v_lshlrev_b32_e64 v90, 16, v75
    v_and_b32 v91, 0xffff0000, v75
    v_pk_add_f32 v[28:29], v[28:29], v[88:89]
    v_pk_add_f32 v[30:31], v[30:31], v[90:91]
    v_lshlrev_b32_e64 v88, 16, v76
    v_and_b32 v89, 0xffff0000, v76
    v_lshlrev_b32_e64 v90, 16, v77
    v_and_b32 v91, 0xffff0000, v77
    v_pk_add_f32 v[24:25], v[24:25], v[88:89]
    v_pk_add_f32 v[26:27], v[26:27], v[90:91]
    v_lshlrev_b32_e64 v88, 16, v78
    v_and_b32 v89, 0xffff0000, v78
    v_lshlrev_b32_e64 v90, 16, v79
    v_and_b32 v91, 0xffff0000, v79
    v_pk_add_f32 v[28:29], v[28:29], v[88:89]
    v_pk_add_f32 v[30:31], v[30:31], v[90:91]
    v_lshlrev_b32_e64 v88, 16, v80
    v_and_b32 v89, 0xffff0000, v80
    v_lshlrev_b32_e64 v90, 16, v81
    v_and_b32 v91, 0xffff0000, v81
    v_pk_add_f32 v[24:25], v[24:25], v[88:89]
    v_pk_add_f32 v[26:27], v[26:27], v[90:91]
    v_lshlrev_b32_e64 v88, 16, v82
    v_and_b32 v89, 0xffff0000, v82
    v_lshlrev_b32_e64 v90, 16, v83
    v_and_b32 v91, 0xffff0000, v83
    v_pk_add_f32 v[28:29], v[28:29], v[88:89]
    v_pk_add_f32 v[30:31], v[30:31], v[90:91]
    v_lshlrev_b32_e64 v88, 16, v84
    v_and_b32 v89, 0xffff0000, v84
    v_lshlrev_b32_e64 v90, 16, v85
    v_and_b32 v91, 0xffff0000, v85
    v_pk_add_f32 v[24:25], v[24:25], v[88:89]
    v_pk_add_f32 v[26:27], v[26:27], v[90:91]
    v_lshlrev_b32_e64 v88, 16, v86
    v_and_b32 v89, 0xffff0000, v86
    v_lshlrev_b32_e64 v90, 16, v87
    v_and_b32 v91, 0xffff0000, v87
    v_pk_add_f32 v[28:29], v[28:29], v[88:89]
    v_pk_add_f32 v[30:31], v[30:31], v[90:91]
    s_nop 0
    v_permlane32_swap_b32 v24, v28
    v_permlane32_swap_b32 v25, v29
    v_permlane32_swap_b32 v26, v30
    v_permlane32_swap_b32 v27, v31
    v_add_f32 v24, v24, v28
    v_add_f32 v25, v25, v29
    v_add_f32 v26, v26, v30
    v_add_f32 v27, v27, v31
    s_nop 0
    v_permlane16_swap_b32 v24, v26
    v_permlane16_swap_b32 v25, v27
    v_add_f32_e64 v24, v24, v26
    v_add_f32 v25, v25, v27
    s_nop 0
    v_add_f32_dpp v24, v24, v24 quad_perm:[2,3,0,1] row_mask:0xf bank_mask:0xf
    v_add_f32_dpp v25, v25, v25 quad_perm:[2,3,0,1] row_mask:0xf bank_mask:0xf
    s_nop 0
    v_add_f32_dpp v24, v24, v24 row_ror:4 row_mask:0xf bank_mask:0xf
    v_add_f32_dpp v25, v25, v25 row_ror:4 row_mask:0xf bank_mask:0xf
    s_nop 0
    v_add_f32_dpp v24, v24, v24 row_ror:8 row_mask:0xf bank_mask:0xf
    v_add_f32_dpp v25, v25, v25 row_ror:8 row_mask:0xf bank_mask:0xf
    v_fma_f32 v28, v24, v96, v92
    v_fma_f32 v29, v25, v96, v93
    v_cvt_pk_bf16_f32 v24, v28, v29
    v_cvt_pk_bf16_f32 v25, v28, v29
    v_cvt_pk_bf16_f32 v26, v28, v29
    v_cvt_pk_bf16_f32 v27, v28, v29
    v_permlane16_swap_b32 v24, v25
    s_nop 0
    v_permlane16_swap_b32 v26, v27
    s_nop 1
    v_permlane32_swap_b32_e64 v24, v26
    v_permlane32_swap_b32 v25, v27
    s_mov_b64 exec, 3
    buffer_store_dwordx4 v[24:27], v253, s[12:15], s34 offen sc1
    s_mov_b64 exec, -1
k_end:
k_exit:
    s_endpgm
    s_nop 0
att_exact0:
    s_waitcnt lgkmcnt(0)
    v_mov_b32 v20, 0xffff
    v_mov_b32 v21, 0xffff0000
    v_cndmask_b32 v22, 0, v20, s[40:41]
    v_cndmask_b32 v23, 0, v21, s[42:43]
    v_or_b32_e64 v12, v22, v23
    v_cndmask_b32 v22, 0, v20, s[44:45]
    v_cndmask_b32 v23, 0, v21, s[46:47]
    v_or_b32_e64 v13, v22, v23
    v_cndmask_b32 v22, 0, v20, s[48:49]
    v_cndmask_b32 v23, 0, v21, s[50:51]
    v_or_b32_e64 v14, v22, v23
    v_cndmask_b32 v22, 0, v20, s[52:53]
    v_cndmask_b32 v23, 0, v21, s[54:55]
    v_or_b32_e64 v15, v22, v23
    v_cndmask_b32 v22, 0, v20, s[56:57]
    v_cndmask_b32 v23, 0, v21, s[58:59]
    v_or_b32_e64 v16, v22, v23
    v_cndmask_b32 v22, 0, v20, s[60:61]
    v_cndmask_b32 v23, 0, v21, s[62:63]
    v_or_b32_e64 v17, v22, v23
    v_cndmask_b32 v22, 0, v20, s[64:65]
    v_cndmask_b32 v23, 0, v21, s[66:67]
    v_or_b32_e64 v18, v22, v23
    v_cndmask_b32 v22, 0, v20, s[68:69]
    v_cndmask_b32 v23, 0, v21, s[70:71]
    v_or_b32_e64 v19, v22, v23
    s_and_b32 s34, s76, 3
    s_lshl_b32 s33, s34, 12
    s_add_u32 s33, s33, 65536
    v_add_u32 v20, s33, v253
    v_mov_b32 v24, 0
    v_mov_b32 v25, 0
    v_mov_b32 v26, 0
    v_mov_b32 v27, 0
    v_mov_b32 v28, 0
    v_mov_b32 v29, 0
    v_mov_b32 v30, 0
    v_mov_b32 v31, 0
    v_mov_b32 v32, 0
    v_mov_b32 v33, 0
    v_mov_b32 v34, 0
    v_mov_b32 v35, 0
    v_mov_b32 v36, 0
    v_mov_b32 v37, 0
    v_mov_b32 v38, 0
    v_mov_b32 v39, 0
    ds_read_b128 v[104:107], v20 offset:32768
    ds_read_b128 v[108:111], v20 offset:33792
    ds_read_b128 v[112:115], v20 offset:28672
    ds_read_b128 v[116:119], v20 offset:29696
    s_waitcnt lgkmcnt(2)
    v_mfma_f32_32x32x16_bf16 v[40:55], v[104:107], v[4:7], 0
    v_mfma_f32_32x32x16_bf16 v[40:55], v[108:111], v[8:11], v[40:55]
    ds_read_b128 v[104:107], v20 offset:24576
    ds_read_b128 v[108:111], v20 offset:25600
    s_cmp_eq_u32 s76, 0
    s_cbranch_scc0 ng_132
    v_mov_b32 v24, 0xf149f2ca
    v_mov_b32 v25, 0xf149f2ca
    v_mov_b32 v26, 0xf149f2ca
    v_mov_b32 v27, 0xf149f2ca
    v_mov_b32 v28, 0xf149f2ca
    v_mov_b32 v29, 0xf149f2ca
    v_mov_b32 v30, 0xf149f2ca
    v_mov_b32 v31, 0xf149f2ca
    v_mov_b32 v32, 0xf149f2ca
    v_mov_b32 v33, 0xf149f2ca
    v_mov_b32 v34, 0xf149f2ca
    v_mov_b32 v35, 0xf149f2ca
    v_mov_b32 v36, 0xf149f2ca
    v_mov_b32 v37, 0xf149f2ca
    v_mov_b32 v38, 0xf149f2ca
    v_mov_b32 v39, 0xf149f2ca
ng_132:
    s_waitcnt lgkmcnt(2)
    s_nop 0
    v_mfma_f32_32x32x16_bf16 v[72:87], v[112:115], v[4:7], v[24:39]
    v_mfma_f32_32x32x16_bf16 v[72:87], v[116:119], v[8:11], v[72:87]
    ds_read_b128 v[112:115], v20 offset:20480
    ds_read_b128 v[116:119], v20 offset:21504
    s_cmp_eq_u32 s76, 1
    s_cbranch_scc0 ng_133
    s_nop 1
    v_mov_b32 v24, 0xf149f2ca
    v_mov_b32 v25, 0xf149f2ca
    v_mov_b32 v26, 0xf149f2ca
    v_mov_b32 v27, 0xf149f2ca
    v_mov_b32 v28, 0xf149f2ca
    v_mov_b32 v29, 0xf149f2ca
    v_mov_b32 v30, 0xf149f2ca
    v_mov_b32 v31, 0xf149f2ca
    v_mov_b32 v32, 0xf149f2ca
    v_mov_b32 v33, 0xf149f2ca
    v_mov_b32 v34, 0xf149f2ca
    v_mov_b32 v35, 0xf149f2ca
    v_mov_b32 v36, 0xf149f2ca
    v_mov_b32 v37, 0xf149f2ca
    v_mov_b32 v38, 0xf149f2ca
    v_mov_b32 v39, 0xf149f2ca
ng_133:
    s_waitcnt lgkmcnt(2)
    s_nop 0
    v_mfma_f32_32x32x16_bf16 v[56:71], v[104:107], v[4:7], v[24:39]
    v_mfma_f32_32x32x16_bf16 v[56:71], v[108:111], v[8:11], v[56:71]
    s_nop 3
    v_max_f32_e64 v21, v72, v73
    v_max3_f32 v21, v21, v74, v75
    v_max3_f32 v21, v21, v76, v77
    v_max3_f32 v21, v21, v78, v79
    v_max3_f32 v21, v21, v80, v81
    v_max3_f32 v21, v21, v82, v83
    v_max3_f32 v21, v21, v84, v85
    v_max3_f32 v21, v21, v86, v87
    ds_read_b128 v[104:107], v20 offset:16384
    ds_read_b128 v[108:111], v20 offset:17408
    s_cmp_eq_u32 s76, 2
    s_cbranch_scc0 ng_134
    v_mov_b32 v24, 0xf149f2ca
    v_mov_b32 v25, 0xf149f2ca
    v_mov_b32 v26, 0xf149f2ca
    v_mov_b32 v27, 0xf149f2ca
    v_mov_b32 v28, 0xf149f2ca
    v_mov_b32 v29, 0xf149f2ca
    v_mov_b32 v30, 0xf149f2ca
    v_mov_b32 v31, 0xf149f2ca
    v_mov_b32 v32, 0xf149f2ca
    v_mov_b32 v33, 0xf149f2ca
    v_mov_b32 v34, 0xf149f2ca
    v_mov_b32 v35, 0xf149f2ca
    v_mov_b32 v36, 0xf149f2ca
    v_mov_b32 v37, 0xf149f2ca
    v_mov_b32 v38, 0xf149f2ca
    v_mov_b32 v39, 0xf149f2ca
ng_134:
    s_waitcnt lgkmcnt(2)
    s_nop 0
    v_mfma_f32_32x32x16_bf16 v[72:87], v[112:115], v[4:7], v[24:39]
    v_mfma_f32_32x32x16_bf16 v[72:87], v[116:119], v[8:11], v[72:87]
    v_max3_f32 v21, v21, v56, v57
    v_max3_f32 v21, v21, v58, v59
    v_max3_f32 v21, v21, v60, v61
    v_max3_f32 v21, v21, v62, v63
    v_max3_f32 v21, v21, v64, v65
    v_max3_f32 v21, v21, v66, v67
    v_max3_f32 v21, v21, v68, v69
    v_max3_f32 v21, v21, v70, v71
    ds_read_b128 v[112:115], v20 offset:12288
    ds_read_b128 v[116:119], v20 offset:13312
    s_cmp_eq_u32 s76, 3
    s_cbranch_scc0 ng_135
    v_mov_b32 v24, 0xf149f2ca
    v_mov_b32 v25, 0xf149f2ca
    v_mov_b32 v26, 0xf149f2ca
    v_mov_b32 v27, 0xf149f2ca
    v_mov_b32 v28, 0xf149f2ca
    v_mov_b32 v29, 0xf149f2ca
    v_mov_b32 v30, 0xf149f2ca
    v_mov_b32 v31, 0xf149f2ca
    v_mov_b32 v32, 0xf149f2ca
    v_mov_b32 v33, 0xf149f2ca
    v_mov_b32 v34, 0xf149f2ca
    v_mov_b32 v35, 0xf149f2ca
    v_mov_b32 v36, 0xf149f2ca
    v_mov_b32 v37, 0xf149f2ca
    v_mov_b32 v38, 0xf149f2ca
    v_mov_b32 v39, 0xf149f2ca
ng_135:
    s_waitcnt lgkmcnt(2)
    s_nop 0
    v_mfma_f32_32x32x16_bf16 v[56:71], v[104:107], v[4:7], v[24:39]
    v_mfma_f32_32x32x16_bf16 v[56:71], v[108:111], v[8:11], v[56:71]
    v_max3_f32 v21, v21, v72, v73
    v_max3_f32 v21, v21, v74, v75
    v_max3_f32 v21, v21, v76, v77
    v_max3_f32 v21, v21, v78, v79
    v_max3_f32 v21, v21, v80, v81
    v_max3_f32 v21, v21, v82, v83
    v_max3_f32 v21, v21, v84, v85
    v_max3_f32 v21, v21, v86, v87
    ds_read_b128 v[104:107], v20 offset:8192
    ds_read_b128 v[108:111], v20 offset:9216
    s_cmp_eq_u32 s76, 4
    s_cbranch_scc0 ng_136
    v_mov_b32 v24, 0xf149f2ca
    v_mov_b32 v25, 0xf149f2ca
    v_mov_b32 v26, 0xf149f2ca
    v_mov_b32 v27, 0xf149f2ca
    v_mov_b32 v28, 0xf149f2ca
    v_mov_b32 v29, 0xf149f2ca
    v_mov_b32 v30, 0xf149f2ca
    v_mov_b32 v31, 0xf149f2ca
    v_mov_b32 v32, 0xf149f2ca
    v_mov_b32 v33, 0xf149f2ca
    v_mov_b32 v34, 0xf149f2ca
    v_mov_b32 v35, 0xf149f2ca
    v_mov_b32 v36, 0xf149f2ca
    v_mov_b32 v37, 0xf149f2ca
    v_mov_b32 v38, 0xf149f2ca
    v_mov_b32 v39, 0xf149f2ca
ng_136:
    s_waitcnt lgkmcnt(2)
    s_nop 0
    v_mfma_f32_32x32x16_bf16 v[72:87], v[112:115], v[4:7], v[24:39]
    v_mfma_f32_32x32x16_bf16 v[72:87], v[116:119], v[8:11], v[72:87]
    v_max3_f32 v21, v21, v56, v57
    v_max3_f32 v21, v21, v58, v59
    v_max3_f32 v21, v21, v60, v61
    v_max3_f32 v21, v21, v62, v63
    v_max3_f32 v21, v21, v64, v65
    v_max3_f32 v21, v21, v66, v67
    v_max3_f32 v21, v21, v68, v69
    v_max3_f32 v21, v21, v70, v71
    ds_read_b128 v[112:115], v20 offset:4096
    ds_read_b128 v[116:119], v20 offset:5120
    s_cmp_eq_u32 s76, 5
    s_cbranch_scc0 ng_137
    v_mov_b32 v24, 0xf149f2ca
    v_mov_b32 v25, 0xf149f2ca
    v_mov_b32 v26, 0xf149f2ca
    v_mov_b32 v27, 0xf149f2ca
    v_mov_b32 v28, 0xf149f2ca
    v_mov_b32 v29, 0xf149f2ca
    v_mov_b32 v30, 0xf149f2ca
    v_mov_b32 v31, 0xf149f2ca
    v_mov_b32 v32, 0xf149f2ca
    v_mov_b32 v33, 0xf149f2ca
    v_mov_b32 v34, 0xf149f2ca
    v_mov_b32 v35, 0xf149f2ca
    v_mov_b32 v36, 0xf149f2ca
    v_mov_b32 v37, 0xf149f2ca
    v_mov_b32 v38, 0xf149f2ca
    v_mov_b32 v39, 0xf149f2ca
ng_137:
    s_waitcnt lgkmcnt(2)
    s_nop 0
    v_mfma_f32_32x32x16_bf16 v[56:71], v[104:107], v[4:7], v[24:39]
    v_mfma_f32_32x32x16_bf16 v[56:71], v[108:111], v[8:11], v[56:71]
    v_max3_f32 v21, v21, v72, v73
    v_max3_f32 v21, v21, v74, v75
    v_max3_f32 v21, v21, v76, v77
    v_max3_f32 v21, v21, v78, v79
    v_max3_f32 v21, v21, v80, v81
    v_max3_f32 v21, v21, v82, v83
    v_max3_f32 v21, v21, v84, v85
    v_max3_f32 v21, v21, v86, v87
    ds_read_b128 v[104:107], v20 offset:0
    ds_read_b128 v[108:111], v20 offset:1024
    s_cmp_eq_u32 s76, 6
    s_cbranch_scc0 ng_138
    v_mov_b32 v24, 0xf149f2ca
    v_mov_b32 v25, 0xf149f2ca
    v_mov_b32 v26, 0xf149f2ca
    v_mov_b32 v27, 0xf149f2ca
    v_mov_b32 v28, 0xf149f2ca
    v_mov_b32 v29, 0xf149f2ca
    v_mov_b32 v30, 0xf149f2ca
    v_mov_b32 v31, 0xf149f2ca
    v_mov_b32 v32, 0xf149f2ca
    v_mov_b32 v33, 0xf149f2ca
    v_mov_b32 v34, 0xf149f2ca
    v_mov_b32 v35, 0xf149f2ca
    v_mov_b32 v36, 0xf149f2ca
    v_mov_b32 v37, 0xf149f2ca
    v_mov_b32 v38, 0xf149f2ca
    v_mov_b32 v39, 0xf149f2ca
ng_138:
    s_waitcnt lgkmcnt(2)
    s_nop 0
    v_mfma_f32_32x32x16_bf16 v[72:87], v[112:115], v[4:7], v[24:39]
    v_mfma_f32_32x32x16_bf16 v[72:87], v[116:119], v[8:11], v[72:87]
    v_max3_f32 v21, v21, v56, v57
    v_max3_f32 v21, v21, v58, v59
    v_max3_f32 v21, v21, v60, v61
    v_max3_f32 v21, v21, v62, v63
    v_max3_f32 v21, v21, v64, v65
    v_max3_f32 v21, v21, v66, v67
    v_max3_f32 v21, v21, v68, v69
    v_max3_f32 v21, v21, v70, v71
    s_cmp_eq_u32 s76, 7
    s_cbranch_scc0 ng_139
    v_mov_b32 v24, 0xf149f2ca
    v_mov_b32 v25, 0xf149f2ca
    v_mov_b32 v26, 0xf149f2ca
    v_mov_b32 v27, 0xf149f2ca
    v_mov_b32 v28, 0xf149f2ca
    v_mov_b32 v29, 0xf149f2ca
    v_mov_b32 v30, 0xf149f2ca
    v_mov_b32 v31, 0xf149f2ca
    v_mov_b32 v32, 0xf149f2ca
    v_mov_b32 v33, 0xf149f2ca
    v_mov_b32 v34, 0xf149f2ca
    v_mov_b32 v35, 0xf149f2ca
    v_mov_b32 v36, 0xf149f2ca
    v_mov_b32 v37, 0xf149f2ca
    v_mov_b32 v38, 0xf149f2ca
    v_mov_b32 v39, 0xf149f2ca
ng_139:
    s_waitcnt lgkmcnt(0)
    s_nop 0
    v_mfma_f32_32x32x16_bf16 v[56:71], v[104:107], v[4:7], v[24:39]
    v_mfma_f32_32x32x16_bf16 v[56:71], v[108:111], v[8:11], v[56:71]
    v_max3_f32 v21, v21, v72, v73
    v_max3_f32 v21, v21, v74, v75
    v_max3_f32 v21, v21, v76, v77
    v_max3_f32 v21, v21, v78, v79
    v_max3_f32 v21, v21, v80, v81
    v_max3_f32 v21, v21, v82, v83
    v_max3_f32 v21, v21, v84, v85
    v_max3_f32 v21, v21, v86, v87
    ds_read_b128 v[112:115], v20 offset:28672
    ds_read_b128 v[116:119], v20 offset:29696
    ds_read_b128 v[120:123], v20 offset:34816
    ds_read_b128 v[124:127], v20 offset:35840
    ds_read_b128 v[128:131], v20 offset:2048
    ds_read_b128 v[132:135], v20 offset:3072
    v_cndmask_b32 v40, v56, v40, s[40:41]
    v_cndmask_b32 v41, v57, v41, s[42:43]
    v_cndmask_b32 v42, v58, v42, s[44:45]
    v_cndmask_b32 v43, v59, v43, s[46:47]
    v_cndmask_b32 v44, v60, v44, s[48:49]
    v_cndmask_b32 v45, v61, v45, s[50:51]
    v_cndmask_b32 v46, v62, v46, s[52:53]
    v_cndmask_b32 v47, v63, v47, s[54:55]
    v_cndmask_b32 v48, v64, v48, s[56:57]
    v_cndmask_b32 v49, v65, v49, s[58:59]
    v_cndmask_b32 v50, v66, v50, s[60:61]
    v_cndmask_b32 v51, v67, v51, s[62:63]
    v_cndmask_b32 v52, v68, v52, s[64:65]
    v_cndmask_b32 v53, v69, v53, s[66:67]
    v_cndmask_b32 v54, v70, v54, s[68:69]
    v_cndmask_b32 v55, v71, v55, s[70:71]
    v_max3_f32 v21, v21, v40, v41
    v_max3_f32 v21, v21, v42, v43
    v_max3_f32 v21, v21, v44, v45
    v_max3_f32 v21, v21, v46, v47
    v_max3_f32 v21, v21, v48, v49
    v_max3_f32 v21, v21, v50, v51
    v_max3_f32 v21, v21, v52, v53
    v_max3_f32 v21, v21, v54, v55
    v_mov_b32 v152, v21
    s_nop 1
    v_permlane32_swap_b32 v21, v152
    v_max_f32 v21, v21, v152
    v_sub_f32 v24, 0, v21
    v_sub_f32 v25, 0, v21
    v_sub_f32 v26, 0, v21
    v_sub_f32 v27, 0, v21
    v_sub_f32 v28, 0, v21
    v_sub_f32 v29, 0, v21
    v_sub_f32 v30, 0, v21
    v_sub_f32 v31, 0, v21
    v_sub_f32 v32, 0, v21
    v_sub_f32 v33, 0, v21
    v_sub_f32 v34, 0, v21
    v_sub_f32 v35, 0, v21
    v_sub_f32 v36, 0, v21
    v_sub_f32 v37, 0, v21
    v_sub_f32 v38, 0, v21
    v_sub_f32 v39, 0, v21
    s_cmp_eq_u32 s76, 0
    s_cbranch_scc0 ng_140
    v_mov_b32 v24, 0xf149f2ca
    v_mov_b32 v25, 0xf149f2ca
    v_mov_b32 v26, 0xf149f2ca
    v_mov_b32 v27, 0xf149f2ca
    v_mov_b32 v28, 0xf149f2ca
    v_mov_b32 v29, 0xf149f2ca
    v_mov_b32 v30, 0xf149f2ca
    v_mov_b32 v31, 0xf149f2ca
    v_mov_b32 v32, 0xf149f2ca
    v_mov_b32 v33, 0xf149f2ca
    v_mov_b32 v34, 0xf149f2ca
    v_mov_b32 v35, 0xf149f2ca
    v_mov_b32 v36, 0xf149f2ca
    v_mov_b32 v37, 0xf149f2ca
    v_mov_b32 v38, 0xf149f2ca
    v_mov_b32 v39, 0xf149f2ca
ng_140:
    s_waitcnt lgkmcnt(4)
    s_nop 0
    v_mfma_f32_32x32x16_bf16 v[72:87], v[112:115], v[4:7], v[24:39]
    v_mfma_f32_32x32x16_bf16 v[72:87], v[116:119], v[8:11], v[72:87]
    ds_read_b128 v[104:107], v20 offset:24576
    ds_read_b128 v[108:111], v20 offset:25600
    v_sub_f32 v40, v40, v21
    v_sub_f32 v41, v41, v21
    v_sub_f32 v42, v42, v21
    v_sub_f32 v43, v43, v21
    v_sub_f32 v44, v44, v21
    v_sub_f32 v45, v45, v21
    v_sub_f32 v46, v46, v21
    v_sub_f32 v47, v47, v21
    v_sub_f32 v48, v48, v21
    v_sub_f32 v49, v49, v21
    v_sub_f32 v50, v50, v21
    v_sub_f32 v51, v51, v21
    v_sub_f32 v52, v52, v21
    v_sub_f32 v53, v53, v21
    v_sub_f32 v54, v54, v21
    v_sub_f32 v55, v55, v21
    v_exp_f32 v40, v40
    v_exp_f32 v41, v41
    v_exp_f32 v42, v42
    v_exp_f32 v43, v43
    v_exp_f32 v44, v44
    v_exp_f32 v45, v45
    v_exp_f32 v46, v46
    v_exp_f32 v47, v47
    v_exp_f32 v48, v48
    v_exp_f32 v49, v49
    v_exp_f32 v50, v50
    v_exp_f32 v51, v51
    v_exp_f32 v52, v52
    v_exp_f32 v53, v53
    v_exp_f32 v54, v54
    v_exp_f32 v55, v55
    v_add_f32 v22, v40, v41
    v_add_f32 v23, v42, v43
    v_add_f32 v22, v22, v44
    v_add_f32 v23, v23, v45
    v_add_f32 v22, v22, v46
    v_add_f32 v23, v23, v47
    v_add_f32 v22, v22, v48
    v_add_f32 v23, v23, v49
    v_add_f32 v22, v22, v50
    v_add_f32 v23, v23, v51
    v_add_f32 v22, v22, v52
    v_add_f32 v23, v23, v53
    v_add_f32 v22, v22, v54
    v_add_f32 v23, v23, v55
    v_cvt_pk_bf16_f32 v144, v40, v41
    v_cvt_pk_bf16_f32 v145, v42, v43
    v_cvt_pk_bf16_f32 v146, v44, v45
    v_cvt_pk_bf16_f32 v147, v46, v47
    v_cvt_pk_bf16_f32 v148, v48, v49
    v_cvt_pk_bf16_f32 v149, v50, v51
    v_cvt_pk_bf16_f32 v150, v52, v53
    v_cvt_pk_bf16_f32 v151, v54, v55
    v_and_b32 v136, v144, v12
    v_and_b32 v137, v145, v13
    v_and_b32 v138, v146, v14
    v_and_b32 v139, v147, v15
    v_and_b32 v140, v148, v16
    v_and_b32 v141, v149, v17
    v_and_b32 v142, v150, v18
    v_and_b32 v143, v151, v19
    v_xor_b32 v144, v144, v136
    v_xor_b32 v145, v145, v137
    v_xor_b32 v146, v146, v138
    v_xor_b32 v147, v147, v139
    v_xor_b32 v148, v148, v140
    v_xor_b32 v149, v149, v141
    v_xor_b32_e64 v150, v150, v142
    v_xor_b32 v151, v151, v143
    s_waitcnt lgkmcnt(2)
    v_mfma_f32_32x32x16_bf16 v[88:103], v[120:123], v[136:139], 0
    v_mfma_f32_32x32x16_bf16 v[88:103], v[124:127], v[140:143], v[88:103]
    v_mfma_f32_32x32x16_bf16 v[88:103], v[128:131], v[144:147], v[88:103]
    v_mfma_f32_32x32x16_bf16 v[88:103], v[132:135], v[148:151], v[88:103]
    ds_read_b128 v[128:131], v20 offset:30720
    ds_read_b128 v[132:135], v20 offset:31744
    s_cmp_eq_u32 s76, 1
    s_cbranch_scc0 ng_141
    v_mov_b32 v24, 0xf149f2ca
    v_mov_b32 v25, 0xf149f2ca
    v_mov_b32 v26, 0xf149f2ca
    v_mov_b32 v27, 0xf149f2ca
    v_mov_b32 v28, 0xf149f2ca
    v_mov_b32 v29, 0xf149f2ca
    v_mov_b32 v30, 0xf149f2ca
    v_mov_b32 v31, 0xf149f2ca
    v_mov_b32 v32, 0xf149f2ca
    v_mov_b32 v33, 0xf149f2ca
    v_mov_b32 v34, 0xf149f2ca
    v_mov_b32 v35, 0xf149f2ca
    v_mov_b32 v36, 0xf149f2ca
    v_mov_b32 v37, 0xf149f2ca
    v_mov_b32 v38, 0xf149f2ca
    v_mov_b32 v39, 0xf149f2ca
ng_141:
    s_waitcnt lgkmcnt(2)
    s_nop 0
    v_mfma_f32_32x32x16_bf16 v[56:71], v[104:107], v[4:7], v[24:39]
    v_mfma_f32_32x32x16_bf16 v[56:71], v[108:111], v[8:11], v[56:71]
    ds_read_b128 v[112:115], v20 offset:20480
    ds_read_b128 v[116:119], v20 offset:21504
    v_exp_f32 v72, v72
    v_exp_f32 v73, v73
    v_exp_f32 v74, v74
    v_exp_f32 v75, v75
    v_exp_f32 v76, v76
    v_exp_f32 v77, v77
    v_exp_f32 v78, v78
    v_exp_f32 v79, v79
    v_exp_f32 v80, v80
    v_exp_f32 v81, v81
    v_exp_f32 v82, v82
    v_exp_f32 v83, v83
    v_exp_f32 v84, v84
    v_exp_f32 v85, v85
    v_exp_f32 v86, v86
    v_exp_f32 v87, v87
    v_add_f32 v22, v22, v72
    v_add_f32 v23, v23, v73
    v_add_f32 v22, v22, v74
    v_add_f32 v23, v23, v75
    v_add_f32 v22, v22, v76
    v_add_f32 v23, v23, v77
    v_add_f32 v22, v22, v78
    v_add_f32 v23, v23, v79
    v_add_f32 v22, v22, v80
    v_add_f32 v23, v23, v81
    v_add_f32 v22, v22, v82
    v_add_f32 v23, v23, v83
    v_add_f32 v22, v22, v84
    v_add_f32 v23, v23, v85
    v_add_f32_e64 v22, v22, v86
    v_add_f32 v23, v23, v87
    v_cvt_pk_bf16_f32 v144, v72, v73
    v_cvt_pk_bf16_f32 v145, v74, v75
    v_cvt_pk_bf16_f32 v146, v76, v77
    v_cvt_pk_bf16_f32 v147, v78, v79
    v_cvt_pk_bf16_f32 v148, v80, v81
    v_cvt_pk_bf16_f32 v149, v82, v83
    v_cvt_pk_bf16_f32 v150, v84, v85
    v_cvt_pk_bf16_f32 v151, v86, v87
    s_waitcnt lgkmcnt(2)
    v_mfma_f32_32x32x16_bf16 v[88:103], v[128:131], v[144:147], v[88:103]
    v_mfma_f32_32x32x16_bf16 v[88:103], v[132:135], v[148:151], v[88:103]
    ds_read_b128 v[120:123], v20 offset:26624
    ds_read_b128 v[124:127], v20 offset:27648
    s_cmp_eq_u32 s76, 2
    s_cbranch_scc0 ng_142
    v_mov_b32 v24, 0xf149f2ca
    v_mov_b32 v25, 0xf149f2ca
    v_mov_b32 v26, 0xf149f2ca
    v_mov_b32 v27, 0xf149f2ca
    v_mov_b32 v28, 0xf149f2ca
    v_mov_b32 v29, 0xf149f2ca
    v_mov_b32 v30, 0xf149f2ca
    v_mov_b32 v31, 0xf149f2ca
    v_mov_b32 v32, 0xf149f2ca
    v_mov_b32 v33, 0xf149f2ca
    v_mov_b32 v34, 0xf149f2ca
    v_mov_b32 v35, 0xf149f2ca
    v_mov_b32 v36, 0xf149f2ca
    v_mov_b32 v37, 0xf149f2ca
    v_mov_b32 v38, 0xf149f2ca
    v_mov_b32 v39, 0xf149f2ca
ng_142:
    s_waitcnt lgkmcnt(2)
    s_nop 0
    v_mfma_f32_32x32x16_bf16 v[72:87], v[112:115], v[4:7], v[24:39]
    v_mfma_f32_32x32x16_bf16 v[72:87], v[116:119], v[8:11], v[72:87]
    ds_read_b128 v[104:107], v20 offset:16384
    ds_read_b128 v[108:111], v20 offset:17408
    v_exp_f32 v56, v56
    v_exp_f32 v57, v57
    v_exp_f32 v58, v58
    v_exp_f32 v59, v59
    v_exp_f32 v60, v60
    v_exp_f32 v61, v61
    v_exp_f32 v62, v62
    v_exp_f32 v63, v63
    v_exp_f32 v64, v64
    v_exp_f32 v65, v65
    v_exp_f32 v66, v66
    v_exp_f32 v67, v67
    v_exp_f32 v68, v68
    v_exp_f32 v69, v69
    v_exp_f32 v70, v70
    v_exp_f32 v71, v71
    v_add_f32 v22, v22, v56
    v_add_f32 v23, v23, v57
    v_add_f32 v22, v22, v58
    v_add_f32 v23, v23, v59
    v_add_f32 v22, v22, v60
    v_add_f32 v23, v23, v61
    v_add_f32 v22, v22, v62
    v_add_f32 v23, v23, v63
    v_add_f32 v22, v22, v64
    v_add_f32 v23, v23, v65
    v_add_f32 v22, v22, v66
    v_add_f32 v23, v23, v67
    v_add_f32 v22, v22, v68
    v_add_f32 v23, v23, v69
    v_add_f32_e64 v22, v22, v70
    v_add_f32 v23, v23, v71
    v_cvt_pk_bf16_f32 v136, v56, v57
    v_cvt_pk_bf16_f32 v137, v58, v59
    v_cvt_pk_bf16_f32 v138, v60, v61
    v_cvt_pk_bf16_f32 v139, v62, v63
    v_cvt_pk_bf16_f32 v140, v64, v65
    v_cvt_pk_bf16_f32 v141, v66, v67
    v_cvt_pk_bf16_f32 v142, v68, v69
    v_cvt_pk_bf16_f32 v143, v70, v71
    s_waitcnt lgkmcnt(2)
    v_mfma_f32_32x32x16_bf16 v[88:103], v[120:123], v[136:139], v[88:103]
    v_mfma_f32_32x32x16_bf16 v[88:103], v[124:127], v[140:143], v[88:103]
    ds_read_b128 v[128:131], v20 offset:22528
    ds_read_b128 v[132:135], v20 offset:23552
    s_cmp_eq_u32 s76, 3
    s_cbranch_scc0 ng_143
    v_mov_b32 v24, 0xf149f2ca
    v_mov_b32 v25, 0xf149f2ca
    v_mov_b32 v26, 0xf149f2ca
    v_mov_b32 v27, 0xf149f2ca
    v_mov_b32 v28, 0xf149f2ca
    v_mov_b32 v29, 0xf149f2ca
    v_mov_b32 v30, 0xf149f2ca
    v_mov_b32 v31, 0xf149f2ca
    v_mov_b32 v32, 0xf149f2ca
    v_mov_b32 v33, 0xf149f2ca
    v_mov_b32 v34, 0xf149f2ca
    v_mov_b32 v35, 0xf149f2ca
    v_mov_b32 v36, 0xf149f2ca
    v_mov_b32 v37, 0xf149f2ca
    v_mov_b32 v38, 0xf149f2ca
    v_mov_b32 v39, 0xf149f2ca
ng_143:
    s_waitcnt lgkmcnt(2)
    s_nop 0
    v_mfma_f32_32x32x16_bf16 v[56:71], v[104:107], v[4:7], v[24:39]
    v_mfma_f32_32x32x16_bf16 v[56:71], v[108:111], v[8:11], v[56:71]
    ds_read_b128 v[112:115], v20 offset:12288
    ds_read_b128 v[116:119], v20 offset:13312
    v_exp_f32 v72, v72
    v_exp_f32 v73, v73
    v_exp_f32 v74, v74
    v_exp_f32 v75, v75
    v_exp_f32 v76, v76
    v_exp_f32 v77, v77
    v_exp_f32 v78, v78
    v_exp_f32 v79, v79
    v_exp_f32 v80, v80
    v_exp_f32 v81, v81
    v_exp_f32 v82, v82
    v_exp_f32 v83, v83
    v_exp_f32 v84, v84
    v_exp_f32 v85, v85
    v_exp_f32 v86, v86
    v_exp_f32 v87, v87
    v_add_f32 v22, v22, v72
    v_add_f32 v23, v23, v73
    v_add_f32 v22, v22, v74
    v_add_f32 v23, v23, v75
    v_add_f32 v22, v22, v76
    v_add_f32 v23, v23, v77
    v_add_f32 v22, v22, v78
    v_add_f32 v23, v23, v79
    v_add_f32 v22, v22, v80
    v_add_f32 v23, v23, v81
    v_add_f32 v22, v22, v82
    v_add_f32 v23, v23, v83
    v_add_f32 v22, v22, v84
    v_add_f32 v23, v23, v85
    v_add_f32_e64 v22, v22, v86
    v_add_f32 v23, v23, v87
    v_cvt_pk_bf16_f32 v144, v72, v73
    v_cvt_pk_bf16_f32 v145, v74, v75
    v_cvt_pk_bf16_f32 v146, v76, v77
    v_cvt_pk_bf16_f32 v147, v78, v79
    v_cvt_pk_bf16_f32 v148, v80, v81
    v_cvt_pk_bf16_f32 v149, v82, v83
    v_cvt_pk_bf16_f32 v150, v84, v85
    v_cvt_pk_bf16_f32 v151, v86, v87
    s_waitcnt lgkmcnt(2)
    v_mfma_f32_32x32x16_bf16 v[88:103], v[128:131], v[144:147], v[88:103]
    v_mfma_f32_32x32x16_bf16 v[88:103], v[132:135], v[148:151], v[88:103]
    ds_read_b128 v[120:123], v20 offset:18432
    ds_read_b128 v[124:127], v20 offset:19456
    s_cmp_eq_u32 s76, 4
    s_cbranch_scc0 ng_144
    v_mov_b32 v24, 0xf149f2ca
    v_mov_b32 v25, 0xf149f2ca
    v_mov_b32 v26, 0xf149f2ca
    v_mov_b32 v27, 0xf149f2ca
    v_mov_b32 v28, 0xf149f2ca
    v_mov_b32 v29, 0xf149f2ca
    v_mov_b32 v30, 0xf149f2ca
    v_mov_b32 v31, 0xf149f2ca
    v_mov_b32 v32, 0xf149f2ca
    v_mov_b32 v33, 0xf149f2ca
    v_mov_b32 v34, 0xf149f2ca
    v_mov_b32 v35, 0xf149f2ca
    v_mov_b32 v36, 0xf149f2ca
    v_mov_b32 v37, 0xf149f2ca
    v_mov_b32 v38, 0xf149f2ca
    v_mov_b32 v39, 0xf149f2ca
ng_144:
    s_waitcnt lgkmcnt(2)
    s_nop 0
    v_mfma_f32_32x32x16_bf16 v[72:87], v[112:115], v[4:7], v[24:39]
    v_mfma_f32_32x32x16_bf16 v[72:87], v[116:119], v[8:11], v[72:87]
    ds_read_b128 v[104:107], v20 offset:8192
    ds_read_b128 v[108:111], v20 offset:9216
    v_exp_f32 v56, v56
    v_exp_f32 v57, v57
    v_exp_f32 v58, v58
    v_exp_f32 v59, v59
    v_exp_f32 v60, v60
    v_exp_f32 v61, v61
    v_exp_f32 v62, v62
    v_exp_f32 v63, v63
    v_exp_f32 v64, v64
    v_exp_f32 v65, v65
    v_exp_f32 v66, v66
    v_exp_f32 v67, v67
    v_exp_f32 v68, v68
    v_exp_f32 v69, v69
    v_exp_f32 v70, v70
    v_exp_f32 v71, v71
    v_add_f32 v22, v22, v56
    v_add_f32 v23, v23, v57
    v_add_f32 v22, v22, v58
    v_add_f32 v23, v23, v59
    v_add_f32 v22, v22, v60
    v_add_f32 v23, v23, v61
    v_add_f32 v22, v22, v62
    v_add_f32 v23, v23, v63
    v_add_f32 v22, v22, v64
    v_add_f32 v23, v23, v65
    v_add_f32 v22, v22, v66
    v_add_f32 v23, v23, v67
    v_add_f32 v22, v22, v68
    v_add_f32 v23, v23, v69
    v_add_f32_e64 v22, v22, v70
    v_add_f32 v23, v23, v71
    v_cvt_pk_bf16_f32 v136, v56, v57
    v_cvt_pk_bf16_f32 v137, v58, v59
    v_cvt_pk_bf16_f32 v138, v60, v61
    v_cvt_pk_bf16_f32 v139, v62, v63
    v_cvt_pk_bf16_f32 v140, v64, v65
    v_cvt_pk_bf16_f32 v141, v66, v67
    v_cvt_pk_bf16_f32 v142, v68, v69
    v_cvt_pk_bf16_f32 v143, v70, v71
    s_waitcnt lgkmcnt(2)
    v_mfma_f32_32x32x16_bf16 v[88:103], v[120:123], v[136:139], v[88:103]
    v_mfma_f32_32x32x16_bf16 v[88:103], v[124:127], v[140:143], v[88:103]
    ds_read_b128 v[128:131], v20 offset:14336
    ds_read_b128 v[132:135], v20 offset:15360
    s_cmp_eq_u32 s76, 5
    s_cbranch_scc0 ng_145
    v_mov_b32 v24, 0xf149f2ca
    v_mov_b32 v25, 0xf149f2ca
    v_mov_b32 v26, 0xf149f2ca
    v_mov_b32 v27, 0xf149f2ca
    v_mov_b32 v28, 0xf149f2ca
    v_mov_b32 v29, 0xf149f2ca
    v_mov_b32 v30, 0xf149f2ca
    v_mov_b32 v31, 0xf149f2ca
    v_mov_b32 v32, 0xf149f2ca
    v_mov_b32 v33, 0xf149f2ca
    v_mov_b32 v34, 0xf149f2ca
    v_mov_b32 v35, 0xf149f2ca
    v_mov_b32 v36, 0xf149f2ca
    v_mov_b32 v37, 0xf149f2ca
    v_mov_b32 v38, 0xf149f2ca
    v_mov_b32 v39, 0xf149f2ca
ng_145:
    s_waitcnt lgkmcnt(2)
    s_nop 0
    v_mfma_f32_32x32x16_bf16 v[56:71], v[104:107], v[4:7], v[24:39]
    v_mfma_f32_32x32x16_bf16 v[56:71], v[108:111], v[8:11], v[56:71]
    ds_read_b128 v[112:115], v20 offset:4096
    ds_read_b128 v[116:119], v20 offset:5120
    v_exp_f32 v72, v72
    v_exp_f32 v73, v73
    v_exp_f32 v74, v74
    v_exp_f32 v75, v75
    v_exp_f32 v76, v76
    v_exp_f32 v77, v77
    v_exp_f32 v78, v78
    v_exp_f32 v79, v79
    v_exp_f32 v80, v80
    v_exp_f32 v81, v81
    v_exp_f32 v82, v82
    v_exp_f32 v83, v83
    v_exp_f32 v84, v84
    v_exp_f32 v85, v85
    v_exp_f32 v86, v86
    v_exp_f32 v87, v87
    v_add_f32 v22, v22, v72
    v_add_f32 v23, v23, v73
    v_add_f32 v22, v22, v74
    v_add_f32 v23, v23, v75
    v_add_f32 v22, v22, v76
    v_add_f32 v23, v23, v77
    v_add_f32 v22, v22, v78
    v_add_f32 v23, v23, v79
    v_add_f32 v22, v22, v80
    v_add_f32 v23, v23, v81
    v_add_f32 v22, v22, v82
    v_add_f32 v23, v23, v83
    v_add_f32 v22, v22, v84
    v_add_f32 v23, v23, v85
    v_add_f32_e64 v22, v22, v86
    v_add_f32 v23, v23, v87
    v_cvt_pk_bf16_f32 v144, v72, v73
    v_cvt_pk_bf16_f32 v145, v74, v75
    v_cvt_pk_bf16_f32 v146, v76, v77
    v_cvt_pk_bf16_f32 v147, v78, v79
    v_cvt_pk_bf16_f32 v148, v80, v81
    v_cvt_pk_bf16_f32 v149, v82, v83
    v_cvt_pk_bf16_f32 v150, v84, v85
    v_cvt_pk_bf16_f32 v151, v86, v87
    s_waitcnt lgkmcnt(2)
    v_mfma_f32_32x32x16_bf16 v[88:103], v[128:131], v[144:147], v[88:103]
    v_mfma_f32_32x32x16_bf16 v[88:103], v[132:135], v[148:151], v[88:103]
    ds_read_b128 v[120:123], v20 offset:10240
    ds_read_b128 v[124:127], v20 offset:11264
    s_cmp_eq_u32 s76, 6
    s_cbranch_scc0 ng_146
    v_mov_b32 v24, 0xf149f2ca
    v_mov_b32 v25, 0xf149f2ca
    v_mov_b32 v26, 0xf149f2ca
    v_mov_b32 v27, 0xf149f2ca
    v_mov_b32 v28, 0xf149f2ca
    v_mov_b32 v29, 0xf149f2ca
    v_mov_b32 v30, 0xf149f2ca
    v_mov_b32 v31, 0xf149f2ca
    v_mov_b32 v32, 0xf149f2ca
    v_mov_b32 v33, 0xf149f2ca
    v_mov_b32 v34, 0xf149f2ca
    v_mov_b32 v35, 0xf149f2ca
    v_mov_b32 v36, 0xf149f2ca
    v_mov_b32 v37, 0xf149f2ca
    v_mov_b32 v38, 0xf149f2ca
    v_mov_b32 v39, 0xf149f2ca
ng_146:
    s_waitcnt lgkmcnt(2)
    s_nop 0
    v_mfma_f32_32x32x16_bf16 v[72:87], v[112:115], v[4:7], v[24:39]
    v_mfma_f32_32x32x16_bf16 v[72:87], v[116:119], v[8:11], v[72:87]
    v_exp_f32 v56, v56
    v_exp_f32 v57, v57
    v_exp_f32 v58, v58
    v_exp_f32 v59, v59
    v_exp_f32 v60, v60
    v_exp_f32 v61, v61
    v_exp_f32 v62, v62
    v_exp_f32 v63, v63
    v_exp_f32 v64, v64
    v_exp_f32 v65, v65
    v_exp_f32 v66, v66
    v_exp_f32 v67, v67
    v_exp_f32 v68, v68
    v_exp_f32 v69, v69
    v_exp_f32 v70, v70
    v_exp_f32 v71, v71
    v_add_f32 v22, v22, v56
    v_add_f32 v23, v23, v57
    v_add_f32 v22, v22, v58
    v_add_f32 v23, v23, v59
    v_add_f32 v22, v22, v60
    v_add_f32 v23, v23, v61
    v_add_f32 v22, v22, v62
    v_add_f32 v23, v23, v63
    v_add_f32 v22, v22, v64
    v_add_f32 v23, v23, v65
    v_add_f32 v22, v22, v66
    v_add_f32 v23, v23, v67
    v_add_f32 v22, v22, v68
    v_add_f32 v23, v23, v69
    v_add_f32 v22, v22, v70
    v_add_f32 v23, v23, v71
    v_cvt_pk_bf16_f32 v136, v56, v57
    v_cvt_pk_bf16_f32 v137, v58, v59
    v_cvt_pk_bf16_f32 v138, v60, v61
    v_cvt_pk_bf16_f32 v139, v62, v63
    v_cvt_pk_bf16_f32 v140, v64, v65
    v_cvt_pk_bf16_f32 v141, v66, v67
    v_cvt_pk_bf16_f32 v142, v68, v69
    v_cvt_pk_bf16_f32 v143, v70, v71
    s_waitcnt lgkmcnt(0)
    v_mfma_f32_32x32x16_bf16 v[88:103], v[120:123], v[136:139], v[88:103]
    v_mfma_f32_32x32x16_bf16 v[88:103], v[124:127], v[140:143], v[88:103]
    ds_read_b128 v[128:131], v20 offset:6144
    ds_read_b128 v[132:135], v20 offset:7168
    v_exp_f32 v72, v72
    v_exp_f32 v73, v73
    v_exp_f32 v74, v74
    v_exp_f32 v75, v75
    v_exp_f32 v76, v76
    v_exp_f32 v77, v77
    v_exp_f32 v78, v78
    v_exp_f32 v79, v79
    v_exp_f32 v80, v80
    v_exp_f32 v81, v81
    v_exp_f32 v82, v82
    v_exp_f32 v83, v83
    v_exp_f32 v84, v84
    v_exp_f32 v85, v85
    v_exp_f32 v86, v86
    v_exp_f32 v87, v87
    v_add_f32 v22, v22, v72
    v_add_f32 v23, v23, v73
    v_add_f32 v22, v22, v74
    v_add_f32 v23, v23, v75
    v_add_f32 v22, v22, v76
    v_add_f32 v23, v23, v77
    v_add_f32 v22, v22, v78
    v_add_f32 v23, v23, v79
    v_add_f32 v22, v22, v80
    v_add_f32 v23, v23, v81
    v_add_f32 v22, v22, v82
    v_add_f32 v23, v23, v83
    v_add_f32 v22, v22, v84
    v_add_f32 v23, v23, v85
    v_add_f32 v22, v22, v86
    v_add_f32_e64 v23, v23, v87
    v_cvt_pk_bf16_f32 v144, v72, v73
    v_cvt_pk_bf16_f32 v145, v74, v75
    v_cvt_pk_bf16_f32 v146, v76, v77
    v_cvt_pk_bf16_f32 v147, v78, v79
    v_cvt_pk_bf16_f32 v148, v80, v81
    v_cvt_pk_bf16_f32 v149, v82, v83
    v_cvt_pk_bf16_f32 v150, v84, v85
    v_cvt_pk_bf16_f32 v151, v86, v87
    s_waitcnt lgkmcnt(0)
    v_mfma_f32_32x32x16_bf16 v[88:103], v[128:131], v[144:147], v[88:103]
    v_mfma_f32_32x32x16_bf16 v[88:103], v[132:135], v[148:151], v[88:103]
    v_add_f32 v22, v22, v23
    v_mov_b32 v152, v22
    s_nop 1
    v_permlane32_swap_b32 v22, v152
    v_add_f32 v22, v22, v152
    v_rcp_f32 v22, v22
    s_lshl_b32 s33, s25, 11
    s_add_u32 s33, s33, s36
    s_branch att_ret0
    s_nop 0
att_exact1:
    s_waitcnt lgkmcnt(0)
    v_mov_b32 v20, 0xffff
    v_mov_b32 v21, 0xffff0000
    v_cndmask_b32 v22, 0, v20, s[40:41]
    v_cndmask_b32 v23, 0, v21, s[42:43]
    v_or_b32_e64 v12, v22, v23
    v_cndmask_b32 v22, 0, v20, s[44:45]
    v_cndmask_b32 v23, 0, v21, s[46:47]
    v_or_b32_e64 v13, v22, v23
    v_cndmask_b32 v22, 0, v20, s[48:49]
    v_cndmask_b32 v23, 0, v21, s[50:51]
    v_or_b32_e64 v14, v22, v23
    v_cndmask_b32 v22, 0, v20, s[52:53]
    v_cndmask_b32 v23, 0, v21, s[54:55]
    v_or_b32_e64 v15, v22, v23
    v_cndmask_b32 v22, 0, v20, s[56:57]
    v_cndmask_b32 v23, 0, v21, s[58:59]
    v_or_b32_e64 v16, v22, v23
    v_cndmask_b32 v22, 0, v20, s[60:61]
    v_cndmask_b32 v23, 0, v21, s[62:63]
    v_or_b32_e64 v17, v22, v23
    v_cndmask_b32 v22, 0, v20, s[64:65]
    v_cndmask_b32 v23, 0, v21, s[66:67]
    v_or_b32_e64 v18, v22, v23
    v_cndmask_b32 v22, 0, v20, s[68:69]
    v_cndmask_b32 v23, 0, v21, s[70:71]
    v_or_b32_e64 v19, v22, v23
    s_and_b32 s34, s76, 3
    s_lshl_b32 s33, s34, 12
    s_add_u32 s33, s33, 114688
    v_add_u32 v20, s33, v253
    v_mov_b32 v24, 0
    v_mov_b32 v25, 0
    v_mov_b32 v26, 0
    v_mov_b32 v27, 0
    v_mov_b32 v28, 0
    v_mov_b32 v29, 0
    v_mov_b32 v30, 0
    v_mov_b32 v31, 0
    v_mov_b32 v32, 0
    v_mov_b32 v33, 0
    v_mov_b32 v34, 0
    v_mov_b32 v35, 0
    v_mov_b32 v36, 0
    v_mov_b32 v37, 0
    v_mov_b32 v38, 0
    v_mov_b32 v39, 0
    ds_read_b128 v[104:107], v20 offset:32768
    ds_read_b128 v[108:111], v20 offset:33792
    ds_read_b128 v[112:115], v20 offset:28672
    ds_read_b128 v[116:119], v20 offset:29696
    s_waitcnt lgkmcnt(2)
    v_mfma_f32_32x32x16_bf16 v[40:55], v[104:107], v[4:7], 0
    v_mfma_f32_32x32x16_bf16 v[40:55], v[108:111], v[8:11], v[40:55]
    ds_read_b128 v[104:107], v20 offset:24576
    ds_read_b128 v[108:111], v20 offset:25600
    s_cmp_eq_u32 s76, 0
    s_cbranch_scc0 ng_147
    v_mov_b32 v24, 0xf149f2ca
    v_mov_b32 v25, 0xf149f2ca
    v_mov_b32 v26, 0xf149f2ca
    v_mov_b32 v27, 0xf149f2ca
    v_mov_b32 v28, 0xf149f2ca
    v_mov_b32 v29, 0xf149f2ca
    v_mov_b32 v30, 0xf149f2ca
    v_mov_b32 v31, 0xf149f2ca
    v_mov_b32 v32, 0xf149f2ca
    v_mov_b32 v33, 0xf149f2ca
    v_mov_b32 v34, 0xf149f2ca
    v_mov_b32 v35, 0xf149f2ca
    v_mov_b32 v36, 0xf149f2ca
    v_mov_b32 v37, 0xf149f2ca
    v_mov_b32 v38, 0xf149f2ca
    v_mov_b32 v39, 0xf149f2ca
ng_147:
    s_waitcnt lgkmcnt(2)
    s_nop 0
    v_mfma_f32_32x32x16_bf16 v[72:87], v[112:115], v[4:7], v[24:39]
    v_mfma_f32_32x32x16_bf16 v[72:87], v[116:119], v[8:11], v[72:87]
    ds_read_b128 v[112:115], v20 offset:20480
    ds_read_b128 v[116:119], v20 offset:21504
    s_cmp_eq_u32 s76, 1
    s_cbranch_scc0 ng_148
    s_nop 1
    v_mov_b32 v24, 0xf149f2ca
    v_mov_b32 v25, 0xf149f2ca
    v_mov_b32 v26, 0xf149f2ca
    v_mov_b32 v27, 0xf149f2ca
    v_mov_b32 v28, 0xf149f2ca
    v_mov_b32 v29, 0xf149f2ca
    v_mov_b32 v30, 0xf149f2ca
    v_mov_b32 v31, 0xf149f2ca
    v_mov_b32 v32, 0xf149f2ca
    v_mov_b32 v33, 0xf149f2ca
    v_mov_b32 v34, 0xf149f2ca
    v_mov_b32 v35, 0xf149f2ca
    v_mov_b32 v36, 0xf149f2ca
    v_mov_b32 v37, 0xf149f2ca
    v_mov_b32 v38, 0xf149f2ca
    v_mov_b32 v39, 0xf149f2ca
ng_148:
    s_waitcnt lgkmcnt(2)
    s_nop 0
    v_mfma_f32_32x32x16_bf16 v[56:71], v[104:107], v[4:7], v[24:39]
    v_mfma_f32_32x32x16_bf16 v[56:71], v[108:111], v[8:11], v[56:71]
    s_nop 3
    v_max_f32_e64 v21, v72, v73
    v_max3_f32 v21, v21, v74, v75
    v_max3_f32 v21, v21, v76, v77
    v_max3_f32 v21, v21, v78, v79
    v_max3_f32 v21, v21, v80, v81
    v_max3_f32 v21, v21, v82, v83
    v_max3_f32 v21, v21, v84, v85
    v_max3_f32 v21, v21, v86, v87
    ds_read_b128 v[104:107], v20 offset:16384
    ds_read_b128 v[108:111], v20 offset:17408
    s_cmp_eq_u32 s76, 2
    s_cbranch_scc0 ng_149
    v_mov_b32 v24, 0xf149f2ca
    v_mov_b32 v25, 0xf149f2ca
    v_mov_b32 v26, 0xf149f2ca
    v_mov_b32 v27, 0xf149f2ca
    v_mov_b32 v28, 0xf149f2ca
    v_mov_b32 v29, 0xf149f2ca
    v_mov_b32 v30, 0xf149f2ca
    v_mov_b32 v31, 0xf149f2ca
    v_mov_b32 v32, 0xf149f2ca
    v_mov_b32 v33, 0xf149f2ca
    v_mov_b32 v34, 0xf149f2ca
    v_mov_b32 v35, 0xf149f2ca
    v_mov_b32 v36, 0xf149f2ca
    v_mov_b32 v37, 0xf149f2ca
    v_mov_b32 v38, 0xf149f2ca
    v_mov_b32 v39, 0xf149f2ca
ng_149:
    s_waitcnt lgkmcnt(2)
    s_nop 0
    v_mfma_f32_32x32x16_bf16 v[72:87], v[112:115], v[4:7], v[24:39]
    v_mfma_f32_32x32x16_bf16 v[72:87], v[116:119], v[8:11], v[72:87]
    v_max3_f32 v21, v21, v56, v57
    v_max3_f32 v21, v21, v58, v59
    v_max3_f32 v21, v21, v60, v61
    v_max3_f32 v21, v21, v62, v63
    v_max3_f32 v21, v21, v64, v65
    v_max3_f32 v21, v21, v66, v67
    v_max3_f32 v21, v21, v68, v69
    v_max3_f32 v21, v21, v70, v71
    ds_read_b128 v[112:115], v20 offset:12288
    ds_read_b128 v[116:119], v20 offset:13312
    s_cmp_eq_u32 s76, 3
    s_cbranch_scc0 ng_150
    v_mov_b32 v24, 0xf149f2ca
    v_mov_b32 v25, 0xf149f2ca
    v_mov_b32 v26, 0xf149f2ca
    v_mov_b32 v27, 0xf149f2ca
    v_mov_b32 v28, 0xf149f2ca
    v_mov_b32 v29, 0xf149f2ca
    v_mov_b32 v30, 0xf149f2ca
    v_mov_b32 v31, 0xf149f2ca
    v_mov_b32 v32, 0xf149f2ca
    v_mov_b32 v33, 0xf149f2ca
    v_mov_b32 v34, 0xf149f2ca
    v_mov_b32 v35, 0xf149f2ca
    v_mov_b32 v36, 0xf149f2ca
    v_mov_b32 v37, 0xf149f2ca
    v_mov_b32 v38, 0xf149f2ca
    v_mov_b32 v39, 0xf149f2ca
ng_150:
    s_waitcnt lgkmcnt(2)
    s_nop 0
    v_mfma_f32_32x32x16_bf16 v[56:71], v[104:107], v[4:7], v[24:39]
    v_mfma_f32_32x32x16_bf16 v[56:71], v[108:111], v[8:11], v[56:71]
    v_max3_f32 v21, v21, v72, v73
    v_max3_f32 v21, v21, v74, v75
    v_max3_f32 v21, v21, v76, v77
    v_max3_f32 v21, v21, v78, v79
    v_max3_f32 v21, v21, v80, v81
    v_max3_f32 v21, v21, v82, v83
    v_max3_f32 v21, v21, v84, v85
    v_max3_f32 v21, v21, v86, v87
    ds_read_b128 v[104:107], v20 offset:8192
    ds_read_b128 v[108:111], v20 offset:9216
    s_cmp_eq_u32 s76, 4
    s_cbranch_scc0 ng_151
    v_mov_b32 v24, 0xf149f2ca
    v_mov_b32 v25, 0xf149f2ca
    v_mov_b32 v26, 0xf149f2ca
    v_mov_b32 v27, 0xf149f2ca
    v_mov_b32 v28, 0xf149f2ca
    v_mov_b32 v29, 0xf149f2ca
    v_mov_b32 v30, 0xf149f2ca
    v_mov_b32 v31, 0xf149f2ca
    v_mov_b32 v32, 0xf149f2ca
    v_mov_b32 v33, 0xf149f2ca
    v_mov_b32 v34, 0xf149f2ca
    v_mov_b32 v35, 0xf149f2ca
    v_mov_b32 v36, 0xf149f2ca
    v_mov_b32 v37, 0xf149f2ca
    v_mov_b32 v38, 0xf149f2ca
    v_mov_b32 v39, 0xf149f2ca
ng_151:
    s_waitcnt lgkmcnt(2)
    s_nop 0
    v_mfma_f32_32x32x16_bf16 v[72:87], v[112:115], v[4:7], v[24:39]
    v_mfma_f32_32x32x16_bf16 v[72:87], v[116:119], v[8:11], v[72:87]
    v_max3_f32 v21, v21, v56, v57
    v_max3_f32 v21, v21, v58, v59
    v_max3_f32 v21, v21, v60, v61
    v_max3_f32 v21, v21, v62, v63
    v_max3_f32 v21, v21, v64, v65
    v_max3_f32 v21, v21, v66, v67
    v_max3_f32 v21, v21, v68, v69
    v_max3_f32 v21, v21, v70, v71
    ds_read_b128 v[112:115], v20 offset:4096
    ds_read_b128 v[116:119], v20 offset:5120
    s_cmp_eq_u32 s76, 5
    s_cbranch_scc0 ng_152
    v_mov_b32 v24, 0xf149f2ca
    v_mov_b32 v25, 0xf149f2ca
    v_mov_b32 v26, 0xf149f2ca
    v_mov_b32 v27, 0xf149f2ca
    v_mov_b32 v28, 0xf149f2ca
    v_mov_b32 v29, 0xf149f2ca
    v_mov_b32 v30, 0xf149f2ca
    v_mov_b32 v31, 0xf149f2ca
    v_mov_b32 v32, 0xf149f2ca
    v_mov_b32 v33, 0xf149f2ca
    v_mov_b32 v34, 0xf149f2ca
    v_mov_b32 v35, 0xf149f2ca
    v_mov_b32 v36, 0xf149f2ca
    v_mov_b32 v37, 0xf149f2ca
    v_mov_b32 v38, 0xf149f2ca
    v_mov_b32 v39, 0xf149f2ca
ng_152:
    s_waitcnt lgkmcnt(2)
    s_nop 0
    v_mfma_f32_32x32x16_bf16 v[56:71], v[104:107], v[4:7], v[24:39]
    v_mfma_f32_32x32x16_bf16 v[56:71], v[108:111], v[8:11], v[56:71]
    v_max3_f32 v21, v21, v72, v73
    v_max3_f32 v21, v21, v74, v75
    v_max3_f32 v21, v21, v76, v77
    v_max3_f32 v21, v21, v78, v79
    v_max3_f32 v21, v21, v80, v81
    v_max3_f32 v21, v21, v82, v83
    v_max3_f32 v21, v21, v84, v85
    v_max3_f32 v21, v21, v86, v87
    ds_read_b128 v[104:107], v20 offset:0
    ds_read_b128 v[108:111], v20 offset:1024
    s_cmp_eq_u32 s76, 6
    s_cbranch_scc0 ng_153
    v_mov_b32 v24, 0xf149f2ca
    v_mov_b32 v25, 0xf149f2ca
    v_mov_b32 v26, 0xf149f2ca
    v_mov_b32 v27, 0xf149f2ca
    v_mov_b32 v28, 0xf149f2ca
    v_mov_b32 v29, 0xf149f2ca
    v_mov_b32 v30, 0xf149f2ca
    v_mov_b32 v31, 0xf149f2ca
    v_mov_b32 v32, 0xf149f2ca
    v_mov_b32 v33, 0xf149f2ca
    v_mov_b32 v34, 0xf149f2ca
    v_mov_b32 v35, 0xf149f2ca
    v_mov_b32 v36, 0xf149f2ca
    v_mov_b32 v37, 0xf149f2ca
    v_mov_b32 v38, 0xf149f2ca
    v_mov_b32 v39, 0xf149f2ca
ng_153:
    s_waitcnt lgkmcnt(2)
    s_nop 0
    v_mfma_f32_32x32x16_bf16 v[72:87], v[112:115], v[4:7], v[24:39]
    v_mfma_f32_32x32x16_bf16 v[72:87], v[116:119], v[8:11], v[72:87]
    v_max3_f32 v21, v21, v56, v57
    v_max3_f32 v21, v21, v58, v59
    v_max3_f32 v21, v21, v60, v61
    v_max3_f32 v21, v21, v62, v63
    v_max3_f32 v21, v21, v64, v65
    v_max3_f32 v21, v21, v66, v67
    v_max3_f32 v21, v21, v68, v69
    v_max3_f32 v21, v21, v70, v71
    s_cmp_eq_u32 s76, 7
    s_cbranch_scc0 ng_154
    v_mov_b32 v24, 0xf149f2ca
    v_mov_b32 v25, 0xf149f2ca
    v_mov_b32 v26, 0xf149f2ca
    v_mov_b32 v27, 0xf149f2ca
    v_mov_b32 v28, 0xf149f2ca
    v_mov_b32 v29, 0xf149f2ca
    v_mov_b32 v30, 0xf149f2ca
    v_mov_b32 v31, 0xf149f2ca
    v_mov_b32 v32, 0xf149f2ca
    v_mov_b32 v33, 0xf149f2ca
    v_mov_b32 v34, 0xf149f2ca
    v_mov_b32 v35, 0xf149f2ca
    v_mov_b32 v36, 0xf149f2ca
    v_mov_b32 v37, 0xf149f2ca
    v_mov_b32 v38, 0xf149f2ca
    v_mov_b32 v39, 0xf149f2ca
ng_154:
    s_waitcnt lgkmcnt(0)
    s_nop 0
    v_mfma_f32_32x32x16_bf16 v[56:71], v[104:107], v[4:7], v[24:39]
    v_mfma_f32_32x32x16_bf16 v[56:71], v[108:111], v[8:11], v[56:71]
    v_max3_f32 v21, v21, v72, v73
    v_max3_f32 v21, v21, v74, v75
    v_max3_f32 v21, v21, v76, v77
    v_max3_f32 v21, v21, v78, v79
    v_max3_f32 v21, v21, v80, v81
    v_max3_f32 v21, v21, v82, v83
    v_max3_f32 v21, v21, v84, v85
    v_max3_f32 v21, v21, v86, v87
    ds_read_b128 v[112:115], v20 offset:28672
    ds_read_b128 v[116:119], v20 offset:29696
    ds_read_b128 v[120:123], v20 offset:34816
    ds_read_b128 v[124:127], v20 offset:35840
    ds_read_b128 v[128:131], v20 offset:2048
    ds_read_b128 v[132:135], v20 offset:3072
    v_cndmask_b32 v40, v56, v40, s[40:41]
    v_cndmask_b32 v41, v57, v41, s[42:43]
    v_cndmask_b32 v42, v58, v42, s[44:45]
    v_cndmask_b32 v43, v59, v43, s[46:47]
    v_cndmask_b32 v44, v60, v44, s[48:49]
    v_cndmask_b32 v45, v61, v45, s[50:51]
    v_cndmask_b32 v46, v62, v46, s[52:53]
    v_cndmask_b32 v47, v63, v47, s[54:55]
    v_cndmask_b32 v48, v64, v48, s[56:57]
    v_cndmask_b32 v49, v65, v49, s[58:59]
    v_cndmask_b32 v50, v66, v50, s[60:61]
    v_cndmask_b32 v51, v67, v51, s[62:63]
    v_cndmask_b32 v52, v68, v52, s[64:65]
    v_cndmask_b32 v53, v69, v53, s[66:67]
    v_cndmask_b32 v54, v70, v54, s[68:69]
    v_cndmask_b32 v55, v71, v55, s[70:71]
    v_max3_f32 v21, v21, v40, v41
    v_max3_f32 v21, v21, v42, v43
    v_max3_f32 v21, v21, v44, v45
    v_max3_f32 v21, v21, v46, v47
    v_max3_f32 v21, v21, v48, v49
    v_max3_f32 v21, v21, v50, v51
    v_max3_f32 v21, v21, v52, v53
    v_max3_f32 v21, v21, v54, v55
    v_mov_b32 v152, v21
    s_nop 1
    v_permlane32_swap_b32 v21, v152
    v_max_f32 v21, v21, v152
    v_sub_f32 v24, 0, v21
    v_sub_f32 v25, 0, v21
    v_sub_f32 v26, 0, v21
    v_sub_f32 v27, 0, v21
    v_sub_f32 v28, 0, v21
    v_sub_f32 v29, 0, v21
    v_sub_f32 v30, 0, v21
    v_sub_f32 v31, 0, v21
    v_sub_f32 v32, 0, v21
    v_sub_f32 v33, 0, v21
    v_sub_f32 v34, 0, v21
    v_sub_f32 v35, 0, v21
    v_sub_f32 v36, 0, v21
    v_sub_f32 v37, 0, v21
    v_sub_f32 v38, 0, v21
    v_sub_f32 v39, 0, v21
    s_cmp_eq_u32 s76, 0
    s_cbranch_scc0 ng_155
    v_mov_b32 v24, 0xf149f2ca
    v_mov_b32 v25, 0xf149f2ca
    v_mov_b32 v26, 0xf149f2ca
    v_mov_b32 v27, 0xf149f2ca
    v_mov_b32 v28, 0xf149f2ca
    v_mov_b32 v29, 0xf149f2ca
    v_mov_b32 v30, 0xf149f2ca
    v_mov_b32 v31, 0xf149f2ca
    v_mov_b32 v32, 0xf149f2ca
    v_mov_b32 v33, 0xf149f2ca
    v_mov_b32 v34, 0xf149f2ca
    v_mov_b32 v35, 0xf149f2ca
    v_mov_b32 v36, 0xf149f2ca
    v_mov_b32 v37, 0xf149f2ca
    v_mov_b32 v38, 0xf149f2ca
    v_mov_b32 v39, 0xf149f2ca
ng_155:
    s_waitcnt lgkmcnt(4)
    s_nop 0
    v_mfma_f32_32x32x16_bf16 v[72:87], v[112:115], v[4:7], v[24:39]
    v_mfma_f32_32x32x16_bf16 v[72:87], v[116:119], v[8:11], v[72:87]
    ds_read_b128 v[104:107], v20 offset:24576
    ds_read_b128 v[108:111], v20 offset:25600
    v_sub_f32 v40, v40, v21
    v_sub_f32 v41, v41, v21
    v_sub_f32 v42, v42, v21
    v_sub_f32 v43, v43, v21
    v_sub_f32 v44, v44, v21
    v_sub_f32 v45, v45, v21
    v_sub_f32 v46, v46, v21
    v_sub_f32 v47, v47, v21
    v_sub_f32 v48, v48, v21
    v_sub_f32 v49, v49, v21
    v_sub_f32 v50, v50, v21
    v_sub_f32 v51, v51, v21
    v_sub_f32 v52, v52, v21
    v_sub_f32 v53, v53, v21
    v_sub_f32 v54, v54, v21
    v_sub_f32 v55, v55, v21
    v_exp_f32 v40, v40
    v_exp_f32 v41, v41
    v_exp_f32 v42, v42
    v_exp_f32 v43, v43
    v_exp_f32 v44, v44
    v_exp_f32 v45, v45
    v_exp_f32 v46, v46
    v_exp_f32 v47, v47
    v_exp_f32 v48, v48
    v_exp_f32 v49, v49
    v_exp_f32 v50, v50
    v_exp_f32 v51, v51
    v_exp_f32 v52, v52
    v_exp_f32 v53, v53
    v_exp_f32 v54, v54
    v_exp_f32 v55, v55
    v_add_f32 v22, v40, v41
    v_add_f32 v23, v42, v43
    v_add_f32 v22, v22, v44
    v_add_f32 v23, v23, v45
    v_add_f32 v22, v22, v46
    v_add_f32 v23, v23, v47
    v_add_f32 v22, v22, v48
    v_add_f32 v23, v23, v49
    v_add_f32 v22, v22, v50
    v_add_f32 v23, v23, v51
    v_add_f32 v22, v22, v52
    v_add_f32 v23, v23, v53
    v_add_f32 v22, v22, v54
    v_add_f32 v23, v23, v55
    v_cvt_pk_bf16_f32 v144, v40, v41
    v_cvt_pk_bf16_f32 v145, v42, v43
    v_cvt_pk_bf16_f32 v146, v44, v45
    v_cvt_pk_bf16_f32 v147, v46, v47
    v_cvt_pk_bf16_f32 v148, v48, v49
    v_cvt_pk_bf16_f32 v149, v50, v51
    v_cvt_pk_bf16_f32 v150, v52, v53
    v_cvt_pk_bf16_f32 v151, v54, v55
    v_and_b32 v136, v144, v12
    v_and_b32 v137, v145, v13
    v_and_b32 v138, v146, v14
    v_and_b32 v139, v147, v15
    v_and_b32 v140, v148, v16
    v_and_b32 v141, v149, v17
    v_and_b32 v142, v150, v18
    v_and_b32 v143, v151, v19
    v_xor_b32 v144, v144, v136
    v_xor_b32 v145, v145, v137
    v_xor_b32 v146, v146, v138
    v_xor_b32 v147, v147, v139
    v_xor_b32 v148, v148, v140
    v_xor_b32 v149, v149, v141
    v_xor_b32_e64 v150, v150, v142
    v_xor_b32 v151, v151, v143
    s_waitcnt lgkmcnt(2)
    v_mfma_f32_32x32x16_bf16 v[88:103], v[120:123], v[136:139], 0
    v_mfma_f32_32x32x16_bf16 v[88:103], v[124:127], v[140:143], v[88:103]
    v_mfma_f32_32x32x16_bf16 v[88:103], v[128:131], v[144:147], v[88:103]
    v_mfma_f32_32x32x16_bf16 v[88:103], v[132:135], v[148:151], v[88:103]
    ds_read_b128 v[128:131], v20 offset:30720
    ds_read_b128 v[132:135], v20 offset:31744
    s_cmp_eq_u32 s76, 1
    s_cbranch_scc0 ng_156
    v_mov_b32 v24, 0xf149f2ca
    v_mov_b32 v25, 0xf149f2ca
    v_mov_b32 v26, 0xf149f2ca
    v_mov_b32 v27, 0xf149f2ca
    v_mov_b32 v28, 0xf149f2ca
    v_mov_b32 v29, 0xf149f2ca
    v_mov_b32 v30, 0xf149f2ca
    v_mov_b32 v31, 0xf149f2ca
    v_mov_b32 v32, 0xf149f2ca
    v_mov_b32 v33, 0xf149f2ca
    v_mov_b32 v34, 0xf149f2ca
    v_mov_b32 v35, 0xf149f2ca
    v_mov_b32 v36, 0xf149f2ca
    v_mov_b32 v37, 0xf149f2ca
    v_mov_b32 v38, 0xf149f2ca
    v_mov_b32 v39, 0xf149f2ca
ng_156:
    s_waitcnt lgkmcnt(2)
    s_nop 0
    v_mfma_f32_32x32x16_bf16 v[56:71], v[104:107], v[4:7], v[24:39]
    v_mfma_f32_32x32x16_bf16 v[56:71], v[108:111], v[8:11], v[56:71]
    ds_read_b128 v[112:115], v20 offset:20480
    ds_read_b128 v[116:119], v20 offset:21504
    v_exp_f32 v72, v72
    v_exp_f32 v73, v73
    v_exp_f32 v74, v74
    v_exp_f32 v75, v75
    v_exp_f32 v76, v76
    v_exp_f32 v77, v77
    v_exp_f32 v78, v78
    v_exp_f32 v79, v79
    v_exp_f32 v80, v80
    v_exp_f32 v81, v81
    v_exp_f32 v82, v82
    v_exp_f32 v83, v83
    v_exp_f32 v84, v84
    v_exp_f32 v85, v85
    v_exp_f32 v86, v86
    v_exp_f32 v87, v87
    v_add_f32 v22, v22, v72
    v_add_f32 v23, v23, v73
    v_add_f32 v22, v22, v74
    v_add_f32 v23, v23, v75
    v_add_f32 v22, v22, v76
    v_add_f32 v23, v23, v77
    v_add_f32 v22, v22, v78
    v_add_f32 v23, v23, v79
    v_add_f32 v22, v22, v80
    v_add_f32 v23, v23, v81
    v_add_f32 v22, v22, v82
    v_add_f32 v23, v23, v83
    v_add_f32 v22, v22, v84
    v_add_f32 v23, v23, v85
    v_add_f32_e64 v22, v22, v86
    v_add_f32 v23, v23, v87
    v_cvt_pk_bf16_f32 v144, v72, v73
    v_cvt_pk_bf16_f32 v145, v74, v75
    v_cvt_pk_bf16_f32 v146, v76, v77
    v_cvt_pk_bf16_f32 v147, v78, v79
    v_cvt_pk_bf16_f32 v148, v80, v81
    v_cvt_pk_bf16_f32 v149, v82, v83
    v_cvt_pk_bf16_f32 v150, v84, v85
    v_cvt_pk_bf16_f32 v151, v86, v87
    s_waitcnt lgkmcnt(2)
    v_mfma_f32_32x32x16_bf16 v[88:103], v[128:131], v[144:147], v[88:103]
    v_mfma_f32_32x32x16_bf16 v[88:103], v[132:135], v[148:151], v[88:103]
    ds_read_b128 v[120:123], v20 offset:26624
    ds_read_b128 v[124:127], v20 offset:27648
    s_cmp_eq_u32 s76, 2
    s_cbranch_scc0 ng_157
    v_mov_b32 v24, 0xf149f2ca
    v_mov_b32 v25, 0xf149f2ca
    v_mov_b32 v26, 0xf149f2ca
    v_mov_b32 v27, 0xf149f2ca
    v_mov_b32 v28, 0xf149f2ca
    v_mov_b32 v29, 0xf149f2ca
    v_mov_b32 v30, 0xf149f2ca
    v_mov_b32 v31, 0xf149f2ca
    v_mov_b32 v32, 0xf149f2ca
    v_mov_b32 v33, 0xf149f2ca
    v_mov_b32 v34, 0xf149f2ca
    v_mov_b32 v35, 0xf149f2ca
    v_mov_b32 v36, 0xf149f2ca
    v_mov_b32 v37, 0xf149f2ca
    v_mov_b32 v38, 0xf149f2ca
    v_mov_b32 v39, 0xf149f2ca
ng_157:
    s_waitcnt lgkmcnt(2)
    s_nop 0
    v_mfma_f32_32x32x16_bf16 v[72:87], v[112:115], v[4:7], v[24:39]
    v_mfma_f32_32x32x16_bf16 v[72:87], v[116:119], v[8:11], v[72:87]
    ds_read_b128 v[104:107], v20 offset:16384
    ds_read_b128 v[108:111], v20 offset:17408
    v_exp_f32 v56, v56
    v_exp_f32 v57, v57
    v_exp_f32 v58, v58
    v_exp_f32 v59, v59
    v_exp_f32 v60, v60
    v_exp_f32 v61, v61
    v_exp_f32 v62, v62
    v_exp_f32 v63, v63
    v_exp_f32 v64, v64
    v_exp_f32 v65, v65
    v_exp_f32 v66, v66
    v_exp_f32 v67, v67
    v_exp_f32 v68, v68
    v_exp_f32 v69, v69
    v_exp_f32 v70, v70
    v_exp_f32 v71, v71
    v_add_f32 v22, v22, v56
    v_add_f32 v23, v23, v57
    v_add_f32 v22, v22, v58
    v_add_f32 v23, v23, v59
    v_add_f32 v22, v22, v60
    v_add_f32 v23, v23, v61
    v_add_f32 v22, v22, v62
    v_add_f32 v23, v23, v63
    v_add_f32 v22, v22, v64
    v_add_f32 v23, v23, v65
    v_add_f32 v22, v22, v66
    v_add_f32 v23, v23, v67
    v_add_f32 v22, v22, v68
    v_add_f32 v23, v23, v69
    v_add_f32_e64 v22, v22, v70
    v_add_f32 v23, v23, v71
    v_cvt_pk_bf16_f32 v136, v56, v57
    v_cvt_pk_bf16_f32 v137, v58, v59
    v_cvt_pk_bf16_f32 v138, v60, v61
    v_cvt_pk_bf16_f32 v139, v62, v63
    v_cvt_pk_bf16_f32 v140, v64, v65
    v_cvt_pk_bf16_f32 v141, v66, v67
    v_cvt_pk_bf16_f32 v142, v68, v69
    v_cvt_pk_bf16_f32 v143, v70, v71
    s_waitcnt lgkmcnt(2)
    v_mfma_f32_32x32x16_bf16 v[88:103], v[120:123], v[136:139], v[88:103]
    v_mfma_f32_32x32x16_bf16 v[88:103], v[124:127], v[140:143], v[88:103]
    ds_read_b128 v[128:131], v20 offset:22528
    ds_read_b128 v[132:135], v20 offset:23552
    s_cmp_eq_u32 s76, 3
    s_cbranch_scc0 ng_158
    v_mov_b32 v24, 0xf149f2ca
    v_mov_b32 v25, 0xf149f2ca
    v_mov_b32 v26, 0xf149f2ca
    v_mov_b32 v27, 0xf149f2ca
    v_mov_b32 v28, 0xf149f2ca
    v_mov_b32 v29, 0xf149f2ca
    v_mov_b32 v30, 0xf149f2ca
    v_mov_b32 v31, 0xf149f2ca
    v_mov_b32 v32, 0xf149f2ca
    v_mov_b32 v33, 0xf149f2ca
    v_mov_b32 v34, 0xf149f2ca
    v_mov_b32 v35, 0xf149f2ca
    v_mov_b32 v36, 0xf149f2ca
    v_mov_b32 v37, 0xf149f2ca
    v_mov_b32 v38, 0xf149f2ca
    v_mov_b32 v39, 0xf149f2ca
ng_158:
    s_waitcnt lgkmcnt(2)
    s_nop 0
    v_mfma_f32_32x32x16_bf16 v[56:71], v[104:107], v[4:7], v[24:39]
    v_mfma_f32_32x32x16_bf16 v[56:71], v[108:111], v[8:11], v[56:71]
    ds_read_b128 v[112:115], v20 offset:12288
    ds_read_b128 v[116:119], v20 offset:13312
    v_exp_f32 v72, v72
    v_exp_f32 v73, v73
    v_exp_f32 v74, v74
    v_exp_f32 v75, v75
    v_exp_f32 v76, v76
    v_exp_f32 v77, v77
    v_exp_f32 v78, v78
    v_exp_f32 v79, v79
    v_exp_f32 v80, v80
    v_exp_f32 v81, v81
    v_exp_f32 v82, v82
    v_exp_f32 v83, v83
    v_exp_f32 v84, v84
    v_exp_f32 v85, v85
    v_exp_f32 v86, v86
    v_exp_f32 v87, v87
    v_add_f32 v22, v22, v72
    v_add_f32 v23, v23, v73
    v_add_f32 v22, v22, v74
    v_add_f32 v23, v23, v75
    v_add_f32 v22, v22, v76
    v_add_f32 v23, v23, v77
    v_add_f32 v22, v22, v78
    v_add_f32 v23, v23, v79
    v_add_f32 v22, v22, v80
    v_add_f32 v23, v23, v81
    v_add_f32 v22, v22, v82
    v_add_f32 v23, v23, v83
    v_add_f32 v22, v22, v84
    v_add_f32 v23, v23, v85
    v_add_f32_e64 v22, v22, v86
    v_add_f32 v23, v23, v87
    v_cvt_pk_bf16_f32 v144, v72, v73
    v_cvt_pk_bf16_f32 v145, v74, v75
    v_cvt_pk_bf16_f32 v146, v76, v77
    v_cvt_pk_bf16_f32 v147, v78, v79
    v_cvt_pk_bf16_f32 v148, v80, v81
    v_cvt_pk_bf16_f32 v149, v82, v83
    v_cvt_pk_bf16_f32 v150, v84, v85
    v_cvt_pk_bf16_f32 v151, v86, v87
    s_waitcnt lgkmcnt(2)
    v_mfma_f32_32x32x16_bf16 v[88:103], v[128:131], v[144:147], v[88:103]
    v_mfma_f32_32x32x16_bf16 v[88:103], v[132:135], v[148:151], v[88:103]
    ds_read_b128 v[120:123], v20 offset:18432
    ds_read_b128 v[124:127], v20 offset:19456
    s_cmp_eq_u32 s76, 4
    s_cbranch_scc0 ng_159
    v_mov_b32 v24, 0xf149f2ca
    v_mov_b32 v25, 0xf149f2ca
    v_mov_b32 v26, 0xf149f2ca
    v_mov_b32 v27, 0xf149f2ca
    v_mov_b32 v28, 0xf149f2ca
    v_mov_b32 v29, 0xf149f2ca
    v_mov_b32 v30, 0xf149f2ca
    v_mov_b32 v31, 0xf149f2ca
    v_mov_b32 v32, 0xf149f2ca
    v_mov_b32 v33, 0xf149f2ca
    v_mov_b32 v34, 0xf149f2ca
    v_mov_b32 v35, 0xf149f2ca
    v_mov_b32 v36, 0xf149f2ca
    v_mov_b32 v37, 0xf149f2ca
    v_mov_b32 v38, 0xf149f2ca
    v_mov_b32 v39, 0xf149f2ca
ng_159:
    s_waitcnt lgkmcnt(2)
    s_nop 0
    v_mfma_f32_32x32x16_bf16 v[72:87], v[112:115], v[4:7], v[24:39]
    v_mfma_f32_32x32x16_bf16 v[72:87], v[116:119], v[8:11], v[72:87]
    ds_read_b128 v[104:107], v20 offset:8192
    ds_read_b128 v[108:111], v20 offset:9216
    v_exp_f32 v56, v56
    v_exp_f32 v57, v57
    v_exp_f32 v58, v58
    v_exp_f32 v59, v59
    v_exp_f32 v60, v60
    v_exp_f32 v61, v61
    v_exp_f32 v62, v62
    v_exp_f32 v63, v63
    v_exp_f32 v64, v64
    v_exp_f32 v65, v65
    v_exp_f32 v66, v66
    v_exp_f32 v67, v67
    v_exp_f32 v68, v68
    v_exp_f32 v69, v69
    v_exp_f32 v70, v70
    v_exp_f32 v71, v71
    v_add_f32 v22, v22, v56
    v_add_f32 v23, v23, v57
    v_add_f32 v22, v22, v58
    v_add_f32 v23, v23, v59
    v_add_f32 v22, v22, v60
    v_add_f32 v23, v23, v61
    v_add_f32 v22, v22, v62
    v_add_f32 v23, v23, v63
    v_add_f32 v22, v22, v64
    v_add_f32 v23, v23, v65
    v_add_f32 v22, v22, v66
    v_add_f32 v23, v23, v67
    v_add_f32 v22, v22, v68
    v_add_f32 v23, v23, v69
    v_add_f32_e64 v22, v22, v70
    v_add_f32 v23, v23, v71
    v_cvt_pk_bf16_f32 v136, v56, v57
    v_cvt_pk_bf16_f32 v137, v58, v59
    v_cvt_pk_bf16_f32 v138, v60, v61
    v_cvt_pk_bf16_f32 v139, v62, v63
    v_cvt_pk_bf16_f32 v140, v64, v65
    v_cvt_pk_bf16_f32 v141, v66, v67
    v_cvt_pk_bf16_f32 v142, v68, v69
    v_cvt_pk_bf16_f32 v143, v70, v71
    s_waitcnt lgkmcnt(2)
    v_mfma_f32_32x32x16_bf16 v[88:103], v[120:123], v[136:139], v[88:103]
    v_mfma_f32_32x32x16_bf16 v[88:103], v[124:127], v[140:143], v[88:103]
    ds_read_b128 v[128:131], v20 offset:14336
    ds_read_b128 v[132:135], v20 offset:15360
    s_cmp_eq_u32 s76, 5
    s_cbranch_scc0 ng_160
    v_mov_b32 v24, 0xf149f2ca
    v_mov_b32 v25, 0xf149f2ca
    v_mov_b32 v26, 0xf149f2ca
    v_mov_b32 v27, 0xf149f2ca
    v_mov_b32 v28, 0xf149f2ca
    v_mov_b32 v29, 0xf149f2ca
    v_mov_b32 v30, 0xf149f2ca
    v_mov_b32 v31, 0xf149f2ca
    v_mov_b32 v32, 0xf149f2ca
    v_mov_b32 v33, 0xf149f2ca
    v_mov_b32 v34, 0xf149f2ca
    v_mov_b32 v35, 0xf149f2ca
    v_mov_b32 v36, 0xf149f2ca
    v_mov_b32 v37, 0xf149f2ca
    v_mov_b32 v38, 0xf149f2ca
    v_mov_b32 v39, 0xf149f2ca
ng_160:
    s_waitcnt lgkmcnt(2)
    s_nop 0
    v_mfma_f32_32x32x16_bf16 v[56:71], v[104:107], v[4:7], v[24:39]
    v_mfma_f32_32x32x16_bf16 v[56:71], v[108:111], v[8:11], v[56:71]
    ds_read_b128 v[112:115], v20 offset:4096
    ds_read_b128 v[116:119], v20 offset:5120
    v_exp_f32 v72, v72
    v_exp_f32 v73, v73
    v_exp_f32 v74, v74
    v_exp_f32 v75, v75
    v_exp_f32 v76, v76
    v_exp_f32 v77, v77
    v_exp_f32 v78, v78
    v_exp_f32 v79, v79
    v_exp_f32 v80, v80
    v_exp_f32 v81, v81
    v_exp_f32 v82, v82
    v_exp_f32 v83, v83
    v_exp_f32 v84, v84
    v_exp_f32 v85, v85
    v_exp_f32 v86, v86
    v_exp_f32 v87, v87
    v_add_f32 v22, v22, v72
    v_add_f32 v23, v23, v73
    v_add_f32 v22, v22, v74
    v_add_f32 v23, v23, v75
    v_add_f32 v22, v22, v76
    v_add_f32 v23, v23, v77
    v_add_f32 v22, v22, v78
    v_add_f32 v23, v23, v79
    v_add_f32 v22, v22, v80
    v_add_f32 v23, v23, v81
    v_add_f32 v22, v22, v82
    v_add_f32 v23, v23, v83
    v_add_f32 v22, v22, v84
    v_add_f32 v23, v23, v85
    v_add_f32_e64 v22, v22, v86
    v_add_f32 v23, v23, v87
    v_cvt_pk_bf16_f32 v144, v72, v73
    v_cvt_pk_bf16_f32 v145, v74, v75
    v_cvt_pk_bf16_f32 v146, v76, v77
    v_cvt_pk_bf16_f32 v147, v78, v79
    v_cvt_pk_bf16_f32 v148, v80, v81
    v_cvt_pk_bf16_f32 v149, v82, v83
    v_cvt_pk_bf16_f32 v150, v84, v85
    v_cvt_pk_bf16_f32 v151, v86, v87
    s_waitcnt lgkmcnt(2)
    v_mfma_f32_32x32x16_bf16 v[88:103], v[128:131], v[144:147], v[88:103]
    v_mfma_f32_32x32x16_bf16 v[88:103], v[132:135], v[148:151], v[88:103]
    ds_read_b128 v[120:123], v20 offset:10240
    ds_read_b128 v[124:127], v20 offset:11264
    s_cmp_eq_u32 s76, 6
    s_cbranch_scc0 ng_161
    v_mov_b32 v24, 0xf149f2ca
    v_mov_b32 v25, 0xf149f2ca
    v_mov_b32 v26, 0xf149f2ca
    v_mov_b32 v27, 0xf149f2ca
    v_mov_b32 v28, 0xf149f2ca
    v_mov_b32 v29, 0xf149f2ca
    v_mov_b32 v30, 0xf149f2ca
    v_mov_b32 v31, 0xf149f2ca
    v_mov_b32 v32, 0xf149f2ca
    v_mov_b32 v33, 0xf149f2ca
    v_mov_b32 v34, 0xf149f2ca
    v_mov_b32 v35, 0xf149f2ca
    v_mov_b32 v36, 0xf149f2ca
    v_mov_b32 v37, 0xf149f2ca
    v_mov_b32 v38, 0xf149f2ca
    v_mov_b32 v39, 0xf149f2ca
ng_161:
    s_waitcnt lgkmcnt(2)
    s_nop 0
    v_mfma_f32_32x32x16_bf16 v[72:87], v[112:115], v[4:7], v[24:39]
    v_mfma_f32_32x32x16_bf16 v[72:87], v[116:119], v[8:11], v[72:87]
    v_exp_f32 v56, v56
    v_exp_f32 v57, v57
    v_exp_f32 v58, v58
    v_exp_f32 v59, v59
    v_exp_f32 v60, v60
    v_exp_f32 v61, v61
    v_exp_f32 v62, v62
    v_exp_f32 v63, v63
    v_exp_f32 v64, v64
    v_exp_f32 v65, v65
    v_exp_f32 v66, v66
    v_exp_f32 v67, v67
    v_exp_f32 v68, v68
    v_exp_f32 v69, v69
    v_exp_f32 v70, v70
    v_exp_f32 v71, v71
    v_add_f32 v22, v22, v56
    v_add_f32 v23, v23, v57
    v_add_f32 v22, v22, v58
    v_add_f32 v23, v23, v59
    v_add_f32 v22, v22, v60
    v_add_f32 v23, v23, v61
    v_add_f32 v22, v22, v62
    v_add_f32 v23, v23, v63
    v_add_f32 v22, v22, v64
    v_add_f32 v23, v23, v65
    v_add_f32 v22, v22, v66
    v_add_f32 v23, v23, v67
    v_add_f32 v22, v22, v68
    v_add_f32 v23, v23, v69
    v_add_f32 v22, v22, v70
    v_add_f32 v23, v23, v71
    v_cvt_pk_bf16_f32 v136, v56, v57
    v_cvt_pk_bf16_f32 v137, v58, v59
    v_cvt_pk_bf16_f32 v138, v60, v61
    v_cvt_pk_bf16_f32 v139, v62, v63
    v_cvt_pk_bf16_f32 v140, v64, v65
    v_cvt_pk_bf16_f32 v141, v66, v67
    v_cvt_pk_bf16_f32 v142, v68, v69
    v_cvt_pk_bf16_f32 v143, v70, v71
    s_waitcnt lgkmcnt(0)
    v_mfma_f32_32x32x16_bf16 v[88:103], v[120:123], v[136:139], v[88:103]
    v_mfma_f32_32x32x16_bf16 v[88:103], v[124:127], v[140:143], v[88:103]
    ds_read_b128 v[128:131], v20 offset:6144
    ds_read_b128 v[132:135], v20 offset:7168
    v_exp_f32 v72, v72
    v_exp_f32 v73, v73
    v_exp_f32 v74, v74
    v_exp_f32 v75, v75
    v_exp_f32 v76, v76
    v_exp_f32 v77, v77
    v_exp_f32 v78, v78
    v_exp_f32 v79, v79
    v_exp_f32 v80, v80
    v_exp_f32 v81, v81
    v_exp_f32 v82, v82
    v_exp_f32 v83, v83
    v_exp_f32 v84, v84
    v_exp_f32 v85, v85
    v_exp_f32 v86, v86
    v_exp_f32 v87, v87
    v_add_f32 v22, v22, v72
    v_add_f32 v23, v23, v73
    v_add_f32 v22, v22, v74
    v_add_f32 v23, v23, v75
    v_add_f32 v22, v22, v76
    v_add_f32 v23, v23, v77
    v_add_f32 v22, v22, v78
    v_add_f32 v23, v23, v79
    v_add_f32 v22, v22, v80
    v_add_f32 v23, v23, v81
    v_add_f32 v22, v22, v82
    v_add_f32 v23, v23, v83
    v_add_f32 v22, v22, v84
    v_add_f32 v23, v23, v85
    v_add_f32 v22, v22, v86
    v_add_f32_e64 v23, v23, v87
    v_cvt_pk_bf16_f32 v144, v72, v73
    v_cvt_pk_bf16_f32 v145, v74, v75
    v_cvt_pk_bf16_f32 v146, v76, v77
    v_cvt_pk_bf16_f32 v147, v78, v79
    v_cvt_pk_bf16_f32 v148, v80, v81
    v_cvt_pk_bf16_f32 v149, v82, v83
    v_cvt_pk_bf16_f32 v150, v84, v85
    v_cvt_pk_bf16_f32 v151, v86, v87
    s_waitcnt lgkmcnt(0)
    v_mfma_f32_32x32x16_bf16 v[88:103], v[128:131], v[144:147], v[88:103]
    v_mfma_f32_32x32x16_bf16 v[88:103], v[132:135], v[148:151], v[88:103]
    v_add_f32 v22, v22, v23
    v_mov_b32 v152, v22
    s_nop 1
    v_permlane32_swap_b32 v22, v152
    v_add_f32 v22, v22, v152
    v_rcp_f32 v22, v22
    s_lshl_b32 s33, s25, 11
    s_add_u32 s33, s33, s36
    s_branch att_ret1
.section .rodata,"a"
.p2align 6
.amdhsa_kernel interleave_layers__sliding_block__moe_arch_mod__prompt_kernel
  .amdhsa_next_free_vgpr 256
  .amdhsa_next_free_sgpr 102
  .amdhsa_accum_offset 256
  .amdhsa_group_segment_fixed_size 0
  .amdhsa_kernarg_size 88
  .amdhsa_user_sgpr_count 2
  .amdhsa_user_sgpr_kernarg_segment_ptr 1
  .amdhsa_system_sgpr_workgroup_id_x 1
.end_amdhsa_kernel
```

```asm
; @launch grid=(256,1,1) block=(512,1,1) lds=163840
.amdgcn_target "amdgcn-amd-amdhsa--gfx950"
.text
.globl interleave_layers__sliding_block__moe_arch_mod__prompt_kernel
.p2align 8
.type interleave_layers__sliding_block__moe_arch_mod__prompt_kernel,@function
interleave_layers__sliding_block__moe_arch_mod__prompt_kernel:
    s_cmp_ge_u32 s2, 256
    s_cbranch_scc1 k_exit
    s_load_dwordx4 s[4:7], s[0:1], 0
    s_load_dwordx2 s[8:9], s[0:1], 16
    s_load_dwordx2 s[20:21], s[0:1], 80
    s_load_dwordx2 s[80:81], s[0:1], 32
    v_lshrrev_b32 v1, 6, v0
    v_and_b32 v252, 63, v0
    v_readfirstlane_b32 s3, v1
    v_lshlrev_b32 v253, 4, v252
    s_and_b32 s30, s2, 7
    s_lshr_b32 s31, s2, 3
    s_and_b32 s32, s31, 1
    s_lshl_b32 s33, s30, 1
    s_add_u32 s24, s33, s32
    s_lshr_b32 s25, s31, 1
    s_add_u32 s33, s33, s25
    s_add_u32 s94, s33, s32
    s_sub_u32 s95, s33, s32
    s_add_u32 s98, s95, 15
    s_and_b32 s98, s98, 15
    s_mul_i32 s29, s30, 28
    s_lshl_b32 s32, s30, 2
    s_add_u32 s32, s32, 196
    s_cmp_lt_u32 s31, 28
    s_cselect_b32 s29, s29, s32
    s_add_u32 s29, s29, s31
    s_lshl_b32 s72, s24, 4
    s_add_u32 s72, s72, s25
    s_mov_b32 s26, 0
    s_mov_b32 s27, 20000
    s_and_b32 s28, s3, 3
    s_lshl_b32 s99, s24, 2
    s_add_u32 s99, s99, s28
    s_lshl_b32 s101, s28, 10
    s_mov_b32 s18, 0x600000
    s_mov_b32 s19, 0x20000
    s_mov_b32 s10, 0x200000
    s_mov_b32 s11, 0x20000
    s_mov_b32 s22, 0x8000000
    s_mov_b32 s23, 0x20000
    s_mov_b32 s82, 0x800
    s_mov_b32 s83, 0x20000
    s_cmp_ge_u32 s3, 4
    s_cbranch_scc1 l_start
    s_getpc_b64 s[32:33]
pc_1:
    s_sub_u32 s32, s32, pc_1-interleave_layers__sliding_block__moe_arch_mod__prompt_kernel
    s_subb_u32 s33, s33, 0
    s_lshr_b32 s34, s2, 3
    s_lshl_b32 s34, s34, 2
    s_add_u32 s34, s34, s28
    s_and_b32 s34, s34, 63
    s_lshl_b32 s34, s34, 7
    v_lshl_add_u32 v191, v252, 13, s34
    s_mov_b32 s34, k_exit-interleave_layers__sliding_block__moe_arch_mod__prompt_kernel
    s_mov_b32 s35, 0x20000
    buffer_load_dword v191, v191, s[32:35], 0 offen
    s_load_dwordx4 s[36:39], s[0:1], 40
    s_load_dwordx2 s[74:75], s[0:1], 56
    s_waitcnt lgkmcnt(0)
    s_mov_b32 s88, 0xdd8000
    s_load_dword s88, s[20:21], s88
    s_mov_b64 s[16:17], s[6:7]
    s_mov_b32 s6, 0x400000
    s_mov_b32 s7, 0x20000
    s_lshr_b32 s30, s2, 3
    s_lshl_b32 s30, s30, 2
    s_add_u32 s30, s30, s3
    s_and_b32 s31, s2, 7
    v_mul_u32_u24 v4, 9363, v252
    v_lshrrev_b32 v4, 16, v4
    v_mul_u32_u24 v5, 7, v4
    v_sub_u32 v5, v252, v5
    v_min_u32_e64 v4, 7, v4
    v_lshl_add_u32 v4, v4, 7, s30
    v_mul_u32_u24 v6, 37, v5
    v_lshrrev_b32 v6, 8, v6
    v_mul_u32_u24 v7, 7, v6
    v_sub_u32 v5, v5, v7
    v_mad_u32_u24 v6, v6, 0, 0
    v_cmp_eq_u32_e64 vcc, 2, v6
    v_mov_b32 v7, 7168
    v_mov_b32 v8, 896
    v_cndmask_b32 v7, v7, v8, vcc
    v_mul_u32_u24 v4, v4, v7
    v_mul_u32_u24 v198, 1024, v7
    v_lshl_add_u32 v4, v5, 7, v4
    v_mov_b32 v7, 917504
    v_cndmask_b32_e64 v7, v8, v7, vcc
    v_mad_u32_u24 v4, v7, s31, v4
    v_mov_b32 v196, s36
    v_mov_b32 v7, s74
    v_cndmask_b32 v196, v196, v7, vcc
    v_mov_b32 v197, s37
    v_mov_b32 v7, s75
    v_cndmask_b32 v197, v197, v7, vcc
    v_cmp_eq_u32 vcc, 1, v6
    v_mov_b32 v7, s38
    s_nop 0
    v_cndmask_b32 v196, v196, v7, vcc
    v_mov_b32 v7, s39
    v_cndmask_b32 v197, v197, v7, vcc
    v_add_co_u32 v196, vcc, v196, v4
    s_nop 1
    v_addc_co_u32 v197, vcc, 0, v197, vcc
    s_mov_b32 s30, 0x1000100
    s_mov_b32 s31, 0x1000100
    s_lshl_b32 s86, s3, 4
    s_lshr_b64 s[30:31], s[30:31], s86
    s_and_b32 s86, s30, 0xffff
    s_mul_i32 s30, s25, 6
    s_lshr_b32 s30, s30, 4
    s_lshr_b32 s86, s86, s30
    s_load_dwordx2 s[12:13], s[0:1], 64
    s_mov_b32 s14, 0x400000
    s_mov_b32 s15, 0x20000
    s_lshr_b32 s30, s16, 7
    s_sub_u32 s30, 3, s30
    s_and_b32 s30, s30, 7
    s_and_b32 s31, s24, 1
    s_lshl_b32 s31, s31, 3
    s_add_u32 s30, s30, s31
    s_and_b32 s31, s24, 14
    s_add_u32 s84, s31, s30
    s_lshl_b32 s31, s25, 2
    s_add_u32 s31, s31, s28
    s_mul_i32 s31, s31, 6144
    s_lshl_b32 s30, s30, 7
    s_add_u32 s30, s30, s31
    v_min_u32_e64 v190, 2, v252
    v_lshl_add_u32 v190, v190, 11, s30
    s_add_u32 s30, s84, 0
    s_and_b32 s30, s30, 15
    s_mul_i32 s30, s30, 393216
    buffer_load_dword v191, v190, s[16:19], s30 offen
    s_add_u32 s30, s84, 1
    s_and_b32 s30, s30, 15
    s_mul_i32 s30, s30, 393216
    buffer_load_dword v191, v190, s[16:19], s30 offen
    v_lshrrev_b32 v5, 5, v252
    v_lshlrev_b32 v6, 3, v5
    s_lshl_b32 s33, s98, 7
    buffer_load_dwordx2 v[224:225], v6, s[80:83], s33 offen offset:0
    buffer_load_dwordx2 v[226:227], v6, s[80:83], s33 offen offset:16
    buffer_load_dwordx2 v[228:229], v6, s[80:83], s33 offen offset:32
    buffer_load_dwordx2 v[230:231], v6, s[80:83], s33 offen offset:48
    buffer_load_dwordx2 v[232:233], v6, s[80:83], s33 offen offset:64
    buffer_load_dwordx2 v[234:235], v6, s[80:83], s33 offen offset:80
    buffer_load_dwordx2 v[236:237], v6, s[80:83], s33 offen offset:96
    buffer_load_dwordx2 v[238:239], v6, s[80:83], s33 offen offset:112
    s_mov_b32 s40, 0xffffffff
    s_mov_b32 s41, 0xfffffff0
    s_mov_b32 s42, 0xfffffffe
    s_mov_b32 s43, 0xffffffe0
    s_mov_b32 s44, 0xfffffffc
    s_mov_b32 s45, 0xffffffc0
    s_mov_b32 s46, 0xfffffff8
    s_mov_b32 s47, 0xffffff80
    s_mov_b32 s48, 0xffff0000
    s_mov_b32 s49, 0xfff00000
    s_mov_b32 s50, 0xfffe0000
    s_mov_b32 s51, 0xffe00000
    s_mov_b32 s52, 0xfffc0000
    s_mov_b32 s53, 0xffc00000
    s_mov_b32 s54, 0xfff80000
    s_mov_b32 s55, 0xff800000
    s_mov_b32 s56, 0xffffff00
    s_mov_b32 s57, 0xfffff000
    s_mov_b32 s58, 0xfffffe00
    s_mov_b32 s59, 0xffffe000
    s_mov_b32 s60, 0xfffffc00
    s_mov_b32 s61, 0xffffc000
    s_mov_b32 s62, 0xfffff800
    s_mov_b32 s63, 0xffff8000
    s_mov_b32 s64, 0xff000000
    s_mov_b32 s65, 0xf0000000
    s_mov_b32 s66, 0xfe000000
    s_mov_b32 s67, 0xe0000000
    s_mov_b32 s68, 0xfc000000
    s_mov_b32 s69, 0xc0000000
    s_mov_b32 s70, 0xf8000000
    s_mov_b32 s71, 0x80000000
    v_bfe_u32 v20, v252, 3, 2
    v_lshrrev_b32 v21, 5, v252
    v_lshl_add_u32 v20, v21, 3, v20
    s_lshr_b32 s32, s28, 1
    s_lshl_b32 s32, s32, 4
    s_and_b32 s33, s28, 1
    s_lshl_b32 s33, s33, 2
    s_add_u32 s32, s32, s33
    v_add_u32 v20, s32, v20
    v_lshlrev_b32 v20, 11, v20
    v_lshrrev_b32 v21, 2, v252
    v_and_b32 v21, 4, v21
    v_xor_b32 v21, v21, v252
    v_and_b32_e64 v21, 7, v21
    v_lshl_add_u32 v20, v21, 4, v20
    s_lshl_b32 s32, s98, 7
    v_add_u32 v243, s32, v20
    s_and_b32 s34, s3, 1
    s_lshr_b32 s35, s3, 1
    v_and_b32 v4, 15, v252
    v_lshrrev_b32 v7, 4, v252
    v_lshrrev_b32 v6, 1, v4
    v_xor_b32 v6, v6, v7
    v_lshlrev_b32_e64 v6, 4, v6
    v_lshl_add_u32 v6, v4, 7, v6
    s_lshl_b32 s30, s34, 13
    v_add_u32 v176, s30, v6
    v_xor_b32 v177, 64, v176
    s_lshl_b32 s30, s35, 1
    v_lshrrev_b32_e64 v20, 2, v252
    v_bfe_u32 v21, v20, 1, 2
    v_xor_b32 v21, s30, v21
    v_lshlrev_b32 v20, 7, v20
    v_lshl_add_u32 v20, v21, 5, v20
    v_and_b32_e64 v21, 3, v252
    v_lshl_add_u32 v20, v21, 3, v20
    v_add_u32 v178, 40960, v20
    v_xor_b32 v179, 32, v178
    v_and_b32 v8, 31, v252
    v_bfe_u32 v6, v8, 1, 3
    v_xor_b32 v6, v6, v5
    v_lshlrev_b32 v6, 4, v6
    v_lshl_add_u32 v6, v8, 7, v6
    s_lshl_b32 s30, s3, 12
    s_add_u32 s30, s30, 147456
    v_add_u32 v192, s30, v6
    v_xor_b32 v193, 32, v192
    v_xor_b32 v194, 64, v192
    v_xor_b32 v195, 96, v192
    s_lshl_b32 s30, s34, 8
    v_lshl_add_u32 v184, v4, 2, s30
    v_lshl_add_u32 v185, v7, 4, s30
    s_lshl_b32 s30, s35, 7
    v_lshl_add_u32 v186, v7, 4, s30
    s_add_u32 s30, s30, 1536
    v_lshl_add_u32 v187, v4, 2, s30
    s_lshl_b32 s30, s3, 7
    s_add_u32 s30, s30, 2048
    v_lshl_add_u32 v188, v8, 2, s30
    v_mov_b32 v189, 0
    v_lshlrev_b32_e64 v6, 9, v7
    v_lshl_add_u32 v245, v4, 4, v6
    v_and_b32_e64 v9, 8, v4
    v_lshl_add_u32 v244, v9, 4, v245
    s_mul_i32 s30, s35, 49152
    s_lshl_b32 s31, s34, 13
    s_add_u32 s30, s30, s31
    s_add_u32 s30, s30, 98304
    v_add_u32_e64 v246, s30, v244
    v_add_u32 v247, s30, v245
    s_lshl_b32 s30, s3, 12
    s_add_u32 s30, s30, 49152
    v_add_u32 v248, s30, v245
    s_getreg_b32 s30, hwreg(HW_REG_XCC_ID, 0, 4)
    v_mov_b32 v251, s30
    s_lshl_b32 s30, s25, 4
    s_add_u32 s30, s30, s24
    s_sub_u32 s30, s30, s72
    s_add_u32 s30, s30, 512
    v_mul_u32_u24 v249, s30, v252
    v_add_u32 v249, s72, v249
    v_lshlrev_b32 v249, 3, v249
    s_cmp_eq_u32 s3, 0
    s_cselect_b32 s89, 10, -1
    v_mov_b32 v242, 0
    v_mov_b32 v0, 0
    v_mov_b32 v1, 0
    v_mov_b32 v2, 0
    v_mov_b32 v3, 0
    v_mov_b32 v4, 0
    v_mov_b32 v5, 0
    v_mov_b32 v6, 0
    v_mov_b32 v7, 0
    v_mov_b32 v8, 0
    v_mov_b32 v9, 0
    v_mov_b32 v10, 0
    v_mov_b32 v11, 0
    v_mov_b32 v12, 0
    v_mov_b32 v13, 0
    v_mov_b32 v14, 0
    v_mov_b32 v15, 0
    v_mov_b32 v16, 0
    v_mov_b32 v17, 0
    v_mov_b32 v18, 0
    v_mov_b32 v19, 0
    v_mov_b32 v20, 0
    v_mov_b32 v21, 0
    v_mov_b32 v22, 0
    v_mov_b32 v23, 0
    v_mov_b32 v24, 0
    v_mov_b32 v25, 0
    v_mov_b32 v26, 0
    v_mov_b32 v27, 0
    v_mov_b32 v28, 0
    v_mov_b32 v29, 0
    v_mov_b32 v30, 0
    v_mov_b32 v31, 0
    v_mov_b32 v32, 0
    v_mov_b32 v33, 0
    v_mov_b32 v34, 0
    v_mov_b32 v35, 0
    v_mov_b32 v36, 0
    v_mov_b32 v37, 0
    v_mov_b32 v38, 0
    v_mov_b32 v39, 0
    v_mov_b32 v40, 0
    v_mov_b32 v41, 0
    v_mov_b32 v42, 0
    v_mov_b32 v43, 0
    v_mov_b32 v44, 0
    v_mov_b32 v45, 0
    v_mov_b32 v46, 0
    v_mov_b32 v47, 0
    v_mov_b32 v48, 0
    v_mov_b32 v49, 0
    v_mov_b32 v50, 0
    v_mov_b32 v51, 0
    v_mov_b32 v52, 0
    v_mov_b32 v53, 0
    v_mov_b32 v54, 0
    v_mov_b32 v55, 0
    v_mov_b32 v56, 0
    v_mov_b32 v57, 0
    v_mov_b32 v58, 0
    v_mov_b32 v59, 0
    v_mov_b32 v60, 0
    v_mov_b32 v61, 0
    v_mov_b32 v62, 0
    v_mov_b32 v63, 0
    v_mov_b32 v64, 0
    v_mov_b32 v65, 0
    v_mov_b32 v66, 0
    v_mov_b32 v67, 0
    v_mov_b32 v68, 0
    v_mov_b32 v69, 0
    v_mov_b32 v70, 0
    v_mov_b32 v71, 0
    v_mov_b32 v72, 0
    v_mov_b32 v73, 0
    v_mov_b32 v74, 0
    v_mov_b32 v75, 0
    v_mov_b32 v76, 0
    v_mov_b32 v77, 0
    v_mov_b32 v78, 0
    v_mov_b32 v79, 0
    v_mov_b32 v80, 0
    v_mov_b32 v81, 0
    v_mov_b32 v82, 0
    v_mov_b32 v83, 0
    v_mov_b32 v84, 0
    v_mov_b32 v85, 0
    v_mov_b32 v86, 0
    v_mov_b32 v87, 0
    v_mov_b32 v88, 0
    v_mov_b32 v89, 0
    v_mov_b32 v90, 0
    v_mov_b32 v91, 0
    v_mov_b32 v92, 0
    v_mov_b32 v93, 0
    v_mov_b32_e64 v94, 0
    v_mov_b32 v95, 0
    s_waitcnt vmcnt(0) lgkmcnt(0)
    s_add_u32 s88, s88, 0x9e3779b9
    v_mov_b32_e64 v250, s88
    v_dot2c_f32_bf16 v242, 0x3f803f80, v224
    v_dot2c_f32_bf16 v242, 0x3f803f80, v225
    v_dot2c_f32_bf16 v242, 0x3f803f80, v226
    v_dot2c_f32_bf16 v242, 0x3f803f80, v227
    v_dot2c_f32_bf16 v242, 0x3f803f80, v228
    v_dot2c_f32_bf16 v242, 0x3f803f80, v229
    v_dot2c_f32_bf16 v242, 0x3f803f80, v230
    v_dot2c_f32_bf16 v242, 0x3f803f80, v231
    v_dot2c_f32_bf16 v242, 0x3f803f80, v232
    v_dot2c_f32_bf16 v242, 0x3f803f80, v233
    v_dot2c_f32_bf16 v242, 0x3f803f80, v234
    v_dot2c_f32_bf16 v242, 0x3f803f80, v235
    v_dot2c_f32_bf16 v242, 0x3f803f80, v236
    v_dot2c_f32_bf16 v242, 0x3f803f80, v237
    v_dot2c_f32_bf16 v242, 0x3f803f80, v238
    v_dot2c_f32_bf16 v242, 0x3f803f80, v239
    s_add_u32 s30, s84, 2
    s_and_b32 s30, s30, 15
    s_mul_i32 s30, s30, 393216
    buffer_load_dword v191, v190, s[16:19], s30 offen
    s_add_u32 s30, s84, 3
    s_and_b32 s30, s30, 15
    s_mul_i32 s30, s30, 393216
    buffer_load_dword v191, v190, s[16:19], s30 offen
    s_add_u32 s30, s84, 4
    s_and_b32 s30, s30, 15
    s_mul_i32 s30, s30, 393216
    buffer_load_dword v191, v190, s[16:19], s30 offen
    s_add_u32 s30, s84, 5
    s_and_b32 s30, s30, 15
    s_mul_i32 s30, s30, 393216
    buffer_load_dword v191, v190, s[16:19], s30 offen
    s_setprio 1
e_q:
    s_mov_b32 s31, 0
    s_mov_b32 s32, 147456
    s_mov_b32 s36, 15
    v_add_u32 v180, s32, v176
    v_mov_b32 v182, v178
    v_add_u32 v181, s32, v177
    v_mov_b32 v183, v179
    s_barrier
    ds_read_b128 v[96:99], v180 offset:0
    ds_read_b64_tr_b16 v[112:113], v182 offset:0
    ds_read_b64_tr_b16 v[114:115], v182 offset:2048
    ds_read_b128 v[100:103], v180 offset:2048
    ds_read_b128 v[104:107], v180 offset:4096
    ds_read_b128 v[108:111], v180 offset:6144
    ds_read_b64_tr_b16 v[116:117], v183 offset:0
    ds_read_b64_tr_b16 v[118:119], v183 offset:2048
    ds_read_b64_tr_b16 v[120:121], v182 offset:8192
    ds_read_b64_tr_b16 v[122:123], v182 offset:10240
    ds_read_b64_tr_b16 v[124:125], v183 offset:8192
    ds_read_b64_tr_b16 v[126:127], v183 offset:10240
    ds_read_b64_tr_b16 v[128:129], v182 offset:16384
    ds_read_b64_tr_b16 v[130:131], v182 offset:18432
    ds_read_b64_tr_b16 v[132:133], v183 offset:16384
    ds_read_b64_tr_b16 v[134:135], v183 offset:18432
    s_add_u32 s85, s84, 5
e_loop:
    s_waitcnt lgkmcnt(0)
    v_mfma_f32_16x16x32_bf16 v[0:3], v[112:115], v[96:99], v[0:3]
    ds_read_b128 v[136:139], v181 offset:0
    v_mfma_f32_16x16x32_bf16 v[8:11], v[112:115], v[100:103], v[8:11]
    ds_read_b64_tr_b16 v[152:153], v182 offset:4096
    v_mfma_f32_16x16x32_bf16 v[16:19], v[112:115], v[104:107], v[16:19]
    ds_read_b64_tr_b16 v[154:155], v182 offset:6144
    v_mfma_f32_16x16x32_bf16 v[24:27], v[112:115], v[108:111], v[24:27]
    ds_read_b128 v[140:143], v181 offset:2048
    v_mfma_f32_16x16x32_bf16 v[28:31], v[116:119], v[108:111], v[28:31]
    ds_read_b128 v[144:147], v181 offset:4096
    v_mfma_f32_16x16x32_bf16 v[20:23], v[116:119], v[104:107], v[20:23]
    ds_read_b128 v[148:151], v181 offset:6144
    v_mfma_f32_16x16x32_bf16 v[12:15], v[116:119], v[100:103], v[12:15]
    ds_read_b64_tr_b16 v[156:157], v183 offset:4096
    v_mfma_f32_16x16x32_bf16 v[4:7], v[116:119], v[96:99], v[4:7]
    ds_read_b64_tr_b16 v[158:159], v183 offset:6144
    v_mfma_f32_16x16x32_bf16 v[32:35], v[120:123], v[96:99], v[32:35]
    ds_read_b64_tr_b16 v[160:161], v182 offset:12288
    v_mfma_f32_16x16x32_bf16 v[40:43], v[120:123], v[100:103], v[40:43]
    ds_read_b64_tr_b16 v[162:163], v182 offset:14336
    v_mfma_f32_16x16x32_bf16 v[48:51], v[120:123], v[104:107], v[48:51]
    ds_read_b64_tr_b16 v[164:165], v183 offset:12288
    v_mfma_f32_16x16x32_bf16 v[56:59], v[120:123], v[108:111], v[56:59]
    ds_read_b64_tr_b16 v[166:167], v183 offset:14336
    v_mfma_f32_16x16x32_bf16 v[60:63], v[124:127], v[108:111], v[60:63]
    ds_read_b64_tr_b16 v[168:169], v182 offset:20480
    v_mfma_f32_16x16x32_bf16 v[52:55], v[124:127], v[104:107], v[52:55]
    ds_read_b64_tr_b16 v[170:171], v182 offset:22528
    v_mfma_f32_16x16x32_bf16 v[44:47], v[124:127], v[100:103], v[44:47]
    ds_read_b64_tr_b16 v[172:173], v183 offset:20480
    v_mfma_f32_16x16x32_bf16 v[36:39], v[124:127], v[96:99], v[36:39]
    ds_read_b64_tr_b16 v[174:175], v183 offset:22528
    v_mfma_f32_16x16x32_bf16 v[64:67], v[96:99], v[128:131], v[64:67]
    s_cmp_eq_u32 s36, s89
    s_cbranch_scc1 e_arr
e_arr_ret:
    v_mfma_f32_16x16x32_bf16 v[68:71], v[100:103], v[128:131], v[68:71]
    s_add_u32 s31, s31, 24576
    s_sub_u32 s32, s32, 16384
    v_mfma_f32_16x16x32_bf16 v[72:75], v[104:107], v[128:131], v[72:75]
    s_cmp_ge_u32 s31, 73728
    s_cselect_b32 s31, 0, s31
    s_cselect_b32 s32, 147456, s32
    v_mfma_f32_16x16x32_bf16 v[76:79], v[108:111], v[128:131], v[76:79]
    v_add_u32 v182, s31, v178
    v_add_u32_e64 v180, s32, v176
    v_mfma_f32_16x16x32_bf16 v[92:95], v[108:111], v[132:135], v[92:95]
    v_add_u32_e64 v183, s31, v179
    v_add_u32 v181, s32, v177
    v_mfma_f32_16x16x32_bf16 v[88:91], v[104:107], v[132:135], v[88:91]
    s_add_u32 s85, s85, 1
    s_and_b32 s30, s85, 15
    v_mfma_f32_16x16x32_bf16 v[84:87], v[100:103], v[132:135], v[84:87]
    s_mul_i32 s30, s30, 393216
    s_cmp_ge_u32 s36, 6
    v_mfma_f32_16x16x32_bf16 v[80:83], v[96:99], v[132:135], v[80:83]
    s_waitcnt lgkmcnt(0)
    v_mfma_f32_16x16x32_bf16 v[0:3], v[152:155], v[136:139], v[0:3]
    s_barrier
    ds_read_b128 v[96:99], v180 offset:0
    v_mfma_f32_16x16x32_bf16 v[8:11], v[152:155], v[140:143], v[8:11]
    ds_read_b64_tr_b16 v[112:113], v182 offset:0
    v_mfma_f32_16x16x32_bf16 v[16:19], v[152:155], v[144:147], v[16:19]
    ds_read_b64_tr_b16 v[114:115], v182 offset:2048
    v_mfma_f32_16x16x32_bf16 v[24:27], v[152:155], v[148:151], v[24:27]
    ds_read_b128 v[100:103], v180 offset:2048
    v_mfma_f32_16x16x32_bf16 v[28:31], v[156:159], v[148:151], v[28:31]
    ds_read_b128 v[104:107], v180 offset:4096
    v_mfma_f32_16x16x32_bf16 v[20:23], v[156:159], v[144:147], v[20:23]
    ds_read_b128 v[108:111], v180 offset:6144
    v_mfma_f32_16x16x32_bf16 v[12:15], v[156:159], v[140:143], v[12:15]
    ds_read_b64_tr_b16 v[116:117], v183 offset:0
    v_mfma_f32_16x16x32_bf16 v[4:7], v[156:159], v[136:139], v[4:7]
    ds_read_b64_tr_b16 v[118:119], v183 offset:2048
    v_mfma_f32_16x16x32_bf16 v[32:35], v[160:163], v[136:139], v[32:35]
    ds_read_b64_tr_b16 v[120:121], v182 offset:8192
    v_mfma_f32_16x16x32_bf16 v[40:43], v[160:163], v[140:143], v[40:43]
    ds_read_b64_tr_b16 v[122:123], v182 offset:10240
    v_mfma_f32_16x16x32_bf16 v[48:51], v[160:163], v[144:147], v[48:51]
    ds_read_b64_tr_b16 v[124:125], v183 offset:8192
    v_mfma_f32_16x16x32_bf16 v[56:59], v[160:163], v[148:151], v[56:59]
    ds_read_b64_tr_b16 v[126:127], v183 offset:10240
    v_mfma_f32_16x16x32_bf16 v[60:63], v[164:167], v[148:151], v[60:63]
    ds_read_b64_tr_b16 v[128:129], v182 offset:16384
    v_mfma_f32_16x16x32_bf16 v[52:55], v[164:167], v[144:147], v[52:55]
    ds_read_b64_tr_b16 v[130:131], v182 offset:18432
    v_mfma_f32_16x16x32_bf16 v[44:47], v[164:167], v[140:143], v[44:47]
    ds_read_b64_tr_b16 v[132:133], v183 offset:16384
    v_mfma_f32_16x16x32_bf16 v[36:39], v[164:167], v[136:139], v[36:39]
    ds_read_b64_tr_b16 v[134:135], v183 offset:18432
    v_mfma_f32_16x16x32_bf16 v[64:67], v[136:139], v[168:171], v[64:67]
    s_cselect_b64 exec, 7, 0
    buffer_load_dword v191, v190, s[16:19], s30 offen
    s_mov_b64 exec, -1
    v_mfma_f32_16x16x32_bf16 v[68:71], v[140:143], v[168:171], v[68:71]
    s_bitcmp1_b32 s86, s36
    s_cbranch_scc1 e_fpf
e_fpf_ret:
    v_mfma_f32_16x16x32_bf16 v[72:75], v[144:147], v[168:171], v[72:75]
    s_sub_u32 s36, s36, 1
    s_cmp_eq_u32 s36, 0
    v_mfma_f32_16x16x32_bf16 v[76:79], v[148:151], v[168:171], v[76:79]
    v_mfma_f32_16x16x32_bf16 v[92:95], v[148:151], v[172:175], v[92:95]
    v_mfma_f32_16x16x32_bf16 v[88:91], v[144:147], v[172:175], v[88:91]
    v_mfma_f32_16x16x32_bf16 v[84:87], v[140:143], v[172:175], v[84:87]
    v_mfma_f32_16x16x32_bf16 v[80:83], v[136:139], v[172:175], v[80:83]
    s_cbranch_scc0 e_loop
    s_waitcnt lgkmcnt(0)
    v_mfma_f32_16x16x32_bf16 v[0:3], v[112:115], v[96:99], v[0:3]
    ds_read_b128 v[136:139], v181 offset:0
    v_mfma_f32_16x16x32_bf16 v[8:11], v[112:115], v[100:103], v[8:11]
    ds_read_b64_tr_b16 v[152:153], v182 offset:4096
    v_mfma_f32_16x16x32_bf16 v[16:19], v[112:115], v[104:107], v[16:19]
    ds_read_b64_tr_b16 v[154:155], v182 offset:6144
    v_mfma_f32_16x16x32_bf16 v[24:27], v[112:115], v[108:111], v[24:27]
    ds_read_b128 v[140:143], v181 offset:2048
    v_mfma_f32_16x16x32_bf16 v[28:31], v[116:119], v[108:111], v[28:31]
    ds_read_b128 v[144:147], v181 offset:4096
    v_mfma_f32_16x16x32_bf16 v[20:23], v[116:119], v[104:107], v[20:23]
    ds_read_b128 v[148:151], v181 offset:6144
    v_mfma_f32_16x16x32_bf16 v[12:15], v[116:119], v[100:103], v[12:15]
    ds_read_b64_tr_b16 v[156:157], v183 offset:4096
    v_mfma_f32_16x16x32_bf16 v[4:7], v[116:119], v[96:99], v[4:7]
    ds_read_b64_tr_b16 v[158:159], v183 offset:6144
    v_mfma_f32_16x16x32_bf16 v[32:35], v[120:123], v[96:99], v[32:35]
    ds_read_b64_tr_b16 v[160:161], v182 offset:12288
    v_mfma_f32_16x16x32_bf16 v[40:43], v[120:123], v[100:103], v[40:43]
    ds_read_b64_tr_b16 v[162:163], v182 offset:14336
    v_mfma_f32_16x16x32_bf16 v[48:51], v[120:123], v[104:107], v[48:51]
    ds_read_b64_tr_b16 v[164:165], v183 offset:12288
    v_mfma_f32_16x16x32_bf16 v[56:59], v[120:123], v[108:111], v[56:59]
    ds_read_b64_tr_b16 v[166:167], v183 offset:14336
    v_mfma_f32_16x16x32_bf16 v[60:63], v[124:127], v[108:111], v[60:63]
    ds_read_b64_tr_b16 v[168:169], v182 offset:20480
    v_mfma_f32_16x16x32_bf16 v[52:55], v[124:127], v[104:107], v[52:55]
    ds_read_b64_tr_b16 v[170:171], v182 offset:22528
    v_mfma_f32_16x16x32_bf16 v[44:47], v[124:127], v[100:103], v[44:47]
    ds_read_b64_tr_b16 v[172:173], v183 offset:20480
    v_mfma_f32_16x16x32_bf16 v[36:39], v[124:127], v[96:99], v[36:39]
    ds_read_b64_tr_b16 v[174:175], v183 offset:22528
    v_mfma_f32_16x16x32_bf16 v[64:67], v[96:99], v[128:131], v[64:67]
    s_cmp_lg_u32 s26, 0
    s_cbranch_scc1 e_nores
    ds_read_b128 v[208:211], v192
    ds_read_b128 v[212:215], v193
    ds_read_b128 v[216:219], v194
    ds_read_b128 v[220:223], v195
e_nores:
    v_mfma_f32_16x16x32_bf16 v[68:71], v[100:103], v[128:131], v[68:71]
    s_and_b32 s34, s3, 1
    s_lshr_b32 s35, s3, 1
    s_lshl_b32 s30, s25, 1
    v_mfma_f32_16x16x32_bf16 v[72:75], v[104:107], v[128:131], v[72:75]
    s_add_u32 s30, s30, s35
    s_lshl_b32 s30, s30, 6
    s_lshl_b32 s31, s24, 2
    v_mfma_f32_16x16x32_bf16 v[76:79], v[108:111], v[128:131], v[76:79]
    s_add_u32 s30, s30, s31
    s_lshl_b32 s31, s34, 1
    s_add_u32 s30, s30, s31
    v_mfma_f32_16x16x32_bf16 v[92:95], v[108:111], v[132:135], v[92:95]
    s_lshl_b32 s32, s30, 12
    s_add_u32 s32, s32, s26
    s_add_u32 s33, s32, 4096
    v_mfma_f32_16x16x32_bf16 v[88:91], v[104:107], v[132:135], v[88:91]
    v_mfma_f32_16x16x32_bf16 v[84:87], v[100:103], v[132:135], v[84:87]
    v_mfma_f32_16x16x32_bf16 v[80:83], v[96:99], v[132:135], v[80:83]
    s_waitcnt vmcnt(0) lgkmcnt(0)
    v_mfma_f32_16x16x32_bf16 v[32:35], v[160:163], v[136:139], v[32:35]
    s_barrier
    ds_read2_b32 v[204:205], v184 offset0:128 offset1:144
    ds_read_b128 v[128:131], v186 offset:1280
    v_mfma_f32_16x16x32_bf16 v[40:43], v[160:163], v[140:143], v[40:43]
    ds_read_b128 v[132:135], v186 offset:1344
    ds_read2_b32 v[192:193], v184 offset0:0 offset1:16
    v_mfma_f32_16x16x32_bf16 v[48:51], v[160:163], v[144:147], v[48:51]
    ds_read2_b32 v[206:207], v184 offset0:160 offset1:176
    ds_read2_b32 v[194:195], v184 offset0:32 offset1:48
    v_mfma_f32_16x16x32_bf16 v[56:59], v[160:163], v[148:151], v[56:59]
    ds_read2_b32 v[190:191], v187 offset0:0 offset1:16
    ds_read_b128 v[112:115], v185 offset:512
    v_mfma_f32_16x16x32_bf16 v[36:39], v[164:167], v[136:139], v[36:39]
    ds_read_b128 v[96:99], v185 offset:0
    ds_read_b128 v[116:119], v185 offset:576
    v_mfma_f32_16x16x32_bf16 v[44:47], v[164:167], v[140:143], v[44:47]
    ds_read_b128 v[100:103], v185 offset:64
    ds_read_b128 v[120:123], v185 offset:640
    v_mfma_f32_16x16x32_bf16 v[52:55], v[164:167], v[144:147], v[52:55]
    ds_read_b128 v[104:107], v185 offset:128
    ds_read_b128 v[124:127], v185 offset:704
    v_mfma_f32_16x16x32_bf16 v[60:63], v[164:167], v[148:151], v[60:63]
    ds_read_b128 v[108:111], v185 offset:192
    ds_read_b128 v[196:199], v186 offset:1024
    v_mfma_f32_16x16x32_bf16 v[64:67], v[136:139], v[168:171], v[64:67]
    ds_read_b128 v[200:203], v186 offset:1088
    ds_read2_b32 v[240:241], v188 offset0:0 offset1:128
    v_mfma_f32_16x16x32_bf16 v[68:71], v[140:143], v[168:171], v[68:71]
    ds_read_b64 v[250:251], v189 offset:3072
    v_mfma_f32_16x16x32_bf16 v[72:75], v[144:147], v[168:171], v[72:75]
    s_waitcnt lgkmcnt(13)
    v_fma_f32 v32, v128, -v204, v32
    v_fma_f32 v33, v129, -v204, v33
    v_fma_f32 v34, v130, -v204, v34
    v_mfma_f32_16x16x32_bf16 v[76:79], v[148:151], v[168:171], v[76:79]
    v_fma_f32 v35, v131, -v204, v35
    v_fma_f32 v36, v132, -v204, v36
    v_fma_f32 v37, v133, -v204, v37
    v_mfma_f32_16x16x32_bf16 v[80:83], v[136:139], v[172:175], v[80:83]
    v_fma_f32 v38, v134, -v204, v38
    v_fma_f32 v39, v135, -v204, v39
    v_mul_f32_e64 v32, v32, v192
    v_mfma_f32_16x16x32_bf16 v[84:87], v[140:143], v[172:175], v[84:87]
    v_mul_f32 v33, v33, v192
    v_mul_f32 v34, v34, v192
    v_mul_f32_e64 v35, v35, v192
    v_mfma_f32_16x16x32_bf16 v[88:91], v[144:147], v[172:175], v[88:91]
    v_mul_f32 v36, v36, v192
    v_mul_f32 v37, v37, v192
    v_mul_f32_e64 v38, v38, v192
    v_mfma_f32_16x16x32_bf16 v[92:95], v[148:151], v[172:175], v[92:95]
    v_mul_f32_e64 v39, v39, v192
    v_cvt_pk_bf16_f32 v32, v32, v33
    v_cvt_pk_bf16_f32 v33, v34, v35
    v_mfma_f32_16x16x32_bf16 v[0:3], v[152:155], v[136:139], v[0:3]
    v_cvt_pk_bf16_f32 v34, v36, v37
    v_cvt_pk_bf16_f32 v35, v38, v39
    buffer_store_dwordx4 v[32:35], v244, s[20:23], s32 offen offset:0 sc1
    v_mfma_f32_16x16x32_bf16 v[8:11], v[152:155], v[140:143], v[8:11]
    v_fma_f32 v40, v128, -v205, v40
    v_fma_f32 v41, v129, -v205, v41
    v_fma_f32 v42, v130, -v205, v42
    v_mfma_f32_16x16x32_bf16 v[16:19], v[152:155], v[144:147], v[16:19]
    v_fma_f32 v43, v131, -v205, v43
    v_fma_f32 v44, v132, -v205, v44
    v_fma_f32 v45, v133, -v205, v45
    v_mfma_f32_16x16x32_bf16 v[24:27], v[152:155], v[148:151], v[24:27]
    v_fma_f32 v46, v134, -v205, v46
    v_fma_f32 v47, v135, -v205, v47
    v_mul_f32_e64 v40, v40, v193
    v_mfma_f32_16x16x32_bf16 v[4:7], v[156:159], v[136:139], v[4:7]
    v_mul_f32 v41, v41, v193
    v_mul_f32 v42, v42, v193
    v_mul_f32_e64 v43, v43, v193
    v_mfma_f32_16x16x32_bf16 v[12:15], v[156:159], v[140:143], v[12:15]
    v_mul_f32 v44, v44, v193
    v_mul_f32 v45, v45, v193
    v_mul_f32_e64 v46, v46, v193
    v_mfma_f32_16x16x32_bf16 v[20:23], v[156:159], v[144:147], v[20:23]
    v_mul_f32 v47, v47, v193
    v_cvt_pk_bf16_f32 v40, v40, v41
    v_cvt_pk_bf16_f32 v41, v42, v43
    v_mfma_f32_16x16x32_bf16 v[28:31], v[156:159], v[148:151], v[28:31]
    v_cvt_pk_bf16_f32 v42, v44, v45
    v_cvt_pk_bf16_f32 v43, v46, v47
    buffer_store_dwordx4 v[40:43], v244, s[20:23], s32 offen offset:128 sc1
    v_pk_fma_f32 v[48:49], v[128:129], v[206:207], v[48:49] op_sel_hi:[1,0,1] neg_lo:[0,1,0] neg_hi:[0,1,0]
    v_pk_fma_f32 v[50:51], v[130:131], v[206:207], v[50:51] op_sel_hi:[1,0,1] neg_lo:[0,1,0] neg_hi:[0,1,0]
    v_pk_fma_f32 v[52:53], v[132:133], v[206:207], v[52:53] op_sel_hi:[1,0,1] neg_lo:[0,1,0] neg_hi:[0,1,0]
    v_pk_fma_f32 v[54:55], v[134:135], v[206:207], v[54:55] op_sel_hi:[1,0,1] neg_lo:[0,1,0] neg_hi:[0,1,0]
    v_pk_mul_f32 v[48:49], v[48:49], v[194:195] op_sel_hi:[1,0]
    v_pk_mul_f32 v[50:51], v[50:51], v[194:195] op_sel_hi:[1,0]
    v_pk_mul_f32 v[52:53], v[52:53], v[194:195] op_sel_hi:[1,0]
    v_pk_mul_f32 v[54:55], v[54:55], v[194:195] op_sel_hi:[1,0]
    v_cvt_pk_bf16_f32 v48, v48, v49
    v_cvt_pk_bf16_f32 v49, v50, v51
    v_cvt_pk_bf16_f32 v50, v52, v53
    v_cvt_pk_bf16_f32 v51, v54, v55
    buffer_store_dwordx4 v[48:51], v244, s[20:23], s33 offen offset:0 sc1
    v_pk_fma_f32 v[56:57], v[128:129], v[206:207], v[56:57] op_sel:[0,1,0] op_sel_hi:[1,1,1] neg_lo:[0,1,0] neg_hi:[0,1,0]
    v_pk_fma_f32 v[58:59], v[130:131], v[206:207], v[58:59] op_sel:[0,1,0] op_sel_hi:[1,1,1] neg_lo:[0,1,0] neg_hi:[0,1,0]
    v_pk_fma_f32 v[60:61], v[132:133], v[206:207], v[60:61] op_sel:[0,1,0] op_sel_hi:[1,1,1] neg_lo:[0,1,0] neg_hi:[0,1,0]
    v_pk_fma_f32 v[62:63], v[134:135], v[206:207], v[62:63] op_sel:[0,1,0] op_sel_hi:[1,1,1] neg_lo:[0,1,0] neg_hi:[0,1,0]
    v_pk_mul_f32 v[56:57], v[56:57], v[194:195] op_sel:[0,1] op_sel_hi:[1,1]
    v_pk_mul_f32 v[58:59], v[58:59], v[194:195] op_sel:[0,1] op_sel_hi:[1,1]
    v_pk_mul_f32 v[60:61], v[60:61], v[194:195] op_sel:[0,1] op_sel_hi:[1,1]
    v_pk_mul_f32 v[62:63], v[62:63], v[194:195] op_sel:[0,1] op_sel_hi:[1,1]
    v_cvt_pk_bf16_f32 v56, v56, v57
    v_cvt_pk_bf16_f32 v57, v58, v59
    v_cvt_pk_bf16_f32 v58, v60, v61
    v_cvt_pk_bf16_f32 v59, v62, v63
    buffer_store_dwordx4 v[56:59], v244, s[20:23], s33 offen offset:128 sc1
    s_waitcnt lgkmcnt(0)
    v_pk_fma_f32 v[64:65], v[112:113], v[190:191], v[64:65] op_sel_hi:[1,0,1] neg_lo:[0,1,0] neg_hi:[0,1,0]
    v_pk_fma_f32 v[66:67], v[114:115], v[190:191], v[66:67] op_sel_hi:[1,0,1] neg_lo:[0,1,0] neg_hi:[0,1,0]
    v_pk_fma_f32 v[68:69], v[116:117], v[190:191], v[68:69] op_sel_hi:[1,0,1] neg_lo:[0,1,0] neg_hi:[0,1,0]
    v_pk_fma_f32 v[70:71], v[118:119], v[190:191], v[70:71] op_sel_hi:[1,0,1] neg_lo:[0,1,0] neg_hi:[0,1,0]
    v_pk_mul_f32 v[64:65], v[64:65], v[96:97]
    v_pk_mul_f32 v[66:67], v[66:67], v[98:99]
    v_pk_mul_f32 v[68:69], v[68:69], v[100:101]
    v_pk_mul_f32 v[70:71], v[70:71], v[102:103]
    v_cvt_pk_bf16_f32 v64, v64, v65
    v_cvt_pk_bf16_f32 v65, v66, v67
    v_cvt_pk_bf16_f32 v66, v68, v69
    v_cvt_pk_bf16_f32 v67, v70, v71
    buffer_store_dwordx4 v[64:67], v245, s[20:23], s32 offen offset:2048 sc1
    v_pk_fma_f32 v[80:81], v[112:113], v[190:191], v[80:81] op_sel:[0,1,0] op_sel_hi:[1,1,1] neg_lo:[0,1,0] neg_hi:[0,1,0]
    v_pk_fma_f32 v[82:83], v[114:115], v[190:191], v[82:83] op_sel:[0,1,0] op_sel_hi:[1,1,1] neg_lo:[0,1,0] neg_hi:[0,1,0]
    v_pk_fma_f32 v[84:85], v[116:117], v[190:191], v[84:85] op_sel:[0,1,0] op_sel_hi:[1,1,1] neg_lo:[0,1,0] neg_hi:[0,1,0]
    v_pk_fma_f32 v[86:87], v[118:119], v[190:191], v[86:87] op_sel:[0,1,0] op_sel_hi:[1,1,1] neg_lo:[0,1,0] neg_hi:[0,1,0]
    v_pk_mul_f32 v[80:81], v[80:81], v[96:97]
    v_pk_mul_f32 v[82:83], v[82:83], v[98:99]
    v_pk_mul_f32 v[84:85], v[84:85], v[100:101]
    v_pk_mul_f32 v[86:87], v[86:87], v[102:103]
    v_cvt_pk_bf16_f32 v80, v80, v81
    v_cvt_pk_bf16_f32 v81, v82, v83
    v_cvt_pk_bf16_f32 v82, v84, v85
    v_cvt_pk_bf16_f32 v83, v86, v87
    buffer_store_dwordx4 v[80:83], v245, s[20:23], s32 offen offset:2304 sc1
    v_pk_fma_f32 v[72:73], v[120:121], v[190:191], v[72:73] op_sel_hi:[1,0,1] neg_lo:[0,1,0] neg_hi:[0,1,0]
    v_pk_fma_f32 v[74:75], v[122:123], v[190:191], v[74:75] op_sel_hi:[1,0,1] neg_lo:[0,1,0] neg_hi:[0,1,0]
    v_pk_fma_f32 v[76:77], v[124:125], v[190:191], v[76:77] op_sel_hi:[1,0,1] neg_lo:[0,1,0] neg_hi:[0,1,0]
    v_pk_fma_f32 v[78:79], v[126:127], v[190:191], v[78:79] op_sel_hi:[1,0,1] neg_lo:[0,1,0] neg_hi:[0,1,0]
    v_pk_mul_f32 v[72:73], v[72:73], v[104:105]
    v_pk_mul_f32 v[74:75], v[74:75], v[106:107]
    v_pk_mul_f32 v[76:77], v[76:77], v[108:109]
    v_pk_mul_f32 v[78:79], v[78:79], v[110:111]
    v_cvt_pk_bf16_f32 v72, v72, v73
    v_cvt_pk_bf16_f32 v73, v74, v75
    v_cvt_pk_bf16_f32 v74, v76, v77
    v_cvt_pk_bf16_f32 v75, v78, v79
    buffer_store_dwordx4 v[72:75], v245, s[20:23], s33 offen offset:2048 sc1
    v_pk_fma_f32 v[88:89], v[120:121], v[190:191], v[88:89] op_sel:[0,1,0] op_sel_hi:[1,1,1] neg_lo:[0,1,0] neg_hi:[0,1,0]
    v_pk_fma_f32 v[90:91], v[122:123], v[190:191], v[90:91] op_sel:[0,1,0] op_sel_hi:[1,1,1] neg_lo:[0,1,0] neg_hi:[0,1,0]
    v_pk_fma_f32 v[92:93], v[124:125], v[190:191], v[92:93] op_sel:[0,1,0] op_sel_hi:[1,1,1] neg_lo:[0,1,0] neg_hi:[0,1,0]
    v_pk_fma_f32 v[94:95], v[126:127], v[190:191], v[94:95] op_sel:[0,1,0] op_sel_hi:[1,1,1] neg_lo:[0,1,0] neg_hi:[0,1,0]
    v_pk_mul_f32 v[88:89], v[88:89], v[104:105]
    v_pk_mul_f32 v[90:91], v[90:91], v[106:107]
    v_pk_mul_f32 v[92:93], v[92:93], v[108:109]
    v_pk_mul_f32 v[94:95], v[94:95], v[110:111]
    v_cvt_pk_bf16_f32 v88, v88, v89
    v_cvt_pk_bf16_f32 v89, v90, v91
    v_cvt_pk_bf16_f32 v90, v92, v93
    v_cvt_pk_bf16_f32 v91, v94, v95
    buffer_store_dwordx4 v[88:91], v245, s[20:23], s33 offen offset:2304 sc1
    ds_write_b128 v246, v[32:35] offset:0
    v_mul_f32 v192, 0x3e8293ee, v192
    ds_write_b128 v246, v[40:43] offset:128
    v_mul_f32 v193, 0x3e8293ee, v193
    ds_write_b128 v246, v[48:51] offset:4096
    v_mul_f32 v194, 0x3e8293ee, v194
    ds_write_b128 v246, v[56:59] offset:4224
    v_mul_f32 v195, 0x3e8293ee, v195
    v_pk_fma_f32 v[0:1], v[196:197], v[204:205], v[0:1] op_sel_hi:[1,0,1] neg_lo:[0,1,0] neg_hi:[0,1,0]
    v_pk_fma_f32 v[2:3], v[198:199], v[204:205], v[2:3] op_sel_hi:[1,0,1] neg_lo:[0,1,0] neg_hi:[0,1,0]
    v_pk_fma_f32 v[4:5], v[200:201], v[204:205], v[4:5] op_sel_hi:[1,0,1] neg_lo:[0,1,0] neg_hi:[0,1,0]
    v_pk_fma_f32 v[6:7], v[202:203], v[204:205], v[6:7] op_sel_hi:[1,0,1] neg_lo:[0,1,0] neg_hi:[0,1,0]
    v_pk_mul_f32 v[0:1], v[0:1], v[192:193] op_sel_hi:[1,0]
    v_pk_mul_f32 v[2:3], v[2:3], v[192:193] op_sel_hi:[1,0]
    v_pk_mul_f32 v[4:5], v[4:5], v[192:193] op_sel_hi:[1,0]
    v_pk_mul_f32 v[6:7], v[6:7], v[192:193] op_sel_hi:[1,0]
    v_cvt_pk_bf16_f32 v0, v0, v1
    v_cvt_pk_bf16_f32 v1, v2, v3
    v_cvt_pk_bf16_f32 v2, v4, v5
    v_cvt_pk_bf16_f32 v3, v6, v7
    ds_write_b128 v247, v[64:67] offset:2048
    ds_write_b128 v248, v[0:3] offset:0
    v_pk_fma_f32 v[8:9], v[196:197], v[204:205], v[8:9] op_sel:[0,1,0] op_sel_hi:[1,1,1] neg_lo:[0,1,0] neg_hi:[0,1,0]
    v_pk_fma_f32 v[10:11], v[198:199], v[204:205], v[10:11] op_sel:[0,1,0] op_sel_hi:[1,1,1] neg_lo:[0,1,0] neg_hi:[0,1,0]
    v_pk_fma_f32 v[12:13], v[200:201], v[204:205], v[12:13] op_sel:[0,1,0] op_sel_hi:[1,1,1] neg_lo:[0,1,0] neg_hi:[0,1,0]
    v_pk_fma_f32 v[14:15], v[202:203], v[204:205], v[14:15] op_sel:[0,1,0] op_sel_hi:[1,1,1] neg_lo:[0,1,0] neg_hi:[0,1,0]
    v_pk_mul_f32 v[8:9], v[8:9], v[192:193] op_sel:[0,1] op_sel_hi:[1,1]
    v_pk_mul_f32 v[10:11], v[10:11], v[192:193] op_sel:[0,1] op_sel_hi:[1,1]
    v_pk_mul_f32 v[12:13], v[12:13], v[192:193] op_sel:[0,1] op_sel_hi:[1,1]
    v_pk_mul_f32 v[14:15], v[14:15], v[192:193] op_sel:[0,1] op_sel_hi:[1,1]
    v_cvt_pk_bf16_f32 v8, v8, v9
    v_cvt_pk_bf16_f32 v9, v10, v11
    v_cvt_pk_bf16_f32 v10, v12, v13
    v_cvt_pk_bf16_f32 v11, v14, v15
    ds_write_b128 v247, v[80:83] offset:2304
    ds_write_b128 v248, v[8:11] offset:256
    v_pk_fma_f32 v[16:17], v[196:197], v[206:207], v[16:17] op_sel_hi:[1,0,1] neg_lo:[0,1,0] neg_hi:[0,1,0]
    v_pk_fma_f32 v[18:19], v[198:199], v[206:207], v[18:19] op_sel_hi:[1,0,1] neg_lo:[0,1,0] neg_hi:[0,1,0]
    v_pk_fma_f32 v[20:21], v[200:201], v[206:207], v[20:21] op_sel_hi:[1,0,1] neg_lo:[0,1,0] neg_hi:[0,1,0]
    v_pk_fma_f32 v[22:23], v[202:203], v[206:207], v[22:23] op_sel_hi:[1,0,1] neg_lo:[0,1,0] neg_hi:[0,1,0]
    v_pk_mul_f32 v[16:17], v[16:17], v[194:195] op_sel_hi:[1,0]
    v_pk_mul_f32 v[18:19], v[18:19], v[194:195] op_sel_hi:[1,0]
    v_pk_mul_f32 v[20:21], v[20:21], v[194:195] op_sel_hi:[1,0]
    v_pk_mul_f32 v[22:23], v[22:23], v[194:195] op_sel_hi:[1,0]
    v_cvt_pk_bf16_f32 v16, v16, v17
    v_cvt_pk_bf16_f32 v17, v18, v19
    v_cvt_pk_bf16_f32 v18, v20, v21
    v_cvt_pk_bf16_f32 v19, v22, v23
    ds_write_b128 v247, v[72:75] offset:6144
    ds_write_b128 v248, v[16:19] offset:2048
    v_pk_fma_f32 v[24:25], v[196:197], v[206:207], v[24:25] op_sel:[0,1,0] op_sel_hi:[1,1,1] neg_lo:[0,1,0] neg_hi:[0,1,0]
    v_pk_fma_f32 v[26:27], v[198:199], v[206:207], v[26:27] op_sel:[0,1,0] op_sel_hi:[1,1,1] neg_lo:[0,1,0] neg_hi:[0,1,0]
    v_pk_fma_f32 v[28:29], v[200:201], v[206:207], v[28:29] op_sel:[0,1,0] op_sel_hi:[1,1,1] neg_lo:[0,1,0] neg_hi:[0,1,0]
    v_pk_fma_f32 v[30:31], v[202:203], v[206:207], v[30:31] op_sel:[0,1,0] op_sel_hi:[1,1,1] neg_lo:[0,1,0] neg_hi:[0,1,0]
    v_pk_mul_f32 v[24:25], v[24:25], v[194:195] op_sel:[0,1] op_sel_hi:[1,1]
    v_pk_mul_f32 v[26:27], v[26:27], v[194:195] op_sel:[0,1] op_sel_hi:[1,1]
    v_pk_mul_f32 v[28:29], v[28:29], v[194:195] op_sel:[0,1] op_sel_hi:[1,1]
    v_pk_mul_f32 v[30:31], v[30:31], v[194:195] op_sel:[0,1] op_sel_hi:[1,1]
    v_cvt_pk_bf16_f32 v24, v24, v25
    v_cvt_pk_bf16_f32 v25, v26, v27
    v_cvt_pk_bf16_f32 v26, v28, v29
    v_cvt_pk_bf16_f32 v27, v30, v31
    ds_write_b128 v247, v[88:91] offset:6400
    ds_write_b128 v248, v[24:27] offset:2304
    s_lshl_b32 s30, s25, 8
    s_lshl_b32 s31, s24, 4
    s_add_u32 s30, s30, s31
    s_lshl_b32 s31, s34, 3
    s_add_u32 s30, s30, s31
    s_lshl_b32 s31, s35, 2
    s_add_u32 s30, s30, s31
    s_lshl_b32 s30, s30, 3
    s_add_u32 s30, s30, s26
    s_add_u32 s30, s30, 0xe00000
    v_readfirstlane_b32 s73, v250
    v_readfirstlane_b32 s77, v251
    s_lshr_b32 s39, s73, 5
    s_lshl_b32 s34, s24, 2
    s_sub_u32 s39, s39, s34
    s_add_u32 s39, s39, 8
    s_lshr_b32 s34, s39, 3
    s_add_u32 s34, s34, 1
    s_cmp_lt_u32 s39, 12
    s_cselect_b32 s100, s34, 0
    s_cmp_lg_u32 s26, 0
    s_cbranch_scc1 sk_2
    v_permlane32_swap_b32 v208, v210
    v_permlane32_swap_b32 v209, v211
    v_permlane32_swap_b32 v212, v214
    v_permlane32_swap_b32 v213, v215
    v_permlane32_swap_b32 v216, v218
    v_permlane32_swap_b32 v217, v219
    v_permlane32_swap_b32 v220, v222
    v_permlane32_swap_b32_e64 v221, v223
sk_2:
    v_mov_b32 v20, 0xffff
    v_mov_b32 v21, 0xffff0000
    v_cndmask_b32 v22, 0, v20, s[40:41]
    v_cndmask_b32 v23, 0, v21, s[42:43]
    v_or_b32_e64 v12, v22, v23
    v_cndmask_b32 v22, 0, v20, s[44:45]
    v_cndmask_b32 v23, 0, v21, s[46:47]
    v_or_b32_e64 v13, v22, v23
    v_cndmask_b32 v22, 0, v20, s[48:49]
    v_cndmask_b32 v23, 0, v21, s[50:51]
    v_or_b32_e64 v14, v22, v23
    v_cndmask_b32 v22, 0, v20, s[52:53]
    v_cndmask_b32 v23, 0, v21, s[54:55]
    v_or_b32_e64 v15, v22, v23
    v_cndmask_b32 v22, 0, v20, s[56:57]
    v_cndmask_b32 v23, 0, v21, s[58:59]
    v_or_b32_e64 v16, v22, v23
    v_cndmask_b32 v22, 0, v20, s[60:61]
    v_cndmask_b32 v23, 0, v21, s[62:63]
    v_or_b32_e64 v17, v22, v23
    v_cndmask_b32 v22, 0, v20, s[64:65]
    v_cndmask_b32 v23, 0, v21, s[66:67]
    v_or_b32_e64 v18, v22, v23
    v_cndmask_b32 v22, 0, v20, s[68:69]
    v_cndmask_b32 v23, 0, v21, s[70:71]
    v_or_b32 v19, v22, v23
    s_xor_b32 s76, s99, 0
    s_and_b32 s34, s76, 3
    s_lshl_b32 s33, s34, 12
    s_add_u32 s33, s33, 65536
    v_add_u32_e64 v20, s33, v253
    v_add_u32 v22, 32768, v20
    v_add_u32 v23, 94208, v253
    s_add_u32 s74, s34, 1
    s_mov_b32 s75, 0
    s_lshl_b32 s34, s34, 11
    s_add_u32 s34, s34, 49152
    v_add_u32 v3, s34, v253
    v_mov_b32 v21, 0xf149f2ca
    v_cndmask_b32 v24, v21, 0, s[40:41]
    v_cndmask_b32 v25, v21, 0, s[42:43]
    v_cndmask_b32 v26, v21, 0, s[44:45]
    v_cndmask_b32 v27, v21, 0, s[46:47]
    v_cndmask_b32 v28, v21, 0, s[48:49]
    v_cndmask_b32 v29, v21, 0, s[50:51]
    v_cndmask_b32 v30, v21, 0, s[52:53]
    v_cndmask_b32 v31, v21, 0, s[54:55]
    v_cndmask_b32 v32, v21, 0, s[56:57]
    v_cndmask_b32 v33, v21, 0, s[58:59]
    v_cndmask_b32 v34, v21, 0, s[60:61]
    v_cndmask_b32 v35, v21, 0, s[62:63]
    v_cndmask_b32 v36, v21, 0, s[64:65]
    v_cndmask_b32 v37, v21, 0, s[66:67]
    v_cndmask_b32 v38, v21, 0, s[68:69]
    v_cndmask_b32 v39, v21, 0, s[70:71]
    v_lshrrev_b32 v40, 2, v252
    v_xor_b32 v40, v40, v252
    v_bfe_u32 v40, v40, 2, 1
    v_add_u32_e64 v40, -1, v40
    v_and_b32 v40, 0x3f803f80, v40
    v_mov_b32 v41, v40
    v_mov_b32 v42, v40
    v_mov_b32 v43, v40
    v_mov_b32 v44, 0
    v_mov_b32 v45, 0
    v_mov_b32 v46, 0
    v_mov_b32 v47, 0
    v_mov_b32 v88, 0
    v_mov_b32 v89, 0
    v_mov_b32 v90, 0
    v_mov_b32 v91, 0
    v_mov_b32 v92, 0
    v_mov_b32 v93, 0
    v_mov_b32 v94, 0
    v_mov_b32 v95, 0
    v_mov_b32 v96, 0
    v_mov_b32 v97, 0
    v_mov_b32 v98, 0
    v_mov_b32 v99, 0
    v_mov_b32 v100, 0
    v_mov_b32 v101, 0
    v_mov_b32 v102, 0
    v_mov_b32_e64 v103, 0
    s_cmp_lg_u32 s100, 2
    s_cbranch_scc1 sk_3
    s_and_b32 s32, s28, 1
    s_lshr_b32 s33, s28, 1
    s_add_u32 s36, s32, s24
    s_sub_u32 s36, s36, 2
    s_lshl_b32 s37, s25, 4
    s_add_u32 s37, s37, s36
    s_lshl_b32 s37, s37, 2
    s_add_u32 s37, s37, s33
    s_lshl_b32 s37, s37, 5
    s_add_u32 s37, s37, s26
    s_add_u32 s37, s37, 0xe00000
    s_lshl_b32 s38, s25, 1
    s_add_u32 s38, s38, s33
    s_lshl_b32 s38, s38, 4
    s_add_u32 s38, s38, s36
    s_lshl_b32 s38, s38, 14
    s_add_u32 s38, s38, s26
    s_mul_i32 s33, s33, 49152
    s_lshl_b32 s32, s32, 14
    s_add_u32 s39, s32, s33
    v_and_b32 v48, 8, v252
    v_lshlrev_b32 v48, 3, v48
    v_mov_b32_e64 v154, s88
    s_mov_b64 exec, 1
    s_waitcnt vmcnt(0)
    buffer_store_dword v154, v253, s[20:23], s30 offen sc1
    s_mov_b64 exec, -1
    s_cmp_lt_i32 s36, 0
    s_cbranch_scc1 sk_4
    s_mov_b32 s78, s27
pl_5:
    buffer_load_dword v49, v48, s[20:23], s37 offen sc1
    s_waitcnt vmcnt(0)
pc_6:
    v_cmp_ne_u32_e64 vcc, s88, v49
    s_cbranch_vccz pd_7
    s_sub_u32 s78, s78, 1
    s_cmp_lg_u32 s78, 0
    s_cbranch_scc1 pl_5
    s_mov_b32 s27, 1
pd_7:
    s_mov_b32 s36, -1
    s_add_u32 m0, s39, 65536
    s_add_u32 s32, s38, 0
    buffer_load_dwordx4 v253, s[20:23], s32 offen offset:0 sc1 lds
    buffer_load_dwordx4 v253, s[20:23], s32 offen offset:1024 sc1 lds
    buffer_load_dwordx4 v253, s[20:23], s32 offen offset:2048 sc1 lds
    buffer_load_dwordx4 v253, s[20:23], s32 offen offset:3072 sc1 lds
    s_add_u32 m0, s39, 69632
    s_add_u32 s32, s38, 4096
    buffer_load_dwordx4 v253, s[20:23], s32 offen offset:0 sc1 lds
    buffer_load_dwordx4 v253, s[20:23], s32 offen offset:1024 sc1 lds
    buffer_load_dwordx4 v253, s[20:23], s32 offen offset:2048 sc1 lds
    buffer_load_dwordx4 v253, s[20:23], s32 offen offset:3072 sc1 lds
    s_add_u32 m0, s39, 73728
    s_add_u32 s32, s38, 8192
    buffer_load_dwordx4 v253, s[20:23], s32 offen offset:0 sc1 lds
    buffer_load_dwordx4 v253, s[20:23], s32 offen offset:1024 sc1 lds
    buffer_load_dwordx4 v253, s[20:23], s32 offen offset:2048 sc1 lds
    buffer_load_dwordx4 v253, s[20:23], s32 offen offset:3072 sc1 lds
    s_add_u32 m0, s39, 77824
    s_add_u32 s32, s38, 12288
    buffer_load_dwordx4 v253, s[20:23], s32 offen offset:0 sc1 lds
    buffer_load_dwordx4 v253, s[20:23], s32 offen offset:1024 sc1 lds
    buffer_load_dwordx4 v253, s[20:23], s32 offen offset:2048 sc1 lds
    buffer_load_dwordx4 v253, s[20:23], s32 offen offset:3072 sc1 lds
sk_4:
sk_3:
    s_waitcnt lgkmcnt(0)
    s_barrier
    s_cmp_lg_u32 s100, 2
    s_cbranch_scc1 sk_8
    s_lshr_b32 s34, s73, 5
    s_cmp_lg_u32 s34, s99
    s_cbranch_scc1 sk_9
    s_lshl_b32 s34, s98, 7
    s_lshr_b32 vcc_lo, s24, 1
    s_lshl_b32 vcc_lo, vcc_lo, 11
    s_add_u32 vcc_lo, vcc_lo, s34
    s_add_u32 s34, vcc_lo, 0xdc4000
    s_and_b32 s32, s73, 31
    v_and_b32 v0, 31, v252
    v_cmp_eq_u32 vcc, s32, v0
    v_lshrrev_b32_e64 v0, 5, v252
    v_lshlrev_b32 v0, 3, v0
    s_mov_b64 exec, vcc
    buffer_load_dwordx2 v[208:209], v0, s[20:23], s34 offen offset:0 sc1
    buffer_load_dwordx2 v[210:211], v0, s[20:23], s34 offen offset:16 sc1
    buffer_load_dwordx2 v[212:213], v0, s[20:23], s34 offen offset:32 sc1
    buffer_load_dwordx2 v[214:215], v0, s[20:23], s34 offen offset:48 sc1
    buffer_load_dwordx2 v[216:217], v0, s[20:23], s34 offen offset:64 sc1
    buffer_load_dwordx2 v[218:219], v0, s[20:23], s34 offen offset:80 sc1
    buffer_load_dwordx2 v[220:221], v0, s[20:23], s34 offen offset:96 sc1
    buffer_load_dwordx2 v[222:223], v0, s[20:23], s34 offen offset:112 sc1
    v_mov_b32_e64 v240, 1.0
    v_mov_b32 v241, 0
    s_mov_b64 exec, -1
sk_9:
    s_barrier
sk_8:
    ds_read_b128 v[4:7], v3
    ds_read_b128 v[8:11], v3 offset:1024
    ds_read_b128 v[112:115], v22 offset:0
    ds_read_b128 v[116:119], v22 offset:1024
    s_waitcnt lgkmcnt(0)
    v_mfma_f32_32x32x16_bf16 v[56:71], v[112:115], v[4:7], v[24:39]
    v_mfma_f32_32x32x16_bf16 v[56:71], v[116:119], v[8:11], v[56:71]
    ds_read_b128 v[104:107], v23 offset:4096
    ds_read_b128 v[124:127], v22 offset:3072
    ds_read_b128 v[108:111], v23 offset:5120
    ds_read_b128 v[120:123], v22 offset:2048
    s_cmp_eq_u32 s100, 2
    s_cbranch_scc1 sk_11
    s_and_b32 s32, s28, 1
    s_lshr_b32 s33, s28, 1
    s_add_u32 s36, s32, s24
    s_sub_u32 s36, s36, 2
    s_lshl_b32 s37, s25, 4
    s_add_u32 s37, s37, s36
    s_lshl_b32 s37, s37, 2
    s_add_u32 s37, s37, s33
    s_lshl_b32 s37, s37, 5
    s_add_u32 s37, s37, s26
    s_add_u32 s37, s37, 0xe00000
    s_lshl_b32 s38, s25, 1
    s_add_u32 s38, s38, s33
    s_lshl_b32 s38, s38, 4
    s_add_u32 s38, s38, s36
    s_lshl_b32 s38, s38, 14
    s_add_u32 s38, s38, s26
    s_mul_i32 s33, s33, 49152
    s_lshl_b32 s32, s32, 14
    s_add_u32 s39, s32, s33
    v_and_b32 v48, 8, v252
    v_lshlrev_b32 v48, 3, v48
    v_mov_b32_e64 v154, s88
    s_mov_b64 exec, 1
    s_waitcnt vmcnt(0)
    buffer_store_dword v154, v253, s[20:23], s30 offen sc1
    s_mov_b64 exec, -1
sk_11:
    s_nop 5
    v_max3_f32 v21, v56, v57, v58
    v_max3_f32 v152, v59, v60, v61
    v_max3_f32 v21, v21, v62, v63
    v_max3_f32 v152, v152, v64, v65
    v_max3_f32 v21, v21, v66, v67
    v_max3_f32 v152, v152, v68, v69
    v_max3_f32 v21, v21, v70, v71
    v_max_f32 v21, v21, v152
    v_mov_b32 v152, v21
    s_nop 1
    v_permlane32_swap_b32 v21, v152
    v_max_f32 v21, v21, v152
    v_sub_f32 v24, 0, v21
    v_sub_f32 v25, 0, v21
    v_sub_f32 v26, 0, v21
    v_sub_f32 v27, 0, v21
    v_sub_f32 v28, 0, v21
    v_sub_f32 v29, 0, v21
    v_sub_f32 v30, 0, v21
    v_sub_f32 v31, 0, v21
    v_sub_f32 v32, 0, v21
    v_sub_f32 v33, 0, v21
    v_sub_f32 v34, 0, v21
    v_sub_f32 v35, 0, v21
    v_sub_f32 v36, 0, v21
    v_sub_f32 v37, 0, v21
    v_sub_f32 v38, 0, v21
    v_sub_f32 v39, 0, v21
    s_branch a0_10_go
    s_nop 0
a0_10_mid:
    s_cmp_ge_u32 s76, 8
    s_cselect_b32 s33, 0, -1
    v_not_b32 v12, v12
    v_or_b32 v12, s33, v12
    v_not_b32 v13, v13
    v_or_b32 v13, s33, v13
    v_not_b32 v14, v14
    v_or_b32 v14, s33, v14
    v_not_b32 v15, v15
    v_or_b32 v15, s33, v15
    v_not_b32 v16, v16
    v_or_b32 v16, s33, v16
    v_not_b32 v17, v17
    v_or_b32 v17, s33, v17
    v_not_b32 v18, v18
    v_or_b32 v18, s33, v18
    v_not_b32 v19, v19
    v_or_b32 v19, s33, v19
    s_and_b32 s32, s76, 3
    s_cmp_ge_u32 s76, 8
    s_cselect_b32 s32, s32, 4
    s_sub_u32 s74, 8, s32
    s_lshl_b32 s32, s32, 12
    s_add_u32 s32, s32, 65536
    v_add_u32 v22, s32, v253
    v_add_u32 v23, s32, v253
    s_cmp_eq_u32 s26, 0
    s_cselect_b32 s75, 2, 1
    s_cmp_lt_i32 s36, 0
    s_cbranch_scc1 sk_12
    s_mov_b32 s78, s27
pl_13:
    buffer_load_dword v49, v48, s[20:23], s37 offen sc1
    s_waitcnt vmcnt(0)
pc_14:
    v_cmp_ne_u32 vcc, s88, v49
    s_cbranch_vccz pd_15
    s_sub_u32 s78, s78, 1
    s_cmp_lg_u32 s78, 0
    s_cbranch_scc1 pl_13
    s_mov_b32 s27, 1
pd_15:
    s_mov_b32 s36, -1
    s_add_u32 m0, s39, 65536
    s_add_u32 s32, s38, 0
    buffer_load_dwordx4 v253, s[20:23], s32 offen offset:0 sc1 lds
    buffer_load_dwordx4 v253, s[20:23], s32 offen offset:1024 sc1 lds
    buffer_load_dwordx4 v253, s[20:23], s32 offen offset:2048 sc1 lds
    buffer_load_dwordx4 v253, s[20:23], s32 offen offset:3072 sc1 lds
    s_add_u32 m0, s39, 69632
    s_add_u32 s32, s38, 4096
    buffer_load_dwordx4 v253, s[20:23], s32 offen offset:0 sc1 lds
    buffer_load_dwordx4 v253, s[20:23], s32 offen offset:1024 sc1 lds
    buffer_load_dwordx4 v253, s[20:23], s32 offen offset:2048 sc1 lds
    buffer_load_dwordx4 v253, s[20:23], s32 offen offset:3072 sc1 lds
    s_add_u32 m0, s39, 73728
    s_add_u32 s32, s38, 8192
    buffer_load_dwordx4 v253, s[20:23], s32 offen offset:0 sc1 lds
    buffer_load_dwordx4 v253, s[20:23], s32 offen offset:1024 sc1 lds
    buffer_load_dwordx4 v253, s[20:23], s32 offen offset:2048 sc1 lds
    buffer_load_dwordx4 v253, s[20:23], s32 offen offset:3072 sc1 lds
    s_add_u32 m0, s39, 77824
    s_add_u32 s32, s38, 12288
    buffer_load_dwordx4 v253, s[20:23], s32 offen offset:0 sc1 lds
    buffer_load_dwordx4 v253, s[20:23], s32 offen offset:1024 sc1 lds
    buffer_load_dwordx4 v253, s[20:23], s32 offen offset:2048 sc1 lds
    buffer_load_dwordx4 v253, s[20:23], s32 offen offset:3072 sc1 lds
sk_12:
    s_cmp_eq_u32 s100, 1
    s_cselect_b32 s32, 0, s28
    s_cmp_ge_u32 s32, 2
    s_cbranch_scc1 sk_16
    s_waitcnt vmcnt(0)
sk_16:
    s_barrier
    s_cmp_lg_u32 s100, 1
    s_cbranch_scc1 sk_17
    s_barrier
sk_17:
    s_cmp_lt_u32 s76, 4
    s_cbranch_scc1 a0_10_none
    ds_read_b128 v[112:115], v22 offset:0
    ds_read_b128 v[116:119], v22 offset:1024
    ds_read_b128 v[104:107], v23 offset:4096
    ds_read_b128 v[124:127], v22 offset:3072
    ds_read_b128 v[108:111], v23 offset:5120
    ds_read_b128 v[120:123], v22 offset:2048
    s_waitcnt lgkmcnt(4)
a0_10_go:
    s_nop 0
    v_mfma_f32_32x32x16_bf16 v[56:71], v[112:115], v[4:7], v[24:39]
    v_mfma_f32_32x32x16_bf16 v[56:71], v[116:119], v[8:11], v[56:71]
    s_waitcnt lgkmcnt(3)
    v_mfma_f32_32x32x16_bf16 v[72:87], v[104:107], v[4:7], v[24:39]
    ds_read_b128 v[104:107], v23 offset:8192
    s_nop 8
    v_exp_f32 v56, v56
    v_exp_f32 v57, v57
    v_exp_f32 v58, v58
    ds_read_b128 v[128:131], v23 offset:7168
    v_exp_f32 v59, v59
    v_exp_f32 v60, v60
    v_exp_f32 v61, v61
    s_waitcnt lgkmcnt(2)
    v_mfma_f32_32x32x16_bf16 v[72:87], v[108:111], v[8:11], v[72:87]
    ds_read_b128 v[108:111], v23 offset:9216
    v_exp_f32 v62, v62
    v_exp_f32 v63, v63
    v_cvt_pk_bf16_f32 v136, v56, v57
    v_cvt_pk_bf16_f32 v137, v58, v59
    v_cvt_pk_bf16_f32 v138, v60, v61
    v_cvt_pk_bf16_f32 v139, v62, v63
    v_and_b32 v136, v136, v12
    v_and_b32 v137, v137, v13
    v_and_b32 v138, v138, v14
    v_and_b32 v139, v139, v15
    v_exp_f32 v64, v64
    v_exp_f32 v65, v65
    v_mfma_f32_32x32x16_bf16 v[88:103], v[120:123], v[136:139], v[88:103]
    ds_read_b128 v[120:123], v23 offset:6144
    s_cmp_eq_u32 s75, 0
    s_cbranch_scc1 sk_18
    s_add_u32 s96, s25, 0
    s_and_b32 s96, s96, 15
    s_lshl_b32 s96, s96, 17
    s_add_u32 m0, s101, 0
    s_nop 0
    buffer_load_dwordx4 v243, s[8:11], s96 offen lds
sk_18:
    v_exp_f32 v66, v66
    v_exp_f32 v67, v67
    v_exp_f32 v68, v68
    v_exp_f32_e64 v69, v69
    v_mfma_f32_16x16x32_bf16 v[44:47], v[40:43], v[136:139], v[44:47]
    v_exp_f32 v70, v70
    v_exp_f32 v71, v71
    v_cvt_pk_bf16_f32 v140, v64, v65
    v_cvt_pk_bf16_f32 v141, v66, v67
    v_cvt_pk_bf16_f32 v142, v68, v69
    v_cvt_pk_bf16_f32 v143, v70, v71
    v_and_b32 v140, v140, v16
    v_and_b32 v141, v141, v17
    v_and_b32_e64 v142, v142, v18
    v_and_b32 v143, v143, v19
    s_cmp_eq_u32 s75, 0
    s_cbranch_scc1 sk_19
    s_waitcnt vmcnt(1)
    s_barrier
    s_add_u32 s96, s25, 12
    s_and_b32 s96, s96, 15
    s_lshl_b32 s96, s96, 17
    s_add_u32 m0, s101, 49152
    s_nop 0
    buffer_load_dwordx4 v243, s[8:11], s96 offen lds
sk_19:
    s_cmp_eq_u32 s74, 1
    s_cbranch_scc1 a0_10_e0
    s_cmp_eq_u32 s74, 2
    s_cbranch_scc1 a0_10_t1
    s_waitcnt lgkmcnt(3)
    v_mfma_f32_32x32x16_bf16 v[56:71], v[104:107], v[4:7], v[24:39]
    ds_read_b128 v[104:107], v23 offset:12288
    v_exp_f32 v72, v72
    v_exp_f32 v73, v73
    v_exp_f32_e64 v74, v74
    v_mfma_f32_32x32x16_bf16 v[88:103], v[124:127], v[140:143], v[88:103]
    ds_read_b128 v[124:127], v23 offset:11264
    v_exp_f32 v75, v75
    v_exp_f32 v76, v76
    v_exp_f32 v77, v77
    s_waitcnt lgkmcnt(2)
    v_mfma_f32_32x32x16_bf16 v[56:71], v[108:111], v[8:11], v[56:71]
    ds_read_b128 v[108:111], v23 offset:13312
    v_exp_f32 v78, v78
    v_exp_f32 v79, v79
    v_cvt_pk_bf16_f32 v136, v72, v73
    v_cvt_pk_bf16_f32 v137, v74, v75
    v_mfma_f32_16x16x32_bf16 v[44:47], v[40:43], v[140:143], v[44:47]
    v_cvt_pk_bf16_f32 v138, v76, v77
    v_cvt_pk_bf16_f32 v139, v78, v79
    v_exp_f32 v80, v80
    v_exp_f32 v81, v81
    v_mfma_f32_32x32x16_bf16 v[88:103], v[120:123], v[136:139], v[88:103]
    ds_read_b128 v[120:123], v23 offset:10240
    s_cmp_eq_u32 s75, 0
    s_cbranch_scc1 sk_20
    s_add_u32 s96, s25, 13
    s_and_b32 s96, s96, 15
    s_lshl_b32 s96, s96, 17
    s_add_u32 m0, s101, 53248
    s_nop 0
    buffer_load_dwordx4 v243, s[8:11], s96 offen lds
sk_20:
    v_exp_f32 v82, v82
    v_exp_f32 v83, v83
    v_exp_f32 v84, v84
    v_exp_f32 v85, v85
    v_mfma_f32_16x16x32_bf16 v[44:47], v[40:43], v[136:139], v[44:47]
    v_exp_f32 v86, v86
    v_exp_f32 v87, v87
    v_cvt_pk_bf16_f32 v140, v80, v81
    v_cvt_pk_bf16_f32 v141, v82, v83
    v_cvt_pk_bf16_f32 v142, v84, v85
    v_cvt_pk_bf16_f32 v143, v86, v87
    s_cmp_eq_u32 s75, 0
    s_cbranch_scc1 sk_21
    s_add_u32 s96, s25, 14
    s_and_b32 s96, s96, 15
    s_lshl_b32 s96, s96, 17
    s_add_u32 m0, s101, 57344
    s_nop 0
    buffer_load_dwordx4 v243, s[8:11], s96 offen lds
sk_21:
    s_cmp_eq_u32 s74, 3
    s_cbranch_scc1 a0_10_t0
    s_waitcnt lgkmcnt(3)
    v_mfma_f32_32x32x16_bf16 v[72:87], v[104:107], v[4:7], v[24:39]
    ds_read_b128 v[104:107], v23 offset:16384
    v_exp_f32 v56, v56
    v_exp_f32 v57, v57
    v_exp_f32 v58, v58
    v_mfma_f32_32x32x16_bf16 v[88:103], v[128:131], v[140:143], v[88:103]
    ds_read_b128 v[128:131], v23 offset:15360
    v_exp_f32 v59, v59
    v_exp_f32 v60, v60
    v_exp_f32 v61, v61
    s_waitcnt lgkmcnt(2)
    v_mfma_f32_32x32x16_bf16 v[72:87], v[108:111], v[8:11], v[72:87]
    ds_read_b128 v[108:111], v23 offset:17408
    v_exp_f32 v62, v62
    v_exp_f32 v63, v63
    v_cvt_pk_bf16_f32 v136, v56, v57
    v_cvt_pk_bf16_f32 v137, v58, v59
    v_mfma_f32_16x16x32_bf16 v[44:47], v[40:43], v[140:143], v[44:47]
    v_cvt_pk_bf16_f32 v138, v60, v61
    v_cvt_pk_bf16_f32 v139, v62, v63
    v_exp_f32 v64, v64
    v_exp_f32 v65, v65
    v_mfma_f32_32x32x16_bf16 v[88:103], v[120:123], v[136:139], v[88:103]
    ds_read_b128 v[120:123], v23 offset:14336
    s_cmp_eq_u32 s75, 0
    s_cbranch_scc1 sk_22
    s_add_u32 s96, s25, 15
    s_and_b32 s96, s96, 15
    s_lshl_b32 s96, s96, 17
    s_add_u32 m0, s101, 61440
    s_nop 0
    buffer_load_dwordx4 v243, s[8:11], s96 offen lds
sk_22:
    v_exp_f32 v66, v66
    v_exp_f32 v67, v67
    v_exp_f32 v68, v68
    v_exp_f32 v69, v69
    v_mfma_f32_16x16x32_bf16 v[44:47], v[40:43], v[136:139], v[44:47]
    v_exp_f32 v70, v70
    v_exp_f32 v71, v71
    v_cvt_pk_bf16_f32 v140, v64, v65
    v_cvt_pk_bf16_f32 v141, v66, v67
    v_cvt_pk_bf16_f32 v142, v68, v69
    v_cvt_pk_bf16_f32 v143, v70, v71
    s_cmp_eq_u32 s74, 4
    s_cbranch_scc1 a0_10_t1
    s_waitcnt lgkmcnt(3)
    v_mfma_f32_32x32x16_bf16 v[56:71], v[104:107], v[4:7], v[24:39]
    ds_read_b128 v[104:107], v23 offset:20480
    v_exp_f32 v72, v72
    v_exp_f32 v73, v73
    v_exp_f32 v74, v74
    v_mfma_f32_32x32x16_bf16 v[88:103], v[124:127], v[140:143], v[88:103]
    ds_read_b128 v[124:127], v23 offset:19456
    v_exp_f32 v75, v75
    v_exp_f32 v76, v76
    v_exp_f32 v77, v77
    s_waitcnt lgkmcnt(2)
    v_mfma_f32_32x32x16_bf16 v[56:71], v[108:111], v[8:11], v[56:71]
    ds_read_b128 v[108:111], v23 offset:21504
    v_exp_f32 v78, v78
    v_exp_f32 v79, v79
    v_cvt_pk_bf16_f32 v136, v72, v73
    v_cvt_pk_bf16_f32 v137, v74, v75
    v_mfma_f32_16x16x32_bf16 v[44:47], v[40:43], v[140:143], v[44:47]
    v_cvt_pk_bf16_f32 v138, v76, v77
    v_cvt_pk_bf16_f32 v139, v78, v79
    v_exp_f32 v80, v80
    v_exp_f32 v81, v81
    v_mfma_f32_32x32x16_bf16 v[88:103], v[120:123], v[136:139], v[88:103]
    ds_read_b128 v[120:123], v23 offset:18432
    v_exp_f32 v82, v82
    v_exp_f32 v83, v83
    v_exp_f32 v84, v84
    v_exp_f32 v85, v85
    v_mfma_f32_16x16x32_bf16 v[44:47], v[40:43], v[136:139], v[44:47]
    v_exp_f32 v86, v86
    v_exp_f32 v87, v87
    v_cvt_pk_bf16_f32 v140, v80, v81
    v_cvt_pk_bf16_f32 v141, v82, v83
    v_cvt_pk_bf16_f32 v142, v84, v85
    v_cvt_pk_bf16_f32 v143, v86, v87
    s_cmp_eq_u32 s74, 5
    s_cbranch_scc1 a0_10_t0
    s_waitcnt lgkmcnt(3)
    v_mfma_f32_32x32x16_bf16 v[72:87], v[104:107], v[4:7], v[24:39]
    ds_read_b128 v[104:107], v23 offset:24576
    v_exp_f32 v56, v56
    v_exp_f32 v57, v57
    v_exp_f32 v58, v58
    v_mfma_f32_32x32x16_bf16 v[88:103], v[128:131], v[140:143], v[88:103]
    ds_read_b128 v[128:131], v23 offset:23552
    v_exp_f32 v59, v59
    v_exp_f32 v60, v60
    v_exp_f32 v61, v61
    s_waitcnt lgkmcnt(2)
    v_mfma_f32_32x32x16_bf16 v[72:87], v[108:111], v[8:11], v[72:87]
    ds_read_b128 v[108:111], v23 offset:25600
    v_exp_f32 v62, v62
    v_exp_f32 v63, v63
    v_cvt_pk_bf16_f32 v136, v56, v57
    v_cvt_pk_bf16_f32 v137, v58, v59
    v_mfma_f32_16x16x32_bf16 v[44:47], v[40:43], v[140:143], v[44:47]
    v_cvt_pk_bf16_f32 v138, v60, v61
    v_cvt_pk_bf16_f32 v139, v62, v63
    v_exp_f32 v64, v64
    v_exp_f32 v65, v65
    v_mfma_f32_32x32x16_bf16 v[88:103], v[120:123], v[136:139], v[88:103]
    ds_read_b128 v[120:123], v23 offset:22528
    v_exp_f32 v66, v66
    v_exp_f32 v67, v67
    v_exp_f32 v68, v68
    v_exp_f32 v69, v69
    v_mfma_f32_16x16x32_bf16 v[44:47], v[40:43], v[136:139], v[44:47]
    v_exp_f32 v70, v70
    v_exp_f32 v71, v71
    v_cvt_pk_bf16_f32 v140, v64, v65
    v_cvt_pk_bf16_f32 v141, v66, v67
    v_cvt_pk_bf16_f32 v142, v68, v69
    v_cvt_pk_bf16_f32 v143, v70, v71
    s_cmp_eq_u32 s74, 6
    s_cbranch_scc1 a0_10_t1
    s_waitcnt lgkmcnt(3)
    v_mfma_f32_32x32x16_bf16 v[56:71], v[104:107], v[4:7], v[24:39]
    ds_read_b128 v[104:107], v23 offset:28672
    v_exp_f32 v72, v72
    v_exp_f32 v73, v73
    v_exp_f32 v74, v74
    v_mfma_f32_32x32x16_bf16 v[88:103], v[124:127], v[140:143], v[88:103]
    ds_read_b128 v[124:127], v23 offset:27648
    v_exp_f32 v75, v75
    v_exp_f32 v76, v76
    v_exp_f32 v77, v77
    s_waitcnt lgkmcnt(2)
    v_mfma_f32_32x32x16_bf16 v[56:71], v[108:111], v[8:11], v[56:71]
    ds_read_b128 v[108:111], v23 offset:29696
    v_exp_f32 v78, v78
    v_exp_f32 v79, v79
    v_cvt_pk_bf16_f32 v136, v72, v73
    v_cvt_pk_bf16_f32 v137, v74, v75
    v_mfma_f32_16x16x32_bf16 v[44:47], v[40:43], v[140:143], v[44:47]
    v_cvt_pk_bf16_f32 v138, v76, v77
    v_cvt_pk_bf16_f32 v139, v78, v79
    v_exp_f32 v80, v80
    v_exp_f32 v81, v81
    v_mfma_f32_32x32x16_bf16 v[88:103], v[120:123], v[136:139], v[88:103]
    ds_read_b128 v[120:123], v23 offset:26624
    v_exp_f32 v82, v82
    v_exp_f32 v83, v83
    v_exp_f32 v84, v84
    v_exp_f32 v85, v85
    v_mfma_f32_16x16x32_bf16 v[44:47], v[40:43], v[136:139], v[44:47]
    v_exp_f32 v86, v86
    v_exp_f32 v87, v87
    v_cvt_pk_bf16_f32 v140, v80, v81
    v_cvt_pk_bf16_f32 v141, v82, v83
    v_cvt_pk_bf16_f32 v142, v84, v85
    v_cvt_pk_bf16_f32 v143, v86, v87
    s_cmp_eq_u32 s74, 7
    s_cbranch_scc1 a0_10_t0
    s_waitcnt lgkmcnt(3)
    v_mfma_f32_32x32x16_bf16 v[72:87], v[104:107], v[4:7], v[24:39]
    ds_read_b128 v[104:107], v23 offset:24576
    v_exp_f32 v56, v56
    v_exp_f32 v57, v57
    v_exp_f32 v58, v58
    v_mfma_f32_32x32x16_bf16 v[88:103], v[128:131], v[140:143], v[88:103]
    ds_read_b128 v[128:131], v23 offset:31744
    v_exp_f32 v59, v59
    v_exp_f32 v60, v60
    v_exp_f32 v61, v61
    s_waitcnt lgkmcnt(2)
    v_mfma_f32_32x32x16_bf16 v[72:87], v[108:111], v[8:11], v[72:87]
    ds_read_b128 v[108:111], v23 offset:25600
    v_exp_f32 v62, v62
    v_exp_f32 v63, v63
    v_cvt_pk_bf16_f32 v136, v56, v57
    v_cvt_pk_bf16_f32 v137, v58, v59
    v_mfma_f32_16x16x32_bf16 v[44:47], v[40:43], v[140:143], v[44:47]
    v_cvt_pk_bf16_f32 v138, v60, v61
    v_cvt_pk_bf16_f32 v139, v62, v63
    v_exp_f32 v64, v64
    v_exp_f32 v65, v65
    v_mfma_f32_32x32x16_bf16 v[88:103], v[120:123], v[136:139], v[88:103]
    ds_read_b128 v[120:123], v23 offset:30720
    v_exp_f32 v66, v66
    v_exp_f32 v67, v67
    v_exp_f32 v68, v68
    v_exp_f32 v69, v69
    v_mfma_f32_16x16x32_bf16 v[44:47], v[40:43], v[136:139], v[44:47]
    v_exp_f32 v70, v70
    v_exp_f32 v71, v71
    v_cvt_pk_bf16_f32 v140, v64, v65
    v_cvt_pk_bf16_f32 v141, v66, v67
    v_cvt_pk_bf16_f32 v142, v68, v69
    v_cvt_pk_bf16_f32 v143, v70, v71
a0_10_t1:
    v_exp_f32 v72, v72
    v_exp_f32 v73, v73
    v_exp_f32_e64 v74, v74
    v_mfma_f32_32x32x16_bf16 v[88:103], v[124:127], v[140:143], v[88:103]
    v_exp_f32 v75, v75
    v_exp_f32 v76, v76
    v_exp_f32 v77, v77
    v_exp_f32 v78, v78
    v_exp_f32_e64 v79, v79
    v_cvt_pk_bf16_f32 v136, v72, v73
    v_cvt_pk_bf16_f32 v137, v74, v75
    v_mfma_f32_16x16x32_bf16 v[44:47], v[40:43], v[140:143], v[44:47]
    v_cvt_pk_bf16_f32 v138, v76, v77
    v_cvt_pk_bf16_f32 v139, v78, v79
    v_exp_f32_e64 v80, v80
    v_exp_f32 v81, v81
    s_waitcnt lgkmcnt(0)
    v_mfma_f32_32x32x16_bf16 v[88:103], v[120:123], v[136:139], v[88:103]
    v_exp_f32 v82, v82
    v_exp_f32 v83, v83
    v_exp_f32 v84, v84
    v_exp_f32 v85, v85
    v_mfma_f32_16x16x32_bf16 v[44:47], v[40:43], v[136:139], v[44:47]
    v_exp_f32 v86, v86
    v_exp_f32 v87, v87
    v_cvt_pk_bf16_f32 v140, v80, v81
    v_cvt_pk_bf16_f32 v141, v82, v83
    v_cvt_pk_bf16_f32 v142, v84, v85
    v_cvt_pk_bf16_f32 v143, v86, v87
a0_10_e1:
    s_cmp_eq_u32 s75, 0
    s_nop 0
    v_mfma_f32_16x16x32_bf16 v[44:47], v[40:43], v[140:143], v[44:47]
    v_mfma_f32_32x32x16_bf16 v[88:103], v[128:131], v[140:143], v[88:103]
    s_cbranch_scc1 a0_10_mid
    s_branch a0_10_fin
    s_nop 0
a0_10_t0:
    v_exp_f32 v56, v56
    v_exp_f32 v57, v57
    v_exp_f32 v58, v58
    v_mfma_f32_32x32x16_bf16 v[88:103], v[128:131], v[140:143], v[88:103]
    v_exp_f32 v59, v59
    v_exp_f32 v60, v60
    v_exp_f32 v61, v61
    v_exp_f32 v62, v62
    v_exp_f32_e64 v63, v63
    v_cvt_pk_bf16_f32 v136, v56, v57
    v_cvt_pk_bf16_f32 v137, v58, v59
    v_mfma_f32_16x16x32_bf16 v[44:47], v[40:43], v[140:143], v[44:47]
    v_cvt_pk_bf16_f32 v138, v60, v61
    v_cvt_pk_bf16_f32 v139, v62, v63
    v_exp_f32_e64 v64, v64
    v_exp_f32 v65, v65
    s_waitcnt lgkmcnt(0)
    v_mfma_f32_32x32x16_bf16 v[88:103], v[120:123], v[136:139], v[88:103]
    v_exp_f32 v66, v66
    v_exp_f32 v67, v67
    v_exp_f32 v68, v68
    v_exp_f32 v69, v69
    v_mfma_f32_16x16x32_bf16 v[44:47], v[40:43], v[136:139], v[44:47]
    v_exp_f32 v70, v70
    v_exp_f32 v71, v71
    v_cvt_pk_bf16_f32 v140, v64, v65
    v_cvt_pk_bf16_f32 v141, v66, v67
    v_cvt_pk_bf16_f32 v142, v68, v69
    v_cvt_pk_bf16_f32 v143, v70, v71
a0_10_e0:
    s_cmp_eq_u32 s75, 0
    s_nop 0
    v_mfma_f32_16x16x32_bf16 v[44:47], v[40:43], v[140:143], v[44:47]
    v_mfma_f32_32x32x16_bf16 v[88:103], v[124:127], v[140:143], v[88:103]
    s_cbranch_scc1 a0_10_mid
    s_branch a0_10_fin
    s_nop 0
a0_10_none:
    s_add_u32 s96, s25, 0
    s_and_b32 s96, s96, 15
    s_lshl_b32 s96, s96, 17
    s_add_u32 m0, s101, 0
    s_nop 0
    buffer_load_dwordx4 v243, s[8:11], s96 offen lds
    s_waitcnt vmcnt(1)
    s_barrier
    s_add_u32 s96, s25, 12
    s_and_b32 s96, s96, 15
    s_lshl_b32 s96, s96, 17
    s_add_u32 m0, s101, 49152
    s_nop 0
    buffer_load_dwordx4 v243, s[8:11], s96 offen lds
    s_add_u32 s96, s25, 13
    s_and_b32 s96, s96, 15
    s_lshl_b32 s96, s96, 17
    s_add_u32 m0, s101, 53248
    s_nop 0
    buffer_load_dwordx4 v243, s[8:11], s96 offen lds
    s_add_u32 s96, s25, 14
    s_and_b32 s96, s96, 15
    s_lshl_b32 s96, s96, 17
    s_add_u32 m0, s101, 57344
    s_nop 0
    buffer_load_dwordx4 v243, s[8:11], s96 offen lds
    s_add_u32 s96, s25, 15
    s_and_b32 s96, s96, 15
    s_lshl_b32 s96, s96, 17
    s_add_u32 m0, s101, 61440
    s_nop 0
    buffer_load_dwordx4 v243, s[8:11], s96 offen lds
a0_10_fin:
    s_lshl_b32 s36, s76, 16
    s_add_u32 s36, s36, 0x800000
    s_lshl_b32 s33, s25, 11
    s_add_u32 s33, s33, s36
    s_lshl_b32 s30, s24, 9
    s_and_b32 s31, s76, 3
    s_lshl_b32 s31, s31, 6
    s_add_u32 s30, s30, s31
    s_add_u32 s30, s30, s26
    s_add_u32 s30, s30, 0xdd2000
    s_lshl_b32 s31, s25, 2
    s_add_u32 s31, s31, s30
    v_cmp_ngt_f32 vcc, 0x5d800000, v44
    v_rcp_f32_e64 v22, v44
    s_cbranch_vccnz att_exact0
att_ret0:
    s_nop 3
    v_pk_mul_f32 v[88:89], v[88:89], v[22:23] op_sel_hi:[1,0]
    v_pk_mul_f32 v[90:91], v[90:91], v[22:23] op_sel_hi:[1,0]
    v_pk_mul_f32 v[92:93], v[92:93], v[22:23] op_sel_hi:[1,0]
    v_pk_mul_f32 v[94:95], v[94:95], v[22:23] op_sel_hi:[1,0]
    v_pk_mul_f32 v[96:97], v[96:97], v[22:23] op_sel_hi:[1,0]
    v_pk_mul_f32 v[98:99], v[98:99], v[22:23] op_sel_hi:[1,0]
    v_pk_mul_f32 v[100:101], v[100:101], v[22:23] op_sel_hi:[1,0]
    v_pk_mul_f32 v[102:103], v[102:103], v[22:23] op_sel_hi:[1,0]
    v_cvt_pk_bf16_f32 v88, v88, v89
    v_cvt_pk_bf16_f32 v89, v90, v91
    v_cvt_pk_bf16_f32 v90, v92, v93
    v_cvt_pk_bf16_f32 v91, v94, v95
    v_cvt_pk_bf16_f32 v92, v96, v97
    v_cvt_pk_bf16_f32 v93, v98, v99
    v_cvt_pk_bf16_f32 v94, v100, v101
    v_cvt_pk_bf16_f32 v95, v102, v103
    s_cmp_lg_u32 s77, 0
    s_cbranch_scc1 lc_23
    buffer_store_dwordx4 v[88:91], v253, s[20:23], s33 offen sc1
    buffer_store_dwordx4 v[92:95], v253, s[20:23], s33 offen offset:1024 sc1
    s_branch lc_24
    s_nop 0
lc_23:
    buffer_store_dwordx4 v[88:91], v253, s[20:23], s33 offen
    buffer_store_dwordx4 v[92:95], v253, s[20:23], s33 offen offset:1024
lc_24:
    v_bfe_u32 v33, v252, 2, 2
    v_lshrrev_b32_e64 v32, 5, v252
    v_lshl_add_u32 v34, v32, 3, v33
    v_lshlrev_b32 v34, 7, v34
    v_lshrrev_b32 v33, 1, v33
    v_lshl_add_u32 v34, v33, 6, v34
    v_bfe_u32 v33, v252, 4, 1
    v_lshl_add_u32 v34, v33, 5, v34
    v_and_b32_e64 v33, 3, v252
    v_lshl_add_u32 v56, v33, 3, v34
    v_xor_b32_e64 v57, 64, v56
    v_add_u32 v58, 0x10000, v56
    v_add_u32 v59, 0x10000, v57
    v_and_b32 v60, 15, v252
    v_lshlrev_b32 v60, 2, v60
    s_waitcnt vmcnt(2)
    s_and_b32 s35, s99, 3
    s_cmp_lg_u32 s35, 0
    s_cbranch_scc1 sk_25
    s_barrier
sk_25:
    v_lshlrev_b32 v0, 16, v208
    v_and_b32 v1, 0xffff0000, v208
    v_lshlrev_b32_e64 v2, 16, v209
    v_and_b32 v3, 0xffff0000, v209
    v_lshlrev_b32_e64 v4, 16, v210
    v_and_b32 v5, 0xffff0000, v210
    v_lshlrev_b32_e64 v6, 16, v211
    v_and_b32 v7, 0xffff0000, v211
    v_lshlrev_b32_e64 v8, 16, v212
    v_and_b32 v9, 0xffff0000, v212
    v_lshlrev_b32_e64 v10, 16, v213
    v_and_b32 v11, 0xffff0000, v213
    v_lshlrev_b32_e64 v12, 16, v214
    v_and_b32 v13, 0xffff0000, v214
    v_lshlrev_b32_e64 v14, 16, v215
    v_and_b32 v15, 0xffff0000, v215
    v_lshlrev_b32_e64 v16, 16, v216
    v_and_b32 v17, 0xffff0000, v216
    v_lshlrev_b32_e64 v18, 16, v217
    v_and_b32 v19, 0xffff0000, v217
    v_lshlrev_b32_e64 v20, 16, v218
    v_and_b32 v21, 0xffff0000, v218
    v_lshlrev_b32_e64 v22, 16, v219
    v_and_b32 v23, 0xffff0000, v219
    v_lshlrev_b32_e64 v24, 16, v220
    v_and_b32 v25, 0xffff0000, v220
    v_lshlrev_b32_e64 v26, 16, v221
    v_and_b32 v27, 0xffff0000, v221
    v_lshlrev_b32_e64 v28, 16, v222
    v_and_b32 v29, 0xffff0000, v222
    v_lshlrev_b32_e64 v30, 16, v223
    v_and_b32 v31, 0xffff0000, v223
    v_pk_fma_f32 v[0:1], v[0:1], v[240:241], v[240:241] op_sel:[0,0,1] op_sel_hi:[1,0,1]
    v_pk_fma_f32 v[2:3], v[2:3], v[240:241], v[240:241] op_sel:[0,0,1] op_sel_hi:[1,0,1]
    v_pk_fma_f32 v[4:5], v[4:5], v[240:241], v[240:241] op_sel:[0,0,1] op_sel_hi:[1,0,1]
    v_pk_fma_f32 v[6:7], v[6:7], v[240:241], v[240:241] op_sel:[0,0,1] op_sel_hi:[1,0,1]
    v_pk_fma_f32 v[8:9], v[8:9], v[240:241], v[240:241] op_sel:[0,0,1] op_sel_hi:[1,0,1]
    v_pk_fma_f32 v[10:11], v[10:11], v[240:241], v[240:241] op_sel:[0,0,1] op_sel_hi:[1,0,1]
    v_pk_fma_f32 v[12:13], v[12:13], v[240:241], v[240:241] op_sel:[0,0,1] op_sel_hi:[1,0,1]
    v_pk_fma_f32 v[14:15], v[14:15], v[240:241], v[240:241] op_sel:[0,0,1] op_sel_hi:[1,0,1]
    v_pk_fma_f32 v[16:17], v[16:17], v[240:241], v[240:241] op_sel:[0,0,1] op_sel_hi:[1,0,1]
    v_pk_fma_f32 v[18:19], v[18:19], v[240:241], v[240:241] op_sel:[0,0,1] op_sel_hi:[1,0,1]
    v_pk_fma_f32 v[20:21], v[20:21], v[240:241], v[240:241] op_sel:[0,0,1] op_sel_hi:[1,0,1]
    v_pk_fma_f32 v[22:23], v[22:23], v[240:241], v[240:241] op_sel:[0,0,1] op_sel_hi:[1,0,1]
    v_pk_fma_f32 v[24:25], v[24:25], v[240:241], v[240:241] op_sel:[0,0,1] op_sel_hi:[1,0,1]
    v_pk_fma_f32 v[26:27], v[26:27], v[240:241], v[240:241] op_sel:[0,0,1] op_sel_hi:[1,0,1]
    v_pk_fma_f32 v[28:29], v[28:29], v[240:241], v[240:241] op_sel:[0,0,1] op_sel_hi:[1,0,1]
    v_pk_fma_f32 v[30:31], v[30:31], v[240:241], v[240:241] op_sel:[0,0,1] op_sel_hi:[1,0,1]
    v_mov_b32_e64 v154, s88
    s_mov_b64 exec, 1
    s_waitcnt vmcnt(0)
    s_cmp_lg_u32 s77, 0
    s_cbranch_scc1 lc_26
    buffer_store_dword v154, v253, s[20:23], s31 offen sc1
    s_branch lc_27
lc_26:
    buffer_store_dword v154, v253, s[20:23], s31 offen
lc_27:
    s_mov_b64 exec, -1
    s_cmp_eq_u32 s35, 0
    s_cbranch_scc1 sk_28
    s_barrier
sk_28:
    s_add_u32 s96, s25, 0
    s_and_b32 s96, s96, 15
    s_lshl_b32 s96, s96, 17
    s_add_u32 s96, s96, 65536
    s_add_u32 m0, s101, 65536
    s_nop 0
    buffer_load_dwordx4 v243, s[8:11], s96 offen lds
    s_add_u32 s96, s25, 1
    s_and_b32 s96, s96, 15
    s_lshl_b32 s96, s96, 17
    s_add_u32 s96, s96, 65536
    s_add_u32 m0, s101, 69632
    s_nop 0
    buffer_load_dwordx4 v243, s[8:11], s96 offen lds
    s_add_u32 s96, s25, 2
    s_and_b32 s96, s96, 15
    s_lshl_b32 s96, s96, 17
    s_add_u32 s96, s96, 65536
    s_add_u32 m0, s101, 73728
    s_nop 0
    buffer_load_dwordx4 v243, s[8:11], s96 offen lds
    s_add_u32 s96, s25, 3
    s_and_b32 s96, s96, 15
    s_lshl_b32 s96, s96, 17
    s_add_u32 s96, s96, 65536
    s_add_u32 m0, s101, 77824
    s_nop 0
    buffer_load_dwordx4 v243, s[8:11], s96 offen lds
    s_add_u32 s96, s25, 4
    s_and_b32 s96, s96, 15
    s_lshl_b32 s96, s96, 17
    s_add_u32 s96, s96, 65536
    s_add_u32 m0, s101, 81920
    s_nop 0
    buffer_load_dwordx4 v243, s[8:11], s96 offen lds
    s_add_u32 s96, s25, 5
    s_and_b32 s96, s96, 15
    s_lshl_b32 s96, s96, 17
    s_add_u32 s96, s96, 65536
    s_add_u32 m0, s101, 86016
    s_nop 0
    buffer_load_dwordx4 v243, s[8:11], s96 offen lds
    s_add_u32 s96, s25, 6
    s_and_b32 s96, s96, 15
    s_lshl_b32 s96, s96, 17
    s_add_u32 s96, s96, 65536
    s_add_u32 m0, s101, 90112
    s_nop 0
    buffer_load_dwordx4 v243, s[8:11], s96 offen lds
    s_add_u32 s96, s25, 7
    s_and_b32 s96, s96, 15
    s_lshl_b32 s96, s96, 17
    s_add_u32 s96, s96, 65536
    s_add_u32 m0, s101, 94208
    s_nop 0
    buffer_load_dwordx4 v243, s[8:11], s96 offen lds
    s_add_u32 s96, s25, 8
    s_and_b32 s96, s96, 15
    s_lshl_b32 s96, s96, 17
    s_add_u32 s96, s96, 65536
    s_add_u32 m0, s101, 98304
    s_nop 0
    buffer_load_dwordx4 v243, s[8:11], s96 offen lds
    s_add_u32 s96, s25, 9
    s_and_b32 s96, s96, 15
    s_lshl_b32 s96, s96, 17
    s_add_u32 s96, s96, 65536
    s_add_u32 m0, s101, 102400
    s_nop 0
    buffer_load_dwordx4 v243, s[8:11], s96 offen lds
    s_add_u32 s96, s25, 10
    s_and_b32 s96, s96, 15
    s_lshl_b32 s96, s96, 17
    s_add_u32 s96, s96, 65536
    s_add_u32 m0, s101, 106496
    s_nop 0
    buffer_load_dwordx4 v243, s[8:11], s96 offen lds
    s_add_u32 s96, s25, 11
    s_and_b32 s96, s96, 15
    s_lshl_b32 s96, s96, 17
    s_add_u32 s96, s96, 65536
    s_add_u32 m0, s101, 110592
    s_nop 0
    buffer_load_dwordx4 v243, s[8:11], s96 offen lds
    v_bfe_u32 v100, v252, 4, 1
    v_lshlrev_b32 v100, 11, v100
    v_lshrrev_b32_e64 v101, 5, v252
    v_lshl_add_u32 v100, v101, 8, v100
    v_and_b32 v101, 15, v252
    v_lshl_add_u32 v100, v101, 4, v100
    s_lshl_b32 s34, s28, 12
    s_add_u32 s34, s34, 147456
    v_add_u32 v101, s34, v100
    s_lshl_b32 s37, s25, 11
    ds_read_b64_tr_b16 v[32:33], v56 offset:0
    ds_read_b64_tr_b16 v[34:35], v56 offset:512
    ds_read_b64_tr_b16 v[36:37], v57 offset:0
    ds_read_b64_tr_b16 v[38:39], v57 offset:512
    ds_read_b64_tr_b16 v[40:41], v56 offset:2048
    ds_read_b64_tr_b16 v[42:43], v56 offset:2560
    ds_read_b64_tr_b16 v[44:45], v57 offset:2048
    ds_read_b64_tr_b16 v[46:47], v57 offset:2560
    s_mov_b32 s78, s27
pl_29:
    buffer_load_dword v61, v60, s[20:23], s30 offen offset:0 sc1
    s_waitcnt vmcnt(0)
pc_30:
    v_cmp_ne_u32_e64 vcc, s88, v61
    s_cbranch_vccz pd_31
    s_sub_u32 s78, s78, 1
    s_cmp_lg_u32 s78, 0
    s_cbranch_scc1 pl_29
    s_mov_b32 s27, 1
pd_31:
    s_add_u32 s38, s36, s37
    buffer_load_dwordx4 v[104:107], v253, s[20:23], s38 offen offset:0 sc1
    s_add_u32 s37, s37, 2048
    s_and_b32 s37, s37, 0x7800
    buffer_load_dwordx4 v[108:111], v253, s[20:23], s38 offen offset:1024 sc1
    s_add_u32 s38, s36, s37
    buffer_load_dwordx4 v[112:115], v253, s[20:23], s38 offen offset:0 sc1
    s_add_u32 s37, s37, 2048
    s_and_b32 s37, s37, 0x7800
    buffer_load_dwordx4 v[116:119], v253, s[20:23], s38 offen offset:1024 sc1
    s_add_u32 s38, s36, s37
    buffer_load_dwordx4 v[120:123], v253, s[20:23], s38 offen offset:0 sc1
    s_add_u32 s37, s37, 2048
    s_and_b32 s37, s37, 0x7800
    buffer_load_dwordx4 v[124:127], v253, s[20:23], s38 offen offset:1024 sc1
    s_add_u32 s38, s36, s37
    buffer_load_dwordx4 v[128:131], v253, s[20:23], s38 offen offset:0 sc1
    s_add_u32 s37, s37, 2048
    s_and_b32 s37, s37, 0x7800
    buffer_load_dwordx4 v[132:135], v253, s[20:23], s38 offen offset:1024 sc1
    s_waitcnt vmcnt(7) lgkmcnt(4)
    v_mfma_f32_32x32x16_bf16 v[0:15], v[32:35], v[104:107], v[0:15]
    s_add_u32 s38, s36, s37
    buffer_load_dwordx4 v[136:139], v253, s[20:23], s38 offen offset:0 sc1
    ds_read_b64_tr_b16 v[48:49], v56 offset:4096
    ds_read_b64_tr_b16 v[50:51], v56 offset:4608
    v_mfma_f32_32x32x16_bf16 v[16:31], v[36:39], v[104:107], v[16:31]
    ds_read_b64_tr_b16 v[52:53], v57 offset:4096
    ds_read_b64_tr_b16 v[54:55], v57 offset:4608
    s_waitcnt vmcnt(7) lgkmcnt(4)
    v_mfma_f32_32x32x16_bf16 v[0:15], v[40:43], v[108:111], v[0:15]
    s_add_u32 s37, s37, 2048
    s_and_b32 s37, s37, 0x7800
    buffer_load_dwordx4 v[104:107], v253, s[20:23], s38 offen offset:1024 sc1
    ds_read_b64_tr_b16 v[32:33], v56 offset:6144
    ds_read_b64_tr_b16 v[34:35], v56 offset:6656
    v_mfma_f32_32x32x16_bf16 v[16:31], v[44:47], v[108:111], v[16:31]
    ds_read_b64_tr_b16 v[36:37], v57 offset:6144
    ds_read_b64_tr_b16 v[38:39], v57 offset:6656
    s_waitcnt vmcnt(7) lgkmcnt(4)
    v_mfma_f32_32x32x16_bf16 v[0:15], v[48:51], v[112:115], v[0:15]
    s_add_u32 s38, s36, s37
    buffer_load_dwordx4 v[108:111], v253, s[20:23], s38 offen offset:0 sc1
    ds_read_b64_tr_b16 v[40:41], v56 offset:8192
    ds_read_b64_tr_b16 v[42:43], v56 offset:8704
    v_mfma_f32_32x32x16_bf16 v[16:31], v[52:55], v[112:115], v[16:31]
    ds_read_b64_tr_b16 v[44:45], v57 offset:8192
    ds_read_b64_tr_b16 v[46:47], v57 offset:8704
    s_waitcnt vmcnt(7) lgkmcnt(4)
    v_mfma_f32_32x32x16_bf16 v[0:15], v[32:35], v[116:119], v[0:15]
    s_add_u32 s37, s37, 2048
    s_and_b32 s37, s37, 0x7800
    buffer_load_dwordx4 v[112:115], v253, s[20:23], s38 offen offset:1024 sc1
    ds_read_b64_tr_b16 v[48:49], v56 offset:10240
    ds_read_b64_tr_b16 v[50:51], v56 offset:10752
    v_mfma_f32_32x32x16_bf16 v[16:31], v[36:39], v[116:119], v[16:31]
    ds_read_b64_tr_b16 v[52:53], v57 offset:10240
    ds_read_b64_tr_b16 v[54:55], v57 offset:10752
    s_waitcnt vmcnt(7) lgkmcnt(4)
    v_mfma_f32_32x32x16_bf16 v[0:15], v[40:43], v[120:123], v[0:15]
    s_add_u32 s38, s36, s37
    buffer_load_dwordx4 v[116:119], v253, s[20:23], s38 offen offset:0 sc1
    ds_read_b64_tr_b16 v[32:33], v56 offset:12288
    ds_read_b64_tr_b16 v[34:35], v56 offset:12800
    v_mfma_f32_32x32x16_bf16 v[16:31], v[44:47], v[120:123], v[16:31]
    ds_read_b64_tr_b16 v[36:37], v57 offset:12288
    ds_read_b64_tr_b16 v[38:39], v57 offset:12800
    s_waitcnt vmcnt(7) lgkmcnt(4)
    v_mfma_f32_32x32x16_bf16 v[0:15], v[48:51], v[124:127], v[0:15]
    s_add_u32 s37, s37, 2048
    s_and_b32 s37, s37, 0x7800
    buffer_load_dwordx4 v[120:123], v253, s[20:23], s38 offen offset:1024 sc1
    ds_read_b64_tr_b16 v[40:41], v56 offset:14336
    ds_read_b64_tr_b16 v[42:43], v56 offset:14848
    v_mfma_f32_32x32x16_bf16 v[16:31], v[52:55], v[124:127], v[16:31]
    ds_read_b64_tr_b16 v[44:45], v57 offset:14336
    ds_read_b64_tr_b16 v[46:47], v57 offset:14848
    s_waitcnt vmcnt(7) lgkmcnt(4)
    v_mfma_f32_32x32x16_bf16 v[0:15], v[32:35], v[128:131], v[0:15]
    s_add_u32 s38, s36, s37
    buffer_load_dwordx4 v[124:127], v253, s[20:23], s38 offen offset:0 sc1
    ds_read_b64_tr_b16 v[48:49], v56 offset:16384
    ds_read_b64_tr_b16 v[50:51], v56 offset:16896
    v_mfma_f32_32x32x16_bf16 v[16:31], v[36:39], v[128:131], v[16:31]
    ds_read_b64_tr_b16 v[52:53], v57 offset:16384
    ds_read_b64_tr_b16 v[54:55], v57 offset:16896
    s_waitcnt vmcnt(7) lgkmcnt(4)
    v_mfma_f32_32x32x16_bf16 v[0:15], v[40:43], v[132:135], v[0:15]
    s_add_u32 s37, s37, 2048
    s_and_b32 s37, s37, 0x7800
    buffer_load_dwordx4 v[128:131], v253, s[20:23], s38 offen offset:1024 sc1
    ds_read_b64_tr_b16 v[32:33], v56 offset:18432
    ds_read_b64_tr_b16 v[34:35], v56 offset:18944
    v_mfma_f32_32x32x16_bf16 v[16:31], v[44:47], v[132:135], v[16:31]
    ds_read_b64_tr_b16 v[36:37], v57 offset:18432
    ds_read_b64_tr_b16 v[38:39], v57 offset:18944
    s_waitcnt vmcnt(7) lgkmcnt(4)
    v_mfma_f32_32x32x16_bf16 v[0:15], v[48:51], v[136:139], v[0:15]
    s_add_u32 s38, s36, s37
    buffer_load_dwordx4 v[132:135], v253, s[20:23], s38 offen offset:0 sc1
    ds_read_b64_tr_b16 v[40:41], v56 offset:20480
    ds_read_b64_tr_b16 v[42:43], v56 offset:20992
    v_mfma_f32_32x32x16_bf16 v[16:31], v[52:55], v[136:139], v[16:31]
    ds_read_b64_tr_b16 v[44:45], v57 offset:20480
    ds_read_b64_tr_b16 v[46:47], v57 offset:20992
    s_waitcnt vmcnt(7) lgkmcnt(4)
    v_mfma_f32_32x32x16_bf16 v[0:15], v[32:35], v[104:107], v[0:15]
    s_add_u32 s37, s37, 2048
    s_and_b32 s37, s37, 0x7800
    buffer_load_dwordx4 v[136:139], v253, s[20:23], s38 offen offset:1024 sc1
    ds_read_b64_tr_b16 v[48:49], v56 offset:22528
    ds_read_b64_tr_b16 v[50:51], v56 offset:23040
    v_mfma_f32_32x32x16_bf16 v[16:31], v[36:39], v[104:107], v[16:31]
    ds_read_b64_tr_b16 v[52:53], v57 offset:22528
    ds_read_b64_tr_b16 v[54:55], v57 offset:23040
    s_waitcnt vmcnt(7) lgkmcnt(4)
    v_mfma_f32_32x32x16_bf16 v[0:15], v[40:43], v[108:111], v[0:15]
    s_add_u32 s38, s36, s37
    buffer_load_dwordx4 v[104:107], v253, s[20:23], s38 offen offset:0 sc1
    ds_read_b64_tr_b16 v[32:33], v56 offset:24576
    ds_read_b64_tr_b16 v[34:35], v56 offset:25088
    v_mfma_f32_32x32x16_bf16 v[16:31], v[44:47], v[108:111], v[16:31]
    ds_read_b64_tr_b16 v[36:37], v57 offset:24576
    ds_read_b64_tr_b16 v[38:39], v57 offset:25088
    s_waitcnt vmcnt(7) lgkmcnt(4)
    v_mfma_f32_32x32x16_bf16 v[0:15], v[48:51], v[112:115], v[0:15]
    s_add_u32 s37, s37, 2048
    s_and_b32 s37, s37, 0x7800
    buffer_load_dwordx4 v[108:111], v253, s[20:23], s38 offen offset:1024 sc1
    ds_read_b64_tr_b16 v[40:41], v56 offset:26624
    ds_read_b64_tr_b16 v[42:43], v56 offset:27136
    v_mfma_f32_32x32x16_bf16 v[16:31], v[52:55], v[112:115], v[16:31]
    ds_read_b64_tr_b16 v[44:45], v57 offset:26624
    ds_read_b64_tr_b16 v[46:47], v57 offset:27136
    s_waitcnt vmcnt(7) lgkmcnt(4)
    v_mfma_f32_32x32x16_bf16 v[0:15], v[32:35], v[116:119], v[0:15]
    s_add_u32 s38, s36, s37
    buffer_load_dwordx4 v[112:115], v253, s[20:23], s38 offen offset:0 sc1
    ds_read_b64_tr_b16 v[48:49], v56 offset:28672
    ds_read_b64_tr_b16 v[50:51], v56 offset:29184
    v_mfma_f32_32x32x16_bf16 v[16:31], v[36:39], v[116:119], v[16:31]
    ds_read_b64_tr_b16 v[52:53], v57 offset:28672
    ds_read_b64_tr_b16 v[54:55], v57 offset:29184
    s_waitcnt vmcnt(7) lgkmcnt(4)
    v_mfma_f32_32x32x16_bf16 v[0:15], v[40:43], v[120:123], v[0:15]
    s_add_u32 s37, s37, 2048
    s_and_b32 s37, s37, 0x7800
    buffer_load_dwordx4 v[116:119], v253, s[20:23], s38 offen offset:1024 sc1
    ds_read_b64_tr_b16 v[32:33], v56 offset:30720
    ds_read_b64_tr_b16 v[34:35], v56 offset:31232
    v_mfma_f32_32x32x16_bf16 v[16:31], v[44:47], v[120:123], v[16:31]
    ds_read_b64_tr_b16 v[36:37], v57 offset:30720
    ds_read_b64_tr_b16 v[38:39], v57 offset:31232
    s_waitcnt vmcnt(7) lgkmcnt(4)
    v_mfma_f32_32x32x16_bf16 v[0:15], v[48:51], v[124:127], v[0:15]
    s_add_u32 s38, s36, s37
    buffer_load_dwordx4 v[120:123], v253, s[20:23], s38 offen offset:0 sc1
    ds_read_b64_tr_b16 v[40:41], v56 offset:32768
    ds_read_b64_tr_b16 v[42:43], v56 offset:33280
    v_mfma_f32_32x32x16_bf16 v[16:31], v[52:55], v[124:127], v[16:31]
    ds_read_b64_tr_b16 v[44:45], v57 offset:32768
    ds_read_b64_tr_b16 v[46:47], v57 offset:33280
    s_waitcnt vmcnt(7) lgkmcnt(4)
    v_mfma_f32_32x32x16_bf16 v[0:15], v[32:35], v[128:131], v[0:15]
    s_add_u32 s37, s37, 2048
    s_and_b32 s37, s37, 0x7800
    buffer_load_dwordx4 v[124:127], v253, s[20:23], s38 offen offset:1024 sc1
    ds_read_b64_tr_b16 v[48:49], v56 offset:34816
    ds_read_b64_tr_b16 v[50:51], v56 offset:35328
    v_mfma_f32_32x32x16_bf16 v[16:31], v[36:39], v[128:131], v[16:31]
    ds_read_b64_tr_b16 v[52:53], v57 offset:34816
    ds_read_b64_tr_b16 v[54:55], v57 offset:35328
    s_waitcnt vmcnt(7) lgkmcnt(4)
    v_mfma_f32_32x32x16_bf16 v[0:15], v[40:43], v[132:135], v[0:15]
    s_add_u32 s38, s36, s37
    buffer_load_dwordx4 v[128:131], v253, s[20:23], s38 offen offset:0 sc1
    ds_read_b64_tr_b16 v[32:33], v56 offset:36864
    ds_read_b64_tr_b16 v[34:35], v56 offset:37376
    v_mfma_f32_32x32x16_bf16 v[16:31], v[44:47], v[132:135], v[16:31]
    ds_read_b64_tr_b16 v[36:37], v57 offset:36864
    ds_read_b64_tr_b16 v[38:39], v57 offset:37376
    s_waitcnt vmcnt(7) lgkmcnt(4)
    v_mfma_f32_32x32x16_bf16 v[0:15], v[48:51], v[136:139], v[0:15]
    s_add_u32 s37, s37, 2048
    s_and_b32 s37, s37, 0x7800
    buffer_load_dwordx4 v[132:135], v253, s[20:23], s38 offen offset:1024 sc1
    ds_read_b64_tr_b16 v[40:41], v56 offset:38912
    ds_read_b64_tr_b16 v[42:43], v56 offset:39424
    v_mfma_f32_32x32x16_bf16 v[16:31], v[52:55], v[136:139], v[16:31]
    ds_read_b64_tr_b16 v[44:45], v57 offset:38912
    ds_read_b64_tr_b16 v[46:47], v57 offset:39424
    s_waitcnt vmcnt(7) lgkmcnt(4)
    v_mfma_f32_32x32x16_bf16 v[0:15], v[32:35], v[104:107], v[0:15]
    s_add_u32 s38, s36, s37
    buffer_load_dwordx4 v[136:139], v253, s[20:23], s38 offen offset:0 sc1
    ds_read_b64_tr_b16 v[48:49], v56 offset:40960
    ds_read_b64_tr_b16 v[50:51], v56 offset:41472
    v_mfma_f32_32x32x16_bf16 v[16:31], v[36:39], v[104:107], v[16:31]
    ds_read_b64_tr_b16 v[52:53], v57 offset:40960
    ds_read_b64_tr_b16 v[54:55], v57 offset:41472
    s_waitcnt vmcnt(7) lgkmcnt(4)
    v_mfma_f32_32x32x16_bf16 v[0:15], v[40:43], v[108:111], v[0:15]
    s_add_u32 s37, s37, 2048
    s_and_b32 s37, s37, 0x7800
    buffer_load_dwordx4 v[104:107], v253, s[20:23], s38 offen offset:1024 sc1
    ds_read_b64_tr_b16 v[32:33], v56 offset:43008
    ds_read_b64_tr_b16 v[34:35], v56 offset:43520
    v_mfma_f32_32x32x16_bf16 v[16:31], v[44:47], v[108:111], v[16:31]
    ds_read_b64_tr_b16 v[36:37], v57 offset:43008
    ds_read_b64_tr_b16 v[38:39], v57 offset:43520
    s_waitcnt vmcnt(7) lgkmcnt(4)
    v_mfma_f32_32x32x16_bf16 v[0:15], v[48:51], v[112:115], v[0:15]
    buffer_load_dword v61, v60, s[20:23], s30 offen offset:256 sc1
    s_add_u32 s38, s36, s37
    buffer_load_dwordx4 v[108:111], v253, s[20:23], s38 offen offset:0 sc1
    ds_read_b64_tr_b16 v[40:41], v56 offset:45056
    ds_read_b64_tr_b16 v[42:43], v56 offset:45568
    v_mfma_f32_32x32x16_bf16 v[16:31], v[52:55], v[112:115], v[16:31]
    ds_read_b64_tr_b16 v[44:45], v57 offset:45056
    ds_read_b64_tr_b16 v[46:47], v57 offset:45568
    s_waitcnt vmcnt(8) lgkmcnt(4)
    v_mfma_f32_32x32x16_bf16 v[0:15], v[32:35], v[116:119], v[0:15]
    s_add_u32 s37, s37, 2048
    s_and_b32 s37, s37, 0x7800
    buffer_load_dwordx4 v[112:115], v253, s[20:23], s38 offen offset:1024 sc1
    ds_read_b64_tr_b16 v[48:49], v56 offset:47104
    ds_read_b64_tr_b16 v[50:51], v56 offset:47616
    v_mfma_f32_32x32x16_bf16 v[16:31], v[36:39], v[116:119], v[16:31]
    ds_read_b64_tr_b16 v[52:53], v57 offset:47104
    ds_read_b64_tr_b16 v[54:55], v57 offset:47616
    s_waitcnt vmcnt(8) lgkmcnt(4)
    v_mfma_f32_32x32x16_bf16 v[0:15], v[40:43], v[120:123], v[0:15]
    s_add_u32 s38, s36, s37
    buffer_load_dwordx4 v[116:119], v253, s[20:23], s38 offen offset:0 sc1
    ds_read_b64_tr_b16 v[32:33], v56 offset:49152
    ds_read_b64_tr_b16 v[34:35], v56 offset:49664
    v_mfma_f32_32x32x16_bf16 v[16:31], v[44:47], v[120:123], v[16:31]
    ds_read_b64_tr_b16 v[36:37], v57 offset:49152
    ds_read_b64_tr_b16 v[38:39], v57 offset:49664
    s_waitcnt vmcnt(8) lgkmcnt(4)
    v_mfma_f32_32x32x16_bf16 v[0:15], v[48:51], v[124:127], v[0:15]
    s_add_u32 s37, s37, 2048
    s_and_b32 s37, s37, 0x7800
    buffer_load_dwordx4 v[120:123], v253, s[20:23], s38 offen offset:1024 sc1
    ds_read_b64_tr_b16 v[40:41], v56 offset:51200
    ds_read_b64_tr_b16 v[42:43], v56 offset:51712
    v_mfma_f32_32x32x16_bf16 v[16:31], v[52:55], v[124:127], v[16:31]
    ds_read_b64_tr_b16 v[44:45], v57 offset:51200
    ds_read_b64_tr_b16 v[46:47], v57 offset:51712
    s_waitcnt vmcnt(8) lgkmcnt(4)
    v_mfma_f32_32x32x16_bf16 v[0:15], v[32:35], v[128:131], v[0:15]
    s_mov_b32 s78, s27
    s_waitcnt vmcnt(4)
    s_branch pc_33
pl_32:
    buffer_load_dword v61, v60, s[20:23], s30 offen offset:256 sc1
    s_waitcnt vmcnt(0)
pc_33:
    v_cmp_ne_u32 vcc, s88, v61
    s_cbranch_vccz pd_34
    s_sub_u32 s78, s78, 1
    s_cmp_lg_u32 s78, 0
    s_cbranch_scc1 pl_32
    s_mov_b32 s27, 1
pd_34:
    s_add_u32 s36, s36, 32768
    s_add_u32 s38, s36, s37
    buffer_load_dwordx4 v[124:127], v253, s[20:23], s38 offen offset:0 sc1
    ds_read_b64_tr_b16 v[48:49], v56 offset:53248
    ds_read_b64_tr_b16 v[50:51], v56 offset:53760
    v_mfma_f32_32x32x16_bf16 v[16:31], v[36:39], v[128:131], v[16:31]
    ds_read_b64_tr_b16 v[52:53], v57 offset:53248
    ds_read_b64_tr_b16 v[54:55], v57 offset:53760
    s_waitcnt vmcnt(8) lgkmcnt(4)
    v_mfma_f32_32x32x16_bf16 v[0:15], v[40:43], v[132:135], v[0:15]
    s_add_u32 s37, s37, 2048
    s_and_b32 s37, s37, 0x7800
    buffer_load_dwordx4 v[128:131], v253, s[20:23], s38 offen offset:1024 sc1
    ds_read_b64_tr_b16 v[32:33], v56 offset:55296
    ds_read_b64_tr_b16 v[34:35], v56 offset:55808
    v_mfma_f32_32x32x16_bf16 v[16:31], v[44:47], v[132:135], v[16:31]
    ds_read_b64_tr_b16 v[36:37], v57 offset:55296
    ds_read_b64_tr_b16 v[38:39], v57 offset:55808
    s_waitcnt vmcnt(8) lgkmcnt(4)
    v_mfma_f32_32x32x16_bf16 v[0:15], v[48:51], v[136:139], v[0:15]
    s_add_u32 s38, s36, s37
    buffer_load_dwordx4 v[132:135], v253, s[20:23], s38 offen offset:0 sc1
    ds_read_b64_tr_b16 v[40:41], v56 offset:57344
    ds_read_b64_tr_b16 v[42:43], v56 offset:57856
    v_mfma_f32_32x32x16_bf16 v[16:31], v[52:55], v[136:139], v[16:31]
    ds_read_b64_tr_b16 v[44:45], v57 offset:57344
    ds_read_b64_tr_b16 v[46:47], v57 offset:57856
    s_waitcnt vmcnt(8) lgkmcnt(4)
    v_mfma_f32_32x32x16_bf16 v[0:15], v[32:35], v[104:107], v[0:15]
    s_add_u32 s37, s37, 2048
    s_and_b32 s37, s37, 0x7800
    buffer_load_dwordx4 v[136:139], v253, s[20:23], s38 offen offset:1024 sc1
    ds_read_b64_tr_b16 v[48:49], v56 offset:59392
    ds_read_b64_tr_b16 v[50:51], v56 offset:59904
    v_mfma_f32_32x32x16_bf16 v[16:31], v[36:39], v[104:107], v[16:31]
    ds_read_b64_tr_b16 v[52:53], v57 offset:59392
    ds_read_b64_tr_b16 v[54:55], v57 offset:59904
    s_waitcnt vmcnt(7) lgkmcnt(4)
    v_mfma_f32_32x32x16_bf16 v[0:15], v[40:43], v[108:111], v[0:15]
    s_add_u32 s38, s36, s37
    buffer_load_dwordx4 v[104:107], v253, s[20:23], s38 offen offset:0 sc1
    ds_read_b64_tr_b16 v[32:33], v56 offset:61440
    ds_read_b64_tr_b16 v[34:35], v56 offset:61952
    v_mfma_f32_32x32x16_bf16 v[16:31], v[44:47], v[108:111], v[16:31]
    ds_read_b64_tr_b16 v[36:37], v57 offset:61440
    ds_read_b64_tr_b16 v[38:39], v57 offset:61952
    s_waitcnt vmcnt(7) lgkmcnt(4)
    v_mfma_f32_32x32x16_bf16 v[0:15], v[48:51], v[112:115], v[0:15]
    s_add_u32 s37, s37, 2048
    s_and_b32 s37, s37, 0x7800
    buffer_load_dwordx4 v[108:111], v253, s[20:23], s38 offen offset:1024 sc1
    ds_read_b64_tr_b16 v[40:41], v56 offset:63488
    ds_read_b64_tr_b16 v[42:43], v56 offset:64000
    v_mfma_f32_32x32x16_bf16 v[16:31], v[52:55], v[112:115], v[16:31]
    ds_read_b64_tr_b16 v[44:45], v57 offset:63488
    ds_read_b64_tr_b16 v[46:47], v57 offset:64000
    s_barrier
    s_waitcnt vmcnt(7) lgkmcnt(4)
    v_mfma_f32_32x32x16_bf16 v[0:15], v[32:35], v[116:119], v[0:15]
    s_add_u32 s38, s36, s37
    buffer_load_dwordx4 v[112:115], v253, s[20:23], s38 offen offset:0 sc1
    ds_read_b64_tr_b16 v[48:49], v58 offset:0
    ds_read_b64_tr_b16 v[50:51], v58 offset:512
    v_mfma_f32_32x32x16_bf16 v[16:31], v[36:39], v[116:119], v[16:31]
    ds_read_b64_tr_b16 v[52:53], v59 offset:0
    ds_read_b64_tr_b16 v[54:55], v59 offset:512
    s_waitcnt vmcnt(7) lgkmcnt(4)
    v_mfma_f32_32x32x16_bf16 v[0:15], v[40:43], v[120:123], v[0:15]
    s_add_u32 s37, s37, 2048
    s_and_b32 s37, s37, 0x7800
    buffer_load_dwordx4 v[116:119], v253, s[20:23], s38 offen offset:1024 sc1
    ds_read_b64_tr_b16 v[32:33], v58 offset:2048
    ds_read_b64_tr_b16 v[34:35], v58 offset:2560
    v_mfma_f32_32x32x16_bf16 v[16:31], v[44:47], v[120:123], v[16:31]
    ds_read_b64_tr_b16 v[36:37], v59 offset:2048
    ds_read_b64_tr_b16 v[38:39], v59 offset:2560
    s_waitcnt vmcnt(7) lgkmcnt(4)
    v_mfma_f32_32x32x16_bf16 v[0:15], v[48:51], v[124:127], v[0:15]
    s_add_u32 s38, s36, s37
    buffer_load_dwordx4 v[120:123], v253, s[20:23], s38 offen offset:0 sc1
    ds_read_b64_tr_b16 v[40:41], v58 offset:4096
    ds_read_b64_tr_b16 v[42:43], v58 offset:4608
    v_mfma_f32_32x32x16_bf16 v[16:31], v[52:55], v[124:127], v[16:31]
    ds_read_b64_tr_b16 v[44:45], v59 offset:4096
    ds_read_b64_tr_b16 v[46:47], v59 offset:4608
    s_waitcnt vmcnt(7) lgkmcnt(4)
    v_mfma_f32_32x32x16_bf16 v[0:15], v[32:35], v[128:131], v[0:15]
    s_add_u32 s37, s37, 2048
    s_and_b32 s37, s37, 0x7800
    buffer_load_dwordx4 v[124:127], v253, s[20:23], s38 offen offset:1024 sc1
    ds_read_b64_tr_b16 v[48:49], v58 offset:6144
    ds_read_b64_tr_b16 v[50:51], v58 offset:6656
    v_mfma_f32_32x32x16_bf16 v[16:31], v[36:39], v[128:131], v[16:31]
    ds_read_b64_tr_b16 v[52:53], v59 offset:6144
    ds_read_b64_tr_b16 v[54:55], v59 offset:6656
    s_waitcnt vmcnt(7) lgkmcnt(4)
    v_mfma_f32_32x32x16_bf16 v[0:15], v[40:43], v[132:135], v[0:15]
    s_add_u32 s38, s36, s37
    buffer_load_dwordx4 v[128:131], v253, s[20:23], s38 offen offset:0 sc1
    ds_read_b64_tr_b16 v[32:33], v58 offset:8192
    ds_read_b64_tr_b16 v[34:35], v58 offset:8704
    v_mfma_f32_32x32x16_bf16 v[16:31], v[44:47], v[132:135], v[16:31]
    ds_read_b64_tr_b16 v[36:37], v59 offset:8192
    ds_read_b64_tr_b16 v[38:39], v59 offset:8704
    s_waitcnt vmcnt(7) lgkmcnt(4)
    v_mfma_f32_32x32x16_bf16 v[0:15], v[48:51], v[136:139], v[0:15]
    s_add_u32 s37, s37, 2048
    s_and_b32 s37, s37, 0x7800
    buffer_load_dwordx4 v[132:135], v253, s[20:23], s38 offen offset:1024 sc1
    ds_read_b64_tr_b16 v[40:41], v58 offset:10240
    ds_read_b64_tr_b16 v[42:43], v58 offset:10752
    v_mfma_f32_32x32x16_bf16 v[16:31], v[52:55], v[136:139], v[16:31]
    ds_read_b64_tr_b16 v[44:45], v59 offset:10240
    ds_read_b64_tr_b16 v[46:47], v59 offset:10752
    s_waitcnt vmcnt(7) lgkmcnt(4)
    v_mfma_f32_32x32x16_bf16 v[0:15], v[32:35], v[104:107], v[0:15]
    s_add_u32 s38, s36, s37
    buffer_load_dwordx4 v[136:139], v253, s[20:23], s38 offen offset:0 sc1
    ds_read_b64_tr_b16 v[48:49], v58 offset:12288
    ds_read_b64_tr_b16 v[50:51], v58 offset:12800
    v_mfma_f32_32x32x16_bf16 v[16:31], v[36:39], v[104:107], v[16:31]
    ds_read_b64_tr_b16 v[52:53], v59 offset:12288
    ds_read_b64_tr_b16 v[54:55], v59 offset:12800
    s_waitcnt vmcnt(7) lgkmcnt(4)
    v_mfma_f32_32x32x16_bf16 v[0:15], v[40:43], v[108:111], v[0:15]
    s_add_u32 s37, s37, 2048
    s_and_b32 s37, s37, 0x7800
    buffer_load_dwordx4 v[104:107], v253, s[20:23], s38 offen offset:1024 sc1
    ds_read_b64_tr_b16 v[32:33], v58 offset:14336
    ds_read_b64_tr_b16 v[34:35], v58 offset:14848
    v_mfma_f32_32x32x16_bf16 v[16:31], v[44:47], v[108:111], v[16:31]
    ds_read_b64_tr_b16 v[36:37], v59 offset:14336
    ds_read_b64_tr_b16 v[38:39], v59 offset:14848
    s_waitcnt vmcnt(7) lgkmcnt(4)
    v_mfma_f32_32x32x16_bf16 v[0:15], v[48:51], v[112:115], v[0:15]
    s_add_u32 s38, s36, s37
    buffer_load_dwordx4 v[108:111], v253, s[20:23], s38 offen offset:0 sc1
    ds_read_b64_tr_b16 v[40:41], v58 offset:16384
    ds_read_b64_tr_b16 v[42:43], v58 offset:16896
    v_mfma_f32_32x32x16_bf16 v[16:31], v[52:55], v[112:115], v[16:31]
    ds_read_b64_tr_b16 v[44:45], v59 offset:16384
    ds_read_b64_tr_b16 v[46:47], v59 offset:16896
    s_waitcnt vmcnt(7) lgkmcnt(4)
    v_mfma_f32_32x32x16_bf16 v[0:15], v[32:35], v[116:119], v[0:15]
    s_add_u32 s37, s37, 2048
    s_and_b32 s37, s37, 0x7800
    buffer_load_dwordx4 v[112:115], v253, s[20:23], s38 offen offset:1024 sc1
    ds_read_b64_tr_b16 v[48:49], v58 offset:18432
    ds_read_b64_tr_b16 v[50:51], v58 offset:18944
    v_mfma_f32_32x32x16_bf16 v[16:31], v[36:39], v[116:119], v[16:31]
    ds_read_b64_tr_b16 v[52:53], v59 offset:18432
    ds_read_b64_tr_b16 v[54:55], v59 offset:18944
    s_waitcnt vmcnt(7) lgkmcnt(4)
    v_mfma_f32_32x32x16_bf16 v[0:15], v[40:43], v[120:123], v[0:15]
    s_add_u32 s38, s36, s37
    buffer_load_dwordx4 v[116:119], v253, s[20:23], s38 offen offset:0 sc1
    ds_read_b64_tr_b16 v[32:33], v58 offset:20480
    ds_read_b64_tr_b16 v[34:35], v58 offset:20992
    v_mfma_f32_32x32x16_bf16 v[16:31], v[44:47], v[120:123], v[16:31]
    ds_read_b64_tr_b16 v[36:37], v59 offset:20480
    ds_read_b64_tr_b16 v[38:39], v59 offset:20992
    s_waitcnt vmcnt(7) lgkmcnt(4)
    v_mfma_f32_32x32x16_bf16 v[0:15], v[48:51], v[124:127], v[0:15]
    s_add_u32 s37, s37, 2048
    s_and_b32 s37, s37, 0x7800
    buffer_load_dwordx4 v[120:123], v253, s[20:23], s38 offen offset:1024 sc1
    ds_read_b64_tr_b16 v[40:41], v58 offset:22528
    ds_read_b64_tr_b16 v[42:43], v58 offset:23040
    v_mfma_f32_32x32x16_bf16 v[16:31], v[52:55], v[124:127], v[16:31]
    ds_read_b64_tr_b16 v[44:45], v59 offset:22528
    ds_read_b64_tr_b16 v[46:47], v59 offset:23040
    s_waitcnt vmcnt(7) lgkmcnt(4)
    v_mfma_f32_32x32x16_bf16 v[0:15], v[32:35], v[128:131], v[0:15]
    s_add_u32 s38, s36, s37
    buffer_load_dwordx4 v[124:127], v253, s[20:23], s38 offen offset:0 sc1
    ds_read_b64_tr_b16 v[48:49], v58 offset:24576
    ds_read_b64_tr_b16 v[50:51], v58 offset:25088
    v_mfma_f32_32x32x16_bf16 v[16:31], v[36:39], v[128:131], v[16:31]
    ds_read_b64_tr_b16 v[52:53], v59 offset:24576
    ds_read_b64_tr_b16 v[54:55], v59 offset:25088
    s_waitcnt vmcnt(7) lgkmcnt(4)
    v_mfma_f32_32x32x16_bf16 v[0:15], v[40:43], v[132:135], v[0:15]
    s_add_u32 s37, s37, 2048
    s_and_b32 s37, s37, 0x7800
    buffer_load_dwordx4 v[128:131], v253, s[20:23], s38 offen offset:1024 sc1
    ds_read_b64_tr_b16 v[32:33], v58 offset:26624
    ds_read_b64_tr_b16 v[34:35], v58 offset:27136
    v_mfma_f32_32x32x16_bf16 v[16:31], v[44:47], v[132:135], v[16:31]
    ds_read_b64_tr_b16 v[36:37], v59 offset:26624
    ds_read_b64_tr_b16 v[38:39], v59 offset:27136
    s_waitcnt vmcnt(7) lgkmcnt(4)
    v_mfma_f32_32x32x16_bf16 v[0:15], v[48:51], v[136:139], v[0:15]
    s_add_u32 s38, s36, s37
    buffer_load_dwordx4 v[132:135], v253, s[20:23], s38 offen offset:0 sc1
    ds_read_b64_tr_b16 v[40:41], v58 offset:28672
    ds_read_b64_tr_b16 v[42:43], v58 offset:29184
    v_mfma_f32_32x32x16_bf16 v[16:31], v[52:55], v[136:139], v[16:31]
    ds_read_b64_tr_b16 v[44:45], v59 offset:28672
    ds_read_b64_tr_b16 v[46:47], v59 offset:29184
    s_waitcnt vmcnt(7) lgkmcnt(4)
    v_mfma_f32_32x32x16_bf16 v[0:15], v[32:35], v[104:107], v[0:15]
    s_add_u32 s37, s37, 2048
    s_and_b32 s37, s37, 0x7800
    buffer_load_dwordx4 v[136:139], v253, s[20:23], s38 offen offset:1024 sc1
    ds_read_b64_tr_b16 v[48:49], v58 offset:30720
    ds_read_b64_tr_b16 v[50:51], v58 offset:31232
    v_mfma_f32_32x32x16_bf16 v[16:31], v[36:39], v[104:107], v[16:31]
    ds_read_b64_tr_b16 v[52:53], v59 offset:30720
    ds_read_b64_tr_b16 v[54:55], v59 offset:31232
    s_waitcnt vmcnt(7) lgkmcnt(4)
    v_mfma_f32_32x32x16_bf16 v[0:15], v[40:43], v[108:111], v[0:15]
    s_add_u32 s38, s36, s37
    buffer_load_dwordx4 v[104:107], v253, s[20:23], s38 offen offset:0 sc1
    ds_read_b64_tr_b16 v[32:33], v58 offset:32768
    ds_read_b64_tr_b16 v[34:35], v58 offset:33280
    v_mfma_f32_32x32x16_bf16 v[16:31], v[44:47], v[108:111], v[16:31]
    ds_read_b64_tr_b16 v[36:37], v59 offset:32768
    ds_read_b64_tr_b16 v[38:39], v59 offset:33280
    s_waitcnt vmcnt(7) lgkmcnt(4)
    v_mfma_f32_32x32x16_bf16 v[0:15], v[48:51], v[112:115], v[0:15]
    s_add_u32 s37, s37, 2048
    s_and_b32 s37, s37, 0x7800
    buffer_load_dwordx4 v[108:111], v253, s[20:23], s38 offen offset:1024 sc1
    ds_read_b64_tr_b16 v[40:41], v58 offset:34816
    ds_read_b64_tr_b16 v[42:43], v58 offset:35328
    v_mfma_f32_32x32x16_bf16 v[16:31], v[52:55], v[112:115], v[16:31]
    ds_read_b64_tr_b16 v[44:45], v59 offset:34816
    ds_read_b64_tr_b16 v[46:47], v59 offset:35328
    s_waitcnt vmcnt(7) lgkmcnt(4)
    v_mfma_f32_32x32x16_bf16 v[0:15], v[32:35], v[116:119], v[0:15]
    s_add_u32 s38, s36, s37
    buffer_load_dwordx4 v[112:115], v253, s[20:23], s38 offen offset:0 sc1
    ds_read_b64_tr_b16 v[48:49], v58 offset:36864
    ds_read_b64_tr_b16 v[50:51], v58 offset:37376
    v_mfma_f32_32x32x16_bf16 v[16:31], v[36:39], v[116:119], v[16:31]
    ds_read_b64_tr_b16 v[52:53], v59 offset:36864
    ds_read_b64_tr_b16 v[54:55], v59 offset:37376
    s_waitcnt vmcnt(7) lgkmcnt(4)
    v_mfma_f32_32x32x16_bf16 v[0:15], v[40:43], v[120:123], v[0:15]
    s_add_u32 s37, s37, 2048
    s_and_b32 s37, s37, 0x7800
    buffer_load_dwordx4 v[116:119], v253, s[20:23], s38 offen offset:1024 sc1
    ds_read_b64_tr_b16 v[32:33], v58 offset:38912
    ds_read_b64_tr_b16 v[34:35], v58 offset:39424
    v_mfma_f32_32x32x16_bf16 v[16:31], v[44:47], v[120:123], v[16:31]
    ds_read_b64_tr_b16 v[36:37], v59 offset:38912
    ds_read_b64_tr_b16 v[38:39], v59 offset:39424
    s_waitcnt vmcnt(7) lgkmcnt(4)
    v_mfma_f32_32x32x16_bf16 v[0:15], v[48:51], v[124:127], v[0:15]
    s_add_u32 s38, s36, s37
    buffer_load_dwordx4 v[120:123], v253, s[20:23], s38 offen offset:0 sc1
    ds_read_b64_tr_b16 v[40:41], v58 offset:40960
    ds_read_b64_tr_b16 v[42:43], v58 offset:41472
    v_mfma_f32_32x32x16_bf16 v[16:31], v[52:55], v[124:127], v[16:31]
    ds_read_b64_tr_b16 v[44:45], v59 offset:40960
    ds_read_b64_tr_b16 v[46:47], v59 offset:41472
    s_waitcnt vmcnt(7) lgkmcnt(4)
    v_mfma_f32_32x32x16_bf16 v[0:15], v[32:35], v[128:131], v[0:15]
    s_add_u32 s37, s37, 2048
    s_and_b32 s37, s37, 0x7800
    buffer_load_dwordx4 v[124:127], v253, s[20:23], s38 offen offset:1024 sc1
    ds_read_b64_tr_b16 v[48:49], v58 offset:43008
    ds_read_b64_tr_b16 v[50:51], v58 offset:43520
    v_mfma_f32_32x32x16_bf16 v[16:31], v[36:39], v[128:131], v[16:31]
    ds_read_b64_tr_b16 v[52:53], v59 offset:43008
    ds_read_b64_tr_b16 v[54:55], v59 offset:43520
    s_waitcnt vmcnt(7) lgkmcnt(4)
    v_mfma_f32_32x32x16_bf16 v[0:15], v[40:43], v[132:135], v[0:15]
    s_add_u32 s38, s36, s37
    buffer_load_dwordx4 v[128:131], v253, s[20:23], s38 offen offset:0 sc1
    ds_read_b64_tr_b16 v[32:33], v58 offset:45056
    ds_read_b64_tr_b16 v[34:35], v58 offset:45568
    v_mfma_f32_32x32x16_bf16 v[16:31], v[44:47], v[132:135], v[16:31]
    ds_read_b64_tr_b16 v[36:37], v59 offset:45056
    ds_read_b64_tr_b16 v[38:39], v59 offset:45568
    s_waitcnt vmcnt(7) lgkmcnt(4)
    v_mfma_f32_32x32x16_bf16 v[0:15], v[48:51], v[136:139], v[0:15]
    s_add_u32 s37, s37, 2048
    s_and_b32 s37, s37, 0x7800
    buffer_load_dwordx4 v[132:135], v253, s[20:23], s38 offen offset:1024 sc1
    ds_read_b64_tr_b16 v[40:41], v58 offset:47104
    ds_read_b64_tr_b16 v[42:43], v58 offset:47616
    v_mfma_f32_32x32x16_bf16 v[16:31], v[52:55], v[136:139], v[16:31]
    ds_read_b64_tr_b16 v[44:45], v59 offset:47104
    ds_read_b64_tr_b16 v[46:47], v59 offset:47616
    s_barrier
    s_waitcnt vmcnt(7) lgkmcnt(4)
    v_mfma_f32_32x32x16_bf16 v[0:15], v[32:35], v[104:107], v[0:15]
    s_add_u32 s38, s36, s37
    buffer_load_dwordx4 v[136:139], v253, s[20:23], s38 offen offset:0 sc1
    ds_read_b64_tr_b16 v[48:49], v58 offset:49152
    ds_read_b64_tr_b16 v[50:51], v58 offset:49664
    v_mfma_f32_32x32x16_bf16 v[16:31], v[36:39], v[104:107], v[16:31]
    ds_read_b64_tr_b16 v[52:53], v59 offset:49152
    ds_read_b64_tr_b16 v[54:55], v59 offset:49664
    s_waitcnt vmcnt(7) lgkmcnt(4)
    v_mfma_f32_32x32x16_bf16 v[0:15], v[40:43], v[108:111], v[0:15]
    s_add_u32 s37, s37, 2048
    s_and_b32 s37, s37, 0x7800
    buffer_load_dwordx4 v[104:107], v253, s[20:23], s38 offen offset:1024 sc1
    ds_read_b64_tr_b16 v[32:33], v58 offset:51200
    ds_read_b64_tr_b16 v[34:35], v58 offset:51712
    v_mfma_f32_32x32x16_bf16 v[16:31], v[44:47], v[108:111], v[16:31]
    ds_read_b64_tr_b16 v[36:37], v59 offset:51200
    ds_read_b64_tr_b16 v[38:39], v59 offset:51712
    s_waitcnt vmcnt(7) lgkmcnt(4)
    v_mfma_f32_32x32x16_bf16 v[0:15], v[48:51], v[112:115], v[0:15]
    ds_read_b64_tr_b16 v[40:41], v58 offset:53248
    ds_read_b64_tr_b16 v[42:43], v58 offset:53760
    v_mfma_f32_32x32x16_bf16 v[16:31], v[52:55], v[112:115], v[16:31]
    ds_read_b64_tr_b16 v[44:45], v59 offset:53248
    ds_read_b64_tr_b16 v[46:47], v59 offset:53760
    s_waitcnt vmcnt(6) lgkmcnt(4)
    v_mfma_f32_32x32x16_bf16 v[0:15], v[32:35], v[116:119], v[0:15]
    ds_read_b64_tr_b16 v[48:49], v58 offset:55296
    ds_read_b64_tr_b16 v[50:51], v58 offset:55808
    v_mfma_f32_32x32x16_bf16 v[16:31], v[36:39], v[116:119], v[16:31]
    ds_read_b64_tr_b16 v[52:53], v59 offset:55296
    ds_read_b64_tr_b16 v[54:55], v59 offset:55808
    s_waitcnt vmcnt(5) lgkmcnt(4)
    v_mfma_f32_32x32x16_bf16 v[0:15], v[40:43], v[120:123], v[0:15]
    ds_read_b64_tr_b16 v[32:33], v58 offset:57344
    ds_read_b64_tr_b16 v[34:35], v58 offset:57856
    v_mfma_f32_32x32x16_bf16 v[16:31], v[44:47], v[120:123], v[16:31]
    ds_read_b64_tr_b16 v[36:37], v59 offset:57344
    ds_read_b64_tr_b16 v[38:39], v59 offset:57856
    s_waitcnt vmcnt(4) lgkmcnt(4)
    v_mfma_f32_32x32x16_bf16 v[0:15], v[48:51], v[124:127], v[0:15]
    ds_read_b64_tr_b16 v[40:41], v58 offset:59392
    ds_read_b64_tr_b16 v[42:43], v58 offset:59904
    v_mfma_f32_32x32x16_bf16 v[16:31], v[52:55], v[124:127], v[16:31]
    ds_read_b64_tr_b16 v[44:45], v59 offset:59392
    ds_read_b64_tr_b16 v[46:47], v59 offset:59904
    s_waitcnt vmcnt(3) lgkmcnt(4)
    v_mfma_f32_32x32x16_bf16 v[0:15], v[32:35], v[128:131], v[0:15]
    ds_read_b64_tr_b16 v[48:49], v58 offset:61440
    ds_read_b64_tr_b16 v[50:51], v58 offset:61952
    v_mfma_f32_32x32x16_bf16 v[16:31], v[36:39], v[128:131], v[16:31]
    ds_read_b64_tr_b16 v[52:53], v59 offset:61440
    ds_read_b64_tr_b16 v[54:55], v59 offset:61952
    s_waitcnt vmcnt(2) lgkmcnt(4)
    v_mfma_f32_32x32x16_bf16 v[0:15], v[40:43], v[132:135], v[0:15]
    ds_read_b64_tr_b16 v[32:33], v58 offset:63488
    ds_read_b64_tr_b16 v[34:35], v58 offset:64000
    v_mfma_f32_32x32x16_bf16 v[16:31], v[44:47], v[132:135], v[16:31]
    ds_read_b64_tr_b16 v[36:37], v59 offset:63488
    ds_read_b64_tr_b16 v[38:39], v59 offset:64000
    s_waitcnt vmcnt(1) lgkmcnt(4)
    v_mfma_f32_32x32x16_bf16 v[0:15], v[48:51], v[136:139], v[0:15]
    v_mfma_f32_32x32x16_bf16 v[16:31], v[52:55], v[136:139], v[16:31]
    s_waitcnt vmcnt(0) lgkmcnt(0)
    v_mfma_f32_32x32x16_bf16 v[0:15], v[32:35], v[104:107], v[0:15]
    v_mfma_f32_32x32x16_bf16 v[16:31], v[36:39], v[104:107], v[16:31]
    s_lshl_b32 s35, s24, 4
    s_add_u32 s35, s35, s98
    s_lshl_b32 s35, s35, 14
    s_lshl_b32 s34, s3, 12
    s_add_u32 s35, s35, s34
    s_add_u32 s35, s35, 0x2000000
    s_lshl_b32 s30, s99, 13
    s_add_u32 s30, s30, s26
    s_add_u32 s30, s30, 0xc00000
    s_lshl_b32 s31, s98, 9
    s_add_u32 s31, s31, s30
    v_mov_b32 v96, 0
    v_mov_b32 v97, 0
    v_mov_b32 v98, 0
    v_mov_b32 v99, v242
    v_cvt_pk_bf16_f32 v208, v0, v1
    v_cvt_pk_bf16_f32 v209, v2, v3
    v_cvt_pk_bf16_f32 v210, v4, v5
    v_cvt_pk_bf16_f32 v211, v6, v7
    v_cvt_pk_bf16_f32 v212, v8, v9
    v_cvt_pk_bf16_f32 v213, v10, v11
    v_cvt_pk_bf16_f32 v214, v12, v13
    v_cvt_pk_bf16_f32 v215, v14, v15
    v_cvt_pk_bf16_f32 v216, v16, v17
    v_cvt_pk_bf16_f32 v217, v18, v19
    v_cvt_pk_bf16_f32 v218, v20, v21
    v_cvt_pk_bf16_f32 v219, v22, v23
    v_cvt_pk_bf16_f32 v220, v24, v25
    v_cvt_pk_bf16_f32 v221, v26, v27
    v_cvt_pk_bf16_f32 v222, v28, v29
    v_cvt_pk_bf16_f32 v223, v30, v31
    s_cmp_lg_u32 s26, 0
    s_cbranch_scc1 sk_35
    s_cmp_lg_u32 s77, 0
    s_cbranch_scc1 lc_36
    buffer_store_dwordx4 v[208:211], v100, s[20:23], s35 offen offset:0 sc1
    buffer_store_dwordx4 v[212:215], v100, s[20:23], s35 offen offset:512 sc1
    buffer_store_dwordx4 v[216:219], v100, s[20:23], s35 offen offset:1024 sc1
    buffer_store_dwordx4 v[220:223], v100, s[20:23], s35 offen offset:1536 sc1
    s_branch lc_37
    s_nop 0
lc_36:
    buffer_store_dwordx4 v[208:211], v100, s[20:23], s35 offen offset:0
    buffer_store_dwordx4 v[212:215], v100, s[20:23], s35 offen offset:512
    buffer_store_dwordx4 v[216:219], v100, s[20:23], s35 offen offset:1024
    buffer_store_dwordx4 v[220:223], v100, s[20:23], s35 offen offset:1536
lc_37:
    ds_write_b128 v101, v[208:211] offset:0
    ds_write_b128 v101, v[212:215] offset:512
    ds_write_b128 v101, v[216:219] offset:1024
    ds_write_b128 v101, v[220:223] offset:1536
sk_35:
    v_dot2c_f32_bf16 v96, 0x3f803f80, v208
    v_dot2c_f32_bf16 v97, v208, v208
    v_dot2c_f32_bf16 v98, v224, v208
    v_dot2c_f32_bf16 v96, 0x3f803f80, v209
    v_dot2c_f32_bf16 v97, v209, v209
    v_dot2c_f32_bf16 v98, v225, v209
    v_dot2c_f32_bf16 v96, 0x3f803f80, v210
    v_dot2c_f32_bf16 v97, v210, v210
    v_dot2c_f32_bf16 v98, v226, v210
    v_dot2c_f32_bf16 v96, 0x3f803f80, v211
    v_dot2c_f32_bf16 v97, v211, v211
    v_dot2c_f32_bf16 v98, v227, v211
    v_dot2c_f32_bf16 v96, 0x3f803f80, v212
    v_dot2c_f32_bf16 v97, v212, v212
    v_dot2c_f32_bf16 v98, v228, v212
    v_dot2c_f32_bf16 v96, 0x3f803f80, v213
    v_dot2c_f32_bf16 v97, v213, v213
    v_dot2c_f32_bf16 v98, v229, v213
    v_dot2c_f32_bf16 v96, 0x3f803f80, v214
    v_dot2c_f32_bf16 v97, v214, v214
    v_dot2c_f32_bf16 v98, v230, v214
    v_dot2c_f32_bf16 v96, 0x3f803f80, v215
    v_dot2c_f32_bf16 v97, v215, v215
    v_dot2c_f32_bf16 v98, v231, v215
    v_dot2c_f32_bf16 v96, 0x3f803f80, v216
    v_dot2c_f32_bf16 v97, v216, v216
    v_dot2c_f32_bf16 v98, v232, v216
    v_dot2c_f32_bf16 v96, 0x3f803f80, v217
    v_dot2c_f32_bf16 v97, v217, v217
    v_dot2c_f32_bf16 v98, v233, v217
    v_dot2c_f32_bf16 v96, 0x3f803f80, v218
    v_dot2c_f32_bf16 v97, v218, v218
    v_dot2c_f32_bf16 v98, v234, v218
    v_dot2c_f32_bf16 v96, 0x3f803f80, v219
    v_dot2c_f32_bf16 v97, v219, v219
    v_dot2c_f32_bf16 v98, v235, v219
    v_dot2c_f32_bf16 v96, 0x3f803f80, v220
    v_dot2c_f32_bf16 v97, v220, v220
    v_dot2c_f32_bf16 v98, v236, v220
    v_dot2c_f32_bf16 v96, 0x3f803f80, v221
    v_dot2c_f32_bf16 v97, v221, v221
    v_dot2c_f32_bf16 v98, v237, v221
    v_dot2c_f32_bf16 v96, 0x3f803f80, v222
    v_dot2c_f32_bf16 v97, v222, v222
    v_dot2c_f32_bf16 v98, v238, v222
    v_dot2c_f32_bf16 v96, 0x3f803f80, v223
    v_dot2c_f32_bf16 v97, v223, v223
    v_dot2c_f32_bf16 v98, v239, v223
    s_nop 0
    v_mov_b32 v48, v96
    v_mov_b32 v49, v97
    v_mov_b32 v50, v98
    v_mov_b32 v51, v99
    v_permlane32_swap_b32 v96, v48
    v_permlane32_swap_b32 v97, v49
    v_permlane32_swap_b32 v98, v50
    v_permlane32_swap_b32 v99, v51
    v_add_f32 v96, v96, v48
    v_add_f32 v97, v97, v49
    v_add_f32 v98, v98, v50
    v_add_f32_e64 v99, v99, v51
    s_mov_b32 exec_hi, 0
    s_waitcnt vmcnt(0)
    s_cmp_lg_u32 s77, 0
    s_cbranch_scc1 lc_38
    buffer_store_dwordx4 v[96:99], v253, s[20:23], s31 offen sc1
    s_branch lc_39
    s_nop 0
lc_38:
    buffer_store_dwordx4 v[96:99], v253, s[20:23], s31 offen
lc_39:
    s_mov_b64 exec, -1
    s_cmp_lg_u32 s26, 0
    s_cbranch_scc1 e_final
    s_mov_b32 s26, 16777216
    s_and_b32 s30, s3, 1
    s_lshl_b32 s30, s30, 13
    v_add_u32 v176, s30, v253
    v_add_u32 v177, 1024, v176
    s_lshr_b32 s30, s16, 7
    s_sub_u32 s30, 3, s30
    s_and_b32 s30, s30, 7
    s_and_b32 s31, s24, 1
    s_lshl_b32 s31, s31, 3
    s_add_u32 s30, s30, s31
    s_and_b32 s31, s24, 14
    s_add_u32 s84, s31, s30
    s_lshl_b32 s31, s25, 2
    s_add_u32 s31, s31, s28
    s_mul_i32 s31, s31, 6144
    s_lshl_b32 s30, s30, 7
    s_add_u32 s30, s30, s31
    v_min_u32_e64 v190, 2, v252
    v_lshl_add_u32 v190, v190, 11, s30
    s_add_u32 s84, s84, 14
    v_mov_b32 v0, 0
    v_mov_b32 v1, 0
    v_mov_b32 v2, 0
    v_mov_b32 v3, 0
    v_mov_b32 v4, 0
    v_mov_b32 v5, 0
    v_mov_b32 v6, 0
    v_mov_b32 v7, 0
    v_mov_b32 v8, 0
    v_mov_b32 v9, 0
    v_mov_b32 v10, 0
    v_mov_b32 v11, 0
    v_mov_b32 v12, 0
    v_mov_b32 v13, 0
    v_mov_b32 v14, 0
    v_mov_b32 v15, 0
    v_mov_b32 v16, 0
    v_mov_b32 v17, 0
    v_mov_b32 v18, 0
    v_mov_b32 v19, 0
    v_mov_b32 v20, 0
    v_mov_b32 v21, 0
    v_mov_b32 v22, 0
    v_mov_b32 v23, 0
    v_mov_b32 v24, 0
    v_mov_b32 v25, 0
    v_mov_b32 v26, 0
    v_mov_b32 v27, 0
    v_mov_b32 v28, 0
    v_mov_b32 v29, 0
    v_mov_b32 v30, 0
    v_mov_b32 v31, 0
    v_mov_b32 v32, 0
    v_mov_b32 v33, 0
    v_mov_b32 v34, 0
    v_mov_b32 v35, 0
    v_mov_b32 v36, 0
    v_mov_b32 v37, 0
    v_mov_b32 v38, 0
    v_mov_b32 v39, 0
    v_mov_b32 v40, 0
    v_mov_b32 v41, 0
    v_mov_b32 v42, 0
    v_mov_b32 v43, 0
    v_mov_b32 v44, 0
    v_mov_b32 v45, 0
    v_mov_b32 v46, 0
    v_mov_b32 v47, 0
    v_mov_b32 v48, 0
    v_mov_b32 v49, 0
    v_mov_b32 v50, 0
    v_mov_b32 v51, 0
    v_mov_b32 v52, 0
    v_mov_b32 v53, 0
    v_mov_b32 v54, 0
    v_mov_b32 v55, 0
    v_mov_b32 v56, 0
    v_mov_b32 v57, 0
    v_mov_b32 v58, 0
    v_mov_b32 v59, 0
    v_mov_b32 v60, 0
    v_mov_b32 v61, 0
    v_mov_b32 v62, 0
    v_mov_b32 v63, 0
    v_mov_b32 v64, 0
    v_mov_b32 v65, 0
    v_mov_b32 v66, 0
    v_mov_b32 v67, 0
    v_mov_b32 v68, 0
    v_mov_b32 v69, 0
    v_mov_b32 v70, 0
    v_mov_b32 v71, 0
    v_mov_b32 v72, 0
    v_mov_b32 v73, 0
    v_mov_b32 v74, 0
    v_mov_b32 v75, 0
    v_mov_b32 v76, 0
    v_mov_b32 v77, 0
    v_mov_b32 v78, 0
    v_mov_b32 v79, 0
    v_mov_b32 v80, 0
    v_mov_b32 v81, 0
    v_mov_b32 v82, 0
    v_mov_b32 v83, 0
    v_mov_b32 v84, 0
    v_mov_b32 v85, 0
    v_mov_b32 v86, 0
    v_mov_b32 v87, 0
    v_mov_b32 v88, 0
    v_mov_b32 v89, 0
    v_mov_b32 v90, 0
    v_mov_b32 v91, 0
    v_mov_b32 v92, 0
    v_mov_b32 v93, 0
    v_mov_b32 v94, 0
    v_mov_b32 v95, 0
    s_waitcnt lgkmcnt(0)
    s_branch e_q
    s_nop 0
e_fpf:
    s_bitset0_b32 s86, s36
    s_bfm_b64 exec, 56, 0
    global_load_dword v191, v[196:197], off
    v_add_co_u32 v196, vcc, v196, v198
    s_nop 1
    v_addc_co_u32 v197, vcc, 0, v197, vcc
    s_mov_b64 exec, -1
    s_branch e_fpf_ret
e_arr:
    s_mov_b64 exec, 3
    s_mov_b32 s89, 0xdd9000
    buffer_store_dwordx2 v[250:251], v249, s[20:23], s89 offen sc1
    s_mov_b64 exec, -1
    s_branch e_arr_ret
e_final:
    s_mov_b32 s78, s27
pl_40:
    s_lshl_b32 s30, s99, 13
    s_add_u32 s30, s30, 0x1c00000
    s_add_u32 s31, s30, 4096
    buffer_load_dwordx4 v[64:67], v253, s[20:23], s30 offen offset:0 sc1
    buffer_load_dwordx4 v[68:71], v253, s[20:23], s30 offen offset:1024 sc1
    buffer_load_dwordx4 v[72:75], v253, s[20:23], s30 offen offset:2048 sc1
    buffer_load_dwordx4 v[76:79], v253, s[20:23], s30 offen offset:3072 sc1
    buffer_load_dwordx4 v[80:83], v253, s[20:23], s31 offen offset:0 sc1
    buffer_load_dwordx4 v[84:87], v253, s[20:23], s31 offen offset:1024 sc1
    buffer_load_dwordx4 v[88:91], v253, s[20:23], s31 offen offset:2048 sc1
    buffer_load_dwordx4 v[92:95], v253, s[20:23], s31 offen offset:3072 sc1
    s_waitcnt vmcnt(0)
pc_41:
    v_max3_u32 v48, v64, v68, v72
    v_max3_u32 v48, v48, v76, v80
    v_max3_u32 v48, v48, v84, v88
    v_max_u32 v48, v48, v92
    v_cmp_eq_u32 vcc, -1, v48
    s_cbranch_vccz pd_42
    s_sub_u32 s78, s78, 1
    s_cmp_lg_u32 s78, 0
    s_cbranch_scc1 pl_40
    s_mov_b32 s27, 1
pd_42:
    v_pk_add_f32 v[64:65], v[64:65], v[68:69]
    v_pk_add_f32 v[66:67], v[66:67], v[70:71]
    v_pk_add_f32 v[64:65], v[64:65], v[72:73]
    v_pk_add_f32 v[66:67], v[66:67], v[74:75]
    v_pk_add_f32 v[64:65], v[64:65], v[76:77]
    v_pk_add_f32 v[66:67], v[66:67], v[78:79]
    v_pk_add_f32 v[64:65], v[64:65], v[80:81]
    v_pk_add_f32 v[66:67], v[66:67], v[82:83]
    v_pk_add_f32 v[64:65], v[64:65], v[84:85]
    v_pk_add_f32 v[66:67], v[66:67], v[86:87]
    v_pk_add_f32 v[64:65], v[64:65], v[88:89]
    v_pk_add_f32 v[66:67], v[66:67], v[90:91]
    v_pk_add_f32 v[64:65], v[64:65], v[92:93]
    v_pk_add_f32 v[66:67], v[66:67], v[94:95]
    v_mov_b32 v48, v64
    v_mov_b32 v49, v65
    v_mov_b32 v50, v66
    v_mov_b32 v51, v67
    v_permlane32_swap_b32 v64, v48
    v_permlane32_swap_b32 v65, v49
    v_permlane32_swap_b32 v66, v50
    v_permlane32_swap_b32 v67, v51
    v_add_f32 v64, v64, v48
    v_add_f32 v65, v65, v49
    v_add_f32 v66, v66, v50
    v_add_f32 v67, v67, v51
    v_mul_f32 v54, 0x3a800000, v64
    v_mul_f32 v65, 0x3a800000, v65
    v_fma_f32 v65, -v54, v54, v65
    v_max_f32_e64 v65, 0, v65
    v_add_f32 v55, 0x3727c5ac, v65
    v_rsq_f32_e64 v55, v55
    v_fma_f32 v52, -v54, v67, v66
    v_and_b32 v53, 31, v252
    v_mul_f32 v52, v52, v55
    s_lshl_b32 s32, s99, 5
    v_add_u32 v53, s32, v53
    v_mov_b32 v48, v52
    s_nop 1
    v_max_f32_dpp v48, v48, v48 quad_perm:[1,0,3,2] row_mask:0xf bank_mask:0xf
    s_nop 1
    v_max_f32_dpp v48, v48, v48 quad_perm:[2,3,0,1] row_mask:0xf bank_mask:0xf
    s_nop 1
    v_max_f32_dpp v48, v48, v48 row_half_mirror row_mask:0xf bank_mask:0xf
    s_nop 1
    v_max_f32_dpp v48, v48, v48 row_mirror row_mask:0xf bank_mask:0xf
    v_mov_b32 v49, v48
    s_nop 1
    v_permlane16_swap_b32 v48, v49
    v_max_f32 v48, v48, v49
    v_cmp_eq_f32 vcc, v48, v52
    v_lshrrev_b32 v50, 5, v252
    v_lshlrev_b32 v50, 4, v50
    s_lshr_b32 s34, s25, 3
    v_lshl_add_u32 v51, s34, 28, v50
    s_lshl_b32 s32, s99, 11
    s_lshl_b32 s33, s98, 7
    s_add_u32 s32, s32, s33
    s_add_u32 s32, s32, 0x1d60000
    s_and_b32 s34, s25, 7
    s_lshl_b32 s34, s34, 6
    s_add_u32 s34, s34, s99
    s_mul_i32 s34, s34, 32
    s_add_u32 s34, s34, 0x1dc0000
    s_ff1_i32_b32 s35, vcc_lo
    s_lshl_b32 s35, 1, s35
    s_mov_b32 exec_lo, s35
    s_mov_b32 exec_hi, s35
    buffer_store_dwordx4 v[52:55], v51, s[20:23], s34 offen sc1
    buffer_store_dwordx4 v[208:211], v50, s[20:23], s32 offen offset:0 sc1
    buffer_store_dwordx4 v[212:215], v50, s[20:23], s32 offen offset:32 sc1
    buffer_store_dwordx4 v[216:219], v50, s[20:23], s32 offen offset:64 sc1
    buffer_store_dwordx4 v[220:223], v50, s[20:23], s32 offen offset:96 sc1
    s_mov_b64 exec, -1
    s_mov_b32 s38, s35
    s_mov_b32 s39, s35
    v_add_f32 v240, 1.0, v55
    v_mul_f32 v241, v54, v55
    v_sub_f32 v241, 0, v241
    v_pk_fma_f32 v[0:1], v[0:1], v[240:241], v[240:241] op_sel:[0,0,1] op_sel_hi:[1,0,1]
    v_pk_fma_f32 v[2:3], v[2:3], v[240:241], v[240:241] op_sel:[0,0,1] op_sel_hi:[1,0,1]
    v_pk_fma_f32 v[4:5], v[4:5], v[240:241], v[240:241] op_sel:[0,0,1] op_sel_hi:[1,0,1]
    v_pk_fma_f32 v[6:7], v[6:7], v[240:241], v[240:241] op_sel:[0,0,1] op_sel_hi:[1,0,1]
    v_pk_fma_f32 v[8:9], v[8:9], v[240:241], v[240:241] op_sel:[0,0,1] op_sel_hi:[1,0,1]
    v_pk_fma_f32 v[10:11], v[10:11], v[240:241], v[240:241] op_sel:[0,0,1] op_sel_hi:[1,0,1]
    v_pk_fma_f32 v[12:13], v[12:13], v[240:241], v[240:241] op_sel:[0,0,1] op_sel_hi:[1,0,1]
    v_pk_fma_f32 v[14:15], v[14:15], v[240:241], v[240:241] op_sel:[0,0,1] op_sel_hi:[1,0,1]
    v_pk_fma_f32 v[16:17], v[16:17], v[240:241], v[240:241] op_sel:[0,0,1] op_sel_hi:[1,0,1]
    v_pk_fma_f32 v[18:19], v[18:19], v[240:241], v[240:241] op_sel:[0,0,1] op_sel_hi:[1,0,1]
    v_pk_fma_f32 v[20:21], v[20:21], v[240:241], v[240:241] op_sel:[0,0,1] op_sel_hi:[1,0,1]
    v_pk_fma_f32 v[22:23], v[22:23], v[240:241], v[240:241] op_sel:[0,0,1] op_sel_hi:[1,0,1]
    v_pk_fma_f32 v[24:25], v[24:25], v[240:241], v[240:241] op_sel:[0,0,1] op_sel_hi:[1,0,1]
    v_pk_fma_f32 v[26:27], v[26:27], v[240:241], v[240:241] op_sel:[0,0,1] op_sel_hi:[1,0,1]
    v_pk_fma_f32 v[28:29], v[28:29], v[240:241], v[240:241] op_sel:[0,0,1] op_sel_hi:[1,0,1]
    v_pk_fma_f32 v[30:31], v[30:31], v[240:241], v[240:241] op_sel:[0,0,1] op_sel_hi:[1,0,1]
    v_cvt_pk_bf16_f32 v64, v0, v1
    v_cvt_pk_bf16_f32 v65, v2, v3
    v_cvt_pk_bf16_f32 v66, v4, v5
    v_cvt_pk_bf16_f32 v67, v6, v7
    v_cvt_pk_bf16_f32 v68, v8, v9
    v_cvt_pk_bf16_f32 v69, v10, v11
    v_cvt_pk_bf16_f32 v70, v12, v13
    v_cvt_pk_bf16_f32 v71, v14, v15
    v_cvt_pk_bf16_f32 v72, v16, v17
    v_cvt_pk_bf16_f32 v73, v18, v19
    v_cvt_pk_bf16_f32 v74, v20, v21
    v_cvt_pk_bf16_f32 v75, v22, v23
    v_cvt_pk_bf16_f32 v76, v24, v25
    v_cvt_pk_bf16_f32 v77, v26, v27
    v_cvt_pk_bf16_f32 v78, v28, v29
    v_cvt_pk_bf16_f32 v79, v30, v31
    v_permlane32_swap_b32 v64, v66
    v_permlane32_swap_b32 v65, v67
    v_permlane32_swap_b32 v68, v70
    v_permlane32_swap_b32 v69, v71
    v_permlane32_swap_b32 v72, v74
    v_permlane32_swap_b32 v73, v75
    v_permlane32_swap_b32 v76, v78
    v_permlane32_swap_b32 v77, v79
    v_lshl_add_u32 v50, v53, 11, v50
    s_mov_b32 s79, s26
    s_not_b64 exec, s[38:39]
    buffer_store_dwordx4 v[64:67], v50, s[12:15], s33 offen offset:0
    buffer_store_dwordx4 v[68:71], v50, s[12:15], s33 offen offset:32
    buffer_store_dwordx4 v[72:75], v50, s[12:15], s33 offen offset:64
    buffer_store_dwordx4 v[76:79], v50, s[12:15], s33 offen offset:96
    s_mov_b64 exec, -1
    s_cmp_lg_u32 s3, 0
    s_cbranch_scc1 sk_43
    s_mov_b32 s78, s27
pl_44:
    s_add_u32 s32, s79, 0xdc0000
    s_lshr_b32 vcc_lo, s24, 1
    s_mul_i32 vcc_lo, vcc_lo, 2048
    s_add_u32 s32, s32, vcc_lo
    v_lshlrev_b32 v4, 1, v253
    buffer_load_dwordx4 v[0:3], v4, s[20:23], s32 offen sc1
    s_waitcnt vmcnt(0)
pc_45:
    v_max3_u32 v4, v0, v1, v2
    v_max_u32 v4, v4, v3
    v_cmp_eq_u32 vcc, -1, v4
    s_cbranch_vccz pd_46
    s_sub_u32 s78, s78, 1
    s_cmp_lg_u32 s78, 0
    s_cbranch_scc1 pl_44
    s_mov_b32 s27, 1
pd_46:
    v_mov_b32 v4, v0
    s_nop 1
    v_max_f32_dpp v4, v4, v4 quad_perm:[1,0,3,2] row_mask:0xf bank_mask:0xf
    s_nop 1
    v_max_f32_dpp v4, v4, v4 quad_perm:[2,3,0,1] row_mask:0xf bank_mask:0xf
    s_nop 1
    v_max_f32_dpp v4, v4, v4 row_half_mirror row_mask:0xf bank_mask:0xf
    s_nop 1
    v_max_f32_dpp v4, v4, v4 row_mirror row_mask:0xf bank_mask:0xf
    v_mov_b32 v5, v4
    s_nop 1
    v_permlane16_swap_b32 v4, v5
    v_max_f32 v4, v4, v5
    v_mov_b32 v5, v4
    s_nop 1
    v_permlane32_swap_b32 v4, v5
    v_max_f32 v4, v4, v5
    v_cmp_eq_f32 vcc, v4, v0
    s_ff1_i32_b64 s32, vcc
    s_and_b32 s32, s32, 63
    s_lshl_b64 exec, 1, s32
    ds_write_b128 v189, v[0:3] offset:3072
    s_mov_b64 exec, -1
sk_43:
    s_waitcnt lgkmcnt(0)
    s_barrier
    ds_read_b32 v0, v189 offset:3076
    s_waitcnt lgkmcnt(0)
    v_and_b32 v0, 0x7ff, v0
    v_cmp_ne_u32_e64 vcc, v0, v53
    s_and_b64 exec, vcc, s[38:39]
    s_cbranch_execz k_end
    buffer_store_dwordx4 v[64:67], v50, s[12:15], s33 offen offset:0
    buffer_store_dwordx4 v[68:71], v50, s[12:15], s33 offen offset:32
    buffer_store_dwordx4 v[72:75], v50, s[12:15], s33 offen offset:64
    buffer_store_dwordx4 v[76:79], v50, s[12:15], s33 offen offset:96
    s_mov_b64 exec, -1
    s_branch k_end
    s_nop 0
l_start:
    v_lshrrev_b32 v21, 3, v252
    v_lshrrev_b32 v20, 4, v252
    v_xor_b32 v20, v20, v252
    v_and_b32 v20, 7, v20
    v_lshlrev_b32 v20, 4, v20
    v_lshl_add_u32 v4, v21, 11, v20
    v_xor_b32_e64 v5, 64, v4
    v_add_u32 v5, 15360, v5
    v_add_u32 v6, 30720, v4
    v_add_u32 v7, 30720, v5
    s_lshl_b32 s84, s99, 16
    s_lshl_b32 s85, s25, 7
    s_lshl_b32 s86, s28, 12
    s_mul_i32 s87, s28, 6144
    v_and_b32 v20, 4, v21
    v_add_u32_e64 v20, v20, v21
    v_mul_u32_u24 v20, 6144, v20
    v_and_b32 v21, 6, v21
    v_xor_b32 v21, v21, v252
    v_and_b32 v21, 7, v21
    v_lshl_add_u32 v20, v21, 4, v20
    s_mul_i32 s32, s28, 3
    s_bfe_u32 s33, s32, 0x10001
    s_mul_i32 s33, s33, 196608
    s_and_b32 s34, s32, 1
    s_mul_i32 s34, s34, 24576
    s_add_u32 s33, s33, s34
    s_lshr_b32 s34, s32, 2
    s_lshl_b32 s34, s34, 11
    s_add_u32 s33, s33, s34
    v_add_u32 v8, s33, v20
    v_add_u32 v9, 97280, v8
    s_add_u32 s32, s32, 1
    s_bfe_u32 s33, s32, 0x10001
    s_mul_i32 s33, s33, 196608
    s_and_b32 s34, s32, 1
    s_mul_i32 s34, s34, 24576
    s_add_u32 s33, s33, s34
    s_lshr_b32 s34, s32, 2
    s_lshl_b32 s34, s34, 11
    s_add_u32 s33, s33, s34
    s_sub_u32 s33, s33, 2048
    v_add_u32 v10, s33, v20
    v_add_u32 v11, 97280, v10
    s_add_u32 s32, s32, 1
    s_bfe_u32 s33, s32, 0x10001
    s_mul_i32 s33, s33, 196608
    s_and_b32 s34, s32, 1
    s_mul_i32 s34, s34, 24576
    s_add_u32 s33, s33, s34
    s_lshr_b32 s34, s32, 2
    s_lshl_b32 s34, s34, 11
    s_add_u32 s33, s33, s34
    v_add_u32 v12, s33, v20
    v_add_u32 v13, 97280, v12
    s_waitcnt lgkmcnt(0)
    s_mov_b32 s88, 0xdd8000
    s_load_dword s88, s[20:21], s88
    s_mov_b64 s[16:17], s[6:7]
    s_mov_b32 s6, 0x400000
    s_mov_b32 s7, 0x20000
    s_add_u32 s96, s94, 0
    s_and_b32 s96, s96, 15
    s_lshl_b32 s97, s96, 7
    s_add_u32 s97, s97, s84
    s_add_u32 m0, s86, 147456
    s_nop 0
    buffer_load_dwordx4 v4, s[4:7], s97 offen offset:0 lds
    buffer_load_dwordx4 v5, s[4:7], s97 offen offset:1024 lds
    buffer_load_dwordx4 v6, s[4:7], s97 offen offset:2048 lds
    buffer_load_dwordx4 v7, s[4:7], s97 offen offset:3072 lds
    s_add_u32 s96, s94, 0
    s_and_b32 s96, s96, 15
    s_mul_i32 s96, s96, 393216
    s_add_u32 s96, s96, s85
    s_add_u32 m0, s87, 40960
    s_nop 0
    buffer_load_dwordx4 v8, s[16:19], s96 offen offset:0 lds
    buffer_load_dwordx4 v9, s[16:19], s96 offen offset:1024 lds
    buffer_load_dwordx4 v10, s[16:19], s96 offen offset:2048 lds
    buffer_load_dwordx4 v11, s[16:19], s96 offen offset:3072 lds
    s_mov_b32 s40, 0xffffffff
    s_mov_b32 s41, 0xfffffff0
    s_mov_b32 s42, 0xfffffffe
    s_mov_b32 s43, 0xffffffe0
    s_mov_b32 s44, 0xfffffffc
    s_mov_b32 s45, 0xffffffc0
    s_mov_b32 s46, 0xfffffff8
    s_mov_b32 s47, 0xffffff80
    s_mov_b32 s48, 0xffff0000
    s_mov_b32 s49, 0xfff00000
    s_mov_b32 s50, 0xfffe0000
    s_mov_b32 s51, 0xffe00000
    s_mov_b32 s52, 0xfffc0000
    s_mov_b32 s53, 0xffc00000
    s_mov_b32 s54, 0xfff80000
    s_mov_b32 s55, 0xff800000
    s_mov_b32 s56, 0xffffff00
    s_mov_b32 s57, 0xfffff000
    s_mov_b32 s58, 0xfffffe00
    s_mov_b32 s59, 0xffffe000
    s_mov_b32 s60, 0xfffffc00
    s_mov_b32 s61, 0xffffc000
    s_mov_b32 s62, 0xfffff800
    s_mov_b32 s63, 0xffff8000
    s_mov_b32 s64, 0xff000000
    s_mov_b32 s65, 0xf0000000
    s_mov_b32 s66, 0xfe000000
    s_mov_b32 s67, 0xe0000000
    s_mov_b32 s68, 0xfc000000
    s_mov_b32 s69, 0xc0000000
    s_mov_b32 s70, 0xf8000000
    s_mov_b32 s71, 0x80000000
    v_bfe_u32 v20, v252, 3, 2
    v_lshrrev_b32 v21, 5, v252
    v_lshl_add_u32 v20, v21, 3, v20
    s_lshr_b32 s32, s28, 1
    s_lshl_b32 s32, s32, 4
    s_and_b32 s33, s28, 1
    s_lshl_b32 s33, s33, 2
    s_add_u32 s32, s32, s33
    v_add_u32 v20, s32, v20
    v_lshlrev_b32 v20, 11, v20
    v_lshrrev_b32 v21, 2, v252
    v_and_b32 v21, 4, v21
    v_xor_b32 v21, v21, v252
    v_and_b32_e64 v21, 7, v21
    v_lshl_add_u32 v20, v21, 4, v20
    s_lshl_b32 s32, s98, 7
    v_add_u32 v14, s32, v20
    v_lshrrev_b32 v20, 2, v252
    v_lshlrev_b32 v20, 2, v20
    v_bfe_u32 v21, v252, 1, 1
    v_add_u32_e64 v20, v20, v21
    v_mul_u32_u24 v20, 28672, v20
    v_and_b32_e64 v21, 1, v252
    v_lshl_add_u32 v20, v21, 4, v20
    s_mul_i32 s30, s28, 1835008
    s_lshl_b32 s31, s29, 5
    s_add_u32 s30, s30, s31
    v_add_u32 v155, s30, v20
    v_lshlrev_b32 v21, 14, v21
    v_lshrrev_b32_e64 v20, 1, v252
    v_lshl_add_u32 v20, v20, 4, v21
    s_lshl_b32 s30, s28, 9
    s_lshl_b32 s31, s29, 15
    s_add_u32 s30, s30, s31
    v_add_u32 v153, s30, v20
    s_load_dwordx2 s[80:81], s[0:1], 40
    s_cmp_lt_u32 s29, 224
    s_cselect_b32 s82, 0x700000, 0
    s_mov_b32 s83, 0x20000
    s_load_dwordx2 s[12:13], s[0:1], 56
    s_cmp_lt_u32 s29, 224
    s_cselect_b32 s14, 0x700000, 0
    s_mov_b32 s15, 0x20000
    s_mov_b32 s73, -1
    s_mov_b32 s100, 0
    s_sub_u32 s30, s25, s24
    s_add_u32 s30, s30, 31
    v_and_b32 v15, 16, v252
    v_mul_u32_u24 v15, s30, v15
    v_and_b32 v20, 31, v252
    v_add_lshl_u32 v15, v15, v20, 3
    s_lshl_b32 s30, s24, 7
    s_add_u32 s30, s30, 0xdd9000
    v_add_u32_e64 v15, s30, v15
    s_add_u32 m0, s87, 45056
    s_nop 0
    buffer_load_dwordx4 v12, s[16:19], s96 offen offset:0 lds
    buffer_load_dwordx4 v13, s[16:19], s96 offen offset:1024 lds
    s_add_u32 s96, s95, 1
    s_and_b32 s96, s96, 15
    s_lshl_b32 s97, s96, 7
    s_add_u32 s97, s97, s84
    s_add_u32 m0, s86, 131072
    s_nop 0
    buffer_load_dwordx4 v4, s[4:7], s97 offen offset:0 lds
    buffer_load_dwordx4 v5, s[4:7], s97 offen offset:1024 lds
    buffer_load_dwordx4 v6, s[4:7], s97 offen offset:2048 lds
    buffer_load_dwordx4 v7, s[4:7], s97 offen offset:3072 lds
    s_add_u32 s96, s95, 1
    s_and_b32 s96, s96, 15
    s_mul_i32 s96, s96, 393216
    s_add_u32 s96, s96, s85
    s_add_u32 m0, s87, 65536
    s_nop 0
    buffer_load_dwordx4 v8, s[16:19], s96 offen offset:0 lds
    buffer_load_dwordx4 v9, s[16:19], s96 offen offset:1024 lds
    buffer_load_dwordx4 v10, s[16:19], s96 offen offset:2048 lds
    s_waitcnt vmcnt(7) lgkmcnt(0)
    s_add_u32 s88, s88, 0x9e3779b9
    s_barrier
    buffer_load_dwordx4 v11, s[16:19], s96 offen offset:3072 lds
    s_add_u32 m0, s87, 69632
    s_nop 0
    buffer_load_dwordx4 v12, s[16:19], s96 offen offset:0 lds
    buffer_load_dwordx4 v13, s[16:19], s96 offen offset:1024 lds
    s_add_u32 s96, s94, 2
    s_and_b32 s96, s96, 15
    s_lshl_b32 s97, s96, 7
    s_add_u32 s97, s97, s84
    s_add_u32 m0, s86, 114688
    s_nop 0
    buffer_load_dwordx4 v4, s[4:7], s97 offen offset:0 lds
    buffer_load_dwordx4 v5, s[4:7], s97 offen offset:1024 lds
    buffer_load_dwordx4 v6, s[4:7], s97 offen offset:2048 lds
    buffer_load_dwordx4 v7, s[4:7], s97 offen offset:3072 lds
    s_add_u32 s96, s94, 2
    s_and_b32 s96, s96, 15
    s_mul_i32 s96, s96, 393216
    s_add_u32 s96, s96, s85
    s_add_u32 m0, s87, 90112
    s_nop 0
    buffer_load_dwordx4 v8, s[16:19], s96 offen offset:0 lds
    buffer_load_dwordx4 v9, s[16:19], s96 offen offset:1024 lds
    buffer_load_dwordx4 v10, s[16:19], s96 offen offset:2048 lds
    buffer_load_dwordx4 v11, s[16:19], s96 offen offset:3072 lds
    s_add_u32 m0, s87, 94208
    s_nop 0
    buffer_load_dwordx4 v12, s[16:19], s96 offen offset:0 lds
    buffer_load_dwordx4 v13, s[16:19], s96 offen offset:1024 lds
    s_waitcnt vmcnt(10) lgkmcnt(0)
    s_barrier
    s_add_u32 s96, s95, 3
    s_and_b32 s96, s96, 15
    s_lshl_b32 s97, s96, 7
    s_add_u32 s97, s97, s84
    s_add_u32 m0, s86, 147456
    s_nop 0
    buffer_load_dwordx4 v4, s[4:7], s97 offen offset:0 lds
    buffer_load_dwordx4 v5, s[4:7], s97 offen offset:1024 lds
    v_and_b32_e64 v28, 31, v252
    v_bfe_u32 v29, v28, 1, 3
    v_lshrrev_b32 v30, 5, v252
    v_xor_b32 v29, v29, v30
    v_lshlrev_b32_e64 v29, 4, v29
    v_lshl_add_u32 v28, v28, 7, v29
    s_add_u32 s30, s86, 131072
    buffer_load_dwordx4 v6, s[4:7], s97 offen offset:2048 lds
    v_add_u32 v28, s30, v28
    v_xor_b32 v29, 32, v28
    v_xor_b32_e64 v30, 64, v28
    v_xor_b32 v31, 96, v28
    ds_read_b128 v[32:35], v28
    ds_read_b128 v[36:39], v29
    ds_read_b128 v[40:43], v30
    buffer_load_dwordx4 v7, s[4:7], s97 offen offset:3072 lds
    ds_read_b128 v[44:47], v31
    s_min_u32 s30, s28, 2
    s_lshl_b32 s30, s30, 13
    s_add_u32 s30, s30, 65536
    v_lshrrev_b32_e64 v20, 2, v252
    v_bfe_u32 v21, v20, 1, 2
    v_lshlrev_b32_e64 v20, 7, v20
    s_add_u32 s96, s95, 3
    s_and_b32 s96, s96, 15
    s_mul_i32 s96, s96, 393216
    s_add_u32 s96, s96, s85
    s_add_u32 m0, s87, 40960
    s_nop 0
    buffer_load_dwordx4 v8, s[16:19], s96 offen offset:0 lds
    v_lshl_add_u32 v20, v21, 5, v20
    v_and_b32_e64 v21, 3, v252
    v_lshl_add_u32 v20, v21, 3, v20
    v_add_u32 v144, s30, v20
    v_xor_b32 v145, 32, v144
    v_xor_b32_e64 v146, 64, v144
    v_xor_b32 v147, 96, v144
    buffer_load_dwordx4 v9, s[16:19], s96 offen offset:1024 lds
    ds_read_b64_tr_b16 v[100:101], v144 offset:0
    ds_read_b64_tr_b16 v[102:103], v144 offset:2048
    ds_read_b64_tr_b16 v[104:105], v144 offset:4096
    ds_read_b64_tr_b16 v[106:107], v144 offset:6144
    ds_read_b64_tr_b16 v[108:109], v145 offset:0
    ds_read_b64_tr_b16 v[110:111], v145 offset:2048
    ds_read_b64_tr_b16 v[112:113], v145 offset:4096
    buffer_load_dwordx4 v10, s[16:19], s96 offen offset:2048 lds
    ds_read_b64_tr_b16 v[114:115], v145 offset:6144
    ds_read_b64_tr_b16 v[116:117], v146 offset:0
    ds_read_b64_tr_b16 v[118:119], v146 offset:2048
    ds_read_b64_tr_b16 v[120:121], v146 offset:4096
    ds_read_b64_tr_b16 v[122:123], v146 offset:6144
    ds_read_b64_tr_b16 v[124:125], v147 offset:0
    ds_read_b64_tr_b16 v[126:127], v147 offset:2048
    buffer_load_dwordx4 v11, s[16:19], s96 offen offset:3072 lds
    ds_read_b64_tr_b16 v[128:129], v147 offset:4096
    ds_read_b64_tr_b16 v[130:131], v147 offset:6144
    v_mov_b32 v16, -1
    v_mov_b32 v17, -1
    v_mov_b32_e64 v18, -1
    v_mov_b32 v19, -1
    s_lshr_b32 s30, s28, 1
    s_add_u32 m0, s87, 45056
    s_nop 0
    buffer_load_dwordx4 v12, s[16:19], s96 offen offset:0 lds
    s_mul_i32 s30, s30, 16777216
    s_and_b32 s31, s28, 1
    s_lshl_b32 s32, s31, 20
    s_lshl_b32 s33, s72, 10
    s_add_u32 s32, s32, s33
    s_add_u32 s32, s32, s30
    s_add_u32 s32, s32, 0xc00000
    buffer_load_dwordx4 v13, s[16:19], s96 offen offset:1024 lds
    buffer_store_dwordx4 v[16:19], v253, s[20:23], s32 offen sc1
    s_add_u32 s32, s32, 262144
    buffer_store_dwordx4 v[16:19], v253, s[20:23], s32 offen sc1
    s_add_u32 s32, s32, 262144
    buffer_store_dwordx4 v[16:19], v253, s[20:23], s32 offen sc1
    s_add_u32 s32, s32, 262144
    s_lshl_b32 s33, s72, 7
    s_add_u32 s33, s33, s30
    s_add_u32 s33, s33, 0xdc0000
    s_cmp_eq_u32 s31, 0
    s_cselect_b32 s32, s32, s33
    s_cselect_b64 exec, -1, 0xff
    buffer_store_dwordx4 v[16:19], v253, s[20:23], s32 offen sc1
    s_mov_b64 exec, -1
    s_waitcnt vmcnt(14) lgkmcnt(0)
    s_barrier
    s_add_u32 s96, s94, 4
    s_and_b32 s96, s96, 15
    s_lshl_b32 s97, s96, 7
    s_add_u32 s97, s97, s84
    s_add_u32 m0, s86, 131072
    s_nop 0
    buffer_load_dwordx4 v4, s[4:7], s97 offen offset:0 lds
    buffer_load_dwordx4 v5, s[4:7], s97 offen offset:1024 lds
    v_mov_b32_e64 v48, 0
    buffer_load_dwordx4 v6, s[4:7], s97 offen offset:2048 lds
    v_mov_b32_e64 v49, 0
    buffer_load_dwordx4 v7, s[4:7], s97 offen offset:3072 lds
    v_mov_b32_e64 v50, 0
    s_add_u32 s96, s94, 4
    s_and_b32 s96, s96, 15
    s_mul_i32 s96, s96, 393216
    s_add_u32 s96, s96, s85
    s_add_u32 m0, s87, 65536
    s_nop 0
    buffer_load_dwordx4 v8, s[16:19], s96 offen offset:0 lds
    v_mov_b32_e64 v51, 0
    buffer_load_dwordx4 v9, s[16:19], s96 offen offset:1024 lds
    v_mov_b32_e64 v140, 0
    buffer_load_dwordx4 v10, s[16:19], s96 offen offset:2048 lds
    v_mov_b32_e64 v141, 0
    buffer_load_dwordx4 v11, s[16:19], s96 offen offset:3072 lds
    v_mov_b32 v142, 0
    s_add_u32 m0, s87, 69632
    s_nop 0
    buffer_load_dwordx4 v12, s[16:19], s96 offen offset:0 lds
    v_mov_b32_e64 v143, 0
    buffer_load_dwordx4 v13, s[16:19], s96 offen offset:1024 lds
    v_dot2c_f32_bf16 v140, 0x3f803f80, v100
    v_dot2c_f32_bf16 v141, 0x3f803f80, v108
    v_dot2c_f32_bf16 v142, 0x3f803f80, v116
    v_dot2c_f32_bf16 v143, 0x3f803f80, v124
    v_dot2c_f32_bf16 v140, 0x3f803f80, v101
    v_dot2c_f32_bf16 v141, 0x3f803f80, v109
    v_dot2c_f32_bf16 v142, 0x3f803f80, v117
    v_dot2c_f32_bf16 v143, 0x3f803f80, v125
    v_dot2c_f32_bf16 v140, 0x3f803f80, v102
    v_dot2c_f32_bf16 v141, 0x3f803f80, v110
    v_dot2c_f32_bf16 v142, 0x3f803f80, v118
    v_dot2c_f32_bf16 v143, 0x3f803f80, v126
    v_dot2c_f32_bf16 v140, 0x3f803f80, v103
    v_dot2c_f32_bf16 v141, 0x3f803f80, v111
    v_dot2c_f32_bf16 v142, 0x3f803f80, v119
    v_dot2c_f32_bf16 v143, 0x3f803f80, v127
    v_dot2c_f32_bf16 v140, 0x3f803f80, v104
    v_dot2c_f32_bf16 v141, 0x3f803f80, v112
    v_dot2c_f32_bf16 v142, 0x3f803f80, v120
    v_dot2c_f32_bf16 v143, 0x3f803f80, v128
    v_dot2c_f32_bf16 v140, 0x3f803f80, v105
    v_dot2c_f32_bf16 v141, 0x3f803f80, v113
    v_dot2c_f32_bf16 v142, 0x3f803f80, v121
    v_dot2c_f32_bf16 v143, 0x3f803f80, v129
    v_dot2c_f32_bf16 v140, 0x3f803f80, v106
    v_dot2c_f32_bf16 v141, 0x3f803f80, v114
    v_dot2c_f32_bf16 v142, 0x3f803f80, v122
    v_dot2c_f32_bf16 v143, 0x3f803f80, v130
    v_dot2c_f32_bf16 v140, 0x3f803f80, v107
    v_dot2c_f32_bf16 v141, 0x3f803f80, v115
    v_dot2c_f32_bf16 v142, 0x3f803f80, v123
    v_dot2c_f32_bf16 v143, 0x3f803f80, v131
    v_dot2c_f32_bf16 v48, 0x3f803f80, v32
    v_dot2c_f32_bf16 v49, v32, v32
    v_dot2c_f32_bf16 v50, 0x3f803f80, v33
    v_dot2c_f32_bf16 v51, v33, v33
    v_dot2c_f32_bf16 v48, 0x3f803f80, v34
    v_dot2c_f32_bf16 v49, v34, v34
    v_dot2c_f32_bf16 v50, 0x3f803f80, v35
    v_dot2c_f32_bf16 v51, v35, v35
    v_dot2c_f32_bf16 v48, 0x3f803f80, v36
    v_dot2c_f32_bf16 v49, v36, v36
    v_dot2c_f32_bf16 v50, 0x3f803f80, v37
    v_dot2c_f32_bf16 v51, v37, v37
    v_dot2c_f32_bf16 v48, 0x3f803f80, v38
    v_dot2c_f32_bf16 v49, v38, v38
    v_dot2c_f32_bf16 v50, 0x3f803f80, v39
    v_dot2c_f32_bf16 v51, v39, v39
    v_dot2c_f32_bf16 v48, 0x3f803f80, v40
    v_dot2c_f32_bf16 v49, v40, v40
    v_dot2c_f32_bf16 v50, 0x3f803f80, v41
    v_dot2c_f32_bf16 v51, v41, v41
    v_dot2c_f32_bf16 v48, 0x3f803f80, v42
    v_dot2c_f32_bf16 v49, v42, v42
    v_dot2c_f32_bf16 v50, 0x3f803f80, v43
    v_dot2c_f32_bf16 v51, v43, v43
    v_dot2c_f32_bf16 v48, 0x3f803f80, v44
    v_dot2c_f32_bf16 v49, v44, v44
    v_dot2c_f32_bf16 v50, 0x3f803f80, v45
    v_dot2c_f32_bf16 v51, v45, v45
    v_dot2c_f32_bf16 v48, 0x3f803f80, v46
    v_dot2c_f32_bf16 v49, v46, v46
    v_dot2c_f32_bf16 v50, 0x3f803f80, v47
    v_dot2c_f32_bf16 v51, v47, v47
    s_waitcnt vmcnt(14) lgkmcnt(0)
    s_barrier
    s_add_u32 s96, s95, 5
    s_and_b32 s96, s96, 15
    s_lshl_b32 s97, s96, 7
    s_add_u32 s97, s97, s84
    s_add_u32 m0, s86, 114688
    s_nop 0
    buffer_load_dwordx4 v4, s[4:7], s97 offen offset:0 lds
    buffer_load_dwordx4 v5, s[4:7], s97 offen offset:1024 lds
    s_lshl_b32 s30, s99, 12
    s_lshl_b32 s31, s25, 8
    buffer_load_dwordx4 v6, s[4:7], s97 offen offset:2048 lds
    s_add_u32 s30, s30, s31
    s_add_u32 s30, s30, 0x2400000
    buffer_load_dwordx4 v7, s[4:7], s97 offen offset:3072 lds
    v_lshlrev_b32_e64 v28, 3, v252
    s_add_u32 s96, s95, 5
    s_and_b32 s96, s96, 15
    s_mul_i32 s96, s96, 393216
    s_add_u32 s96, s96, s85
    s_add_u32 m0, s87, 90112
    s_nop 0
    buffer_load_dwordx4 v8, s[16:19], s96 offen offset:0 lds
    v_add_f32 v48, v48, v50
    v_add_f32 v49, v49, v51
    buffer_load_dwordx4 v9, s[16:19], s96 offen offset:1024 lds
    v_mov_b32 v50, v48
    v_mov_b32 v51, v49
    buffer_load_dwordx4 v10, s[16:19], s96 offen offset:2048 lds
    v_permlane32_swap_b32_e64 v48, v50
    buffer_load_dwordx4 v11, s[16:19], s96 offen offset:3072 lds
    v_permlane32_swap_b32 v49, v51
    v_add_f32 v48, v48, v50
    s_add_u32 m0, s87, 94208
    s_nop 0
    buffer_load_dwordx4 v12, s[16:19], s96 offen offset:0 lds
    v_add_f32 v49, v49, v51
    buffer_load_dwordx4 v13, s[16:19], s96 offen offset:1024 lds
    s_mov_b32 exec_hi, 0
    buffer_store_dwordx2 v[48:49], v28, s[20:23], s30 offen sc1
    s_mov_b64 exec, -1
    s_min_u32 s32, s28, 2
    s_lshl_b32 s32, s32, 12
    s_lshl_b32 s33, s25, 14
    s_add_u32 s32, s32, s33
    s_add_u32 s32, s32, 0x2500000
    s_lshl_b32 s33, s24, 8
    s_add_u32 s32, s32, s33
    v_lshlrev_b32 v20, 2, v252
    v_permlane32_swap_b32 v140, v142
    v_permlane32_swap_b32 v141, v143
    v_add_f32 v140, v140, v142
    v_add_f32 v141, v141, v143
    s_nop 1
    v_permlane16_swap_b32_e64 v140, v141
    v_add_f32 v140, v140, v141
    buffer_store_dword v140, v20, s[20:23], s32 offen sc1
    s_waitcnt vmcnt(12) lgkmcnt(0)
    s_barrier
    s_add_u32 s96, s94, 6
    s_and_b32 s96, s96, 15
    s_lshl_b32 s97, s96, 7
    s_add_u32 s97, s97, s84
    s_add_u32 m0, s86, 147456
    s_nop 0
    buffer_load_dwordx4 v4, s[4:7], s97 offen offset:0 lds
    buffer_load_dwordx4 v5, s[4:7], s97 offen offset:1024 lds
    buffer_load_dwordx4 v6, s[4:7], s97 offen offset:2048 lds
    buffer_load_dwordx4 v7, s[4:7], s97 offen offset:3072 lds
    s_add_u32 s96, s94, 6
    s_and_b32 s96, s96, 15
    s_mul_i32 s96, s96, 393216
    s_add_u32 s96, s96, s85
    s_add_u32 m0, s87, 40960
    s_nop 0
    buffer_load_dwordx4 v8, s[16:19], s96 offen offset:0 lds
    buffer_load_dwordx4 v9, s[16:19], s96 offen offset:1024 lds
    buffer_load_dwordx4 v10, s[16:19], s96 offen offset:2048 lds
    buffer_load_dwordx4 v11, s[16:19], s96 offen offset:3072 lds
    s_add_u32 m0, s87, 45056
    s_nop 0
    buffer_load_dwordx4 v12, s[16:19], s96 offen offset:0 lds
    buffer_load_dwordx4 v13, s[16:19], s96 offen offset:1024 lds
    s_waitcnt vmcnt(10) lgkmcnt(0)
    s_barrier
    s_add_u32 s96, s95, 7
    s_and_b32 s96, s96, 15
    s_lshl_b32 s97, s96, 7
    s_add_u32 s97, s97, s84
    s_add_u32 m0, s86, 131072
    s_nop 0
    buffer_load_dwordx4 v4, s[4:7], s97 offen offset:0 lds
    buffer_load_dwordx4 v5, s[4:7], s97 offen offset:1024 lds
    buffer_load_dwordx4 v6, s[4:7], s97 offen offset:2048 lds
    buffer_load_dwordx4 v7, s[4:7], s97 offen offset:3072 lds
    s_add_u32 s96, s95, 7
    s_and_b32 s96, s96, 15
    s_mul_i32 s96, s96, 393216
    s_add_u32 s96, s96, s85
    s_add_u32 m0, s87, 65536
    s_nop 0
    buffer_load_dwordx4 v8, s[16:19], s96 offen offset:0 lds
    buffer_load_dwordx4 v9, s[16:19], s96 offen offset:1024 lds
    buffer_load_dwordx4 v10, s[16:19], s96 offen offset:2048 lds
    buffer_load_dwordx4 v11, s[16:19], s96 offen offset:3072 lds
    s_add_u32 m0, s87, 69632
    s_nop 0
    buffer_load_dwordx4 v12, s[16:19], s96 offen offset:0 lds
    buffer_load_dwordx4 v13, s[16:19], s96 offen offset:1024 lds
    s_waitcnt vmcnt(10) lgkmcnt(0)
    s_barrier
    s_add_u32 s96, s94, 8
    s_and_b32 s96, s96, 15
    s_lshl_b32 s97, s96, 7
    s_add_u32 s97, s97, s84
    s_add_u32 m0, s86, 114688
    s_nop 0
    buffer_load_dwordx4 v4, s[4:7], s97 offen offset:0 lds
    buffer_load_dwordx4 v5, s[4:7], s97 offen offset:1024 lds
    buffer_load_dwordx4 v6, s[4:7], s97 offen offset:2048 lds
    buffer_load_dwordx4 v7, s[4:7], s97 offen offset:3072 lds
    s_add_u32 s96, s94, 8
    s_and_b32 s96, s96, 15
    s_mul_i32 s96, s96, 393216
    s_add_u32 s96, s96, s85
    s_add_u32 m0, s87, 90112
    s_nop 0
    buffer_load_dwordx4 v8, s[16:19], s96 offen offset:0 lds
    buffer_load_dwordx4 v9, s[16:19], s96 offen offset:1024 lds
    buffer_load_dwordx4 v10, s[16:19], s96 offen offset:2048 lds
    buffer_load_dwordx4 v11, s[16:19], s96 offen offset:3072 lds
    s_add_u32 m0, s87, 94208
    s_nop 0
    buffer_load_dwordx4 v12, s[16:19], s96 offen offset:0 lds
    buffer_load_dwordx4 v13, s[16:19], s96 offen offset:1024 lds
    s_waitcnt vmcnt(10) lgkmcnt(0)
    s_barrier
    s_add_u32 s96, s95, 9
    s_and_b32 s96, s96, 15
    s_lshl_b32 s97, s96, 7
    s_add_u32 s97, s97, s84
    s_add_u32 m0, s86, 147456
    s_nop 0
    buffer_load_dwordx4 v4, s[4:7], s97 offen offset:0 lds
    buffer_load_dwordx4 v5, s[4:7], s97 offen offset:1024 lds
    buffer_load_dwordx4 v6, s[4:7], s97 offen offset:2048 lds
    buffer_load_dwordx4 v7, s[4:7], s97 offen offset:3072 lds
    s_add_u32 s96, s95, 9
    s_and_b32 s96, s96, 15
    s_mul_i32 s96, s96, 393216
    s_add_u32 s96, s96, s85
    s_add_u32 m0, s87, 40960
    s_nop 0
    buffer_load_dwordx4 v8, s[16:19], s96 offen offset:0 lds
    buffer_load_dwordx4 v9, s[16:19], s96 offen offset:1024 lds
    buffer_load_dwordx4 v10, s[16:19], s96 offen offset:2048 lds
    buffer_load_dwordx4 v11, s[16:19], s96 offen offset:3072 lds
    s_add_u32 m0, s87, 45056
    s_nop 0
    buffer_load_dwordx4 v12, s[16:19], s96 offen offset:0 lds
    buffer_load_dwordx4 v13, s[16:19], s96 offen offset:1024 lds
    s_waitcnt vmcnt(10) lgkmcnt(0)
    s_barrier
    s_add_u32 s96, s94, 10
    s_and_b32 s96, s96, 15
    s_lshl_b32 s97, s96, 7
    s_add_u32 s97, s97, s84
    s_add_u32 m0, s86, 131072
    s_nop 0
    buffer_load_dwordx4 v4, s[4:7], s97 offen offset:0 lds
    buffer_load_dwordx4 v5, s[4:7], s97 offen offset:1024 lds
    buffer_load_dwordx4 v6, s[4:7], s97 offen offset:2048 lds
    buffer_load_dwordx4 v7, s[4:7], s97 offen offset:3072 lds
    s_add_u32 s96, s94, 10
    s_and_b32 s96, s96, 15
    s_mul_i32 s96, s96, 393216
    s_add_u32 s96, s96, s85
    s_add_u32 m0, s87, 65536
    s_nop 0
    buffer_load_dwordx4 v8, s[16:19], s96 offen offset:0 lds
    buffer_load_dwordx4 v9, s[16:19], s96 offen offset:1024 lds
    buffer_load_dwordx4 v10, s[16:19], s96 offen offset:2048 lds
    buffer_load_dwordx4 v11, s[16:19], s96 offen offset:3072 lds
    s_add_u32 m0, s87, 69632
    s_nop 0
    buffer_load_dwordx4 v12, s[16:19], s96 offen offset:0 lds
    buffer_load_dwordx4 v13, s[16:19], s96 offen offset:1024 lds
    s_waitcnt vmcnt(10) lgkmcnt(0)
    s_barrier
    s_add_u32 s96, s95, 11
    s_and_b32 s96, s96, 15
    s_lshl_b32 s97, s96, 7
    s_add_u32 s97, s97, s84
    s_add_u32 m0, s86, 114688
    s_nop 0
    buffer_load_dwordx4 v4, s[4:7], s97 offen offset:0 lds
    buffer_load_dwordx4 v5, s[4:7], s97 offen offset:1024 lds
    buffer_load_dwordx4 v6, s[4:7], s97 offen offset:2048 lds
    buffer_load_dwordx4 v7, s[4:7], s97 offen offset:3072 lds
    s_add_u32 s96, s95, 11
    s_and_b32 s96, s96, 15
    s_mul_i32 s96, s96, 393216
    s_add_u32 s96, s96, s85
    s_add_u32 m0, s87, 90112
    s_nop 0
    buffer_load_dwordx4 v8, s[16:19], s96 offen offset:0 lds
    buffer_load_dwordx4 v9, s[16:19], s96 offen offset:1024 lds
    buffer_load_dwordx4 v10, s[16:19], s96 offen offset:2048 lds
    buffer_load_dwordx4 v11, s[16:19], s96 offen offset:3072 lds
    s_add_u32 m0, s87, 94208
    s_nop 0
    buffer_load_dwordx4 v12, s[16:19], s96 offen offset:0 lds
    buffer_load_dwordx4 v13, s[16:19], s96 offen offset:1024 lds
    s_waitcnt vmcnt(10) lgkmcnt(0)
    s_barrier
    s_add_u32 s96, s94, 12
    s_and_b32 s96, s96, 15
    s_lshl_b32 s97, s96, 7
    s_add_u32 s97, s97, s84
    s_add_u32 m0, s86, 147456
    s_nop 0
    buffer_load_dwordx4 v4, s[4:7], s97 offen offset:0 lds
    buffer_load_dwordx4 v5, s[4:7], s97 offen offset:1024 lds
    s_getpc_b64 s[32:33]
pc_47:
    buffer_load_dwordx4 v6, s[4:7], s97 offen offset:2048 lds
    s_sub_u32 s32, s32, pc_47-interleave_layers__sliding_block__moe_arch_mod__prompt_kernel
    s_subb_u32 s33, s33, 0
    buffer_load_dwordx4 v7, s[4:7], s97 offen offset:3072 lds
    s_lshr_b32 s34, s2, 3
    s_add_u32 s96, s94, 12
    s_and_b32 s96, s96, 15
    s_mul_i32 s96, s96, 393216
    s_add_u32 s96, s96, s85
    s_add_u32 m0, s87, 40960
    s_nop 0
    buffer_load_dwordx4 v8, s[16:19], s96 offen offset:0 lds
    s_lshl_b32 s34, s34, 2
    buffer_load_dwordx4 v9, s[16:19], s96 offen offset:1024 lds
    s_add_u32 s34, s34, s28
    s_and_b32 s34, s34, 127
    buffer_load_dwordx4 v10, s[16:19], s96 offen offset:2048 lds
    s_lshl_b32 s34, s34, 7
    buffer_load_dwordx4 v11, s[16:19], s96 offen offset:3072 lds
    v_lshl_add_u32 v154, v252, 14, s34
    s_mov_b32 s34, k_exit-interleave_layers__sliding_block__moe_arch_mod__prompt_kernel
    s_add_u32 m0, s87, 45056
    s_nop 0
    buffer_load_dwordx4 v12, s[16:19], s96 offen offset:0 lds
    s_mov_b32 s35, 0x20000
    buffer_load_dwordx4 v13, s[16:19], s96 offen offset:1024 lds
    buffer_load_dword v154, v154, s[32:35], 0 offen
    s_waitcnt vmcnt(11) lgkmcnt(0)
    s_barrier
    buffer_load_dwordx2 v[16:17], v15, s[20:23], 0 offen sc1
    s_add_u32 s96, s95, 13
    s_and_b32 s96, s96, 15
    s_lshl_b32 s97, s96, 7
    s_add_u32 s97, s97, s84
    s_add_u32 m0, s86, 131072
    s_nop 0
    buffer_load_dwordx4 v4, s[4:7], s97 offen offset:0 lds
    buffer_load_dwordx4 v5, s[4:7], s97 offen offset:1024 lds
    buffer_load_dwordx4 v6, s[4:7], s97 offen offset:2048 lds
    buffer_load_dwordx4 v7, s[4:7], s97 offen offset:3072 lds
    s_add_u32 s96, s95, 13
    s_and_b32 s96, s96, 15
    s_mul_i32 s96, s96, 393216
    s_add_u32 s96, s96, s85
    s_add_u32 m0, s87, 65536
    s_nop 0
    buffer_load_dwordx4 v8, s[16:19], s96 offen offset:0 lds
    buffer_load_dwordx4 v9, s[16:19], s96 offen offset:1024 lds
    buffer_load_dwordx4 v10, s[16:19], s96 offen offset:2048 lds
    buffer_load_dwordx4 v11, s[16:19], s96 offen offset:3072 lds
    s_add_u32 m0, s87, 69632
    s_nop 0
    buffer_load_dwordx4 v12, s[16:19], s96 offen offset:0 lds
    buffer_load_dwordx4 v13, s[16:19], s96 offen offset:1024 lds
    s_waitcnt vmcnt(12) lgkmcnt(0)
    s_barrier
    s_add_u32 s96, s94, 14
    s_and_b32 s96, s96, 15
    s_lshl_b32 s97, s96, 7
    s_add_u32 s97, s97, s84
    s_add_u32 m0, s86, 114688
    s_nop 0
    buffer_load_dwordx4 v4, s[4:7], s97 offen offset:0 lds
    buffer_load_dwordx4 v5, s[4:7], s97 offen offset:1024 lds
    buffer_load_dwordx4 v6, s[4:7], s97 offen offset:2048 lds
    buffer_load_dwordx4 v7, s[4:7], s97 offen offset:3072 lds
    s_add_u32 s96, s94, 14
    s_and_b32 s96, s96, 15
    s_mul_i32 s96, s96, 393216
    s_add_u32 s96, s96, s85
    s_add_u32 m0, s87, 90112
    s_nop 0
    buffer_load_dwordx4 v8, s[16:19], s96 offen offset:0 lds
    buffer_load_dwordx4 v9, s[16:19], s96 offen offset:1024 lds
    buffer_load_dwordx4 v10, s[16:19], s96 offen offset:2048 lds
    buffer_load_dwordx4 v11, s[16:19], s96 offen offset:3072 lds
    s_add_u32 m0, s87, 94208
    s_nop 0
    buffer_load_dwordx4 v12, s[16:19], s96 offen offset:0 lds
    buffer_load_dwordx4 v13, s[16:19], s96 offen offset:1024 lds
    s_mov_b32 s78, s27
    s_waitcnt vmcnt(20)
    s_branch pc_49
pl_48:
    buffer_load_dwordx2 v[16:17], v15, s[20:23], 0 offen sc1
    s_waitcnt vmcnt(0)
pc_49:
    v_cmp_ne_u32 vcc, s88, v16
    s_cbranch_vccz pd_50
    s_sub_u32 s78, s78, 1
    s_cmp_lg_u32 s78, 0
    s_cbranch_scc1 pl_48
    s_mov_b32 s27, 1
pd_50:
    s_getreg_b32 s30, hwreg(HW_REG_XCC_ID, 0, 4)
    v_cmp_ne_u32_e64 vcc, s30, v17
    s_and_b32 s30, vcc_lo, 0xffff
    s_cselect_b32 s77, 0, 1
    v_mov_b32 v20, s73
    v_mov_b32_e64 v21, s77
    v_mov_b32 v19, 0
    ds_write_b64 v19, v[20:21] offset:3072
    s_waitcnt vmcnt(10) lgkmcnt(0)
    s_barrier
    s_add_u32 s96, s95, 15
    s_and_b32 s96, s96, 15
    s_lshl_b32 s97, s96, 7
    s_add_u32 s97, s97, s84
    s_add_u32 m0, s86, 147456
    s_nop 0
    buffer_load_dwordx4 v4, s[4:7], s97 offen offset:0 lds
    buffer_load_dwordx4 v5, s[4:7], s97 offen offset:1024 lds
    buffer_load_dwordx4 v6, s[4:7], s97 offen offset:2048 lds
    buffer_load_dwordx4 v7, s[4:7], s97 offen offset:3072 lds
    s_add_u32 s96, s95, 15
    s_and_b32 s96, s96, 15
    s_mul_i32 s96, s96, 393216
    s_add_u32 s96, s96, s85
    s_add_u32 m0, s87, 40960
    s_nop 0
    buffer_load_dwordx4 v8, s[16:19], s96 offen offset:0 lds
    buffer_load_dwordx4 v9, s[16:19], s96 offen offset:1024 lds
    buffer_load_dwordx4 v10, s[16:19], s96 offen offset:2048 lds
    buffer_load_dwordx4 v11, s[16:19], s96 offen offset:3072 lds
    s_add_u32 m0, s87, 45056
    s_nop 0
    buffer_load_dwordx4 v12, s[16:19], s96 offen offset:0 lds
    buffer_load_dwordx4 v13, s[16:19], s96 offen offset:1024 lds
    s_waitcnt vmcnt(10) lgkmcnt(0)
    s_barrier
    s_load_dwordx2 s[4:5], s[0:1], 48
    s_cmp_lt_u32 s29, 224
    s_cselect_b32 s6, 0x700000, 0
    s_mov_b32 s7, 0x20000
    s_lshl_b32 s30, s99, 12
    s_add_u32 s30, s30, 0x2400000
    buffer_load_dwordx4 v[64:67], v253, s[20:23], s30 offen offset:0 sc1
    buffer_load_dwordx4 v[68:71], v253, s[20:23], s30 offen offset:1024 sc1
    buffer_load_dwordx4 v[72:75], v253, s[20:23], s30 offen offset:2048 sc1
    buffer_load_dwordx4 v[76:79], v253, s[20:23], s30 offen offset:3072 sc1
    s_min_u32 s32, s28, 2
    s_lshl_b32 s32, s32, 12
    s_lshl_b32 s33, s25, 14
    s_add_u32 s32, s32, s33
    s_add_u32 s32, s32, 0x2500000
    buffer_load_dwordx4 v[32:35], v253, s[20:23], s32 offen offset:0 sc1
    buffer_load_dwordx4 v[36:39], v253, s[20:23], s32 offen offset:1024 sc1
    buffer_load_dwordx4 v[40:43], v253, s[20:23], s32 offen offset:2048 sc1
    buffer_load_dwordx4 v[44:47], v253, s[20:23], s32 offen offset:3072 sc1
    s_add_u32 s96, s25, 1
    s_and_b32 s96, s96, 15
    s_lshl_b32 s96, s96, 17
    s_add_u32 m0, s101, 4096
    s_nop 0
    buffer_load_dwordx4 v14, s[8:11], s96 offen lds
    s_add_u32 s96, s25, 2
    s_and_b32 s96, s96, 15
    s_lshl_b32 s96, s96, 17
    s_add_u32 m0, s101, 8192
    s_nop 0
    buffer_load_dwordx4 v14, s[8:11], s96 offen lds
    s_add_u32 s96, s25, 3
    s_and_b32 s96, s96, 15
    s_lshl_b32 s96, s96, 17
    s_add_u32 m0, s101, 12288
    s_nop 0
    buffer_load_dwordx4 v14, s[8:11], s96 offen lds
    s_waitcnt vmcnt(11) lgkmcnt(0)
    s_barrier
    s_waitcnt vmcnt(3)
    v_add_f32 v64, v64, v68
    v_add_f32 v65, v65, v69
    v_add_f32 v66, v66, v70
    v_add_f32 v67, v67, v71
    v_add_f32 v64, v64, v72
    v_add_f32 v65, v65, v73
    v_add_f32 v66, v66, v74
    v_add_f32 v67, v67, v75
    v_add_f32 v64, v64, v76
    v_add_f32 v65, v65, v77
    v_add_f32 v66, v66, v78
    v_add_f32 v67, v67, v79
    s_nop 0
    v_permlane32_swap_b32 v64, v66
    v_permlane32_swap_b32 v65, v67
    v_add_f32 v64, v64, v66
    v_add_f32 v65, v65, v67
    v_mov_b32 v48, v64
    v_mov_b32 v49, v65
    s_nop 0
    v_permlane16_swap_b32 v64, v48
    v_permlane16_swap_b32 v65, v49
    v_add_f32 v64, v64, v48
    v_add_f32_e64 v65, v65, v49
    v_mul_f32 v54, 0x3a800000, v64
    v_mul_f32 v65, 0x3a800000, v65
    v_fma_f32 v65, -v54, v54, v65
    v_max_f32_e64 v65, 0, v65
    v_add_f32 v55, 0x3727c5ac, v65
    v_rsq_f32 v55, v55
    v_add_f32 v32, v32, v36
    v_add_f32 v33, v33, v37
    v_add_f32 v34, v34, v38
    v_add_f32 v35, v35, v39
    v_add_f32 v32, v32, v40
    v_add_f32 v33, v33, v41
    v_add_f32 v34, v34, v42
    v_add_f32 v35, v35, v43
    v_add_f32 v32, v32, v44
    v_add_f32 v33, v33, v45
    v_add_f32 v34, v34, v46
    v_add_f32 v35, v35, v47
    s_nop 0
    v_permlane32_swap_b32 v32, v34
    v_permlane32_swap_b32 v33, v35
    v_add_f32 v32, v32, v34
    v_add_f32 v33, v33, v35
    s_nop 1
    v_permlane16_swap_b32 v32, v33
    v_add_f32 v32, v32, v33
    v_mov_b32 v2, v32
    v_and_b32 v48, 15, v252
    v_lshrrev_b32 v49, 5, v252
    v_lshl_add_u32 v48, v48, 1, v49
    v_bfe_u32 v49, v252, 4, 1
    v_cmp_eq_u32 vcc, 0, v49
    v_lshlrev_b32 v49, 9, v49
    v_lshl_add_u32 v48, v48, 2, v49
    s_lshl_b32 s32, s28, 7
    v_add_u32 v48, s32, v48
    v_cndmask_b32_e64 v49, v54, v55, vcc
    v_cndmask_b32 v50, 0, 1.0, vcc
    ds_write_b32 v48, v49 offset:0
    ds_write_b32 v48, v50 offset:2048
    v_and_b32 v48, 15, v252
    v_lshrrev_b32 v51, 4, v252
    v_lshl_add_u32 v48, v48, 2, v51
    s_min_u32 s32, s28, 2
    s_lshl_b32 s32, s32, 8
    v_lshl_add_u32 v48, v48, 2, s32
    ds_write_b32 v48, v2 offset:1024
    s_waitcnt lgkmcnt(0)
    s_barrier
l_att:
    s_add_u32 s96, s25, 10
    s_and_b32 s96, s96, 15
    s_lshl_b32 s96, s96, 17
    s_add_u32 m0, s101, 40960
    s_nop 0
    buffer_load_dwordx4 v14, s[8:11], s96 offen lds
    s_add_u32 s96, s25, 11
    s_and_b32 s96, s96, 15
    s_lshl_b32 s96, s96, 17
    s_add_u32 m0, s101, 45056
    s_nop 0
    buffer_load_dwordx4 v14, s[8:11], s96 offen lds
    s_cmp_lg_u32 s26, 0
    s_cbranch_scc1 sk_51
    s_add_u32 s96, s25, 4
    s_and_b32 s96, s96, 15
    s_lshl_b32 s96, s96, 17
    s_add_u32 m0, s101, 16384
    s_nop 0
    buffer_load_dwordx4 v14, s[8:11], s96 offen lds
    s_add_u32 s96, s25, 5
    s_and_b32 s96, s96, 15
    s_lshl_b32 s96, s96, 17
    s_add_u32 m0, s101, 20480
    s_nop 0
    buffer_load_dwordx4 v14, s[8:11], s96 offen lds
    s_add_u32 s96, s25, 6
    s_and_b32 s96, s96, 15
    s_lshl_b32 s96, s96, 17
    s_add_u32 m0, s101, 24576
    s_nop 0
    buffer_load_dwordx4 v14, s[8:11], s96 offen lds
    s_add_u32 s96, s25, 7
    s_and_b32 s96, s96, 15
    s_lshl_b32 s96, s96, 17
    s_add_u32 m0, s101, 28672
    s_nop 0
    buffer_load_dwordx4 v14, s[8:11], s96 offen lds
    s_add_u32 s96, s25, 8
    s_and_b32 s96, s96, 15
    s_lshl_b32 s96, s96, 17
    s_add_u32 m0, s101, 32768
    s_nop 0
    buffer_load_dwordx4 v14, s[8:11], s96 offen lds
    s_add_u32 s96, s25, 9
    s_and_b32 s96, s96, 15
    s_lshl_b32 s96, s96, 17
    s_add_u32 m0, s101, 36864
    s_nop 0
    buffer_load_dwordx4 v14, s[8:11], s96 offen lds
sk_51:
    v_mov_b32 v20, 0xffff
    v_mov_b32 v21, 0xffff0000
    v_cndmask_b32 v22, 0, v20, s[40:41]
    v_cndmask_b32 v23, 0, v21, s[42:43]
    v_or_b32_e64 v12, v22, v23
    v_cndmask_b32 v22, 0, v20, s[44:45]
    v_cndmask_b32 v23, 0, v21, s[46:47]
    v_or_b32_e64 v13, v22, v23
    v_cndmask_b32 v22, 0, v20, s[48:49]
    v_cndmask_b32 v23, 0, v21, s[50:51]
    v_or_b32_e64 v14, v22, v23
    v_cndmask_b32 v22, 0, v20, s[52:53]
    v_cndmask_b32 v23, 0, v21, s[54:55]
    v_or_b32_e64 v15, v22, v23
    v_cndmask_b32 v22, 0, v20, s[56:57]
    v_cndmask_b32 v23, 0, v21, s[58:59]
    v_or_b32_e64 v16, v22, v23
    v_cndmask_b32 v22, 0, v20, s[60:61]
    v_cndmask_b32 v23, 0, v21, s[62:63]
    v_or_b32_e64 v17, v22, v23
    v_cndmask_b32 v22, 0, v20, s[64:65]
    v_cndmask_b32 v23, 0, v21, s[66:67]
    v_or_b32_e64 v18, v22, v23
    v_cndmask_b32 v22, 0, v20, s[68:69]
    v_cndmask_b32 v23, 0, v21, s[70:71]
    v_or_b32 v19, v22, v23
    s_xor_b32 s76, s99, 3
    s_and_b32 s34, s76, 3
    s_lshl_b32 s33, s34, 12
    s_add_u32 s33, s33, 114688
    v_add_u32_e64 v20, s33, v253
    v_add_u32 v22, 32768, v20
    v_add_u32 v23, 143360, v253
    s_add_u32 s74, s34, 1
    s_mov_b32 s75, 0
    s_lshl_b32 s34, s34, 11
    s_add_u32 s34, s34, 57344
    v_add_u32 v3, s34, v253
    v_mov_b32 v21, 0xf149f2ca
    v_cndmask_b32 v24, v21, 0, s[40:41]
    v_cndmask_b32 v25, v21, 0, s[42:43]
    v_cndmask_b32 v26, v21, 0, s[44:45]
    v_cndmask_b32 v27, v21, 0, s[46:47]
    v_cndmask_b32 v28, v21, 0, s[48:49]
    v_cndmask_b32 v29, v21, 0, s[50:51]
    v_cndmask_b32 v30, v21, 0, s[52:53]
    v_cndmask_b32 v31, v21, 0, s[54:55]
    v_cndmask_b32 v32, v21, 0, s[56:57]
    v_cndmask_b32 v33, v21, 0, s[58:59]
    v_cndmask_b32 v34, v21, 0, s[60:61]
    v_cndmask_b32 v35, v21, 0, s[62:63]
    v_cndmask_b32 v36, v21, 0, s[64:65]
    v_cndmask_b32 v37, v21, 0, s[66:67]
    v_cndmask_b32 v38, v21, 0, s[68:69]
    v_cndmask_b32 v39, v21, 0, s[70:71]
    v_lshrrev_b32 v40, 2, v252
    v_xor_b32 v40, v40, v252
    v_bfe_u32 v40, v40, 2, 1
    v_add_u32_e64 v40, -1, v40
    v_and_b32 v40, 0x3f803f80, v40
    v_mov_b32 v41, v40
    v_mov_b32 v42, v40
    v_mov_b32 v43, v40
    v_mov_b32 v44, 0
    v_mov_b32 v45, 0
    v_mov_b32 v46, 0
    v_mov_b32 v47, 0
    v_mov_b32 v88, 0
    v_mov_b32 v89, 0
    v_mov_b32 v90, 0
    v_mov_b32 v91, 0
    v_mov_b32 v92, 0
    v_mov_b32 v93, 0
    v_mov_b32 v94, 0
    v_mov_b32 v95, 0
    v_mov_b32 v96, 0
    v_mov_b32 v97, 0
    v_mov_b32 v98, 0
    v_mov_b32 v99, 0
    v_mov_b32 v100, 0
    v_mov_b32 v101, 0
    v_mov_b32 v102, 0
    v_mov_b32 v103, 0
    s_cmp_eq_u32 s100, 2
    s_cbranch_scc1 sk_52
    s_barrier
sk_52:
    s_cmp_gt_u32 s100, 1
    s_cbranch_scc1 l_patch
l_patched:
l_nohalo:
    ds_read_b128 v[4:7], v3
    ds_read_b128 v[8:11], v3 offset:1024
    ds_read_b128 v[112:115], v22 offset:0
    ds_read_b128 v[116:119], v22 offset:1024
    s_waitcnt lgkmcnt(0)
    v_mfma_f32_32x32x16_bf16 v[56:71], v[112:115], v[4:7], v[24:39]
    v_mfma_f32_32x32x16_bf16 v[56:71], v[116:119], v[8:11], v[56:71]
    ds_read_b128 v[104:107], v23 offset:4096
    ds_read_b128 v[124:127], v22 offset:3072
    ds_read_b128 v[108:111], v23 offset:5120
    ds_read_b128 v[120:123], v22 offset:2048
    s_cmp_lg_u32 s26, 0
    s_cbranch_scc1 sk_54
    s_xor_b32 s96, s29, 0
    s_and_b32 s97, s96, 2
    s_and_b32 s96, s96, 3
    s_mul_i32 s97, s97, 14336
    s_mul_i32 s96, s96, 14336
    s_add_u32 s96, s96, s97
    buffer_load_dwordx4 v[156:159], v155, s[80:83], s96 offen
    s_xor_b32 s96, s29, 0
    s_and_b32 s97, s96, 2
    s_and_b32 s96, s96, 3
    s_mul_i32 s97, s97, 14336
    s_mul_i32 s96, s96, 14336
    s_add_u32 s96, s96, s97
    s_add_u32 s96, s96, 7168
    buffer_load_dwordx4 v[160:163], v155, s[80:83], s96 offen
    s_xor_b32 s96, s29, 1
    s_and_b32 s97, s96, 2
    s_and_b32 s96, s96, 3
    s_mul_i32 s97, s97, 14336
    s_mul_i32 s96, s96, 14336
    s_add_u32 s96, s96, s97
    buffer_load_dwordx4 v[164:167], v155, s[80:83], s96 offen
sk_54:
    s_nop 5
    v_max3_f32 v21, v56, v57, v58
    v_max3_f32 v152, v59, v60, v61
    v_max3_f32 v21, v21, v62, v63
    v_max3_f32 v152, v152, v64, v65
    v_max3_f32 v21, v21, v66, v67
    v_max3_f32 v152, v152, v68, v69
    v_max3_f32 v21, v21, v70, v71
    v_max_f32 v21, v21, v152
    v_mov_b32 v152, v21
    s_nop 1
    v_permlane32_swap_b32 v21, v152
    v_max_f32 v21, v21, v152
    v_sub_f32 v24, 0, v21
    v_sub_f32 v25, 0, v21
    v_sub_f32 v26, 0, v21
    v_sub_f32 v27, 0, v21
    v_sub_f32 v28, 0, v21
    v_sub_f32 v29, 0, v21
    v_sub_f32 v30, 0, v21
    v_sub_f32 v31, 0, v21
    v_sub_f32 v32, 0, v21
    v_sub_f32 v33, 0, v21
    v_sub_f32 v34, 0, v21
    v_sub_f32 v35, 0, v21
    v_sub_f32 v36, 0, v21
    v_sub_f32 v37, 0, v21
    v_sub_f32 v38, 0, v21
    v_sub_f32 v39, 0, v21
    s_branch a1_53_go
    s_nop 0
a1_53_mid:
    s_cmp_ge_u32 s76, 8
    s_cselect_b32 s33, 0, -1
    v_not_b32 v12, v12
    v_or_b32 v12, s33, v12
    v_not_b32 v13, v13
    v_or_b32 v13, s33, v13
    v_not_b32 v14, v14
    v_or_b32 v14, s33, v14
    v_not_b32 v15, v15
    v_or_b32 v15, s33, v15
    v_not_b32 v16, v16
    v_or_b32 v16, s33, v16
    v_not_b32 v17, v17
    v_or_b32 v17, s33, v17
    v_not_b32 v18, v18
    v_or_b32 v18, s33, v18
    v_not_b32 v19, v19
    v_or_b32 v19, s33, v19
    s_and_b32 s32, s76, 3
    s_cmp_ge_u32 s76, 8
    s_cselect_b32 s32, s32, 4
    s_sub_u32 s74, 8, s32
    s_lshl_b32 s32, s32, 12
    s_add_u32 s32, s32, 114688
    v_add_u32 v22, s32, v253
    v_add_u32 v23, s32, v253
    s_cmp_eq_u32 s26, 0
    s_cselect_b32 s75, 2, 1
    s_cmp_eq_u32 s100, 1
    s_cbranch_scc1 l_patch
l_pmid:
    s_cmp_eq_u32 s100, 1
    s_cbranch_scc1 sk_55
    s_barrier
sk_55:
    s_waitcnt vmcnt(3)
    s_cmp_eq_u32 s26, 0
    s_cbranch_scc1 sk_56
    s_waitcnt vmcnt(0)
sk_56:
    s_cmp_lg_u32 s100, 1
    s_cbranch_scc1 sk_57
    s_cmp_lg_u32 s38, 0
    s_barrier
    s_cselect_b64 exec, -1, 0
    ds_write_b16 v0, v1
    s_mov_b64 exec, -1
    s_waitcnt lgkmcnt(0)
    s_barrier
sk_57:
    s_cmp_lg_u32 s26, 0
    s_cbranch_scc1 sk_58
    s_xor_b32 s96, s29, 1
    s_and_b32 s97, s96, 2
    s_and_b32 s96, s96, 3
    s_mul_i32 s97, s97, 14336
    s_mul_i32 s96, s96, 14336
    s_add_u32 s96, s96, s97
    s_add_u32 s96, s96, 7168
    buffer_load_dwordx4 v[168:171], v155, s[80:83], s96 offen
    s_xor_b32 s96, s29, 2
    s_and_b32 s97, s96, 2
    s_and_b32 s96, s96, 3
    s_mul_i32 s97, s97, 14336
    s_mul_i32 s96, s96, 14336
    s_add_u32 s96, s96, s97
    buffer_load_dwordx4 v[172:175], v155, s[80:83], s96 offen
    s_xor_b32 s96, s29, 2
    s_and_b32 s97, s96, 2
    s_and_b32 s96, s96, 3
    s_mul_i32 s97, s97, 14336
    s_mul_i32 s96, s96, 14336
    s_add_u32 s96, s96, s97
    s_add_u32 s96, s96, 7168
    buffer_load_dwordx4 v[176:179], v155, s[80:83], s96 offen
    s_xor_b32 s96, s29, 3
    s_and_b32 s97, s96, 2
    s_and_b32 s96, s96, 3
    s_mul_i32 s97, s97, 14336
    s_mul_i32 s96, s96, 14336
    s_add_u32 s96, s96, s97
    buffer_load_dwordx4 v[180:183], v155, s[80:83], s96 offen
    s_xor_b32 s96, s29, 3
    s_and_b32 s97, s96, 2
    s_and_b32 s96, s96, 3
    s_mul_i32 s97, s97, 14336
    s_mul_i32 s96, s96, 14336
    s_add_u32 s96, s96, s97
    s_add_u32 s96, s96, 7168
    buffer_load_dwordx4 v[184:187], v155, s[80:83], s96 offen
sk_58:
    s_barrier
    s_cmp_lt_u32 s76, 4
    s_cbranch_scc1 a1_53_none
    ds_read_b128 v[112:115], v22 offset:0
    ds_read_b128 v[116:119], v22 offset:1024
    ds_read_b128 v[104:107], v23 offset:4096
    ds_read_b128 v[124:127], v22 offset:3072
    ds_read_b128 v[108:111], v23 offset:5120
    ds_read_b128 v[120:123], v22 offset:2048
    s_waitcnt lgkmcnt(4)
a1_53_go:
    s_nop 0
    v_mfma_f32_32x32x16_bf16 v[56:71], v[112:115], v[4:7], v[24:39]
    v_mfma_f32_32x32x16_bf16 v[56:71], v[116:119], v[8:11], v[56:71]
    s_waitcnt lgkmcnt(3)
    v_mfma_f32_32x32x16_bf16 v[72:87], v[104:107], v[4:7], v[24:39]
    ds_read_b128 v[104:107], v23 offset:8192
    s_nop 8
    v_exp_f32 v56, v56
    v_exp_f32 v57, v57
    v_exp_f32_e64 v58, v58
    ds_read_b128 v[128:131], v23 offset:7168
    v_exp_f32 v59, v59
    v_exp_f32 v60, v60
    v_exp_f32 v61, v61
    s_waitcnt lgkmcnt(2)
    v_mfma_f32_32x32x16_bf16 v[72:87], v[108:111], v[8:11], v[72:87]
    ds_read_b128 v[108:111], v23 offset:9216
    v_exp_f32 v62, v62
    v_exp_f32 v63, v63
    v_cvt_pk_bf16_f32 v136, v56, v57
    v_cvt_pk_bf16_f32 v137, v58, v59
    v_cvt_pk_bf16_f32 v138, v60, v61
    v_cvt_pk_bf16_f32 v139, v62, v63
    v_and_b32 v136, v136, v12
    v_and_b32 v137, v137, v13
    v_and_b32 v138, v138, v14
    v_and_b32 v139, v139, v15
    v_exp_f32 v64, v64
    v_exp_f32 v65, v65
    v_mfma_f32_32x32x16_bf16 v[88:103], v[120:123], v[136:139], v[88:103]
    ds_read_b128 v[120:123], v23 offset:6144
    s_cmp_eq_u32 s75, 0
    s_cbranch_scc1 sk_60
    s_cmp_lg_u32 s26, 0
    s_cbranch_scc1 sk_59
    s_xor_b32 s96, s29, 0
    s_and_b32 s97, s96, 2
    s_and_b32 s96, s96, 3
    s_mul_i32 s97, s97, 14336
    s_mul_i32 s96, s96, 14336
    s_add_u32 s96, s96, s97
    buffer_load_dwordx4 v[188:191], v155, s[4:7], s96 offen
    s_xor_b32 s96, s29, 0
    s_and_b32 s97, s96, 2
    s_and_b32 s96, s96, 3
    s_mul_i32 s97, s97, 14336
    s_mul_i32 s96, s96, 14336
    s_add_u32 s96, s96, s97
    s_add_u32 s96, s96, 7168
    buffer_load_dwordx4 v[192:195], v155, s[4:7], s96 offen
sk_59:
sk_60:
    v_exp_f32 v66, v66
    v_exp_f32 v67, v67
    v_exp_f32 v68, v68
    v_exp_f32 v69, v69
    v_mfma_f32_16x16x32_bf16 v[44:47], v[40:43], v[136:139], v[44:47]
    v_exp_f32 v70, v70
    v_exp_f32 v71, v71
    v_cvt_pk_bf16_f32 v140, v64, v65
    v_cvt_pk_bf16_f32 v141, v66, v67
    v_cvt_pk_bf16_f32 v142, v68, v69
    v_cvt_pk_bf16_f32 v143, v70, v71
    v_and_b32 v140, v140, v16
    v_and_b32 v141, v141, v17
    v_and_b32_e64 v142, v142, v18
    v_and_b32 v143, v143, v19
    s_cmp_eq_u32 s75, 0
    s_cbranch_scc1 sk_62
    s_cmp_lg_u32 s26, 0
    s_cbranch_scc1 sk_61
    s_xor_b32 s96, s29, 1
    s_and_b32 s97, s96, 2
    s_and_b32 s96, s96, 3
    s_mul_i32 s97, s97, 14336
    s_mul_i32 s96, s96, 14336
    s_add_u32 s96, s96, s97
    buffer_load_dwordx4 v[196:199], v155, s[4:7], s96 offen
    s_xor_b32 s96, s29, 1
    s_and_b32 s97, s96, 2
    s_and_b32 s96, s96, 3
    s_mul_i32 s97, s97, 14336
    s_mul_i32 s96, s96, 14336
    s_add_u32 s96, s96, s97
    s_add_u32 s96, s96, 7168
    buffer_load_dwordx4 v[200:203], v155, s[4:7], s96 offen
sk_61:
sk_62:
    s_cmp_eq_u32 s74, 1
    s_cbranch_scc1 a1_53_e0
    s_cmp_eq_u32 s74, 2
    s_cbranch_scc1 a1_53_t1
    s_waitcnt lgkmcnt(3)
    v_mfma_f32_32x32x16_bf16 v[56:71], v[104:107], v[4:7], v[24:39]
    ds_read_b128 v[104:107], v23 offset:12288
    v_exp_f32 v72, v72
    v_exp_f32 v73, v73
    v_exp_f32_e64 v74, v74
    v_mfma_f32_32x32x16_bf16 v[88:103], v[124:127], v[140:143], v[88:103]
    ds_read_b128 v[124:127], v23 offset:11264
    v_exp_f32 v75, v75
    v_exp_f32 v76, v76
    v_exp_f32 v77, v77
    s_waitcnt lgkmcnt(2)
    v_mfma_f32_32x32x16_bf16 v[56:71], v[108:111], v[8:11], v[56:71]
    ds_read_b128 v[108:111], v23 offset:13312
    v_exp_f32 v78, v78
    v_exp_f32 v79, v79
    v_cvt_pk_bf16_f32 v136, v72, v73
    v_cvt_pk_bf16_f32 v137, v74, v75
    v_mfma_f32_16x16x32_bf16 v[44:47], v[40:43], v[140:143], v[44:47]
    v_cvt_pk_bf16_f32 v138, v76, v77
    v_cvt_pk_bf16_f32 v139, v78, v79
    v_exp_f32 v80, v80
    v_exp_f32 v81, v81
    v_mfma_f32_32x32x16_bf16 v[88:103], v[120:123], v[136:139], v[88:103]
    ds_read_b128 v[120:123], v23 offset:10240
    s_cmp_eq_u32 s75, 0
    s_cbranch_scc1 sk_64
    s_cmp_lg_u32 s26, 0
    s_cbranch_scc1 sk_63
    s_xor_b32 s96, s29, 2
    s_and_b32 s97, s96, 2
    s_and_b32 s96, s96, 3
    s_mul_i32 s97, s97, 14336
    s_mul_i32 s96, s96, 14336
    s_add_u32 s96, s96, s97
    buffer_load_dwordx4 v[204:207], v155, s[4:7], s96 offen
sk_63:
sk_64:
    v_exp_f32 v82, v82
    v_exp_f32 v83, v83
    v_exp_f32 v84, v84
    v_exp_f32 v85, v85
    v_mfma_f32_16x16x32_bf16 v[44:47], v[40:43], v[136:139], v[44:47]
    v_exp_f32 v86, v86
    v_exp_f32 v87, v87
    v_cvt_pk_bf16_f32 v140, v80, v81
    v_cvt_pk_bf16_f32 v141, v82, v83
    v_cvt_pk_bf16_f32 v142, v84, v85
    v_cvt_pk_bf16_f32 v143, v86, v87
    s_cmp_eq_u32 s75, 0
    s_cbranch_scc1 sk_66
    s_cmp_lg_u32 s26, 0
    s_cbranch_scc1 sk_65
    s_xor_b32 s96, s29, 2
    s_and_b32 s97, s96, 2
    s_and_b32 s96, s96, 3
    s_mul_i32 s97, s97, 14336
    s_mul_i32 s96, s96, 14336
    s_add_u32 s96, s96, s97
    s_add_u32 s96, s96, 7168
    buffer_load_dwordx4 v[208:211], v155, s[4:7], s96 offen
sk_65:
sk_66:
    s_cmp_eq_u32 s74, 3
    s_cbranch_scc1 a1_53_t0
    s_waitcnt lgkmcnt(3)
    v_mfma_f32_32x32x16_bf16 v[72:87], v[104:107], v[4:7], v[24:39]
    ds_read_b128 v[104:107], v23 offset:16384
    v_exp_f32 v56, v56
    v_exp_f32 v57, v57
    v_exp_f32 v58, v58
    v_mfma_f32_32x32x16_bf16 v[88:103], v[128:131], v[140:143], v[88:103]
    ds_read_b128 v[128:131], v23 offset:15360
    v_exp_f32 v59, v59
    v_exp_f32 v60, v60
    v_exp_f32 v61, v61
    s_waitcnt lgkmcnt(2)
    v_mfma_f32_32x32x16_bf16 v[72:87], v[108:111], v[8:11], v[72:87]
    ds_read_b128 v[108:111], v23 offset:17408
    v_exp_f32 v62, v62
    v_exp_f32 v63, v63
    v_cvt_pk_bf16_f32 v136, v56, v57
    v_cvt_pk_bf16_f32 v137, v58, v59
    v_mfma_f32_16x16x32_bf16 v[44:47], v[40:43], v[140:143], v[44:47]
    v_cvt_pk_bf16_f32 v138, v60, v61
    v_cvt_pk_bf16_f32 v139, v62, v63
    v_exp_f32 v64, v64
    v_exp_f32 v65, v65
    v_mfma_f32_32x32x16_bf16 v[88:103], v[120:123], v[136:139], v[88:103]
    ds_read_b128 v[120:123], v23 offset:14336
    s_cmp_eq_u32 s75, 0
    s_cbranch_scc1 sk_68
    s_cmp_lg_u32 s26, 0
    s_cbranch_scc1 sk_67
    s_xor_b32 s96, s29, 3
    s_and_b32 s97, s96, 2
    s_and_b32 s96, s96, 3
    s_mul_i32 s97, s97, 14336
    s_mul_i32 s96, s96, 14336
    s_add_u32 s96, s96, s97
    buffer_load_dwordx4 v[212:215], v155, s[4:7], s96 offen
sk_67:
sk_68:
    v_exp_f32 v66, v66
    v_exp_f32 v67, v67
    v_exp_f32 v68, v68
    v_exp_f32 v69, v69
    v_mfma_f32_16x16x32_bf16 v[44:47], v[40:43], v[136:139], v[44:47]
    v_exp_f32 v70, v70
    v_exp_f32 v71, v71
    v_cvt_pk_bf16_f32 v140, v64, v65
    v_cvt_pk_bf16_f32 v141, v66, v67
    v_cvt_pk_bf16_f32 v142, v68, v69
    v_cvt_pk_bf16_f32 v143, v70, v71
    s_cmp_eq_u32 s75, 0
    s_cbranch_scc1 sk_70
    s_barrier
    s_cmp_lg_u32 s26, 0
    s_cbranch_scc1 sk_69
    s_xor_b32 s96, s29, 3
    s_and_b32 s97, s96, 2
    s_and_b32 s96, s96, 3
    s_mul_i32 s97, s97, 14336
    s_mul_i32 s96, s96, 14336
    s_add_u32 s96, s96, s97
    s_add_u32 s96, s96, 7168
    buffer_load_dwordx4 v[216:219], v155, s[4:7], s96 offen
sk_69:
sk_70:
    s_cmp_eq_u32 s74, 4
    s_cbranch_scc1 a1_53_t1
    s_waitcnt lgkmcnt(3)
    v_mfma_f32_32x32x16_bf16 v[56:71], v[104:107], v[4:7], v[24:39]
    ds_read_b128 v[104:107], v23 offset:20480
    v_exp_f32 v72, v72
    v_exp_f32 v73, v73
    v_exp_f32_e64 v74, v74
    v_mfma_f32_32x32x16_bf16 v[88:103], v[124:127], v[140:143], v[88:103]
    ds_read_b128 v[124:127], v23 offset:19456
    v_exp_f32 v75, v75
    v_exp_f32 v76, v76
    v_exp_f32 v77, v77
    s_waitcnt lgkmcnt(2)
    v_mfma_f32_32x32x16_bf16 v[56:71], v[108:111], v[8:11], v[56:71]
    ds_read_b128 v[108:111], v23 offset:21504
    v_exp_f32 v78, v78
    v_exp_f32 v79, v79
    v_cvt_pk_bf16_f32 v136, v72, v73
    v_cvt_pk_bf16_f32 v137, v74, v75
    v_mfma_f32_16x16x32_bf16 v[44:47], v[40:43], v[140:143], v[44:47]
    v_cvt_pk_bf16_f32 v138, v76, v77
    v_cvt_pk_bf16_f32 v139, v78, v79
    v_exp_f32 v80, v80
    v_exp_f32 v81, v81
    v_mfma_f32_32x32x16_bf16 v[88:103], v[120:123], v[136:139], v[88:103]
    ds_read_b128 v[120:123], v23 offset:18432
    v_exp_f32 v82, v82
    v_exp_f32 v83, v83
    v_exp_f32 v84, v84
    v_exp_f32 v85, v85
    v_mfma_f32_16x16x32_bf16 v[44:47], v[40:43], v[136:139], v[44:47]
    v_exp_f32 v86, v86
    v_exp_f32 v87, v87
    v_cvt_pk_bf16_f32 v140, v80, v81
    v_cvt_pk_bf16_f32 v141, v82, v83
    v_cvt_pk_bf16_f32 v142, v84, v85
    v_cvt_pk_bf16_f32 v143, v86, v87
    s_cmp_eq_u32 s74, 5
    s_cbranch_scc1 a1_53_t0
    s_waitcnt lgkmcnt(3)
    v_mfma_f32_32x32x16_bf16 v[72:87], v[104:107], v[4:7], v[24:39]
    ds_read_b128 v[104:107], v23 offset:24576
    v_exp_f32 v56, v56
    v_exp_f32 v57, v57
    v_exp_f32 v58, v58
    v_mfma_f32_32x32x16_bf16 v[88:103], v[128:131], v[140:143], v[88:103]
    ds_read_b128 v[128:131], v23 offset:23552
    v_exp_f32 v59, v59
    v_exp_f32 v60, v60
    v_exp_f32 v61, v61
    s_waitcnt lgkmcnt(2)
    v_mfma_f32_32x32x16_bf16 v[72:87], v[108:111], v[8:11], v[72:87]
    ds_read_b128 v[108:111], v23 offset:25600
    v_exp_f32 v62, v62
    v_exp_f32 v63, v63
    v_cvt_pk_bf16_f32 v136, v56, v57
    v_cvt_pk_bf16_f32 v137, v58, v59
    v_mfma_f32_16x16x32_bf16 v[44:47], v[40:43], v[140:143], v[44:47]
    v_cvt_pk_bf16_f32 v138, v60, v61
    v_cvt_pk_bf16_f32 v139, v62, v63
    v_exp_f32 v64, v64
    v_exp_f32 v65, v65
    v_mfma_f32_32x32x16_bf16 v[88:103], v[120:123], v[136:139], v[88:103]
    ds_read_b128 v[120:123], v23 offset:22528
    v_exp_f32 v66, v66
    v_exp_f32 v67, v67
    v_exp_f32 v68, v68
    v_exp_f32 v69, v69
    v_mfma_f32_16x16x32_bf16 v[44:47], v[40:43], v[136:139], v[44:47]
    v_exp_f32 v70, v70
    v_exp_f32 v71, v71
    v_cvt_pk_bf16_f32 v140, v64, v65
    v_cvt_pk_bf16_f32 v141, v66, v67
    v_cvt_pk_bf16_f32 v142, v68, v69
    v_cvt_pk_bf16_f32 v143, v70, v71
    s_cmp_eq_u32 s74, 6
    s_cbranch_scc1 a1_53_t1
    s_waitcnt lgkmcnt(3)
    v_mfma_f32_32x32x16_bf16 v[56:71], v[104:107], v[4:7], v[24:39]
    ds_read_b128 v[104:107], v23 offset:28672
    v_exp_f32 v72, v72
    v_exp_f32 v73, v73
    v_exp_f32 v74, v74
    v_mfma_f32_32x32x16_bf16 v[88:103], v[124:127], v[140:143], v[88:103]
    ds_read_b128 v[124:127], v23 offset:27648
    v_exp_f32 v75, v75
    v_exp_f32 v76, v76
    v_exp_f32 v77, v77
    s_waitcnt lgkmcnt(2)
    v_mfma_f32_32x32x16_bf16 v[56:71], v[108:111], v[8:11], v[56:71]
    ds_read_b128 v[108:111], v23 offset:29696
    v_exp_f32 v78, v78
    v_exp_f32 v79, v79
    v_cvt_pk_bf16_f32 v136, v72, v73
    v_cvt_pk_bf16_f32 v137, v74, v75
    v_mfma_f32_16x16x32_bf16 v[44:47], v[40:43], v[140:143], v[44:47]
    v_cvt_pk_bf16_f32 v138, v76, v77
    v_cvt_pk_bf16_f32 v139, v78, v79
    v_exp_f32 v80, v80
    v_exp_f32 v81, v81
    v_mfma_f32_32x32x16_bf16 v[88:103], v[120:123], v[136:139], v[88:103]
    ds_read_b128 v[120:123], v23 offset:26624
    v_exp_f32 v82, v82
    v_exp_f32 v83, v83
    v_exp_f32 v84, v84
    v_exp_f32 v85, v85
    v_mfma_f32_16x16x32_bf16 v[44:47], v[40:43], v[136:139], v[44:47]
    v_exp_f32 v86, v86
    v_exp_f32 v87, v87
    v_cvt_pk_bf16_f32 v140, v80, v81
    v_cvt_pk_bf16_f32 v141, v82, v83
    v_cvt_pk_bf16_f32 v142, v84, v85
    v_cvt_pk_bf16_f32 v143, v86, v87
    s_cmp_eq_u32 s74, 7
    s_cbranch_scc1 a1_53_t0
    s_waitcnt lgkmcnt(3)
    v_mfma_f32_32x32x16_bf16 v[72:87], v[104:107], v[4:7], v[24:39]
    ds_read_b128 v[104:107], v23 offset:24576
    v_exp_f32 v56, v56
    v_exp_f32 v57, v57
    v_exp_f32 v58, v58
    v_mfma_f32_32x32x16_bf16 v[88:103], v[128:131], v[140:143], v[88:103]
    ds_read_b128 v[128:131], v23 offset:31744
    v_exp_f32 v59, v59
    v_exp_f32 v60, v60
    v_exp_f32 v61, v61
    s_waitcnt lgkmcnt(2)
    v_mfma_f32_32x32x16_bf16 v[72:87], v[108:111], v[8:11], v[72:87]
    ds_read_b128 v[108:111], v23 offset:25600
    v_exp_f32 v62, v62
    v_exp_f32 v63, v63
    v_cvt_pk_bf16_f32 v136, v56, v57
    v_cvt_pk_bf16_f32 v137, v58, v59
    v_mfma_f32_16x16x32_bf16 v[44:47], v[40:43], v[140:143], v[44:47]
    v_cvt_pk_bf16_f32 v138, v60, v61
    v_cvt_pk_bf16_f32 v139, v62, v63
    v_exp_f32 v64, v64
    v_exp_f32 v65, v65
    v_mfma_f32_32x32x16_bf16 v[88:103], v[120:123], v[136:139], v[88:103]
    ds_read_b128 v[120:123], v23 offset:30720
    v_exp_f32 v66, v66
    v_exp_f32 v67, v67
    v_exp_f32 v68, v68
    v_exp_f32 v69, v69
    v_mfma_f32_16x16x32_bf16 v[44:47], v[40:43], v[136:139], v[44:47]
    v_exp_f32 v70, v70
    v_exp_f32 v71, v71
    v_cvt_pk_bf16_f32 v140, v64, v65
    v_cvt_pk_bf16_f32 v141, v66, v67
    v_cvt_pk_bf16_f32 v142, v68, v69
    v_cvt_pk_bf16_f32 v143, v70, v71
a1_53_t1:
    v_exp_f32 v72, v72
    v_exp_f32 v73, v73
    v_exp_f32_e64 v74, v74
    v_mfma_f32_32x32x16_bf16 v[88:103], v[124:127], v[140:143], v[88:103]
    v_exp_f32 v75, v75
    v_exp_f32 v76, v76
    v_exp_f32 v77, v77
    v_exp_f32 v78, v78
    v_exp_f32_e64 v79, v79
    v_cvt_pk_bf16_f32 v136, v72, v73
    v_cvt_pk_bf16_f32 v137, v74, v75
    v_mfma_f32_16x16x32_bf16 v[44:47], v[40:43], v[140:143], v[44:47]
    v_cvt_pk_bf16_f32 v138, v76, v77
    v_cvt_pk_bf16_f32 v139, v78, v79
    v_exp_f32_e64 v80, v80
    v_exp_f32 v81, v81
    s_waitcnt lgkmcnt(0)
    v_mfma_f32_32x32x16_bf16 v[88:103], v[120:123], v[136:139], v[88:103]
    v_exp_f32 v82, v82
    v_exp_f32 v83, v83
    v_exp_f32 v84, v84
    v_exp_f32 v85, v85
    v_mfma_f32_16x16x32_bf16 v[44:47], v[40:43], v[136:139], v[44:47]
    v_exp_f32 v86, v86
    v_exp_f32 v87, v87
    v_cvt_pk_bf16_f32 v140, v80, v81
    v_cvt_pk_bf16_f32 v141, v82, v83
    v_cvt_pk_bf16_f32 v142, v84, v85
    v_cvt_pk_bf16_f32 v143, v86, v87
a1_53_e1:
    s_cmp_eq_u32 s75, 0
    s_nop 0
    v_mfma_f32_16x16x32_bf16 v[44:47], v[40:43], v[140:143], v[44:47]
    v_mfma_f32_32x32x16_bf16 v[88:103], v[128:131], v[140:143], v[88:103]
    s_cbranch_scc1 a1_53_mid
    s_branch a1_53_fin
    s_nop 0
a1_53_t0:
    v_exp_f32 v56, v56
    v_exp_f32 v57, v57
    v_exp_f32 v58, v58
    v_mfma_f32_32x32x16_bf16 v[88:103], v[128:131], v[140:143], v[88:103]
    v_exp_f32 v59, v59
    v_exp_f32 v60, v60
    v_exp_f32 v61, v61
    v_exp_f32 v62, v62
    v_exp_f32_e64 v63, v63
    v_cvt_pk_bf16_f32 v136, v56, v57
    v_cvt_pk_bf16_f32 v137, v58, v59
    v_mfma_f32_16x16x32_bf16 v[44:47], v[40:43], v[140:143], v[44:47]
    v_cvt_pk_bf16_f32 v138, v60, v61
    v_cvt_pk_bf16_f32 v139, v62, v63
    v_exp_f32_e64 v64, v64
    v_exp_f32 v65, v65
    s_waitcnt lgkmcnt(0)
    v_mfma_f32_32x32x16_bf16 v[88:103], v[120:123], v[136:139], v[88:103]
    v_exp_f32 v66, v66
    v_exp_f32 v67, v67
    v_exp_f32 v68, v68
    v_exp_f32 v69, v69
    v_mfma_f32_16x16x32_bf16 v[44:47], v[40:43], v[136:139], v[44:47]
    v_exp_f32 v70, v70
    v_exp_f32 v71, v71
    v_cvt_pk_bf16_f32 v140, v64, v65
    v_cvt_pk_bf16_f32 v141, v66, v67
    v_cvt_pk_bf16_f32 v142, v68, v69
    v_cvt_pk_bf16_f32 v143, v70, v71
a1_53_e0:
    s_cmp_eq_u32 s75, 0
    s_nop 0
    v_mfma_f32_16x16x32_bf16 v[44:47], v[40:43], v[140:143], v[44:47]
    v_mfma_f32_32x32x16_bf16 v[88:103], v[124:127], v[140:143], v[88:103]
    s_cbranch_scc1 a1_53_mid
    s_branch a1_53_fin
    s_nop 0
a1_53_none:
    s_cmp_lg_u32 s26, 0
    s_cbranch_scc1 sk_71
    s_xor_b32 s96, s29, 0
    s_and_b32 s97, s96, 2
    s_and_b32 s96, s96, 3
    s_mul_i32 s97, s97, 14336
    s_mul_i32 s96, s96, 14336
    s_add_u32 s96, s96, s97
    buffer_load_dwordx4 v[188:191], v155, s[4:7], s96 offen
    s_xor_b32 s96, s29, 0
    s_and_b32 s97, s96, 2
    s_and_b32 s96, s96, 3
    s_mul_i32 s97, s97, 14336
    s_mul_i32 s96, s96, 14336
    s_add_u32 s96, s96, s97
    s_add_u32 s96, s96, 7168
    buffer_load_dwordx4 v[192:195], v155, s[4:7], s96 offen
sk_71:
    s_cmp_lg_u32 s26, 0
    s_cbranch_scc1 sk_72
    s_xor_b32 s96, s29, 1
    s_and_b32 s97, s96, 2
    s_and_b32 s96, s96, 3
    s_mul_i32 s97, s97, 14336
    s_mul_i32 s96, s96, 14336
    s_add_u32 s96, s96, s97
    buffer_load_dwordx4 v[196:199], v155, s[4:7], s96 offen
    s_xor_b32 s96, s29, 1
    s_and_b32 s97, s96, 2
    s_and_b32 s96, s96, 3
    s_mul_i32 s97, s97, 14336
    s_mul_i32 s96, s96, 14336
    s_add_u32 s96, s96, s97
    s_add_u32 s96, s96, 7168
    buffer_load_dwordx4 v[200:203], v155, s[4:7], s96 offen
sk_72:
    s_cmp_lg_u32 s26, 0
    s_cbranch_scc1 sk_73
    s_xor_b32 s96, s29, 2
    s_and_b32 s97, s96, 2
    s_and_b32 s96, s96, 3
    s_mul_i32 s97, s97, 14336
    s_mul_i32 s96, s96, 14336
    s_add_u32 s96, s96, s97
    buffer_load_dwordx4 v[204:207], v155, s[4:7], s96 offen
sk_73:
    s_cmp_lg_u32 s26, 0
    s_cbranch_scc1 sk_74
    s_xor_b32 s96, s29, 2
    s_and_b32 s97, s96, 2
    s_and_b32 s96, s96, 3
    s_mul_i32 s97, s97, 14336
    s_mul_i32 s96, s96, 14336
    s_add_u32 s96, s96, s97
    s_add_u32 s96, s96, 7168
    buffer_load_dwordx4 v[208:211], v155, s[4:7], s96 offen
sk_74:
    s_cmp_lg_u32 s26, 0
    s_cbranch_scc1 sk_75
    s_xor_b32 s96, s29, 3
    s_and_b32 s97, s96, 2
    s_and_b32 s96, s96, 3
    s_mul_i32 s97, s97, 14336
    s_mul_i32 s96, s96, 14336
    s_add_u32 s96, s96, s97
    buffer_load_dwordx4 v[212:215], v155, s[4:7], s96 offen
sk_75:
    s_barrier
    s_cmp_lg_u32 s26, 0
    s_cbranch_scc1 sk_76
    s_xor_b32 s96, s29, 3
    s_and_b32 s97, s96, 2
    s_and_b32 s96, s96, 3
    s_mul_i32 s97, s97, 14336
    s_mul_i32 s96, s96, 14336
    s_add_u32 s96, s96, s97
    s_add_u32 s96, s96, 7168
    buffer_load_dwordx4 v[216:219], v155, s[4:7], s96 offen
sk_76:
a1_53_fin:
    s_lshl_b32 s36, s76, 16
    s_add_u32 s36, s36, 0x808000
    s_lshl_b32 s33, s25, 11
    s_add_u32 s33, s33, s36
    s_lshl_b32 s30, s24, 9
    s_and_b32 s31, s76, 3
    s_lshl_b32 s31, s31, 6
    s_add_u32 s30, s30, s31
    s_add_u32 s30, s30, s26
    s_add_u32 s30, s30, 0xdd2100
    s_lshl_b32 s31, s25, 2
    s_add_u32 s31, s31, s30
    v_cmp_ngt_f32 vcc, 0x5d800000, v44
    v_rcp_f32_e64 v22, v44
    s_cbranch_vccnz att_exact1
att_ret1:
    s_nop 3
    v_pk_mul_f32 v[88:89], v[88:89], v[22:23] op_sel_hi:[1,0]
    v_pk_mul_f32 v[90:91], v[90:91], v[22:23] op_sel_hi:[1,0]
    v_pk_mul_f32 v[92:93], v[92:93], v[22:23] op_sel_hi:[1,0]
    v_pk_mul_f32 v[94:95], v[94:95], v[22:23] op_sel_hi:[1,0]
    v_pk_mul_f32 v[96:97], v[96:97], v[22:23] op_sel_hi:[1,0]
    v_pk_mul_f32 v[98:99], v[98:99], v[22:23] op_sel_hi:[1,0]
    v_pk_mul_f32 v[100:101], v[100:101], v[22:23] op_sel_hi:[1,0]
    v_pk_mul_f32 v[102:103], v[102:103], v[22:23] op_sel_hi:[1,0]
    v_cvt_pk_bf16_f32 v88, v88, v89
    v_cvt_pk_bf16_f32 v89, v90, v91
    v_cvt_pk_bf16_f32 v90, v92, v93
    v_cvt_pk_bf16_f32 v91, v94, v95
    v_cvt_pk_bf16_f32 v92, v96, v97
    v_cvt_pk_bf16_f32 v93, v98, v99
    v_cvt_pk_bf16_f32 v94, v100, v101
    v_cvt_pk_bf16_f32 v95, v102, v103
    s_cmp_lg_u32 s77, 0
    s_cbranch_scc1 lc_77
    buffer_store_dwordx4 v[88:91], v253, s[20:23], s33 offen sc1
    buffer_store_dwordx4 v[92:95], v253, s[20:23], s33 offen offset:1024 sc1
    s_branch lc_78
    s_nop 0
lc_77:
    buffer_store_dwordx4 v[88:91], v253, s[20:23], s33 offen
    buffer_store_dwordx4 v[92:95], v253, s[20:23], s33 offen offset:1024
lc_78:
    v_mov_b32_e64 v154, s88
    s_mov_b64 exec, 1
    s_waitcnt vmcnt(0)
    s_cmp_lg_u32 s77, 0
    s_cbranch_scc1 lc_79
    buffer_store_dword v154, v253, s[20:23], s31 offen sc1
    s_branch lc_80
    s_nop 0
lc_79:
    buffer_store_dword v154, v253, s[20:23], s31 offen
lc_80:
    s_mov_b64 exec, -1
    s_cmp_lg_u32 s26, 0
    s_cbranch_scc1 sk_81
    s_mov_b32 s96, 0
    buffer_load_dwordx4 v[220:223], v153, s[12:15], s96 offen
    s_mov_b32 s96, 2048
    buffer_load_dwordx4 v[224:227], v153, s[12:15], s96 offen
    s_mov_b32 s96, 4096
    buffer_load_dwordx4 v[228:231], v153, s[12:15], s96 offen
    s_mov_b32 s96, 6144
    buffer_load_dwordx4 v[232:235], v153, s[12:15], s96 offen
    s_mov_b32 s96, 8192
    buffer_load_dwordx4 v[236:239], v153, s[12:15], s96 offen
    s_mov_b32 s96, 10240
    buffer_load_dwordx4 v[240:243], v153, s[12:15], s96 offen
    s_mov_b32 s96, 12288
    buffer_load_dwordx4 v[244:247], v153, s[12:15], s96 offen
    s_mov_b32 s96, 14336
    buffer_load_dwordx4 v[248:251], v153, s[12:15], s96 offen
sk_81:
    v_bfe_u32 v20, v252, 3, 2
    v_lshrrev_b32_e64 v21, 5, v252
    v_lshl_add_u32 v20, v21, 3, v20
    s_lshr_b32 s32, s28, 1
    s_lshl_b32 s32, s32, 4
    s_and_b32 s33, s28, 1
    s_lshl_b32 s33, s33, 2
    s_add_u32 s32, s32, s33
    v_add_u32 v20, s32, v20
    v_lshlrev_b32 v20, 11, v20
    v_lshrrev_b32 v21, 2, v252
    v_and_b32 v21, 4, v21
    v_xor_b32 v21, v21, v252
    v_and_b32 v21, 7, v21
    v_lshl_add_u32 v20, v21, 4, v20
    s_lshl_b32 s32, s98, 7
    v_add_u32 v14, s32, v20
    s_lshl_b32 s32, s28, 9
    s_sub_u32 s34, s29, 224
    s_lshl_b32 s34, s34, 2
    s_mul_i32 s35, s28, 2
    s_and_b32 s33, s35, 3
    s_add_u32 s34, s34, s33
    s_cmp_lt_u32 s35, 4
    s_cselect_b32 s89, s34, -1
    v_and_b32 v23, 1, v252
    v_add_u32 v23, s34, v23
    v_lshrrev_b32_e64 v22, 5, v252
    v_and_or_b32 v23, v23, -2, v22
    v_lshrrev_b32_e64 v22, 1, v252
    s_cmp_lt_u32 s29, 224
    s_cselect_b32 s32, s32, 0
    s_cselect_b64 vcc, -1, 0
    v_cndmask_b32_e64 v22, v23, v22, vcc
    v_lshl_add_u32 v22, v22, 4, s32
    s_mov_b32 s79, s26
    s_cmp_lg_u32 s26, 0
    s_cbranch_scc1 sk_82
    s_waitcnt vmcnt(0)
    s_getpc_b64 s[32:33]
pc_83:
    s_sub_u32 s32, s32, pc_83-interleave_layers__sliding_block__moe_arch_mod__prompt_kernel
    s_subb_u32 s33, s33, 0
    s_lshr_b32 s34, s2, 3
    s_lshl_b32 s34, s34, 2
    s_add_u32 s34, s34, s28
    s_and_b32 s34, s34, 127
    s_lshl_b32 s34, s34, 7
    v_lshl_add_u32 v19, v252, 14, s34
    s_mov_b32 s34, k_exit-interleave_layers__sliding_block__moe_arch_mod__prompt_kernel
    s_mov_b32 s35, 0x20000
    buffer_load_dword v19, v19, s[32:35], 0 offen
    s_lshr_b32 s30, s16, 7
    s_sub_u32 s30, 3, s30
    s_and_b32 s30, s30, 7
    s_and_b32 s31, s24, 1
    s_lshl_b32 s31, s31, 3
    s_add_u32 s30, s30, s31
    s_and_b32 s31, s24, 14
    s_add_u32 s35, s31, s30
    s_lshl_b32 s31, s25, 2
    s_add_u32 s31, s31, s28
    s_mul_i32 s31, s31, 6144
    s_lshl_b32 s30, s30, 7
    s_add_u32 s30, s30, s31
    v_min_u32_e64 v18, 2, v252
    v_lshl_add_u32 v18, v18, 11, s30
    s_add_u32 s30, s35, 14
    s_and_b32 s30, s30, 15
    s_mul_i32 s30, s30, 393216
    buffer_load_dword v19, v18, s[16:19], s30 offen
    s_add_u32 s30, s35, 15
    s_and_b32 s30, s30, 15
    s_mul_i32 s30, s30, 393216
    buffer_load_dword v19, v18, s[16:19], s30 offen
    s_add_u32 s30, s35, 0
    s_and_b32 s30, s30, 15
    s_mul_i32 s30, s30, 393216
    buffer_load_dword v19, v18, s[16:19], s30 offen
    s_add_u32 s30, s35, 1
    s_and_b32 s30, s30, 15
    s_mul_i32 s30, s30, 393216
    buffer_load_dword v19, v18, s[16:19], s30 offen
    s_add_u32 s30, s35, 2
    s_and_b32 s30, s30, 15
    s_mul_i32 s30, s30, 393216
    buffer_load_dword v19, v18, s[16:19], s30 offen
    s_add_u32 s30, s35, 3
    s_and_b32 s30, s30, 15
    s_mul_i32 s30, s30, 393216
    buffer_load_dword v19, v18, s[16:19], s30 offen
    s_mov_b32 s30, 0x05040100
    s_mov_b32 s31, 0x07060302
    v_perm_b32 v155, v160, v156, s30
    v_perm_b32 v160, v160, v156, s31
    v_perm_b32 v156, v161, v157, s30
    v_perm_b32 v161, v161, v157, s31
    v_perm_b32 v157, v162, v158, s30
    v_perm_b32 v162, v162, v158, s31
    v_perm_b32 v158, v163, v159, s30
    v_perm_b32 v163, v163, v159, s31
    v_perm_b32 v159, v168, v164, s30
    v_perm_b32 v168, v168, v164, s31
    v_perm_b32 v164, v169, v165, s30
    v_perm_b32 v169, v169, v165, s31
    v_perm_b32 v165, v170, v166, s30
    v_perm_b32 v170, v170, v166, s31
    v_perm_b32 v166, v171, v167, s30
    v_perm_b32 v171, v171, v167, s31
    v_perm_b32 v167, v176, v172, s30
    v_perm_b32 v176, v176, v172, s31
    v_perm_b32 v172, v177, v173, s30
    v_perm_b32 v177, v177, v173, s31
    v_perm_b32 v173, v178, v174, s30
    v_perm_b32 v178, v178, v174, s31
    v_perm_b32 v174, v179, v175, s30
    v_perm_b32 v179, v179, v175, s31
    v_perm_b32 v175, v184, v180, s30
    v_perm_b32 v184, v184, v180, s31
    v_perm_b32 v180, v185, v181, s30
    v_perm_b32 v185, v185, v181, s31
    v_perm_b32 v181, v186, v182, s30
    v_perm_b32 v186, v186, v182, s31
    v_perm_b32 v182, v187, v183, s30
    v_perm_b32 v187, v187, v183, s31
    v_perm_b32 v183, v192, v188, s30
    v_perm_b32 v192, v192, v188, s31
    v_perm_b32 v188, v193, v189, s30
    v_perm_b32 v193, v193, v189, s31
    v_perm_b32 v189, v194, v190, s30
    v_perm_b32 v194, v194, v190, s31
    v_perm_b32 v190, v195, v191, s30
    v_perm_b32 v195, v195, v191, s31
    v_perm_b32 v191, v200, v196, s30
    v_perm_b32 v200, v200, v196, s31
    v_perm_b32 v196, v201, v197, s30
    v_perm_b32 v201, v201, v197, s31
    v_perm_b32 v197, v202, v198, s30
    v_perm_b32 v202, v202, v198, s31
    v_perm_b32 v198, v203, v199, s30
    v_perm_b32 v203, v203, v199, s31
    v_perm_b32 v199, v208, v204, s30
    v_perm_b32 v208, v208, v204, s31
    v_perm_b32 v204, v209, v205, s30
    v_perm_b32 v209, v209, v205, s31
    v_perm_b32 v205, v210, v206, s30
    v_perm_b32 v210, v210, v206, s31
    v_perm_b32 v206, v211, v207, s30
    v_perm_b32 v211, v211, v207, s31
    v_perm_b32 v207, v216, v212, s30
    v_perm_b32 v216, v216, v212, s31
    v_perm_b32 v212, v217, v213, s30
    v_perm_b32 v217, v217, v213, s31
    v_perm_b32 v213, v218, v214, s30
    v_perm_b32 v218, v218, v214, s31
    v_perm_b32 v214, v219, v215, s30
    v_perm_b32 v219, v219, v215, s31
    v_perm_b32 v215, v224, v220, s30
    v_perm_b32 v224, v224, v220, s31
    v_perm_b32 v220, v225, v221, s30
    v_perm_b32 v225, v225, v221, s31
    v_perm_b32 v221, v226, v222, s30
    v_perm_b32 v226, v226, v222, s31
    v_perm_b32 v222, v227, v223, s30
    v_perm_b32 v227, v227, v223, s31
    v_perm_b32 v223, v232, v228, s30
    v_perm_b32 v232, v232, v228, s31
    v_perm_b32 v228, v233, v229, s30
    v_perm_b32 v233, v233, v229, s31
    v_perm_b32 v229, v234, v230, s30
    v_perm_b32 v234, v234, v230, s31
    v_perm_b32 v230, v235, v231, s30
    v_perm_b32 v235, v235, v231, s31
    v_perm_b32 v231, v240, v236, s30
    v_perm_b32 v240, v240, v236, s31
    v_perm_b32 v236, v241, v237, s30
    v_perm_b32 v241, v241, v237, s31
    v_perm_b32 v237, v242, v238, s30
    v_perm_b32 v242, v242, v238, s31
    v_perm_b32 v238, v243, v239, s30
    v_perm_b32 v243, v243, v239, s31
    v_perm_b32 v239, v248, v244, s30
    v_perm_b32 v248, v248, v244, s31
    v_perm_b32 v244, v249, v245, s30
    v_perm_b32 v249, v249, v245, s31
    v_perm_b32 v245, v250, v246, s30
    v_perm_b32 v250, v250, v246, s31
    v_perm_b32 v246, v251, v247, s30
    v_perm_b32 v251, v251, v247, s31
    v_lshrrev_b32_e64 v21, 3, v252
    s_lshl_b32 s84, s24, 18
    s_add_u32 s84, s84, s86
    s_add_u32 s84, s84, 0x2000000
    v_mul_u32_u24 v20, 6144, v21
    v_and_b32 v21, 6, v21
    v_xor_b32 v21, v21, v252
    v_and_b32 v21, 7, v21
    v_lshl_add_u32 v20, v21, 4, v20
    s_mul_i32 s32, s28, 3
    s_bfe_u32 s33, s32, 0x10001
    s_mul_i32 s33, s33, 196608
    s_and_b32 s34, s32, 1
    s_mul_i32 s34, s34, 49152
    s_add_u32 s33, s33, s34
    s_lshr_b32 s34, s32, 2
    s_lshl_b32 s34, s34, 11
    s_add_u32 s33, s33, s34
    v_add_u32 v8, s33, v20
    v_add_u32 v9, 97280, v8
    s_add_u32 s32, s32, 1
    s_bfe_u32 s33, s32, 0x10001
    s_mul_i32 s33, s33, 196608
    s_and_b32 s34, s32, 1
    s_mul_i32 s34, s34, 49152
    s_add_u32 s33, s33, s34
    s_lshr_b32 s34, s32, 2
    s_lshl_b32 s34, s34, 11
    s_add_u32 s33, s33, s34
    s_sub_u32 s33, s33, 2048
    v_add_u32 v10, s33, v20
    v_add_u32 v11, 97280, v10
    s_add_u32 s32, s32, 1
    s_bfe_u32 s33, s32, 0x10001
    s_mul_i32 s33, s33, 196608
    s_and_b32 s34, s32, 1
    s_mul_i32 s34, s34, 49152
    s_add_u32 s33, s33, s34
    s_lshr_b32 s34, s32, 2
    s_lshl_b32 s34, s34, 11
    s_add_u32 s33, s33, s34
    v_add_u32 v12, s33, v20
    v_add_u32 v13, 97280, v12
    s_sub_u32 s30, s95, 1
    s_sub_u32 s95, s94, 3
    s_mov_b32 s94, s30
    v_bfe_u32 v116, v252, 4, 1
    v_lshlrev_b32 v116, 11, v116
    v_lshrrev_b32_e64 v117, 5, v252
    v_lshl_add_u32 v116, v117, 8, v116
    v_and_b32 v117, 15, v252
    v_lshl_add_u32 v116, v117, 4, v116
    s_lshl_b32 s34, s28, 12
    s_add_u32 s34, s34, 147456
    v_add_u32 v117, s34, v116
    v_and_b32 v16, 15, v252
    v_lshlrev_b32_e64 v16, 9, v16
sk_82:
    s_barrier
    s_add_u32 s96, s25, 12
    s_and_b32 s96, s96, 15
    s_lshl_b32 s96, s96, 17
    s_add_u32 s96, s96, 65536
    s_add_u32 m0, s101, 114688
    s_nop 0
    buffer_load_dwordx4 v14, s[8:11], s96 offen lds
    s_add_u32 s96, s25, 13
    s_and_b32 s96, s96, 15
    s_lshl_b32 s96, s96, 17
    s_add_u32 s96, s96, 65536
    s_add_u32 m0, s101, 118784
    s_nop 0
    buffer_load_dwordx4 v14, s[8:11], s96 offen lds
    s_add_u32 s96, s25, 14
    s_and_b32 s96, s96, 15
    s_lshl_b32 s96, s96, 17
    s_add_u32 s96, s96, 65536
    s_add_u32 m0, s101, 122880
    s_nop 0
    buffer_load_dwordx4 v14, s[8:11], s96 offen lds
    s_add_u32 s96, s25, 15
    s_and_b32 s96, s96, 15
    s_lshl_b32 s96, s96, 17
    s_add_u32 s96, s96, 65536
    s_add_u32 m0, s101, 126976
    s_nop 0
    buffer_load_dwordx4 v14, s[8:11], s96 offen lds
    s_waitcnt vmcnt(0) lgkmcnt(0)
    s_barrier
    s_cmp_lg_u32 s26, 0
    s_cbranch_scc1 l_tail
    s_mov_b32 s26, 16777216
    s_mov_b32 s36, 0
    s_add_u32 s96, s94, 0
    s_and_b32 s96, s96, 15
    s_mul_i32 s96, s96, 393216
    s_add_u32 s96, s96, s85
    s_add_u32 m0, s87, 40960
    s_nop 0
    buffer_load_dwordx4 v8, s[16:19], s96 offen offset:0 lds
    buffer_load_dwordx4 v9, s[16:19], s96 offen offset:1024 lds
    buffer_load_dwordx4 v10, s[16:19], s96 offen offset:2048 lds
    buffer_load_dwordx4 v11, s[16:19], s96 offen offset:3072 lds
    s_add_u32 m0, s87, 45056
    s_nop 0
    buffer_load_dwordx4 v12, s[16:19], s96 offen offset:0 lds
    buffer_load_dwordx4 v13, s[16:19], s96 offen offset:1024 lds
    s_add_u32 s96, s95, 1
    s_and_b32 s96, s96, 15
    s_mul_i32 s96, s96, 393216
    s_add_u32 s96, s96, s85
    s_add_u32 m0, s87, 65536
    s_nop 0
    buffer_load_dwordx4 v8, s[16:19], s96 offen offset:0 lds
    buffer_load_dwordx4 v9, s[16:19], s96 offen offset:1024 lds
    buffer_load_dwordx4 v10, s[16:19], s96 offen offset:2048 lds
    buffer_load_dwordx4 v11, s[16:19], s96 offen offset:3072 lds
    s_add_u32 m0, s87, 69632
    s_nop 0
    buffer_load_dwordx4 v12, s[16:19], s96 offen offset:0 lds
    buffer_load_dwordx4 v13, s[16:19], s96 offen offset:1024 lds
    s_add_u32 s96, s95, 1
    s_and_b32 s96, s96, 15
    s_lshl_b32 s37, 1, s96
    s_lshl_b32 s38, 1, s98
    s_or_b32 s38, s38, s37
    s_lshl_b32 s30, s99, 13
    s_add_u32 s30, s30, 0xc00000
    s_mov_b32 s78, s27
pl_84:
    buffer_load_dword v17, v16, s[20:23], s30 offen sc1
    s_waitcnt vmcnt(0)
pc_85:
    v_cmp_ne_u32 vcc, -1, v17
    s_and_b32 s36, vcc_lo, s38
    s_cselect_b64 vcc, 0, -1
    s_cbranch_vccz pd_86
    s_sub_u32 s78, s78, 1
    s_cmp_lg_u32 s78, 0
    s_cbranch_scc1 pl_84
    s_mov_b32 s27, 1
pd_86:
    s_and_b32 s36, s36, s37
    s_cmp_eq_u32 s36, 0
    s_cbranch_scc1 sk_87
    s_add_u32 s96, s95, 1
    s_and_b32 s96, s96, 15
    s_lshl_b32 s97, s96, 14
    s_add_u32 s97, s97, s84
    s_add_u32 m0, s86, 131072
    s_nop 0
    buffer_load_dwordx4 v253, s[20:23], s97 offen offset:0 sc1 lds
    buffer_load_dwordx4 v253, s[20:23], s97 offen offset:1024 sc1 lds
    buffer_load_dwordx4 v253, s[20:23], s97 offen offset:2048 sc1 lds
    buffer_load_dwordx4 v253, s[20:23], s97 offen offset:3072 sc1 lds
sk_87:
    s_barrier
    s_lshl_b32 s30, s99, 13
    s_add_u32 s30, s30, 0xc00000
    s_add_u32 s31, s30, 4096
    buffer_load_dwordx4 v[64:67], v253, s[20:23], s30 offen offset:0 sc1
    buffer_load_dwordx4 v[68:71], v253, s[20:23], s30 offen offset:1024 sc1
    buffer_load_dwordx4 v[72:75], v253, s[20:23], s30 offen offset:2048 sc1
    buffer_load_dwordx4 v[76:79], v253, s[20:23], s30 offen offset:3072 sc1
    buffer_load_dwordx4 v[80:83], v253, s[20:23], s31 offen offset:0 sc1
    buffer_load_dwordx4 v[84:87], v253, s[20:23], s31 offen offset:1024 sc1
    buffer_load_dwordx4 v[88:91], v253, s[20:23], s31 offen offset:2048 sc1
    buffer_load_dwordx4 v[92:95], v253, s[20:23], s31 offen offset:3072 sc1
    s_add_u32 s96, s94, 2
    s_and_b32 s96, s96, 15
    s_mul_i32 s96, s96, 393216
    s_add_u32 s96, s96, s85
    s_add_u32 m0, s87, 90112
    s_nop 0
    buffer_load_dwordx4 v8, s[16:19], s96 offen offset:0 lds
    buffer_load_dwordx4 v9, s[16:19], s96 offen offset:1024 lds
    buffer_load_dwordx4 v10, s[16:19], s96 offen offset:2048 lds
    buffer_load_dwordx4 v11, s[16:19], s96 offen offset:3072 lds
    s_add_u32 m0, s87, 94208
    s_nop 0
    buffer_load_dwordx4 v12, s[16:19], s96 offen offset:0 lds
    buffer_load_dwordx4 v13, s[16:19], s96 offen offset:1024 lds
    ds_read_b128 v[32:35], v117 offset:0
    ds_read_b128 v[36:39], v117 offset:512
    ds_read_b128 v[40:43], v117 offset:1024
    ds_read_b128 v[44:47], v117 offset:1536
    s_mov_b32 s78, s27
    s_waitcnt vmcnt(6)
    s_branch pc_89
    s_nop 0
pl_88:
    s_lshl_b32 s30, s99, 13
    s_add_u32 s30, s30, 0xc00000
    s_add_u32 s31, s30, 4096
    buffer_load_dwordx4 v[64:67], v253, s[20:23], s30 offen offset:0 sc1
    buffer_load_dwordx4 v[68:71], v253, s[20:23], s30 offen offset:1024 sc1
    buffer_load_dwordx4 v[72:75], v253, s[20:23], s30 offen offset:2048 sc1
    buffer_load_dwordx4 v[76:79], v253, s[20:23], s30 offen offset:3072 sc1
    buffer_load_dwordx4 v[80:83], v253, s[20:23], s31 offen offset:0 sc1
    buffer_load_dwordx4 v[84:87], v253, s[20:23], s31 offen offset:1024 sc1
    buffer_load_dwordx4 v[88:91], v253, s[20:23], s31 offen offset:2048 sc1
    buffer_load_dwordx4 v[92:95], v253, s[20:23], s31 offen offset:3072 sc1
    s_waitcnt vmcnt(0)
pc_89:
    v_max3_u32 v48, v64, v68, v72
    v_max3_u32 v48, v48, v76, v80
    v_max3_u32 v48, v48, v84, v88
    v_max_u32 v48, v48, v92
    v_cmp_eq_u32_e64 vcc, -1, v48
    s_cbranch_vccz pd_90
    s_sub_u32 s78, s78, 1
    s_cmp_lg_u32 s78, 0
    s_cbranch_scc1 pl_88
    s_mov_b32 s27, 1
pd_90:
    s_cmp_lg_u32 s36, 0
    s_cbranch_scc1 sk_91
    s_add_u32 s96, s95, 1
    s_and_b32 s96, s96, 15
    s_lshl_b32 s97, s96, 14
    s_add_u32 s97, s97, s84
    s_add_u32 m0, s86, 131072
    s_nop 0
    buffer_load_dwordx4 v253, s[20:23], s97 offen offset:0 sc1 lds
    buffer_load_dwordx4 v253, s[20:23], s97 offen offset:1024 sc1 lds
    buffer_load_dwordx4 v253, s[20:23], s97 offen offset:2048 sc1 lds
    buffer_load_dwordx4 v253, s[20:23], s97 offen offset:3072 sc1 lds
sk_91:
    s_add_u32 s96, s94, 2
    s_and_b32 s96, s96, 15
    s_lshl_b32 s97, s96, 14
    s_add_u32 s97, s97, s84
    s_add_u32 m0, s86, 114688
    s_nop 0
    buffer_load_dwordx4 v253, s[20:23], s97 offen offset:0 sc1 lds
    v_add_f32 v64, v64, v68
    v_add_f32 v65, v65, v69
    v_add_f32 v66, v66, v70
    v_add_f32 v67, v67, v71
    v_add_f32 v64, v64, v72
    v_add_f32 v65, v65, v73
    v_add_f32 v66, v66, v74
    v_add_f32 v67, v67, v75
    v_add_f32 v64, v64, v76
    v_add_f32 v65, v65, v77
    v_add_f32 v66, v66, v78
    v_add_f32 v67, v67, v79
    v_add_f32 v64, v64, v80
    v_add_f32 v65, v65, v81
    v_add_f32 v66, v66, v82
    v_add_f32 v67, v67, v83
    v_add_f32 v64, v64, v84
    v_add_f32 v65, v65, v85
    v_add_f32 v66, v66, v86
    v_add_f32 v67, v67, v87
    v_add_f32 v64, v64, v88
    v_add_f32 v65, v65, v89
    v_add_f32 v66, v66, v90
    v_add_f32 v67, v67, v91
    v_add_f32 v64, v64, v92
    v_add_f32_e64 v65, v65, v93
    buffer_load_dwordx4 v253, s[20:23], s97 offen offset:1024 sc1 lds
    v_add_f32 v66, v66, v94
    v_add_f32 v67, v67, v95
    v_mov_b32 v48, v64
    v_mov_b32 v49, v65
    v_mov_b32 v50, v66
    v_mov_b32 v51, v67
    v_permlane32_swap_b32 v64, v48
    v_permlane32_swap_b32 v65, v49
    v_permlane32_swap_b32 v66, v50
    v_permlane32_swap_b32 v67, v51
    v_add_f32 v64, v64, v48
    v_add_f32 v65, v65, v49
    v_add_f32 v66, v66, v50
    v_add_f32 v67, v67, v51
    v_mul_f32 v54, 0x3a800000, v64
    v_mul_f32 v65, 0x3a800000, v65
    v_fma_f32 v65, -v54, v54, v65
    v_max_f32_e64 v65, 0, v65
    v_add_f32 v55, 0x3727c5ac, v65
    v_rsq_f32 v55, v55
    s_waitcnt lgkmcnt(0)
    v_fma_f32 v52, -v54, v67, v66
    v_and_b32_e64 v53, 31, v252
    v_mul_f32 v52, v52, v55
    s_lshl_b32 s32, s99, 5
    buffer_load_dwordx4 v253, s[20:23], s97 offen offset:2048 sc1 lds
    v_add_u32 v53, s32, v53
    v_mov_b32 v48, v52
    s_nop 1
    v_max_f32_dpp v48, v48, v48 quad_perm:[1,0,3,2] row_mask:0xf bank_mask:0xf
    s_nop 1
    v_max_f32_dpp v48, v48, v48 quad_perm:[2,3,0,1] row_mask:0xf bank_mask:0xf
    s_nop 1
    v_max_f32_dpp v48, v48, v48 row_half_mirror row_mask:0xf bank_mask:0xf
    s_nop 1
    v_max_f32_dpp v48, v48, v48 row_mirror row_mask:0xf bank_mask:0xf
    v_mov_b32 v49, v48
    s_nop 1
    v_permlane16_swap_b32 v48, v49
    v_max_f32 v48, v48, v49
    v_cmp_eq_f32 vcc, v48, v52
    v_lshrrev_b32 v50, 5, v252
    v_lshlrev_b32_e64 v50, 4, v50
    s_lshr_b32 s34, s25, 3
    v_lshl_add_u32 v51, s34, 28, v50
    s_lshl_b32 s32, s99, 11
    s_lshl_b32 s33, s98, 7
    s_add_u32 s32, s32, s33
    s_add_u32 s32, s32, 0xd60000
    s_and_b32 s34, s25, 7
    s_lshl_b32 s34, s34, 6
    s_add_u32 s34, s34, s99
    s_mul_i32 s34, s34, 32
    s_add_u32 s34, s34, 0xdc0000
    s_ff1_i32_b32 s35, vcc_lo
    s_lshl_b32 s35, 1, s35
    buffer_load_dwordx4 v253, s[20:23], s97 offen offset:3072 sc1 lds
    s_mov_b32 exec_lo, s35
    s_mov_b32 exec_hi, s35
    buffer_store_dwordx4 v[52:55], v51, s[20:23], s34 offen sc1
    buffer_store_dwordx4 v[32:35], v50, s[20:23], s32 offen offset:0 sc1
    buffer_store_dwordx4 v[36:39], v50, s[20:23], s32 offen offset:32 sc1
    buffer_store_dwordx4 v[40:43], v50, s[20:23], s32 offen offset:64 sc1
    buffer_store_dwordx4 v[44:47], v50, s[20:23], s32 offen offset:96 sc1
    s_mov_b64 exec, -1
    s_waitcnt vmcnt(9) lgkmcnt(0)
    s_barrier
    s_add_u32 s96, s95, 3
    s_and_b32 s96, s96, 15
    s_lshl_b32 s97, s96, 14
    s_add_u32 s97, s97, s84
    s_add_u32 m0, s86, 147456
    s_nop 0
    buffer_load_dwordx4 v253, s[20:23], s97 offen offset:0 sc1 lds
    buffer_load_dwordx4 v253, s[20:23], s97 offen offset:1024 sc1 lds
    buffer_load_dwordx4 v253, s[20:23], s97 offen offset:2048 sc1 lds
    buffer_load_dwordx4 v253, s[20:23], s97 offen offset:3072 sc1 lds
    s_add_u32 s96, s95, 3
    s_and_b32 s96, s96, 15
    s_mul_i32 s96, s96, 393216
    s_add_u32 s96, s96, s85
    s_add_u32 m0, s87, 40960
    s_nop 0
    buffer_load_dwordx4 v8, s[16:19], s96 offen offset:0 lds
    buffer_load_dwordx4 v9, s[16:19], s96 offen offset:1024 lds
    buffer_load_dwordx4 v10, s[16:19], s96 offen offset:2048 lds
    buffer_load_dwordx4 v11, s[16:19], s96 offen offset:3072 lds
    s_add_u32 m0, s87, 45056
    s_nop 0
    buffer_load_dwordx4 v12, s[16:19], s96 offen offset:0 lds
    buffer_load_dwordx4 v13, s[16:19], s96 offen offset:1024 lds
    s_waitcnt vmcnt(15) lgkmcnt(0)
    s_barrier
    s_add_u32 s96, s94, 4
    s_and_b32 s96, s96, 15
    s_lshl_b32 s97, s96, 14
    s_add_u32 s97, s97, s84
    s_add_u32 m0, s86, 131072
    s_nop 0
    buffer_load_dwordx4 v253, s[20:23], s97 offen offset:0 sc1 lds
    buffer_load_dwordx4 v253, s[20:23], s97 offen offset:1024 sc1 lds
    v_add_f32 v56, 1.0, v55
    v_mul_f32 v57, v54, v55
    v_mul_f32_e64 v58, v56, v56
    buffer_load_dwordx4 v253, s[20:23], s97 offen offset:2048 sc1 lds
    v_sub_f32 v57, 0, v57
    v_mul_f32 v58, v58, v65
    v_add_f32 v58, 0x3727c5ac, v58
    buffer_load_dwordx4 v253, s[20:23], s97 offen offset:3072 sc1 lds
    v_rsq_f32 v58, v58
    s_nop 0
    v_mul_f32 v58, v58, v56
    v_and_b32 v48, 31, v252
    s_add_u32 s96, s94, 4
    s_and_b32 s96, s96, 15
    s_mul_i32 s96, s96, 393216
    s_add_u32 s96, s96, s85
    s_add_u32 m0, s87, 65536
    s_nop 0
    buffer_load_dwordx4 v8, s[16:19], s96 offen offset:0 lds
    v_lshrrev_b32 v49, 5, v252
    v_cmp_eq_u32 vcc, 0, v49
    v_lshlrev_b32_e64 v49, 9, v49
    buffer_load_dwordx4 v9, s[16:19], s96 offen offset:1024 lds
    v_lshl_add_u32 v48, v48, 2, v49
    s_lshl_b32 s32, s28, 7
    v_add_u32 v48, s32, v48
    buffer_load_dwordx4 v10, s[16:19], s96 offen offset:2048 lds
    v_cndmask_b32 v49, v54, v58, vcc
    v_cndmask_b32 v50, v57, v56, vcc
    ds_write_b32 v48, v49 offset:0
    buffer_load_dwordx4 v11, s[16:19], s96 offen offset:3072 lds
    ds_write_b32 v48, v50 offset:2048
    v_and_b32 v48, 15, v252
    v_lshrrev_b32 v51, 4, v252
    s_add_u32 m0, s87, 69632
    s_nop 0
    buffer_load_dwordx4 v12, s[16:19], s96 offen offset:0 lds
    v_lshl_add_u32 v48, v48, 2, v51
    s_min_u32 s32, s28, 2
    s_lshl_b32 s32, s32, 8
    buffer_load_dwordx4 v13, s[16:19], s96 offen offset:1024 lds
    v_lshl_add_u32 v48, v48, 2, s32
    ds_write_b32 v48, v2 offset:1024
    s_waitcnt vmcnt(10) lgkmcnt(0)
    s_barrier
    s_add_u32 s96, s95, 5
    s_and_b32 s96, s96, 15
    s_lshl_b32 s97, s96, 14
    s_add_u32 s97, s97, s84
    s_add_u32 m0, s86, 114688
    s_nop 0
    buffer_load_dwordx4 v253, s[20:23], s97 offen offset:0 sc1 lds
    buffer_load_dwordx4 v253, s[20:23], s97 offen offset:1024 sc1 lds
    buffer_load_dwordx4 v253, s[20:23], s97 offen offset:2048 sc1 lds
    buffer_load_dwordx4 v253, s[20:23], s97 offen offset:3072 sc1 lds
    s_add_u32 s96, s95, 5
    s_and_b32 s96, s96, 15
    s_mul_i32 s96, s96, 393216
    s_add_u32 s96, s96, s85
    s_add_u32 m0, s87, 90112
    s_nop 0
    buffer_load_dwordx4 v8, s[16:19], s96 offen offset:0 lds
    buffer_load_dwordx4 v9, s[16:19], s96 offen offset:1024 lds
    buffer_load_dwordx4 v10, s[16:19], s96 offen offset:2048 lds
    buffer_load_dwordx4 v11, s[16:19], s96 offen offset:3072 lds
    s_add_u32 m0, s87, 94208
    s_nop 0
    buffer_load_dwordx4 v12, s[16:19], s96 offen offset:0 lds
    buffer_load_dwordx4 v13, s[16:19], s96 offen offset:1024 lds
    s_waitcnt vmcnt(10) lgkmcnt(0)
    s_barrier
    s_add_u32 s32, s79, 0xdc0000
    s_lshr_b32 vcc_lo, s24, 1
    s_mul_i32 vcc_lo, vcc_lo, 2048
    s_add_u32 s32, s32, vcc_lo
    v_lshlrev_b32_e64 v20, 1, v253
    buffer_load_dwordx4 v[16:19], v20, s[20:23], s32 offen sc1
    s_add_u32 s96, s94, 6
    s_and_b32 s96, s96, 15
    s_lshl_b32 s97, s96, 14
    s_add_u32 s97, s97, s84
    s_add_u32 m0, s86, 147456
    s_nop 0
    buffer_load_dwordx4 v253, s[20:23], s97 offen offset:0 sc1 lds
    buffer_load_dwordx4 v253, s[20:23], s97 offen offset:1024 sc1 lds
    buffer_load_dwordx4 v253, s[20:23], s97 offen offset:2048 sc1 lds
    buffer_load_dwordx4 v253, s[20:23], s97 offen offset:3072 sc1 lds
    s_add_u32 s96, s94, 6
    s_and_b32 s96, s96, 15
    s_mul_i32 s96, s96, 393216
    s_add_u32 s96, s96, s85
    s_add_u32 m0, s87, 40960
    s_nop 0
    buffer_load_dwordx4 v8, s[16:19], s96 offen offset:0 lds
    buffer_load_dwordx4 v9, s[16:19], s96 offen offset:1024 lds
    buffer_load_dwordx4 v10, s[16:19], s96 offen offset:2048 lds
    buffer_load_dwordx4 v11, s[16:19], s96 offen offset:3072 lds
    s_add_u32 m0, s87, 45056
    s_nop 0
    buffer_load_dwordx4 v12, s[16:19], s96 offen offset:0 lds
    buffer_load_dwordx4 v13, s[16:19], s96 offen offset:1024 lds
    s_waitcnt vmcnt(11) lgkmcnt(0)
    s_barrier
    s_add_u32 s96, s95, 7
    s_and_b32 s96, s96, 15
    s_lshl_b32 s97, s96, 14
    s_add_u32 s97, s97, s84
    s_add_u32 m0, s86, 131072
    s_nop 0
    buffer_load_dwordx4 v253, s[20:23], s97 offen offset:0 sc1 lds
    buffer_load_dwordx4 v253, s[20:23], s97 offen offset:1024 sc1 lds
    s_mov_b32 s78, s27
    s_waitcnt vmcnt(12)
    s_branch pc_104
pl_103:
    s_add_u32 s32, s79, 0xdc0000
    s_lshr_b32 vcc_lo, s24, 1
    s_mul_i32 vcc_lo, vcc_lo, 2048
    s_add_u32 s32, s32, vcc_lo
    v_lshlrev_b32 v20, 1, v253
    buffer_load_dwordx4 v[16:19], v20, s[20:23], s32 offen sc1
    s_waitcnt vmcnt(0)
pc_104:
    v_max3_u32 v20, v16, v17, v18
    v_max_u32 v20, v20, v19
    v_cmp_eq_u32 vcc, -1, v20
    s_cbranch_vccz pd_105
    s_sub_u32 s78, s78, 1
    s_cmp_lg_u32 s78, 0
    s_cbranch_scc1 pl_103
    s_mov_b32 s27, 1
pd_105:
    buffer_load_dwordx4 v253, s[20:23], s97 offen offset:2048 sc1 lds
    buffer_load_dwordx4 v253, s[20:23], s97 offen offset:3072 sc1 lds
    s_add_u32 s96, s95, 7
    s_and_b32 s96, s96, 15
    s_mul_i32 s96, s96, 393216
    s_add_u32 s96, s96, s85
    s_add_u32 m0, s87, 65536
    s_nop 0
    buffer_load_dwordx4 v8, s[16:19], s96 offen offset:0 lds
    v_mov_b32 v20, v16
    s_nop 1
    v_max_f32_dpp v20, v20, v20 quad_perm:[1,0,3,2] row_mask:0xf bank_mask:0xf
    s_nop 1
    v_max_f32_dpp v20, v20, v20 quad_perm:[2,3,0,1] row_mask:0xf bank_mask:0xf
    s_nop 1
    v_max_f32_dpp v20, v20, v20 row_half_mirror row_mask:0xf bank_mask:0xf
    buffer_load_dwordx4 v9, s[16:19], s96 offen offset:1024 lds
    s_nop 0
    v_max_f32_dpp v20, v20, v20 row_mirror row_mask:0xf bank_mask:0xf
    v_mov_b32 v21, v20
    s_nop 1
    v_permlane16_swap_b32 v20, v21
    v_max_f32 v20, v20, v21
    v_mov_b32 v21, v20
    s_nop 1
    v_permlane32_swap_b32 v20, v21
    buffer_load_dwordx4 v10, s[16:19], s96 offen offset:2048 lds
    v_max_f32 v20, v20, v21
    v_cmp_eq_f32 vcc, v20, v16
    s_ff1_i32_b64 s32, vcc
    s_and_b32 s32, s32, 63
    v_readlane_b32 s74, v16, s32
    v_readlane_b32 s73, v17, s32
    v_readlane_b32 s75, v18, s32
    buffer_load_dwordx4 v11, s[16:19], s96 offen offset:3072 lds
    v_readlane_b32 s76, v19, s32
    s_and_b32 s73, s73, 2047
    s_lshr_b32 s33, s73, 5
    s_lshl_b32 s33, s33, 11
    s_add_u32 s33, s33, s79
    s_add_u32 s33, s33, 0xd60000
    s_add_u32 m0, s87, 69632
    s_nop 0
    buffer_load_dwordx4 v12, s[16:19], s96 offen offset:0 lds
    buffer_load_dwordx4 v[24:27], v22, s[20:23], s33 offen sc1
    v_mov_b32 v20, s73
    v_mov_b32 v21, s77
    v_mov_b32_e64 v19, 0
    ds_write_b64 v19, v[20:21] offset:3072
    s_lshr_b32 s39, s73, 5
    s_lshl_b32 s34, s24, 2
    buffer_load_dwordx4 v13, s[16:19], s96 offen offset:1024 lds
    s_sub_u32 s39, s39, s34
    s_add_u32 s39, s39, 8
    s_lshr_b32 s34, s39, 3
    s_add_u32 s34, s34, 1
    s_cmp_lt_u32 s39, 12
    s_cselect_b32 s100, s34, 0
    s_waitcnt vmcnt(11) lgkmcnt(0)
    s_barrier
    s_add_u32 s96, s94, 8
    s_and_b32 s96, s96, 15
    s_lshl_b32 s97, s96, 14
    s_add_u32 s97, s97, s84
    s_add_u32 m0, s86, 114688
    s_nop 0
    buffer_load_dwordx4 v253, s[20:23], s97 offen offset:0 sc1 lds
    buffer_load_dwordx4 v253, s[20:23], s97 offen offset:1024 sc1 lds
    s_mov_b32 s78, s27
    s_waitcnt vmcnt(3)
    s_branch pc_93
    s_nop 0
pl_92:
    s_lshr_b32 s33, s73, 5
    s_lshl_b32 s33, s33, 11
    s_add_u32 s33, s33, s79
    s_add_u32 s33, s33, 0xd60000
    buffer_load_dwordx4 v[24:27], v22, s[20:23], s33 offen sc1
    s_waitcnt vmcnt(0)
pc_93:
    v_max3_u32 v30, v24, v25, v26
    v_max_u32 v30, v30, v27
    v_cmp_eq_u32 vcc, -1, v30
    s_cbranch_vccz pd_94
    s_sub_u32 s78, s78, 1
    s_cmp_lg_u32 s78, 0
    s_cbranch_scc1 pl_92
    s_mov_b32 s27, 1
pd_94:
    buffer_load_dwordx4 v253, s[20:23], s97 offen offset:2048 sc1 lds
    buffer_load_dwordx4 v253, s[20:23], s97 offen offset:3072 sc1 lds
    s_cmp_lt_i32 s89, 0
    s_cbranch_scc1 sk_95
    v_and_b32 v30, 16, v252
    v_cmp_eq_u32 vcc, 16, v30
    v_mov_b32 v28, s76
    v_mul_f32 v29, s75, v28
    v_add_f32 v28, 1.0, v28
    v_cndmask_b32 v30, v24, v25, vcc
    v_cndmask_b32_e64 v31, v26, v27, vcc
    s_mov_b32 vcc_lo, 0xaaaaaaaa
    s_mov_b32 vcc_hi, 0xaaaaaaaa
    v_mov_b32 v96, 0xbfb8aa3b
    v_mul_f32 v96, s74, v96
    v_exp_f32 v96, v96
    v_cndmask_b32 v30, v30, v31, vcc
    v_lshlrev_b32 v92, 16, v30
    v_and_b32 v93, 0xffff0000, v30
    v_fma_f32 v92, v92, v28, -v29
    v_fma_f32 v93, v93, v28, -v29
    v_add_f32 v96, 1.0, v96
    v_rcp_f32 v96, v96
sk_95:
    s_add_u32 s96, s94, 8
    s_and_b32 s96, s96, 15
    s_mul_i32 s96, s96, 393216
    s_add_u32 s96, s96, s85
    s_add_u32 m0, s87, 90112
    s_nop 0
    buffer_load_dwordx4 v8, s[16:19], s96 offen offset:0 lds
    buffer_load_dwordx4 v9, s[16:19], s96 offen offset:1024 lds
    v_mov_b32 v28, s76
    v_mul_f32 v29, s75, v28
    v_lshlrev_b32_e64 v30, 16, v24
    v_and_b32 v31, 0xffff0000, v24
    v_fma_f32 v30, v30, v28, -v29
    v_fma_f32 v31, v31, v28, -v29
    buffer_load_dwordx4 v10, s[16:19], s96 offen offset:2048 lds
    v_cvt_pk_bf16_f32 v24, v30, v31
    v_lshlrev_b32_e64 v30, 16, v25
    v_and_b32 v31, 0xffff0000, v25
    v_fma_f32 v30, v30, v28, -v29
    v_fma_f32 v31, v31, v28, -v29
    v_cvt_pk_bf16_f32 v25, v30, v31
    v_lshlrev_b32_e64 v30, 16, v26
    v_and_b32 v31, 0xffff0000, v26
    v_fma_f32 v30, v30, v28, -v29
    v_fma_f32 v31, v31, v28, -v29
    buffer_load_dwordx4 v11, s[16:19], s96 offen offset:3072 lds
    v_cvt_pk_bf16_f32 v26, v30, v31
    v_lshlrev_b32_e64 v30, 16, v27
    v_and_b32 v31, 0xffff0000, v27
    v_fma_f32 v30, v30, v28, -v29
    v_fma_f32 v31, v31, v28, -v29
    v_cvt_pk_bf16_f32 v27, v30, v31
    s_bitcmp0_b32 s29, 0
    s_cbranch_scc1 sk_96
    v_swap_b32 v24, v25
    v_swap_b32 v26, v27
sk_96:
    s_add_u32 m0, s87, 94208
    s_nop 0
    buffer_load_dwordx4 v12, s[16:19], s96 offen offset:0 lds
    s_bitcmp0_b32 s29, 1
    s_cbranch_scc1 sk_97
    v_swap_b32 v24, v26
    v_swap_b32 v25, v27
sk_97:
    buffer_load_dwordx4 v13, s[16:19], s96 offen offset:1024 lds
    s_cmp_ge_u32 s29, 224
    s_cbranch_scc1 sk_98
    v_dot2_f32_bf16 v32, v155, v24, 0
    v_dot2_f32_bf16 v33, v160, v24, 0
    v_dot2_f32_bf16 v34, v156, v24, 0
    v_dot2_f32_bf16 v35, v161, v24, 0
    v_dot2_f32_bf16 v36, v157, v24, 0
    v_dot2_f32_bf16 v37, v162, v24, 0
    v_dot2_f32_bf16 v38, v158, v24, 0
    v_dot2_f32_bf16 v39, v163, v24, 0
    v_dot2_f32_bf16 v40, v183, v24, 0
    v_dot2_f32_bf16 v41, v192, v24, 0
    v_dot2_f32_bf16 v42, v188, v24, 0
    v_dot2_f32_bf16 v43, v193, v24, 0
    v_dot2_f32_bf16 v44, v189, v24, 0
    v_dot2_f32_bf16 v45, v194, v24, 0
    v_dot2_f32_bf16 v46, v190, v24, 0
    v_dot2_f32_bf16 v47, v195, v24, 0
    v_dot2_f32_bf16 v32, v159, v25, v32
    v_dot2_f32_bf16 v33, v168, v25, v33
    v_dot2_f32_bf16 v34, v164, v25, v34
    v_dot2_f32_bf16 v35, v169, v25, v35
    v_dot2_f32_bf16 v36, v165, v25, v36
    v_dot2_f32_bf16 v37, v170, v25, v37
    v_dot2_f32_bf16 v38, v166, v25, v38
    v_dot2_f32_bf16 v39, v171, v25, v39
    v_dot2_f32_bf16 v40, v191, v25, v40
    v_dot2_f32_bf16 v41, v200, v25, v41
    v_dot2_f32_bf16 v42, v196, v25, v42
    v_dot2_f32_bf16 v43, v201, v25, v43
    v_dot2_f32_bf16 v44, v197, v25, v44
    v_dot2_f32_bf16 v45, v202, v25, v45
    v_dot2_f32_bf16 v46, v198, v25, v46
    v_dot2_f32_bf16 v47, v203, v25, v47
    v_dot2_f32_bf16 v32, v167, v26, v32
    v_dot2_f32_bf16 v33, v176, v26, v33
    v_dot2_f32_bf16 v34, v172, v26, v34
    v_dot2_f32_bf16 v35, v177, v26, v35
    v_dot2_f32_bf16 v36, v173, v26, v36
    v_dot2_f32_bf16 v37, v178, v26, v37
    v_dot2_f32_bf16 v38, v174, v26, v38
    v_dot2_f32_bf16 v39, v179, v26, v39
    v_dot2_f32_bf16 v40, v199, v26, v40
    v_dot2_f32_bf16 v41, v208, v26, v41
    v_dot2_f32_bf16 v42, v204, v26, v42
    v_dot2_f32_bf16 v43, v209, v26, v43
    v_dot2_f32_bf16 v44, v205, v26, v44
    v_dot2_f32_bf16 v45, v210, v26, v45
    v_dot2_f32_bf16 v46, v206, v26, v46
    v_dot2_f32_bf16 v47, v211, v26, v47
    v_dot2_f32_bf16 v32, v175, v27, v32
    v_dot2_f32_bf16 v33, v184, v27, v33
    v_dot2_f32_bf16 v34, v180, v27, v34
    v_dot2_f32_bf16 v35, v185, v27, v35
    v_dot2_f32_bf16 v36, v181, v27, v36
    v_dot2_f32_bf16 v37, v186, v27, v37
    v_dot2_f32_bf16 v38, v182, v27, v38
    v_dot2_f32_bf16 v39, v187, v27, v39
    v_dot2_f32_bf16 v40, v207, v27, v40
    v_dot2_f32_bf16 v41, v216, v27, v41
    v_dot2_f32_bf16 v42, v212, v27, v42
    v_dot2_f32_bf16 v43, v217, v27, v43
    v_dot2_f32_bf16 v44, v213, v27, v44
    v_dot2_f32_bf16 v45, v218, v27, v45
    v_dot2_f32_bf16 v46, v214, v27, v46
    v_dot2_f32_bf16 v47, v219, v27, v47
sk_98:
    s_waitcnt vmcnt(10) lgkmcnt(0)
    s_barrier
    s_add_u32 s96, s95, 9
    s_and_b32 s96, s96, 15
    s_lshl_b32 s97, s96, 14
    s_add_u32 s97, s97, s84
    s_add_u32 m0, s86, 147456
    s_nop 0
    buffer_load_dwordx4 v253, s[20:23], s97 offen offset:0 sc1 lds
    buffer_load_dwordx4 v253, s[20:23], s97 offen offset:1024 sc1 lds
    v_lshrrev_b32 v31, 5, v252
    v_lshlrev_b32 v30, 6, v31
    v_permlane32_swap_b32 v32, v40
    v_permlane32_swap_b32 v33, v41
    v_permlane32_swap_b32 v34, v42
    v_permlane32_swap_b32_e64 v35, v43
    buffer_load_dwordx4 v253, s[20:23], s97 offen offset:2048 sc1 lds
    v_permlane32_swap_b32 v36, v44
    v_permlane32_swap_b32 v37, v45
    v_permlane32_swap_b32 v38, v46
    v_permlane32_swap_b32 v39, v47
    v_add_f32_e64 v32, v32, v40
    buffer_load_dwordx4 v253, s[20:23], s97 offen offset:3072 sc1 lds
    v_add_f32 v33, v33, v41
    v_add_f32 v34, v34, v42
    v_add_f32 v35, v35, v43
    v_add_f32 v36, v36, v44
    v_add_f32_e64 v37, v37, v45
    s_add_u32 s96, s95, 9
    s_and_b32 s96, s96, 15
    s_mul_i32 s96, s96, 393216
    s_add_u32 s96, s96, s85
    s_add_u32 m0, s87, 40960
    s_nop 0
    buffer_load_dwordx4 v8, s[16:19], s96 offen offset:0 lds
    v_add_f32 v38, v38, v46
    v_add_f32 v39, v39, v47
    v_and_b32_e64 v31, 1, v252
    v_lshl_add_u32 v30, v31, 5, v30
    v_permlane16_swap_b32_e64 v32, v36
    buffer_load_dwordx4 v9, s[16:19], s96 offen offset:1024 lds
    v_permlane16_swap_b32 v33, v37
    v_permlane16_swap_b32 v34, v38
    v_permlane16_swap_b32 v35, v39
    v_add_f32 v32, v32, v36
    v_add_f32 v33, v33, v37
    v_add_f32 v34, v34, v38
    buffer_load_dwordx4 v10, s[16:19], s96 offen offset:2048 lds
    v_add_f32 v35, v35, v39
    v_and_b32 v31, 16, v252
    s_lshl_b32 s32, s28, 7
    v_add3_u32 v30, v31, v30, s32
    v_add_f32_dpp v32, v32, v32 quad_perm:[2,3,0,1] row_mask:0xf bank_mask:0xf
    buffer_load_dwordx4 v11, s[16:19], s96 offen offset:3072 lds
    v_add_f32_dpp v33, v33, v33 quad_perm:[2,3,0,1] row_mask:0xf bank_mask:0xf
    v_add_f32_dpp v34, v34, v34 quad_perm:[2,3,0,1] row_mask:0xf bank_mask:0xf
    v_add_f32_dpp v35, v35, v35 quad_perm:[2,3,0,1] row_mask:0xf bank_mask:0xf
    v_add_f32_dpp v32, v32, v32 row_ror:4 row_mask:0xf bank_mask:0xf
    v_add_f32_dpp v33, v33, v33 row_ror:4 row_mask:0xf bank_mask:0xf
    s_add_u32 m0, s87, 45056
    s_nop 0
    buffer_load_dwordx4 v12, s[16:19], s96 offen offset:0 lds
    v_add_f32_dpp v34, v34, v34 row_ror:4 row_mask:0xf bank_mask:0xf
    v_add_f32_dpp v35, v35, v35 row_ror:4 row_mask:0xf bank_mask:0xf
    v_add_f32_dpp v32, v32, v32 row_ror:8 row_mask:0xf bank_mask:0xf
    v_add_f32_dpp v33, v33, v33 row_ror:8 row_mask:0xf bank_mask:0xf
    v_add_f32_dpp v34, v34, v34 row_ror:8 row_mask:0xf bank_mask:0xf
    buffer_load_dwordx4 v13, s[16:19], s96 offen offset:1024 lds
    v_add_f32_dpp v35, v35, v35 row_ror:8 row_mask:0xf bank_mask:0xf
    s_mov_b32 exec_lo, 0x00030003
    s_mov_b32 exec_hi, 0x00030003
    ds_write_b128 v30, v[32:35] offset:3328
    s_mov_b64 exec, -1
    s_waitcnt vmcnt(10) lgkmcnt(0)
    s_barrier
    s_add_u32 s96, s94, 10
    s_and_b32 s96, s96, 15
    s_lshl_b32 s97, s96, 14
    s_add_u32 s97, s97, s84
    s_add_u32 m0, s86, 131072
    s_nop 0
    buffer_load_dwordx4 v253, s[20:23], s97 offen offset:0 sc1 lds
    buffer_load_dwordx4 v253, s[20:23], s97 offen offset:1024 sc1 lds
    v_and_b32_e64 v30, 1, v252
    v_bfe_u32 v31, v252, 1, 3
    v_lshl_add_u32 v30, v30, 3, v31
    v_lshlrev_b32_e64 v30, 2, v30
    v_add_u32 v30, 3328, v30
    ds_read2_b32 v[32:33], v30 offset0:0 offset1:16
    buffer_load_dwordx4 v253, s[20:23], s97 offen offset:2048 sc1 lds
    ds_read2_b32 v[34:35], v30 offset0:32 offset1:48
    ds_read2_b32 v[36:37], v30 offset0:64 offset1:80
    ds_read2_b32 v[38:39], v30 offset0:96 offset1:112
    v_lshrrev_b32_e64 v30, 2, v252
    v_mul_u32_u24 v30, 7168, v30
    buffer_load_dwordx4 v253, s[20:23], s97 offen offset:3072 sc1 lds
    v_and_b32_e64 v31, 2, v252
    v_lshl_add_u32 v30, v31, 3, v30
    s_add_u32 s32, s29, 32
    s_lshr_b32 s32, s32, 8
    v_lshl_add_u32 v30, s32, 31, v30
    s_add_u32 s96, s94, 10
    s_and_b32 s96, s96, 15
    s_mul_i32 s96, s96, 393216
    s_add_u32 s96, s96, s85
    s_add_u32 m0, s87, 65536
    s_nop 0
    buffer_load_dwordx4 v8, s[16:19], s96 offen offset:0 lds
    s_mul_i32 s32, s28, 114688
    s_mul_i32 s33, s29, 32
    s_add_u32 s32, s32, s33
    s_add_u32 s32, s32, s79
    s_add_u32 s32, s32, 0xc80000
    buffer_load_dwordx4 v9, s[16:19], s96 offen offset:1024 lds
    s_waitcnt lgkmcnt(0)
    v_add_f32 v32, v32, v34
    v_add_f32 v33, v33, v35
    v_add_f32 v36, v36, v38
    v_add_f32 v37, v37, v39
    buffer_load_dwordx4 v10, s[16:19], s96 offen offset:2048 lds
    v_add_f32 v32, v32, v36
    v_add_f32 v33, v33, v37
    v_mul_f32 v34, 0xbfb8aa3b, v32
    v_exp_f32 v34, v34
    v_mul_f32 v32, v32, v33
    buffer_load_dwordx4 v11, s[16:19], s96 offen offset:3072 lds
    v_add_f32 v34, 1.0, v34
    v_rcp_f32 v34, v34
    s_nop 0
    v_mul_f32 v32, v32, v34
    s_nop 1
    v_mov_b32_dpp v33, v32 quad_perm:[2,3,2,3] row_mask:0xf bank_mask:0xf
    v_cvt_pk_bf16_f32 v32, v32, v33
    s_add_u32 m0, s87, 69632
    s_nop 0
    buffer_load_dwordx4 v12, s[16:19], s96 offen offset:0 lds
    ds_swizzle_b32 v36, v32 offset:0x1
    ds_swizzle_b32 v37, v32 offset:0x81
    ds_swizzle_b32 v38, v32 offset:0x101
    ds_swizzle_b32 v39, v32 offset:0x181
    s_waitcnt lgkmcnt(0)
    buffer_load_dwordx4 v13, s[16:19], s96 offen offset:1024 lds
    s_cmp_ge_u32 s29, 224
    s_cbranch_scc1 sk_99
    v_dot2_f32_bf16 v40, v215, v36, 0
    v_dot2_f32_bf16 v41, v224, v36, 0
    v_dot2_f32_bf16 v42, v220, v36, 0
    v_dot2_f32_bf16 v43, v225, v36, 0
    v_dot2_f32_bf16 v44, v221, v36, 0
    v_dot2_f32_bf16 v45, v226, v36, 0
    v_dot2_f32_bf16 v46, v222, v36, 0
    v_dot2_f32_bf16 v47, v227, v36, 0
    v_dot2_f32_bf16 v40, v223, v37, v40
    v_dot2_f32_bf16 v41, v232, v37, v41
    v_dot2_f32_bf16 v42, v228, v37, v42
    v_dot2_f32_bf16 v43, v233, v37, v43
    v_dot2_f32_bf16 v44, v229, v37, v44
    v_dot2_f32_bf16 v45, v234, v37, v45
    v_dot2_f32_bf16 v46, v230, v37, v46
    v_dot2_f32_bf16 v47, v235, v37, v47
    v_dot2_f32_bf16 v40, v231, v38, v40
    v_dot2_f32_bf16 v41, v240, v38, v41
    v_dot2_f32_bf16 v42, v236, v38, v42
    v_dot2_f32_bf16 v43, v241, v38, v43
    v_dot2_f32_bf16 v44, v237, v38, v44
    v_dot2_f32_bf16 v45, v242, v38, v45
    v_dot2_f32_bf16 v46, v238, v38, v46
    v_dot2_f32_bf16 v47, v243, v38, v47
    v_dot2_f32_bf16 v40, v239, v39, v40
    v_dot2_f32_bf16 v41, v248, v39, v41
    v_dot2_f32_bf16 v42, v244, v39, v42
    v_dot2_f32_bf16 v43, v249, v39, v43
    v_dot2_f32_bf16 v44, v245, v39, v44
    v_dot2_f32_bf16 v45, v250, v39, v45
    v_dot2_f32_bf16 v46, v246, v39, v46
    v_dot2_f32_bf16 v47, v251, v39, v47
sk_99:
    v_add_f32_dpp v40, v40, v40 quad_perm:[1,0,3,2] row_mask:0xf bank_mask:0xf
    v_add_f32_dpp v41, v41, v41 quad_perm:[1,0,3,2] row_mask:0xf bank_mask:0xf
    v_add_f32_dpp v42, v42, v42 quad_perm:[1,0,3,2] row_mask:0xf bank_mask:0xf
    v_add_f32_dpp v43, v43, v43 quad_perm:[1,0,3,2] row_mask:0xf bank_mask:0xf
    v_add_f32_dpp v44, v44, v44 quad_perm:[1,0,3,2] row_mask:0xf bank_mask:0xf
    v_add_f32_dpp v45, v45, v45 quad_perm:[1,0,3,2] row_mask:0xf bank_mask:0xf
    v_add_f32_dpp v46, v46, v46 quad_perm:[1,0,3,2] row_mask:0xf bank_mask:0xf
    v_add_f32_dpp v47, v47, v47 quad_perm:[1,0,3,2] row_mask:0xf bank_mask:0xf
    s_mov_b32 exec_lo, 0x55555555
    s_mov_b32 exec_hi, 0x55555555
    v_cvt_pk_bf16_f32 v40, v40, v41
    v_cvt_pk_bf16_f32 v41, v42, v43
    v_cvt_pk_bf16_f32 v42, v44, v45
    v_cvt_pk_bf16_f32 v43, v46, v47
    buffer_store_dwordx4 v[40:43], v30, s[20:23], s32 offen sc1
    s_mov_b64 exec, -1
    s_waitcnt vmcnt(11) lgkmcnt(0)
    s_barrier
    s_add_u32 s96, s95, 11
    s_and_b32 s96, s96, 15
    s_lshl_b32 s97, s96, 14
    s_add_u32 s97, s97, s84
    s_add_u32 m0, s86, 114688
    s_nop 0
    buffer_load_dwordx4 v253, s[20:23], s97 offen offset:0 sc1 lds
    buffer_load_dwordx4 v253, s[20:23], s97 offen offset:1024 sc1 lds
    buffer_load_dwordx4 v253, s[20:23], s97 offen offset:2048 sc1 lds
    buffer_load_dwordx4 v253, s[20:23], s97 offen offset:3072 sc1 lds
    s_add_u32 s96, s95, 11
    s_and_b32 s96, s96, 15
    s_mul_i32 s96, s96, 393216
    s_add_u32 s96, s96, s85
    s_add_u32 m0, s87, 90112
    s_nop 0
    buffer_load_dwordx4 v8, s[16:19], s96 offen offset:0 lds
    buffer_load_dwordx4 v9, s[16:19], s96 offen offset:1024 lds
    buffer_load_dwordx4 v10, s[16:19], s96 offen offset:2048 lds
    buffer_load_dwordx4 v11, s[16:19], s96 offen offset:3072 lds
    s_add_u32 m0, s87, 94208
    s_nop 0
    buffer_load_dwordx4 v12, s[16:19], s96 offen offset:0 lds
    buffer_load_dwordx4 v13, s[16:19], s96 offen offset:1024 lds
    s_waitcnt vmcnt(11) lgkmcnt(0)
    s_barrier
    s_add_u32 s96, s94, 12
    s_and_b32 s96, s96, 15
    s_lshl_b32 s97, s96, 14
    s_add_u32 s97, s97, s84
    s_add_u32 m0, s86, 147456
    s_nop 0
    buffer_load_dwordx4 v253, s[20:23], s97 offen offset:0 sc1 lds
    buffer_load_dwordx4 v253, s[20:23], s97 offen offset:1024 sc1 lds
    buffer_load_dwordx4 v253, s[20:23], s97 offen offset:2048 sc1 lds
    buffer_load_dwordx4 v253, s[20:23], s97 offen offset:3072 sc1 lds
    s_add_u32 s96, s94, 12
    s_and_b32 s96, s96, 15
    s_mul_i32 s96, s96, 393216
    s_add_u32 s96, s96, s85
    s_add_u32 m0, s87, 40960
    s_nop 0
    buffer_load_dwordx4 v8, s[16:19], s96 offen offset:0 lds
    buffer_load_dwordx4 v9, s[16:19], s96 offen offset:1024 lds
    buffer_load_dwordx4 v10, s[16:19], s96 offen offset:2048 lds
    buffer_load_dwordx4 v11, s[16:19], s96 offen offset:3072 lds
    s_add_u32 m0, s87, 45056
    s_nop 0
    buffer_load_dwordx4 v12, s[16:19], s96 offen offset:0 lds
    buffer_load_dwordx4 v13, s[16:19], s96 offen offset:1024 lds
    s_waitcnt vmcnt(10) lgkmcnt(0)
    s_barrier
    s_cmp_lt_i32 s89, 0
    s_cbranch_scc1 sk_106
    s_mul_i32 s32, s89, 3584
    s_add_u32 s32, s32, s79
    s_add_u32 s32, s32, 0xc80000
    buffer_load_dwordx4 v[60:63], v253, s[20:23], s32 offen offset:0 sc1
    buffer_load_dwordx4 v[64:67], v253, s[20:23], s32 offen offset:1024 sc1
    buffer_load_dwordx4 v[68:71], v253, s[20:23], s32 offen offset:2048 sc1
    buffer_load_dwordx4 v[72:75], v253, s[20:23], s32 offen offset:3072 sc1
    s_add_u32 s32, s32, 4096
    buffer_load_dwordx4 v[76:79], v253, s[20:23], s32 offen offset:0 sc1
    buffer_load_dwordx4 v[80:83], v253, s[20:23], s32 offen offset:1024 sc1
    buffer_load_dwordx4 v[84:87], v253, s[20:23], s32 offen offset:2048 sc1
sk_106:
    s_add_u32 s96, s95, 13
    s_and_b32 s96, s96, 15
    s_lshl_b32 s97, s96, 14
    s_add_u32 s97, s97, s84
    s_add_u32 m0, s86, 131072
    s_nop 0
    buffer_load_dwordx4 v253, s[20:23], s97 offen offset:0 sc1 lds
    buffer_load_dwordx4 v253, s[20:23], s97 offen offset:1024 sc1 lds
    buffer_load_dwordx4 v253, s[20:23], s97 offen offset:2048 sc1 lds
    buffer_load_dwordx4 v253, s[20:23], s97 offen offset:3072 sc1 lds
    s_add_u32 s96, s95, 13
    s_and_b32 s96, s96, 15
    s_mul_i32 s96, s96, 393216
    s_add_u32 s96, s96, s85
    s_add_u32 m0, s87, 65536
    s_nop 0
    buffer_load_dwordx4 v8, s[16:19], s96 offen offset:0 lds
    buffer_load_dwordx4 v9, s[16:19], s96 offen offset:1024 lds
    buffer_load_dwordx4 v10, s[16:19], s96 offen offset:2048 lds
    buffer_load_dwordx4 v11, s[16:19], s96 offen offset:3072 lds
    s_add_u32 m0, s87, 69632
    s_nop 0
    buffer_load_dwordx4 v12, s[16:19], s96 offen offset:0 lds
    buffer_load_dwordx4 v13, s[16:19], s96 offen offset:1024 lds
    s_waitcnt vmcnt(10) lgkmcnt(0)
    s_barrier
    s_add_u32 s96, s94, 14
    s_and_b32 s96, s96, 15
    s_lshl_b32 s97, s96, 14
    s_add_u32 s97, s97, s84
    s_add_u32 m0, s86, 114688
    s_nop 0
    buffer_load_dwordx4 v253, s[20:23], s97 offen offset:0 sc1 lds
    buffer_load_dwordx4 v253, s[20:23], s97 offen offset:1024 sc1 lds
    s_cmp_lt_i32 s89, 0
    s_cbranch_scc1 sk_107
    s_mov_b32 s78, s27
    s_waitcnt vmcnt(12)
    s_branch pc_101
    s_nop 0
pl_100:
    s_mul_i32 s32, s89, 3584
    s_add_u32 s32, s32, s79
    s_add_u32 s32, s32, 0xc80000
    buffer_load_dwordx4 v[60:63], v253, s[20:23], s32 offen offset:0 sc1
    buffer_load_dwordx4 v[64:67], v253, s[20:23], s32 offen offset:1024 sc1
    buffer_load_dwordx4 v[68:71], v253, s[20:23], s32 offen offset:2048 sc1
    buffer_load_dwordx4 v[72:75], v253, s[20:23], s32 offen offset:3072 sc1
    s_add_u32 s32, s32, 4096
    buffer_load_dwordx4 v[76:79], v253, s[20:23], s32 offen offset:0 sc1
    buffer_load_dwordx4 v[80:83], v253, s[20:23], s32 offen offset:1024 sc1
    buffer_load_dwordx4 v[84:87], v253, s[20:23], s32 offen offset:2048 sc1
    s_waitcnt vmcnt(0)
pc_101:
    v_max3_u32 v30, v60, v64, v68
    v_max3_u32 v30, v30, v72, v76
    v_max3_u32 v30, v30, v80, v84
    v_cmp_eq_u32 vcc, -1, v30
    s_cbranch_vccz pd_102
    s_sub_u32 s78, s78, 1
    s_cmp_lg_u32 s78, 0
    s_cbranch_scc1 pl_100
    s_mov_b32 s27, 1
pd_102:
sk_107:
    buffer_load_dwordx4 v253, s[20:23], s97 offen offset:2048 sc1 lds
    s_cmp_lt_i32 s89, 0
    s_cbranch_scc1 sk_108
    v_lshlrev_b32 v24, 16, v60
    v_and_b32 v25, 0xffff0000, v60
    v_lshlrev_b32_e64 v26, 16, v61
    v_and_b32 v27, 0xffff0000, v61
    v_lshlrev_b32_e64 v28, 16, v62
    v_and_b32 v29, 0xffff0000, v62
    v_lshlrev_b32_e64 v30, 16, v63
    v_and_b32 v31, 0xffff0000, v63
    v_lshlrev_b32_e64 v88, 16, v64
    v_and_b32 v89, 0xffff0000, v64
    v_lshlrev_b32_e64 v90, 16, v65
sk_108:
    s_cmp_lt_i32 s89, 0
    s_cbranch_scc1 sk_109
    v_and_b32 v91, 0xffff0000, v65
    v_add_f32 v24, v24, v88
    v_add_f32 v25, v25, v89
    v_add_f32 v26, v26, v90
    v_add_f32 v27, v27, v91
    v_lshlrev_b32_e64 v88, 16, v66
    v_and_b32 v89, 0xffff0000, v66
    v_lshlrev_b32_e64 v90, 16, v67
    v_and_b32 v91, 0xffff0000, v67
    v_add_f32 v28, v28, v88
    v_add_f32 v29, v29, v89
    v_add_f32 v30, v30, v90
    v_add_f32 v31, v31, v91
    v_lshlrev_b32_e64 v88, 16, v68
    v_and_b32 v89, 0xffff0000, v68
    v_lshlrev_b32_e64 v90, 16, v69
    v_and_b32 v91, 0xffff0000, v69
    v_add_f32 v24, v24, v88
    v_add_f32 v25, v25, v89
    v_add_f32_e64 v26, v26, v90
sk_109:
    buffer_load_dwordx4 v253, s[20:23], s97 offen offset:3072 sc1 lds
    s_cmp_lt_i32 s89, 0
    s_cbranch_scc1 sk_110
    v_add_f32 v27, v27, v91
    v_lshlrev_b32 v88, 16, v70
    v_and_b32 v89, 0xffff0000, v70
    v_lshlrev_b32_e64 v90, 16, v71
    v_and_b32 v91, 0xffff0000, v71
    v_add_f32 v28, v28, v88
    v_add_f32 v29, v29, v89
    v_add_f32 v30, v30, v90
    v_add_f32 v31, v31, v91
    v_lshlrev_b32_e64 v88, 16, v72
    v_and_b32 v89, 0xffff0000, v72
    v_lshlrev_b32_e64 v90, 16, v73
    v_and_b32 v91, 0xffff0000, v73
    v_add_f32 v24, v24, v88
    v_add_f32 v25, v25, v89
    v_add_f32 v26, v26, v90
    v_add_f32 v27, v27, v91
    v_lshlrev_b32_e64 v88, 16, v74
    v_and_b32 v89, 0xffff0000, v74
    v_lshlrev_b32_e64 v90, 16, v75
sk_110:
    s_add_u32 s96, s94, 14
    s_and_b32 s96, s96, 15
    s_mul_i32 s96, s96, 393216
    s_add_u32 s96, s96, s85
    s_add_u32 m0, s87, 90112
    s_nop 0
    buffer_load_dwordx4 v8, s[16:19], s96 offen offset:0 lds
    s_cmp_lt_i32 s89, 0
    s_cbranch_scc1 sk_111
    v_and_b32 v91, 0xffff0000, v75
    v_add_f32 v28, v28, v88
    v_add_f32 v29, v29, v89
    v_add_f32 v30, v30, v90
    v_add_f32 v31, v31, v91
    v_lshlrev_b32_e64 v88, 16, v76
    v_and_b32 v89, 0xffff0000, v76
    v_lshlrev_b32_e64 v90, 16, v77
    v_and_b32 v91, 0xffff0000, v77
    v_add_f32 v24, v24, v88
    v_add_f32 v25, v25, v89
    v_add_f32 v26, v26, v90
    v_add_f32 v27, v27, v91
    v_lshlrev_b32_e64 v88, 16, v78
    v_and_b32 v89, 0xffff0000, v78
    v_lshlrev_b32_e64 v90, 16, v79
    v_and_b32 v91, 0xffff0000, v79
    v_add_f32 v28, v28, v88
    v_add_f32 v29, v29, v89
    v_add_f32_e64 v30, v30, v90
sk_111:
    buffer_load_dwordx4 v9, s[16:19], s96 offen offset:1024 lds
    s_cmp_lt_i32 s89, 0
    s_cbranch_scc1 sk_112
    v_add_f32 v31, v31, v91
    v_lshlrev_b32 v88, 16, v80
    v_and_b32 v89, 0xffff0000, v80
    v_lshlrev_b32_e64 v90, 16, v81
    v_and_b32 v91, 0xffff0000, v81
    v_add_f32 v24, v24, v88
    v_add_f32 v25, v25, v89
    v_add_f32 v26, v26, v90
    v_add_f32 v27, v27, v91
    v_lshlrev_b32_e64 v88, 16, v82
    v_and_b32 v89, 0xffff0000, v82
    v_lshlrev_b32_e64 v90, 16, v83
    v_and_b32 v91, 0xffff0000, v83
    v_add_f32 v28, v28, v88
    v_add_f32 v29, v29, v89
    v_add_f32 v30, v30, v90
    v_add_f32 v31, v31, v91
    v_lshlrev_b32_e64 v88, 16, v84
    v_and_b32 v89, 0xffff0000, v84
    v_lshlrev_b32_e64 v90, 16, v85
sk_112:
    buffer_load_dwordx4 v10, s[16:19], s96 offen offset:2048 lds
    s_cmp_lt_i32 s89, 0
    s_cbranch_scc1 sk_113
    v_and_b32 v91, 0xffff0000, v85
    v_add_f32 v24, v24, v88
    v_add_f32 v25, v25, v89
    v_add_f32 v26, v26, v90
    v_add_f32 v27, v27, v91
    v_lshlrev_b32_e64 v88, 16, v86
    v_and_b32 v89, 0xffff0000, v86
    v_lshlrev_b32_e64 v90, 16, v87
    v_and_b32 v91, 0xffff0000, v87
    v_add_f32 v28, v28, v88
    v_add_f32 v29, v29, v89
    v_add_f32 v30, v30, v90
    v_add_f32 v31, v31, v91
    v_permlane32_swap_b32 v24, v28
    v_permlane32_swap_b32 v25, v29
    v_permlane32_swap_b32 v26, v30
    v_permlane32_swap_b32 v27, v31
    v_add_f32 v24, v24, v28
    v_add_f32 v25, v25, v29
    v_add_f32_e64 v26, v26, v30
sk_113:
    buffer_load_dwordx4 v11, s[16:19], s96 offen offset:3072 lds
    s_cmp_lt_i32 s89, 0
    s_cbranch_scc1 sk_114
    v_add_f32 v27, v27, v31
    v_permlane16_swap_b32 v24, v26
    s_nop 0
    v_permlane16_swap_b32 v25, v27
    v_add_f32_e64 v24, v24, v26
    v_add_f32 v25, v25, v27
    s_nop 0
    v_add_f32_dpp v24, v24, v24 quad_perm:[2,3,0,1] row_mask:0xf bank_mask:0xf
    v_add_f32_dpp v25, v25, v25 quad_perm:[2,3,0,1] row_mask:0xf bank_mask:0xf
    s_nop 0
    v_add_f32_dpp v24, v24, v24 row_ror:4 row_mask:0xf bank_mask:0xf
    v_add_f32_dpp v25, v25, v25 row_ror:4 row_mask:0xf bank_mask:0xf
    s_nop 0
    v_add_f32_dpp v24, v24, v24 row_ror:8 row_mask:0xf bank_mask:0xf
    v_add_f32_dpp v25, v25, v25 row_ror:8 row_mask:0xf bank_mask:0xf
    v_fma_f32 v28, v24, v96, v92
    v_fma_f32 v29, v25, v96, v93
    v_cvt_pk_bf16_f32 v24, v28, v29
    v_cvt_pk_bf16_f32 v25, v28, v29
    v_cvt_pk_bf16_f32 v26, v28, v29
    v_cvt_pk_bf16_f32 v27, v28, v29
    v_permlane16_swap_b32 v24, v25
    s_nop 0
    v_permlane16_swap_b32 v26, v27
    s_nop 1
    v_permlane32_swap_b32_e64 v24, v26
    v_permlane32_swap_b32 v25, v27
sk_114:
    s_add_u32 m0, s87, 94208
    s_nop 0
    buffer_load_dwordx4 v12, s[16:19], s96 offen offset:0 lds
    s_mov_b32 s32, 0xdc4000
    s_lshl_b32 s33, s89, 4
    v_lshrrev_b32 v89, 1, v252
    v_and_or_b32 v88, v253, 16, s33
    v_lshl_or_b32 v88, v89, 11, v88
    buffer_load_dwordx4 v13, s[16:19], s96 offen offset:1024 lds
    s_mov_b64 exec, 65535
    buffer_store_dwordx4 v[24:27], v88, s[20:23], s32 offen sc1
    s_mov_b64 exec, -1
    s_waitcnt vmcnt(11) lgkmcnt(0)
    s_barrier
    s_add_u32 s96, s95, 15
    s_and_b32 s96, s96, 15
    s_lshl_b32 s97, s96, 14
    s_add_u32 s97, s97, s84
    s_add_u32 m0, s86, 147456
    s_nop 0
    buffer_load_dwordx4 v253, s[20:23], s97 offen offset:0 sc1 lds
    buffer_load_dwordx4 v253, s[20:23], s97 offen offset:1024 sc1 lds
    buffer_load_dwordx4 v253, s[20:23], s97 offen offset:2048 sc1 lds
    buffer_load_dwordx4 v253, s[20:23], s97 offen offset:3072 sc1 lds
    s_add_u32 s96, s95, 15
    s_and_b32 s96, s96, 15
    s_mul_i32 s96, s96, 393216
    s_add_u32 s96, s96, s85
    s_add_u32 m0, s87, 40960
    s_nop 0
    buffer_load_dwordx4 v8, s[16:19], s96 offen offset:0 lds
    buffer_load_dwordx4 v9, s[16:19], s96 offen offset:1024 lds
    buffer_load_dwordx4 v10, s[16:19], s96 offen offset:2048 lds
    buffer_load_dwordx4 v11, s[16:19], s96 offen offset:3072 lds
    s_add_u32 m0, s87, 45056
    s_nop 0
    buffer_load_dwordx4 v12, s[16:19], s96 offen offset:0 lds
    buffer_load_dwordx4 v13, s[16:19], s96 offen offset:1024 lds
    s_waitcnt vmcnt(11) lgkmcnt(0)
    s_barrier
    s_min_u32 s30, s28, 2
    s_lshl_b32 s30, s30, 13
    s_add_u32 s30, s30, 90112
    v_lshrrev_b32 v20, 2, v252
    v_bfe_u32 v21, v20, 1, 2
    v_lshlrev_b32_e64 v20, 7, v20
    v_lshl_add_u32 v20, v21, 5, v20
    v_and_b32_e64 v21, 3, v252
    v_lshl_add_u32 v20, v21, 3, v20
    v_add_u32 v144, s30, v20
    v_xor_b32 v145, 32, v144
    v_xor_b32_e64 v146, 64, v144
    v_xor_b32 v147, 96, v144
    ds_read_b64_tr_b16 v[100:101], v144 offset:0
    ds_read_b64_tr_b16 v[102:103], v144 offset:2048
    ds_read_b64_tr_b16 v[104:105], v144 offset:4096
    ds_read_b64_tr_b16 v[106:107], v144 offset:6144
    ds_read_b64_tr_b16 v[108:109], v145 offset:0
    ds_read_b64_tr_b16 v[110:111], v145 offset:2048
    ds_read_b64_tr_b16 v[112:113], v145 offset:4096
    ds_read_b64_tr_b16 v[114:115], v145 offset:6144
    ds_read_b64_tr_b16 v[116:117], v146 offset:0
    ds_read_b64_tr_b16 v[118:119], v146 offset:2048
    ds_read_b64_tr_b16 v[120:121], v146 offset:4096
    ds_read_b64_tr_b16 v[122:123], v146 offset:6144
    ds_read_b64_tr_b16 v[124:125], v147 offset:0
    ds_read_b64_tr_b16 v[126:127], v147 offset:2048
    ds_read_b64_tr_b16 v[128:129], v147 offset:4096
    ds_read_b64_tr_b16 v[130:131], v147 offset:6144
    s_getpc_b64 s[32:33]
pc_115:
    s_sub_u32 s32, s32, pc_115-interleave_layers__sliding_block__moe_arch_mod__prompt_kernel
    s_subb_u32 s33, s33, 0
    s_lshr_b32 s34, s2, 3
    s_lshl_b32 s34, s34, 2
    s_add_u32 s34, s34, s28
    s_and_b32 s34, s34, 127
    s_lshl_b32 s34, s34, 7
    v_lshl_add_u32 v154, v252, 14, s34
    s_mov_b32 s34, k_exit-interleave_layers__sliding_block__moe_arch_mod__prompt_kernel
    s_mov_b32 s35, 0x20000
    buffer_load_dword v154, v154, s[32:35], 0 offen
    s_waitcnt vmcnt(1) lgkmcnt(0)
    s_barrier
    s_add_u32 s35, s94, 14
    s_and_b32 s35, s35, 15
    s_lshl_b32 s35, s35, 7
    s_lshr_b32 vcc_lo, s24, 1
    s_lshl_b32 vcc_lo, vcc_lo, 11
    s_add_u32 vcc_lo, vcc_lo, s35
    s_add_u32 s35, vcc_lo, 0xdc4000
    v_and_b32_e64 v19, 32, v252
    v_bfe_u32 v18, v252, 4, 1
    v_lshl_add_u32 v19, v18, 3, v19
    buffer_load_dwordx2 v[132:133], v19, s[20:23], s35 offen offset:0 sc1
    buffer_load_dwordx2 v[134:135], v19, s[20:23], s35 offen offset:16 sc1
    buffer_load_dwordx2 v[136:137], v19, s[20:23], s35 offen offset:64 sc1
    buffer_load_dwordx2 v[138:139], v19, s[20:23], s35 offen offset:80 sc1
    s_cmp_eq_u32 s100, 0
    s_cbranch_scc1 sk_116
    v_and_b32 v20, 7, v252
    v_lshrrev_b32 v21, 4, v252
    v_lshl_add_u32 v21, v20, 2, v21
    s_and_b32 s34, s73, 31
    s_and_b32 s32, s34, 7
    s_and_b32 s33, s34, 8
    s_lshl_b32 s33, s33, 1
    s_add_u32 s32, s32, s33
    s_lshr_b32 s33, s34, 4
    s_lshl_b32 s33, s33, 3
    s_add_u32 s32, s32, s33
    s_cmp_eq_u32 s28, 1
    s_cselect_b32 s34, s32, s34
    v_mov_b32_e64 v20, s34
    s_cmp_ge_u32 s28, 2
    s_cselect_b64 vcc, -1, 0
    s_cselect_b32 s32, 2048, 0
    v_cndmask_b32 v30, v20, v21, vcc
    v_cndmask_b32 v31, v21, v20, vcc
    v_lshlrev_b32_e64 v0, 4, v30
    v_bfe_u32 v20, v31, 2, 2
    v_lshl_add_u32 v0, v20, 9, v0
    v_lshrrev_b32_e64 v20, 4, v31
    v_lshl_add_u32 v0, v20, 3, v0
    v_and_b32 v20, 3, v31
    v_lshl_add_u32 v0, v20, 1, v0
    s_lshl_b32 s33, s39, 12
    s_add_u32 s33, s33, s32
    s_add_u32 s33, s33, 65536
    s_lshl_b32 s34, s39, 11
    s_add_u32 s34, s34, 32768
    s_cmp_ge_u32 s39, 8
    s_cselect_b32 s38, 1, 0
    s_movk_i32 s32, 8192
    s_cmp_eq_u32 s28, 0
    s_cselect_b32 s33, s34, s33
    s_cselect_b32 s32, s32, 49152
    s_cselect_b32 s38, s38, 1
    s_cselect_b32 s37, 0x3e8293ee, 1.0
    v_bfe_u32 v20, v252, 3, 1
    v_mul_u32_u24_e64 v20, s32, v20
    v_add3_u32 v0, v0, v20, s33
sk_116:
    s_waitcnt lgkmcnt(0)
    s_barrier
    s_mov_b32 s78, s27
    s_waitcnt vmcnt(0)
    s_branch pc_118
    s_nop 0
pl_117:
    s_add_u32 s35, s94, 14
    s_and_b32 s35, s35, 15
    s_lshl_b32 s35, s35, 7
    s_lshr_b32 vcc_lo, s24, 1
    s_lshl_b32 vcc_lo, vcc_lo, 11
    s_add_u32 vcc_lo, vcc_lo, s35
    s_add_u32 s35, vcc_lo, 0xdc4000
    v_and_b32_e64 v19, 32, v252
    v_bfe_u32 v18, v252, 4, 1
    v_lshl_add_u32 v19, v18, 3, v19
    buffer_load_dwordx2 v[132:133], v19, s[20:23], s35 offen offset:0 sc1
    buffer_load_dwordx2 v[134:135], v19, s[20:23], s35 offen offset:16 sc1
    buffer_load_dwordx2 v[136:137], v19, s[20:23], s35 offen offset:64 sc1
    buffer_load_dwordx2 v[138:139], v19, s[20:23], s35 offen offset:80 sc1
    s_waitcnt vmcnt(0)
pc_118:
    v_max3_u32 v30, v132, v133, v134
    v_max3_u32 v30, v30, v135, v136
    v_max3_u32 v30, v30, v137, v138
    v_max_u32 v30, v30, v139
    v_cmp_eq_u32 vcc, -1, v30
    s_cbranch_vccz pd_119
    s_sub_u32 s78, s78, 1
    s_cmp_lg_u32 s78, 0
    s_cbranch_scc1 pl_117
    s_mov_b32 s27, 1
pd_119:
    v_mov_b32 v140, 0
    v_mov_b32 v141, 0
    v_mov_b32 v142, 0
    v_mov_b32 v143, 0
    v_dot2c_f32_bf16 v140, v132, v100
    v_dot2c_f32_bf16 v141, v132, v108
    v_dot2c_f32_bf16 v142, v132, v116
    v_dot2c_f32_bf16 v143, v132, v124
    v_dot2c_f32_bf16 v140, v133, v101
    v_dot2c_f32_bf16 v141, v133, v109
    v_dot2c_f32_bf16 v142, v133, v117
    v_dot2c_f32_bf16 v143, v133, v125
    v_dot2c_f32_bf16 v140, v134, v102
    v_dot2c_f32_bf16 v141, v134, v110
    v_dot2c_f32_bf16 v142, v134, v118
    v_dot2c_f32_bf16 v143, v134, v126
    v_dot2c_f32_bf16 v140, v135, v103
    v_dot2c_f32_bf16 v141, v135, v111
    v_dot2c_f32_bf16 v142, v135, v119
    v_dot2c_f32_bf16 v143, v135, v127
    v_dot2c_f32_bf16 v140, v136, v104
    v_dot2c_f32_bf16 v141, v136, v112
    v_dot2c_f32_bf16 v142, v136, v120
    v_dot2c_f32_bf16 v143, v136, v128
    v_dot2c_f32_bf16 v140, v137, v105
    v_dot2c_f32_bf16 v141, v137, v113
    v_dot2c_f32_bf16 v142, v137, v121
    v_dot2c_f32_bf16 v143, v137, v129
    v_dot2c_f32_bf16 v140, v138, v106
    v_dot2c_f32_bf16 v141, v138, v114
    v_dot2c_f32_bf16 v142, v138, v122
    v_dot2c_f32_bf16 v143, v138, v130
    v_dot2c_f32_bf16 v140, v139, v107
    v_dot2c_f32_bf16 v141, v139, v115
    v_dot2c_f32_bf16 v142, v139, v123
    v_dot2c_f32_bf16 v143, v139, v131
    s_min_u32 s32, s28, 2
    s_lshl_b32 s32, s32, 12
    s_lshl_b32 s33, s25, 14
    s_add_u32 s32, s32, s33
    s_add_u32 s32, s32, 0x1d80000
    s_lshl_b32 s33, s24, 8
    s_add_u32 s32, s32, s33
    v_lshlrev_b32 v20, 2, v252
    v_permlane32_swap_b32 v140, v142
    v_permlane32_swap_b32 v141, v143
    v_add_f32 v140, v140, v142
    v_add_f32 v141, v141, v143
    s_nop 1
    v_permlane16_swap_b32 v140, v141
    v_add_f32 v140, v140, v141
    buffer_store_dword v140, v20, s[20:23], s32 offen sc1
    s_branch l_att
    s_nop 0
l_patch:
    s_lshr_b32 vcc_lo, s24, 1
    s_lshl_b32 vcc_lo, vcc_lo, 11
    s_add_u32 s32, vcc_lo, 0xdc4000
    buffer_load_dwordx4 v[72:75], v253, s[20:23], s32 offen offset:0 sc1
    buffer_load_dwordx4 v[76:79], v253, s[20:23], s32 offen offset:1024 sc1
    s_min_u32 s32, s28, 2
    s_lshl_b32 s32, s32, 12
    s_lshl_b32 s33, s25, 14
    s_add_u32 s32, s32, s33
    s_add_u32 s32, s32, 0x1d80000
    buffer_load_dwordx4 v[56:59], v253, s[20:23], s32 offen offset:0 sc1
    buffer_load_dwordx4 v[60:63], v253, s[20:23], s32 offen offset:1024 sc1
    buffer_load_dwordx4 v[64:67], v253, s[20:23], s32 offen offset:2048 sc1
    buffer_load_dwordx4 v[68:71], v253, s[20:23], s32 offen offset:3072 sc1
    s_mov_b32 s78, s27
    s_waitcnt vmcnt(4)
    s_branch pc_121
    s_nop 0
pl_120:
    s_lshr_b32 vcc_lo, s24, 1
    s_lshl_b32 vcc_lo, vcc_lo, 11
    s_add_u32 s32, vcc_lo, 0xdc4000
    buffer_load_dwordx4 v[72:75], v253, s[20:23], s32 offen offset:0 sc1
    buffer_load_dwordx4 v[76:79], v253, s[20:23], s32 offen offset:1024 sc1
    s_waitcnt vmcnt(0)
pc_121:
    v_max3_u32 v82, v72, v73, v74
    v_max3_u32 v82, v82, v75, v76
    v_max3_u32 v82, v82, v77, v78
    v_max_u32 v82, v82, v79
    v_cmp_eq_u32 vcc, -1, v82
    s_cbranch_vccz pd_122
    s_sub_u32 s78, s78, 1
    s_cmp_lg_u32 s78, 0
    s_cbranch_scc1 pl_120
    s_mov_b32 s27, 1
pd_122:
    v_mov_b32 v80, 0
    v_mov_b32 v81, 0
    v_dot2c_f32_bf16 v80, 0x3f803f80, v72
    v_dot2c_f32_bf16 v81, v72, v72
    v_dot2c_f32_bf16 v80, 0x3f803f80, v73
    v_dot2c_f32_bf16 v81, v73, v73
    v_dot2c_f32_bf16 v80, 0x3f803f80, v74
    v_dot2c_f32_bf16 v81, v74, v74
    v_dot2c_f32_bf16 v80, 0x3f803f80, v75
    v_dot2c_f32_bf16 v81, v75, v75
    v_dot2c_f32_bf16 v80, 0x3f803f80, v76
    v_dot2c_f32_bf16 v81, v76, v76
    v_dot2c_f32_bf16 v80, 0x3f803f80, v77
    v_dot2c_f32_bf16 v81, v77, v77
    v_dot2c_f32_bf16 v80, 0x3f803f80, v78
    v_dot2c_f32_bf16 v81, v78, v78
    v_dot2c_f32_bf16 v80, 0x3f803f80, v79
    v_dot2c_f32_bf16 v81, v79, v79
    s_nop 1
    v_add_f32_dpp v80, v80, v80 quad_perm:[1,0,3,2] row_mask:0xf bank_mask:0xf
    v_add_f32_dpp v81, v81, v81 quad_perm:[1,0,3,2] row_mask:0xf bank_mask:0xf
    s_nop 0
    v_add_f32_dpp v80, v80, v80 quad_perm:[2,3,0,1] row_mask:0xf bank_mask:0xf
    v_add_f32_dpp v81, v81, v81 quad_perm:[2,3,0,1] row_mask:0xf bank_mask:0xf
    s_nop 0
    v_add_f32_dpp v80, v80, v80 row_half_mirror row_mask:0xf bank_mask:0xf
    v_add_f32_dpp v81, v81, v81 row_half_mirror row_mask:0xf bank_mask:0xf
    s_nop 0
    v_add_f32_dpp v80, v80, v80 row_mirror row_mask:0xf bank_mask:0xf
    v_add_f32_dpp v81, v81, v81 row_mirror row_mask:0xf bank_mask:0xf
    v_mov_b32 v82, v80
    v_mov_b32 v83, v81
    s_nop 0
    v_permlane16_swap_b32 v80, v82
    v_permlane16_swap_b32 v81, v83
    v_add_f32 v80, v80, v82
    v_add_f32 v81, v81, v83
    v_mov_b32 v82, v80
    v_mov_b32 v83, v81
    s_nop 0
    v_permlane32_swap_b32 v80, v82
    v_permlane32_swap_b32 v81, v83
    v_add_f32 v80, v80, v82
    v_add_f32 v81, v81, v83
    v_mul_f32 v80, 0x3a800000, v80
    v_mul_f32 v81, 0x3a800000, v81
    v_fma_f32 v81, -v80, v80, v81
    v_max_f32_e64 v81, 0, v81
    v_add_f32 v81, 0x3727c5ac, v81
    v_rsq_f32 v81, v81
    s_mov_b32 s78, s27
    s_waitcnt vmcnt(0)
    s_branch pc_124
    s_nop 0
pl_123:
    s_min_u32 s32, s28, 2
    s_lshl_b32 s32, s32, 12
    s_lshl_b32 s33, s25, 14
    s_add_u32 s32, s32, s33
    s_add_u32 s32, s32, 0x1d80000
    buffer_load_dwordx4 v[56:59], v253, s[20:23], s32 offen offset:0 sc1
    buffer_load_dwordx4 v[60:63], v253, s[20:23], s32 offen offset:1024 sc1
    buffer_load_dwordx4 v[64:67], v253, s[20:23], s32 offen offset:2048 sc1
    buffer_load_dwordx4 v[68:71], v253, s[20:23], s32 offen offset:3072 sc1
    s_waitcnt vmcnt(0)
pc_124:
    v_max3_u32 v82, v56, v57, v58
    v_max3_u32 v82, v82, v59, v60
    v_max3_u32 v82, v82, v61, v62
    v_max3_u32 v82, v82, v63, v64
    v_max3_u32 v82, v82, v65, v66
    v_max3_u32 v82, v82, v67, v68
    v_max3_u32 v82, v82, v69, v70
    v_max_u32_e64 v82, v82, v71
    v_cmp_eq_u32 vcc, -1, v82
    s_cbranch_vccz pd_125
    s_sub_u32 s78, s78, 1
    s_cmp_lg_u32 s78, 0
    s_cbranch_scc1 pl_123
    s_mov_b32 s27, 1
pd_125:
l_zok:
    v_pk_add_f32 v[56:57], v[56:57], v[60:61]
    v_pk_add_f32 v[58:59], v[58:59], v[62:63]
    v_pk_add_f32 v[56:57], v[56:57], v[64:65]
    v_pk_add_f32 v[58:59], v[58:59], v[66:67]
    v_pk_add_f32 v[56:57], v[56:57], v[68:69]
    v_pk_add_f32 v[58:59], v[58:59], v[70:71]
    s_nop 1
    v_permlane32_swap_b32 v56, v58
    v_permlane32_swap_b32 v57, v59
    v_add_f32 v56, v56, v58
    v_add_f32 v57, v57, v59
    s_nop 1
    v_permlane16_swap_b32 v56, v57
    v_add_f32 v56, v56, v57
    v_fma_f32 v56, -v80, v2, v56
    v_mul_f32 v81, s37, v81
    v_mul_f32 v56, v56, v81
    v_cvt_pk_bf16_f32 v1, v56, v56
    s_cmp_lg_u32 s100, 2
    s_cbranch_scc1 l_pmid
    s_cmp_lg_u32 s38, 0
    s_barrier
    s_cselect_b64 exec, -1, 0
    ds_write_b16 v0, v1
    s_mov_b64 exec, -1
    s_waitcnt lgkmcnt(0)
    s_barrier
    s_branch l_patched
    s_nop 0
l_tail:
    s_load_dwordx2 s[12:13], s[0:1], 64
    s_mov_b32 s14, 0x400000
    s_mov_b32 s15, 0x20000
    s_waitcnt lgkmcnt(0)
    v_mov_b32_e64 v20, 0
    s_or_b32 s34, s72, s28
    s_cmp_lg_u32 s34, 0
    s_cbranch_scc1 sk_126
    s_mov_b32 s34, 0xdd8000
    v_mov_b32 v154, s88
    s_mov_b64 exec, 1
    s_waitcnt vmcnt(0)
    buffer_store_dword v154, v253, s[20:23], s34 offen sc1
    s_mov_b64 exec, -1
sk_126:
    s_barrier
    ds_read_b128 v[16:19], v20 offset:3072
    s_waitcnt lgkmcnt(0)
    v_readlane_b32 s74, v16, 0
    v_readlane_b32 s73, v17, 0
    v_readlane_b32 s75, v18, 0
    v_readlane_b32 s76, v19, 0
    s_and_b32 s73, s73, 2047
    s_mov_b32 s78, s27
pl_127:
    s_lshr_b32 s33, s73, 5
    s_lshl_b32 s33, s33, 11
    s_add_u32 s33, s33, s79
    s_add_u32 s33, s33, 0xd60000
    buffer_load_dwordx4 v[24:27], v22, s[20:23], s33 offen sc1
    s_waitcnt vmcnt(0)
pc_128:
    v_max3_u32 v30, v24, v25, v26
    v_max_u32 v30, v30, v27
    v_cmp_eq_u32 vcc, -1, v30
    s_cbranch_vccz pd_129
    s_sub_u32 s78, s78, 1
    s_cmp_lg_u32 s78, 0
    s_cbranch_scc1 pl_127
    s_mov_b32 s27, 1
pd_129:
    s_cmp_ge_u32 s29, 224
    s_cbranch_scc1 l_tred
    v_mov_b32 v28, s76
    v_mul_f32 v29, s75, v28
    v_lshlrev_b32 v30, 16, v24
    v_and_b32 v31, 0xffff0000, v24
    v_fma_f32 v30, v30, v28, -v29
    v_fma_f32 v31, v31, v28, -v29
    v_cvt_pk_bf16_f32 v24, v30, v31
    v_lshlrev_b32_e64 v30, 16, v25
    v_and_b32 v31, 0xffff0000, v25
    v_fma_f32 v30, v30, v28, -v29
    v_fma_f32 v31, v31, v28, -v29
    v_cvt_pk_bf16_f32 v25, v30, v31
    v_lshlrev_b32_e64 v30, 16, v26
    v_and_b32 v31, 0xffff0000, v26
    v_fma_f32 v30, v30, v28, -v29
    v_fma_f32 v31, v31, v28, -v29
    v_cvt_pk_bf16_f32 v26, v30, v31
    v_lshlrev_b32 v30, 16, v27
    v_and_b32 v31, 0xffff0000, v27
    v_fma_f32 v30, v30, v28, -v29
    v_fma_f32 v31, v31, v28, -v29
    v_cvt_pk_bf16_f32 v27, v30, v31
    s_bitcmp0_b32 s29, 0
    s_cbranch_scc1 sk_130
    v_swap_b32 v24, v25
    v_swap_b32 v26, v27
sk_130:
    s_bitcmp0_b32 s29, 1
    s_cbranch_scc1 sk_131
    v_swap_b32 v24, v26
    v_swap_b32 v25, v27
sk_131:
    s_cmp_ge_u32 s29, 224
    s_cbranch_scc1 sk_132
    v_dot2_f32_bf16 v32, v155, v24, 0
    v_dot2_f32_bf16 v33, v160, v24, 0
    v_dot2_f32_bf16 v34, v156, v24, 0
    v_dot2_f32_bf16 v35, v161, v24, 0
    v_dot2_f32_bf16 v36, v157, v24, 0
    v_dot2_f32_bf16 v37, v162, v24, 0
    v_dot2_f32_bf16 v38, v158, v24, 0
    v_dot2_f32_bf16 v39, v163, v24, 0
    v_dot2_f32_bf16 v40, v183, v24, 0
    v_dot2_f32_bf16 v41, v192, v24, 0
    v_dot2_f32_bf16 v42, v188, v24, 0
    v_dot2_f32_bf16 v43, v193, v24, 0
    v_dot2_f32_bf16 v44, v189, v24, 0
    v_dot2_f32_bf16 v45, v194, v24, 0
    v_dot2_f32_bf16 v46, v190, v24, 0
    v_dot2_f32_bf16 v47, v195, v24, 0
    v_dot2_f32_bf16 v32, v159, v25, v32
    v_dot2_f32_bf16 v33, v168, v25, v33
    v_dot2_f32_bf16 v34, v164, v25, v34
    v_dot2_f32_bf16 v35, v169, v25, v35
    v_dot2_f32_bf16 v36, v165, v25, v36
    v_dot2_f32_bf16 v37, v170, v25, v37
    v_dot2_f32_bf16 v38, v166, v25, v38
    v_dot2_f32_bf16 v39, v171, v25, v39
    v_dot2_f32_bf16 v40, v191, v25, v40
    v_dot2_f32_bf16 v41, v200, v25, v41
    v_dot2_f32_bf16 v42, v196, v25, v42
    v_dot2_f32_bf16 v43, v201, v25, v43
    v_dot2_f32_bf16 v44, v197, v25, v44
    v_dot2_f32_bf16 v45, v202, v25, v45
    v_dot2_f32_bf16 v46, v198, v25, v46
    v_dot2_f32_bf16 v47, v203, v25, v47
    v_dot2_f32_bf16 v32, v167, v26, v32
    v_dot2_f32_bf16 v33, v176, v26, v33
    v_dot2_f32_bf16 v34, v172, v26, v34
    v_dot2_f32_bf16 v35, v177, v26, v35
    v_dot2_f32_bf16 v36, v173, v26, v36
    v_dot2_f32_bf16 v37, v178, v26, v37
    v_dot2_f32_bf16 v38, v174, v26, v38
    v_dot2_f32_bf16 v39, v179, v26, v39
    v_dot2_f32_bf16 v40, v199, v26, v40
    v_dot2_f32_bf16 v41, v208, v26, v41
    v_dot2_f32_bf16 v42, v204, v26, v42
    v_dot2_f32_bf16 v43, v209, v26, v43
    v_dot2_f32_bf16 v44, v205, v26, v44
    v_dot2_f32_bf16 v45, v210, v26, v45
    v_dot2_f32_bf16 v46, v206, v26, v46
    v_dot2_f32_bf16 v47, v211, v26, v47
    v_dot2_f32_bf16 v32, v175, v27, v32
    v_dot2_f32_bf16 v33, v184, v27, v33
    v_dot2_f32_bf16 v34, v180, v27, v34
    v_dot2_f32_bf16 v35, v185, v27, v35
    v_dot2_f32_bf16 v36, v181, v27, v36
    v_dot2_f32_bf16 v37, v186, v27, v37
    v_dot2_f32_bf16 v38, v182, v27, v38
    v_dot2_f32_bf16 v39, v187, v27, v39
    v_dot2_f32_bf16 v40, v207, v27, v40
    v_dot2_f32_bf16 v41, v216, v27, v41
    v_dot2_f32_bf16 v42, v212, v27, v42
    v_dot2_f32_bf16 v43, v217, v27, v43
    v_dot2_f32_bf16 v44, v213, v27, v44
    v_dot2_f32_bf16 v45, v218, v27, v45
    v_dot2_f32_bf16 v46, v214, v27, v46
    v_dot2_f32_bf16 v47, v219, v27, v47
sk_132:
    v_lshrrev_b32 v31, 5, v252
    v_lshlrev_b32 v30, 6, v31
    v_permlane32_swap_b32 v32, v40
    v_permlane32_swap_b32 v33, v41
    v_permlane32_swap_b32 v34, v42
    v_permlane32_swap_b32 v35, v43
    v_permlane32_swap_b32 v36, v44
    v_permlane32_swap_b32 v37, v45
    v_permlane32_swap_b32 v38, v46
    v_permlane32_swap_b32 v39, v47
    v_add_f32 v32, v32, v40
    v_add_f32 v33, v33, v41
    v_add_f32 v34, v34, v42
    v_add_f32 v35, v35, v43
    v_add_f32 v36, v36, v44
    v_add_f32 v37, v37, v45
    v_add_f32 v38, v38, v46
    v_add_f32 v39, v39, v47
    v_and_b32_e64 v31, 1, v252
    v_lshl_add_u32 v30, v31, 5, v30
    v_permlane16_swap_b32 v32, v36
    v_permlane16_swap_b32 v33, v37
    v_permlane16_swap_b32 v34, v38
    v_permlane16_swap_b32 v35, v39
    v_add_f32 v32, v32, v36
    v_add_f32 v33, v33, v37
    v_add_f32 v34, v34, v38
    v_add_f32 v35, v35, v39
    v_and_b32 v31, 16, v252
    s_lshl_b32 s32, s28, 7
    v_add3_u32 v30, v31, v30, s32
    v_add_f32_dpp v32, v32, v32 quad_perm:[2,3,0,1] row_mask:0xf bank_mask:0xf
    v_add_f32_dpp v33, v33, v33 quad_perm:[2,3,0,1] row_mask:0xf bank_mask:0xf
    v_add_f32_dpp v34, v34, v34 quad_perm:[2,3,0,1] row_mask:0xf bank_mask:0xf
    v_add_f32_dpp v35, v35, v35 quad_perm:[2,3,0,1] row_mask:0xf bank_mask:0xf
    v_add_f32_dpp v32, v32, v32 row_ror:4 row_mask:0xf bank_mask:0xf
    v_add_f32_dpp v33, v33, v33 row_ror:4 row_mask:0xf bank_mask:0xf
    v_add_f32_dpp v34, v34, v34 row_ror:4 row_mask:0xf bank_mask:0xf
    v_add_f32_dpp v35, v35, v35 row_ror:4 row_mask:0xf bank_mask:0xf
    v_add_f32_dpp v32, v32, v32 row_ror:8 row_mask:0xf bank_mask:0xf
    v_add_f32_dpp v33, v33, v33 row_ror:8 row_mask:0xf bank_mask:0xf
    v_add_f32_dpp v34, v34, v34 row_ror:8 row_mask:0xf bank_mask:0xf
    v_add_f32_dpp v35, v35, v35 row_ror:8 row_mask:0xf bank_mask:0xf
    s_mov_b32 exec_lo, 0x00030003
    s_mov_b32 exec_hi, 0x00030003
    ds_write_b128 v30, v[32:35] offset:3328
    s_mov_b64 exec, -1
    s_waitcnt lgkmcnt(0)
    s_barrier
    v_and_b32 v30, 1, v252
    v_bfe_u32 v31, v252, 1, 3
    v_lshl_add_u32 v30, v30, 3, v31
    v_lshlrev_b32_e64 v30, 2, v30
    v_add_u32 v30, 3328, v30
    ds_read2_b32 v[32:33], v30 offset0:0 offset1:16
    ds_read2_b32 v[34:35], v30 offset0:32 offset1:48
    ds_read2_b32 v[36:37], v30 offset0:64 offset1:80
    ds_read2_b32 v[38:39], v30 offset0:96 offset1:112
    v_lshrrev_b32_e64 v30, 2, v252
    v_mul_u32_u24 v30, 7168, v30
    v_and_b32_e64 v31, 2, v252
    v_lshl_add_u32 v30, v31, 3, v30
    s_add_u32 s32, s29, 32
    s_lshr_b32 s32, s32, 8
    v_lshl_add_u32 v30, s32, 31, v30
    s_mul_i32 s32, s28, 114688
    s_mul_i32 s33, s29, 32
    s_add_u32 s32, s32, s33
    s_add_u32 s32, s32, s79
    s_add_u32 s32, s32, 0xc80000
    s_waitcnt lgkmcnt(0)
    v_pk_add_f32 v[32:33], v[32:33], v[34:35]
    v_pk_add_f32 v[36:37], v[36:37], v[38:39]
    v_pk_add_f32 v[32:33], v[32:33], v[36:37]
    v_mul_f32 v34, 0xbfb8aa3b, v32
    v_exp_f32 v34, v34
    v_mul_f32 v32, v32, v33
    v_add_f32_e64 v34, 1.0, v34
    v_rcp_f32 v34, v34
    s_nop 0
    v_mul_f32 v32, v32, v34
    s_nop 1
    v_mov_b32_dpp v33, v32 quad_perm:[2,3,2,3] row_mask:0xf bank_mask:0xf
    v_cvt_pk_bf16_f32 v32, v32, v33
    ds_swizzle_b32 v36, v32 offset:0x1
    ds_swizzle_b32 v37, v32 offset:0x81
    ds_swizzle_b32 v38, v32 offset:0x101
    ds_swizzle_b32 v39, v32 offset:0x181
    s_waitcnt lgkmcnt(0)
    s_cmp_ge_u32 s29, 224
    s_cbranch_scc1 sk_133
    v_dot2_f32_bf16 v40, v215, v36, 0
    v_dot2_f32_bf16 v41, v224, v36, 0
    v_dot2_f32_bf16 v42, v220, v36, 0
    v_dot2_f32_bf16 v43, v225, v36, 0
    v_dot2_f32_bf16 v44, v221, v36, 0
    v_dot2_f32_bf16 v45, v226, v36, 0
    v_dot2_f32_bf16 v46, v222, v36, 0
    v_dot2_f32_bf16 v47, v227, v36, 0
    v_dot2_f32_bf16 v40, v223, v37, v40
    v_dot2_f32_bf16 v41, v232, v37, v41
    v_dot2_f32_bf16 v42, v228, v37, v42
    v_dot2_f32_bf16 v43, v233, v37, v43
    v_dot2_f32_bf16 v44, v229, v37, v44
    v_dot2_f32_bf16 v45, v234, v37, v45
    v_dot2_f32_bf16 v46, v230, v37, v46
    v_dot2_f32_bf16 v47, v235, v37, v47
    v_dot2_f32_bf16 v40, v231, v38, v40
    v_dot2_f32_bf16 v41, v240, v38, v41
    v_dot2_f32_bf16 v42, v236, v38, v42
    v_dot2_f32_bf16 v43, v241, v38, v43
    v_dot2_f32_bf16 v44, v237, v38, v44
    v_dot2_f32_bf16 v45, v242, v38, v45
    v_dot2_f32_bf16 v46, v238, v38, v46
    v_dot2_f32_bf16 v47, v243, v38, v47
    v_dot2_f32_bf16 v40, v239, v39, v40
    v_dot2_f32_bf16 v41, v248, v39, v41
    v_dot2_f32_bf16 v42, v244, v39, v42
    v_dot2_f32_bf16 v43, v249, v39, v43
    v_dot2_f32_bf16 v44, v245, v39, v44
    v_dot2_f32_bf16 v45, v250, v39, v45
    v_dot2_f32_bf16 v46, v246, v39, v46
    v_dot2_f32_bf16 v47, v251, v39, v47
sk_133:
    v_add_f32_dpp v40, v40, v40 quad_perm:[1,0,3,2] row_mask:0xf bank_mask:0xf
    v_add_f32_dpp v41, v41, v41 quad_perm:[1,0,3,2] row_mask:0xf bank_mask:0xf
    v_add_f32_dpp v42, v42, v42 quad_perm:[1,0,3,2] row_mask:0xf bank_mask:0xf
    v_add_f32_dpp v43, v43, v43 quad_perm:[1,0,3,2] row_mask:0xf bank_mask:0xf
    v_add_f32_dpp v44, v44, v44 quad_perm:[1,0,3,2] row_mask:0xf bank_mask:0xf
    v_add_f32_dpp v45, v45, v45 quad_perm:[1,0,3,2] row_mask:0xf bank_mask:0xf
    v_add_f32_dpp v46, v46, v46 quad_perm:[1,0,3,2] row_mask:0xf bank_mask:0xf
    v_add_f32_dpp v47, v47, v47 quad_perm:[1,0,3,2] row_mask:0xf bank_mask:0xf
    s_mov_b32 exec_lo, 0x55555555
    s_mov_b32 exec_hi, 0x55555555
    v_cvt_pk_bf16_f32 v40, v40, v41
    v_cvt_pk_bf16_f32 v41, v42, v43
    v_cvt_pk_bf16_f32 v42, v44, v45
    v_cvt_pk_bf16_f32 v43, v46, v47
    buffer_store_dwordx4 v[40:43], v30, s[20:23], s32 offen sc1
    s_mov_b64 exec, -1
    s_branch k_end
    s_nop 0
l_tred:
    s_cmp_lt_i32 s89, 0
    s_cbranch_scc1 k_end
    v_and_b32 v30, 16, v252
    v_cmp_eq_u32 vcc, 16, v30
    v_mov_b32 v28, s76
    v_mul_f32 v29, s75, v28
    v_add_f32 v28, 1.0, v28
    v_cndmask_b32 v30, v24, v25, vcc
    v_cndmask_b32 v31, v26, v27, vcc
    s_mov_b32 vcc_lo, 0xaaaaaaaa
    s_mov_b32 vcc_hi, 0xaaaaaaaa
    v_mov_b32 v96, 0xbfb8aa3b
    v_mul_f32 v96, s74, v96
    v_exp_f32 v96, v96
    v_cndmask_b32 v30, v30, v31, vcc
    v_lshlrev_b32 v92, 16, v30
    v_and_b32 v93, 0xffff0000, v30
    v_fma_f32 v92, v92, v28, -v29
    v_fma_f32 v93, v93, v28, -v29
    v_add_f32_e64 v96, 1.0, v96
    v_rcp_f32 v96, v96
    s_lshl_b32 s34, s73, 11
    s_lshl_b32 s33, s89, 4
    s_add_u32 s34, s34, s33
    s_mov_b32 s78, s27
pl_134:
    s_mul_i32 s32, s89, 3584
    s_add_u32 s32, s32, s79
    s_add_u32 s32, s32, 0xc80000
    buffer_load_dwordx4 v[60:63], v253, s[20:23], s32 offen offset:0 sc1
    buffer_load_dwordx4 v[64:67], v253, s[20:23], s32 offen offset:1024 sc1
    buffer_load_dwordx4 v[68:71], v253, s[20:23], s32 offen offset:2048 sc1
    buffer_load_dwordx4 v[72:75], v253, s[20:23], s32 offen offset:3072 sc1
    s_add_u32 s32, s32, 4096
    buffer_load_dwordx4 v[76:79], v253, s[20:23], s32 offen offset:0 sc1
    buffer_load_dwordx4 v[80:83], v253, s[20:23], s32 offen offset:1024 sc1
    buffer_load_dwordx4 v[84:87], v253, s[20:23], s32 offen offset:2048 sc1
    s_waitcnt vmcnt(0)
pc_135:
    v_max3_u32 v30, v60, v64, v68
    v_max3_u32 v30, v30, v72, v76
    v_max3_u32 v30, v30, v80, v84
    v_cmp_eq_u32 vcc, -1, v30
    s_cbranch_vccz pd_136
    s_sub_u32 s78, s78, 1
    s_cmp_lg_u32 s78, 0
    s_cbranch_scc1 pl_134
    s_mov_b32 s27, 1
pd_136:
    v_lshlrev_b32 v24, 16, v60
    v_and_b32 v25, 0xffff0000, v60
    v_lshlrev_b32_e64 v26, 16, v61
    v_and_b32 v27, 0xffff0000, v61
    v_lshlrev_b32_e64 v28, 16, v62
    v_and_b32 v29, 0xffff0000, v62
    v_lshlrev_b32_e64 v30, 16, v63
    v_and_b32 v31, 0xffff0000, v63
    v_lshlrev_b32_e64 v88, 16, v64
    v_and_b32 v89, 0xffff0000, v64
    v_lshlrev_b32_e64 v90, 16, v65
    v_and_b32 v91, 0xffff0000, v65
    v_pk_add_f32 v[24:25], v[24:25], v[88:89]
    v_pk_add_f32 v[26:27], v[26:27], v[90:91]
    v_lshlrev_b32_e64 v88, 16, v66
    v_and_b32 v89, 0xffff0000, v66
    v_lshlrev_b32_e64 v90, 16, v67
    v_and_b32 v91, 0xffff0000, v67
    v_pk_add_f32 v[28:29], v[28:29], v[88:89]
    v_pk_add_f32 v[30:31], v[30:31], v[90:91]
    v_lshlrev_b32_e64 v88, 16, v68
    v_and_b32 v89, 0xffff0000, v68
    v_lshlrev_b32_e64 v90, 16, v69
    v_and_b32 v91, 0xffff0000, v69
    v_pk_add_f32 v[24:25], v[24:25], v[88:89]
    v_pk_add_f32 v[26:27], v[26:27], v[90:91]
    v_lshlrev_b32_e64 v88, 16, v70
    v_and_b32 v89, 0xffff0000, v70
    v_lshlrev_b32_e64 v90, 16, v71
    v_and_b32 v91, 0xffff0000, v71
    v_pk_add_f32 v[28:29], v[28:29], v[88:89]
    v_pk_add_f32 v[30:31], v[30:31], v[90:91]
    v_lshlrev_b32_e64 v88, 16, v72
    v_and_b32 v89, 0xffff0000, v72
    v_lshlrev_b32_e64 v90, 16, v73
    v_and_b32 v91, 0xffff0000, v73
    v_pk_add_f32 v[24:25], v[24:25], v[88:89]
    v_pk_add_f32 v[26:27], v[26:27], v[90:91]
    v_lshlrev_b32_e64 v88, 16, v74
    v_and_b32 v89, 0xffff0000, v74
    v_lshlrev_b32_e64 v90, 16, v75
    v_and_b32 v91, 0xffff0000, v75
    v_pk_add_f32 v[28:29], v[28:29], v[88:89]
    v_pk_add_f32 v[30:31], v[30:31], v[90:91]
    v_lshlrev_b32_e64 v88, 16, v76
    v_and_b32 v89, 0xffff0000, v76
    v_lshlrev_b32_e64 v90, 16, v77
    v_and_b32 v91, 0xffff0000, v77
    v_pk_add_f32 v[24:25], v[24:25], v[88:89]
    v_pk_add_f32 v[26:27], v[26:27], v[90:91]
    v_lshlrev_b32_e64 v88, 16, v78
    v_and_b32 v89, 0xffff0000, v78
    v_lshlrev_b32_e64 v90, 16, v79
    v_and_b32 v91, 0xffff0000, v79
    v_pk_add_f32 v[28:29], v[28:29], v[88:89]
    v_pk_add_f32 v[30:31], v[30:31], v[90:91]
    v_lshlrev_b32_e64 v88, 16, v80
    v_and_b32 v89, 0xffff0000, v80
    v_lshlrev_b32_e64 v90, 16, v81
    v_and_b32 v91, 0xffff0000, v81
    v_pk_add_f32 v[24:25], v[24:25], v[88:89]
    v_pk_add_f32 v[26:27], v[26:27], v[90:91]
    v_lshlrev_b32_e64 v88, 16, v82
    v_and_b32 v89, 0xffff0000, v82
    v_lshlrev_b32_e64 v90, 16, v83
    v_and_b32 v91, 0xffff0000, v83
    v_pk_add_f32 v[28:29], v[28:29], v[88:89]
    v_pk_add_f32 v[30:31], v[30:31], v[90:91]
    v_lshlrev_b32_e64 v88, 16, v84
    v_and_b32 v89, 0xffff0000, v84
    v_lshlrev_b32_e64 v90, 16, v85
    v_and_b32 v91, 0xffff0000, v85
    v_pk_add_f32 v[24:25], v[24:25], v[88:89]
    v_pk_add_f32 v[26:27], v[26:27], v[90:91]
    v_lshlrev_b32_e64 v88, 16, v86
    v_and_b32 v89, 0xffff0000, v86
    v_lshlrev_b32_e64 v90, 16, v87
    v_and_b32 v91, 0xffff0000, v87
    v_pk_add_f32 v[28:29], v[28:29], v[88:89]
    v_pk_add_f32 v[30:31], v[30:31], v[90:91]
    s_nop 0
    v_permlane32_swap_b32 v24, v28
    v_permlane32_swap_b32 v25, v29
    v_permlane32_swap_b32 v26, v30
    v_permlane32_swap_b32 v27, v31
    v_add_f32 v24, v24, v28
    v_add_f32 v25, v25, v29
    v_add_f32 v26, v26, v30
    v_add_f32 v27, v27, v31
    s_nop 0
    v_permlane16_swap_b32 v24, v26
    v_permlane16_swap_b32 v25, v27
    v_add_f32_e64 v24, v24, v26
    v_add_f32 v25, v25, v27
    s_nop 0
    v_add_f32_dpp v24, v24, v24 quad_perm:[2,3,0,1] row_mask:0xf bank_mask:0xf
    v_add_f32_dpp v25, v25, v25 quad_perm:[2,3,0,1] row_mask:0xf bank_mask:0xf
    s_nop 0
    v_add_f32_dpp v24, v24, v24 row_ror:4 row_mask:0xf bank_mask:0xf
    v_add_f32_dpp v25, v25, v25 row_ror:4 row_mask:0xf bank_mask:0xf
    s_nop 0
    v_add_f32_dpp v24, v24, v24 row_ror:8 row_mask:0xf bank_mask:0xf
    v_add_f32_dpp v25, v25, v25 row_ror:8 row_mask:0xf bank_mask:0xf
    v_fma_f32 v28, v24, v96, v92
    v_fma_f32 v29, v25, v96, v93
    v_cvt_pk_bf16_f32 v24, v28, v29
    v_cvt_pk_bf16_f32 v25, v28, v29
    v_cvt_pk_bf16_f32 v26, v28, v29
    v_cvt_pk_bf16_f32 v27, v28, v29
    v_permlane16_swap_b32 v24, v25
    s_nop 0
    v_permlane16_swap_b32 v26, v27
    s_nop 1
    v_permlane32_swap_b32_e64 v24, v26
    v_permlane32_swap_b32 v25, v27
    s_mov_b64 exec, 3
    buffer_store_dwordx4 v[24:27], v253, s[12:15], s34 offen sc1
    s_mov_b64 exec, -1
k_end:
k_exit:
    s_endpgm
    s_nop 0
att_exact0:
    s_waitcnt lgkmcnt(0)
    v_mov_b32 v20, 0xffff
    v_mov_b32 v21, 0xffff0000
    v_cndmask_b32 v22, 0, v20, s[40:41]
    v_cndmask_b32 v23, 0, v21, s[42:43]
    v_or_b32_e64 v12, v22, v23
    v_cndmask_b32 v22, 0, v20, s[44:45]
    v_cndmask_b32 v23, 0, v21, s[46:47]
    v_or_b32_e64 v13, v22, v23
    v_cndmask_b32 v22, 0, v20, s[48:49]
    v_cndmask_b32 v23, 0, v21, s[50:51]
    v_or_b32_e64 v14, v22, v23
    v_cndmask_b32 v22, 0, v20, s[52:53]
    v_cndmask_b32 v23, 0, v21, s[54:55]
    v_or_b32_e64 v15, v22, v23
    v_cndmask_b32 v22, 0, v20, s[56:57]
    v_cndmask_b32 v23, 0, v21, s[58:59]
    v_or_b32_e64 v16, v22, v23
    v_cndmask_b32 v22, 0, v20, s[60:61]
    v_cndmask_b32 v23, 0, v21, s[62:63]
    v_or_b32_e64 v17, v22, v23
    v_cndmask_b32 v22, 0, v20, s[64:65]
    v_cndmask_b32 v23, 0, v21, s[66:67]
    v_or_b32_e64 v18, v22, v23
    v_cndmask_b32 v22, 0, v20, s[68:69]
    v_cndmask_b32 v23, 0, v21, s[70:71]
    v_or_b32_e64 v19, v22, v23
    s_and_b32 s34, s76, 3
    s_lshl_b32 s33, s34, 12
    s_add_u32 s33, s33, 65536
    v_add_u32 v20, s33, v253
    v_mov_b32 v24, 0
    v_mov_b32 v25, 0
    v_mov_b32 v26, 0
    v_mov_b32 v27, 0
    v_mov_b32 v28, 0
    v_mov_b32 v29, 0
    v_mov_b32 v30, 0
    v_mov_b32 v31, 0
    v_mov_b32 v32, 0
    v_mov_b32 v33, 0
    v_mov_b32 v34, 0
    v_mov_b32 v35, 0
    v_mov_b32 v36, 0
    v_mov_b32 v37, 0
    v_mov_b32 v38, 0
    v_mov_b32 v39, 0
    ds_read_b128 v[104:107], v20 offset:32768
    ds_read_b128 v[108:111], v20 offset:33792
    ds_read_b128 v[112:115], v20 offset:28672
    ds_read_b128 v[116:119], v20 offset:29696
    s_waitcnt lgkmcnt(2)
    v_mfma_f32_32x32x16_bf16 v[40:55], v[104:107], v[4:7], 0
    v_mfma_f32_32x32x16_bf16 v[40:55], v[108:111], v[8:11], v[40:55]
    ds_read_b128 v[104:107], v20 offset:24576
    ds_read_b128 v[108:111], v20 offset:25600
    s_cmp_eq_u32 s76, 0
    s_cbranch_scc0 ng_137
    v_mov_b32 v24, 0xf149f2ca
    v_mov_b32 v25, 0xf149f2ca
    v_mov_b32 v26, 0xf149f2ca
    v_mov_b32 v27, 0xf149f2ca
    v_mov_b32 v28, 0xf149f2ca
    v_mov_b32 v29, 0xf149f2ca
    v_mov_b32 v30, 0xf149f2ca
    v_mov_b32 v31, 0xf149f2ca
    v_mov_b32 v32, 0xf149f2ca
    v_mov_b32 v33, 0xf149f2ca
    v_mov_b32 v34, 0xf149f2ca
    v_mov_b32 v35, 0xf149f2ca
    v_mov_b32 v36, 0xf149f2ca
    v_mov_b32 v37, 0xf149f2ca
    v_mov_b32 v38, 0xf149f2ca
    v_mov_b32 v39, 0xf149f2ca
ng_137:
    s_waitcnt lgkmcnt(2)
    s_nop 0
    v_mfma_f32_32x32x16_bf16 v[72:87], v[112:115], v[4:7], v[24:39]
    v_mfma_f32_32x32x16_bf16 v[72:87], v[116:119], v[8:11], v[72:87]
    ds_read_b128 v[112:115], v20 offset:20480
    ds_read_b128 v[116:119], v20 offset:21504
    s_cmp_eq_u32 s76, 1
    s_cbranch_scc0 ng_138
    s_nop 1
    v_mov_b32 v24, 0xf149f2ca
    v_mov_b32 v25, 0xf149f2ca
    v_mov_b32 v26, 0xf149f2ca
    v_mov_b32 v27, 0xf149f2ca
    v_mov_b32 v28, 0xf149f2ca
    v_mov_b32 v29, 0xf149f2ca
    v_mov_b32 v30, 0xf149f2ca
    v_mov_b32 v31, 0xf149f2ca
    v_mov_b32 v32, 0xf149f2ca
    v_mov_b32 v33, 0xf149f2ca
    v_mov_b32 v34, 0xf149f2ca
    v_mov_b32 v35, 0xf149f2ca
    v_mov_b32 v36, 0xf149f2ca
    v_mov_b32 v37, 0xf149f2ca
    v_mov_b32 v38, 0xf149f2ca
    v_mov_b32 v39, 0xf149f2ca
ng_138:
    s_waitcnt lgkmcnt(2)
    s_nop 0
    v_mfma_f32_32x32x16_bf16 v[56:71], v[104:107], v[4:7], v[24:39]
    v_mfma_f32_32x32x16_bf16 v[56:71], v[108:111], v[8:11], v[56:71]
    s_nop 3
    v_max_f32_e64 v21, v72, v73
    v_max3_f32 v21, v21, v74, v75
    v_max3_f32 v21, v21, v76, v77
    v_max3_f32 v21, v21, v78, v79
    v_max3_f32 v21, v21, v80, v81
    v_max3_f32 v21, v21, v82, v83
    v_max3_f32 v21, v21, v84, v85
    v_max3_f32 v21, v21, v86, v87
    ds_read_b128 v[104:107], v20 offset:16384
    ds_read_b128 v[108:111], v20 offset:17408
    s_cmp_eq_u32 s76, 2
    s_cbranch_scc0 ng_139
    v_mov_b32 v24, 0xf149f2ca
    v_mov_b32 v25, 0xf149f2ca
    v_mov_b32 v26, 0xf149f2ca
    v_mov_b32 v27, 0xf149f2ca
    v_mov_b32 v28, 0xf149f2ca
    v_mov_b32 v29, 0xf149f2ca
    v_mov_b32 v30, 0xf149f2ca
    v_mov_b32 v31, 0xf149f2ca
    v_mov_b32 v32, 0xf149f2ca
    v_mov_b32 v33, 0xf149f2ca
    v_mov_b32 v34, 0xf149f2ca
    v_mov_b32 v35, 0xf149f2ca
    v_mov_b32 v36, 0xf149f2ca
    v_mov_b32 v37, 0xf149f2ca
    v_mov_b32 v38, 0xf149f2ca
    v_mov_b32 v39, 0xf149f2ca
ng_139:
    s_waitcnt lgkmcnt(2)
    s_nop 0
    v_mfma_f32_32x32x16_bf16 v[72:87], v[112:115], v[4:7], v[24:39]
    v_mfma_f32_32x32x16_bf16 v[72:87], v[116:119], v[8:11], v[72:87]
    v_max3_f32 v21, v21, v56, v57
    v_max3_f32 v21, v21, v58, v59
    v_max3_f32 v21, v21, v60, v61
    v_max3_f32 v21, v21, v62, v63
    v_max3_f32 v21, v21, v64, v65
    v_max3_f32 v21, v21, v66, v67
    v_max3_f32 v21, v21, v68, v69
    v_max3_f32 v21, v21, v70, v71
    ds_read_b128 v[112:115], v20 offset:12288
    ds_read_b128 v[116:119], v20 offset:13312
    s_cmp_eq_u32 s76, 3
    s_cbranch_scc0 ng_140
    v_mov_b32 v24, 0xf149f2ca
    v_mov_b32 v25, 0xf149f2ca
    v_mov_b32 v26, 0xf149f2ca
    v_mov_b32 v27, 0xf149f2ca
    v_mov_b32 v28, 0xf149f2ca
    v_mov_b32 v29, 0xf149f2ca
    v_mov_b32 v30, 0xf149f2ca
    v_mov_b32 v31, 0xf149f2ca
    v_mov_b32 v32, 0xf149f2ca
    v_mov_b32 v33, 0xf149f2ca
    v_mov_b32 v34, 0xf149f2ca
    v_mov_b32 v35, 0xf149f2ca
    v_mov_b32 v36, 0xf149f2ca
    v_mov_b32 v37, 0xf149f2ca
    v_mov_b32 v38, 0xf149f2ca
    v_mov_b32 v39, 0xf149f2ca
ng_140:
    s_waitcnt lgkmcnt(2)
    s_nop 0
    v_mfma_f32_32x32x16_bf16 v[56:71], v[104:107], v[4:7], v[24:39]
    v_mfma_f32_32x32x16_bf16 v[56:71], v[108:111], v[8:11], v[56:71]
    v_max3_f32 v21, v21, v72, v73
    v_max3_f32 v21, v21, v74, v75
    v_max3_f32 v21, v21, v76, v77
    v_max3_f32 v21, v21, v78, v79
    v_max3_f32 v21, v21, v80, v81
    v_max3_f32 v21, v21, v82, v83
    v_max3_f32 v21, v21, v84, v85
    v_max3_f32 v21, v21, v86, v87
    ds_read_b128 v[104:107], v20 offset:8192
    ds_read_b128 v[108:111], v20 offset:9216
    s_cmp_eq_u32 s76, 4
    s_cbranch_scc0 ng_141
    v_mov_b32 v24, 0xf149f2ca
    v_mov_b32 v25, 0xf149f2ca
    v_mov_b32 v26, 0xf149f2ca
    v_mov_b32 v27, 0xf149f2ca
    v_mov_b32 v28, 0xf149f2ca
    v_mov_b32 v29, 0xf149f2ca
    v_mov_b32 v30, 0xf149f2ca
    v_mov_b32 v31, 0xf149f2ca
    v_mov_b32 v32, 0xf149f2ca
    v_mov_b32 v33, 0xf149f2ca
    v_mov_b32 v34, 0xf149f2ca
    v_mov_b32 v35, 0xf149f2ca
    v_mov_b32 v36, 0xf149f2ca
    v_mov_b32 v37, 0xf149f2ca
    v_mov_b32 v38, 0xf149f2ca
    v_mov_b32 v39, 0xf149f2ca
ng_141:
    s_waitcnt lgkmcnt(2)
    s_nop 0
    v_mfma_f32_32x32x16_bf16 v[72:87], v[112:115], v[4:7], v[24:39]
    v_mfma_f32_32x32x16_bf16 v[72:87], v[116:119], v[8:11], v[72:87]
    v_max3_f32 v21, v21, v56, v57
    v_max3_f32 v21, v21, v58, v59
    v_max3_f32 v21, v21, v60, v61
    v_max3_f32 v21, v21, v62, v63
    v_max3_f32 v21, v21, v64, v65
    v_max3_f32 v21, v21, v66, v67
    v_max3_f32 v21, v21, v68, v69
    v_max3_f32 v21, v21, v70, v71
    ds_read_b128 v[112:115], v20 offset:4096
    ds_read_b128 v[116:119], v20 offset:5120
    s_cmp_eq_u32 s76, 5
    s_cbranch_scc0 ng_142
    v_mov_b32 v24, 0xf149f2ca
    v_mov_b32 v25, 0xf149f2ca
    v_mov_b32 v26, 0xf149f2ca
    v_mov_b32 v27, 0xf149f2ca
    v_mov_b32 v28, 0xf149f2ca
    v_mov_b32 v29, 0xf149f2ca
    v_mov_b32 v30, 0xf149f2ca
    v_mov_b32 v31, 0xf149f2ca
    v_mov_b32 v32, 0xf149f2ca
    v_mov_b32 v33, 0xf149f2ca
    v_mov_b32 v34, 0xf149f2ca
    v_mov_b32 v35, 0xf149f2ca
    v_mov_b32 v36, 0xf149f2ca
    v_mov_b32 v37, 0xf149f2ca
    v_mov_b32 v38, 0xf149f2ca
    v_mov_b32 v39, 0xf149f2ca
ng_142:
    s_waitcnt lgkmcnt(2)
    s_nop 0
    v_mfma_f32_32x32x16_bf16 v[56:71], v[104:107], v[4:7], v[24:39]
    v_mfma_f32_32x32x16_bf16 v[56:71], v[108:111], v[8:11], v[56:71]
    v_max3_f32 v21, v21, v72, v73
    v_max3_f32 v21, v21, v74, v75
    v_max3_f32 v21, v21, v76, v77
    v_max3_f32 v21, v21, v78, v79
    v_max3_f32 v21, v21, v80, v81
    v_max3_f32 v21, v21, v82, v83
    v_max3_f32 v21, v21, v84, v85
    v_max3_f32 v21, v21, v86, v87
    ds_read_b128 v[104:107], v20 offset:0
    ds_read_b128 v[108:111], v20 offset:1024
    s_cmp_eq_u32 s76, 6
    s_cbranch_scc0 ng_143
    v_mov_b32 v24, 0xf149f2ca
    v_mov_b32 v25, 0xf149f2ca
    v_mov_b32 v26, 0xf149f2ca
    v_mov_b32 v27, 0xf149f2ca
    v_mov_b32 v28, 0xf149f2ca
    v_mov_b32 v29, 0xf149f2ca
    v_mov_b32 v30, 0xf149f2ca
    v_mov_b32 v31, 0xf149f2ca
    v_mov_b32 v32, 0xf149f2ca
    v_mov_b32 v33, 0xf149f2ca
    v_mov_b32 v34, 0xf149f2ca
    v_mov_b32 v35, 0xf149f2ca
    v_mov_b32 v36, 0xf149f2ca
    v_mov_b32 v37, 0xf149f2ca
    v_mov_b32 v38, 0xf149f2ca
    v_mov_b32 v39, 0xf149f2ca
ng_143:
    s_waitcnt lgkmcnt(2)
    s_nop 0
    v_mfma_f32_32x32x16_bf16 v[72:87], v[112:115], v[4:7], v[24:39]
    v_mfma_f32_32x32x16_bf16 v[72:87], v[116:119], v[8:11], v[72:87]
    v_max3_f32 v21, v21, v56, v57
    v_max3_f32 v21, v21, v58, v59
    v_max3_f32 v21, v21, v60, v61
    v_max3_f32 v21, v21, v62, v63
    v_max3_f32 v21, v21, v64, v65
    v_max3_f32 v21, v21, v66, v67
    v_max3_f32 v21, v21, v68, v69
    v_max3_f32 v21, v21, v70, v71
    s_cmp_eq_u32 s76, 7
    s_cbranch_scc0 ng_144
    v_mov_b32 v24, 0xf149f2ca
    v_mov_b32 v25, 0xf149f2ca
    v_mov_b32 v26, 0xf149f2ca
    v_mov_b32 v27, 0xf149f2ca
    v_mov_b32 v28, 0xf149f2ca
    v_mov_b32 v29, 0xf149f2ca
    v_mov_b32 v30, 0xf149f2ca
    v_mov_b32 v31, 0xf149f2ca
    v_mov_b32 v32, 0xf149f2ca
    v_mov_b32 v33, 0xf149f2ca
    v_mov_b32 v34, 0xf149f2ca
    v_mov_b32 v35, 0xf149f2ca
    v_mov_b32 v36, 0xf149f2ca
    v_mov_b32 v37, 0xf149f2ca
    v_mov_b32 v38, 0xf149f2ca
    v_mov_b32 v39, 0xf149f2ca
ng_144:
    s_waitcnt lgkmcnt(0)
    s_nop 0
    v_mfma_f32_32x32x16_bf16 v[56:71], v[104:107], v[4:7], v[24:39]
    v_mfma_f32_32x32x16_bf16 v[56:71], v[108:111], v[8:11], v[56:71]
    v_max3_f32 v21, v21, v72, v73
    v_max3_f32 v21, v21, v74, v75
    v_max3_f32 v21, v21, v76, v77
    v_max3_f32 v21, v21, v78, v79
    v_max3_f32 v21, v21, v80, v81
    v_max3_f32 v21, v21, v82, v83
    v_max3_f32 v21, v21, v84, v85
    v_max3_f32 v21, v21, v86, v87
    ds_read_b128 v[112:115], v20 offset:28672
    ds_read_b128 v[116:119], v20 offset:29696
    ds_read_b128 v[120:123], v20 offset:34816
    ds_read_b128 v[124:127], v20 offset:35840
    ds_read_b128 v[128:131], v20 offset:2048
    ds_read_b128 v[132:135], v20 offset:3072
    v_cndmask_b32 v40, v56, v40, s[40:41]
    v_cndmask_b32 v41, v57, v41, s[42:43]
    v_cndmask_b32 v42, v58, v42, s[44:45]
    v_cndmask_b32 v43, v59, v43, s[46:47]
    v_cndmask_b32 v44, v60, v44, s[48:49]
    v_cndmask_b32 v45, v61, v45, s[50:51]
    v_cndmask_b32 v46, v62, v46, s[52:53]
    v_cndmask_b32 v47, v63, v47, s[54:55]
    v_cndmask_b32 v48, v64, v48, s[56:57]
    v_cndmask_b32 v49, v65, v49, s[58:59]
    v_cndmask_b32 v50, v66, v50, s[60:61]
    v_cndmask_b32 v51, v67, v51, s[62:63]
    v_cndmask_b32 v52, v68, v52, s[64:65]
    v_cndmask_b32 v53, v69, v53, s[66:67]
    v_cndmask_b32 v54, v70, v54, s[68:69]
    v_cndmask_b32 v55, v71, v55, s[70:71]
    v_max3_f32 v21, v21, v40, v41
    v_max3_f32 v21, v21, v42, v43
    v_max3_f32 v21, v21, v44, v45
    v_max3_f32 v21, v21, v46, v47
    v_max3_f32 v21, v21, v48, v49
    v_max3_f32 v21, v21, v50, v51
    v_max3_f32 v21, v21, v52, v53
    v_max3_f32 v21, v21, v54, v55
    v_mov_b32 v152, v21
    s_nop 1
    v_permlane32_swap_b32 v21, v152
    v_max_f32 v21, v21, v152
    v_sub_f32 v24, 0, v21
    v_sub_f32 v25, 0, v21
    v_sub_f32 v26, 0, v21
    v_sub_f32 v27, 0, v21
    v_sub_f32 v28, 0, v21
    v_sub_f32 v29, 0, v21
    v_sub_f32 v30, 0, v21
    v_sub_f32 v31, 0, v21
    v_sub_f32 v32, 0, v21
    v_sub_f32 v33, 0, v21
    v_sub_f32 v34, 0, v21
    v_sub_f32 v35, 0, v21
    v_sub_f32 v36, 0, v21
    v_sub_f32 v37, 0, v21
    v_sub_f32 v38, 0, v21
    v_sub_f32 v39, 0, v21
    s_cmp_eq_u32 s76, 0
    s_cbranch_scc0 ng_145
    v_mov_b32 v24, 0xf149f2ca
    v_mov_b32 v25, 0xf149f2ca
    v_mov_b32 v26, 0xf149f2ca
    v_mov_b32 v27, 0xf149f2ca
    v_mov_b32 v28, 0xf149f2ca
    v_mov_b32 v29, 0xf149f2ca
    v_mov_b32 v30, 0xf149f2ca
    v_mov_b32 v31, 0xf149f2ca
    v_mov_b32 v32, 0xf149f2ca
    v_mov_b32 v33, 0xf149f2ca
    v_mov_b32 v34, 0xf149f2ca
    v_mov_b32 v35, 0xf149f2ca
    v_mov_b32 v36, 0xf149f2ca
    v_mov_b32 v37, 0xf149f2ca
    v_mov_b32 v38, 0xf149f2ca
    v_mov_b32 v39, 0xf149f2ca
ng_145:
    s_waitcnt lgkmcnt(4)
    s_nop 0
    v_mfma_f32_32x32x16_bf16 v[72:87], v[112:115], v[4:7], v[24:39]
    v_mfma_f32_32x32x16_bf16 v[72:87], v[116:119], v[8:11], v[72:87]
    ds_read_b128 v[104:107], v20 offset:24576
    ds_read_b128 v[108:111], v20 offset:25600
    v_sub_f32 v40, v40, v21
    v_sub_f32 v41, v41, v21
    v_sub_f32 v42, v42, v21
    v_sub_f32 v43, v43, v21
    v_sub_f32 v44, v44, v21
    v_sub_f32 v45, v45, v21
    v_sub_f32 v46, v46, v21
    v_sub_f32 v47, v47, v21
    v_sub_f32 v48, v48, v21
    v_sub_f32 v49, v49, v21
    v_sub_f32 v50, v50, v21
    v_sub_f32 v51, v51, v21
    v_sub_f32 v52, v52, v21
    v_sub_f32 v53, v53, v21
    v_sub_f32 v54, v54, v21
    v_sub_f32 v55, v55, v21
    v_exp_f32 v40, v40
    v_exp_f32 v41, v41
    v_exp_f32 v42, v42
    v_exp_f32 v43, v43
    v_exp_f32 v44, v44
    v_exp_f32 v45, v45
    v_exp_f32 v46, v46
    v_exp_f32 v47, v47
    v_exp_f32 v48, v48
    v_exp_f32 v49, v49
    v_exp_f32 v50, v50
    v_exp_f32 v51, v51
    v_exp_f32 v52, v52
    v_exp_f32 v53, v53
    v_exp_f32 v54, v54
    v_exp_f32 v55, v55
    v_add_f32 v22, v40, v41
    v_add_f32 v23, v42, v43
    v_add_f32 v22, v22, v44
    v_add_f32 v23, v23, v45
    v_add_f32 v22, v22, v46
    v_add_f32 v23, v23, v47
    v_add_f32 v22, v22, v48
    v_add_f32 v23, v23, v49
    v_add_f32 v22, v22, v50
    v_add_f32 v23, v23, v51
    v_add_f32 v22, v22, v52
    v_add_f32 v23, v23, v53
    v_add_f32 v22, v22, v54
    v_add_f32 v23, v23, v55
    v_cvt_pk_bf16_f32 v144, v40, v41
    v_cvt_pk_bf16_f32 v145, v42, v43
    v_cvt_pk_bf16_f32 v146, v44, v45
    v_cvt_pk_bf16_f32 v147, v46, v47
    v_cvt_pk_bf16_f32 v148, v48, v49
    v_cvt_pk_bf16_f32 v149, v50, v51
    v_cvt_pk_bf16_f32 v150, v52, v53
    v_cvt_pk_bf16_f32 v151, v54, v55
    v_and_b32 v136, v144, v12
    v_and_b32 v137, v145, v13
    v_and_b32 v138, v146, v14
    v_and_b32 v139, v147, v15
    v_and_b32 v140, v148, v16
    v_and_b32 v141, v149, v17
    v_and_b32 v142, v150, v18
    v_and_b32 v143, v151, v19
    v_xor_b32 v144, v144, v136
    v_xor_b32 v145, v145, v137
    v_xor_b32 v146, v146, v138
    v_xor_b32 v147, v147, v139
    v_xor_b32 v148, v148, v140
    v_xor_b32 v149, v149, v141
    v_xor_b32_e64 v150, v150, v142
    v_xor_b32 v151, v151, v143
    s_waitcnt lgkmcnt(2)
    v_mfma_f32_32x32x16_bf16 v[88:103], v[120:123], v[136:139], 0
    v_mfma_f32_32x32x16_bf16 v[88:103], v[124:127], v[140:143], v[88:103]
    v_mfma_f32_32x32x16_bf16 v[88:103], v[128:131], v[144:147], v[88:103]
    v_mfma_f32_32x32x16_bf16 v[88:103], v[132:135], v[148:151], v[88:103]
    ds_read_b128 v[128:131], v20 offset:30720
    ds_read_b128 v[132:135], v20 offset:31744
    s_cmp_eq_u32 s76, 1
    s_cbranch_scc0 ng_146
    v_mov_b32 v24, 0xf149f2ca
    v_mov_b32 v25, 0xf149f2ca
    v_mov_b32 v26, 0xf149f2ca
    v_mov_b32 v27, 0xf149f2ca
    v_mov_b32 v28, 0xf149f2ca
    v_mov_b32 v29, 0xf149f2ca
    v_mov_b32 v30, 0xf149f2ca
    v_mov_b32 v31, 0xf149f2ca
    v_mov_b32 v32, 0xf149f2ca
    v_mov_b32 v33, 0xf149f2ca
    v_mov_b32 v34, 0xf149f2ca
    v_mov_b32 v35, 0xf149f2ca
    v_mov_b32 v36, 0xf149f2ca
    v_mov_b32 v37, 0xf149f2ca
    v_mov_b32 v38, 0xf149f2ca
    v_mov_b32 v39, 0xf149f2ca
ng_146:
    s_waitcnt lgkmcnt(2)
    s_nop 0
    v_mfma_f32_32x32x16_bf16 v[56:71], v[104:107], v[4:7], v[24:39]
    v_mfma_f32_32x32x16_bf16 v[56:71], v[108:111], v[8:11], v[56:71]
    ds_read_b128 v[112:115], v20 offset:20480
    ds_read_b128 v[116:119], v20 offset:21504
    v_exp_f32 v72, v72
    v_exp_f32 v73, v73
    v_exp_f32 v74, v74
    v_exp_f32 v75, v75
    v_exp_f32 v76, v76
    v_exp_f32 v77, v77
    v_exp_f32 v78, v78
    v_exp_f32 v79, v79
    v_exp_f32 v80, v80
    v_exp_f32 v81, v81
    v_exp_f32 v82, v82
    v_exp_f32 v83, v83
    v_exp_f32 v84, v84
    v_exp_f32 v85, v85
    v_exp_f32 v86, v86
    v_exp_f32 v87, v87
    v_add_f32 v22, v22, v72
    v_add_f32 v23, v23, v73
    v_add_f32 v22, v22, v74
    v_add_f32 v23, v23, v75
    v_add_f32 v22, v22, v76
    v_add_f32 v23, v23, v77
    v_add_f32 v22, v22, v78
    v_add_f32 v23, v23, v79
    v_add_f32 v22, v22, v80
    v_add_f32 v23, v23, v81
    v_add_f32 v22, v22, v82
    v_add_f32 v23, v23, v83
    v_add_f32 v22, v22, v84
    v_add_f32 v23, v23, v85
    v_add_f32_e64 v22, v22, v86
    v_add_f32 v23, v23, v87
    v_cvt_pk_bf16_f32 v144, v72, v73
    v_cvt_pk_bf16_f32 v145, v74, v75
    v_cvt_pk_bf16_f32 v146, v76, v77
    v_cvt_pk_bf16_f32 v147, v78, v79
    v_cvt_pk_bf16_f32 v148, v80, v81
    v_cvt_pk_bf16_f32 v149, v82, v83
    v_cvt_pk_bf16_f32 v150, v84, v85
    v_cvt_pk_bf16_f32 v151, v86, v87
    s_waitcnt lgkmcnt(2)
    v_mfma_f32_32x32x16_bf16 v[88:103], v[128:131], v[144:147], v[88:103]
    v_mfma_f32_32x32x16_bf16 v[88:103], v[132:135], v[148:151], v[88:103]
    ds_read_b128 v[120:123], v20 offset:26624
    ds_read_b128 v[124:127], v20 offset:27648
    s_cmp_eq_u32 s76, 2
    s_cbranch_scc0 ng_147
    v_mov_b32 v24, 0xf149f2ca
    v_mov_b32 v25, 0xf149f2ca
    v_mov_b32 v26, 0xf149f2ca
    v_mov_b32 v27, 0xf149f2ca
    v_mov_b32 v28, 0xf149f2ca
    v_mov_b32 v29, 0xf149f2ca
    v_mov_b32 v30, 0xf149f2ca
    v_mov_b32 v31, 0xf149f2ca
    v_mov_b32 v32, 0xf149f2ca
    v_mov_b32 v33, 0xf149f2ca
    v_mov_b32 v34, 0xf149f2ca
    v_mov_b32 v35, 0xf149f2ca
    v_mov_b32 v36, 0xf149f2ca
    v_mov_b32 v37, 0xf149f2ca
    v_mov_b32 v38, 0xf149f2ca
    v_mov_b32 v39, 0xf149f2ca
ng_147:
    s_waitcnt lgkmcnt(2)
    s_nop 0
    v_mfma_f32_32x32x16_bf16 v[72:87], v[112:115], v[4:7], v[24:39]
    v_mfma_f32_32x32x16_bf16 v[72:87], v[116:119], v[8:11], v[72:87]
    ds_read_b128 v[104:107], v20 offset:16384
    ds_read_b128 v[108:111], v20 offset:17408
    v_exp_f32 v56, v56
    v_exp_f32 v57, v57
    v_exp_f32 v58, v58
    v_exp_f32 v59, v59
    v_exp_f32 v60, v60
    v_exp_f32 v61, v61
    v_exp_f32 v62, v62
    v_exp_f32 v63, v63
    v_exp_f32 v64, v64
    v_exp_f32 v65, v65
    v_exp_f32 v66, v66
    v_exp_f32 v67, v67
    v_exp_f32 v68, v68
    v_exp_f32 v69, v69
    v_exp_f32 v70, v70
    v_exp_f32 v71, v71
    v_add_f32 v22, v22, v56
    v_add_f32 v23, v23, v57
    v_add_f32 v22, v22, v58
    v_add_f32 v23, v23, v59
    v_add_f32 v22, v22, v60
    v_add_f32 v23, v23, v61
    v_add_f32 v22, v22, v62
    v_add_f32 v23, v23, v63
    v_add_f32 v22, v22, v64
    v_add_f32 v23, v23, v65
    v_add_f32 v22, v22, v66
    v_add_f32 v23, v23, v67
    v_add_f32 v22, v22, v68
    v_add_f32 v23, v23, v69
    v_add_f32_e64 v22, v22, v70
    v_add_f32 v23, v23, v71
    v_cvt_pk_bf16_f32 v136, v56, v57
    v_cvt_pk_bf16_f32 v137, v58, v59
    v_cvt_pk_bf16_f32 v138, v60, v61
    v_cvt_pk_bf16_f32 v139, v62, v63
    v_cvt_pk_bf16_f32 v140, v64, v65
    v_cvt_pk_bf16_f32 v141, v66, v67
    v_cvt_pk_bf16_f32 v142, v68, v69
    v_cvt_pk_bf16_f32 v143, v70, v71
    s_waitcnt lgkmcnt(2)
    v_mfma_f32_32x32x16_bf16 v[88:103], v[120:123], v[136:139], v[88:103]
    v_mfma_f32_32x32x16_bf16 v[88:103], v[124:127], v[140:143], v[88:103]
    ds_read_b128 v[128:131], v20 offset:22528
    ds_read_b128 v[132:135], v20 offset:23552
    s_cmp_eq_u32 s76, 3
    s_cbranch_scc0 ng_148
    v_mov_b32 v24, 0xf149f2ca
    v_mov_b32 v25, 0xf149f2ca
    v_mov_b32 v26, 0xf149f2ca
    v_mov_b32 v27, 0xf149f2ca
    v_mov_b32 v28, 0xf149f2ca
    v_mov_b32 v29, 0xf149f2ca
    v_mov_b32 v30, 0xf149f2ca
    v_mov_b32 v31, 0xf149f2ca
    v_mov_b32 v32, 0xf149f2ca
    v_mov_b32 v33, 0xf149f2ca
    v_mov_b32 v34, 0xf149f2ca
    v_mov_b32 v35, 0xf149f2ca
    v_mov_b32 v36, 0xf149f2ca
    v_mov_b32 v37, 0xf149f2ca
    v_mov_b32 v38, 0xf149f2ca
    v_mov_b32 v39, 0xf149f2ca
ng_148:
    s_waitcnt lgkmcnt(2)
    s_nop 0
    v_mfma_f32_32x32x16_bf16 v[56:71], v[104:107], v[4:7], v[24:39]
    v_mfma_f32_32x32x16_bf16 v[56:71], v[108:111], v[8:11], v[56:71]
    ds_read_b128 v[112:115], v20 offset:12288
    ds_read_b128 v[116:119], v20 offset:13312
    v_exp_f32 v72, v72
    v_exp_f32 v73, v73
    v_exp_f32 v74, v74
    v_exp_f32 v75, v75
    v_exp_f32 v76, v76
    v_exp_f32 v77, v77
    v_exp_f32 v78, v78
    v_exp_f32 v79, v79
    v_exp_f32 v80, v80
    v_exp_f32 v81, v81
    v_exp_f32 v82, v82
    v_exp_f32 v83, v83
    v_exp_f32 v84, v84
    v_exp_f32 v85, v85
    v_exp_f32 v86, v86
    v_exp_f32 v87, v87
    v_add_f32 v22, v22, v72
    v_add_f32 v23, v23, v73
    v_add_f32 v22, v22, v74
    v_add_f32 v23, v23, v75
    v_add_f32 v22, v22, v76
    v_add_f32 v23, v23, v77
    v_add_f32 v22, v22, v78
    v_add_f32 v23, v23, v79
    v_add_f32 v22, v22, v80
    v_add_f32 v23, v23, v81
    v_add_f32 v22, v22, v82
    v_add_f32 v23, v23, v83
    v_add_f32 v22, v22, v84
    v_add_f32 v23, v23, v85
    v_add_f32_e64 v22, v22, v86
    v_add_f32 v23, v23, v87
    v_cvt_pk_bf16_f32 v144, v72, v73
    v_cvt_pk_bf16_f32 v145, v74, v75
    v_cvt_pk_bf16_f32 v146, v76, v77
    v_cvt_pk_bf16_f32 v147, v78, v79
    v_cvt_pk_bf16_f32 v148, v80, v81
    v_cvt_pk_bf16_f32 v149, v82, v83
    v_cvt_pk_bf16_f32 v150, v84, v85
    v_cvt_pk_bf16_f32 v151, v86, v87
    s_waitcnt lgkmcnt(2)
    v_mfma_f32_32x32x16_bf16 v[88:103], v[128:131], v[144:147], v[88:103]
    v_mfma_f32_32x32x16_bf16 v[88:103], v[132:135], v[148:151], v[88:103]
    ds_read_b128 v[120:123], v20 offset:18432
    ds_read_b128 v[124:127], v20 offset:19456
    s_cmp_eq_u32 s76, 4
    s_cbranch_scc0 ng_149
    v_mov_b32 v24, 0xf149f2ca
    v_mov_b32 v25, 0xf149f2ca
    v_mov_b32 v26, 0xf149f2ca
    v_mov_b32 v27, 0xf149f2ca
    v_mov_b32 v28, 0xf149f2ca
    v_mov_b32 v29, 0xf149f2ca
    v_mov_b32 v30, 0xf149f2ca
    v_mov_b32 v31, 0xf149f2ca
    v_mov_b32 v32, 0xf149f2ca
    v_mov_b32 v33, 0xf149f2ca
    v_mov_b32 v34, 0xf149f2ca
    v_mov_b32 v35, 0xf149f2ca
    v_mov_b32 v36, 0xf149f2ca
    v_mov_b32 v37, 0xf149f2ca
    v_mov_b32 v38, 0xf149f2ca
    v_mov_b32 v39, 0xf149f2ca
ng_149:
    s_waitcnt lgkmcnt(2)
    s_nop 0
    v_mfma_f32_32x32x16_bf16 v[72:87], v[112:115], v[4:7], v[24:39]
    v_mfma_f32_32x32x16_bf16 v[72:87], v[116:119], v[8:11], v[72:87]
    ds_read_b128 v[104:107], v20 offset:8192
    ds_read_b128 v[108:111], v20 offset:9216
    v_exp_f32 v56, v56
    v_exp_f32 v57, v57
    v_exp_f32 v58, v58
    v_exp_f32 v59, v59
    v_exp_f32 v60, v60
    v_exp_f32 v61, v61
    v_exp_f32 v62, v62
    v_exp_f32 v63, v63
    v_exp_f32 v64, v64
    v_exp_f32 v65, v65
    v_exp_f32 v66, v66
    v_exp_f32 v67, v67
    v_exp_f32 v68, v68
    v_exp_f32 v69, v69
    v_exp_f32 v70, v70
    v_exp_f32 v71, v71
    v_add_f32 v22, v22, v56
    v_add_f32 v23, v23, v57
    v_add_f32 v22, v22, v58
    v_add_f32 v23, v23, v59
    v_add_f32 v22, v22, v60
    v_add_f32 v23, v23, v61
    v_add_f32 v22, v22, v62
    v_add_f32 v23, v23, v63
    v_add_f32 v22, v22, v64
    v_add_f32 v23, v23, v65
    v_add_f32 v22, v22, v66
    v_add_f32 v23, v23, v67
    v_add_f32 v22, v22, v68
    v_add_f32 v23, v23, v69
    v_add_f32_e64 v22, v22, v70
    v_add_f32 v23, v23, v71
    v_cvt_pk_bf16_f32 v136, v56, v57
    v_cvt_pk_bf16_f32 v137, v58, v59
    v_cvt_pk_bf16_f32 v138, v60, v61
    v_cvt_pk_bf16_f32 v139, v62, v63
    v_cvt_pk_bf16_f32 v140, v64, v65
    v_cvt_pk_bf16_f32 v141, v66, v67
    v_cvt_pk_bf16_f32 v142, v68, v69
    v_cvt_pk_bf16_f32 v143, v70, v71
    s_waitcnt lgkmcnt(2)
    v_mfma_f32_32x32x16_bf16 v[88:103], v[120:123], v[136:139], v[88:103]
    v_mfma_f32_32x32x16_bf16 v[88:103], v[124:127], v[140:143], v[88:103]
    ds_read_b128 v[128:131], v20 offset:14336
    ds_read_b128 v[132:135], v20 offset:15360
    s_cmp_eq_u32 s76, 5
    s_cbranch_scc0 ng_150
    v_mov_b32 v24, 0xf149f2ca
    v_mov_b32 v25, 0xf149f2ca
    v_mov_b32 v26, 0xf149f2ca
    v_mov_b32 v27, 0xf149f2ca
    v_mov_b32 v28, 0xf149f2ca
    v_mov_b32 v29, 0xf149f2ca
    v_mov_b32 v30, 0xf149f2ca
    v_mov_b32 v31, 0xf149f2ca
    v_mov_b32 v32, 0xf149f2ca
    v_mov_b32 v33, 0xf149f2ca
    v_mov_b32 v34, 0xf149f2ca
    v_mov_b32 v35, 0xf149f2ca
    v_mov_b32 v36, 0xf149f2ca
    v_mov_b32 v37, 0xf149f2ca
    v_mov_b32 v38, 0xf149f2ca
    v_mov_b32 v39, 0xf149f2ca
ng_150:
    s_waitcnt lgkmcnt(2)
    s_nop 0
    v_mfma_f32_32x32x16_bf16 v[56:71], v[104:107], v[4:7], v[24:39]
    v_mfma_f32_32x32x16_bf16 v[56:71], v[108:111], v[8:11], v[56:71]
    ds_read_b128 v[112:115], v20 offset:4096
    ds_read_b128 v[116:119], v20 offset:5120
    v_exp_f32 v72, v72
    v_exp_f32 v73, v73
    v_exp_f32 v74, v74
    v_exp_f32 v75, v75
    v_exp_f32 v76, v76
    v_exp_f32 v77, v77
    v_exp_f32 v78, v78
    v_exp_f32 v79, v79
    v_exp_f32 v80, v80
    v_exp_f32 v81, v81
    v_exp_f32 v82, v82
    v_exp_f32 v83, v83
    v_exp_f32 v84, v84
    v_exp_f32 v85, v85
    v_exp_f32 v86, v86
    v_exp_f32 v87, v87
    v_add_f32 v22, v22, v72
    v_add_f32 v23, v23, v73
    v_add_f32 v22, v22, v74
    v_add_f32 v23, v23, v75
    v_add_f32 v22, v22, v76
    v_add_f32 v23, v23, v77
    v_add_f32 v22, v22, v78
    v_add_f32 v23, v23, v79
    v_add_f32 v22, v22, v80
    v_add_f32 v23, v23, v81
    v_add_f32 v22, v22, v82
    v_add_f32 v23, v23, v83
    v_add_f32 v22, v22, v84
    v_add_f32 v23, v23, v85
    v_add_f32_e64 v22, v22, v86
    v_add_f32 v23, v23, v87
    v_cvt_pk_bf16_f32 v144, v72, v73
    v_cvt_pk_bf16_f32 v145, v74, v75
    v_cvt_pk_bf16_f32 v146, v76, v77
    v_cvt_pk_bf16_f32 v147, v78, v79
    v_cvt_pk_bf16_f32 v148, v80, v81
    v_cvt_pk_bf16_f32 v149, v82, v83
    v_cvt_pk_bf16_f32 v150, v84, v85
    v_cvt_pk_bf16_f32 v151, v86, v87
    s_waitcnt lgkmcnt(2)
    v_mfma_f32_32x32x16_bf16 v[88:103], v[128:131], v[144:147], v[88:103]
    v_mfma_f32_32x32x16_bf16 v[88:103], v[132:135], v[148:151], v[88:103]
    ds_read_b128 v[120:123], v20 offset:10240
    ds_read_b128 v[124:127], v20 offset:11264
    s_cmp_eq_u32 s76, 6
    s_cbranch_scc0 ng_151
    v_mov_b32 v24, 0xf149f2ca
    v_mov_b32 v25, 0xf149f2ca
    v_mov_b32 v26, 0xf149f2ca
    v_mov_b32 v27, 0xf149f2ca
    v_mov_b32 v28, 0xf149f2ca
    v_mov_b32 v29, 0xf149f2ca
    v_mov_b32 v30, 0xf149f2ca
    v_mov_b32 v31, 0xf149f2ca
    v_mov_b32 v32, 0xf149f2ca
    v_mov_b32 v33, 0xf149f2ca
    v_mov_b32 v34, 0xf149f2ca
    v_mov_b32 v35, 0xf149f2ca
    v_mov_b32 v36, 0xf149f2ca
    v_mov_b32 v37, 0xf149f2ca
    v_mov_b32 v38, 0xf149f2ca
    v_mov_b32 v39, 0xf149f2ca
ng_151:
    s_waitcnt lgkmcnt(2)
    s_nop 0
    v_mfma_f32_32x32x16_bf16 v[72:87], v[112:115], v[4:7], v[24:39]
    v_mfma_f32_32x32x16_bf16 v[72:87], v[116:119], v[8:11], v[72:87]
    v_exp_f32 v56, v56
    v_exp_f32 v57, v57
    v_exp_f32 v58, v58
    v_exp_f32 v59, v59
    v_exp_f32 v60, v60
    v_exp_f32 v61, v61
    v_exp_f32 v62, v62
    v_exp_f32 v63, v63
    v_exp_f32 v64, v64
    v_exp_f32 v65, v65
    v_exp_f32 v66, v66
    v_exp_f32 v67, v67
    v_exp_f32 v68, v68
    v_exp_f32 v69, v69
    v_exp_f32 v70, v70
    v_exp_f32 v71, v71
    v_add_f32 v22, v22, v56
    v_add_f32 v23, v23, v57
    v_add_f32 v22, v22, v58
    v_add_f32 v23, v23, v59
    v_add_f32 v22, v22, v60
    v_add_f32 v23, v23, v61
    v_add_f32 v22, v22, v62
    v_add_f32 v23, v23, v63
    v_add_f32 v22, v22, v64
    v_add_f32 v23, v23, v65
    v_add_f32 v22, v22, v66
    v_add_f32 v23, v23, v67
    v_add_f32 v22, v22, v68
    v_add_f32 v23, v23, v69
    v_add_f32 v22, v22, v70
    v_add_f32 v23, v23, v71
    v_cvt_pk_bf16_f32 v136, v56, v57
    v_cvt_pk_bf16_f32 v137, v58, v59
    v_cvt_pk_bf16_f32 v138, v60, v61
    v_cvt_pk_bf16_f32 v139, v62, v63
    v_cvt_pk_bf16_f32 v140, v64, v65
    v_cvt_pk_bf16_f32 v141, v66, v67
    v_cvt_pk_bf16_f32 v142, v68, v69
    v_cvt_pk_bf16_f32 v143, v70, v71
    s_waitcnt lgkmcnt(0)
    v_mfma_f32_32x32x16_bf16 v[88:103], v[120:123], v[136:139], v[88:103]
    v_mfma_f32_32x32x16_bf16 v[88:103], v[124:127], v[140:143], v[88:103]
    ds_read_b128 v[128:131], v20 offset:6144
    ds_read_b128 v[132:135], v20 offset:7168
    v_exp_f32 v72, v72
    v_exp_f32 v73, v73
    v_exp_f32 v74, v74
    v_exp_f32 v75, v75
    v_exp_f32 v76, v76
    v_exp_f32 v77, v77
    v_exp_f32 v78, v78
    v_exp_f32 v79, v79
    v_exp_f32 v80, v80
    v_exp_f32 v81, v81
    v_exp_f32 v82, v82
    v_exp_f32 v83, v83
    v_exp_f32 v84, v84
    v_exp_f32 v85, v85
    v_exp_f32 v86, v86
    v_exp_f32 v87, v87
    v_add_f32 v22, v22, v72
    v_add_f32 v23, v23, v73
    v_add_f32 v22, v22, v74
    v_add_f32 v23, v23, v75
    v_add_f32 v22, v22, v76
    v_add_f32 v23, v23, v77
    v_add_f32 v22, v22, v78
    v_add_f32 v23, v23, v79
    v_add_f32 v22, v22, v80
    v_add_f32 v23, v23, v81
    v_add_f32 v22, v22, v82
    v_add_f32 v23, v23, v83
    v_add_f32 v22, v22, v84
    v_add_f32 v23, v23, v85
    v_add_f32 v22, v22, v86
    v_add_f32_e64 v23, v23, v87
    v_cvt_pk_bf16_f32 v144, v72, v73
    v_cvt_pk_bf16_f32 v145, v74, v75
    v_cvt_pk_bf16_f32 v146, v76, v77
    v_cvt_pk_bf16_f32 v147, v78, v79
    v_cvt_pk_bf16_f32 v148, v80, v81
    v_cvt_pk_bf16_f32 v149, v82, v83
    v_cvt_pk_bf16_f32 v150, v84, v85
    v_cvt_pk_bf16_f32 v151, v86, v87
    s_waitcnt lgkmcnt(0)
    v_mfma_f32_32x32x16_bf16 v[88:103], v[128:131], v[144:147], v[88:103]
    v_mfma_f32_32x32x16_bf16 v[88:103], v[132:135], v[148:151], v[88:103]
    v_add_f32 v22, v22, v23
    v_mov_b32 v152, v22
    s_nop 1
    v_permlane32_swap_b32 v22, v152
    v_add_f32 v22, v22, v152
    v_rcp_f32 v22, v22
    s_lshl_b32 s33, s25, 11
    s_add_u32 s33, s33, s36
    s_branch att_ret0
    s_nop 0
att_exact1:
    s_waitcnt lgkmcnt(0)
    v_mov_b32 v20, 0xffff
    v_mov_b32 v21, 0xffff0000
    v_cndmask_b32 v22, 0, v20, s[40:41]
    v_cndmask_b32 v23, 0, v21, s[42:43]
    v_or_b32_e64 v12, v22, v23
    v_cndmask_b32 v22, 0, v20, s[44:45]
    v_cndmask_b32 v23, 0, v21, s[46:47]
    v_or_b32_e64 v13, v22, v23
    v_cndmask_b32 v22, 0, v20, s[48:49]
    v_cndmask_b32 v23, 0, v21, s[50:51]
    v_or_b32_e64 v14, v22, v23
    v_cndmask_b32 v22, 0, v20, s[52:53]
    v_cndmask_b32 v23, 0, v21, s[54:55]
    v_or_b32_e64 v15, v22, v23
    v_cndmask_b32 v22, 0, v20, s[56:57]
    v_cndmask_b32 v23, 0, v21, s[58:59]
    v_or_b32_e64 v16, v22, v23
    v_cndmask_b32 v22, 0, v20, s[60:61]
    v_cndmask_b32 v23, 0, v21, s[62:63]
    v_or_b32_e64 v17, v22, v23
    v_cndmask_b32 v22, 0, v20, s[64:65]
    v_cndmask_b32 v23, 0, v21, s[66:67]
    v_or_b32_e64 v18, v22, v23
    v_cndmask_b32 v22, 0, v20, s[68:69]
    v_cndmask_b32 v23, 0, v21, s[70:71]
    v_or_b32_e64 v19, v22, v23
    s_and_b32 s34, s76, 3
    s_lshl_b32 s33, s34, 12
    s_add_u32 s33, s33, 114688
    v_add_u32 v20, s33, v253
    v_mov_b32 v24, 0
    v_mov_b32 v25, 0
    v_mov_b32 v26, 0
    v_mov_b32 v27, 0
    v_mov_b32 v28, 0
    v_mov_b32 v29, 0
    v_mov_b32 v30, 0
    v_mov_b32 v31, 0
    v_mov_b32 v32, 0
    v_mov_b32 v33, 0
    v_mov_b32 v34, 0
    v_mov_b32 v35, 0
    v_mov_b32 v36, 0
    v_mov_b32 v37, 0
    v_mov_b32 v38, 0
    v_mov_b32 v39, 0
    ds_read_b128 v[104:107], v20 offset:32768
    ds_read_b128 v[108:111], v20 offset:33792
    ds_read_b128 v[112:115], v20 offset:28672
    ds_read_b128 v[116:119], v20 offset:29696
    s_waitcnt lgkmcnt(2)
    v_mfma_f32_32x32x16_bf16 v[40:55], v[104:107], v[4:7], 0
    v_mfma_f32_32x32x16_bf16 v[40:55], v[108:111], v[8:11], v[40:55]
    ds_read_b128 v[104:107], v20 offset:24576
    ds_read_b128 v[108:111], v20 offset:25600
    s_cmp_eq_u32 s76, 0
    s_cbranch_scc0 ng_152
    v_mov_b32 v24, 0xf149f2ca
    v_mov_b32 v25, 0xf149f2ca
    v_mov_b32 v26, 0xf149f2ca
    v_mov_b32 v27, 0xf149f2ca
    v_mov_b32 v28, 0xf149f2ca
    v_mov_b32 v29, 0xf149f2ca
    v_mov_b32 v30, 0xf149f2ca
    v_mov_b32 v31, 0xf149f2ca
    v_mov_b32 v32, 0xf149f2ca
    v_mov_b32 v33, 0xf149f2ca
    v_mov_b32 v34, 0xf149f2ca
    v_mov_b32 v35, 0xf149f2ca
    v_mov_b32 v36, 0xf149f2ca
    v_mov_b32 v37, 0xf149f2ca
    v_mov_b32 v38, 0xf149f2ca
    v_mov_b32 v39, 0xf149f2ca
ng_152:
    s_waitcnt lgkmcnt(2)
    s_nop 0
    v_mfma_f32_32x32x16_bf16 v[72:87], v[112:115], v[4:7], v[24:39]
    v_mfma_f32_32x32x16_bf16 v[72:87], v[116:119], v[8:11], v[72:87]
    ds_read_b128 v[112:115], v20 offset:20480
    ds_read_b128 v[116:119], v20 offset:21504
    s_cmp_eq_u32 s76, 1
    s_cbranch_scc0 ng_153
    s_nop 1
    v_mov_b32 v24, 0xf149f2ca
    v_mov_b32 v25, 0xf149f2ca
    v_mov_b32 v26, 0xf149f2ca
    v_mov_b32 v27, 0xf149f2ca
    v_mov_b32 v28, 0xf149f2ca
    v_mov_b32 v29, 0xf149f2ca
    v_mov_b32 v30, 0xf149f2ca
    v_mov_b32 v31, 0xf149f2ca
    v_mov_b32 v32, 0xf149f2ca
    v_mov_b32 v33, 0xf149f2ca
    v_mov_b32 v34, 0xf149f2ca
    v_mov_b32 v35, 0xf149f2ca
    v_mov_b32 v36, 0xf149f2ca
    v_mov_b32 v37, 0xf149f2ca
    v_mov_b32 v38, 0xf149f2ca
    v_mov_b32 v39, 0xf149f2ca
ng_153:
    s_waitcnt lgkmcnt(2)
    s_nop 0
    v_mfma_f32_32x32x16_bf16 v[56:71], v[104:107], v[4:7], v[24:39]
    v_mfma_f32_32x32x16_bf16 v[56:71], v[108:111], v[8:11], v[56:71]
    s_nop 3
    v_max_f32_e64 v21, v72, v73
    v_max3_f32 v21, v21, v74, v75
    v_max3_f32 v21, v21, v76, v77
    v_max3_f32 v21, v21, v78, v79
    v_max3_f32 v21, v21, v80, v81
    v_max3_f32 v21, v21, v82, v83
    v_max3_f32 v21, v21, v84, v85
    v_max3_f32 v21, v21, v86, v87
    ds_read_b128 v[104:107], v20 offset:16384
    ds_read_b128 v[108:111], v20 offset:17408
    s_cmp_eq_u32 s76, 2
    s_cbranch_scc0 ng_154
    v_mov_b32 v24, 0xf149f2ca
    v_mov_b32 v25, 0xf149f2ca
    v_mov_b32 v26, 0xf149f2ca
    v_mov_b32 v27, 0xf149f2ca
    v_mov_b32 v28, 0xf149f2ca
    v_mov_b32 v29, 0xf149f2ca
    v_mov_b32 v30, 0xf149f2ca
    v_mov_b32 v31, 0xf149f2ca
    v_mov_b32 v32, 0xf149f2ca
    v_mov_b32 v33, 0xf149f2ca
    v_mov_b32 v34, 0xf149f2ca
    v_mov_b32 v35, 0xf149f2ca
    v_mov_b32 v36, 0xf149f2ca
    v_mov_b32 v37, 0xf149f2ca
    v_mov_b32 v38, 0xf149f2ca
    v_mov_b32 v39, 0xf149f2ca
ng_154:
    s_waitcnt lgkmcnt(2)
    s_nop 0
    v_mfma_f32_32x32x16_bf16 v[72:87], v[112:115], v[4:7], v[24:39]
    v_mfma_f32_32x32x16_bf16 v[72:87], v[116:119], v[8:11], v[72:87]
    v_max3_f32 v21, v21, v56, v57
    v_max3_f32 v21, v21, v58, v59
    v_max3_f32 v21, v21, v60, v61
    v_max3_f32 v21, v21, v62, v63
    v_max3_f32 v21, v21, v64, v65
    v_max3_f32 v21, v21, v66, v67
    v_max3_f32 v21, v21, v68, v69
    v_max3_f32 v21, v21, v70, v71
    ds_read_b128 v[112:115], v20 offset:12288
    ds_read_b128 v[116:119], v20 offset:13312
    s_cmp_eq_u32 s76, 3
    s_cbranch_scc0 ng_155
    v_mov_b32 v24, 0xf149f2ca
    v_mov_b32 v25, 0xf149f2ca
    v_mov_b32 v26, 0xf149f2ca
    v_mov_b32 v27, 0xf149f2ca
    v_mov_b32 v28, 0xf149f2ca
    v_mov_b32 v29, 0xf149f2ca
    v_mov_b32 v30, 0xf149f2ca
    v_mov_b32 v31, 0xf149f2ca
    v_mov_b32 v32, 0xf149f2ca
    v_mov_b32 v33, 0xf149f2ca
    v_mov_b32 v34, 0xf149f2ca
    v_mov_b32 v35, 0xf149f2ca
    v_mov_b32 v36, 0xf149f2ca
    v_mov_b32 v37, 0xf149f2ca
    v_mov_b32 v38, 0xf149f2ca
    v_mov_b32 v39, 0xf149f2ca
ng_155:
    s_waitcnt lgkmcnt(2)
    s_nop 0
    v_mfma_f32_32x32x16_bf16 v[56:71], v[104:107], v[4:7], v[24:39]
    v_mfma_f32_32x32x16_bf16 v[56:71], v[108:111], v[8:11], v[56:71]
    v_max3_f32 v21, v21, v72, v73
    v_max3_f32 v21, v21, v74, v75
    v_max3_f32 v21, v21, v76, v77
    v_max3_f32 v21, v21, v78, v79
    v_max3_f32 v21, v21, v80, v81
    v_max3_f32 v21, v21, v82, v83
    v_max3_f32 v21, v21, v84, v85
    v_max3_f32 v21, v21, v86, v87
    ds_read_b128 v[104:107], v20 offset:8192
    ds_read_b128 v[108:111], v20 offset:9216
    s_cmp_eq_u32 s76, 4
    s_cbranch_scc0 ng_156
    v_mov_b32 v24, 0xf149f2ca
    v_mov_b32 v25, 0xf149f2ca
    v_mov_b32 v26, 0xf149f2ca
    v_mov_b32 v27, 0xf149f2ca
    v_mov_b32 v28, 0xf149f2ca
    v_mov_b32 v29, 0xf149f2ca
    v_mov_b32 v30, 0xf149f2ca
    v_mov_b32 v31, 0xf149f2ca
    v_mov_b32 v32, 0xf149f2ca
    v_mov_b32 v33, 0xf149f2ca
    v_mov_b32 v34, 0xf149f2ca
    v_mov_b32 v35, 0xf149f2ca
    v_mov_b32 v36, 0xf149f2ca
    v_mov_b32 v37, 0xf149f2ca
    v_mov_b32 v38, 0xf149f2ca
    v_mov_b32 v39, 0xf149f2ca
ng_156:
    s_waitcnt lgkmcnt(2)
    s_nop 0
    v_mfma_f32_32x32x16_bf16 v[72:87], v[112:115], v[4:7], v[24:39]
    v_mfma_f32_32x32x16_bf16 v[72:87], v[116:119], v[8:11], v[72:87]
    v_max3_f32 v21, v21, v56, v57
    v_max3_f32 v21, v21, v58, v59
    v_max3_f32 v21, v21, v60, v61
    v_max3_f32 v21, v21, v62, v63
    v_max3_f32 v21, v21, v64, v65
    v_max3_f32 v21, v21, v66, v67
    v_max3_f32 v21, v21, v68, v69
    v_max3_f32 v21, v21, v70, v71
    ds_read_b128 v[112:115], v20 offset:4096
    ds_read_b128 v[116:119], v20 offset:5120
    s_cmp_eq_u32 s76, 5
    s_cbranch_scc0 ng_157
    v_mov_b32 v24, 0xf149f2ca
    v_mov_b32 v25, 0xf149f2ca
    v_mov_b32 v26, 0xf149f2ca
    v_mov_b32 v27, 0xf149f2ca
    v_mov_b32 v28, 0xf149f2ca
    v_mov_b32 v29, 0xf149f2ca
    v_mov_b32 v30, 0xf149f2ca
    v_mov_b32 v31, 0xf149f2ca
    v_mov_b32 v32, 0xf149f2ca
    v_mov_b32 v33, 0xf149f2ca
    v_mov_b32 v34, 0xf149f2ca
    v_mov_b32 v35, 0xf149f2ca
    v_mov_b32 v36, 0xf149f2ca
    v_mov_b32 v37, 0xf149f2ca
    v_mov_b32 v38, 0xf149f2ca
    v_mov_b32 v39, 0xf149f2ca
ng_157:
    s_waitcnt lgkmcnt(2)
    s_nop 0
    v_mfma_f32_32x32x16_bf16 v[56:71], v[104:107], v[4:7], v[24:39]
    v_mfma_f32_32x32x16_bf16 v[56:71], v[108:111], v[8:11], v[56:71]
    v_max3_f32 v21, v21, v72, v73
    v_max3_f32 v21, v21, v74, v75
    v_max3_f32 v21, v21, v76, v77
    v_max3_f32 v21, v21, v78, v79
    v_max3_f32 v21, v21, v80, v81
    v_max3_f32 v21, v21, v82, v83
    v_max3_f32 v21, v21, v84, v85
    v_max3_f32 v21, v21, v86, v87
    ds_read_b128 v[104:107], v20 offset:0
    ds_read_b128 v[108:111], v20 offset:1024
    s_cmp_eq_u32 s76, 6
    s_cbranch_scc0 ng_158
    v_mov_b32 v24, 0xf149f2ca
    v_mov_b32 v25, 0xf149f2ca
    v_mov_b32 v26, 0xf149f2ca
    v_mov_b32 v27, 0xf149f2ca
    v_mov_b32 v28, 0xf149f2ca
    v_mov_b32 v29, 0xf149f2ca
    v_mov_b32 v30, 0xf149f2ca
    v_mov_b32 v31, 0xf149f2ca
    v_mov_b32 v32, 0xf149f2ca
    v_mov_b32 v33, 0xf149f2ca
    v_mov_b32 v34, 0xf149f2ca
    v_mov_b32 v35, 0xf149f2ca
    v_mov_b32 v36, 0xf149f2ca
    v_mov_b32 v37, 0xf149f2ca
    v_mov_b32 v38, 0xf149f2ca
    v_mov_b32 v39, 0xf149f2ca
ng_158:
    s_waitcnt lgkmcnt(2)
    s_nop 0
    v_mfma_f32_32x32x16_bf16 v[72:87], v[112:115], v[4:7], v[24:39]
    v_mfma_f32_32x32x16_bf16 v[72:87], v[116:119], v[8:11], v[72:87]
    v_max3_f32 v21, v21, v56, v57
    v_max3_f32 v21, v21, v58, v59
    v_max3_f32 v21, v21, v60, v61
    v_max3_f32 v21, v21, v62, v63
    v_max3_f32 v21, v21, v64, v65
    v_max3_f32 v21, v21, v66, v67
    v_max3_f32 v21, v21, v68, v69
    v_max3_f32 v21, v21, v70, v71
    s_cmp_eq_u32 s76, 7
    s_cbranch_scc0 ng_159
    v_mov_b32 v24, 0xf149f2ca
    v_mov_b32 v25, 0xf149f2ca
    v_mov_b32 v26, 0xf149f2ca
    v_mov_b32 v27, 0xf149f2ca
    v_mov_b32 v28, 0xf149f2ca
    v_mov_b32 v29, 0xf149f2ca
    v_mov_b32 v30, 0xf149f2ca
    v_mov_b32 v31, 0xf149f2ca
    v_mov_b32 v32, 0xf149f2ca
    v_mov_b32 v33, 0xf149f2ca
    v_mov_b32 v34, 0xf149f2ca
    v_mov_b32 v35, 0xf149f2ca
    v_mov_b32 v36, 0xf149f2ca
    v_mov_b32 v37, 0xf149f2ca
    v_mov_b32 v38, 0xf149f2ca
    v_mov_b32 v39, 0xf149f2ca
ng_159:
    s_waitcnt lgkmcnt(0)
    s_nop 0
    v_mfma_f32_32x32x16_bf16 v[56:71], v[104:107], v[4:7], v[24:39]
    v_mfma_f32_32x32x16_bf16 v[56:71], v[108:111], v[8:11], v[56:71]
    v_max3_f32 v21, v21, v72, v73
    v_max3_f32 v21, v21, v74, v75
    v_max3_f32 v21, v21, v76, v77
    v_max3_f32 v21, v21, v78, v79
    v_max3_f32 v21, v21, v80, v81
    v_max3_f32 v21, v21, v82, v83
    v_max3_f32 v21, v21, v84, v85
    v_max3_f32 v21, v21, v86, v87
    ds_read_b128 v[112:115], v20 offset:28672
    ds_read_b128 v[116:119], v20 offset:29696
    ds_read_b128 v[120:123], v20 offset:34816
    ds_read_b128 v[124:127], v20 offset:35840
    ds_read_b128 v[128:131], v20 offset:2048
    ds_read_b128 v[132:135], v20 offset:3072
    v_cndmask_b32 v40, v56, v40, s[40:41]
    v_cndmask_b32 v41, v57, v41, s[42:43]
    v_cndmask_b32 v42, v58, v42, s[44:45]
    v_cndmask_b32 v43, v59, v43, s[46:47]
    v_cndmask_b32 v44, v60, v44, s[48:49]
    v_cndmask_b32 v45, v61, v45, s[50:51]
    v_cndmask_b32 v46, v62, v46, s[52:53]
    v_cndmask_b32 v47, v63, v47, s[54:55]
    v_cndmask_b32 v48, v64, v48, s[56:57]
    v_cndmask_b32 v49, v65, v49, s[58:59]
    v_cndmask_b32 v50, v66, v50, s[60:61]
    v_cndmask_b32 v51, v67, v51, s[62:63]
    v_cndmask_b32 v52, v68, v52, s[64:65]
    v_cndmask_b32 v53, v69, v53, s[66:67]
    v_cndmask_b32 v54, v70, v54, s[68:69]
    v_cndmask_b32 v55, v71, v55, s[70:71]
    v_max3_f32 v21, v21, v40, v41
    v_max3_f32 v21, v21, v42, v43
    v_max3_f32 v21, v21, v44, v45
    v_max3_f32 v21, v21, v46, v47
    v_max3_f32 v21, v21, v48, v49
    v_max3_f32 v21, v21, v50, v51
    v_max3_f32 v21, v21, v52, v53
    v_max3_f32 v21, v21, v54, v55
    v_mov_b32 v152, v21
    s_nop 1
    v_permlane32_swap_b32 v21, v152
    v_max_f32 v21, v21, v152
    v_sub_f32 v24, 0, v21
    v_sub_f32 v25, 0, v21
    v_sub_f32 v26, 0, v21
    v_sub_f32 v27, 0, v21
    v_sub_f32 v28, 0, v21
    v_sub_f32 v29, 0, v21
    v_sub_f32 v30, 0, v21
    v_sub_f32 v31, 0, v21
    v_sub_f32 v32, 0, v21
    v_sub_f32 v33, 0, v21
    v_sub_f32 v34, 0, v21
    v_sub_f32 v35, 0, v21
    v_sub_f32 v36, 0, v21
    v_sub_f32 v37, 0, v21
    v_sub_f32 v38, 0, v21
    v_sub_f32 v39, 0, v21
    s_cmp_eq_u32 s76, 0
    s_cbranch_scc0 ng_160
    v_mov_b32 v24, 0xf149f2ca
    v_mov_b32 v25, 0xf149f2ca
    v_mov_b32 v26, 0xf149f2ca
    v_mov_b32 v27, 0xf149f2ca
    v_mov_b32 v28, 0xf149f2ca
    v_mov_b32 v29, 0xf149f2ca
    v_mov_b32 v30, 0xf149f2ca
    v_mov_b32 v31, 0xf149f2ca
    v_mov_b32 v32, 0xf149f2ca
    v_mov_b32 v33, 0xf149f2ca
    v_mov_b32 v34, 0xf149f2ca
    v_mov_b32 v35, 0xf149f2ca
    v_mov_b32 v36, 0xf149f2ca
    v_mov_b32 v37, 0xf149f2ca
    v_mov_b32 v38, 0xf149f2ca
    v_mov_b32 v39, 0xf149f2ca
ng_160:
    s_waitcnt lgkmcnt(4)
    s_nop 0
    v_mfma_f32_32x32x16_bf16 v[72:87], v[112:115], v[4:7], v[24:39]
    v_mfma_f32_32x32x16_bf16 v[72:87], v[116:119], v[8:11], v[72:87]
    ds_read_b128 v[104:107], v20 offset:24576
    ds_read_b128 v[108:111], v20 offset:25600
    v_sub_f32 v40, v40, v21
    v_sub_f32 v41, v41, v21
    v_sub_f32 v42, v42, v21
    v_sub_f32 v43, v43, v21
    v_sub_f32 v44, v44, v21
    v_sub_f32 v45, v45, v21
    v_sub_f32 v46, v46, v21
    v_sub_f32 v47, v47, v21
    v_sub_f32 v48, v48, v21
    v_sub_f32 v49, v49, v21
    v_sub_f32 v50, v50, v21
    v_sub_f32 v51, v51, v21
    v_sub_f32 v52, v52, v21
    v_sub_f32 v53, v53, v21
    v_sub_f32 v54, v54, v21
    v_sub_f32 v55, v55, v21
    v_exp_f32 v40, v40
    v_exp_f32 v41, v41
    v_exp_f32 v42, v42
    v_exp_f32 v43, v43
    v_exp_f32 v44, v44
    v_exp_f32 v45, v45
    v_exp_f32 v46, v46
    v_exp_f32 v47, v47
    v_exp_f32 v48, v48
    v_exp_f32 v49, v49
    v_exp_f32 v50, v50
    v_exp_f32 v51, v51
    v_exp_f32 v52, v52
    v_exp_f32 v53, v53
    v_exp_f32 v54, v54
    v_exp_f32 v55, v55
    v_add_f32 v22, v40, v41
    v_add_f32 v23, v42, v43
    v_add_f32 v22, v22, v44
    v_add_f32 v23, v23, v45
    v_add_f32 v22, v22, v46
    v_add_f32 v23, v23, v47
    v_add_f32 v22, v22, v48
    v_add_f32 v23, v23, v49
    v_add_f32 v22, v22, v50
    v_add_f32 v23, v23, v51
    v_add_f32 v22, v22, v52
    v_add_f32 v23, v23, v53
    v_add_f32 v22, v22, v54
    v_add_f32 v23, v23, v55
    v_cvt_pk_bf16_f32 v144, v40, v41
    v_cvt_pk_bf16_f32 v145, v42, v43
    v_cvt_pk_bf16_f32 v146, v44, v45
    v_cvt_pk_bf16_f32 v147, v46, v47
    v_cvt_pk_bf16_f32 v148, v48, v49
    v_cvt_pk_bf16_f32 v149, v50, v51
    v_cvt_pk_bf16_f32 v150, v52, v53
    v_cvt_pk_bf16_f32 v151, v54, v55
    v_and_b32 v136, v144, v12
    v_and_b32 v137, v145, v13
    v_and_b32 v138, v146, v14
    v_and_b32 v139, v147, v15
    v_and_b32 v140, v148, v16
    v_and_b32 v141, v149, v17
    v_and_b32 v142, v150, v18
    v_and_b32 v143, v151, v19
    v_xor_b32 v144, v144, v136
    v_xor_b32 v145, v145, v137
    v_xor_b32 v146, v146, v138
    v_xor_b32 v147, v147, v139
    v_xor_b32 v148, v148, v140
    v_xor_b32 v149, v149, v141
    v_xor_b32_e64 v150, v150, v142
    v_xor_b32 v151, v151, v143
    s_waitcnt lgkmcnt(2)
    v_mfma_f32_32x32x16_bf16 v[88:103], v[120:123], v[136:139], 0
    v_mfma_f32_32x32x16_bf16 v[88:103], v[124:127], v[140:143], v[88:103]
    v_mfma_f32_32x32x16_bf16 v[88:103], v[128:131], v[144:147], v[88:103]
    v_mfma_f32_32x32x16_bf16 v[88:103], v[132:135], v[148:151], v[88:103]
    ds_read_b128 v[128:131], v20 offset:30720
    ds_read_b128 v[132:135], v20 offset:31744
    s_cmp_eq_u32 s76, 1
    s_cbranch_scc0 ng_161
    v_mov_b32 v24, 0xf149f2ca
    v_mov_b32 v25, 0xf149f2ca
    v_mov_b32 v26, 0xf149f2ca
    v_mov_b32 v27, 0xf149f2ca
    v_mov_b32 v28, 0xf149f2ca
    v_mov_b32 v29, 0xf149f2ca
    v_mov_b32 v30, 0xf149f2ca
    v_mov_b32 v31, 0xf149f2ca
    v_mov_b32 v32, 0xf149f2ca
    v_mov_b32 v33, 0xf149f2ca
    v_mov_b32 v34, 0xf149f2ca
    v_mov_b32 v35, 0xf149f2ca
    v_mov_b32 v36, 0xf149f2ca
    v_mov_b32 v37, 0xf149f2ca
    v_mov_b32 v38, 0xf149f2ca
    v_mov_b32 v39, 0xf149f2ca
ng_161:
    s_waitcnt lgkmcnt(2)
    s_nop 0
    v_mfma_f32_32x32x16_bf16 v[56:71], v[104:107], v[4:7], v[24:39]
    v_mfma_f32_32x32x16_bf16 v[56:71], v[108:111], v[8:11], v[56:71]
    ds_read_b128 v[112:115], v20 offset:20480
    ds_read_b128 v[116:119], v20 offset:21504
    v_exp_f32 v72, v72
    v_exp_f32 v73, v73
    v_exp_f32 v74, v74
    v_exp_f32 v75, v75
    v_exp_f32 v76, v76
    v_exp_f32 v77, v77
    v_exp_f32 v78, v78
    v_exp_f32 v79, v79
    v_exp_f32 v80, v80
    v_exp_f32 v81, v81
    v_exp_f32 v82, v82
    v_exp_f32 v83, v83
    v_exp_f32 v84, v84
    v_exp_f32 v85, v85
    v_exp_f32 v86, v86
    v_exp_f32 v87, v87
    v_add_f32 v22, v22, v72
    v_add_f32 v23, v23, v73
    v_add_f32 v22, v22, v74
    v_add_f32 v23, v23, v75
    v_add_f32 v22, v22, v76
    v_add_f32 v23, v23, v77
    v_add_f32 v22, v22, v78
    v_add_f32 v23, v23, v79
    v_add_f32 v22, v22, v80
    v_add_f32 v23, v23, v81
    v_add_f32 v22, v22, v82
    v_add_f32 v23, v23, v83
    v_add_f32 v22, v22, v84
    v_add_f32 v23, v23, v85
    v_add_f32_e64 v22, v22, v86
    v_add_f32 v23, v23, v87
    v_cvt_pk_bf16_f32 v144, v72, v73
    v_cvt_pk_bf16_f32 v145, v74, v75
    v_cvt_pk_bf16_f32 v146, v76, v77
    v_cvt_pk_bf16_f32 v147, v78, v79
    v_cvt_pk_bf16_f32 v148, v80, v81
    v_cvt_pk_bf16_f32 v149, v82, v83
    v_cvt_pk_bf16_f32 v150, v84, v85
    v_cvt_pk_bf16_f32 v151, v86, v87
    s_waitcnt lgkmcnt(2)
    v_mfma_f32_32x32x16_bf16 v[88:103], v[128:131], v[144:147], v[88:103]
    v_mfma_f32_32x32x16_bf16 v[88:103], v[132:135], v[148:151], v[88:103]
    ds_read_b128 v[120:123], v20 offset:26624
    ds_read_b128 v[124:127], v20 offset:27648
    s_cmp_eq_u32 s76, 2
    s_cbranch_scc0 ng_162
    v_mov_b32 v24, 0xf149f2ca
    v_mov_b32 v25, 0xf149f2ca
    v_mov_b32 v26, 0xf149f2ca
    v_mov_b32 v27, 0xf149f2ca
    v_mov_b32 v28, 0xf149f2ca
    v_mov_b32 v29, 0xf149f2ca
    v_mov_b32 v30, 0xf149f2ca
    v_mov_b32 v31, 0xf149f2ca
    v_mov_b32 v32, 0xf149f2ca
    v_mov_b32 v33, 0xf149f2ca
    v_mov_b32 v34, 0xf149f2ca
    v_mov_b32 v35, 0xf149f2ca
    v_mov_b32 v36, 0xf149f2ca
    v_mov_b32 v37, 0xf149f2ca
    v_mov_b32 v38, 0xf149f2ca
    v_mov_b32 v39, 0xf149f2ca
ng_162:
    s_waitcnt lgkmcnt(2)
    s_nop 0
    v_mfma_f32_32x32x16_bf16 v[72:87], v[112:115], v[4:7], v[24:39]
    v_mfma_f32_32x32x16_bf16 v[72:87], v[116:119], v[8:11], v[72:87]
    ds_read_b128 v[104:107], v20 offset:16384
    ds_read_b128 v[108:111], v20 offset:17408
    v_exp_f32 v56, v56
    v_exp_f32 v57, v57
    v_exp_f32 v58, v58
    v_exp_f32 v59, v59
    v_exp_f32 v60, v60
    v_exp_f32 v61, v61
    v_exp_f32 v62, v62
    v_exp_f32 v63, v63
    v_exp_f32 v64, v64
    v_exp_f32 v65, v65
    v_exp_f32 v66, v66
    v_exp_f32 v67, v67
    v_exp_f32 v68, v68
    v_exp_f32 v69, v69
    v_exp_f32 v70, v70
    v_exp_f32 v71, v71
    v_add_f32 v22, v22, v56
    v_add_f32 v23, v23, v57
    v_add_f32 v22, v22, v58
    v_add_f32 v23, v23, v59
    v_add_f32 v22, v22, v60
    v_add_f32 v23, v23, v61
    v_add_f32 v22, v22, v62
    v_add_f32 v23, v23, v63
    v_add_f32 v22, v22, v64
    v_add_f32 v23, v23, v65
    v_add_f32 v22, v22, v66
    v_add_f32 v23, v23, v67
    v_add_f32 v22, v22, v68
    v_add_f32 v23, v23, v69
    v_add_f32_e64 v22, v22, v70
    v_add_f32 v23, v23, v71
    v_cvt_pk_bf16_f32 v136, v56, v57
    v_cvt_pk_bf16_f32 v137, v58, v59
    v_cvt_pk_bf16_f32 v138, v60, v61
    v_cvt_pk_bf16_f32 v139, v62, v63
    v_cvt_pk_bf16_f32 v140, v64, v65
    v_cvt_pk_bf16_f32 v141, v66, v67
    v_cvt_pk_bf16_f32 v142, v68, v69
    v_cvt_pk_bf16_f32 v143, v70, v71
    s_waitcnt lgkmcnt(2)
    v_mfma_f32_32x32x16_bf16 v[88:103], v[120:123], v[136:139], v[88:103]
    v_mfma_f32_32x32x16_bf16 v[88:103], v[124:127], v[140:143], v[88:103]
    ds_read_b128 v[128:131], v20 offset:22528
    ds_read_b128 v[132:135], v20 offset:23552
    s_cmp_eq_u32 s76, 3
    s_cbranch_scc0 ng_163
    v_mov_b32 v24, 0xf149f2ca
    v_mov_b32 v25, 0xf149f2ca
    v_mov_b32 v26, 0xf149f2ca
    v_mov_b32 v27, 0xf149f2ca
    v_mov_b32 v28, 0xf149f2ca
    v_mov_b32 v29, 0xf149f2ca
    v_mov_b32 v30, 0xf149f2ca
    v_mov_b32 v31, 0xf149f2ca
    v_mov_b32 v32, 0xf149f2ca
    v_mov_b32 v33, 0xf149f2ca
    v_mov_b32 v34, 0xf149f2ca
    v_mov_b32 v35, 0xf149f2ca
    v_mov_b32 v36, 0xf149f2ca
    v_mov_b32 v37, 0xf149f2ca
    v_mov_b32 v38, 0xf149f2ca
    v_mov_b32 v39, 0xf149f2ca
ng_163:
    s_waitcnt lgkmcnt(2)
    s_nop 0
    v_mfma_f32_32x32x16_bf16 v[56:71], v[104:107], v[4:7], v[24:39]
    v_mfma_f32_32x32x16_bf16 v[56:71], v[108:111], v[8:11], v[56:71]
    ds_read_b128 v[112:115], v20 offset:12288
    ds_read_b128 v[116:119], v20 offset:13312
    v_exp_f32 v72, v72
    v_exp_f32 v73, v73
    v_exp_f32 v74, v74
    v_exp_f32 v75, v75
    v_exp_f32 v76, v76
    v_exp_f32 v77, v77
    v_exp_f32 v78, v78
    v_exp_f32 v79, v79
    v_exp_f32 v80, v80
    v_exp_f32 v81, v81
    v_exp_f32 v82, v82
    v_exp_f32 v83, v83
    v_exp_f32 v84, v84
    v_exp_f32 v85, v85
    v_exp_f32 v86, v86
    v_exp_f32 v87, v87
    v_add_f32 v22, v22, v72
    v_add_f32 v23, v23, v73
    v_add_f32 v22, v22, v74
    v_add_f32 v23, v23, v75
    v_add_f32 v22, v22, v76
    v_add_f32 v23, v23, v77
    v_add_f32 v22, v22, v78
    v_add_f32 v23, v23, v79
    v_add_f32 v22, v22, v80
    v_add_f32 v23, v23, v81
    v_add_f32 v22, v22, v82
    v_add_f32 v23, v23, v83
    v_add_f32 v22, v22, v84
    v_add_f32 v23, v23, v85
    v_add_f32_e64 v22, v22, v86
    v_add_f32 v23, v23, v87
    v_cvt_pk_bf16_f32 v144, v72, v73
    v_cvt_pk_bf16_f32 v145, v74, v75
    v_cvt_pk_bf16_f32 v146, v76, v77
    v_cvt_pk_bf16_f32 v147, v78, v79
    v_cvt_pk_bf16_f32 v148, v80, v81
    v_cvt_pk_bf16_f32 v149, v82, v83
    v_cvt_pk_bf16_f32 v150, v84, v85
    v_cvt_pk_bf16_f32 v151, v86, v87
    s_waitcnt lgkmcnt(2)
    v_mfma_f32_32x32x16_bf16 v[88:103], v[128:131], v[144:147], v[88:103]
    v_mfma_f32_32x32x16_bf16 v[88:103], v[132:135], v[148:151], v[88:103]
    ds_read_b128 v[120:123], v20 offset:18432
    ds_read_b128 v[124:127], v20 offset:19456
    s_cmp_eq_u32 s76, 4
    s_cbranch_scc0 ng_164
    v_mov_b32 v24, 0xf149f2ca
    v_mov_b32 v25, 0xf149f2ca
    v_mov_b32 v26, 0xf149f2ca
    v_mov_b32 v27, 0xf149f2ca
    v_mov_b32 v28, 0xf149f2ca
    v_mov_b32 v29, 0xf149f2ca
    v_mov_b32 v30, 0xf149f2ca
    v_mov_b32 v31, 0xf149f2ca
    v_mov_b32 v32, 0xf149f2ca
    v_mov_b32 v33, 0xf149f2ca
    v_mov_b32 v34, 0xf149f2ca
    v_mov_b32 v35, 0xf149f2ca
    v_mov_b32 v36, 0xf149f2ca
    v_mov_b32 v37, 0xf149f2ca
    v_mov_b32 v38, 0xf149f2ca
    v_mov_b32 v39, 0xf149f2ca
ng_164:
    s_waitcnt lgkmcnt(2)
    s_nop 0
    v_mfma_f32_32x32x16_bf16 v[72:87], v[112:115], v[4:7], v[24:39]
    v_mfma_f32_32x32x16_bf16 v[72:87], v[116:119], v[8:11], v[72:87]
    ds_read_b128 v[104:107], v20 offset:8192
    ds_read_b128 v[108:111], v20 offset:9216
    v_exp_f32 v56, v56
    v_exp_f32 v57, v57
    v_exp_f32 v58, v58
    v_exp_f32 v59, v59
    v_exp_f32 v60, v60
    v_exp_f32 v61, v61
    v_exp_f32 v62, v62
    v_exp_f32 v63, v63
    v_exp_f32 v64, v64
    v_exp_f32 v65, v65
    v_exp_f32 v66, v66
    v_exp_f32 v67, v67
    v_exp_f32 v68, v68
    v_exp_f32 v69, v69
    v_exp_f32 v70, v70
    v_exp_f32 v71, v71
    v_add_f32 v22, v22, v56
    v_add_f32 v23, v23, v57
    v_add_f32 v22, v22, v58
    v_add_f32 v23, v23, v59
    v_add_f32 v22, v22, v60
    v_add_f32 v23, v23, v61
    v_add_f32 v22, v22, v62
    v_add_f32 v23, v23, v63
    v_add_f32 v22, v22, v64
    v_add_f32 v23, v23, v65
    v_add_f32 v22, v22, v66
    v_add_f32 v23, v23, v67
    v_add_f32 v22, v22, v68
    v_add_f32 v23, v23, v69
    v_add_f32_e64 v22, v22, v70
    v_add_f32 v23, v23, v71
    v_cvt_pk_bf16_f32 v136, v56, v57
    v_cvt_pk_bf16_f32 v137, v58, v59
    v_cvt_pk_bf16_f32 v138, v60, v61
    v_cvt_pk_bf16_f32 v139, v62, v63
    v_cvt_pk_bf16_f32 v140, v64, v65
    v_cvt_pk_bf16_f32 v141, v66, v67
    v_cvt_pk_bf16_f32 v142, v68, v69
    v_cvt_pk_bf16_f32 v143, v70, v71
    s_waitcnt lgkmcnt(2)
    v_mfma_f32_32x32x16_bf16 v[88:103], v[120:123], v[136:139], v[88:103]
    v_mfma_f32_32x32x16_bf16 v[88:103], v[124:127], v[140:143], v[88:103]
    ds_read_b128 v[128:131], v20 offset:14336
    ds_read_b128 v[132:135], v20 offset:15360
    s_cmp_eq_u32 s76, 5
    s_cbranch_scc0 ng_165
    v_mov_b32 v24, 0xf149f2ca
    v_mov_b32 v25, 0xf149f2ca
    v_mov_b32 v26, 0xf149f2ca
    v_mov_b32 v27, 0xf149f2ca
    v_mov_b32 v28, 0xf149f2ca
    v_mov_b32 v29, 0xf149f2ca
    v_mov_b32 v30, 0xf149f2ca
    v_mov_b32 v31, 0xf149f2ca
    v_mov_b32 v32, 0xf149f2ca
    v_mov_b32 v33, 0xf149f2ca
    v_mov_b32 v34, 0xf149f2ca
    v_mov_b32 v35, 0xf149f2ca
    v_mov_b32 v36, 0xf149f2ca
    v_mov_b32 v37, 0xf149f2ca
    v_mov_b32 v38, 0xf149f2ca
    v_mov_b32 v39, 0xf149f2ca
ng_165:
    s_waitcnt lgkmcnt(2)
    s_nop 0
    v_mfma_f32_32x32x16_bf16 v[56:71], v[104:107], v[4:7], v[24:39]
    v_mfma_f32_32x32x16_bf16 v[56:71], v[108:111], v[8:11], v[56:71]
    ds_read_b128 v[112:115], v20 offset:4096
    ds_read_b128 v[116:119], v20 offset:5120
    v_exp_f32 v72, v72
    v_exp_f32 v73, v73
    v_exp_f32 v74, v74
    v_exp_f32 v75, v75
    v_exp_f32 v76, v76
    v_exp_f32 v77, v77
    v_exp_f32 v78, v78
    v_exp_f32 v79, v79
    v_exp_f32 v80, v80
    v_exp_f32 v81, v81
    v_exp_f32 v82, v82
    v_exp_f32 v83, v83
    v_exp_f32 v84, v84
    v_exp_f32 v85, v85
    v_exp_f32 v86, v86
    v_exp_f32 v87, v87
    v_add_f32 v22, v22, v72
    v_add_f32 v23, v23, v73
    v_add_f32 v22, v22, v74
    v_add_f32 v23, v23, v75
    v_add_f32 v22, v22, v76
    v_add_f32 v23, v23, v77
    v_add_f32 v22, v22, v78
    v_add_f32 v23, v23, v79
    v_add_f32 v22, v22, v80
    v_add_f32 v23, v23, v81
    v_add_f32 v22, v22, v82
    v_add_f32 v23, v23, v83
    v_add_f32 v22, v22, v84
    v_add_f32 v23, v23, v85
    v_add_f32_e64 v22, v22, v86
    v_add_f32 v23, v23, v87
    v_cvt_pk_bf16_f32 v144, v72, v73
    v_cvt_pk_bf16_f32 v145, v74, v75
    v_cvt_pk_bf16_f32 v146, v76, v77
    v_cvt_pk_bf16_f32 v147, v78, v79
    v_cvt_pk_bf16_f32 v148, v80, v81
    v_cvt_pk_bf16_f32 v149, v82, v83
    v_cvt_pk_bf16_f32 v150, v84, v85
    v_cvt_pk_bf16_f32 v151, v86, v87
    s_waitcnt lgkmcnt(2)
    v_mfma_f32_32x32x16_bf16 v[88:103], v[128:131], v[144:147], v[88:103]
    v_mfma_f32_32x32x16_bf16 v[88:103], v[132:135], v[148:151], v[88:103]
    ds_read_b128 v[120:123], v20 offset:10240
    ds_read_b128 v[124:127], v20 offset:11264
    s_cmp_eq_u32 s76, 6
    s_cbranch_scc0 ng_166
    v_mov_b32 v24, 0xf149f2ca
    v_mov_b32 v25, 0xf149f2ca
    v_mov_b32 v26, 0xf149f2ca
    v_mov_b32 v27, 0xf149f2ca
    v_mov_b32 v28, 0xf149f2ca
    v_mov_b32 v29, 0xf149f2ca
    v_mov_b32 v30, 0xf149f2ca
    v_mov_b32 v31, 0xf149f2ca
    v_mov_b32 v32, 0xf149f2ca
    v_mov_b32 v33, 0xf149f2ca
    v_mov_b32 v34, 0xf149f2ca
    v_mov_b32 v35, 0xf149f2ca
    v_mov_b32 v36, 0xf149f2ca
    v_mov_b32 v37, 0xf149f2ca
    v_mov_b32 v38, 0xf149f2ca
    v_mov_b32 v39, 0xf149f2ca
ng_166:
    s_waitcnt lgkmcnt(2)
    s_nop 0
    v_mfma_f32_32x32x16_bf16 v[72:87], v[112:115], v[4:7], v[24:39]
    v_mfma_f32_32x32x16_bf16 v[72:87], v[116:119], v[8:11], v[72:87]
    v_exp_f32 v56, v56
    v_exp_f32 v57, v57
    v_exp_f32 v58, v58
    v_exp_f32 v59, v59
    v_exp_f32 v60, v60
    v_exp_f32 v61, v61
    v_exp_f32 v62, v62
    v_exp_f32 v63, v63
    v_exp_f32 v64, v64
    v_exp_f32 v65, v65
    v_exp_f32 v66, v66
    v_exp_f32 v67, v67
    v_exp_f32 v68, v68
    v_exp_f32 v69, v69
    v_exp_f32 v70, v70
    v_exp_f32 v71, v71
    v_add_f32 v22, v22, v56
    v_add_f32 v23, v23, v57
    v_add_f32 v22, v22, v58
    v_add_f32 v23, v23, v59
    v_add_f32 v22, v22, v60
    v_add_f32 v23, v23, v61
    v_add_f32 v22, v22, v62
    v_add_f32 v23, v23, v63
    v_add_f32 v22, v22, v64
    v_add_f32 v23, v23, v65
    v_add_f32 v22, v22, v66
    v_add_f32 v23, v23, v67
    v_add_f32 v22, v22, v68
    v_add_f32 v23, v23, v69
    v_add_f32 v22, v22, v70
    v_add_f32 v23, v23, v71
    v_cvt_pk_bf16_f32 v136, v56, v57
    v_cvt_pk_bf16_f32 v137, v58, v59
    v_cvt_pk_bf16_f32 v138, v60, v61
    v_cvt_pk_bf16_f32 v139, v62, v63
    v_cvt_pk_bf16_f32 v140, v64, v65
    v_cvt_pk_bf16_f32 v141, v66, v67
    v_cvt_pk_bf16_f32 v142, v68, v69
    v_cvt_pk_bf16_f32 v143, v70, v71
    s_waitcnt lgkmcnt(0)
    v_mfma_f32_32x32x16_bf16 v[88:103], v[120:123], v[136:139], v[88:103]
    v_mfma_f32_32x32x16_bf16 v[88:103], v[124:127], v[140:143], v[88:103]
    ds_read_b128 v[128:131], v20 offset:6144
    ds_read_b128 v[132:135], v20 offset:7168
    v_exp_f32 v72, v72
    v_exp_f32 v73, v73
    v_exp_f32 v74, v74
    v_exp_f32 v75, v75
    v_exp_f32 v76, v76
    v_exp_f32 v77, v77
    v_exp_f32 v78, v78
    v_exp_f32 v79, v79
    v_exp_f32 v80, v80
    v_exp_f32 v81, v81
    v_exp_f32 v82, v82
    v_exp_f32 v83, v83
    v_exp_f32 v84, v84
    v_exp_f32 v85, v85
    v_exp_f32 v86, v86
    v_exp_f32 v87, v87
    v_add_f32 v22, v22, v72
    v_add_f32 v23, v23, v73
    v_add_f32 v22, v22, v74
    v_add_f32 v23, v23, v75
    v_add_f32 v22, v22, v76
    v_add_f32 v23, v23, v77
    v_add_f32 v22, v22, v78
    v_add_f32 v23, v23, v79
    v_add_f32 v22, v22, v80
    v_add_f32 v23, v23, v81
    v_add_f32 v22, v22, v82
    v_add_f32 v23, v23, v83
    v_add_f32 v22, v22, v84
    v_add_f32 v23, v23, v85
    v_add_f32 v22, v22, v86
    v_add_f32_e64 v23, v23, v87
    v_cvt_pk_bf16_f32 v144, v72, v73
    v_cvt_pk_bf16_f32 v145, v74, v75
    v_cvt_pk_bf16_f32 v146, v76, v77
    v_cvt_pk_bf16_f32 v147, v78, v79
    v_cvt_pk_bf16_f32 v148, v80, v81
    v_cvt_pk_bf16_f32 v149, v82, v83
    v_cvt_pk_bf16_f32 v150, v84, v85
    v_cvt_pk_bf16_f32 v151, v86, v87
    s_waitcnt lgkmcnt(0)
    v_mfma_f32_32x32x16_bf16 v[88:103], v[128:131], v[144:147], v[88:103]
    v_mfma_f32_32x32x16_bf16 v[88:103], v[132:135], v[148:151], v[88:103]
    v_add_f32 v22, v22, v23
    v_mov_b32 v152, v22
    s_nop 1
    v_permlane32_swap_b32 v22, v152
    v_add_f32 v22, v22, v152
    v_rcp_f32 v22, v22
    s_lshl_b32 s33, s25, 11
    s_add_u32 s33, s33, s36
    s_branch att_ret1
.section .rodata,"a"
.p2align 6
.amdhsa_kernel interleave_layers__sliding_block__moe_arch_mod__prompt_kernel
  .amdhsa_next_free_vgpr 256
  .amdhsa_next_free_sgpr 102
  .amdhsa_accum_offset 256
  .amdhsa_group_segment_fixed_size 0
  .amdhsa_kernarg_size 88
  .amdhsa_user_sgpr_count 2
  .amdhsa_user_sgpr_kernarg_segment_ptr 1
  .amdhsa_system_sgpr_workgroup_id_x 1
.end_amdhsa_kernel
```

```asm
; @launch grid=(256,1,1) block=(512,1,1) lds=163840
.amdgcn_target "amdgcn-amd-amdhsa--gfx950"
.text
.globl interleave_layers__sliding_block__moe_arch_mod__prompt_kernel
.p2align 8
.type interleave_layers__sliding_block__moe_arch_mod__prompt_kernel,@function
interleave_layers__sliding_block__moe_arch_mod__prompt_kernel:
    s_cmp_ge_u32 s2, 256
    s_cbranch_scc1 k_exit
    s_load_dwordx4 s[4:7], s[0:1], 0
    s_load_dwordx2 s[8:9], s[0:1], 16
    s_load_dwordx2 s[20:21], s[0:1], 80
    s_load_dwordx2 s[80:81], s[0:1], 32
    v_lshrrev_b32 v1, 6, v0
    v_and_b32 v252, 63, v0
    v_readfirstlane_b32 s3, v1
    v_lshlrev_b32 v253, 4, v252
    s_and_b32 s30, s2, 7
    s_lshr_b32 s31, s2, 3
    s_and_b32 s32, s31, 1
    s_lshl_b32 s33, s30, 1
    s_add_u32 s24, s33, s32
    s_lshr_b32 s25, s31, 1
    s_add_u32 s33, s33, s25
    s_add_u32 s94, s33, s32
    s_sub_u32 s95, s33, s32
    s_add_u32 s98, s95, 15
    s_and_b32 s98, s98, 15
    s_mul_i32 s29, s30, 28
    s_lshl_b32 s32, s30, 2
    s_add_u32 s32, s32, 196
    s_cmp_lt_u32 s31, 28
    s_cselect_b32 s29, s29, s32
    s_add_u32 s29, s29, s31
    s_lshl_b32 s72, s24, 4
    s_add_u32 s72, s72, s25
    s_mov_b32 s26, 0
    s_mov_b32 s27, 20000
    s_and_b32 s28, s3, 3
    s_lshl_b32 s99, s24, 2
    s_add_u32 s99, s99, s28
    s_lshl_b32 s101, s28, 10
    s_mov_b32 s18, 0x600000
    s_mov_b32 s19, 0x20000
    s_mov_b32 s10, 0x200000
    s_mov_b32 s11, 0x20000
    s_mov_b32 s22, 0x8000000
    s_mov_b32 s23, 0x20000
    s_mov_b32 s82, 0x800
    s_mov_b32 s83, 0x20000
    s_cmp_ge_u32 s3, 4
    s_cbranch_scc1 l_start
    s_getpc_b64 s[32:33]
pc_1:
    s_sub_u32 s32, s32, pc_1-interleave_layers__sliding_block__moe_arch_mod__prompt_kernel
    s_subb_u32 s33, s33, 0
    s_lshr_b32 s34, s2, 3
    s_lshl_b32 s34, s34, 2
    s_add_u32 s34, s34, s28
    s_and_b32 s34, s34, 63
    s_lshl_b32 s34, s34, 7
    v_lshl_add_u32 v191, v252, 13, s34
    s_mov_b32 s34, k_exit-interleave_layers__sliding_block__moe_arch_mod__prompt_kernel
    s_mov_b32 s35, 0x20000
    buffer_load_dword v191, v191, s[32:35], 0 offen
    s_load_dwordx4 s[36:39], s[0:1], 40
    s_load_dwordx2 s[74:75], s[0:1], 56
    s_waitcnt lgkmcnt(0)
    s_mov_b32 s88, 0xdd8000
    s_load_dword s88, s[20:21], s88
    s_mov_b64 s[16:17], s[6:7]
    s_mov_b32 s6, 0x400000
    s_mov_b32 s7, 0x20000
    s_lshr_b32 s30, s2, 3
    s_lshl_b32 s30, s30, 2
    s_add_u32 s30, s30, s3
    s_and_b32 s31, s2, 7
    v_mul_u32_u24 v4, 9363, v252
    v_lshrrev_b32 v4, 16, v4
    v_mul_u32_u24 v5, 7, v4
    v_sub_u32 v5, v252, v5
    v_min_u32_e64 v4, 7, v4
    v_lshl_add_u32 v4, v4, 7, s30
    v_mul_u32_u24 v6, 37, v5
    v_lshrrev_b32 v6, 8, v6
    v_mul_u32_u24 v7, 7, v6
    v_sub_u32 v5, v5, v7
    v_mad_u32_u24 v6, v6, 0, 0
    v_cmp_eq_u32_e64 vcc, 2, v6
    v_mov_b32 v7, 7168
    v_mov_b32 v8, 896
    v_cndmask_b32 v7, v7, v8, vcc
    v_mul_u32_u24 v4, v4, v7
    v_mul_u32_u24 v198, 1024, v7
    v_lshl_add_u32 v4, v5, 7, v4
    v_mov_b32 v7, 917504
    v_cndmask_b32_e64 v7, v8, v7, vcc
    v_mad_u32_u24 v4, v7, s31, v4
    v_mov_b32 v196, s36
    v_mov_b32 v7, s74
    v_cndmask_b32 v196, v196, v7, vcc
    v_mov_b32 v197, s37
    v_mov_b32 v7, s75
    v_cndmask_b32 v197, v197, v7, vcc
    v_cmp_eq_u32 vcc, 1, v6
    v_mov_b32 v7, s38
    s_nop 0
    v_cndmask_b32 v196, v196, v7, vcc
    v_mov_b32 v7, s39
    v_cndmask_b32 v197, v197, v7, vcc
    v_add_co_u32 v196, vcc, v196, v4
    s_nop 1
    v_addc_co_u32 v197, vcc, 0, v197, vcc
    s_mov_b32 s30, 0x1000100
    s_mov_b32 s31, 0x1000100
    s_lshl_b32 s86, s3, 4
    s_lshr_b64 s[30:31], s[30:31], s86
    s_and_b32 s86, s30, 0xffff
    s_mul_i32 s30, s25, 6
    s_lshr_b32 s30, s30, 4
    s_lshr_b32 s86, s86, s30
    s_load_dwordx2 s[12:13], s[0:1], 64
    s_mov_b32 s14, 0x400000
    s_mov_b32 s15, 0x20000
    s_lshr_b32 s30, s16, 7
    s_sub_u32 s30, 3, s30
    s_and_b32 s30, s30, 7
    s_and_b32 s31, s24, 1
    s_lshl_b32 s31, s31, 3
    s_add_u32 s30, s30, s31
    s_and_b32 s31, s24, 14
    s_add_u32 s84, s31, s30
    s_lshl_b32 s31, s25, 2
    s_add_u32 s31, s31, s28
    s_mul_i32 s31, s31, 6144
    s_lshl_b32 s30, s30, 7
    s_add_u32 s30, s30, s31
    v_min_u32_e64 v190, 2, v252
    v_lshl_add_u32 v190, v190, 11, s30
    s_add_u32 s30, s84, 0
    s_and_b32 s30, s30, 15
    s_mul_i32 s30, s30, 393216
    buffer_load_dword v191, v190, s[16:19], s30 offen
    s_add_u32 s30, s84, 1
    s_and_b32 s30, s30, 15
    s_mul_i32 s30, s30, 393216
    buffer_load_dword v191, v190, s[16:19], s30 offen
    v_lshrrev_b32 v5, 5, v252
    v_lshlrev_b32 v6, 3, v5
    s_lshl_b32 s33, s98, 7
    buffer_load_dwordx2 v[224:225], v6, s[80:83], s33 offen offset:0
    buffer_load_dwordx2 v[226:227], v6, s[80:83], s33 offen offset:16
    buffer_load_dwordx2 v[228:229], v6, s[80:83], s33 offen offset:32
    buffer_load_dwordx2 v[230:231], v6, s[80:83], s33 offen offset:48
    buffer_load_dwordx2 v[232:233], v6, s[80:83], s33 offen offset:64
    buffer_load_dwordx2 v[234:235], v6, s[80:83], s33 offen offset:80
    buffer_load_dwordx2 v[236:237], v6, s[80:83], s33 offen offset:96
    buffer_load_dwordx2 v[238:239], v6, s[80:83], s33 offen offset:112
    s_mov_b32 s40, 0xffffffff
    s_mov_b32 s41, 0xfffffff0
    s_mov_b32 s42, 0xfffffffe
    s_mov_b32 s43, 0xffffffe0
    s_mov_b32 s44, 0xfffffffc
    s_mov_b32 s45, 0xffffffc0
    s_mov_b32 s46, 0xfffffff8
    s_mov_b32 s47, 0xffffff80
    s_mov_b32 s48, 0xffff0000
    s_mov_b32 s49, 0xfff00000
    s_mov_b32 s50, 0xfffe0000
    s_mov_b32 s51, 0xffe00000
    s_mov_b32 s52, 0xfffc0000
    s_mov_b32 s53, 0xffc00000
    s_mov_b32 s54, 0xfff80000
    s_mov_b32 s55, 0xff800000
    s_mov_b32 s56, 0xffffff00
    s_mov_b32 s57, 0xfffff000
    s_mov_b32 s58, 0xfffffe00
    s_mov_b32 s59, 0xffffe000
    s_mov_b32 s60, 0xfffffc00
    s_mov_b32 s61, 0xffffc000
    s_mov_b32 s62, 0xfffff800
    s_mov_b32 s63, 0xffff8000
    s_mov_b32 s64, 0xff000000
    s_mov_b32 s65, 0xf0000000
    s_mov_b32 s66, 0xfe000000
    s_mov_b32 s67, 0xe0000000
    s_mov_b32 s68, 0xfc000000
    s_mov_b32 s69, 0xc0000000
    s_mov_b32 s70, 0xf8000000
    s_mov_b32 s71, 0x80000000
    v_bfe_u32 v20, v252, 3, 2
    v_lshrrev_b32 v21, 5, v252
    v_lshl_add_u32 v20, v21, 3, v20
    s_lshr_b32 s32, s28, 1
    s_lshl_b32 s32, s32, 4
    s_and_b32 s33, s28, 1
    s_lshl_b32 s33, s33, 2
    s_add_u32 s32, s32, s33
    v_add_u32 v20, s32, v20
    v_lshlrev_b32 v20, 11, v20
    v_lshrrev_b32 v21, 2, v252
    v_and_b32 v21, 4, v21
    v_xor_b32 v21, v21, v252
    v_and_b32_e64 v21, 7, v21
    v_lshl_add_u32 v20, v21, 4, v20
    s_lshl_b32 s32, s98, 7
    v_add_u32 v243, s32, v20
    s_and_b32 s34, s3, 1
    s_lshr_b32 s35, s3, 1
    v_and_b32 v4, 15, v252
    v_lshrrev_b32 v7, 4, v252
    v_lshrrev_b32 v6, 1, v4
    v_xor_b32 v6, v6, v7
    v_lshlrev_b32_e64 v6, 4, v6
    v_lshl_add_u32 v6, v4, 7, v6
    s_lshl_b32 s30, s34, 13
    v_add_u32 v176, s30, v6
    v_xor_b32 v177, 64, v176
    s_lshl_b32 s30, s35, 1
    v_lshrrev_b32_e64 v20, 2, v252
    v_bfe_u32 v21, v20, 1, 2
    v_xor_b32 v21, s30, v21
    v_lshlrev_b32 v20, 7, v20
    v_lshl_add_u32 v20, v21, 5, v20
    v_and_b32_e64 v21, 3, v252
    v_lshl_add_u32 v20, v21, 3, v20
    v_add_u32 v178, 40960, v20
    v_xor_b32 v179, 32, v178
    v_and_b32 v8, 31, v252
    v_bfe_u32 v6, v8, 1, 3
    v_xor_b32 v6, v6, v5
    v_lshlrev_b32 v6, 4, v6
    v_lshl_add_u32 v6, v8, 7, v6
    s_lshl_b32 s30, s3, 12
    s_add_u32 s30, s30, 147456
    v_add_u32 v192, s30, v6
    v_xor_b32 v193, 32, v192
    v_xor_b32 v194, 64, v192
    v_xor_b32 v195, 96, v192
    s_lshl_b32 s30, s34, 8
    v_lshl_add_u32 v184, v4, 2, s30
    v_lshl_add_u32 v185, v7, 4, s30
    s_lshl_b32 s30, s35, 7
    v_lshl_add_u32 v186, v7, 4, s30
    s_add_u32 s30, s30, 1536
    v_lshl_add_u32 v187, v4, 2, s30
    s_lshl_b32 s30, s3, 7
    s_add_u32 s30, s30, 2048
    v_lshl_add_u32 v188, v8, 2, s30
    v_mov_b32 v189, 0
    v_lshlrev_b32_e64 v6, 9, v7
    v_lshl_add_u32 v245, v4, 4, v6
    v_and_b32_e64 v9, 8, v4
    v_lshl_add_u32 v244, v9, 4, v245
    s_mul_i32 s30, s35, 49152
    s_lshl_b32 s31, s34, 13
    s_add_u32 s30, s30, s31
    s_add_u32 s30, s30, 98304
    v_add_u32_e64 v246, s30, v244
    v_add_u32 v247, s30, v245
    s_lshl_b32 s30, s3, 12
    s_add_u32 s30, s30, 49152
    v_add_u32 v248, s30, v245
    s_getreg_b32 s30, hwreg(HW_REG_XCC_ID, 0, 4)
    v_mov_b32 v251, s30
    s_lshl_b32 s30, s25, 4
    s_add_u32 s30, s30, s24
    s_sub_u32 s30, s30, s72
    s_add_u32 s30, s30, 512
    v_mul_u32_u24 v249, s30, v252
    v_add_u32 v249, s72, v249
    v_lshlrev_b32 v249, 3, v249
    s_cmp_eq_u32 s3, 0
    s_cselect_b32 s89, 10, -1
    v_mov_b32 v242, 0
    v_mov_b32 v0, 0
    v_mov_b32 v1, 0
    v_mov_b32 v2, 0
    v_mov_b32 v3, 0
    v_mov_b32 v4, 0
    v_mov_b32 v5, 0
    v_mov_b32 v6, 0
    v_mov_b32 v7, 0
    v_mov_b32 v8, 0
    v_mov_b32 v9, 0
    v_mov_b32 v10, 0
    v_mov_b32 v11, 0
    v_mov_b32 v12, 0
    v_mov_b32 v13, 0
    v_mov_b32 v14, 0
    v_mov_b32 v15, 0
    v_mov_b32 v16, 0
    v_mov_b32 v17, 0
    v_mov_b32 v18, 0
    v_mov_b32 v19, 0
    v_mov_b32 v20, 0
    v_mov_b32 v21, 0
    v_mov_b32 v22, 0
    v_mov_b32 v23, 0
    v_mov_b32 v24, 0
    v_mov_b32 v25, 0
    v_mov_b32 v26, 0
    v_mov_b32 v27, 0
    v_mov_b32 v28, 0
    v_mov_b32 v29, 0
    v_mov_b32 v30, 0
    v_mov_b32 v31, 0
    v_mov_b32 v32, 0
    v_mov_b32 v33, 0
    v_mov_b32 v34, 0
    v_mov_b32 v35, 0
    v_mov_b32 v36, 0
    v_mov_b32 v37, 0
    v_mov_b32 v38, 0
    v_mov_b32 v39, 0
    v_mov_b32 v40, 0
    v_mov_b32 v41, 0
    v_mov_b32 v42, 0
    v_mov_b32 v43, 0
    v_mov_b32 v44, 0
    v_mov_b32 v45, 0
    v_mov_b32 v46, 0
    v_mov_b32 v47, 0
    v_mov_b32 v48, 0
    v_mov_b32 v49, 0
    v_mov_b32 v50, 0
    v_mov_b32 v51, 0
    v_mov_b32 v52, 0
    v_mov_b32 v53, 0
    v_mov_b32 v54, 0
    v_mov_b32 v55, 0
    v_mov_b32 v56, 0
    v_mov_b32 v57, 0
    v_mov_b32 v58, 0
    v_mov_b32 v59, 0
    v_mov_b32 v60, 0
    v_mov_b32 v61, 0
    v_mov_b32 v62, 0
    v_mov_b32 v63, 0
    v_mov_b32 v64, 0
    v_mov_b32 v65, 0
    v_mov_b32 v66, 0
    v_mov_b32 v67, 0
    v_mov_b32 v68, 0
    v_mov_b32 v69, 0
    v_mov_b32 v70, 0
    v_mov_b32 v71, 0
    v_mov_b32 v72, 0
    v_mov_b32 v73, 0
    v_mov_b32 v74, 0
    v_mov_b32 v75, 0
    v_mov_b32 v76, 0
    v_mov_b32 v77, 0
    v_mov_b32 v78, 0
    v_mov_b32 v79, 0
    v_mov_b32 v80, 0
    v_mov_b32 v81, 0
    v_mov_b32 v82, 0
    v_mov_b32 v83, 0
    v_mov_b32 v84, 0
    v_mov_b32 v85, 0
    v_mov_b32 v86, 0
    v_mov_b32 v87, 0
    v_mov_b32 v88, 0
    v_mov_b32 v89, 0
    v_mov_b32 v90, 0
    v_mov_b32 v91, 0
    v_mov_b32 v92, 0
    v_mov_b32 v93, 0
    v_mov_b32_e64 v94, 0
    v_mov_b32 v95, 0
    s_waitcnt vmcnt(0) lgkmcnt(0)
    s_add_u32 s88, s88, 0x9e3779b9
    v_mov_b32_e64 v250, s88
    v_dot2c_f32_bf16 v242, 0x3f803f80, v224
    v_dot2c_f32_bf16 v242, 0x3f803f80, v225
    v_dot2c_f32_bf16 v242, 0x3f803f80, v226
    v_dot2c_f32_bf16 v242, 0x3f803f80, v227
    v_dot2c_f32_bf16 v242, 0x3f803f80, v228
    v_dot2c_f32_bf16 v242, 0x3f803f80, v229
    v_dot2c_f32_bf16 v242, 0x3f803f80, v230
    v_dot2c_f32_bf16 v242, 0x3f803f80, v231
    v_dot2c_f32_bf16 v242, 0x3f803f80, v232
    v_dot2c_f32_bf16 v242, 0x3f803f80, v233
    v_dot2c_f32_bf16 v242, 0x3f803f80, v234
    v_dot2c_f32_bf16 v242, 0x3f803f80, v235
    v_dot2c_f32_bf16 v242, 0x3f803f80, v236
    v_dot2c_f32_bf16 v242, 0x3f803f80, v237
    v_dot2c_f32_bf16 v242, 0x3f803f80, v238
    v_dot2c_f32_bf16 v242, 0x3f803f80, v239
    s_add_u32 s30, s84, 2
    s_and_b32 s30, s30, 15
    s_mul_i32 s30, s30, 393216
    buffer_load_dword v191, v190, s[16:19], s30 offen
    s_add_u32 s30, s84, 3
    s_and_b32 s30, s30, 15
    s_mul_i32 s30, s30, 393216
    buffer_load_dword v191, v190, s[16:19], s30 offen
    s_add_u32 s30, s84, 4
    s_and_b32 s30, s30, 15
    s_mul_i32 s30, s30, 393216
    buffer_load_dword v191, v190, s[16:19], s30 offen
    s_add_u32 s30, s84, 5
    s_and_b32 s30, s30, 15
    s_mul_i32 s30, s30, 393216
    buffer_load_dword v191, v190, s[16:19], s30 offen
    s_setprio 1
e_q:
    s_mov_b32 s31, 0
    s_mov_b32 s32, 147456
    s_mov_b32 s36, 15
    v_add_u32 v180, s32, v176
    v_mov_b32 v182, v178
    v_add_u32 v181, s32, v177
    v_mov_b32 v183, v179
    s_barrier
    ds_read_b128 v[96:99], v180 offset:0
    ds_read_b64_tr_b16 v[112:113], v182 offset:0
    ds_read_b64_tr_b16 v[114:115], v182 offset:2048
    ds_read_b128 v[100:103], v180 offset:2048
    ds_read_b128 v[104:107], v180 offset:4096
    ds_read_b128 v[108:111], v180 offset:6144
    ds_read_b64_tr_b16 v[116:117], v183 offset:0
    ds_read_b64_tr_b16 v[118:119], v183 offset:2048
    ds_read_b64_tr_b16 v[120:121], v182 offset:8192
    ds_read_b64_tr_b16 v[122:123], v182 offset:10240
    ds_read_b64_tr_b16 v[124:125], v183 offset:8192
    ds_read_b64_tr_b16 v[126:127], v183 offset:10240
    ds_read_b64_tr_b16 v[128:129], v182 offset:16384
    ds_read_b64_tr_b16 v[130:131], v182 offset:18432
    ds_read_b64_tr_b16 v[132:133], v183 offset:16384
    ds_read_b64_tr_b16 v[134:135], v183 offset:18432
    s_add_u32 s85, s84, 5
e_loop:
    s_waitcnt lgkmcnt(0)
    v_mfma_f32_16x16x32_bf16 v[0:3], v[112:115], v[96:99], v[0:3]
    ds_read_b128 v[136:139], v181 offset:0
    v_mfma_f32_16x16x32_bf16 v[8:11], v[112:115], v[100:103], v[8:11]
    ds_read_b64_tr_b16 v[152:153], v182 offset:4096
    v_mfma_f32_16x16x32_bf16 v[16:19], v[112:115], v[104:107], v[16:19]
    ds_read_b64_tr_b16 v[154:155], v182 offset:6144
    v_mfma_f32_16x16x32_bf16 v[24:27], v[112:115], v[108:111], v[24:27]
    ds_read_b128 v[140:143], v181 offset:2048
    v_mfma_f32_16x16x32_bf16 v[28:31], v[116:119], v[108:111], v[28:31]
    ds_read_b128 v[144:147], v181 offset:4096
    v_mfma_f32_16x16x32_bf16 v[20:23], v[116:119], v[104:107], v[20:23]
    ds_read_b128 v[148:151], v181 offset:6144
    v_mfma_f32_16x16x32_bf16 v[12:15], v[116:119], v[100:103], v[12:15]
    ds_read_b64_tr_b16 v[156:157], v183 offset:4096
    v_mfma_f32_16x16x32_bf16 v[4:7], v[116:119], v[96:99], v[4:7]
    ds_read_b64_tr_b16 v[158:159], v183 offset:6144
    v_mfma_f32_16x16x32_bf16 v[32:35], v[120:123], v[96:99], v[32:35]
    ds_read_b64_tr_b16 v[160:161], v182 offset:12288
    v_mfma_f32_16x16x32_bf16 v[40:43], v[120:123], v[100:103], v[40:43]
    ds_read_b64_tr_b16 v[162:163], v182 offset:14336
    v_mfma_f32_16x16x32_bf16 v[48:51], v[120:123], v[104:107], v[48:51]
    ds_read_b64_tr_b16 v[164:165], v183 offset:12288
    v_mfma_f32_16x16x32_bf16 v[56:59], v[120:123], v[108:111], v[56:59]
    ds_read_b64_tr_b16 v[166:167], v183 offset:14336
    v_mfma_f32_16x16x32_bf16 v[60:63], v[124:127], v[108:111], v[60:63]
    ds_read_b64_tr_b16 v[168:169], v182 offset:20480
    v_mfma_f32_16x16x32_bf16 v[52:55], v[124:127], v[104:107], v[52:55]
    ds_read_b64_tr_b16 v[170:171], v182 offset:22528
    v_mfma_f32_16x16x32_bf16 v[44:47], v[124:127], v[100:103], v[44:47]
    ds_read_b64_tr_b16 v[172:173], v183 offset:20480
    v_mfma_f32_16x16x32_bf16 v[36:39], v[124:127], v[96:99], v[36:39]
    ds_read_b64_tr_b16 v[174:175], v183 offset:22528
    v_mfma_f32_16x16x32_bf16 v[64:67], v[96:99], v[128:131], v[64:67]
    s_cmp_eq_u32 s36, s89
    s_cbranch_scc1 e_arr
e_arr_ret:
    v_mfma_f32_16x16x32_bf16 v[68:71], v[100:103], v[128:131], v[68:71]
    s_add_u32 s31, s31, 24576
    s_sub_u32 s32, s32, 16384
    v_mfma_f32_16x16x32_bf16 v[72:75], v[104:107], v[128:131], v[72:75]
    s_cmp_ge_u32 s31, 73728
    s_cselect_b32 s31, 0, s31
    s_cselect_b32 s32, 147456, s32
    v_mfma_f32_16x16x32_bf16 v[76:79], v[108:111], v[128:131], v[76:79]
    v_add_u32 v182, s31, v178
    v_add_u32_e64 v180, s32, v176
    v_mfma_f32_16x16x32_bf16 v[92:95], v[108:111], v[132:135], v[92:95]
    v_add_u32_e64 v183, s31, v179
    v_add_u32 v181, s32, v177
    v_mfma_f32_16x16x32_bf16 v[88:91], v[104:107], v[132:135], v[88:91]
    s_add_u32 s85, s85, 1
    s_and_b32 s30, s85, 15
    v_mfma_f32_16x16x32_bf16 v[84:87], v[100:103], v[132:135], v[84:87]
    s_mul_i32 s30, s30, 393216
    s_cmp_ge_u32 s36, 6
    v_mfma_f32_16x16x32_bf16 v[80:83], v[96:99], v[132:135], v[80:83]
    s_waitcnt lgkmcnt(0)
    v_mfma_f32_16x16x32_bf16 v[0:3], v[152:155], v[136:139], v[0:3]
    s_barrier
    ds_read_b128 v[96:99], v180 offset:0
    v_mfma_f32_16x16x32_bf16 v[8:11], v[152:155], v[140:143], v[8:11]
    ds_read_b64_tr_b16 v[112:113], v182 offset:0
    v_mfma_f32_16x16x32_bf16 v[16:19], v[152:155], v[144:147], v[16:19]
    ds_read_b64_tr_b16 v[114:115], v182 offset:2048
    v_mfma_f32_16x16x32_bf16 v[24:27], v[152:155], v[148:151], v[24:27]
    ds_read_b128 v[100:103], v180 offset:2048
    v_mfma_f32_16x16x32_bf16 v[28:31], v[156:159], v[148:151], v[28:31]
    ds_read_b128 v[104:107], v180 offset:4096
    v_mfma_f32_16x16x32_bf16 v[20:23], v[156:159], v[144:147], v[20:23]
    ds_read_b128 v[108:111], v180 offset:6144
    v_mfma_f32_16x16x32_bf16 v[12:15], v[156:159], v[140:143], v[12:15]
    ds_read_b64_tr_b16 v[116:117], v183 offset:0
    v_mfma_f32_16x16x32_bf16 v[4:7], v[156:159], v[136:139], v[4:7]
    ds_read_b64_tr_b16 v[118:119], v183 offset:2048
    v_mfma_f32_16x16x32_bf16 v[32:35], v[160:163], v[136:139], v[32:35]
    ds_read_b64_tr_b16 v[120:121], v182 offset:8192
    v_mfma_f32_16x16x32_bf16 v[40:43], v[160:163], v[140:143], v[40:43]
    ds_read_b64_tr_b16 v[122:123], v182 offset:10240
    v_mfma_f32_16x16x32_bf16 v[48:51], v[160:163], v[144:147], v[48:51]
    ds_read_b64_tr_b16 v[124:125], v183 offset:8192
    v_mfma_f32_16x16x32_bf16 v[56:59], v[160:163], v[148:151], v[56:59]
    ds_read_b64_tr_b16 v[126:127], v183 offset:10240
    v_mfma_f32_16x16x32_bf16 v[60:63], v[164:167], v[148:151], v[60:63]
    ds_read_b64_tr_b16 v[128:129], v182 offset:16384
    v_mfma_f32_16x16x32_bf16 v[52:55], v[164:167], v[144:147], v[52:55]
    ds_read_b64_tr_b16 v[130:131], v182 offset:18432
    v_mfma_f32_16x16x32_bf16 v[44:47], v[164:167], v[140:143], v[44:47]
    ds_read_b64_tr_b16 v[132:133], v183 offset:16384
    v_mfma_f32_16x16x32_bf16 v[36:39], v[164:167], v[136:139], v[36:39]
    ds_read_b64_tr_b16 v[134:135], v183 offset:18432
    v_mfma_f32_16x16x32_bf16 v[64:67], v[136:139], v[168:171], v[64:67]
    s_cselect_b64 exec, 7, 0
    buffer_load_dword v191, v190, s[16:19], s30 offen
    s_mov_b64 exec, -1
    v_mfma_f32_16x16x32_bf16 v[68:71], v[140:143], v[168:171], v[68:71]
    s_bitcmp1_b32 s86, s36
    s_cbranch_scc1 e_fpf
e_fpf_ret:
    v_mfma_f32_16x16x32_bf16 v[72:75], v[144:147], v[168:171], v[72:75]
    s_sub_u32 s36, s36, 1
    s_cmp_eq_u32 s36, 0
    v_mfma_f32_16x16x32_bf16 v[76:79], v[148:151], v[168:171], v[76:79]
    v_mfma_f32_16x16x32_bf16 v[92:95], v[148:151], v[172:175], v[92:95]
    v_mfma_f32_16x16x32_bf16 v[88:91], v[144:147], v[172:175], v[88:91]
    v_mfma_f32_16x16x32_bf16 v[84:87], v[140:143], v[172:175], v[84:87]
    v_mfma_f32_16x16x32_bf16 v[80:83], v[136:139], v[172:175], v[80:83]
    s_cbranch_scc0 e_loop
    s_waitcnt lgkmcnt(0)
    v_mfma_f32_16x16x32_bf16 v[0:3], v[112:115], v[96:99], v[0:3]
    ds_read_b128 v[136:139], v181 offset:0
    v_mfma_f32_16x16x32_bf16 v[8:11], v[112:115], v[100:103], v[8:11]
    ds_read_b64_tr_b16 v[152:153], v182 offset:4096
    v_mfma_f32_16x16x32_bf16 v[16:19], v[112:115], v[104:107], v[16:19]
    ds_read_b64_tr_b16 v[154:155], v182 offset:6144
    v_mfma_f32_16x16x32_bf16 v[24:27], v[112:115], v[108:111], v[24:27]
    ds_read_b128 v[140:143], v181 offset:2048
    v_mfma_f32_16x16x32_bf16 v[28:31], v[116:119], v[108:111], v[28:31]
    ds_read_b128 v[144:147], v181 offset:4096
    v_mfma_f32_16x16x32_bf16 v[20:23], v[116:119], v[104:107], v[20:23]
    ds_read_b128 v[148:151], v181 offset:6144
    v_mfma_f32_16x16x32_bf16 v[12:15], v[116:119], v[100:103], v[12:15]
    ds_read_b64_tr_b16 v[156:157], v183 offset:4096
    v_mfma_f32_16x16x32_bf16 v[4:7], v[116:119], v[96:99], v[4:7]
    ds_read_b64_tr_b16 v[158:159], v183 offset:6144
    v_mfma_f32_16x16x32_bf16 v[32:35], v[120:123], v[96:99], v[32:35]
    ds_read_b64_tr_b16 v[160:161], v182 offset:12288
    v_mfma_f32_16x16x32_bf16 v[40:43], v[120:123], v[100:103], v[40:43]
    ds_read_b64_tr_b16 v[162:163], v182 offset:14336
    v_mfma_f32_16x16x32_bf16 v[48:51], v[120:123], v[104:107], v[48:51]
    ds_read_b64_tr_b16 v[164:165], v183 offset:12288
    v_mfma_f32_16x16x32_bf16 v[56:59], v[120:123], v[108:111], v[56:59]
    ds_read_b64_tr_b16 v[166:167], v183 offset:14336
    v_mfma_f32_16x16x32_bf16 v[60:63], v[124:127], v[108:111], v[60:63]
    ds_read_b64_tr_b16 v[168:169], v182 offset:20480
    v_mfma_f32_16x16x32_bf16 v[52:55], v[124:127], v[104:107], v[52:55]
    ds_read_b64_tr_b16 v[170:171], v182 offset:22528
    v_mfma_f32_16x16x32_bf16 v[44:47], v[124:127], v[100:103], v[44:47]
    ds_read_b64_tr_b16 v[172:173], v183 offset:20480
    v_mfma_f32_16x16x32_bf16 v[36:39], v[124:127], v[96:99], v[36:39]
    ds_read_b64_tr_b16 v[174:175], v183 offset:22528
    v_mfma_f32_16x16x32_bf16 v[64:67], v[96:99], v[128:131], v[64:67]
    s_cmp_lg_u32 s26, 0
    s_cbranch_scc1 e_nores
    ds_read_b128 v[208:211], v192
    ds_read_b128 v[212:215], v193
    ds_read_b128 v[216:219], v194
    ds_read_b128 v[220:223], v195
e_nores:
    v_mfma_f32_16x16x32_bf16 v[68:71], v[100:103], v[128:131], v[68:71]
    s_and_b32 s34, s3, 1
    s_lshr_b32 s35, s3, 1
    s_lshl_b32 s30, s25, 1
    v_mfma_f32_16x16x32_bf16 v[72:75], v[104:107], v[128:131], v[72:75]
    s_add_u32 s30, s30, s35
    s_lshl_b32 s30, s30, 6
    s_lshl_b32 s31, s24, 2
    v_mfma_f32_16x16x32_bf16 v[76:79], v[108:111], v[128:131], v[76:79]
    s_add_u32 s30, s30, s31
    s_lshl_b32 s31, s34, 1
    s_add_u32 s30, s30, s31
    v_mfma_f32_16x16x32_bf16 v[92:95], v[108:111], v[132:135], v[92:95]
    s_lshl_b32 s32, s30, 12
    s_add_u32 s32, s32, s26
    s_add_u32 s33, s32, 4096
    v_mfma_f32_16x16x32_bf16 v[88:91], v[104:107], v[132:135], v[88:91]
    v_mfma_f32_16x16x32_bf16 v[84:87], v[100:103], v[132:135], v[84:87]
    v_mfma_f32_16x16x32_bf16 v[80:83], v[96:99], v[132:135], v[80:83]
    s_waitcnt vmcnt(0) lgkmcnt(0)
    v_mfma_f32_16x16x32_bf16 v[32:35], v[160:163], v[136:139], v[32:35]
    s_barrier
    ds_read2_b32 v[204:205], v184 offset0:128 offset1:144
    ds_read_b128 v[128:131], v186 offset:1280
    v_mfma_f32_16x16x32_bf16 v[40:43], v[160:163], v[140:143], v[40:43]
    ds_read_b128 v[132:135], v186 offset:1344
    ds_read2_b32 v[192:193], v184 offset0:0 offset1:16
    v_mfma_f32_16x16x32_bf16 v[48:51], v[160:163], v[144:147], v[48:51]
    ds_read2_b32 v[206:207], v184 offset0:160 offset1:176
    ds_read2_b32 v[194:195], v184 offset0:32 offset1:48
    v_mfma_f32_16x16x32_bf16 v[56:59], v[160:163], v[148:151], v[56:59]
    ds_read2_b32 v[190:191], v187 offset0:0 offset1:16
    ds_read_b128 v[112:115], v185 offset:512
    v_mfma_f32_16x16x32_bf16 v[36:39], v[164:167], v[136:139], v[36:39]
    ds_read_b128 v[96:99], v185 offset:0
    ds_read_b128 v[116:119], v185 offset:576
    v_mfma_f32_16x16x32_bf16 v[44:47], v[164:167], v[140:143], v[44:47]
    ds_read_b128 v[100:103], v185 offset:64
    ds_read_b128 v[120:123], v185 offset:640
    v_mfma_f32_16x16x32_bf16 v[52:55], v[164:167], v[144:147], v[52:55]
    ds_read_b128 v[104:107], v185 offset:128
    ds_read_b128 v[124:127], v185 offset:704
    v_mfma_f32_16x16x32_bf16 v[60:63], v[164:167], v[148:151], v[60:63]
    ds_read_b128 v[108:111], v185 offset:192
    ds_read_b128 v[196:199], v186 offset:1024
    v_mfma_f32_16x16x32_bf16 v[64:67], v[136:139], v[168:171], v[64:67]
    ds_read_b128 v[200:203], v186 offset:1088
    ds_read2_b32 v[240:241], v188 offset0:0 offset1:128
    v_mfma_f32_16x16x32_bf16 v[68:71], v[140:143], v[168:171], v[68:71]
    ds_read_b64 v[250:251], v189 offset:3072
    v_mfma_f32_16x16x32_bf16 v[72:75], v[144:147], v[168:171], v[72:75]
    s_waitcnt lgkmcnt(13)
    v_fma_f32 v32, v128, -v204, v32
    v_fma_f32 v33, v129, -v204, v33
    v_fma_f32 v34, v130, -v204, v34
    v_mfma_f32_16x16x32_bf16 v[76:79], v[148:151], v[168:171], v[76:79]
    v_fma_f32 v35, v131, -v204, v35
    v_fma_f32 v36, v132, -v204, v36
    v_fma_f32 v37, v133, -v204, v37
    v_mfma_f32_16x16x32_bf16 v[80:83], v[136:139], v[172:175], v[80:83]
    v_fma_f32 v38, v134, -v204, v38
    v_fma_f32 v39, v135, -v204, v39
    v_mul_f32_e64 v32, v32, v192
    v_mfma_f32_16x16x32_bf16 v[84:87], v[140:143], v[172:175], v[84:87]
    v_mul_f32 v33, v33, v192
    v_mul_f32 v34, v34, v192
    v_mul_f32_e64 v35, v35, v192
    v_mfma_f32_16x16x32_bf16 v[88:91], v[144:147], v[172:175], v[88:91]
    v_mul_f32 v36, v36, v192
    v_mul_f32 v37, v37, v192
    v_mul_f32_e64 v38, v38, v192
    v_mfma_f32_16x16x32_bf16 v[92:95], v[148:151], v[172:175], v[92:95]
    v_mul_f32_e64 v39, v39, v192
    v_cvt_pk_bf16_f32 v32, v32, v33
    v_cvt_pk_bf16_f32 v33, v34, v35
    v_mfma_f32_16x16x32_bf16 v[0:3], v[152:155], v[136:139], v[0:3]
    v_cvt_pk_bf16_f32 v34, v36, v37
    v_cvt_pk_bf16_f32 v35, v38, v39
    buffer_store_dwordx4 v[32:35], v244, s[20:23], s32 offen offset:0 sc1
    v_mfma_f32_16x16x32_bf16 v[8:11], v[152:155], v[140:143], v[8:11]
    v_fma_f32 v40, v128, -v205, v40
    v_fma_f32 v41, v129, -v205, v41
    v_fma_f32 v42, v130, -v205, v42
    v_mfma_f32_16x16x32_bf16 v[16:19], v[152:155], v[144:147], v[16:19]
    v_fma_f32 v43, v131, -v205, v43
    v_fma_f32 v44, v132, -v205, v44
    v_fma_f32 v45, v133, -v205, v45
    v_mfma_f32_16x16x32_bf16 v[24:27], v[152:155], v[148:151], v[24:27]
    v_fma_f32 v46, v134, -v205, v46
    v_fma_f32 v47, v135, -v205, v47
    v_mul_f32_e64 v40, v40, v193
    v_mfma_f32_16x16x32_bf16 v[4:7], v[156:159], v[136:139], v[4:7]
    v_mul_f32 v41, v41, v193
    v_mul_f32 v42, v42, v193
    v_mul_f32_e64 v43, v43, v193
    v_mfma_f32_16x16x32_bf16 v[12:15], v[156:159], v[140:143], v[12:15]
    v_mul_f32 v44, v44, v193
    v_mul_f32 v45, v45, v193
    v_mul_f32_e64 v46, v46, v193
    v_mfma_f32_16x16x32_bf16 v[20:23], v[156:159], v[144:147], v[20:23]
    v_mul_f32 v47, v47, v193
    v_cvt_pk_bf16_f32 v40, v40, v41
    v_cvt_pk_bf16_f32 v41, v42, v43
    v_mfma_f32_16x16x32_bf16 v[28:31], v[156:159], v[148:151], v[28:31]
    v_cvt_pk_bf16_f32 v42, v44, v45
    v_cvt_pk_bf16_f32 v43, v46, v47
    buffer_store_dwordx4 v[40:43], v244, s[20:23], s32 offen offset:128 sc1
    v_pk_fma_f32 v[48:49], v[128:129], v[206:207], v[48:49] op_sel_hi:[1,0,1] neg_lo:[0,1,0] neg_hi:[0,1,0]
    v_pk_fma_f32 v[50:51], v[130:131], v[206:207], v[50:51] op_sel_hi:[1,0,1] neg_lo:[0,1,0] neg_hi:[0,1,0]
    v_pk_fma_f32 v[52:53], v[132:133], v[206:207], v[52:53] op_sel_hi:[1,0,1] neg_lo:[0,1,0] neg_hi:[0,1,0]
    v_pk_fma_f32 v[54:55], v[134:135], v[206:207], v[54:55] op_sel_hi:[1,0,1] neg_lo:[0,1,0] neg_hi:[0,1,0]
    v_pk_mul_f32 v[48:49], v[48:49], v[194:195] op_sel_hi:[1,0]
    v_pk_mul_f32 v[50:51], v[50:51], v[194:195] op_sel_hi:[1,0]
    v_pk_mul_f32 v[52:53], v[52:53], v[194:195] op_sel_hi:[1,0]
    v_pk_mul_f32 v[54:55], v[54:55], v[194:195] op_sel_hi:[1,0]
    v_cvt_pk_bf16_f32 v48, v48, v49
    v_cvt_pk_bf16_f32 v49, v50, v51
    v_cvt_pk_bf16_f32 v50, v52, v53
    v_cvt_pk_bf16_f32 v51, v54, v55
    buffer_store_dwordx4 v[48:51], v244, s[20:23], s33 offen offset:0 sc1
    v_pk_fma_f32 v[56:57], v[128:129], v[206:207], v[56:57] op_sel:[0,1,0] op_sel_hi:[1,1,1] neg_lo:[0,1,0] neg_hi:[0,1,0]
    v_pk_fma_f32 v[58:59], v[130:131], v[206:207], v[58:59] op_sel:[0,1,0] op_sel_hi:[1,1,1] neg_lo:[0,1,0] neg_hi:[0,1,0]
    v_pk_fma_f32 v[60:61], v[132:133], v[206:207], v[60:61] op_sel:[0,1,0] op_sel_hi:[1,1,1] neg_lo:[0,1,0] neg_hi:[0,1,0]
    v_pk_fma_f32 v[62:63], v[134:135], v[206:207], v[62:63] op_sel:[0,1,0] op_sel_hi:[1,1,1] neg_lo:[0,1,0] neg_hi:[0,1,0]
    v_pk_mul_f32 v[56:57], v[56:57], v[194:195] op_sel:[0,1] op_sel_hi:[1,1]
    v_pk_mul_f32 v[58:59], v[58:59], v[194:195] op_sel:[0,1] op_sel_hi:[1,1]
    v_pk_mul_f32 v[60:61], v[60:61], v[194:195] op_sel:[0,1] op_sel_hi:[1,1]
    v_pk_mul_f32 v[62:63], v[62:63], v[194:195] op_sel:[0,1] op_sel_hi:[1,1]
    v_cvt_pk_bf16_f32 v56, v56, v57
    v_cvt_pk_bf16_f32 v57, v58, v59
    v_cvt_pk_bf16_f32 v58, v60, v61
    v_cvt_pk_bf16_f32 v59, v62, v63
    buffer_store_dwordx4 v[56:59], v244, s[20:23], s33 offen offset:128 sc1
    s_waitcnt lgkmcnt(0)
    v_pk_fma_f32 v[64:65], v[112:113], v[190:191], v[64:65] op_sel_hi:[1,0,1] neg_lo:[0,1,0] neg_hi:[0,1,0]
    v_pk_fma_f32 v[66:67], v[114:115], v[190:191], v[66:67] op_sel_hi:[1,0,1] neg_lo:[0,1,0] neg_hi:[0,1,0]
    v_pk_fma_f32 v[68:69], v[116:117], v[190:191], v[68:69] op_sel_hi:[1,0,1] neg_lo:[0,1,0] neg_hi:[0,1,0]
    v_pk_fma_f32 v[70:71], v[118:119], v[190:191], v[70:71] op_sel_hi:[1,0,1] neg_lo:[0,1,0] neg_hi:[0,1,0]
    v_pk_mul_f32 v[64:65], v[64:65], v[96:97]
    v_pk_mul_f32 v[66:67], v[66:67], v[98:99]
    v_pk_mul_f32 v[68:69], v[68:69], v[100:101]
    v_pk_mul_f32 v[70:71], v[70:71], v[102:103]
    v_cvt_pk_bf16_f32 v64, v64, v65
    v_cvt_pk_bf16_f32 v65, v66, v67
    v_cvt_pk_bf16_f32 v66, v68, v69
    v_cvt_pk_bf16_f32 v67, v70, v71
    buffer_store_dwordx4 v[64:67], v245, s[20:23], s32 offen offset:2048 sc1
    v_pk_fma_f32 v[80:81], v[112:113], v[190:191], v[80:81] op_sel:[0,1,0] op_sel_hi:[1,1,1] neg_lo:[0,1,0] neg_hi:[0,1,0]
    v_pk_fma_f32 v[82:83], v[114:115], v[190:191], v[82:83] op_sel:[0,1,0] op_sel_hi:[1,1,1] neg_lo:[0,1,0] neg_hi:[0,1,0]
    v_pk_fma_f32 v[84:85], v[116:117], v[190:191], v[84:85] op_sel:[0,1,0] op_sel_hi:[1,1,1] neg_lo:[0,1,0] neg_hi:[0,1,0]
    v_pk_fma_f32 v[86:87], v[118:119], v[190:191], v[86:87] op_sel:[0,1,0] op_sel_hi:[1,1,1] neg_lo:[0,1,0] neg_hi:[0,1,0]
    v_pk_mul_f32 v[80:81], v[80:81], v[96:97]
    v_pk_mul_f32 v[82:83], v[82:83], v[98:99]
    v_pk_mul_f32 v[84:85], v[84:85], v[100:101]
    v_pk_mul_f32 v[86:87], v[86:87], v[102:103]
    v_cvt_pk_bf16_f32 v80, v80, v81
    v_cvt_pk_bf16_f32 v81, v82, v83
    v_cvt_pk_bf16_f32 v82, v84, v85
    v_cvt_pk_bf16_f32 v83, v86, v87
    buffer_store_dwordx4 v[80:83], v245, s[20:23], s32 offen offset:2304 sc1
    v_pk_fma_f32 v[72:73], v[120:121], v[190:191], v[72:73] op_sel_hi:[1,0,1] neg_lo:[0,1,0] neg_hi:[0,1,0]
    v_pk_fma_f32 v[74:75], v[122:123], v[190:191], v[74:75] op_sel_hi:[1,0,1] neg_lo:[0,1,0] neg_hi:[0,1,0]
    v_pk_fma_f32 v[76:77], v[124:125], v[190:191], v[76:77] op_sel_hi:[1,0,1] neg_lo:[0,1,0] neg_hi:[0,1,0]
    v_pk_fma_f32 v[78:79], v[126:127], v[190:191], v[78:79] op_sel_hi:[1,0,1] neg_lo:[0,1,0] neg_hi:[0,1,0]
    v_pk_mul_f32 v[72:73], v[72:73], v[104:105]
    v_pk_mul_f32 v[74:75], v[74:75], v[106:107]
    v_pk_mul_f32 v[76:77], v[76:77], v[108:109]
    v_pk_mul_f32 v[78:79], v[78:79], v[110:111]
    v_cvt_pk_bf16_f32 v72, v72, v73
    v_cvt_pk_bf16_f32 v73, v74, v75
    v_cvt_pk_bf16_f32 v74, v76, v77
    v_cvt_pk_bf16_f32 v75, v78, v79
    buffer_store_dwordx4 v[72:75], v245, s[20:23], s33 offen offset:2048 sc1
    v_pk_fma_f32 v[88:89], v[120:121], v[190:191], v[88:89] op_sel:[0,1,0] op_sel_hi:[1,1,1] neg_lo:[0,1,0] neg_hi:[0,1,0]
    v_pk_fma_f32 v[90:91], v[122:123], v[190:191], v[90:91] op_sel:[0,1,0] op_sel_hi:[1,1,1] neg_lo:[0,1,0] neg_hi:[0,1,0]
    v_pk_fma_f32 v[92:93], v[124:125], v[190:191], v[92:93] op_sel:[0,1,0] op_sel_hi:[1,1,1] neg_lo:[0,1,0] neg_hi:[0,1,0]
    v_pk_fma_f32 v[94:95], v[126:127], v[190:191], v[94:95] op_sel:[0,1,0] op_sel_hi:[1,1,1] neg_lo:[0,1,0] neg_hi:[0,1,0]
    v_pk_mul_f32 v[88:89], v[88:89], v[104:105]
    v_pk_mul_f32 v[90:91], v[90:91], v[106:107]
    v_pk_mul_f32 v[92:93], v[92:93], v[108:109]
    v_pk_mul_f32 v[94:95], v[94:95], v[110:111]
    v_cvt_pk_bf16_f32 v88, v88, v89
    v_cvt_pk_bf16_f32 v89, v90, v91
    v_cvt_pk_bf16_f32 v90, v92, v93
    v_cvt_pk_bf16_f32 v91, v94, v95
    buffer_store_dwordx4 v[88:91], v245, s[20:23], s33 offen offset:2304 sc1
    ds_write_b128 v246, v[32:35] offset:0
    v_mul_f32 v192, 0x3e8293ee, v192
    ds_write_b128 v246, v[40:43] offset:128
    v_mul_f32 v193, 0x3e8293ee, v193
    ds_write_b128 v246, v[48:51] offset:4096
    v_mul_f32 v194, 0x3e8293ee, v194
    ds_write_b128 v246, v[56:59] offset:4224
    v_mul_f32 v195, 0x3e8293ee, v195
    v_pk_fma_f32 v[0:1], v[196:197], v[204:205], v[0:1] op_sel_hi:[1,0,1] neg_lo:[0,1,0] neg_hi:[0,1,0]
    v_pk_fma_f32 v[2:3], v[198:199], v[204:205], v[2:3] op_sel_hi:[1,0,1] neg_lo:[0,1,0] neg_hi:[0,1,0]
    v_pk_fma_f32 v[4:5], v[200:201], v[204:205], v[4:5] op_sel_hi:[1,0,1] neg_lo:[0,1,0] neg_hi:[0,1,0]
    v_pk_fma_f32 v[6:7], v[202:203], v[204:205], v[6:7] op_sel_hi:[1,0,1] neg_lo:[0,1,0] neg_hi:[0,1,0]
    v_pk_mul_f32 v[0:1], v[0:1], v[192:193] op_sel_hi:[1,0]
    v_pk_mul_f32 v[2:3], v[2:3], v[192:193] op_sel_hi:[1,0]
    v_pk_mul_f32 v[4:5], v[4:5], v[192:193] op_sel_hi:[1,0]
    v_pk_mul_f32 v[6:7], v[6:7], v[192:193] op_sel_hi:[1,0]
    v_cvt_pk_bf16_f32 v0, v0, v1
    v_cvt_pk_bf16_f32 v1, v2, v3
    v_cvt_pk_bf16_f32 v2, v4, v5
    v_cvt_pk_bf16_f32 v3, v6, v7
    ds_write_b128 v247, v[64:67] offset:2048
    ds_write_b128 v248, v[0:3] offset:0
    v_pk_fma_f32 v[8:9], v[196:197], v[204:205], v[8:9] op_sel:[0,1,0] op_sel_hi:[1,1,1] neg_lo:[0,1,0] neg_hi:[0,1,0]
    v_pk_fma_f32 v[10:11], v[198:199], v[204:205], v[10:11] op_sel:[0,1,0] op_sel_hi:[1,1,1] neg_lo:[0,1,0] neg_hi:[0,1,0]
    v_pk_fma_f32 v[12:13], v[200:201], v[204:205], v[12:13] op_sel:[0,1,0] op_sel_hi:[1,1,1] neg_lo:[0,1,0] neg_hi:[0,1,0]
    v_pk_fma_f32 v[14:15], v[202:203], v[204:205], v[14:15] op_sel:[0,1,0] op_sel_hi:[1,1,1] neg_lo:[0,1,0] neg_hi:[0,1,0]
    v_pk_mul_f32 v[8:9], v[8:9], v[192:193] op_sel:[0,1] op_sel_hi:[1,1]
    v_pk_mul_f32 v[10:11], v[10:11], v[192:193] op_sel:[0,1] op_sel_hi:[1,1]
    v_pk_mul_f32 v[12:13], v[12:13], v[192:193] op_sel:[0,1] op_sel_hi:[1,1]
    v_pk_mul_f32 v[14:15], v[14:15], v[192:193] op_sel:[0,1] op_sel_hi:[1,1]
    v_cvt_pk_bf16_f32 v8, v8, v9
    v_cvt_pk_bf16_f32 v9, v10, v11
    v_cvt_pk_bf16_f32 v10, v12, v13
    v_cvt_pk_bf16_f32 v11, v14, v15
    ds_write_b128 v247, v[80:83] offset:2304
    ds_write_b128 v248, v[8:11] offset:256
    v_pk_fma_f32 v[16:17], v[196:197], v[206:207], v[16:17] op_sel_hi:[1,0,1] neg_lo:[0,1,0] neg_hi:[0,1,0]
    v_pk_fma_f32 v[18:19], v[198:199], v[206:207], v[18:19] op_sel_hi:[1,0,1] neg_lo:[0,1,0] neg_hi:[0,1,0]
    v_pk_fma_f32 v[20:21], v[200:201], v[206:207], v[20:21] op_sel_hi:[1,0,1] neg_lo:[0,1,0] neg_hi:[0,1,0]
    v_pk_fma_f32 v[22:23], v[202:203], v[206:207], v[22:23] op_sel_hi:[1,0,1] neg_lo:[0,1,0] neg_hi:[0,1,0]
    v_pk_mul_f32 v[16:17], v[16:17], v[194:195] op_sel_hi:[1,0]
    v_pk_mul_f32 v[18:19], v[18:19], v[194:195] op_sel_hi:[1,0]
    v_pk_mul_f32 v[20:21], v[20:21], v[194:195] op_sel_hi:[1,0]
    v_pk_mul_f32 v[22:23], v[22:23], v[194:195] op_sel_hi:[1,0]
    v_cvt_pk_bf16_f32 v16, v16, v17
    v_cvt_pk_bf16_f32 v17, v18, v19
    v_cvt_pk_bf16_f32 v18, v20, v21
    v_cvt_pk_bf16_f32 v19, v22, v23
    ds_write_b128 v247, v[72:75] offset:6144
    ds_write_b128 v248, v[16:19] offset:2048
    v_pk_fma_f32 v[24:25], v[196:197], v[206:207], v[24:25] op_sel:[0,1,0] op_sel_hi:[1,1,1] neg_lo:[0,1,0] neg_hi:[0,1,0]
    v_pk_fma_f32 v[26:27], v[198:199], v[206:207], v[26:27] op_sel:[0,1,0] op_sel_hi:[1,1,1] neg_lo:[0,1,0] neg_hi:[0,1,0]
    v_pk_fma_f32 v[28:29], v[200:201], v[206:207], v[28:29] op_sel:[0,1,0] op_sel_hi:[1,1,1] neg_lo:[0,1,0] neg_hi:[0,1,0]
    v_pk_fma_f32 v[30:31], v[202:203], v[206:207], v[30:31] op_sel:[0,1,0] op_sel_hi:[1,1,1] neg_lo:[0,1,0] neg_hi:[0,1,0]
    v_pk_mul_f32 v[24:25], v[24:25], v[194:195] op_sel:[0,1] op_sel_hi:[1,1]
    v_pk_mul_f32 v[26:27], v[26:27], v[194:195] op_sel:[0,1] op_sel_hi:[1,1]
    v_pk_mul_f32 v[28:29], v[28:29], v[194:195] op_sel:[0,1] op_sel_hi:[1,1]
    v_pk_mul_f32 v[30:31], v[30:31], v[194:195] op_sel:[0,1] op_sel_hi:[1,1]
    v_cvt_pk_bf16_f32 v24, v24, v25
    v_cvt_pk_bf16_f32 v25, v26, v27
    v_cvt_pk_bf16_f32 v26, v28, v29
    v_cvt_pk_bf16_f32 v27, v30, v31
    ds_write_b128 v247, v[88:91] offset:6400
    ds_write_b128 v248, v[24:27] offset:2304
    s_lshl_b32 s30, s25, 8
    s_lshl_b32 s31, s24, 4
    s_add_u32 s30, s30, s31
    s_lshl_b32 s31, s34, 3
    s_add_u32 s30, s30, s31
    s_lshl_b32 s31, s35, 2
    s_add_u32 s30, s30, s31
    s_lshl_b32 s30, s30, 3
    s_add_u32 s30, s30, s26
    s_add_u32 s30, s30, 0xe00000
    v_readfirstlane_b32 s73, v250
    v_readfirstlane_b32 s77, v251
    s_lshr_b32 s39, s73, 5
    s_lshl_b32 s34, s24, 2
    s_sub_u32 s39, s39, s34
    s_add_u32 s39, s39, 8
    s_lshr_b32 s34, s39, 3
    s_add_u32 s34, s34, 1
    s_cmp_lt_u32 s39, 12
    s_cselect_b32 s100, s34, 0
    s_cmp_lg_u32 s26, 0
    s_cbranch_scc1 sk_2
    v_permlane32_swap_b32 v208, v210
    v_permlane32_swap_b32 v209, v211
    v_permlane32_swap_b32 v212, v214
    v_permlane32_swap_b32 v213, v215
    v_permlane32_swap_b32 v216, v218
    v_permlane32_swap_b32 v217, v219
    v_permlane32_swap_b32 v220, v222
    v_permlane32_swap_b32_e64 v221, v223
sk_2:
    v_mov_b32 v20, 0xffff
    v_mov_b32 v21, 0xffff0000
    v_cndmask_b32 v22, 0, v20, s[40:41]
    v_cndmask_b32 v23, 0, v21, s[42:43]
    v_or_b32_e64 v12, v22, v23
    v_cndmask_b32 v22, 0, v20, s[44:45]
    v_cndmask_b32 v23, 0, v21, s[46:47]
    v_or_b32_e64 v13, v22, v23
    v_cndmask_b32 v22, 0, v20, s[48:49]
    v_cndmask_b32 v23, 0, v21, s[50:51]
    v_or_b32_e64 v14, v22, v23
    v_cndmask_b32 v22, 0, v20, s[52:53]
    v_cndmask_b32 v23, 0, v21, s[54:55]
    v_or_b32_e64 v15, v22, v23
    v_cndmask_b32 v22, 0, v20, s[56:57]
    v_cndmask_b32 v23, 0, v21, s[58:59]
    v_or_b32_e64 v16, v22, v23
    v_cndmask_b32 v22, 0, v20, s[60:61]
    v_cndmask_b32 v23, 0, v21, s[62:63]
    v_or_b32_e64 v17, v22, v23
    v_cndmask_b32 v22, 0, v20, s[64:65]
    v_cndmask_b32 v23, 0, v21, s[66:67]
    v_or_b32_e64 v18, v22, v23
    v_cndmask_b32 v22, 0, v20, s[68:69]
    v_cndmask_b32 v23, 0, v21, s[70:71]
    v_or_b32 v19, v22, v23
    s_xor_b32 s76, s99, 0
    s_and_b32 s34, s76, 3
    s_lshl_b32 s33, s34, 12
    s_add_u32 s33, s33, 65536
    v_add_u32_e64 v20, s33, v253
    v_add_u32 v22, 32768, v20
    v_add_u32 v23, 94208, v253
    s_add_u32 s74, s34, 1
    s_mov_b32 s75, 0
    s_lshl_b32 s34, s34, 11
    s_add_u32 s34, s34, 49152
    v_add_u32 v3, s34, v253
    v_mov_b32 v21, 0xf149f2ca
    v_cndmask_b32 v24, v21, 0, s[40:41]
    v_cndmask_b32 v25, v21, 0, s[42:43]
    v_cndmask_b32 v26, v21, 0, s[44:45]
    v_cndmask_b32 v27, v21, 0, s[46:47]
    v_cndmask_b32 v28, v21, 0, s[48:49]
    v_cndmask_b32 v29, v21, 0, s[50:51]
    v_cndmask_b32 v30, v21, 0, s[52:53]
    v_cndmask_b32 v31, v21, 0, s[54:55]
    v_cndmask_b32 v32, v21, 0, s[56:57]
    v_cndmask_b32 v33, v21, 0, s[58:59]
    v_cndmask_b32 v34, v21, 0, s[60:61]
    v_cndmask_b32 v35, v21, 0, s[62:63]
    v_cndmask_b32 v36, v21, 0, s[64:65]
    v_cndmask_b32 v37, v21, 0, s[66:67]
    v_cndmask_b32 v38, v21, 0, s[68:69]
    v_cndmask_b32 v39, v21, 0, s[70:71]
    v_lshrrev_b32 v40, 2, v252
    v_xor_b32 v40, v40, v252
    v_bfe_u32 v40, v40, 2, 1
    v_add_u32_e64 v40, -1, v40
    v_and_b32 v40, 0x3f803f80, v40
    v_mov_b32 v41, v40
    v_mov_b32 v42, v40
    v_mov_b32 v43, v40
    v_mov_b32 v44, 0
    v_mov_b32 v45, 0
    v_mov_b32 v46, 0
    v_mov_b32 v47, 0
    v_mov_b32 v88, 0
    v_mov_b32 v89, 0
    v_mov_b32 v90, 0
    v_mov_b32 v91, 0
    v_mov_b32 v92, 0
    v_mov_b32 v93, 0
    v_mov_b32 v94, 0
    v_mov_b32 v95, 0
    v_mov_b32 v96, 0
    v_mov_b32 v97, 0
    v_mov_b32 v98, 0
    v_mov_b32 v99, 0
    v_mov_b32 v100, 0
    v_mov_b32 v101, 0
    v_mov_b32 v102, 0
    v_mov_b32_e64 v103, 0
    s_cmp_lg_u32 s100, 2
    s_cbranch_scc1 sk_3
    s_and_b32 s32, s28, 1
    s_lshr_b32 s33, s28, 1
    s_add_u32 s36, s32, s24
    s_sub_u32 s36, s36, 2
    s_lshl_b32 s37, s25, 4
    s_add_u32 s37, s37, s36
    s_lshl_b32 s37, s37, 2
    s_add_u32 s37, s37, s33
    s_lshl_b32 s37, s37, 5
    s_add_u32 s37, s37, s26
    s_add_u32 s37, s37, 0xe00000
    s_lshl_b32 s38, s25, 1
    s_add_u32 s38, s38, s33
    s_lshl_b32 s38, s38, 4
    s_add_u32 s38, s38, s36
    s_lshl_b32 s38, s38, 14
    s_add_u32 s38, s38, s26
    s_mul_i32 s33, s33, 49152
    s_lshl_b32 s32, s32, 14
    s_add_u32 s39, s32, s33
    v_and_b32 v48, 8, v252
    v_lshlrev_b32 v48, 3, v48
    v_mov_b32_e64 v154, s88
    s_mov_b64 exec, 1
    s_waitcnt vmcnt(0)
    buffer_store_dword v154, v253, s[20:23], s30 offen sc1
    s_mov_b64 exec, -1
sk_3:
    s_waitcnt lgkmcnt(0)
    s_barrier
    s_cmp_lg_u32 s100, 2
    s_cbranch_scc1 sk_4
    s_lshr_b32 s34, s73, 5
    s_cmp_lg_u32 s34, s99
    s_cbranch_scc1 sk_5
    s_lshl_b32 s34, s98, 7
    s_lshr_b32 vcc_lo, s24, 1
    s_lshl_b32 vcc_lo, vcc_lo, 11
    s_add_u32 vcc_lo, vcc_lo, s34
    s_add_u32 s34, vcc_lo, 0xdc4000
    s_and_b32 s32, s73, 31
    v_and_b32 v0, 31, v252
    v_cmp_eq_u32 vcc, s32, v0
    v_lshrrev_b32 v0, 5, v252
    v_lshlrev_b32 v0, 3, v0
    s_mov_b64 exec, vcc
    buffer_load_dwordx2 v[208:209], v0, s[20:23], s34 offen offset:0 sc1
    buffer_load_dwordx2 v[210:211], v0, s[20:23], s34 offen offset:16 sc1
    buffer_load_dwordx2 v[212:213], v0, s[20:23], s34 offen offset:32 sc1
    buffer_load_dwordx2 v[214:215], v0, s[20:23], s34 offen offset:48 sc1
    buffer_load_dwordx2 v[216:217], v0, s[20:23], s34 offen offset:64 sc1
    buffer_load_dwordx2 v[218:219], v0, s[20:23], s34 offen offset:80 sc1
    buffer_load_dwordx2 v[220:221], v0, s[20:23], s34 offen offset:96 sc1
    buffer_load_dwordx2 v[222:223], v0, s[20:23], s34 offen offset:112 sc1
    v_mov_b32_e64 v240, 1.0
    v_mov_b32 v241, 0
    s_mov_b64 exec, -1
sk_5:
    s_barrier
sk_4:
    ds_read_b128 v[4:7], v3
    ds_read_b128 v[8:11], v3 offset:1024
    ds_read_b128 v[112:115], v22 offset:0
    ds_read_b128 v[116:119], v22 offset:1024
    s_waitcnt lgkmcnt(0)
    v_mfma_f32_32x32x16_bf16 v[56:71], v[112:115], v[4:7], v[24:39]
    v_mfma_f32_32x32x16_bf16 v[56:71], v[116:119], v[8:11], v[56:71]
    ds_read_b128 v[104:107], v23 offset:4096
    ds_read_b128 v[124:127], v22 offset:3072
    ds_read_b128 v[108:111], v23 offset:5120
    ds_read_b128 v[120:123], v22 offset:2048
    s_cmp_eq_u32 s100, 2
    s_cbranch_scc1 sk_7
    s_and_b32 s32, s28, 1
    s_lshr_b32 s33, s28, 1
    s_add_u32 s36, s32, s24
    s_sub_u32 s36, s36, 2
    s_lshl_b32 s37, s25, 4
    s_add_u32 s37, s37, s36
    s_lshl_b32 s37, s37, 2
    s_add_u32 s37, s37, s33
    s_lshl_b32 s37, s37, 5
    s_add_u32 s37, s37, s26
    s_add_u32 s37, s37, 0xe00000
    s_lshl_b32 s38, s25, 1
    s_add_u32 s38, s38, s33
    s_lshl_b32 s38, s38, 4
    s_add_u32 s38, s38, s36
    s_lshl_b32 s38, s38, 14
    s_add_u32 s38, s38, s26
    s_mul_i32 s33, s33, 49152
    s_lshl_b32 s32, s32, 14
    s_add_u32 s39, s32, s33
    v_and_b32 v48, 8, v252
    v_lshlrev_b32 v48, 3, v48
    v_mov_b32_e64 v154, s88
    s_mov_b64 exec, 1
    s_waitcnt vmcnt(0)
    buffer_store_dword v154, v253, s[20:23], s30 offen sc1
    s_mov_b64 exec, -1
sk_7:
    s_nop 5
    v_max3_f32 v21, v56, v57, v58
    v_max3_f32 v152, v59, v60, v61
    v_max3_f32 v21, v21, v62, v63
    v_max3_f32 v152, v152, v64, v65
    v_max3_f32 v21, v21, v66, v67
    v_max3_f32 v152, v152, v68, v69
    v_max3_f32 v21, v21, v70, v71
    v_max_f32 v21, v21, v152
    v_mov_b32 v152, v21
    s_nop 1
    v_permlane32_swap_b32 v21, v152
    v_max_f32 v21, v21, v152
    v_sub_f32 v24, 0, v21
    v_sub_f32 v25, 0, v21
    v_sub_f32 v26, 0, v21
    v_sub_f32 v27, 0, v21
    v_sub_f32 v28, 0, v21
    v_sub_f32 v29, 0, v21
    v_sub_f32 v30, 0, v21
    v_sub_f32 v31, 0, v21
    v_sub_f32 v32, 0, v21
    v_sub_f32 v33, 0, v21
    v_sub_f32 v34, 0, v21
    v_sub_f32 v35, 0, v21
    v_sub_f32 v36, 0, v21
    v_sub_f32 v37, 0, v21
    v_sub_f32 v38, 0, v21
    v_sub_f32 v39, 0, v21
    s_branch a0_6_go
    s_nop 0
a0_6_mid:
    s_cmp_ge_u32 s76, 8
    s_cselect_b32 s33, 0, -1
    v_not_b32 v12, v12
    v_or_b32 v12, s33, v12
    v_not_b32 v13, v13
    v_or_b32 v13, s33, v13
    v_not_b32 v14, v14
    v_or_b32 v14, s33, v14
    v_not_b32 v15, v15
    v_or_b32 v15, s33, v15
    v_not_b32 v16, v16
    v_or_b32 v16, s33, v16
    v_not_b32 v17, v17
    v_or_b32 v17, s33, v17
    v_not_b32 v18, v18
    v_or_b32 v18, s33, v18
    v_not_b32 v19, v19
    v_or_b32 v19, s33, v19
    s_and_b32 s32, s76, 3
    s_cmp_ge_u32 s76, 8
    s_cselect_b32 s32, s32, 4
    s_sub_u32 s74, 8, s32
    s_lshl_b32 s32, s32, 12
    s_add_u32 s32, s32, 65536
    v_add_u32 v22, s32, v253
    v_add_u32 v23, s32, v253
    s_cmp_eq_u32 s26, 0
    s_cselect_b32 s75, 2, 1
    s_cmp_lt_i32 s36, 0
    s_cbranch_scc1 sk_8
    s_mov_b32 s78, s27
pl_9:
    buffer_load_dword v49, v48, s[20:23], s37 offen sc1
    s_waitcnt vmcnt(0)
pc_10:
    v_cmp_ne_u32 vcc, s88, v49
    s_cbranch_vccz pd_11
    s_sub_u32 s78, s78, 1
    s_cmp_lg_u32 s78, 0
    s_cbranch_scc1 pl_9
    s_mov_b32 s27, 1
pd_11:
    s_mov_b32 s36, -1
    s_add_u32 m0, s39, 65536
    s_add_u32 s32, s38, 0
    buffer_load_dwordx4 v253, s[20:23], s32 offen offset:0 sc1 lds
    buffer_load_dwordx4 v253, s[20:23], s32 offen offset:1024 sc1 lds
    buffer_load_dwordx4 v253, s[20:23], s32 offen offset:2048 sc1 lds
    buffer_load_dwordx4 v253, s[20:23], s32 offen offset:3072 sc1 lds
    s_add_u32 m0, s39, 69632
    s_add_u32 s32, s38, 4096
    buffer_load_dwordx4 v253, s[20:23], s32 offen offset:0 sc1 lds
    buffer_load_dwordx4 v253, s[20:23], s32 offen offset:1024 sc1 lds
    buffer_load_dwordx4 v253, s[20:23], s32 offen offset:2048 sc1 lds
    buffer_load_dwordx4 v253, s[20:23], s32 offen offset:3072 sc1 lds
    s_add_u32 m0, s39, 73728
    s_add_u32 s32, s38, 8192
    buffer_load_dwordx4 v253, s[20:23], s32 offen offset:0 sc1 lds
    buffer_load_dwordx4 v253, s[20:23], s32 offen offset:1024 sc1 lds
    buffer_load_dwordx4 v253, s[20:23], s32 offen offset:2048 sc1 lds
    buffer_load_dwordx4 v253, s[20:23], s32 offen offset:3072 sc1 lds
    s_add_u32 m0, s39, 77824
    s_add_u32 s32, s38, 12288
    buffer_load_dwordx4 v253, s[20:23], s32 offen offset:0 sc1 lds
    buffer_load_dwordx4 v253, s[20:23], s32 offen offset:1024 sc1 lds
    buffer_load_dwordx4 v253, s[20:23], s32 offen offset:2048 sc1 lds
    buffer_load_dwordx4 v253, s[20:23], s32 offen offset:3072 sc1 lds
sk_8:
    s_cmp_eq_u32 s100, 1
    s_cselect_b32 s32, 0, s28
    s_cmp_ge_u32 s32, 2
    s_cbranch_scc1 sk_12
    s_waitcnt vmcnt(0)
sk_12:
    s_barrier
    s_cmp_lg_u32 s100, 1
    s_cbranch_scc1 sk_13
    s_barrier
sk_13:
    s_cmp_lt_u32 s76, 4
    s_cbranch_scc1 a0_6_none
    ds_read_b128 v[112:115], v22 offset:0
    ds_read_b128 v[116:119], v22 offset:1024
    ds_read_b128 v[104:107], v23 offset:4096
    ds_read_b128 v[124:127], v22 offset:3072
    ds_read_b128 v[108:111], v23 offset:5120
    ds_read_b128 v[120:123], v22 offset:2048
    s_waitcnt lgkmcnt(4)
a0_6_go:
    s_nop 0
    v_mfma_f32_32x32x16_bf16 v[56:71], v[112:115], v[4:7], v[24:39]
    v_mfma_f32_32x32x16_bf16 v[56:71], v[116:119], v[8:11], v[56:71]
    s_waitcnt lgkmcnt(3)
    v_mfma_f32_32x32x16_bf16 v[72:87], v[104:107], v[4:7], v[24:39]
    ds_read_b128 v[104:107], v23 offset:8192
    s_nop 8
    v_exp_f32 v56, v56
    v_exp_f32 v57, v57
    v_exp_f32 v58, v58
    ds_read_b128 v[128:131], v23 offset:7168
    v_exp_f32 v59, v59
    v_exp_f32 v60, v60
    v_exp_f32 v61, v61
    s_waitcnt lgkmcnt(2)
    v_mfma_f32_32x32x16_bf16 v[72:87], v[108:111], v[8:11], v[72:87]
    ds_read_b128 v[108:111], v23 offset:9216
    v_exp_f32 v62, v62
    v_exp_f32 v63, v63
    v_cvt_pk_bf16_f32 v136, v56, v57
    v_cvt_pk_bf16_f32 v137, v58, v59
    v_cvt_pk_bf16_f32 v138, v60, v61
    v_cvt_pk_bf16_f32 v139, v62, v63
    v_and_b32 v136, v136, v12
    v_and_b32 v137, v137, v13
    v_and_b32 v138, v138, v14
    v_and_b32 v139, v139, v15
    v_exp_f32 v64, v64
    v_exp_f32 v65, v65
    v_mfma_f32_32x32x16_bf16 v[88:103], v[120:123], v[136:139], v[88:103]
    ds_read_b128 v[120:123], v23 offset:6144
    s_cmp_eq_u32 s75, 0
    s_cbranch_scc1 sk_14
    s_add_u32 s96, s25, 0
    s_and_b32 s96, s96, 15
    s_lshl_b32 s96, s96, 17
    s_add_u32 m0, s101, 0
    s_nop 0
    buffer_load_dwordx4 v243, s[8:11], s96 offen lds
sk_14:
    v_exp_f32 v66, v66
    v_exp_f32 v67, v67
    v_exp_f32 v68, v68
    v_exp_f32_e64 v69, v69
    v_mfma_f32_16x16x32_bf16 v[44:47], v[40:43], v[136:139], v[44:47]
    v_exp_f32 v70, v70
    v_exp_f32 v71, v71
    v_cvt_pk_bf16_f32 v140, v64, v65
    v_cvt_pk_bf16_f32 v141, v66, v67
    v_cvt_pk_bf16_f32 v142, v68, v69
    v_cvt_pk_bf16_f32 v143, v70, v71
    v_and_b32 v140, v140, v16
    v_and_b32 v141, v141, v17
    v_and_b32_e64 v142, v142, v18
    v_and_b32 v143, v143, v19
    s_cmp_eq_u32 s75, 0
    s_cbranch_scc1 sk_15
    s_waitcnt vmcnt(1)
    s_barrier
    s_add_u32 s96, s25, 12
    s_and_b32 s96, s96, 15
    s_lshl_b32 s96, s96, 17
    s_add_u32 m0, s101, 49152
    s_nop 0
    buffer_load_dwordx4 v243, s[8:11], s96 offen lds
sk_15:
    s_cmp_eq_u32 s74, 1
    s_cbranch_scc1 a0_6_e0
    s_cmp_eq_u32 s74, 2
    s_cbranch_scc1 a0_6_t1
    s_waitcnt lgkmcnt(3)
    v_mfma_f32_32x32x16_bf16 v[56:71], v[104:107], v[4:7], v[24:39]
    ds_read_b128 v[104:107], v23 offset:12288
    v_exp_f32 v72, v72
    v_exp_f32 v73, v73
    v_exp_f32_e64 v74, v74
    v_mfma_f32_32x32x16_bf16 v[88:103], v[124:127], v[140:143], v[88:103]
    ds_read_b128 v[124:127], v23 offset:11264
    v_exp_f32 v75, v75
    v_exp_f32 v76, v76
    v_exp_f32 v77, v77
    s_waitcnt lgkmcnt(2)
    v_mfma_f32_32x32x16_bf16 v[56:71], v[108:111], v[8:11], v[56:71]
    ds_read_b128 v[108:111], v23 offset:13312
    v_exp_f32 v78, v78
    v_exp_f32 v79, v79
    v_cvt_pk_bf16_f32 v136, v72, v73
    v_cvt_pk_bf16_f32 v137, v74, v75
    v_mfma_f32_16x16x32_bf16 v[44:47], v[40:43], v[140:143], v[44:47]
    v_cvt_pk_bf16_f32 v138, v76, v77
    v_cvt_pk_bf16_f32 v139, v78, v79
    v_exp_f32 v80, v80
    v_exp_f32 v81, v81
    v_mfma_f32_32x32x16_bf16 v[88:103], v[120:123], v[136:139], v[88:103]
    ds_read_b128 v[120:123], v23 offset:10240
    s_cmp_eq_u32 s75, 0
    s_cbranch_scc1 sk_16
    s_add_u32 s96, s25, 13
    s_and_b32 s96, s96, 15
    s_lshl_b32 s96, s96, 17
    s_add_u32 m0, s101, 53248
    s_nop 0
    buffer_load_dwordx4 v243, s[8:11], s96 offen lds
sk_16:
    v_exp_f32 v82, v82
    v_exp_f32 v83, v83
    v_exp_f32 v84, v84
    v_exp_f32 v85, v85
    v_mfma_f32_16x16x32_bf16 v[44:47], v[40:43], v[136:139], v[44:47]
    v_exp_f32 v86, v86
    v_exp_f32 v87, v87
    v_cvt_pk_bf16_f32 v140, v80, v81
    v_cvt_pk_bf16_f32 v141, v82, v83
    v_cvt_pk_bf16_f32 v142, v84, v85
    v_cvt_pk_bf16_f32 v143, v86, v87
    s_cmp_eq_u32 s75, 0
    s_cbranch_scc1 sk_17
    s_add_u32 s96, s25, 14
    s_and_b32 s96, s96, 15
    s_lshl_b32 s96, s96, 17
    s_add_u32 m0, s101, 57344
    s_nop 0
    buffer_load_dwordx4 v243, s[8:11], s96 offen lds
sk_17:
    s_cmp_eq_u32 s74, 3
    s_cbranch_scc1 a0_6_t0
    s_waitcnt lgkmcnt(3)
    v_mfma_f32_32x32x16_bf16 v[72:87], v[104:107], v[4:7], v[24:39]
    ds_read_b128 v[104:107], v23 offset:16384
    v_exp_f32 v56, v56
    v_exp_f32 v57, v57
    v_exp_f32 v58, v58
    v_mfma_f32_32x32x16_bf16 v[88:103], v[128:131], v[140:143], v[88:103]
    ds_read_b128 v[128:131], v23 offset:15360
    v_exp_f32 v59, v59
    v_exp_f32 v60, v60
    v_exp_f32 v61, v61
    s_waitcnt lgkmcnt(2)
    v_mfma_f32_32x32x16_bf16 v[72:87], v[108:111], v[8:11], v[72:87]
    ds_read_b128 v[108:111], v23 offset:17408
    v_exp_f32 v62, v62
    v_exp_f32 v63, v63
    v_cvt_pk_bf16_f32 v136, v56, v57
    v_cvt_pk_bf16_f32 v137, v58, v59
    v_mfma_f32_16x16x32_bf16 v[44:47], v[40:43], v[140:143], v[44:47]
    v_cvt_pk_bf16_f32 v138, v60, v61
    v_cvt_pk_bf16_f32 v139, v62, v63
    v_exp_f32 v64, v64
    v_exp_f32 v65, v65
    v_mfma_f32_32x32x16_bf16 v[88:103], v[120:123], v[136:139], v[88:103]
    ds_read_b128 v[120:123], v23 offset:14336
    s_cmp_eq_u32 s75, 0
    s_cbranch_scc1 sk_18
    s_add_u32 s96, s25, 15
    s_and_b32 s96, s96, 15
    s_lshl_b32 s96, s96, 17
    s_add_u32 m0, s101, 61440
    s_nop 0
    buffer_load_dwordx4 v243, s[8:11], s96 offen lds
sk_18:
    v_exp_f32 v66, v66
    v_exp_f32 v67, v67
    v_exp_f32 v68, v68
    v_exp_f32 v69, v69
    v_mfma_f32_16x16x32_bf16 v[44:47], v[40:43], v[136:139], v[44:47]
    v_exp_f32 v70, v70
    v_exp_f32 v71, v71
    v_cvt_pk_bf16_f32 v140, v64, v65
    v_cvt_pk_bf16_f32 v141, v66, v67
    v_cvt_pk_bf16_f32 v142, v68, v69
    v_cvt_pk_bf16_f32 v143, v70, v71
    s_cmp_eq_u32 s74, 4
    s_cbranch_scc1 a0_6_t1
    s_waitcnt lgkmcnt(3)
    v_mfma_f32_32x32x16_bf16 v[56:71], v[104:107], v[4:7], v[24:39]
    ds_read_b128 v[104:107], v23 offset:20480
    v_exp_f32 v72, v72
    v_exp_f32 v73, v73
    v_exp_f32 v74, v74
    v_mfma_f32_32x32x16_bf16 v[88:103], v[124:127], v[140:143], v[88:103]
    ds_read_b128 v[124:127], v23 offset:19456
    v_exp_f32 v75, v75
    v_exp_f32 v76, v76
    v_exp_f32 v77, v77
    s_waitcnt lgkmcnt(2)
    v_mfma_f32_32x32x16_bf16 v[56:71], v[108:111], v[8:11], v[56:71]
    ds_read_b128 v[108:111], v23 offset:21504
    v_exp_f32 v78, v78
    v_exp_f32 v79, v79
    v_cvt_pk_bf16_f32 v136, v72, v73
    v_cvt_pk_bf16_f32 v137, v74, v75
    v_mfma_f32_16x16x32_bf16 v[44:47], v[40:43], v[140:143], v[44:47]
    v_cvt_pk_bf16_f32 v138, v76, v77
    v_cvt_pk_bf16_f32 v139, v78, v79
    v_exp_f32 v80, v80
    v_exp_f32 v81, v81
    v_mfma_f32_32x32x16_bf16 v[88:103], v[120:123], v[136:139], v[88:103]
    ds_read_b128 v[120:123], v23 offset:18432
    v_exp_f32 v82, v82
    v_exp_f32 v83, v83
    v_exp_f32 v84, v84
    v_exp_f32 v85, v85
    v_mfma_f32_16x16x32_bf16 v[44:47], v[40:43], v[136:139], v[44:47]
    v_exp_f32 v86, v86
    v_exp_f32 v87, v87
    v_cvt_pk_bf16_f32 v140, v80, v81
    v_cvt_pk_bf16_f32 v141, v82, v83
    v_cvt_pk_bf16_f32 v142, v84, v85
    v_cvt_pk_bf16_f32 v143, v86, v87
    s_cmp_eq_u32 s74, 5
    s_cbranch_scc1 a0_6_t0
    s_waitcnt lgkmcnt(3)
    v_mfma_f32_32x32x16_bf16 v[72:87], v[104:107], v[4:7], v[24:39]
    ds_read_b128 v[104:107], v23 offset:24576
    v_exp_f32 v56, v56
    v_exp_f32 v57, v57
    v_exp_f32 v58, v58
    v_mfma_f32_32x32x16_bf16 v[88:103], v[128:131], v[140:143], v[88:103]
    ds_read_b128 v[128:131], v23 offset:23552
    v_exp_f32 v59, v59
    v_exp_f32 v60, v60
    v_exp_f32 v61, v61
    s_waitcnt lgkmcnt(2)
    v_mfma_f32_32x32x16_bf16 v[72:87], v[108:111], v[8:11], v[72:87]
    ds_read_b128 v[108:111], v23 offset:25600
    v_exp_f32 v62, v62
    v_exp_f32 v63, v63
    v_cvt_pk_bf16_f32 v136, v56, v57
    v_cvt_pk_bf16_f32 v137, v58, v59
    v_mfma_f32_16x16x32_bf16 v[44:47], v[40:43], v[140:143], v[44:47]
    v_cvt_pk_bf16_f32 v138, v60, v61
    v_cvt_pk_bf16_f32 v139, v62, v63
    v_exp_f32 v64, v64
    v_exp_f32 v65, v65
    v_mfma_f32_32x32x16_bf16 v[88:103], v[120:123], v[136:139], v[88:103]
    ds_read_b128 v[120:123], v23 offset:22528
    v_exp_f32 v66, v66
    v_exp_f32 v67, v67
    v_exp_f32 v68, v68
    v_exp_f32 v69, v69
    v_mfma_f32_16x16x32_bf16 v[44:47], v[40:43], v[136:139], v[44:47]
    v_exp_f32 v70, v70
    v_exp_f32 v71, v71
    v_cvt_pk_bf16_f32 v140, v64, v65
    v_cvt_pk_bf16_f32 v141, v66, v67
    v_cvt_pk_bf16_f32 v142, v68, v69
    v_cvt_pk_bf16_f32 v143, v70, v71
    s_cmp_eq_u32 s74, 6
    s_cbranch_scc1 a0_6_t1
    s_waitcnt lgkmcnt(3)
    v_mfma_f32_32x32x16_bf16 v[56:71], v[104:107], v[4:7], v[24:39]
    ds_read_b128 v[104:107], v23 offset:28672
    v_exp_f32 v72, v72
    v_exp_f32 v73, v73
    v_exp_f32 v74, v74
    v_mfma_f32_32x32x16_bf16 v[88:103], v[124:127], v[140:143], v[88:103]
    ds_read_b128 v[124:127], v23 offset:27648
    v_exp_f32 v75, v75
    v_exp_f32 v76, v76
    v_exp_f32 v77, v77
    s_waitcnt lgkmcnt(2)
    v_mfma_f32_32x32x16_bf16 v[56:71], v[108:111], v[8:11], v[56:71]
    ds_read_b128 v[108:111], v23 offset:29696
    v_exp_f32 v78, v78
    v_exp_f32 v79, v79
    v_cvt_pk_bf16_f32 v136, v72, v73
    v_cvt_pk_bf16_f32 v137, v74, v75
    v_mfma_f32_16x16x32_bf16 v[44:47], v[40:43], v[140:143], v[44:47]
    v_cvt_pk_bf16_f32 v138, v76, v77
    v_cvt_pk_bf16_f32 v139, v78, v79
    v_exp_f32 v80, v80
    v_exp_f32 v81, v81
    v_mfma_f32_32x32x16_bf16 v[88:103], v[120:123], v[136:139], v[88:103]
    ds_read_b128 v[120:123], v23 offset:26624
    v_exp_f32 v82, v82
    v_exp_f32 v83, v83
    v_exp_f32 v84, v84
    v_exp_f32 v85, v85
    v_mfma_f32_16x16x32_bf16 v[44:47], v[40:43], v[136:139], v[44:47]
    v_exp_f32 v86, v86
    v_exp_f32 v87, v87
    v_cvt_pk_bf16_f32 v140, v80, v81
    v_cvt_pk_bf16_f32 v141, v82, v83
    v_cvt_pk_bf16_f32 v142, v84, v85
    v_cvt_pk_bf16_f32 v143, v86, v87
    s_cmp_eq_u32 s74, 7
    s_cbranch_scc1 a0_6_t0
    s_waitcnt lgkmcnt(3)
    v_mfma_f32_32x32x16_bf16 v[72:87], v[104:107], v[4:7], v[24:39]
    ds_read_b128 v[104:107], v23 offset:24576
    v_exp_f32 v56, v56
    v_exp_f32 v57, v57
    v_exp_f32 v58, v58
    v_mfma_f32_32x32x16_bf16 v[88:103], v[128:131], v[140:143], v[88:103]
    ds_read_b128 v[128:131], v23 offset:31744
    v_exp_f32 v59, v59
    v_exp_f32 v60, v60
    v_exp_f32 v61, v61
    s_waitcnt lgkmcnt(2)
    v_mfma_f32_32x32x16_bf16 v[72:87], v[108:111], v[8:11], v[72:87]
    ds_read_b128 v[108:111], v23 offset:25600
    v_exp_f32 v62, v62
    v_exp_f32 v63, v63
    v_cvt_pk_bf16_f32 v136, v56, v57
    v_cvt_pk_bf16_f32 v137, v58, v59
    v_mfma_f32_16x16x32_bf16 v[44:47], v[40:43], v[140:143], v[44:47]
    v_cvt_pk_bf16_f32 v138, v60, v61
    v_cvt_pk_bf16_f32 v139, v62, v63
    v_exp_f32 v64, v64
    v_exp_f32 v65, v65
    v_mfma_f32_32x32x16_bf16 v[88:103], v[120:123], v[136:139], v[88:103]
    ds_read_b128 v[120:123], v23 offset:30720
    v_exp_f32 v66, v66
    v_exp_f32 v67, v67
    v_exp_f32 v68, v68
    v_exp_f32 v69, v69
    v_mfma_f32_16x16x32_bf16 v[44:47], v[40:43], v[136:139], v[44:47]
    v_exp_f32 v70, v70
    v_exp_f32 v71, v71
    v_cvt_pk_bf16_f32 v140, v64, v65
    v_cvt_pk_bf16_f32 v141, v66, v67
    v_cvt_pk_bf16_f32 v142, v68, v69
    v_cvt_pk_bf16_f32 v143, v70, v71
a0_6_t1:
    v_exp_f32 v72, v72
    v_exp_f32 v73, v73
    v_exp_f32_e64 v74, v74
    v_mfma_f32_32x32x16_bf16 v[88:103], v[124:127], v[140:143], v[88:103]
    v_exp_f32 v75, v75
    v_exp_f32 v76, v76
    v_exp_f32 v77, v77
    v_exp_f32 v78, v78
    v_exp_f32_e64 v79, v79
    v_cvt_pk_bf16_f32 v136, v72, v73
    v_cvt_pk_bf16_f32 v137, v74, v75
    v_mfma_f32_16x16x32_bf16 v[44:47], v[40:43], v[140:143], v[44:47]
    v_cvt_pk_bf16_f32 v138, v76, v77
    v_cvt_pk_bf16_f32 v139, v78, v79
    v_exp_f32_e64 v80, v80
    v_exp_f32 v81, v81
    s_waitcnt lgkmcnt(0)
    v_mfma_f32_32x32x16_bf16 v[88:103], v[120:123], v[136:139], v[88:103]
    v_exp_f32 v82, v82
    v_exp_f32 v83, v83
    v_exp_f32 v84, v84
    v_exp_f32 v85, v85
    v_mfma_f32_16x16x32_bf16 v[44:47], v[40:43], v[136:139], v[44:47]
    v_exp_f32 v86, v86
    v_exp_f32 v87, v87
    v_cvt_pk_bf16_f32 v140, v80, v81
    v_cvt_pk_bf16_f32 v141, v82, v83
    v_cvt_pk_bf16_f32 v142, v84, v85
    v_cvt_pk_bf16_f32 v143, v86, v87
a0_6_e1:
    s_cmp_eq_u32 s75, 0
    s_nop 0
    v_mfma_f32_16x16x32_bf16 v[44:47], v[40:43], v[140:143], v[44:47]
    v_mfma_f32_32x32x16_bf16 v[88:103], v[128:131], v[140:143], v[88:103]
    s_cbranch_scc1 a0_6_mid
    s_branch a0_6_fin
    s_nop 0
a0_6_t0:
    v_exp_f32 v56, v56
    v_exp_f32 v57, v57
    v_exp_f32 v58, v58
    v_mfma_f32_32x32x16_bf16 v[88:103], v[128:131], v[140:143], v[88:103]
    v_exp_f32 v59, v59
    v_exp_f32 v60, v60
    v_exp_f32 v61, v61
    v_exp_f32 v62, v62
    v_exp_f32_e64 v63, v63
    v_cvt_pk_bf16_f32 v136, v56, v57
    v_cvt_pk_bf16_f32 v137, v58, v59
    v_mfma_f32_16x16x32_bf16 v[44:47], v[40:43], v[140:143], v[44:47]
    v_cvt_pk_bf16_f32 v138, v60, v61
    v_cvt_pk_bf16_f32 v139, v62, v63
    v_exp_f32_e64 v64, v64
    v_exp_f32 v65, v65
    s_waitcnt lgkmcnt(0)
    v_mfma_f32_32x32x16_bf16 v[88:103], v[120:123], v[136:139], v[88:103]
    v_exp_f32 v66, v66
    v_exp_f32 v67, v67
    v_exp_f32 v68, v68
    v_exp_f32 v69, v69
    v_mfma_f32_16x16x32_bf16 v[44:47], v[40:43], v[136:139], v[44:47]
    v_exp_f32 v70, v70
    v_exp_f32 v71, v71
    v_cvt_pk_bf16_f32 v140, v64, v65
    v_cvt_pk_bf16_f32 v141, v66, v67
    v_cvt_pk_bf16_f32 v142, v68, v69
    v_cvt_pk_bf16_f32 v143, v70, v71
a0_6_e0:
    s_cmp_eq_u32 s75, 0
    s_nop 0
    v_mfma_f32_16x16x32_bf16 v[44:47], v[40:43], v[140:143], v[44:47]
    v_mfma_f32_32x32x16_bf16 v[88:103], v[124:127], v[140:143], v[88:103]
    s_cbranch_scc1 a0_6_mid
    s_branch a0_6_fin
    s_nop 0
a0_6_none:
    s_add_u32 s96, s25, 0
    s_and_b32 s96, s96, 15
    s_lshl_b32 s96, s96, 17
    s_add_u32 m0, s101, 0
    s_nop 0
    buffer_load_dwordx4 v243, s[8:11], s96 offen lds
    s_waitcnt vmcnt(1)
    s_barrier
    s_add_u32 s96, s25, 12
    s_and_b32 s96, s96, 15
    s_lshl_b32 s96, s96, 17
    s_add_u32 m0, s101, 49152
    s_nop 0
    buffer_load_dwordx4 v243, s[8:11], s96 offen lds
    s_add_u32 s96, s25, 13
    s_and_b32 s96, s96, 15
    s_lshl_b32 s96, s96, 17
    s_add_u32 m0, s101, 53248
    s_nop 0
    buffer_load_dwordx4 v243, s[8:11], s96 offen lds
    s_add_u32 s96, s25, 14
    s_and_b32 s96, s96, 15
    s_lshl_b32 s96, s96, 17
    s_add_u32 m0, s101, 57344
    s_nop 0
    buffer_load_dwordx4 v243, s[8:11], s96 offen lds
    s_add_u32 s96, s25, 15
    s_and_b32 s96, s96, 15
    s_lshl_b32 s96, s96, 17
    s_add_u32 m0, s101, 61440
    s_nop 0
    buffer_load_dwordx4 v243, s[8:11], s96 offen lds
a0_6_fin:
    s_lshl_b32 s36, s76, 17
    s_lshr_b32 s33, s26, 8
    s_add_u32 s36, s36, s33
    s_add_u32 s36, s36, 0x2800000
    s_lshl_b32 s33, s25, 11
    s_add_u32 s33, s33, s36
    s_lshl_b32 s30, s24, 9
    s_and_b32 s31, s76, 3
    s_lshl_b32 s31, s31, 6
    s_add_u32 s30, s30, s31
    s_add_u32 s30, s30, s26
    s_add_u32 s30, s30, 0xdd2000
    s_lshl_b32 s31, s25, 2
    s_add_u32 s31, s31, s30
    v_cmp_ngt_f32 vcc, 0x5d800000, v44
    v_rcp_f32_e64 v22, v44
    s_cbranch_vccnz att_exact0
att_ret0:
    s_nop 3
    v_pk_mul_f32 v[88:89], v[88:89], v[22:23] op_sel_hi:[1,0]
    v_pk_mul_f32 v[90:91], v[90:91], v[22:23] op_sel_hi:[1,0]
    v_pk_mul_f32 v[92:93], v[92:93], v[22:23] op_sel_hi:[1,0]
    v_pk_mul_f32 v[94:95], v[94:95], v[22:23] op_sel_hi:[1,0]
    v_pk_mul_f32 v[96:97], v[96:97], v[22:23] op_sel_hi:[1,0]
    v_pk_mul_f32 v[98:99], v[98:99], v[22:23] op_sel_hi:[1,0]
    v_pk_mul_f32 v[100:101], v[100:101], v[22:23] op_sel_hi:[1,0]
    v_pk_mul_f32 v[102:103], v[102:103], v[22:23] op_sel_hi:[1,0]
    v_cvt_pk_bf16_f32 v88, v88, v89
    v_cvt_pk_bf16_f32 v89, v90, v91
    v_cvt_pk_bf16_f32 v90, v92, v93
    v_cvt_pk_bf16_f32 v91, v94, v95
    v_cvt_pk_bf16_f32 v92, v96, v97
    v_cvt_pk_bf16_f32 v93, v98, v99
    v_cvt_pk_bf16_f32 v94, v100, v101
    v_cvt_pk_bf16_f32 v95, v102, v103
    s_cmp_gt_u32 s77, s26
    s_cbranch_scc1 lc_19
    buffer_store_dwordx4 v[88:91], v253, s[20:23], s33 offen sc1
    buffer_store_dwordx4 v[92:95], v253, s[20:23], s33 offen offset:1024 sc1
    s_branch lc_20
    s_nop 0
lc_19:
    buffer_store_dwordx4 v[88:91], v253, s[20:23], s33 offen
    buffer_store_dwordx4 v[92:95], v253, s[20:23], s33 offen offset:1024
lc_20:
    v_bfe_u32 v33, v252, 2, 2
    v_lshrrev_b32_e64 v32, 5, v252
    v_lshl_add_u32 v34, v32, 3, v33
    v_lshlrev_b32 v34, 7, v34
    v_lshrrev_b32 v33, 1, v33
    v_lshl_add_u32 v34, v33, 6, v34
    v_bfe_u32 v33, v252, 4, 1
    v_lshl_add_u32 v34, v33, 5, v34
    v_and_b32_e64 v33, 3, v252
    v_lshl_add_u32 v56, v33, 3, v34
    v_xor_b32_e64 v57, 64, v56
    v_add_u32 v58, 0x10000, v56
    v_add_u32 v59, 0x10000, v57
    v_and_b32 v60, 15, v252
    v_lshlrev_b32 v60, 2, v60
    s_waitcnt vmcnt(2)
    s_and_b32 s35, s99, 3
    s_cmp_lg_u32 s35, 0
    s_cbranch_scc1 sk_21
    s_barrier
sk_21:
    v_lshlrev_b32 v0, 16, v208
    v_and_b32 v1, 0xffff0000, v208
    v_lshlrev_b32_e64 v2, 16, v209
    v_and_b32 v3, 0xffff0000, v209
    v_lshlrev_b32_e64 v4, 16, v210
    v_and_b32 v5, 0xffff0000, v210
    v_lshlrev_b32_e64 v6, 16, v211
    v_and_b32 v7, 0xffff0000, v211
    v_lshlrev_b32_e64 v8, 16, v212
    v_and_b32 v9, 0xffff0000, v212
    v_lshlrev_b32_e64 v10, 16, v213
    v_and_b32 v11, 0xffff0000, v213
    v_lshlrev_b32_e64 v12, 16, v214
    v_and_b32 v13, 0xffff0000, v214
    v_lshlrev_b32_e64 v14, 16, v215
    v_and_b32 v15, 0xffff0000, v215
    v_lshlrev_b32_e64 v16, 16, v216
    v_and_b32 v17, 0xffff0000, v216
    v_lshlrev_b32_e64 v18, 16, v217
    v_and_b32 v19, 0xffff0000, v217
    v_lshlrev_b32_e64 v20, 16, v218
    v_and_b32 v21, 0xffff0000, v218
    v_lshlrev_b32_e64 v22, 16, v219
    v_and_b32 v23, 0xffff0000, v219
    v_lshlrev_b32_e64 v24, 16, v220
    v_and_b32 v25, 0xffff0000, v220
    v_lshlrev_b32_e64 v26, 16, v221
    v_and_b32 v27, 0xffff0000, v221
    v_lshlrev_b32_e64 v28, 16, v222
    v_and_b32 v29, 0xffff0000, v222
    v_lshlrev_b32_e64 v30, 16, v223
    v_and_b32 v31, 0xffff0000, v223
    v_pk_fma_f32 v[0:1], v[0:1], v[240:241], v[240:241] op_sel:[0,0,1] op_sel_hi:[1,0,1]
    v_pk_fma_f32 v[2:3], v[2:3], v[240:241], v[240:241] op_sel:[0,0,1] op_sel_hi:[1,0,1]
    v_pk_fma_f32 v[4:5], v[4:5], v[240:241], v[240:241] op_sel:[0,0,1] op_sel_hi:[1,0,1]
    v_pk_fma_f32 v[6:7], v[6:7], v[240:241], v[240:241] op_sel:[0,0,1] op_sel_hi:[1,0,1]
    v_pk_fma_f32 v[8:9], v[8:9], v[240:241], v[240:241] op_sel:[0,0,1] op_sel_hi:[1,0,1]
    v_pk_fma_f32 v[10:11], v[10:11], v[240:241], v[240:241] op_sel:[0,0,1] op_sel_hi:[1,0,1]
    v_pk_fma_f32 v[12:13], v[12:13], v[240:241], v[240:241] op_sel:[0,0,1] op_sel_hi:[1,0,1]
    v_pk_fma_f32 v[14:15], v[14:15], v[240:241], v[240:241] op_sel:[0,0,1] op_sel_hi:[1,0,1]
    v_pk_fma_f32 v[16:17], v[16:17], v[240:241], v[240:241] op_sel:[0,0,1] op_sel_hi:[1,0,1]
    v_pk_fma_f32 v[18:19], v[18:19], v[240:241], v[240:241] op_sel:[0,0,1] op_sel_hi:[1,0,1]
    v_pk_fma_f32 v[20:21], v[20:21], v[240:241], v[240:241] op_sel:[0,0,1] op_sel_hi:[1,0,1]
    v_pk_fma_f32 v[22:23], v[22:23], v[240:241], v[240:241] op_sel:[0,0,1] op_sel_hi:[1,0,1]
    v_pk_fma_f32 v[24:25], v[24:25], v[240:241], v[240:241] op_sel:[0,0,1] op_sel_hi:[1,0,1]
    v_pk_fma_f32 v[26:27], v[26:27], v[240:241], v[240:241] op_sel:[0,0,1] op_sel_hi:[1,0,1]
    v_pk_fma_f32 v[28:29], v[28:29], v[240:241], v[240:241] op_sel:[0,0,1] op_sel_hi:[1,0,1]
    v_pk_fma_f32 v[30:31], v[30:31], v[240:241], v[240:241] op_sel:[0,0,1] op_sel_hi:[1,0,1]
    v_mov_b32_e64 v154, s88
    s_mov_b64 exec, 1
    s_waitcnt vmcnt(0)
    s_cmp_lg_u32 s77, 0
    s_cbranch_scc1 lc_22
    buffer_store_dword v154, v253, s[20:23], s31 offen sc1
    s_branch lc_23
lc_22:
    buffer_store_dword v154, v253, s[20:23], s31 offen
lc_23:
    s_mov_b64 exec, -1
    s_cmp_eq_u32 s35, 0
    s_cbranch_scc1 sk_24
    s_barrier
sk_24:
    s_add_u32 s96, s25, 0
    s_and_b32 s96, s96, 15
    s_lshl_b32 s96, s96, 17
    s_add_u32 s96, s96, 65536
    s_add_u32 m0, s101, 65536
    s_nop 0
    buffer_load_dwordx4 v243, s[8:11], s96 offen lds
    s_add_u32 s96, s25, 1
    s_and_b32 s96, s96, 15
    s_lshl_b32 s96, s96, 17
    s_add_u32 s96, s96, 65536
    s_add_u32 m0, s101, 69632
    s_nop 0
    buffer_load_dwordx4 v243, s[8:11], s96 offen lds
    s_add_u32 s96, s25, 2
    s_and_b32 s96, s96, 15
    s_lshl_b32 s96, s96, 17
    s_add_u32 s96, s96, 65536
    s_add_u32 m0, s101, 73728
    s_nop 0
    buffer_load_dwordx4 v243, s[8:11], s96 offen lds
    s_add_u32 s96, s25, 3
    s_and_b32 s96, s96, 15
    s_lshl_b32 s96, s96, 17
    s_add_u32 s96, s96, 65536
    s_add_u32 m0, s101, 77824
    s_nop 0
    buffer_load_dwordx4 v243, s[8:11], s96 offen lds
    s_add_u32 s96, s25, 4
    s_and_b32 s96, s96, 15
    s_lshl_b32 s96, s96, 17
    s_add_u32 s96, s96, 65536
    s_add_u32 m0, s101, 81920
    s_nop 0
    buffer_load_dwordx4 v243, s[8:11], s96 offen lds
    s_add_u32 s96, s25, 5
    s_and_b32 s96, s96, 15
    s_lshl_b32 s96, s96, 17
    s_add_u32 s96, s96, 65536
    s_add_u32 m0, s101, 86016
    s_nop 0
    buffer_load_dwordx4 v243, s[8:11], s96 offen lds
    s_add_u32 s96, s25, 6
    s_and_b32 s96, s96, 15
    s_lshl_b32 s96, s96, 17
    s_add_u32 s96, s96, 65536
    s_add_u32 m0, s101, 90112
    s_nop 0
    buffer_load_dwordx4 v243, s[8:11], s96 offen lds
    s_add_u32 s96, s25, 7
    s_and_b32 s96, s96, 15
    s_lshl_b32 s96, s96, 17
    s_add_u32 s96, s96, 65536
    s_add_u32 m0, s101, 94208
    s_nop 0
    buffer_load_dwordx4 v243, s[8:11], s96 offen lds
    s_add_u32 s96, s25, 8
    s_and_b32 s96, s96, 15
    s_lshl_b32 s96, s96, 17
    s_add_u32 s96, s96, 65536
    s_add_u32 m0, s101, 98304
    s_nop 0
    buffer_load_dwordx4 v243, s[8:11], s96 offen lds
    s_add_u32 s96, s25, 9
    s_and_b32 s96, s96, 15
    s_lshl_b32 s96, s96, 17
    s_add_u32 s96, s96, 65536
    s_add_u32 m0, s101, 102400
    s_nop 0
    buffer_load_dwordx4 v243, s[8:11], s96 offen lds
    s_add_u32 s96, s25, 10
    s_and_b32 s96, s96, 15
    s_lshl_b32 s96, s96, 17
    s_add_u32 s96, s96, 65536
    s_add_u32 m0, s101, 106496
    s_nop 0
    buffer_load_dwordx4 v243, s[8:11], s96 offen lds
    s_add_u32 s96, s25, 11
    s_and_b32 s96, s96, 15
    s_lshl_b32 s96, s96, 17
    s_add_u32 s96, s96, 65536
    s_add_u32 m0, s101, 110592
    s_nop 0
    buffer_load_dwordx4 v243, s[8:11], s96 offen lds
    v_bfe_u32 v100, v252, 4, 1
    v_lshlrev_b32 v100, 11, v100
    v_lshrrev_b32_e64 v101, 5, v252
    v_lshl_add_u32 v100, v101, 8, v100
    v_and_b32 v101, 15, v252
    v_lshl_add_u32 v100, v101, 4, v100
    s_lshl_b32 s34, s28, 12
    s_add_u32 s34, s34, 147456
    v_add_u32 v101, s34, v100
    s_lshl_b32 s37, s25, 11
    ds_read_b64_tr_b16 v[32:33], v56 offset:0
    ds_read_b64_tr_b16 v[34:35], v56 offset:512
    ds_read_b64_tr_b16 v[36:37], v57 offset:0
    ds_read_b64_tr_b16 v[38:39], v57 offset:512
    ds_read_b64_tr_b16 v[40:41], v56 offset:2048
    ds_read_b64_tr_b16 v[42:43], v56 offset:2560
    ds_read_b64_tr_b16 v[44:45], v57 offset:2048
    ds_read_b64_tr_b16 v[46:47], v57 offset:2560
    s_mov_b32 s78, s27
pl_25:
    buffer_load_dword v61, v60, s[20:23], s30 offen offset:0 sc1
    s_waitcnt vmcnt(0)
pc_26:
    v_cmp_ne_u32_e64 vcc, s88, v61
    s_cbranch_vccz pd_27
    s_sub_u32 s78, s78, 1
    s_cmp_lg_u32 s78, 0
    s_cbranch_scc1 pl_25
    s_mov_b32 s27, 1
pd_27:
    s_add_u32 s38, s36, s37
    buffer_load_dwordx4 v[104:107], v253, s[20:23], s38 offen offset:0 sc1
    s_add_u32 s37, s37, 2048
    s_and_b32 s37, s37, 0x7800
    buffer_load_dwordx4 v[108:111], v253, s[20:23], s38 offen offset:1024 sc1
    s_add_u32 s38, s36, s37
    buffer_load_dwordx4 v[112:115], v253, s[20:23], s38 offen offset:0 sc1
    s_add_u32 s37, s37, 2048
    s_and_b32 s37, s37, 0x7800
    buffer_load_dwordx4 v[116:119], v253, s[20:23], s38 offen offset:1024 sc1
    s_add_u32 s38, s36, s37
    buffer_load_dwordx4 v[120:123], v253, s[20:23], s38 offen offset:0 sc1
    s_add_u32 s37, s37, 2048
    s_and_b32 s37, s37, 0x7800
    buffer_load_dwordx4 v[124:127], v253, s[20:23], s38 offen offset:1024 sc1
    s_add_u32 s38, s36, s37
    buffer_load_dwordx4 v[128:131], v253, s[20:23], s38 offen offset:0 sc1
    s_add_u32 s37, s37, 2048
    s_and_b32 s37, s37, 0x7800
    buffer_load_dwordx4 v[132:135], v253, s[20:23], s38 offen offset:1024 sc1
    s_waitcnt vmcnt(7) lgkmcnt(4)
    v_mfma_f32_32x32x16_bf16 v[0:15], v[32:35], v[104:107], v[0:15]
    s_add_u32 s38, s36, s37
    buffer_load_dwordx4 v[136:139], v253, s[20:23], s38 offen offset:0 sc1
    ds_read_b64_tr_b16 v[48:49], v56 offset:4096
    ds_read_b64_tr_b16 v[50:51], v56 offset:4608
    v_mfma_f32_32x32x16_bf16 v[16:31], v[36:39], v[104:107], v[16:31]
    ds_read_b64_tr_b16 v[52:53], v57 offset:4096
    ds_read_b64_tr_b16 v[54:55], v57 offset:4608
    s_waitcnt vmcnt(7) lgkmcnt(4)
    v_mfma_f32_32x32x16_bf16 v[0:15], v[40:43], v[108:111], v[0:15]
    s_add_u32 s37, s37, 2048
    s_and_b32 s37, s37, 0x7800
    buffer_load_dwordx4 v[104:107], v253, s[20:23], s38 offen offset:1024 sc1
    ds_read_b64_tr_b16 v[32:33], v56 offset:6144
    ds_read_b64_tr_b16 v[34:35], v56 offset:6656
    v_mfma_f32_32x32x16_bf16 v[16:31], v[44:47], v[108:111], v[16:31]
    ds_read_b64_tr_b16 v[36:37], v57 offset:6144
    ds_read_b64_tr_b16 v[38:39], v57 offset:6656
    s_waitcnt vmcnt(7) lgkmcnt(4)
    v_mfma_f32_32x32x16_bf16 v[0:15], v[48:51], v[112:115], v[0:15]
    s_add_u32 s38, s36, s37
    buffer_load_dwordx4 v[108:111], v253, s[20:23], s38 offen offset:0 sc1
    ds_read_b64_tr_b16 v[40:41], v56 offset:8192
    ds_read_b64_tr_b16 v[42:43], v56 offset:8704
    v_mfma_f32_32x32x16_bf16 v[16:31], v[52:55], v[112:115], v[16:31]
    ds_read_b64_tr_b16 v[44:45], v57 offset:8192
    ds_read_b64_tr_b16 v[46:47], v57 offset:8704
    s_waitcnt vmcnt(7) lgkmcnt(4)
    v_mfma_f32_32x32x16_bf16 v[0:15], v[32:35], v[116:119], v[0:15]
    s_add_u32 s37, s37, 2048
    s_and_b32 s37, s37, 0x7800
    buffer_load_dwordx4 v[112:115], v253, s[20:23], s38 offen offset:1024 sc1
    ds_read_b64_tr_b16 v[48:49], v56 offset:10240
    ds_read_b64_tr_b16 v[50:51], v56 offset:10752
    v_mfma_f32_32x32x16_bf16 v[16:31], v[36:39], v[116:119], v[16:31]
    ds_read_b64_tr_b16 v[52:53], v57 offset:10240
    ds_read_b64_tr_b16 v[54:55], v57 offset:10752
    s_waitcnt vmcnt(7) lgkmcnt(4)
    v_mfma_f32_32x32x16_bf16 v[0:15], v[40:43], v[120:123], v[0:15]
    s_add_u32 s38, s36, s37
    buffer_load_dwordx4 v[116:119], v253, s[20:23], s38 offen offset:0 sc1
    ds_read_b64_tr_b16 v[32:33], v56 offset:12288
    ds_read_b64_tr_b16 v[34:35], v56 offset:12800
    v_mfma_f32_32x32x16_bf16 v[16:31], v[44:47], v[120:123], v[16:31]
    ds_read_b64_tr_b16 v[36:37], v57 offset:12288
    ds_read_b64_tr_b16 v[38:39], v57 offset:12800
    s_waitcnt vmcnt(7) lgkmcnt(4)
    v_mfma_f32_32x32x16_bf16 v[0:15], v[48:51], v[124:127], v[0:15]
    s_add_u32 s37, s37, 2048
    s_and_b32 s37, s37, 0x7800
    buffer_load_dwordx4 v[120:123], v253, s[20:23], s38 offen offset:1024 sc1
    ds_read_b64_tr_b16 v[40:41], v56 offset:14336
    ds_read_b64_tr_b16 v[42:43], v56 offset:14848
    v_mfma_f32_32x32x16_bf16 v[16:31], v[52:55], v[124:127], v[16:31]
    ds_read_b64_tr_b16 v[44:45], v57 offset:14336
    ds_read_b64_tr_b16 v[46:47], v57 offset:14848
    s_waitcnt vmcnt(7) lgkmcnt(4)
    v_mfma_f32_32x32x16_bf16 v[0:15], v[32:35], v[128:131], v[0:15]
    s_add_u32 s38, s36, s37
    buffer_load_dwordx4 v[124:127], v253, s[20:23], s38 offen offset:0 sc1
    ds_read_b64_tr_b16 v[48:49], v56 offset:16384
    ds_read_b64_tr_b16 v[50:51], v56 offset:16896
    v_mfma_f32_32x32x16_bf16 v[16:31], v[36:39], v[128:131], v[16:31]
    ds_read_b64_tr_b16 v[52:53], v57 offset:16384
    ds_read_b64_tr_b16 v[54:55], v57 offset:16896
    s_waitcnt vmcnt(7) lgkmcnt(4)
    v_mfma_f32_32x32x16_bf16 v[0:15], v[40:43], v[132:135], v[0:15]
    s_add_u32 s37, s37, 2048
    s_and_b32 s37, s37, 0x7800
    buffer_load_dwordx4 v[128:131], v253, s[20:23], s38 offen offset:1024 sc1
    ds_read_b64_tr_b16 v[32:33], v56 offset:18432
    ds_read_b64_tr_b16 v[34:35], v56 offset:18944
    v_mfma_f32_32x32x16_bf16 v[16:31], v[44:47], v[132:135], v[16:31]
    ds_read_b64_tr_b16 v[36:37], v57 offset:18432
    ds_read_b64_tr_b16 v[38:39], v57 offset:18944
    s_waitcnt vmcnt(7) lgkmcnt(4)
    v_mfma_f32_32x32x16_bf16 v[0:15], v[48:51], v[136:139], v[0:15]
    s_add_u32 s38, s36, s37
    buffer_load_dwordx4 v[132:135], v253, s[20:23], s38 offen offset:0 sc1
    ds_read_b64_tr_b16 v[40:41], v56 offset:20480
    ds_read_b64_tr_b16 v[42:43], v56 offset:20992
    v_mfma_f32_32x32x16_bf16 v[16:31], v[52:55], v[136:139], v[16:31]
    ds_read_b64_tr_b16 v[44:45], v57 offset:20480
    ds_read_b64_tr_b16 v[46:47], v57 offset:20992
    s_waitcnt vmcnt(7) lgkmcnt(4)
    v_mfma_f32_32x32x16_bf16 v[0:15], v[32:35], v[104:107], v[0:15]
    s_add_u32 s37, s37, 2048
    s_and_b32 s37, s37, 0x7800
    buffer_load_dwordx4 v[136:139], v253, s[20:23], s38 offen offset:1024 sc1
    ds_read_b64_tr_b16 v[48:49], v56 offset:22528
    ds_read_b64_tr_b16 v[50:51], v56 offset:23040
    v_mfma_f32_32x32x16_bf16 v[16:31], v[36:39], v[104:107], v[16:31]
    ds_read_b64_tr_b16 v[52:53], v57 offset:22528
    ds_read_b64_tr_b16 v[54:55], v57 offset:23040
    s_waitcnt vmcnt(7) lgkmcnt(4)
    v_mfma_f32_32x32x16_bf16 v[0:15], v[40:43], v[108:111], v[0:15]
    s_add_u32 s38, s36, s37
    buffer_load_dwordx4 v[104:107], v253, s[20:23], s38 offen offset:0 sc1
    ds_read_b64_tr_b16 v[32:33], v56 offset:24576
    ds_read_b64_tr_b16 v[34:35], v56 offset:25088
    v_mfma_f32_32x32x16_bf16 v[16:31], v[44:47], v[108:111], v[16:31]
    ds_read_b64_tr_b16 v[36:37], v57 offset:24576
    ds_read_b64_tr_b16 v[38:39], v57 offset:25088
    s_waitcnt vmcnt(7) lgkmcnt(4)
    v_mfma_f32_32x32x16_bf16 v[0:15], v[48:51], v[112:115], v[0:15]
    s_add_u32 s37, s37, 2048
    s_and_b32 s37, s37, 0x7800
    buffer_load_dwordx4 v[108:111], v253, s[20:23], s38 offen offset:1024 sc1
    ds_read_b64_tr_b16 v[40:41], v56 offset:26624
    ds_read_b64_tr_b16 v[42:43], v56 offset:27136
    v_mfma_f32_32x32x16_bf16 v[16:31], v[52:55], v[112:115], v[16:31]
    ds_read_b64_tr_b16 v[44:45], v57 offset:26624
    ds_read_b64_tr_b16 v[46:47], v57 offset:27136
    s_waitcnt vmcnt(7) lgkmcnt(4)
    v_mfma_f32_32x32x16_bf16 v[0:15], v[32:35], v[116:119], v[0:15]
    s_add_u32 s38, s36, s37
    buffer_load_dwordx4 v[112:115], v253, s[20:23], s38 offen offset:0 sc1
    ds_read_b64_tr_b16 v[48:49], v56 offset:28672
    ds_read_b64_tr_b16 v[50:51], v56 offset:29184
    v_mfma_f32_32x32x16_bf16 v[16:31], v[36:39], v[116:119], v[16:31]
    ds_read_b64_tr_b16 v[52:53], v57 offset:28672
    ds_read_b64_tr_b16 v[54:55], v57 offset:29184
    s_waitcnt vmcnt(7) lgkmcnt(4)
    v_mfma_f32_32x32x16_bf16 v[0:15], v[40:43], v[120:123], v[0:15]
    s_add_u32 s37, s37, 2048
    s_and_b32 s37, s37, 0x7800
    buffer_load_dwordx4 v[116:119], v253, s[20:23], s38 offen offset:1024 sc1
    ds_read_b64_tr_b16 v[32:33], v56 offset:30720
    ds_read_b64_tr_b16 v[34:35], v56 offset:31232
    v_mfma_f32_32x32x16_bf16 v[16:31], v[44:47], v[120:123], v[16:31]
    ds_read_b64_tr_b16 v[36:37], v57 offset:30720
    ds_read_b64_tr_b16 v[38:39], v57 offset:31232
    s_waitcnt vmcnt(7) lgkmcnt(4)
    v_mfma_f32_32x32x16_bf16 v[0:15], v[48:51], v[124:127], v[0:15]
    s_add_u32 s38, s36, s37
    buffer_load_dwordx4 v[120:123], v253, s[20:23], s38 offen offset:0 sc1
    ds_read_b64_tr_b16 v[40:41], v56 offset:32768
    ds_read_b64_tr_b16 v[42:43], v56 offset:33280
    v_mfma_f32_32x32x16_bf16 v[16:31], v[52:55], v[124:127], v[16:31]
    ds_read_b64_tr_b16 v[44:45], v57 offset:32768
    ds_read_b64_tr_b16 v[46:47], v57 offset:33280
    s_waitcnt vmcnt(7) lgkmcnt(4)
    v_mfma_f32_32x32x16_bf16 v[0:15], v[32:35], v[128:131], v[0:15]
    s_add_u32 s37, s37, 2048
    s_and_b32 s37, s37, 0x7800
    buffer_load_dwordx4 v[124:127], v253, s[20:23], s38 offen offset:1024 sc1
    ds_read_b64_tr_b16 v[48:49], v56 offset:34816
    ds_read_b64_tr_b16 v[50:51], v56 offset:35328
    v_mfma_f32_32x32x16_bf16 v[16:31], v[36:39], v[128:131], v[16:31]
    ds_read_b64_tr_b16 v[52:53], v57 offset:34816
    ds_read_b64_tr_b16 v[54:55], v57 offset:35328
    s_waitcnt vmcnt(7) lgkmcnt(4)
    v_mfma_f32_32x32x16_bf16 v[0:15], v[40:43], v[132:135], v[0:15]
    s_add_u32 s38, s36, s37
    buffer_load_dwordx4 v[128:131], v253, s[20:23], s38 offen offset:0 sc1
    ds_read_b64_tr_b16 v[32:33], v56 offset:36864
    ds_read_b64_tr_b16 v[34:35], v56 offset:37376
    v_mfma_f32_32x32x16_bf16 v[16:31], v[44:47], v[132:135], v[16:31]
    ds_read_b64_tr_b16 v[36:37], v57 offset:36864
    ds_read_b64_tr_b16 v[38:39], v57 offset:37376
    s_waitcnt vmcnt(7) lgkmcnt(4)
    v_mfma_f32_32x32x16_bf16 v[0:15], v[48:51], v[136:139], v[0:15]
    s_add_u32 s37, s37, 2048
    s_and_b32 s37, s37, 0x7800
    buffer_load_dwordx4 v[132:135], v253, s[20:23], s38 offen offset:1024 sc1
    ds_read_b64_tr_b16 v[40:41], v56 offset:38912
    ds_read_b64_tr_b16 v[42:43], v56 offset:39424
    v_mfma_f32_32x32x16_bf16 v[16:31], v[52:55], v[136:139], v[16:31]
    ds_read_b64_tr_b16 v[44:45], v57 offset:38912
    ds_read_b64_tr_b16 v[46:47], v57 offset:39424
    s_waitcnt vmcnt(7) lgkmcnt(4)
    v_mfma_f32_32x32x16_bf16 v[0:15], v[32:35], v[104:107], v[0:15]
    s_add_u32 s38, s36, s37
    buffer_load_dwordx4 v[136:139], v253, s[20:23], s38 offen offset:0 sc1
    ds_read_b64_tr_b16 v[48:49], v56 offset:40960
    ds_read_b64_tr_b16 v[50:51], v56 offset:41472
    v_mfma_f32_32x32x16_bf16 v[16:31], v[36:39], v[104:107], v[16:31]
    ds_read_b64_tr_b16 v[52:53], v57 offset:40960
    ds_read_b64_tr_b16 v[54:55], v57 offset:41472
    s_waitcnt vmcnt(7) lgkmcnt(4)
    v_mfma_f32_32x32x16_bf16 v[0:15], v[40:43], v[108:111], v[0:15]
    s_add_u32 s37, s37, 2048
    s_and_b32 s37, s37, 0x7800
    buffer_load_dwordx4 v[104:107], v253, s[20:23], s38 offen offset:1024 sc1
    ds_read_b64_tr_b16 v[32:33], v56 offset:43008
    ds_read_b64_tr_b16 v[34:35], v56 offset:43520
    v_mfma_f32_32x32x16_bf16 v[16:31], v[44:47], v[108:111], v[16:31]
    ds_read_b64_tr_b16 v[36:37], v57 offset:43008
    ds_read_b64_tr_b16 v[38:39], v57 offset:43520
    s_waitcnt vmcnt(7) lgkmcnt(4)
    v_mfma_f32_32x32x16_bf16 v[0:15], v[48:51], v[112:115], v[0:15]
    buffer_load_dword v61, v60, s[20:23], s30 offen offset:256 sc1
    s_add_u32 s38, s36, s37
    buffer_load_dwordx4 v[108:111], v253, s[20:23], s38 offen offset:0 sc1
    ds_read_b64_tr_b16 v[40:41], v56 offset:45056
    ds_read_b64_tr_b16 v[42:43], v56 offset:45568
    v_mfma_f32_32x32x16_bf16 v[16:31], v[52:55], v[112:115], v[16:31]
    ds_read_b64_tr_b16 v[44:45], v57 offset:45056
    ds_read_b64_tr_b16 v[46:47], v57 offset:45568
    s_waitcnt vmcnt(8) lgkmcnt(4)
    v_mfma_f32_32x32x16_bf16 v[0:15], v[32:35], v[116:119], v[0:15]
    s_add_u32 s37, s37, 2048
    s_and_b32 s37, s37, 0x7800
    buffer_load_dwordx4 v[112:115], v253, s[20:23], s38 offen offset:1024 sc1
    ds_read_b64_tr_b16 v[48:49], v56 offset:47104
    ds_read_b64_tr_b16 v[50:51], v56 offset:47616
    v_mfma_f32_32x32x16_bf16 v[16:31], v[36:39], v[116:119], v[16:31]
    ds_read_b64_tr_b16 v[52:53], v57 offset:47104
    ds_read_b64_tr_b16 v[54:55], v57 offset:47616
    s_waitcnt vmcnt(8) lgkmcnt(4)
    v_mfma_f32_32x32x16_bf16 v[0:15], v[40:43], v[120:123], v[0:15]
    s_add_u32 s38, s36, s37
    buffer_load_dwordx4 v[116:119], v253, s[20:23], s38 offen offset:0 sc1
    ds_read_b64_tr_b16 v[32:33], v56 offset:49152
    ds_read_b64_tr_b16 v[34:35], v56 offset:49664
    v_mfma_f32_32x32x16_bf16 v[16:31], v[44:47], v[120:123], v[16:31]
    ds_read_b64_tr_b16 v[36:37], v57 offset:49152
    ds_read_b64_tr_b16 v[38:39], v57 offset:49664
    s_waitcnt vmcnt(8) lgkmcnt(4)
    v_mfma_f32_32x32x16_bf16 v[0:15], v[48:51], v[124:127], v[0:15]
    s_add_u32 s37, s37, 2048
    s_and_b32 s37, s37, 0x7800
    buffer_load_dwordx4 v[120:123], v253, s[20:23], s38 offen offset:1024 sc1
    ds_read_b64_tr_b16 v[40:41], v56 offset:51200
    ds_read_b64_tr_b16 v[42:43], v56 offset:51712
    v_mfma_f32_32x32x16_bf16 v[16:31], v[52:55], v[124:127], v[16:31]
    ds_read_b64_tr_b16 v[44:45], v57 offset:51200
    ds_read_b64_tr_b16 v[46:47], v57 offset:51712
    s_waitcnt vmcnt(8) lgkmcnt(4)
    v_mfma_f32_32x32x16_bf16 v[0:15], v[32:35], v[128:131], v[0:15]
    s_mov_b32 s78, s27
    s_waitcnt vmcnt(4)
    s_branch pc_29
pl_28:
    buffer_load_dword v61, v60, s[20:23], s30 offen offset:256 sc1
    s_waitcnt vmcnt(0)
pc_29:
    v_cmp_ne_u32 vcc, s88, v61
    s_cbranch_vccz pd_30
    s_sub_u32 s78, s78, 1
    s_cmp_lg_u32 s78, 0
    s_cbranch_scc1 pl_28
    s_mov_b32 s27, 1
pd_30:
    s_add_u32 s36, s36, 32768
    s_add_u32 s38, s36, s37
    buffer_load_dwordx4 v[124:127], v253, s[20:23], s38 offen offset:0 sc1
    ds_read_b64_tr_b16 v[48:49], v56 offset:53248
    ds_read_b64_tr_b16 v[50:51], v56 offset:53760
    v_mfma_f32_32x32x16_bf16 v[16:31], v[36:39], v[128:131], v[16:31]
    ds_read_b64_tr_b16 v[52:53], v57 offset:53248
    ds_read_b64_tr_b16 v[54:55], v57 offset:53760
    s_waitcnt vmcnt(8) lgkmcnt(4)
    v_mfma_f32_32x32x16_bf16 v[0:15], v[40:43], v[132:135], v[0:15]
    s_add_u32 s37, s37, 2048
    s_and_b32 s37, s37, 0x7800
    buffer_load_dwordx4 v[128:131], v253, s[20:23], s38 offen offset:1024 sc1
    ds_read_b64_tr_b16 v[32:33], v56 offset:55296
    ds_read_b64_tr_b16 v[34:35], v56 offset:55808
    v_mfma_f32_32x32x16_bf16 v[16:31], v[44:47], v[132:135], v[16:31]
    ds_read_b64_tr_b16 v[36:37], v57 offset:55296
    ds_read_b64_tr_b16 v[38:39], v57 offset:55808
    s_waitcnt vmcnt(8) lgkmcnt(4)
    v_mfma_f32_32x32x16_bf16 v[0:15], v[48:51], v[136:139], v[0:15]
    s_add_u32 s38, s36, s37
    buffer_load_dwordx4 v[132:135], v253, s[20:23], s38 offen offset:0 sc1
    ds_read_b64_tr_b16 v[40:41], v56 offset:57344
    ds_read_b64_tr_b16 v[42:43], v56 offset:57856
    v_mfma_f32_32x32x16_bf16 v[16:31], v[52:55], v[136:139], v[16:31]
    ds_read_b64_tr_b16 v[44:45], v57 offset:57344
    ds_read_b64_tr_b16 v[46:47], v57 offset:57856
    s_waitcnt vmcnt(8) lgkmcnt(4)
    v_mfma_f32_32x32x16_bf16 v[0:15], v[32:35], v[104:107], v[0:15]
    s_add_u32 s37, s37, 2048
    s_and_b32 s37, s37, 0x7800
    buffer_load_dwordx4 v[136:139], v253, s[20:23], s38 offen offset:1024 sc1
    ds_read_b64_tr_b16 v[48:49], v56 offset:59392
    ds_read_b64_tr_b16 v[50:51], v56 offset:59904
    v_mfma_f32_32x32x16_bf16 v[16:31], v[36:39], v[104:107], v[16:31]
    ds_read_b64_tr_b16 v[52:53], v57 offset:59392
    ds_read_b64_tr_b16 v[54:55], v57 offset:59904
    s_waitcnt vmcnt(7) lgkmcnt(4)
    v_mfma_f32_32x32x16_bf16 v[0:15], v[40:43], v[108:111], v[0:15]
    s_add_u32 s38, s36, s37
    buffer_load_dwordx4 v[104:107], v253, s[20:23], s38 offen offset:0 sc1
    ds_read_b64_tr_b16 v[32:33], v56 offset:61440
    ds_read_b64_tr_b16 v[34:35], v56 offset:61952
    v_mfma_f32_32x32x16_bf16 v[16:31], v[44:47], v[108:111], v[16:31]
    ds_read_b64_tr_b16 v[36:37], v57 offset:61440
    ds_read_b64_tr_b16 v[38:39], v57 offset:61952
    s_waitcnt vmcnt(7) lgkmcnt(4)
    v_mfma_f32_32x32x16_bf16 v[0:15], v[48:51], v[112:115], v[0:15]
    s_add_u32 s37, s37, 2048
    s_and_b32 s37, s37, 0x7800
    buffer_load_dwordx4 v[108:111], v253, s[20:23], s38 offen offset:1024 sc1
    ds_read_b64_tr_b16 v[40:41], v56 offset:63488
    ds_read_b64_tr_b16 v[42:43], v56 offset:64000
    v_mfma_f32_32x32x16_bf16 v[16:31], v[52:55], v[112:115], v[16:31]
    ds_read_b64_tr_b16 v[44:45], v57 offset:63488
    ds_read_b64_tr_b16 v[46:47], v57 offset:64000
    s_barrier
    s_waitcnt vmcnt(7) lgkmcnt(4)
    v_mfma_f32_32x32x16_bf16 v[0:15], v[32:35], v[116:119], v[0:15]
    s_add_u32 s38, s36, s37
    buffer_load_dwordx4 v[112:115], v253, s[20:23], s38 offen offset:0 sc1
    ds_read_b64_tr_b16 v[48:49], v58 offset:0
    ds_read_b64_tr_b16 v[50:51], v58 offset:512
    v_mfma_f32_32x32x16_bf16 v[16:31], v[36:39], v[116:119], v[16:31]
    ds_read_b64_tr_b16 v[52:53], v59 offset:0
    ds_read_b64_tr_b16 v[54:55], v59 offset:512
    s_waitcnt vmcnt(7) lgkmcnt(4)
    v_mfma_f32_32x32x16_bf16 v[0:15], v[40:43], v[120:123], v[0:15]
    s_add_u32 s37, s37, 2048
    s_and_b32 s37, s37, 0x7800
    buffer_load_dwordx4 v[116:119], v253, s[20:23], s38 offen offset:1024 sc1
    ds_read_b64_tr_b16 v[32:33], v58 offset:2048
    ds_read_b64_tr_b16 v[34:35], v58 offset:2560
    v_mfma_f32_32x32x16_bf16 v[16:31], v[44:47], v[120:123], v[16:31]
    ds_read_b64_tr_b16 v[36:37], v59 offset:2048
    ds_read_b64_tr_b16 v[38:39], v59 offset:2560
    s_waitcnt vmcnt(7) lgkmcnt(4)
    v_mfma_f32_32x32x16_bf16 v[0:15], v[48:51], v[124:127], v[0:15]
    s_add_u32 s38, s36, s37
    buffer_load_dwordx4 v[120:123], v253, s[20:23], s38 offen offset:0 sc1
    ds_read_b64_tr_b16 v[40:41], v58 offset:4096
    ds_read_b64_tr_b16 v[42:43], v58 offset:4608
    v_mfma_f32_32x32x16_bf16 v[16:31], v[52:55], v[124:127], v[16:31]
    ds_read_b64_tr_b16 v[44:45], v59 offset:4096
    ds_read_b64_tr_b16 v[46:47], v59 offset:4608
    s_waitcnt vmcnt(7) lgkmcnt(4)
    v_mfma_f32_32x32x16_bf16 v[0:15], v[32:35], v[128:131], v[0:15]
    s_add_u32 s37, s37, 2048
    s_and_b32 s37, s37, 0x7800
    buffer_load_dwordx4 v[124:127], v253, s[20:23], s38 offen offset:1024 sc1
    ds_read_b64_tr_b16 v[48:49], v58 offset:6144
    ds_read_b64_tr_b16 v[50:51], v58 offset:6656
    v_mfma_f32_32x32x16_bf16 v[16:31], v[36:39], v[128:131], v[16:31]
    ds_read_b64_tr_b16 v[52:53], v59 offset:6144
    ds_read_b64_tr_b16 v[54:55], v59 offset:6656
    s_waitcnt vmcnt(7) lgkmcnt(4)
    v_mfma_f32_32x32x16_bf16 v[0:15], v[40:43], v[132:135], v[0:15]
    s_add_u32 s38, s36, s37
    buffer_load_dwordx4 v[128:131], v253, s[20:23], s38 offen offset:0 sc1
    ds_read_b64_tr_b16 v[32:33], v58 offset:8192
    ds_read_b64_tr_b16 v[34:35], v58 offset:8704
    v_mfma_f32_32x32x16_bf16 v[16:31], v[44:47], v[132:135], v[16:31]
    ds_read_b64_tr_b16 v[36:37], v59 offset:8192
    ds_read_b64_tr_b16 v[38:39], v59 offset:8704
    s_waitcnt vmcnt(7) lgkmcnt(4)
    v_mfma_f32_32x32x16_bf16 v[0:15], v[48:51], v[136:139], v[0:15]
    s_add_u32 s37, s37, 2048
    s_and_b32 s37, s37, 0x7800
    buffer_load_dwordx4 v[132:135], v253, s[20:23], s38 offen offset:1024 sc1
    ds_read_b64_tr_b16 v[40:41], v58 offset:10240
    ds_read_b64_tr_b16 v[42:43], v58 offset:10752
    v_mfma_f32_32x32x16_bf16 v[16:31], v[52:55], v[136:139], v[16:31]
    ds_read_b64_tr_b16 v[44:45], v59 offset:10240
    ds_read_b64_tr_b16 v[46:47], v59 offset:10752
    s_waitcnt vmcnt(7) lgkmcnt(4)
    v_mfma_f32_32x32x16_bf16 v[0:15], v[32:35], v[104:107], v[0:15]
    s_add_u32 s38, s36, s37
    buffer_load_dwordx4 v[136:139], v253, s[20:23], s38 offen offset:0 sc1
    ds_read_b64_tr_b16 v[48:49], v58 offset:12288
    ds_read_b64_tr_b16 v[50:51], v58 offset:12800
    v_mfma_f32_32x32x16_bf16 v[16:31], v[36:39], v[104:107], v[16:31]
    ds_read_b64_tr_b16 v[52:53], v59 offset:12288
    ds_read_b64_tr_b16 v[54:55], v59 offset:12800
    s_waitcnt vmcnt(7) lgkmcnt(4)
    v_mfma_f32_32x32x16_bf16 v[0:15], v[40:43], v[108:111], v[0:15]
    s_add_u32 s37, s37, 2048
    s_and_b32 s37, s37, 0x7800
    buffer_load_dwordx4 v[104:107], v253, s[20:23], s38 offen offset:1024 sc1
    ds_read_b64_tr_b16 v[32:33], v58 offset:14336
    ds_read_b64_tr_b16 v[34:35], v58 offset:14848
    v_mfma_f32_32x32x16_bf16 v[16:31], v[44:47], v[108:111], v[16:31]
    ds_read_b64_tr_b16 v[36:37], v59 offset:14336
    ds_read_b64_tr_b16 v[38:39], v59 offset:14848
    s_waitcnt vmcnt(7) lgkmcnt(4)
    v_mfma_f32_32x32x16_bf16 v[0:15], v[48:51], v[112:115], v[0:15]
    s_add_u32 s38, s36, s37
    buffer_load_dwordx4 v[108:111], v253, s[20:23], s38 offen offset:0 sc1
    ds_read_b64_tr_b16 v[40:41], v58 offset:16384
    ds_read_b64_tr_b16 v[42:43], v58 offset:16896
    v_mfma_f32_32x32x16_bf16 v[16:31], v[52:55], v[112:115], v[16:31]
    ds_read_b64_tr_b16 v[44:45], v59 offset:16384
    ds_read_b64_tr_b16 v[46:47], v59 offset:16896
    s_waitcnt vmcnt(7) lgkmcnt(4)
    v_mfma_f32_32x32x16_bf16 v[0:15], v[32:35], v[116:119], v[0:15]
    s_add_u32 s37, s37, 2048
    s_and_b32 s37, s37, 0x7800
    buffer_load_dwordx4 v[112:115], v253, s[20:23], s38 offen offset:1024 sc1
    ds_read_b64_tr_b16 v[48:49], v58 offset:18432
    ds_read_b64_tr_b16 v[50:51], v58 offset:18944
    v_mfma_f32_32x32x16_bf16 v[16:31], v[36:39], v[116:119], v[16:31]
    ds_read_b64_tr_b16 v[52:53], v59 offset:18432
    ds_read_b64_tr_b16 v[54:55], v59 offset:18944
    s_waitcnt vmcnt(7) lgkmcnt(4)
    v_mfma_f32_32x32x16_bf16 v[0:15], v[40:43], v[120:123], v[0:15]
    s_add_u32 s38, s36, s37
    buffer_load_dwordx4 v[116:119], v253, s[20:23], s38 offen offset:0 sc1
    ds_read_b64_tr_b16 v[32:33], v58 offset:20480
    ds_read_b64_tr_b16 v[34:35], v58 offset:20992
    v_mfma_f32_32x32x16_bf16 v[16:31], v[44:47], v[120:123], v[16:31]
    ds_read_b64_tr_b16 v[36:37], v59 offset:20480
    ds_read_b64_tr_b16 v[38:39], v59 offset:20992
    s_waitcnt vmcnt(7) lgkmcnt(4)
    v_mfma_f32_32x32x16_bf16 v[0:15], v[48:51], v[124:127], v[0:15]
    s_add_u32 s37, s37, 2048
    s_and_b32 s37, s37, 0x7800
    buffer_load_dwordx4 v[120:123], v253, s[20:23], s38 offen offset:1024 sc1
    ds_read_b64_tr_b16 v[40:41], v58 offset:22528
    ds_read_b64_tr_b16 v[42:43], v58 offset:23040
    v_mfma_f32_32x32x16_bf16 v[16:31], v[52:55], v[124:127], v[16:31]
    ds_read_b64_tr_b16 v[44:45], v59 offset:22528
    ds_read_b64_tr_b16 v[46:47], v59 offset:23040
    s_waitcnt vmcnt(7) lgkmcnt(4)
    v_mfma_f32_32x32x16_bf16 v[0:15], v[32:35], v[128:131], v[0:15]
    s_add_u32 s38, s36, s37
    buffer_load_dwordx4 v[124:127], v253, s[20:23], s38 offen offset:0 sc1
    ds_read_b64_tr_b16 v[48:49], v58 offset:24576
    ds_read_b64_tr_b16 v[50:51], v58 offset:25088
    v_mfma_f32_32x32x16_bf16 v[16:31], v[36:39], v[128:131], v[16:31]
    ds_read_b64_tr_b16 v[52:53], v59 offset:24576
    ds_read_b64_tr_b16 v[54:55], v59 offset:25088
    s_waitcnt vmcnt(7) lgkmcnt(4)
    v_mfma_f32_32x32x16_bf16 v[0:15], v[40:43], v[132:135], v[0:15]
    s_add_u32 s37, s37, 2048
    s_and_b32 s37, s37, 0x7800
    buffer_load_dwordx4 v[128:131], v253, s[20:23], s38 offen offset:1024 sc1
    ds_read_b64_tr_b16 v[32:33], v58 offset:26624
    ds_read_b64_tr_b16 v[34:35], v58 offset:27136
    v_mfma_f32_32x32x16_bf16 v[16:31], v[44:47], v[132:135], v[16:31]
    ds_read_b64_tr_b16 v[36:37], v59 offset:26624
    ds_read_b64_tr_b16 v[38:39], v59 offset:27136
    s_waitcnt vmcnt(7) lgkmcnt(4)
    v_mfma_f32_32x32x16_bf16 v[0:15], v[48:51], v[136:139], v[0:15]
    s_add_u32 s38, s36, s37
    buffer_load_dwordx4 v[132:135], v253, s[20:23], s38 offen offset:0 sc1
    ds_read_b64_tr_b16 v[40:41], v58 offset:28672
    ds_read_b64_tr_b16 v[42:43], v58 offset:29184
    v_mfma_f32_32x32x16_bf16 v[16:31], v[52:55], v[136:139], v[16:31]
    ds_read_b64_tr_b16 v[44:45], v59 offset:28672
    ds_read_b64_tr_b16 v[46:47], v59 offset:29184
    s_waitcnt vmcnt(7) lgkmcnt(4)
    v_mfma_f32_32x32x16_bf16 v[0:15], v[32:35], v[104:107], v[0:15]
    s_add_u32 s37, s37, 2048
    s_and_b32 s37, s37, 0x7800
    buffer_load_dwordx4 v[136:139], v253, s[20:23], s38 offen offset:1024 sc1
    ds_read_b64_tr_b16 v[48:49], v58 offset:30720
    ds_read_b64_tr_b16 v[50:51], v58 offset:31232
    v_mfma_f32_32x32x16_bf16 v[16:31], v[36:39], v[104:107], v[16:31]
    ds_read_b64_tr_b16 v[52:53], v59 offset:30720
    ds_read_b64_tr_b16 v[54:55], v59 offset:31232
    s_waitcnt vmcnt(7) lgkmcnt(4)
    v_mfma_f32_32x32x16_bf16 v[0:15], v[40:43], v[108:111], v[0:15]
    s_add_u32 s38, s36, s37
    buffer_load_dwordx4 v[104:107], v253, s[20:23], s38 offen offset:0 sc1
    ds_read_b64_tr_b16 v[32:33], v58 offset:32768
    ds_read_b64_tr_b16 v[34:35], v58 offset:33280
    v_mfma_f32_32x32x16_bf16 v[16:31], v[44:47], v[108:111], v[16:31]
    ds_read_b64_tr_b16 v[36:37], v59 offset:32768
    ds_read_b64_tr_b16 v[38:39], v59 offset:33280
    s_waitcnt vmcnt(7) lgkmcnt(4)
    v_mfma_f32_32x32x16_bf16 v[0:15], v[48:51], v[112:115], v[0:15]
    s_add_u32 s37, s37, 2048
    s_and_b32 s37, s37, 0x7800
    buffer_load_dwordx4 v[108:111], v253, s[20:23], s38 offen offset:1024 sc1
    ds_read_b64_tr_b16 v[40:41], v58 offset:34816
    ds_read_b64_tr_b16 v[42:43], v58 offset:35328
    v_mfma_f32_32x32x16_bf16 v[16:31], v[52:55], v[112:115], v[16:31]
    ds_read_b64_tr_b16 v[44:45], v59 offset:34816
    ds_read_b64_tr_b16 v[46:47], v59 offset:35328
    s_waitcnt vmcnt(7) lgkmcnt(4)
    v_mfma_f32_32x32x16_bf16 v[0:15], v[32:35], v[116:119], v[0:15]
    s_add_u32 s38, s36, s37
    buffer_load_dwordx4 v[112:115], v253, s[20:23], s38 offen offset:0 sc1
    ds_read_b64_tr_b16 v[48:49], v58 offset:36864
    ds_read_b64_tr_b16 v[50:51], v58 offset:37376
    v_mfma_f32_32x32x16_bf16 v[16:31], v[36:39], v[116:119], v[16:31]
    ds_read_b64_tr_b16 v[52:53], v59 offset:36864
    ds_read_b64_tr_b16 v[54:55], v59 offset:37376
    s_waitcnt vmcnt(7) lgkmcnt(4)
    v_mfma_f32_32x32x16_bf16 v[0:15], v[40:43], v[120:123], v[0:15]
    s_add_u32 s37, s37, 2048
    s_and_b32 s37, s37, 0x7800
    buffer_load_dwordx4 v[116:119], v253, s[20:23], s38 offen offset:1024 sc1
    ds_read_b64_tr_b16 v[32:33], v58 offset:38912
    ds_read_b64_tr_b16 v[34:35], v58 offset:39424
    v_mfma_f32_32x32x16_bf16 v[16:31], v[44:47], v[120:123], v[16:31]
    ds_read_b64_tr_b16 v[36:37], v59 offset:38912
    ds_read_b64_tr_b16 v[38:39], v59 offset:39424
    s_waitcnt vmcnt(7) lgkmcnt(4)
    v_mfma_f32_32x32x16_bf16 v[0:15], v[48:51], v[124:127], v[0:15]
    s_add_u32 s38, s36, s37
    buffer_load_dwordx4 v[120:123], v253, s[20:23], s38 offen offset:0 sc1
    ds_read_b64_tr_b16 v[40:41], v58 offset:40960
    ds_read_b64_tr_b16 v[42:43], v58 offset:41472
    v_mfma_f32_32x32x16_bf16 v[16:31], v[52:55], v[124:127], v[16:31]
    ds_read_b64_tr_b16 v[44:45], v59 offset:40960
    ds_read_b64_tr_b16 v[46:47], v59 offset:41472
    s_waitcnt vmcnt(7) lgkmcnt(4)
    v_mfma_f32_32x32x16_bf16 v[0:15], v[32:35], v[128:131], v[0:15]
    s_add_u32 s37, s37, 2048
    s_and_b32 s37, s37, 0x7800
    buffer_load_dwordx4 v[124:127], v253, s[20:23], s38 offen offset:1024 sc1
    ds_read_b64_tr_b16 v[48:49], v58 offset:43008
    ds_read_b64_tr_b16 v[50:51], v58 offset:43520
    v_mfma_f32_32x32x16_bf16 v[16:31], v[36:39], v[128:131], v[16:31]
    ds_read_b64_tr_b16 v[52:53], v59 offset:43008
    ds_read_b64_tr_b16 v[54:55], v59 offset:43520
    s_waitcnt vmcnt(7) lgkmcnt(4)
    v_mfma_f32_32x32x16_bf16 v[0:15], v[40:43], v[132:135], v[0:15]
    s_add_u32 s38, s36, s37
    buffer_load_dwordx4 v[128:131], v253, s[20:23], s38 offen offset:0 sc1
    ds_read_b64_tr_b16 v[32:33], v58 offset:45056
    ds_read_b64_tr_b16 v[34:35], v58 offset:45568
    v_mfma_f32_32x32x16_bf16 v[16:31], v[44:47], v[132:135], v[16:31]
    ds_read_b64_tr_b16 v[36:37], v59 offset:45056
    ds_read_b64_tr_b16 v[38:39], v59 offset:45568
    s_waitcnt vmcnt(7) lgkmcnt(4)
    v_mfma_f32_32x32x16_bf16 v[0:15], v[48:51], v[136:139], v[0:15]
    s_add_u32 s37, s37, 2048
    s_and_b32 s37, s37, 0x7800
    buffer_load_dwordx4 v[132:135], v253, s[20:23], s38 offen offset:1024 sc1
    ds_read_b64_tr_b16 v[40:41], v58 offset:47104
    ds_read_b64_tr_b16 v[42:43], v58 offset:47616
    v_mfma_f32_32x32x16_bf16 v[16:31], v[52:55], v[136:139], v[16:31]
    ds_read_b64_tr_b16 v[44:45], v59 offset:47104
    ds_read_b64_tr_b16 v[46:47], v59 offset:47616
    s_barrier
    s_waitcnt vmcnt(7) lgkmcnt(4)
    v_mfma_f32_32x32x16_bf16 v[0:15], v[32:35], v[104:107], v[0:15]
    s_add_u32 s38, s36, s37
    buffer_load_dwordx4 v[136:139], v253, s[20:23], s38 offen offset:0 sc1
    ds_read_b64_tr_b16 v[48:49], v58 offset:49152
    ds_read_b64_tr_b16 v[50:51], v58 offset:49664
    v_mfma_f32_32x32x16_bf16 v[16:31], v[36:39], v[104:107], v[16:31]
    ds_read_b64_tr_b16 v[52:53], v59 offset:49152
    ds_read_b64_tr_b16 v[54:55], v59 offset:49664
    s_waitcnt vmcnt(7) lgkmcnt(4)
    v_mfma_f32_32x32x16_bf16 v[0:15], v[40:43], v[108:111], v[0:15]
    s_add_u32 s37, s37, 2048
    s_and_b32 s37, s37, 0x7800
    buffer_load_dwordx4 v[104:107], v253, s[20:23], s38 offen offset:1024 sc1
    ds_read_b64_tr_b16 v[32:33], v58 offset:51200
    ds_read_b64_tr_b16 v[34:35], v58 offset:51712
    v_mfma_f32_32x32x16_bf16 v[16:31], v[44:47], v[108:111], v[16:31]
    ds_read_b64_tr_b16 v[36:37], v59 offset:51200
    ds_read_b64_tr_b16 v[38:39], v59 offset:51712
    s_waitcnt vmcnt(7) lgkmcnt(4)
    v_mfma_f32_32x32x16_bf16 v[0:15], v[48:51], v[112:115], v[0:15]
    ds_read_b64_tr_b16 v[40:41], v58 offset:53248
    ds_read_b64_tr_b16 v[42:43], v58 offset:53760
    v_mfma_f32_32x32x16_bf16 v[16:31], v[52:55], v[112:115], v[16:31]
    ds_read_b64_tr_b16 v[44:45], v59 offset:53248
    ds_read_b64_tr_b16 v[46:47], v59 offset:53760
    s_waitcnt vmcnt(6) lgkmcnt(4)
    v_mfma_f32_32x32x16_bf16 v[0:15], v[32:35], v[116:119], v[0:15]
    ds_read_b64_tr_b16 v[48:49], v58 offset:55296
    ds_read_b64_tr_b16 v[50:51], v58 offset:55808
    v_mfma_f32_32x32x16_bf16 v[16:31], v[36:39], v[116:119], v[16:31]
    ds_read_b64_tr_b16 v[52:53], v59 offset:55296
    ds_read_b64_tr_b16 v[54:55], v59 offset:55808
    s_waitcnt vmcnt(5) lgkmcnt(4)
    v_mfma_f32_32x32x16_bf16 v[0:15], v[40:43], v[120:123], v[0:15]
    ds_read_b64_tr_b16 v[32:33], v58 offset:57344
    ds_read_b64_tr_b16 v[34:35], v58 offset:57856
    v_mfma_f32_32x32x16_bf16 v[16:31], v[44:47], v[120:123], v[16:31]
    ds_read_b64_tr_b16 v[36:37], v59 offset:57344
    ds_read_b64_tr_b16 v[38:39], v59 offset:57856
    s_waitcnt vmcnt(4) lgkmcnt(4)
    v_mfma_f32_32x32x16_bf16 v[0:15], v[48:51], v[124:127], v[0:15]
    ds_read_b64_tr_b16 v[40:41], v58 offset:59392
    ds_read_b64_tr_b16 v[42:43], v58 offset:59904
    v_mfma_f32_32x32x16_bf16 v[16:31], v[52:55], v[124:127], v[16:31]
    ds_read_b64_tr_b16 v[44:45], v59 offset:59392
    ds_read_b64_tr_b16 v[46:47], v59 offset:59904
    s_waitcnt vmcnt(3) lgkmcnt(4)
    v_mfma_f32_32x32x16_bf16 v[0:15], v[32:35], v[128:131], v[0:15]
    ds_read_b64_tr_b16 v[48:49], v58 offset:61440
    ds_read_b64_tr_b16 v[50:51], v58 offset:61952
    v_mfma_f32_32x32x16_bf16 v[16:31], v[36:39], v[128:131], v[16:31]
    ds_read_b64_tr_b16 v[52:53], v59 offset:61440
    ds_read_b64_tr_b16 v[54:55], v59 offset:61952
    s_waitcnt vmcnt(2) lgkmcnt(4)
    v_mfma_f32_32x32x16_bf16 v[0:15], v[40:43], v[132:135], v[0:15]
    ds_read_b64_tr_b16 v[32:33], v58 offset:63488
    ds_read_b64_tr_b16 v[34:35], v58 offset:64000
    v_mfma_f32_32x32x16_bf16 v[16:31], v[44:47], v[132:135], v[16:31]
    ds_read_b64_tr_b16 v[36:37], v59 offset:63488
    ds_read_b64_tr_b16 v[38:39], v59 offset:64000
    s_waitcnt vmcnt(1) lgkmcnt(4)
    v_mfma_f32_32x32x16_bf16 v[0:15], v[48:51], v[136:139], v[0:15]
    v_mfma_f32_32x32x16_bf16 v[16:31], v[52:55], v[136:139], v[16:31]
    s_waitcnt vmcnt(0) lgkmcnt(0)
    v_mfma_f32_32x32x16_bf16 v[0:15], v[32:35], v[104:107], v[0:15]
    v_mfma_f32_32x32x16_bf16 v[16:31], v[36:39], v[104:107], v[16:31]
    s_lshl_b32 s35, s24, 4
    s_add_u32 s35, s35, s98
    s_lshl_b32 s35, s35, 14
    s_lshl_b32 s34, s3, 12
    s_add_u32 s35, s35, s34
    s_add_u32 s35, s35, 0x2000000
    s_lshl_b32 s30, s99, 13
    s_add_u32 s30, s30, s26
    s_add_u32 s30, s30, 0xc00000
    s_lshl_b32 s31, s98, 9
    s_add_u32 s31, s31, s30
    v_mov_b32 v96, 0
    v_mov_b32 v97, 0
    v_mov_b32 v98, 0
    v_mov_b32 v99, v242
    v_cvt_pk_bf16_f32 v208, v0, v1
    v_cvt_pk_bf16_f32 v209, v2, v3
    v_cvt_pk_bf16_f32 v210, v4, v5
    v_cvt_pk_bf16_f32 v211, v6, v7
    v_cvt_pk_bf16_f32 v212, v8, v9
    v_cvt_pk_bf16_f32 v213, v10, v11
    v_cvt_pk_bf16_f32 v214, v12, v13
    v_cvt_pk_bf16_f32 v215, v14, v15
    v_cvt_pk_bf16_f32 v216, v16, v17
    v_cvt_pk_bf16_f32 v217, v18, v19
    v_cvt_pk_bf16_f32 v218, v20, v21
    v_cvt_pk_bf16_f32 v219, v22, v23
    v_cvt_pk_bf16_f32 v220, v24, v25
    v_cvt_pk_bf16_f32 v221, v26, v27
    v_cvt_pk_bf16_f32 v222, v28, v29
    v_cvt_pk_bf16_f32 v223, v30, v31
    s_cmp_lg_u32 s26, 0
    s_cbranch_scc1 sk_31
    s_cmp_lg_u32 s77, 0
    s_cbranch_scc1 lc_32
    buffer_store_dwordx4 v[208:211], v100, s[20:23], s35 offen offset:0 sc1
    buffer_store_dwordx4 v[212:215], v100, s[20:23], s35 offen offset:512 sc1
    buffer_store_dwordx4 v[216:219], v100, s[20:23], s35 offen offset:1024 sc1
    buffer_store_dwordx4 v[220:223], v100, s[20:23], s35 offen offset:1536 sc1
    s_branch lc_33
    s_nop 0
lc_32:
    buffer_store_dwordx4 v[208:211], v100, s[20:23], s35 offen offset:0 sc1
    buffer_store_dwordx4 v[212:215], v100, s[20:23], s35 offen offset:512 sc1
    buffer_store_dwordx4 v[216:219], v100, s[20:23], s35 offen offset:1024 sc1
    buffer_store_dwordx4 v[220:223], v100, s[20:23], s35 offen offset:1536 sc1
lc_33:
    ds_write_b128 v101, v[208:211] offset:0
    ds_write_b128 v101, v[212:215] offset:512
    ds_write_b128 v101, v[216:219] offset:1024
    ds_write_b128 v101, v[220:223] offset:1536
sk_31:
    v_dot2c_f32_bf16 v96, 0x3f803f80, v208
    v_dot2c_f32_bf16 v97, v208, v208
    v_dot2c_f32_bf16 v98, v224, v208
    v_dot2c_f32_bf16 v96, 0x3f803f80, v209
    v_dot2c_f32_bf16 v97, v209, v209
    v_dot2c_f32_bf16 v98, v225, v209
    v_dot2c_f32_bf16 v96, 0x3f803f80, v210
    v_dot2c_f32_bf16 v97, v210, v210
    v_dot2c_f32_bf16 v98, v226, v210
    v_dot2c_f32_bf16 v96, 0x3f803f80, v211
    v_dot2c_f32_bf16 v97, v211, v211
    v_dot2c_f32_bf16 v98, v227, v211
    v_dot2c_f32_bf16 v96, 0x3f803f80, v212
    v_dot2c_f32_bf16 v97, v212, v212
    v_dot2c_f32_bf16 v98, v228, v212
    v_dot2c_f32_bf16 v96, 0x3f803f80, v213
    v_dot2c_f32_bf16 v97, v213, v213
    v_dot2c_f32_bf16 v98, v229, v213
    v_dot2c_f32_bf16 v96, 0x3f803f80, v214
    v_dot2c_f32_bf16 v97, v214, v214
    v_dot2c_f32_bf16 v98, v230, v214
    v_dot2c_f32_bf16 v96, 0x3f803f80, v215
    v_dot2c_f32_bf16 v97, v215, v215
    v_dot2c_f32_bf16 v98, v231, v215
    v_dot2c_f32_bf16 v96, 0x3f803f80, v216
    v_dot2c_f32_bf16 v97, v216, v216
    v_dot2c_f32_bf16 v98, v232, v216
    v_dot2c_f32_bf16 v96, 0x3f803f80, v217
    v_dot2c_f32_bf16 v97, v217, v217
    v_dot2c_f32_bf16 v98, v233, v217
    v_dot2c_f32_bf16 v96, 0x3f803f80, v218
    v_dot2c_f32_bf16 v97, v218, v218
    v_dot2c_f32_bf16 v98, v234, v218
    v_dot2c_f32_bf16 v96, 0x3f803f80, v219
    v_dot2c_f32_bf16 v97, v219, v219
    v_dot2c_f32_bf16 v98, v235, v219
    v_dot2c_f32_bf16 v96, 0x3f803f80, v220
    v_dot2c_f32_bf16 v97, v220, v220
    v_dot2c_f32_bf16 v98, v236, v220
    v_dot2c_f32_bf16 v96, 0x3f803f80, v221
    v_dot2c_f32_bf16 v97, v221, v221
    v_dot2c_f32_bf16 v98, v237, v221
    v_dot2c_f32_bf16 v96, 0x3f803f80, v222
    v_dot2c_f32_bf16 v97, v222, v222
    v_dot2c_f32_bf16 v98, v238, v222
    v_dot2c_f32_bf16 v96, 0x3f803f80, v223
    v_dot2c_f32_bf16 v97, v223, v223
    v_dot2c_f32_bf16 v98, v239, v223
    s_nop 0
    v_mov_b32 v48, v96
    v_mov_b32 v49, v97
    v_mov_b32 v50, v98
    v_mov_b32 v51, v99
    v_permlane32_swap_b32 v96, v48
    v_permlane32_swap_b32 v97, v49
    v_permlane32_swap_b32 v98, v50
    v_permlane32_swap_b32 v99, v51
    v_add_f32 v96, v96, v48
    v_add_f32 v97, v97, v49
    v_add_f32 v98, v98, v50
    v_add_f32_e64 v99, v99, v51
    s_mov_b32 exec_hi, 0
    s_waitcnt vmcnt(0)
    s_cmp_lg_u32 s77, 0
    s_cbranch_scc1 lc_34
    buffer_store_dwordx4 v[96:99], v253, s[20:23], s31 offen sc1
    s_branch lc_35
    s_nop 0
lc_34:
    buffer_store_dwordx4 v[96:99], v253, s[20:23], s31 offen
lc_35:
    s_mov_b64 exec, -1
    s_cmp_lg_u32 s26, 0
    s_cbranch_scc1 e_final
    s_mov_b32 s26, 16777216
    s_and_b32 s30, s3, 1
    s_lshl_b32 s30, s30, 13
    v_add_u32 v176, s30, v253
    v_add_u32 v177, 1024, v176
    s_lshr_b32 s30, s16, 7
    s_sub_u32 s30, 3, s30
    s_and_b32 s30, s30, 7
    s_and_b32 s31, s24, 1
    s_lshl_b32 s31, s31, 3
    s_add_u32 s30, s30, s31
    s_and_b32 s31, s24, 14
    s_add_u32 s84, s31, s30
    s_lshl_b32 s31, s25, 2
    s_add_u32 s31, s31, s28
    s_mul_i32 s31, s31, 6144
    s_lshl_b32 s30, s30, 7
    s_add_u32 s30, s30, s31
    v_min_u32_e64 v190, 2, v252
    v_lshl_add_u32 v190, v190, 11, s30
    s_add_u32 s84, s84, 14
    v_mov_b32 v0, 0
    v_mov_b32 v1, 0
    v_mov_b32 v2, 0
    v_mov_b32 v3, 0
    v_mov_b32 v4, 0
    v_mov_b32 v5, 0
    v_mov_b32 v6, 0
    v_mov_b32 v7, 0
    v_mov_b32 v8, 0
    v_mov_b32 v9, 0
    v_mov_b32 v10, 0
    v_mov_b32 v11, 0
    v_mov_b32 v12, 0
    v_mov_b32 v13, 0
    v_mov_b32 v14, 0
    v_mov_b32 v15, 0
    v_mov_b32 v16, 0
    v_mov_b32 v17, 0
    v_mov_b32 v18, 0
    v_mov_b32 v19, 0
    v_mov_b32 v20, 0
    v_mov_b32 v21, 0
    v_mov_b32 v22, 0
    v_mov_b32 v23, 0
    v_mov_b32 v24, 0
    v_mov_b32 v25, 0
    v_mov_b32 v26, 0
    v_mov_b32 v27, 0
    v_mov_b32 v28, 0
    v_mov_b32 v29, 0
    v_mov_b32 v30, 0
    v_mov_b32 v31, 0
    v_mov_b32 v32, 0
    v_mov_b32 v33, 0
    v_mov_b32 v34, 0
    v_mov_b32 v35, 0
    v_mov_b32 v36, 0
    v_mov_b32 v37, 0
    v_mov_b32 v38, 0
    v_mov_b32 v39, 0
    v_mov_b32 v40, 0
    v_mov_b32 v41, 0
    v_mov_b32 v42, 0
    v_mov_b32 v43, 0
    v_mov_b32 v44, 0
    v_mov_b32 v45, 0
    v_mov_b32 v46, 0
    v_mov_b32 v47, 0
    v_mov_b32 v48, 0
    v_mov_b32 v49, 0
    v_mov_b32 v50, 0
    v_mov_b32 v51, 0
    v_mov_b32 v52, 0
    v_mov_b32 v53, 0
    v_mov_b32 v54, 0
    v_mov_b32 v55, 0
    v_mov_b32 v56, 0
    v_mov_b32 v57, 0
    v_mov_b32 v58, 0
    v_mov_b32 v59, 0
    v_mov_b32 v60, 0
    v_mov_b32 v61, 0
    v_mov_b32 v62, 0
    v_mov_b32 v63, 0
    v_mov_b32 v64, 0
    v_mov_b32 v65, 0
    v_mov_b32 v66, 0
    v_mov_b32 v67, 0
    v_mov_b32 v68, 0
    v_mov_b32 v69, 0
    v_mov_b32 v70, 0
    v_mov_b32 v71, 0
    v_mov_b32 v72, 0
    v_mov_b32 v73, 0
    v_mov_b32 v74, 0
    v_mov_b32 v75, 0
    v_mov_b32 v76, 0
    v_mov_b32 v77, 0
    v_mov_b32 v78, 0
    v_mov_b32 v79, 0
    v_mov_b32 v80, 0
    v_mov_b32 v81, 0
    v_mov_b32 v82, 0
    v_mov_b32 v83, 0
    v_mov_b32 v84, 0
    v_mov_b32 v85, 0
    v_mov_b32 v86, 0
    v_mov_b32 v87, 0
    v_mov_b32 v88, 0
    v_mov_b32 v89, 0
    v_mov_b32 v90, 0
    v_mov_b32 v91, 0
    v_mov_b32 v92, 0
    v_mov_b32 v93, 0
    v_mov_b32 v94, 0
    v_mov_b32 v95, 0
    s_waitcnt lgkmcnt(0)
    s_branch e_q
    s_nop 0
e_fpf:
    s_bitset0_b32 s86, s36
    s_bfm_b64 exec, 56, 0
    global_load_dword v191, v[196:197], off
    v_add_co_u32 v196, vcc, v196, v198
    s_nop 1
    v_addc_co_u32 v197, vcc, 0, v197, vcc
    s_mov_b64 exec, -1
    s_branch e_fpf_ret
e_arr:
    s_mov_b64 exec, 3
    s_mov_b32 s89, 0xdd9000
    buffer_store_dwordx2 v[250:251], v249, s[20:23], s89 offen sc1
    s_mov_b64 exec, -1
    s_branch e_arr_ret
e_final:
    s_mov_b32 s78, s27
pl_36:
    s_lshl_b32 s30, s99, 13
    s_add_u32 s30, s30, 0x1c00000
    s_add_u32 s31, s30, 4096
    buffer_load_dwordx4 v[64:67], v253, s[20:23], s30 offen offset:0 sc1
    buffer_load_dwordx4 v[68:71], v253, s[20:23], s30 offen offset:1024 sc1
    buffer_load_dwordx4 v[72:75], v253, s[20:23], s30 offen offset:2048 sc1
    buffer_load_dwordx4 v[76:79], v253, s[20:23], s30 offen offset:3072 sc1
    buffer_load_dwordx4 v[80:83], v253, s[20:23], s31 offen offset:0 sc1
    buffer_load_dwordx4 v[84:87], v253, s[20:23], s31 offen offset:1024 sc1
    buffer_load_dwordx4 v[88:91], v253, s[20:23], s31 offen offset:2048 sc1
    buffer_load_dwordx4 v[92:95], v253, s[20:23], s31 offen offset:3072 sc1
    s_waitcnt vmcnt(0)
pc_37:
    v_max3_u32 v48, v64, v68, v72
    v_max3_u32 v48, v48, v76, v80
    v_max3_u32 v48, v48, v84, v88
    v_max_u32 v48, v48, v92
    v_cmp_eq_u32 vcc, -1, v48
    s_cbranch_vccz pd_38
    s_sub_u32 s78, s78, 1
    s_cmp_lg_u32 s78, 0
    s_cbranch_scc1 pl_36
    s_mov_b32 s27, 1
pd_38:
    v_pk_add_f32 v[64:65], v[64:65], v[68:69]
    v_pk_add_f32 v[66:67], v[66:67], v[70:71]
    v_pk_add_f32 v[64:65], v[64:65], v[72:73]
    v_pk_add_f32 v[66:67], v[66:67], v[74:75]
    v_pk_add_f32 v[64:65], v[64:65], v[76:77]
    v_pk_add_f32 v[66:67], v[66:67], v[78:79]
    v_pk_add_f32 v[64:65], v[64:65], v[80:81]
    v_pk_add_f32 v[66:67], v[66:67], v[82:83]
    v_pk_add_f32 v[64:65], v[64:65], v[84:85]
    v_pk_add_f32 v[66:67], v[66:67], v[86:87]
    v_pk_add_f32 v[64:65], v[64:65], v[88:89]
    v_pk_add_f32 v[66:67], v[66:67], v[90:91]
    v_pk_add_f32 v[64:65], v[64:65], v[92:93]
    v_pk_add_f32 v[66:67], v[66:67], v[94:95]
    v_mov_b32 v48, v64
    v_mov_b32 v49, v65
    v_mov_b32 v50, v66
    v_mov_b32 v51, v67
    v_permlane32_swap_b32 v64, v48
    v_permlane32_swap_b32 v65, v49
    v_permlane32_swap_b32 v66, v50
    v_permlane32_swap_b32 v67, v51
    v_add_f32 v64, v64, v48
    v_add_f32 v65, v65, v49
    v_add_f32 v66, v66, v50
    v_add_f32 v67, v67, v51
    v_mul_f32 v54, 0x3a800000, v64
    v_mul_f32 v65, 0x3a800000, v65
    v_fma_f32 v65, -v54, v54, v65
    v_max_f32_e64 v65, 0, v65
    v_add_f32 v55, 0x3727c5ac, v65
    v_rsq_f32_e64 v55, v55
    v_fma_f32 v52, -v54, v67, v66
    v_and_b32 v53, 31, v252
    v_mul_f32 v52, v52, v55
    s_lshl_b32 s32, s99, 5
    v_add_u32 v53, s32, v53
    v_mov_b32 v48, v52
    s_nop 1
    v_max_f32_dpp v48, v48, v48 quad_perm:[1,0,3,2] row_mask:0xf bank_mask:0xf
    s_nop 1
    v_max_f32_dpp v48, v48, v48 quad_perm:[2,3,0,1] row_mask:0xf bank_mask:0xf
    s_nop 1
    v_max_f32_dpp v48, v48, v48 row_half_mirror row_mask:0xf bank_mask:0xf
    s_nop 1
    v_max_f32_dpp v48, v48, v48 row_mirror row_mask:0xf bank_mask:0xf
    v_mov_b32 v49, v48
    s_nop 1
    v_permlane16_swap_b32 v48, v49
    v_max_f32 v48, v48, v49
    v_cmp_eq_f32 vcc, v48, v52
    v_lshrrev_b32 v50, 5, v252
    v_lshlrev_b32 v50, 4, v50
    s_lshr_b32 s34, s25, 3
    v_lshl_add_u32 v51, s34, 28, v50
    s_lshl_b32 s32, s99, 11
    s_lshl_b32 s33, s98, 7
    s_add_u32 s32, s32, s33
    s_add_u32 s32, s32, 0x1d60000
    s_and_b32 s34, s25, 7
    s_lshl_b32 s34, s34, 6
    s_add_u32 s34, s34, s99
    s_mul_i32 s34, s34, 32
    s_add_u32 s34, s34, 0x1dc0000
    s_ff1_i32_b32 s35, vcc_lo
    s_lshl_b32 s35, 1, s35
    s_mov_b32 exec_lo, s35
    s_mov_b32 exec_hi, s35
    buffer_store_dwordx4 v[52:55], v51, s[20:23], s34 offen sc1
    buffer_store_dwordx4 v[208:211], v50, s[20:23], s32 offen offset:0 sc1
    buffer_store_dwordx4 v[212:215], v50, s[20:23], s32 offen offset:32 sc1
    buffer_store_dwordx4 v[216:219], v50, s[20:23], s32 offen offset:64 sc1
    buffer_store_dwordx4 v[220:223], v50, s[20:23], s32 offen offset:96 sc1
    s_mov_b64 exec, -1
    s_mov_b32 s38, s35
    s_mov_b32 s39, s35
    v_add_f32 v240, 1.0, v55
    v_mul_f32 v241, v54, v55
    v_sub_f32 v241, 0, v241
    v_pk_fma_f32 v[0:1], v[0:1], v[240:241], v[240:241] op_sel:[0,0,1] op_sel_hi:[1,0,1]
    v_pk_fma_f32 v[2:3], v[2:3], v[240:241], v[240:241] op_sel:[0,0,1] op_sel_hi:[1,0,1]
    v_pk_fma_f32 v[4:5], v[4:5], v[240:241], v[240:241] op_sel:[0,0,1] op_sel_hi:[1,0,1]
    v_pk_fma_f32 v[6:7], v[6:7], v[240:241], v[240:241] op_sel:[0,0,1] op_sel_hi:[1,0,1]
    v_pk_fma_f32 v[8:9], v[8:9], v[240:241], v[240:241] op_sel:[0,0,1] op_sel_hi:[1,0,1]
    v_pk_fma_f32 v[10:11], v[10:11], v[240:241], v[240:241] op_sel:[0,0,1] op_sel_hi:[1,0,1]
    v_pk_fma_f32 v[12:13], v[12:13], v[240:241], v[240:241] op_sel:[0,0,1] op_sel_hi:[1,0,1]
    v_pk_fma_f32 v[14:15], v[14:15], v[240:241], v[240:241] op_sel:[0,0,1] op_sel_hi:[1,0,1]
    v_pk_fma_f32 v[16:17], v[16:17], v[240:241], v[240:241] op_sel:[0,0,1] op_sel_hi:[1,0,1]
    v_pk_fma_f32 v[18:19], v[18:19], v[240:241], v[240:241] op_sel:[0,0,1] op_sel_hi:[1,0,1]
    v_pk_fma_f32 v[20:21], v[20:21], v[240:241], v[240:241] op_sel:[0,0,1] op_sel_hi:[1,0,1]
    v_pk_fma_f32 v[22:23], v[22:23], v[240:241], v[240:241] op_sel:[0,0,1] op_sel_hi:[1,0,1]
    v_pk_fma_f32 v[24:25], v[24:25], v[240:241], v[240:241] op_sel:[0,0,1] op_sel_hi:[1,0,1]
    v_pk_fma_f32 v[26:27], v[26:27], v[240:241], v[240:241] op_sel:[0,0,1] op_sel_hi:[1,0,1]
    v_pk_fma_f32 v[28:29], v[28:29], v[240:241], v[240:241] op_sel:[0,0,1] op_sel_hi:[1,0,1]
    v_pk_fma_f32 v[30:31], v[30:31], v[240:241], v[240:241] op_sel:[0,0,1] op_sel_hi:[1,0,1]
    v_cvt_pk_bf16_f32 v64, v0, v1
    v_cvt_pk_bf16_f32 v65, v2, v3
    v_cvt_pk_bf16_f32 v66, v4, v5
    v_cvt_pk_bf16_f32 v67, v6, v7
    v_cvt_pk_bf16_f32 v68, v8, v9
    v_cvt_pk_bf16_f32 v69, v10, v11
    v_cvt_pk_bf16_f32 v70, v12, v13
    v_cvt_pk_bf16_f32 v71, v14, v15
    v_cvt_pk_bf16_f32 v72, v16, v17
    v_cvt_pk_bf16_f32 v73, v18, v19
    v_cvt_pk_bf16_f32 v74, v20, v21
    v_cvt_pk_bf16_f32 v75, v22, v23
    v_cvt_pk_bf16_f32 v76, v24, v25
    v_cvt_pk_bf16_f32 v77, v26, v27
    v_cvt_pk_bf16_f32 v78, v28, v29
    v_cvt_pk_bf16_f32 v79, v30, v31
    v_permlane32_swap_b32 v64, v66
    v_permlane32_swap_b32 v65, v67
    v_permlane32_swap_b32 v68, v70
    v_permlane32_swap_b32 v69, v71
    v_permlane32_swap_b32 v72, v74
    v_permlane32_swap_b32 v73, v75
    v_permlane32_swap_b32 v76, v78
    v_permlane32_swap_b32 v77, v79
    v_lshl_add_u32 v50, v53, 11, v50
    s_mov_b32 s79, s26
    s_lshl_b32 s34, s28, 12
    s_add_u32 s34, s34, 147456
    v_bfe_u32 v16, v252, 1, 3
    v_lshrrev_b32 v17, 5, v252
    v_xor_b32 v16, v16, v17
    v_and_b32 v17, 31, v252
    v_lshlrev_b32 v17, 7, v17
    v_lshl_add_u32 v16, v16, 4, v17
    v_add_u32_e64 v16, s34, v16
    ds_write_b128 v16, v[64:67]
    v_xor_b32_e64 v17, 32, v16
    ds_write_b128 v17, v[68:71]
    v_xor_b32_e64 v17, 64, v16
    ds_write_b128 v17, v[72:75]
    v_xor_b32 v17, 96, v16
    ds_write_b128 v17, v[76:79]
    v_add_u32 v18, s34, v253
    v_lshrrev_b32 v19, 4, v252
    v_xor_b32 v19, v19, v252
    v_and_b32 v19, 7, v19
    v_lshrrev_b32_e64 v20, 3, v252
    v_lshl_add_u32 v20, s99, 5, v20
    v_lshlrev_b32_e64 v20, 11, v20
    v_lshl_add_u32 v20, v19, 4, v20
    v_xor_b32 v21, 64, v20
    s_waitcnt lgkmcnt(0)
    ds_read_b128 v[24:27], v18 offset:0
    ds_read_b128 v[28:31], v18 offset:1024
    ds_read_b128 v[32:35], v18 offset:2048
    ds_read_b128 v[36:39], v18 offset:3072
    s_ff1_i32_b32 s36, s38
    s_and_b32 s37, s36, 7
    s_lshl_b32 s37, s37, 3
    s_lshl_b64 s[40:41], 0xff, s37
    s_not_b64 s[40:41], s[40:41]
    s_lshr_b32 s36, s36, 3
    s_mov_b32 s37, s33
    s_cmp_eq_u32 s36, 0
    s_cselect_b64 exec, s[40:41], -1
    s_waitcnt lgkmcnt(3)
    buffer_store_dwordx4 v[24:27], v20, s[12:15], s37 offen sc1
    s_add_u32 s37, s37, 16384
    s_cmp_eq_u32 s36, 1
    s_cselect_b64 exec, s[40:41], -1
    s_waitcnt lgkmcnt(2)
    buffer_store_dwordx4 v[28:31], v21, s[12:15], s37 offen sc1
    s_add_u32 s37, s37, 16384
    s_cmp_eq_u32 s36, 2
    s_cselect_b64 exec, s[40:41], -1
    s_waitcnt lgkmcnt(1)
    buffer_store_dwordx4 v[32:35], v20, s[12:15], s37 offen sc1
    s_add_u32 s37, s37, 16384
    s_cmp_eq_u32 s36, 3
    s_cselect_b64 exec, s[40:41], -1
    s_waitcnt lgkmcnt(0)
    buffer_store_dwordx4 v[36:39], v21, s[12:15], s37 offen sc1
    s_mov_b64 exec, -1
    s_cmp_lg_u32 s3, 0
    s_cbranch_scc1 sk_39
    s_mov_b32 s78, s27
pl_40:
    s_add_u32 s32, s79, 0xdc0000
    s_lshr_b32 vcc_lo, s24, 1
    s_mul_i32 vcc_lo, vcc_lo, 2048
    s_add_u32 s32, s32, vcc_lo
    v_lshlrev_b32 v4, 1, v253
    buffer_load_dwordx4 v[0:3], v4, s[20:23], s32 offen sc1
    s_waitcnt vmcnt(0)
pc_41:
    v_max3_u32 v4, v0, v1, v2
    v_max_u32 v4, v4, v3
    v_cmp_eq_u32 vcc, -1, v4
    s_cbranch_vccz pd_42
    s_sub_u32 s78, s78, 1
    s_cmp_lg_u32 s78, 0
    s_cbranch_scc1 pl_40
    s_mov_b32 s27, 1
pd_42:
    v_mov_b32 v4, v0
    s_nop 1
    v_max_f32_dpp v4, v4, v4 quad_perm:[1,0,3,2] row_mask:0xf bank_mask:0xf
    s_nop 1
    v_max_f32_dpp v4, v4, v4 quad_perm:[2,3,0,1] row_mask:0xf bank_mask:0xf
    s_nop 1
    v_max_f32_dpp v4, v4, v4 row_half_mirror row_mask:0xf bank_mask:0xf
    s_nop 1
    v_max_f32_dpp v4, v4, v4 row_mirror row_mask:0xf bank_mask:0xf
    v_mov_b32 v5, v4
    s_nop 1
    v_permlane16_swap_b32 v4, v5
    v_max_f32 v4, v4, v5
    v_mov_b32 v5, v4
    s_nop 1
    v_permlane32_swap_b32 v4, v5
    v_max_f32 v4, v4, v5
    v_cmp_eq_f32 vcc, v4, v0
    s_ff1_i32_b64 s32, vcc
    s_and_b32 s32, s32, 63
    s_lshl_b64 exec, 1, s32
    ds_write_b128 v189, v[0:3] offset:3072
    s_mov_b64 exec, -1
sk_39:
    s_waitcnt lgkmcnt(0)
    s_barrier
    ds_read_b32 v0, v189 offset:3076
    s_waitcnt lgkmcnt(0)
    v_and_b32 v0, 0x7ff, v0
    v_cmp_ne_u32_e64 vcc, v0, v53
    s_and_b64 exec, vcc, s[38:39]
    s_cbranch_execz k_end
    buffer_store_dwordx4 v[64:67], v50, s[12:15], s33 offen offset:0
    buffer_store_dwordx4 v[68:71], v50, s[12:15], s33 offen offset:32
    buffer_store_dwordx4 v[72:75], v50, s[12:15], s33 offen offset:64
    buffer_store_dwordx4 v[76:79], v50, s[12:15], s33 offen offset:96
    s_mov_b64 exec, -1
    s_branch k_end
    s_nop 0
l_start:
    v_lshrrev_b32 v21, 3, v252
    v_lshrrev_b32 v20, 4, v252
    v_xor_b32 v20, v20, v252
    v_and_b32 v20, 7, v20
    v_lshlrev_b32 v20, 4, v20
    v_lshl_add_u32 v4, v21, 11, v20
    v_xor_b32_e64 v5, 64, v4
    v_add_u32 v5, 15360, v5
    v_add_u32 v6, 30720, v4
    v_add_u32 v7, 30720, v5
    s_lshl_b32 s84, s99, 16
    s_lshl_b32 s85, s25, 7
    s_lshl_b32 s86, s28, 12
    s_mul_i32 s87, s28, 6144
    v_and_b32 v20, 4, v21
    v_add_u32_e64 v20, v20, v21
    v_mul_u32_u24 v20, 6144, v20
    v_and_b32 v21, 6, v21
    v_xor_b32 v21, v21, v252
    v_and_b32 v21, 7, v21
    v_lshl_add_u32 v20, v21, 4, v20
    s_mul_i32 s32, s28, 3
    s_bfe_u32 s33, s32, 0x10001
    s_mul_i32 s33, s33, 196608
    s_and_b32 s34, s32, 1
    s_mul_i32 s34, s34, 24576
    s_add_u32 s33, s33, s34
    s_lshr_b32 s34, s32, 2
    s_lshl_b32 s34, s34, 11
    s_add_u32 s33, s33, s34
    v_add_u32 v8, s33, v20
    v_add_u32 v9, 97280, v8
    s_add_u32 s32, s32, 1
    s_bfe_u32 s33, s32, 0x10001
    s_mul_i32 s33, s33, 196608
    s_and_b32 s34, s32, 1
    s_mul_i32 s34, s34, 24576
    s_add_u32 s33, s33, s34
    s_lshr_b32 s34, s32, 2
    s_lshl_b32 s34, s34, 11
    s_add_u32 s33, s33, s34
    s_sub_u32 s33, s33, 2048
    v_add_u32 v10, s33, v20
    v_add_u32 v11, 97280, v10
    s_add_u32 s32, s32, 1
    s_bfe_u32 s33, s32, 0x10001
    s_mul_i32 s33, s33, 196608
    s_and_b32 s34, s32, 1
    s_mul_i32 s34, s34, 24576
    s_add_u32 s33, s33, s34
    s_lshr_b32 s34, s32, 2
    s_lshl_b32 s34, s34, 11
    s_add_u32 s33, s33, s34
    v_add_u32 v12, s33, v20
    v_add_u32 v13, 97280, v12
    s_waitcnt lgkmcnt(0)
    s_mov_b32 s88, 0xdd8000
    s_load_dword s88, s[20:21], s88
    s_mov_b64 s[16:17], s[6:7]
    s_mov_b32 s6, 0x400000
    s_mov_b32 s7, 0x20000
    s_add_u32 s96, s94, 0
    s_and_b32 s96, s96, 15
    s_lshl_b32 s97, s96, 7
    s_add_u32 s97, s97, s84
    s_add_u32 m0, s86, 147456
    s_nop 0
    buffer_load_dwordx4 v4, s[4:7], s97 offen offset:0 lds
    buffer_load_dwordx4 v5, s[4:7], s97 offen offset:1024 lds
    buffer_load_dwordx4 v6, s[4:7], s97 offen offset:2048 lds
    buffer_load_dwordx4 v7, s[4:7], s97 offen offset:3072 lds
    s_add_u32 s96, s94, 0
    s_and_b32 s96, s96, 15
    s_mul_i32 s96, s96, 393216
    s_add_u32 s96, s96, s85
    s_add_u32 m0, s87, 40960
    s_nop 0
    buffer_load_dwordx4 v8, s[16:19], s96 offen offset:0 lds
    buffer_load_dwordx4 v9, s[16:19], s96 offen offset:1024 lds
    buffer_load_dwordx4 v10, s[16:19], s96 offen offset:2048 lds
    buffer_load_dwordx4 v11, s[16:19], s96 offen offset:3072 lds
    s_mov_b32 s40, 0xffffffff
    s_mov_b32 s41, 0xfffffff0
    s_mov_b32 s42, 0xfffffffe
    s_mov_b32 s43, 0xffffffe0
    s_mov_b32 s44, 0xfffffffc
    s_mov_b32 s45, 0xffffffc0
    s_mov_b32 s46, 0xfffffff8
    s_mov_b32 s47, 0xffffff80
    s_mov_b32 s48, 0xffff0000
    s_mov_b32 s49, 0xfff00000
    s_mov_b32 s50, 0xfffe0000
    s_mov_b32 s51, 0xffe00000
    s_mov_b32 s52, 0xfffc0000
    s_mov_b32 s53, 0xffc00000
    s_mov_b32 s54, 0xfff80000
    s_mov_b32 s55, 0xff800000
    s_mov_b32 s56, 0xffffff00
    s_mov_b32 s57, 0xfffff000
    s_mov_b32 s58, 0xfffffe00
    s_mov_b32 s59, 0xffffe000
    s_mov_b32 s60, 0xfffffc00
    s_mov_b32 s61, 0xffffc000
    s_mov_b32 s62, 0xfffff800
    s_mov_b32 s63, 0xffff8000
    s_mov_b32 s64, 0xff000000
    s_mov_b32 s65, 0xf0000000
    s_mov_b32 s66, 0xfe000000
    s_mov_b32 s67, 0xe0000000
    s_mov_b32 s68, 0xfc000000
    s_mov_b32 s69, 0xc0000000
    s_mov_b32 s70, 0xf8000000
    s_mov_b32 s71, 0x80000000
    v_bfe_u32 v20, v252, 3, 2
    v_lshrrev_b32 v21, 5, v252
    v_lshl_add_u32 v20, v21, 3, v20
    s_lshr_b32 s32, s28, 1
    s_lshl_b32 s32, s32, 4
    s_and_b32 s33, s28, 1
    s_lshl_b32 s33, s33, 2
    s_add_u32 s32, s32, s33
    v_add_u32 v20, s32, v20
    v_lshlrev_b32 v20, 11, v20
    v_lshrrev_b32 v21, 2, v252
    v_and_b32 v21, 4, v21
    v_xor_b32 v21, v21, v252
    v_and_b32_e64 v21, 7, v21
    v_lshl_add_u32 v20, v21, 4, v20
    s_lshl_b32 s32, s98, 7
    v_add_u32 v14, s32, v20
    v_lshrrev_b32 v20, 2, v252
    v_lshlrev_b32 v20, 2, v20
    v_bfe_u32 v21, v252, 1, 1
    v_add_u32_e64 v20, v20, v21
    v_mul_u32_u24 v20, 28672, v20
    v_and_b32_e64 v21, 1, v252
    v_lshl_add_u32 v20, v21, 4, v20
    s_mul_i32 s30, s28, 1835008
    s_lshl_b32 s31, s29, 5
    s_add_u32 s30, s30, s31
    v_add_u32 v155, s30, v20
    v_lshlrev_b32 v21, 14, v21
    v_lshrrev_b32_e64 v20, 1, v252
    v_lshl_add_u32 v20, v20, 4, v21
    s_lshl_b32 s30, s28, 9
    s_lshl_b32 s31, s29, 15
    s_add_u32 s30, s30, s31
    v_add_u32 v153, s30, v20
    s_load_dwordx2 s[80:81], s[0:1], 40
    s_cmp_lt_u32 s29, 224
    s_cselect_b32 s82, 0x700000, 0
    s_mov_b32 s83, 0x20000
    s_load_dwordx2 s[12:13], s[0:1], 56
    s_cmp_lt_u32 s29, 224
    s_cselect_b32 s14, 0x700000, 0
    s_mov_b32 s15, 0x20000
    s_mov_b32 s73, -1
    s_mov_b32 s100, 0
    s_sub_u32 s30, s25, s24
    s_add_u32 s30, s30, 31
    v_and_b32 v15, 16, v252
    v_mul_u32_u24 v15, s30, v15
    v_and_b32 v20, 31, v252
    v_add_lshl_u32 v15, v15, v20, 3
    s_lshl_b32 s30, s24, 7
    s_add_u32 s30, s30, 0xdd9000
    v_add_u32_e64 v15, s30, v15
    s_add_u32 m0, s87, 45056
    s_nop 0
    buffer_load_dwordx4 v12, s[16:19], s96 offen offset:0 lds
    buffer_load_dwordx4 v13, s[16:19], s96 offen offset:1024 lds
    s_add_u32 s96, s95, 1
    s_and_b32 s96, s96, 15
    s_lshl_b32 s97, s96, 7
    s_add_u32 s97, s97, s84
    s_add_u32 m0, s86, 131072
    s_nop 0
    buffer_load_dwordx4 v4, s[4:7], s97 offen offset:0 lds
    buffer_load_dwordx4 v5, s[4:7], s97 offen offset:1024 lds
    buffer_load_dwordx4 v6, s[4:7], s97 offen offset:2048 lds
    buffer_load_dwordx4 v7, s[4:7], s97 offen offset:3072 lds
    s_add_u32 s96, s95, 1
    s_and_b32 s96, s96, 15
    s_mul_i32 s96, s96, 393216
    s_add_u32 s96, s96, s85
    s_add_u32 m0, s87, 65536
    s_nop 0
    buffer_load_dwordx4 v8, s[16:19], s96 offen offset:0 lds
    buffer_load_dwordx4 v9, s[16:19], s96 offen offset:1024 lds
    buffer_load_dwordx4 v10, s[16:19], s96 offen offset:2048 lds
    s_waitcnt vmcnt(7) lgkmcnt(0)
    s_add_u32 s88, s88, 0x9e3779b9
    s_barrier
    buffer_load_dwordx4 v11, s[16:19], s96 offen offset:3072 lds
    s_add_u32 m0, s87, 69632
    s_nop 0
    buffer_load_dwordx4 v12, s[16:19], s96 offen offset:0 lds
    buffer_load_dwordx4 v13, s[16:19], s96 offen offset:1024 lds
    s_add_u32 s96, s94, 2
    s_and_b32 s96, s96, 15
    s_lshl_b32 s97, s96, 7
    s_add_u32 s97, s97, s84
    s_add_u32 m0, s86, 114688
    s_nop 0
    buffer_load_dwordx4 v4, s[4:7], s97 offen offset:0 lds
    buffer_load_dwordx4 v5, s[4:7], s97 offen offset:1024 lds
    buffer_load_dwordx4 v6, s[4:7], s97 offen offset:2048 lds
    buffer_load_dwordx4 v7, s[4:7], s97 offen offset:3072 lds
    s_add_u32 s96, s94, 2
    s_and_b32 s96, s96, 15
    s_mul_i32 s96, s96, 393216
    s_add_u32 s96, s96, s85
    s_add_u32 m0, s87, 90112
    s_nop 0
    buffer_load_dwordx4 v8, s[16:19], s96 offen offset:0 lds
    buffer_load_dwordx4 v9, s[16:19], s96 offen offset:1024 lds
    buffer_load_dwordx4 v10, s[16:19], s96 offen offset:2048 lds
    buffer_load_dwordx4 v11, s[16:19], s96 offen offset:3072 lds
    s_add_u32 m0, s87, 94208
    s_nop 0
    buffer_load_dwordx4 v12, s[16:19], s96 offen offset:0 lds
    buffer_load_dwordx4 v13, s[16:19], s96 offen offset:1024 lds
    s_waitcnt vmcnt(10) lgkmcnt(0)
    s_barrier
    s_add_u32 s96, s95, 3
    s_and_b32 s96, s96, 15
    s_lshl_b32 s97, s96, 7
    s_add_u32 s97, s97, s84
    s_add_u32 m0, s86, 147456
    s_nop 0
    buffer_load_dwordx4 v4, s[4:7], s97 offen offset:0 lds
    buffer_load_dwordx4 v5, s[4:7], s97 offen offset:1024 lds
    v_and_b32_e64 v28, 31, v252
    v_bfe_u32 v29, v28, 1, 3
    v_lshrrev_b32 v30, 5, v252
    v_xor_b32 v29, v29, v30
    v_lshlrev_b32_e64 v29, 4, v29
    v_lshl_add_u32 v28, v28, 7, v29
    s_add_u32 s30, s86, 131072
    buffer_load_dwordx4 v6, s[4:7], s97 offen offset:2048 lds
    v_add_u32 v28, s30, v28
    v_xor_b32 v29, 32, v28
    v_xor_b32_e64 v30, 64, v28
    v_xor_b32 v31, 96, v28
    ds_read_b128 v[32:35], v28
    ds_read_b128 v[36:39], v29
    ds_read_b128 v[40:43], v30
    buffer_load_dwordx4 v7, s[4:7], s97 offen offset:3072 lds
    ds_read_b128 v[44:47], v31
    s_min_u32 s30, s28, 2
    s_lshl_b32 s30, s30, 13
    s_add_u32 s30, s30, 65536
    v_lshrrev_b32_e64 v20, 2, v252
    v_bfe_u32 v21, v20, 1, 2
    v_lshlrev_b32_e64 v20, 7, v20
    s_add_u32 s96, s95, 3
    s_and_b32 s96, s96, 15
    s_mul_i32 s96, s96, 393216
    s_add_u32 s96, s96, s85
    s_add_u32 m0, s87, 40960
    s_nop 0
    buffer_load_dwordx4 v8, s[16:19], s96 offen offset:0 lds
    v_lshl_add_u32 v20, v21, 5, v20
    v_and_b32_e64 v21, 3, v252
    v_lshl_add_u32 v20, v21, 3, v20
    v_add_u32 v144, s30, v20
    v_xor_b32 v145, 32, v144
    v_xor_b32_e64 v146, 64, v144
    v_xor_b32 v147, 96, v144
    buffer_load_dwordx4 v9, s[16:19], s96 offen offset:1024 lds
    ds_read_b64_tr_b16 v[100:101], v144 offset:0
    ds_read_b64_tr_b16 v[102:103], v144 offset:2048
    ds_read_b64_tr_b16 v[104:105], v144 offset:4096
    ds_read_b64_tr_b16 v[106:107], v144 offset:6144
    ds_read_b64_tr_b16 v[108:109], v145 offset:0
    ds_read_b64_tr_b16 v[110:111], v145 offset:2048
    ds_read_b64_tr_b16 v[112:113], v145 offset:4096
    buffer_load_dwordx4 v10, s[16:19], s96 offen offset:2048 lds
    ds_read_b64_tr_b16 v[114:115], v145 offset:6144
    ds_read_b64_tr_b16 v[116:117], v146 offset:0
    ds_read_b64_tr_b16 v[118:119], v146 offset:2048
    ds_read_b64_tr_b16 v[120:121], v146 offset:4096
    ds_read_b64_tr_b16 v[122:123], v146 offset:6144
    ds_read_b64_tr_b16 v[124:125], v147 offset:0
    ds_read_b64_tr_b16 v[126:127], v147 offset:2048
    buffer_load_dwordx4 v11, s[16:19], s96 offen offset:3072 lds
    ds_read_b64_tr_b16 v[128:129], v147 offset:4096
    ds_read_b64_tr_b16 v[130:131], v147 offset:6144
    v_mov_b32 v16, -1
    v_mov_b32 v17, -1
    v_mov_b32_e64 v18, -1
    v_mov_b32 v19, -1
    s_lshr_b32 s30, s28, 1
    s_add_u32 m0, s87, 45056
    s_nop 0
    buffer_load_dwordx4 v12, s[16:19], s96 offen offset:0 lds
    s_mul_i32 s30, s30, 16777216
    s_and_b32 s31, s28, 1
    s_lshl_b32 s32, s31, 20
    s_lshl_b32 s33, s72, 10
    s_add_u32 s32, s32, s33
    s_add_u32 s32, s32, s30
    s_add_u32 s32, s32, 0xc00000
    buffer_load_dwordx4 v13, s[16:19], s96 offen offset:1024 lds
    buffer_store_dwordx4 v[16:19], v253, s[20:23], s32 offen sc1
    s_add_u32 s32, s32, 262144
    buffer_store_dwordx4 v[16:19], v253, s[20:23], s32 offen sc1
    s_add_u32 s32, s32, 262144
    buffer_store_dwordx4 v[16:19], v253, s[20:23], s32 offen sc1
    s_add_u32 s32, s32, 262144
    s_lshl_b32 s33, s72, 7
    s_add_u32 s33, s33, s30
    s_add_u32 s33, s33, 0xdc0000
    s_cmp_eq_u32 s31, 0
    s_cselect_b32 s32, s32, s33
    s_cselect_b64 exec, -1, 0xff
    buffer_store_dwordx4 v[16:19], v253, s[20:23], s32 offen sc1
    s_mov_b64 exec, -1
    s_waitcnt vmcnt(14) lgkmcnt(0)
    s_barrier
    s_add_u32 s96, s94, 4
    s_and_b32 s96, s96, 15
    s_lshl_b32 s97, s96, 7
    s_add_u32 s97, s97, s84
    s_add_u32 m0, s86, 131072
    s_nop 0
    buffer_load_dwordx4 v4, s[4:7], s97 offen offset:0 lds
    buffer_load_dwordx4 v5, s[4:7], s97 offen offset:1024 lds
    v_mov_b32_e64 v48, 0
    buffer_load_dwordx4 v6, s[4:7], s97 offen offset:2048 lds
    v_mov_b32_e64 v49, 0
    buffer_load_dwordx4 v7, s[4:7], s97 offen offset:3072 lds
    v_mov_b32_e64 v50, 0
    s_add_u32 s96, s94, 4
    s_and_b32 s96, s96, 15
    s_mul_i32 s96, s96, 393216
    s_add_u32 s96, s96, s85
    s_add_u32 m0, s87, 65536
    s_nop 0
    buffer_load_dwordx4 v8, s[16:19], s96 offen offset:0 lds
    v_mov_b32_e64 v51, 0
    buffer_load_dwordx4 v9, s[16:19], s96 offen offset:1024 lds
    v_mov_b32_e64 v140, 0
    buffer_load_dwordx4 v10, s[16:19], s96 offen offset:2048 lds
    v_mov_b32_e64 v141, 0
    buffer_load_dwordx4 v11, s[16:19], s96 offen offset:3072 lds
    v_mov_b32 v142, 0
    s_add_u32 m0, s87, 69632
    s_nop 0
    buffer_load_dwordx4 v12, s[16:19], s96 offen offset:0 lds
    v_mov_b32_e64 v143, 0
    buffer_load_dwordx4 v13, s[16:19], s96 offen offset:1024 lds
    v_dot2c_f32_bf16 v140, 0x3f803f80, v100
    v_dot2c_f32_bf16 v141, 0x3f803f80, v108
    v_dot2c_f32_bf16 v142, 0x3f803f80, v116
    v_dot2c_f32_bf16 v143, 0x3f803f80, v124
    v_dot2c_f32_bf16 v140, 0x3f803f80, v101
    v_dot2c_f32_bf16 v141, 0x3f803f80, v109
    v_dot2c_f32_bf16 v142, 0x3f803f80, v117
    v_dot2c_f32_bf16 v143, 0x3f803f80, v125
    v_dot2c_f32_bf16 v140, 0x3f803f80, v102
    v_dot2c_f32_bf16 v141, 0x3f803f80, v110
    v_dot2c_f32_bf16 v142, 0x3f803f80, v118
    v_dot2c_f32_bf16 v143, 0x3f803f80, v126
    v_dot2c_f32_bf16 v140, 0x3f803f80, v103
    v_dot2c_f32_bf16 v141, 0x3f803f80, v111
    v_dot2c_f32_bf16 v142, 0x3f803f80, v119
    v_dot2c_f32_bf16 v143, 0x3f803f80, v127
    v_dot2c_f32_bf16 v140, 0x3f803f80, v104
    v_dot2c_f32_bf16 v141, 0x3f803f80, v112
    v_dot2c_f32_bf16 v142, 0x3f803f80, v120
    v_dot2c_f32_bf16 v143, 0x3f803f80, v128
    v_dot2c_f32_bf16 v140, 0x3f803f80, v105
    v_dot2c_f32_bf16 v141, 0x3f803f80, v113
    v_dot2c_f32_bf16 v142, 0x3f803f80, v121
    v_dot2c_f32_bf16 v143, 0x3f803f80, v129
    v_dot2c_f32_bf16 v140, 0x3f803f80, v106
    v_dot2c_f32_bf16 v141, 0x3f803f80, v114
    v_dot2c_f32_bf16 v142, 0x3f803f80, v122
    v_dot2c_f32_bf16 v143, 0x3f803f80, v130
    v_dot2c_f32_bf16 v140, 0x3f803f80, v107
    v_dot2c_f32_bf16 v141, 0x3f803f80, v115
    v_dot2c_f32_bf16 v142, 0x3f803f80, v123
    v_dot2c_f32_bf16 v143, 0x3f803f80, v131
    v_dot2c_f32_bf16 v48, 0x3f803f80, v32
    v_dot2c_f32_bf16 v49, v32, v32
    v_dot2c_f32_bf16 v50, 0x3f803f80, v33
    v_dot2c_f32_bf16 v51, v33, v33
    v_dot2c_f32_bf16 v48, 0x3f803f80, v34
    v_dot2c_f32_bf16 v49, v34, v34
    v_dot2c_f32_bf16 v50, 0x3f803f80, v35
    v_dot2c_f32_bf16 v51, v35, v35
    v_dot2c_f32_bf16 v48, 0x3f803f80, v36
    v_dot2c_f32_bf16 v49, v36, v36
    v_dot2c_f32_bf16 v50, 0x3f803f80, v37
    v_dot2c_f32_bf16 v51, v37, v37
    v_dot2c_f32_bf16 v48, 0x3f803f80, v38
    v_dot2c_f32_bf16 v49, v38, v38
    v_dot2c_f32_bf16 v50, 0x3f803f80, v39
    v_dot2c_f32_bf16 v51, v39, v39
    v_dot2c_f32_bf16 v48, 0x3f803f80, v40
    v_dot2c_f32_bf16 v49, v40, v40
    v_dot2c_f32_bf16 v50, 0x3f803f80, v41
    v_dot2c_f32_bf16 v51, v41, v41
    v_dot2c_f32_bf16 v48, 0x3f803f80, v42
    v_dot2c_f32_bf16 v49, v42, v42
    v_dot2c_f32_bf16 v50, 0x3f803f80, v43
    v_dot2c_f32_bf16 v51, v43, v43
    v_dot2c_f32_bf16 v48, 0x3f803f80, v44
    v_dot2c_f32_bf16 v49, v44, v44
    v_dot2c_f32_bf16 v50, 0x3f803f80, v45
    v_dot2c_f32_bf16 v51, v45, v45
    v_dot2c_f32_bf16 v48, 0x3f803f80, v46
    v_dot2c_f32_bf16 v49, v46, v46
    v_dot2c_f32_bf16 v50, 0x3f803f80, v47
    v_dot2c_f32_bf16 v51, v47, v47
    s_waitcnt vmcnt(14) lgkmcnt(0)
    s_barrier
    s_add_u32 s96, s95, 5
    s_and_b32 s96, s96, 15
    s_lshl_b32 s97, s96, 7
    s_add_u32 s97, s97, s84
    s_add_u32 m0, s86, 114688
    s_nop 0
    buffer_load_dwordx4 v4, s[4:7], s97 offen offset:0 lds
    buffer_load_dwordx4 v5, s[4:7], s97 offen offset:1024 lds
    s_lshl_b32 s30, s99, 12
    s_lshl_b32 s31, s25, 8
    buffer_load_dwordx4 v6, s[4:7], s97 offen offset:2048 lds
    s_add_u32 s30, s30, s31
    s_add_u32 s30, s30, 0x2400000
    buffer_load_dwordx4 v7, s[4:7], s97 offen offset:3072 lds
    v_lshlrev_b32_e64 v28, 3, v252
    s_add_u32 s96, s95, 5
    s_and_b32 s96, s96, 15
    s_mul_i32 s96, s96, 393216
    s_add_u32 s96, s96, s85
    s_add_u32 m0, s87, 90112
    s_nop 0
    buffer_load_dwordx4 v8, s[16:19], s96 offen offset:0 lds
    v_add_f32 v48, v48, v50
    v_add_f32 v49, v49, v51
    buffer_load_dwordx4 v9, s[16:19], s96 offen offset:1024 lds
    v_mov_b32 v50, v48
    v_mov_b32 v51, v49
    buffer_load_dwordx4 v10, s[16:19], s96 offen offset:2048 lds
    v_permlane32_swap_b32_e64 v48, v50
    buffer_load_dwordx4 v11, s[16:19], s96 offen offset:3072 lds
    v_permlane32_swap_b32 v49, v51
    v_add_f32 v48, v48, v50
    s_add_u32 m0, s87, 94208
    s_nop 0
    buffer_load_dwordx4 v12, s[16:19], s96 offen offset:0 lds
    v_add_f32 v49, v49, v51
    buffer_load_dwordx4 v13, s[16:19], s96 offen offset:1024 lds
    s_mov_b32 exec_hi, 0
    buffer_store_dwordx2 v[48:49], v28, s[20:23], s30 offen sc1
    s_mov_b64 exec, -1
    s_min_u32 s32, s28, 2
    s_lshl_b32 s32, s32, 12
    s_lshl_b32 s33, s25, 14
    s_add_u32 s32, s32, s33
    s_add_u32 s32, s32, 0x2500000
    s_lshl_b32 s33, s24, 8
    s_add_u32 s32, s32, s33
    v_lshlrev_b32 v20, 2, v252
    v_permlane32_swap_b32 v140, v142
    v_permlane32_swap_b32 v141, v143
    v_add_f32 v140, v140, v142
    v_add_f32 v141, v141, v143
    s_nop 1
    v_permlane16_swap_b32_e64 v140, v141
    v_add_f32 v140, v140, v141
    buffer_store_dword v140, v20, s[20:23], s32 offen sc1
    s_waitcnt vmcnt(12) lgkmcnt(0)
    s_barrier
    s_add_u32 s96, s94, 6
    s_and_b32 s96, s96, 15
    s_lshl_b32 s97, s96, 7
    s_add_u32 s97, s97, s84
    s_add_u32 m0, s86, 147456
    s_nop 0
    buffer_load_dwordx4 v4, s[4:7], s97 offen offset:0 lds
    buffer_load_dwordx4 v5, s[4:7], s97 offen offset:1024 lds
    buffer_load_dwordx4 v6, s[4:7], s97 offen offset:2048 lds
    buffer_load_dwordx4 v7, s[4:7], s97 offen offset:3072 lds
    s_add_u32 s96, s94, 6
    s_and_b32 s96, s96, 15
    s_mul_i32 s96, s96, 393216
    s_add_u32 s96, s96, s85
    s_add_u32 m0, s87, 40960
    s_nop 0
    buffer_load_dwordx4 v8, s[16:19], s96 offen offset:0 lds
    buffer_load_dwordx4 v9, s[16:19], s96 offen offset:1024 lds
    buffer_load_dwordx4 v10, s[16:19], s96 offen offset:2048 lds
    buffer_load_dwordx4 v11, s[16:19], s96 offen offset:3072 lds
    s_add_u32 m0, s87, 45056
    s_nop 0
    buffer_load_dwordx4 v12, s[16:19], s96 offen offset:0 lds
    buffer_load_dwordx4 v13, s[16:19], s96 offen offset:1024 lds
    s_waitcnt vmcnt(10) lgkmcnt(0)
    s_barrier
    s_add_u32 s96, s95, 7
    s_and_b32 s96, s96, 15
    s_lshl_b32 s97, s96, 7
    s_add_u32 s97, s97, s84
    s_add_u32 m0, s86, 131072
    s_nop 0
    buffer_load_dwordx4 v4, s[4:7], s97 offen offset:0 lds
    buffer_load_dwordx4 v5, s[4:7], s97 offen offset:1024 lds
    buffer_load_dwordx4 v6, s[4:7], s97 offen offset:2048 lds
    buffer_load_dwordx4 v7, s[4:7], s97 offen offset:3072 lds
    s_add_u32 s96, s95, 7
    s_and_b32 s96, s96, 15
    s_mul_i32 s96, s96, 393216
    s_add_u32 s96, s96, s85
    s_add_u32 m0, s87, 65536
    s_nop 0
    buffer_load_dwordx4 v8, s[16:19], s96 offen offset:0 lds
    buffer_load_dwordx4 v9, s[16:19], s96 offen offset:1024 lds
    buffer_load_dwordx4 v10, s[16:19], s96 offen offset:2048 lds
    buffer_load_dwordx4 v11, s[16:19], s96 offen offset:3072 lds
    s_add_u32 m0, s87, 69632
    s_nop 0
    buffer_load_dwordx4 v12, s[16:19], s96 offen offset:0 lds
    buffer_load_dwordx4 v13, s[16:19], s96 offen offset:1024 lds
    s_waitcnt vmcnt(10) lgkmcnt(0)
    s_barrier
    s_add_u32 s96, s94, 8
    s_and_b32 s96, s96, 15
    s_lshl_b32 s97, s96, 7
    s_add_u32 s97, s97, s84
    s_add_u32 m0, s86, 114688
    s_nop 0
    buffer_load_dwordx4 v4, s[4:7], s97 offen offset:0 lds
    buffer_load_dwordx4 v5, s[4:7], s97 offen offset:1024 lds
    buffer_load_dwordx4 v6, s[4:7], s97 offen offset:2048 lds
    buffer_load_dwordx4 v7, s[4:7], s97 offen offset:3072 lds
    s_add_u32 s96, s94, 8
    s_and_b32 s96, s96, 15
    s_mul_i32 s96, s96, 393216
    s_add_u32 s96, s96, s85
    s_add_u32 m0, s87, 90112
    s_nop 0
    buffer_load_dwordx4 v8, s[16:19], s96 offen offset:0 lds
    buffer_load_dwordx4 v9, s[16:19], s96 offen offset:1024 lds
    buffer_load_dwordx4 v10, s[16:19], s96 offen offset:2048 lds
    buffer_load_dwordx4 v11, s[16:19], s96 offen offset:3072 lds
    s_add_u32 m0, s87, 94208
    s_nop 0
    buffer_load_dwordx4 v12, s[16:19], s96 offen offset:0 lds
    buffer_load_dwordx4 v13, s[16:19], s96 offen offset:1024 lds
    s_waitcnt vmcnt(10) lgkmcnt(0)
    s_barrier
    s_add_u32 s96, s95, 9
    s_and_b32 s96, s96, 15
    s_lshl_b32 s97, s96, 7
    s_add_u32 s97, s97, s84
    s_add_u32 m0, s86, 147456
    s_nop 0
    buffer_load_dwordx4 v4, s[4:7], s97 offen offset:0 lds
    buffer_load_dwordx4 v5, s[4:7], s97 offen offset:1024 lds
    buffer_load_dwordx4 v6, s[4:7], s97 offen offset:2048 lds
    buffer_load_dwordx4 v7, s[4:7], s97 offen offset:3072 lds
    s_add_u32 s96, s95, 9
    s_and_b32 s96, s96, 15
    s_mul_i32 s96, s96, 393216
    s_add_u32 s96, s96, s85
    s_add_u32 m0, s87, 40960
    s_nop 0
    buffer_load_dwordx4 v8, s[16:19], s96 offen offset:0 lds
    buffer_load_dwordx4 v9, s[16:19], s96 offen offset:1024 lds
    buffer_load_dwordx4 v10, s[16:19], s96 offen offset:2048 lds
    buffer_load_dwordx4 v11, s[16:19], s96 offen offset:3072 lds
    s_add_u32 m0, s87, 45056
    s_nop 0
    buffer_load_dwordx4 v12, s[16:19], s96 offen offset:0 lds
    buffer_load_dwordx4 v13, s[16:19], s96 offen offset:1024 lds
    s_waitcnt vmcnt(10) lgkmcnt(0)
    s_barrier
    s_add_u32 s96, s94, 10
    s_and_b32 s96, s96, 15
    s_lshl_b32 s97, s96, 7
    s_add_u32 s97, s97, s84
    s_add_u32 m0, s86, 131072
    s_nop 0
    buffer_load_dwordx4 v4, s[4:7], s97 offen offset:0 lds
    buffer_load_dwordx4 v5, s[4:7], s97 offen offset:1024 lds
    buffer_load_dwordx4 v6, s[4:7], s97 offen offset:2048 lds
    buffer_load_dwordx4 v7, s[4:7], s97 offen offset:3072 lds
    s_add_u32 s96, s94, 10
    s_and_b32 s96, s96, 15
    s_mul_i32 s96, s96, 393216
    s_add_u32 s96, s96, s85
    s_add_u32 m0, s87, 65536
    s_nop 0
    buffer_load_dwordx4 v8, s[16:19], s96 offen offset:0 lds
    buffer_load_dwordx4 v9, s[16:19], s96 offen offset:1024 lds
    buffer_load_dwordx4 v10, s[16:19], s96 offen offset:2048 lds
    buffer_load_dwordx4 v11, s[16:19], s96 offen offset:3072 lds
    s_add_u32 m0, s87, 69632
    s_nop 0
    buffer_load_dwordx4 v12, s[16:19], s96 offen offset:0 lds
    buffer_load_dwordx4 v13, s[16:19], s96 offen offset:1024 lds
    s_waitcnt vmcnt(10) lgkmcnt(0)
    s_barrier
    s_add_u32 s96, s95, 11
    s_and_b32 s96, s96, 15
    s_lshl_b32 s97, s96, 7
    s_add_u32 s97, s97, s84
    s_add_u32 m0, s86, 114688
    s_nop 0
    buffer_load_dwordx4 v4, s[4:7], s97 offen offset:0 lds
    buffer_load_dwordx4 v5, s[4:7], s97 offen offset:1024 lds
    buffer_load_dwordx4 v6, s[4:7], s97 offen offset:2048 lds
    buffer_load_dwordx4 v7, s[4:7], s97 offen offset:3072 lds
    s_add_u32 s96, s95, 11
    s_and_b32 s96, s96, 15
    s_mul_i32 s96, s96, 393216
    s_add_u32 s96, s96, s85
    s_add_u32 m0, s87, 90112
    s_nop 0
    buffer_load_dwordx4 v8, s[16:19], s96 offen offset:0 lds
    buffer_load_dwordx4 v9, s[16:19], s96 offen offset:1024 lds
    buffer_load_dwordx4 v10, s[16:19], s96 offen offset:2048 lds
    buffer_load_dwordx4 v11, s[16:19], s96 offen offset:3072 lds
    s_add_u32 m0, s87, 94208
    s_nop 0
    buffer_load_dwordx4 v12, s[16:19], s96 offen offset:0 lds
    buffer_load_dwordx4 v13, s[16:19], s96 offen offset:1024 lds
    s_waitcnt vmcnt(10) lgkmcnt(0)
    s_barrier
    s_add_u32 s96, s94, 12
    s_and_b32 s96, s96, 15
    s_lshl_b32 s97, s96, 7
    s_add_u32 s97, s97, s84
    s_add_u32 m0, s86, 147456
    s_nop 0
    buffer_load_dwordx4 v4, s[4:7], s97 offen offset:0 lds
    buffer_load_dwordx4 v5, s[4:7], s97 offen offset:1024 lds
    s_getpc_b64 s[32:33]
pc_43:
    buffer_load_dwordx4 v6, s[4:7], s97 offen offset:2048 lds
    s_sub_u32 s32, s32, pc_43-interleave_layers__sliding_block__moe_arch_mod__prompt_kernel
    s_subb_u32 s33, s33, 0
    buffer_load_dwordx4 v7, s[4:7], s97 offen offset:3072 lds
    s_lshr_b32 s34, s2, 3
    s_add_u32 s96, s94, 12
    s_and_b32 s96, s96, 15
    s_mul_i32 s96, s96, 393216
    s_add_u32 s96, s96, s85
    s_add_u32 m0, s87, 40960
    s_nop 0
    buffer_load_dwordx4 v8, s[16:19], s96 offen offset:0 lds
    s_lshl_b32 s34, s34, 2
    buffer_load_dwordx4 v9, s[16:19], s96 offen offset:1024 lds
    s_add_u32 s34, s34, s28
    s_and_b32 s34, s34, 127
    buffer_load_dwordx4 v10, s[16:19], s96 offen offset:2048 lds
    s_lshl_b32 s34, s34, 7
    buffer_load_dwordx4 v11, s[16:19], s96 offen offset:3072 lds
    v_lshl_add_u32 v154, v252, 14, s34
    s_mov_b32 s34, k_exit-interleave_layers__sliding_block__moe_arch_mod__prompt_kernel
    s_add_u32 m0, s87, 45056
    s_nop 0
    buffer_load_dwordx4 v12, s[16:19], s96 offen offset:0 lds
    s_mov_b32 s35, 0x20000
    buffer_load_dwordx4 v13, s[16:19], s96 offen offset:1024 lds
    buffer_load_dword v154, v154, s[32:35], 0 offen
    s_waitcnt vmcnt(11) lgkmcnt(0)
    s_barrier
    buffer_load_dwordx2 v[16:17], v15, s[20:23], 0 offen sc1
    s_add_u32 s96, s95, 13
    s_and_b32 s96, s96, 15
    s_lshl_b32 s97, s96, 7
    s_add_u32 s97, s97, s84
    s_add_u32 m0, s86, 131072
    s_nop 0
    buffer_load_dwordx4 v4, s[4:7], s97 offen offset:0 lds
    buffer_load_dwordx4 v5, s[4:7], s97 offen offset:1024 lds
    buffer_load_dwordx4 v6, s[4:7], s97 offen offset:2048 lds
    buffer_load_dwordx4 v7, s[4:7], s97 offen offset:3072 lds
    s_add_u32 s96, s95, 13
    s_and_b32 s96, s96, 15
    s_mul_i32 s96, s96, 393216
    s_add_u32 s96, s96, s85
    s_add_u32 m0, s87, 65536
    s_nop 0
    buffer_load_dwordx4 v8, s[16:19], s96 offen offset:0 lds
    buffer_load_dwordx4 v9, s[16:19], s96 offen offset:1024 lds
    buffer_load_dwordx4 v10, s[16:19], s96 offen offset:2048 lds
    buffer_load_dwordx4 v11, s[16:19], s96 offen offset:3072 lds
    s_add_u32 m0, s87, 69632
    s_nop 0
    buffer_load_dwordx4 v12, s[16:19], s96 offen offset:0 lds
    buffer_load_dwordx4 v13, s[16:19], s96 offen offset:1024 lds
    s_waitcnt vmcnt(12) lgkmcnt(0)
    s_barrier
    s_add_u32 s96, s94, 14
    s_and_b32 s96, s96, 15
    s_lshl_b32 s97, s96, 7
    s_add_u32 s97, s97, s84
    s_add_u32 m0, s86, 114688
    s_nop 0
    buffer_load_dwordx4 v4, s[4:7], s97 offen offset:0 lds
    buffer_load_dwordx4 v5, s[4:7], s97 offen offset:1024 lds
    buffer_load_dwordx4 v6, s[4:7], s97 offen offset:2048 lds
    buffer_load_dwordx4 v7, s[4:7], s97 offen offset:3072 lds
    s_add_u32 s96, s94, 14
    s_and_b32 s96, s96, 15
    s_mul_i32 s96, s96, 393216
    s_add_u32 s96, s96, s85
    s_add_u32 m0, s87, 90112
    s_nop 0
    buffer_load_dwordx4 v8, s[16:19], s96 offen offset:0 lds
    buffer_load_dwordx4 v9, s[16:19], s96 offen offset:1024 lds
    buffer_load_dwordx4 v10, s[16:19], s96 offen offset:2048 lds
    buffer_load_dwordx4 v11, s[16:19], s96 offen offset:3072 lds
    s_add_u32 m0, s87, 94208
    s_nop 0
    buffer_load_dwordx4 v12, s[16:19], s96 offen offset:0 lds
    buffer_load_dwordx4 v13, s[16:19], s96 offen offset:1024 lds
    s_mov_b32 s78, s27
    s_waitcnt vmcnt(20)
    s_branch pc_45
pl_44:
    buffer_load_dwordx2 v[16:17], v15, s[20:23], 0 offen sc1
    s_waitcnt vmcnt(0)
pc_45:
    v_cmp_ne_u32 vcc, s88, v16
    s_cbranch_vccz pd_46
    s_sub_u32 s78, s78, 1
    s_cmp_lg_u32 s78, 0
    s_cbranch_scc1 pl_44
    s_mov_b32 s27, 1
pd_46:
    s_getreg_b32 s30, hwreg(HW_REG_XCC_ID, 0, 4)
    v_cmp_ne_u32_e64 vcc, s30, v17
    s_and_b32 s30, vcc_lo, 0xffff
    s_cselect_b32 s77, 0, 1
    v_mov_b32 v20, s73
    v_mov_b32_e64 v21, s77
    v_mov_b32 v19, 0
    ds_write_b64 v19, v[20:21] offset:3072
    s_waitcnt vmcnt(10) lgkmcnt(0)
    s_barrier
    s_add_u32 s96, s95, 15
    s_and_b32 s96, s96, 15
    s_lshl_b32 s97, s96, 7
    s_add_u32 s97, s97, s84
    s_add_u32 m0, s86, 147456
    s_nop 0
    buffer_load_dwordx4 v4, s[4:7], s97 offen offset:0 lds
    buffer_load_dwordx4 v5, s[4:7], s97 offen offset:1024 lds
    buffer_load_dwordx4 v6, s[4:7], s97 offen offset:2048 lds
    buffer_load_dwordx4 v7, s[4:7], s97 offen offset:3072 lds
    s_add_u32 s96, s95, 15
    s_and_b32 s96, s96, 15
    s_mul_i32 s96, s96, 393216
    s_add_u32 s96, s96, s85
    s_add_u32 m0, s87, 40960
    s_nop 0
    buffer_load_dwordx4 v8, s[16:19], s96 offen offset:0 lds
    buffer_load_dwordx4 v9, s[16:19], s96 offen offset:1024 lds
    buffer_load_dwordx4 v10, s[16:19], s96 offen offset:2048 lds
    buffer_load_dwordx4 v11, s[16:19], s96 offen offset:3072 lds
    s_add_u32 m0, s87, 45056
    s_nop 0
    buffer_load_dwordx4 v12, s[16:19], s96 offen offset:0 lds
    buffer_load_dwordx4 v13, s[16:19], s96 offen offset:1024 lds
    s_waitcnt vmcnt(10) lgkmcnt(0)
    s_barrier
    s_load_dwordx2 s[4:5], s[0:1], 48
    s_cmp_lt_u32 s29, 224
    s_cselect_b32 s6, 0x700000, 0
    s_mov_b32 s7, 0x20000
    s_lshl_b32 s30, s99, 12
    s_add_u32 s30, s30, 0x2400000
    buffer_load_dwordx4 v[64:67], v253, s[20:23], s30 offen offset:0 sc1
    buffer_load_dwordx4 v[68:71], v253, s[20:23], s30 offen offset:1024 sc1
    buffer_load_dwordx4 v[72:75], v253, s[20:23], s30 offen offset:2048 sc1
    buffer_load_dwordx4 v[76:79], v253, s[20:23], s30 offen offset:3072 sc1
    s_min_u32 s32, s28, 2
    s_lshl_b32 s32, s32, 12
    s_lshl_b32 s33, s25, 14
    s_add_u32 s32, s32, s33
    s_add_u32 s32, s32, 0x2500000
    buffer_load_dwordx4 v[32:35], v253, s[20:23], s32 offen offset:0 sc1
    buffer_load_dwordx4 v[36:39], v253, s[20:23], s32 offen offset:1024 sc1
    buffer_load_dwordx4 v[40:43], v253, s[20:23], s32 offen offset:2048 sc1
    buffer_load_dwordx4 v[44:47], v253, s[20:23], s32 offen offset:3072 sc1
    s_add_u32 s96, s25, 1
    s_and_b32 s96, s96, 15
    s_lshl_b32 s96, s96, 17
    s_add_u32 m0, s101, 4096
    s_nop 0
    buffer_load_dwordx4 v14, s[8:11], s96 offen lds
    s_add_u32 s96, s25, 2
    s_and_b32 s96, s96, 15
    s_lshl_b32 s96, s96, 17
    s_add_u32 m0, s101, 8192
    s_nop 0
    buffer_load_dwordx4 v14, s[8:11], s96 offen lds
    s_add_u32 s96, s25, 3
    s_and_b32 s96, s96, 15
    s_lshl_b32 s96, s96, 17
    s_add_u32 m0, s101, 12288
    s_nop 0
    buffer_load_dwordx4 v14, s[8:11], s96 offen lds
    s_waitcnt vmcnt(11) lgkmcnt(0)
    s_barrier
    s_waitcnt vmcnt(3)
    v_add_f32 v64, v64, v68
    v_add_f32 v65, v65, v69
    v_add_f32 v66, v66, v70
    v_add_f32 v67, v67, v71
    v_add_f32 v64, v64, v72
    v_add_f32 v65, v65, v73
    v_add_f32 v66, v66, v74
    v_add_f32 v67, v67, v75
    v_add_f32 v64, v64, v76
    v_add_f32 v65, v65, v77
    v_add_f32 v66, v66, v78
    v_add_f32 v67, v67, v79
    s_nop 0
    v_permlane32_swap_b32 v64, v66
    v_permlane32_swap_b32 v65, v67
    v_add_f32 v64, v64, v66
    v_add_f32 v65, v65, v67
    v_mov_b32 v48, v64
    v_mov_b32 v49, v65
    s_nop 0
    v_permlane16_swap_b32 v64, v48
    v_permlane16_swap_b32 v65, v49
    v_add_f32 v64, v64, v48
    v_add_f32_e64 v65, v65, v49
    v_mul_f32 v54, 0x3a800000, v64
    v_mul_f32 v65, 0x3a800000, v65
    v_fma_f32 v65, -v54, v54, v65
    v_max_f32_e64 v65, 0, v65
    v_add_f32 v55, 0x3727c5ac, v65
    v_rsq_f32 v55, v55
    v_add_f32 v32, v32, v36
    v_add_f32 v33, v33, v37
    v_add_f32 v34, v34, v38
    v_add_f32 v35, v35, v39
    v_add_f32 v32, v32, v40
    v_add_f32 v33, v33, v41
    v_add_f32 v34, v34, v42
    v_add_f32 v35, v35, v43
    v_add_f32 v32, v32, v44
    v_add_f32 v33, v33, v45
    v_add_f32 v34, v34, v46
    v_add_f32 v35, v35, v47
    s_nop 0
    v_permlane32_swap_b32 v32, v34
    v_permlane32_swap_b32 v33, v35
    v_add_f32 v32, v32, v34
    v_add_f32 v33, v33, v35
    s_nop 1
    v_permlane16_swap_b32 v32, v33
    v_add_f32 v32, v32, v33
    v_mov_b32 v2, v32
    v_and_b32 v48, 15, v252
    v_lshrrev_b32 v49, 5, v252
    v_lshl_add_u32 v48, v48, 1, v49
    v_bfe_u32 v49, v252, 4, 1
    v_cmp_eq_u32 vcc, 0, v49
    v_lshlrev_b32 v49, 9, v49
    v_lshl_add_u32 v48, v48, 2, v49
    s_lshl_b32 s32, s28, 7
    v_add_u32 v48, s32, v48
    v_cndmask_b32_e64 v49, v54, v55, vcc
    v_cndmask_b32 v50, 0, 1.0, vcc
    ds_write_b32 v48, v49 offset:0
    ds_write_b32 v48, v50 offset:2048
    v_and_b32 v48, 15, v252
    v_lshrrev_b32 v51, 4, v252
    v_lshl_add_u32 v48, v48, 2, v51
    s_min_u32 s32, s28, 2
    s_lshl_b32 s32, s32, 8
    v_lshl_add_u32 v48, v48, 2, s32
    ds_write_b32 v48, v2 offset:1024
    s_waitcnt lgkmcnt(0)
    s_barrier
l_att:
    s_add_u32 s96, s25, 10
    s_and_b32 s96, s96, 15
    s_lshl_b32 s96, s96, 17
    s_add_u32 m0, s101, 40960
    s_nop 0
    buffer_load_dwordx4 v14, s[8:11], s96 offen lds
    s_add_u32 s96, s25, 11
    s_and_b32 s96, s96, 15
    s_lshl_b32 s96, s96, 17
    s_add_u32 m0, s101, 45056
    s_nop 0
    buffer_load_dwordx4 v14, s[8:11], s96 offen lds
    s_cmp_lg_u32 s26, 0
    s_cbranch_scc1 sk_47
    s_add_u32 s96, s25, 4
    s_and_b32 s96, s96, 15
    s_lshl_b32 s96, s96, 17
    s_add_u32 m0, s101, 16384
    s_nop 0
    buffer_load_dwordx4 v14, s[8:11], s96 offen lds
    s_add_u32 s96, s25, 5
    s_and_b32 s96, s96, 15
    s_lshl_b32 s96, s96, 17
    s_add_u32 m0, s101, 20480
    s_nop 0
    buffer_load_dwordx4 v14, s[8:11], s96 offen lds
    s_add_u32 s96, s25, 6
    s_and_b32 s96, s96, 15
    s_lshl_b32 s96, s96, 17
    s_add_u32 m0, s101, 24576
    s_nop 0
    buffer_load_dwordx4 v14, s[8:11], s96 offen lds
    s_add_u32 s96, s25, 7
    s_and_b32 s96, s96, 15
    s_lshl_b32 s96, s96, 17
    s_add_u32 m0, s101, 28672
    s_nop 0
    buffer_load_dwordx4 v14, s[8:11], s96 offen lds
    s_add_u32 s96, s25, 8
    s_and_b32 s96, s96, 15
    s_lshl_b32 s96, s96, 17
    s_add_u32 m0, s101, 32768
    s_nop 0
    buffer_load_dwordx4 v14, s[8:11], s96 offen lds
    s_add_u32 s96, s25, 9
    s_and_b32 s96, s96, 15
    s_lshl_b32 s96, s96, 17
    s_add_u32 m0, s101, 36864
    s_nop 0
    buffer_load_dwordx4 v14, s[8:11], s96 offen lds
sk_47:
    v_mov_b32 v20, 0xffff
    v_mov_b32 v21, 0xffff0000
    v_cndmask_b32 v22, 0, v20, s[40:41]
    v_cndmask_b32 v23, 0, v21, s[42:43]
    v_or_b32_e64 v12, v22, v23
    v_cndmask_b32 v22, 0, v20, s[44:45]
    v_cndmask_b32 v23, 0, v21, s[46:47]
    v_or_b32_e64 v13, v22, v23
    v_cndmask_b32 v22, 0, v20, s[48:49]
    v_cndmask_b32 v23, 0, v21, s[50:51]
    v_or_b32_e64 v14, v22, v23
    v_cndmask_b32 v22, 0, v20, s[52:53]
    v_cndmask_b32 v23, 0, v21, s[54:55]
    v_or_b32_e64 v15, v22, v23
    v_cndmask_b32 v22, 0, v20, s[56:57]
    v_cndmask_b32 v23, 0, v21, s[58:59]
    v_or_b32_e64 v16, v22, v23
    v_cndmask_b32 v22, 0, v20, s[60:61]
    v_cndmask_b32 v23, 0, v21, s[62:63]
    v_or_b32_e64 v17, v22, v23
    v_cndmask_b32 v22, 0, v20, s[64:65]
    v_cndmask_b32 v23, 0, v21, s[66:67]
    v_or_b32_e64 v18, v22, v23
    v_cndmask_b32 v22, 0, v20, s[68:69]
    v_cndmask_b32 v23, 0, v21, s[70:71]
    v_or_b32 v19, v22, v23
    s_xor_b32 s76, s99, 3
    s_and_b32 s34, s76, 3
    s_lshl_b32 s33, s34, 12
    s_add_u32 s33, s33, 114688
    v_add_u32_e64 v20, s33, v253
    v_add_u32 v22, 32768, v20
    v_add_u32 v23, 143360, v253
    s_add_u32 s74, s34, 1
    s_mov_b32 s75, 0
    s_lshl_b32 s34, s34, 11
    s_add_u32 s34, s34, 57344
    v_add_u32 v3, s34, v253
    v_mov_b32 v21, 0xf149f2ca
    v_cndmask_b32 v24, v21, 0, s[40:41]
    v_cndmask_b32 v25, v21, 0, s[42:43]
    v_cndmask_b32 v26, v21, 0, s[44:45]
    v_cndmask_b32 v27, v21, 0, s[46:47]
    v_cndmask_b32 v28, v21, 0, s[48:49]
    v_cndmask_b32 v29, v21, 0, s[50:51]
    v_cndmask_b32 v30, v21, 0, s[52:53]
    v_cndmask_b32 v31, v21, 0, s[54:55]
    v_cndmask_b32 v32, v21, 0, s[56:57]
    v_cndmask_b32 v33, v21, 0, s[58:59]
    v_cndmask_b32 v34, v21, 0, s[60:61]
    v_cndmask_b32 v35, v21, 0, s[62:63]
    v_cndmask_b32 v36, v21, 0, s[64:65]
    v_cndmask_b32 v37, v21, 0, s[66:67]
    v_cndmask_b32 v38, v21, 0, s[68:69]
    v_cndmask_b32 v39, v21, 0, s[70:71]
    v_lshrrev_b32 v40, 2, v252
    v_xor_b32 v40, v40, v252
    v_bfe_u32 v40, v40, 2, 1
    v_add_u32_e64 v40, -1, v40
    v_and_b32 v40, 0x3f803f80, v40
    v_mov_b32 v41, v40
    v_mov_b32 v42, v40
    v_mov_b32 v43, v40
    v_mov_b32 v44, 0
    v_mov_b32 v45, 0
    v_mov_b32 v46, 0
    v_mov_b32 v47, 0
    v_mov_b32 v88, 0
    v_mov_b32 v89, 0
    v_mov_b32 v90, 0
    v_mov_b32 v91, 0
    v_mov_b32 v92, 0
    v_mov_b32 v93, 0
    v_mov_b32 v94, 0
    v_mov_b32 v95, 0
    v_mov_b32 v96, 0
    v_mov_b32 v97, 0
    v_mov_b32 v98, 0
    v_mov_b32 v99, 0
    v_mov_b32 v100, 0
    v_mov_b32 v101, 0
    v_mov_b32 v102, 0
    v_mov_b32 v103, 0
    s_cmp_eq_u32 s100, 2
    s_cbranch_scc1 sk_48
    s_barrier
sk_48:
    s_cmp_gt_u32 s100, 1
    s_cbranch_scc1 l_patch
l_patched:
l_nohalo:
    ds_read_b128 v[4:7], v3
    ds_read_b128 v[8:11], v3 offset:1024
    ds_read_b128 v[112:115], v22 offset:0
    ds_read_b128 v[116:119], v22 offset:1024
    s_waitcnt lgkmcnt(0)
    v_mfma_f32_32x32x16_bf16 v[56:71], v[112:115], v[4:7], v[24:39]
    v_mfma_f32_32x32x16_bf16 v[56:71], v[116:119], v[8:11], v[56:71]
    ds_read_b128 v[104:107], v23 offset:4096
    ds_read_b128 v[124:127], v22 offset:3072
    ds_read_b128 v[108:111], v23 offset:5120
    ds_read_b128 v[120:123], v22 offset:2048
    s_cmp_lg_u32 s26, 0
    s_cbranch_scc1 sk_50
    s_xor_b32 s96, s29, 0
    s_and_b32 s97, s96, 2
    s_and_b32 s96, s96, 3
    s_mul_i32 s97, s97, 14336
    s_mul_i32 s96, s96, 14336
    s_add_u32 s96, s96, s97
    buffer_load_dwordx4 v[156:159], v155, s[80:83], s96 offen
    s_xor_b32 s96, s29, 0
    s_and_b32 s97, s96, 2
    s_and_b32 s96, s96, 3
    s_mul_i32 s97, s97, 14336
    s_mul_i32 s96, s96, 14336
    s_add_u32 s96, s96, s97
    s_add_u32 s96, s96, 7168
    buffer_load_dwordx4 v[160:163], v155, s[80:83], s96 offen
    s_xor_b32 s96, s29, 1
    s_and_b32 s97, s96, 2
    s_and_b32 s96, s96, 3
    s_mul_i32 s97, s97, 14336
    s_mul_i32 s96, s96, 14336
    s_add_u32 s96, s96, s97
    buffer_load_dwordx4 v[164:167], v155, s[80:83], s96 offen
sk_50:
    s_nop 5
    v_max3_f32 v21, v56, v57, v58
    v_max3_f32 v152, v59, v60, v61
    v_max3_f32 v21, v21, v62, v63
    v_max3_f32 v152, v152, v64, v65
    v_max3_f32 v21, v21, v66, v67
    v_max3_f32 v152, v152, v68, v69
    v_max3_f32 v21, v21, v70, v71
    v_max_f32 v21, v21, v152
    v_mov_b32 v152, v21
    s_nop 1
    v_permlane32_swap_b32 v21, v152
    v_max_f32 v21, v21, v152
    v_sub_f32 v24, 0, v21
    v_sub_f32 v25, 0, v21
    v_sub_f32 v26, 0, v21
    v_sub_f32 v27, 0, v21
    v_sub_f32 v28, 0, v21
    v_sub_f32 v29, 0, v21
    v_sub_f32 v30, 0, v21
    v_sub_f32 v31, 0, v21
    v_sub_f32 v32, 0, v21
    v_sub_f32 v33, 0, v21
    v_sub_f32 v34, 0, v21
    v_sub_f32 v35, 0, v21
    v_sub_f32 v36, 0, v21
    v_sub_f32 v37, 0, v21
    v_sub_f32 v38, 0, v21
    v_sub_f32 v39, 0, v21
    s_branch a1_49_go
    s_nop 0
a1_49_mid:
    s_cmp_ge_u32 s76, 8
    s_cselect_b32 s33, 0, -1
    v_not_b32 v12, v12
    v_or_b32 v12, s33, v12
    v_not_b32 v13, v13
    v_or_b32 v13, s33, v13
    v_not_b32 v14, v14
    v_or_b32 v14, s33, v14
    v_not_b32 v15, v15
    v_or_b32 v15, s33, v15
    v_not_b32 v16, v16
    v_or_b32 v16, s33, v16
    v_not_b32 v17, v17
    v_or_b32 v17, s33, v17
    v_not_b32 v18, v18
    v_or_b32 v18, s33, v18
    v_not_b32 v19, v19
    v_or_b32 v19, s33, v19
    s_and_b32 s32, s76, 3
    s_cmp_ge_u32 s76, 8
    s_cselect_b32 s32, s32, 4
    s_sub_u32 s74, 8, s32
    s_lshl_b32 s32, s32, 12
    s_add_u32 s32, s32, 114688
    v_add_u32 v22, s32, v253
    v_add_u32 v23, s32, v253
    s_cmp_eq_u32 s26, 0
    s_cselect_b32 s75, 2, 1
    s_cmp_eq_u32 s100, 1
    s_cbranch_scc1 l_patch
l_pmid:
    s_cmp_eq_u32 s100, 1
    s_cbranch_scc1 sk_51
    s_barrier
sk_51:
    s_waitcnt vmcnt(3)
    s_cmp_eq_u32 s26, 0
    s_cbranch_scc1 sk_52
    s_waitcnt vmcnt(0)
sk_52:
    s_cmp_lg_u32 s100, 1
    s_cbranch_scc1 sk_53
    s_cmp_lg_u32 s38, 0
    s_barrier
    s_cselect_b64 exec, -1, 0
    ds_write_b16 v0, v1
    s_mov_b64 exec, -1
    s_waitcnt lgkmcnt(0)
    s_barrier
sk_53:
    s_cmp_lg_u32 s26, 0
    s_cbranch_scc1 sk_54
    s_xor_b32 s96, s29, 1
    s_and_b32 s97, s96, 2
    s_and_b32 s96, s96, 3
    s_mul_i32 s97, s97, 14336
    s_mul_i32 s96, s96, 14336
    s_add_u32 s96, s96, s97
    s_add_u32 s96, s96, 7168
    buffer_load_dwordx4 v[168:171], v155, s[80:83], s96 offen
    s_xor_b32 s96, s29, 2
    s_and_b32 s97, s96, 2
    s_and_b32 s96, s96, 3
    s_mul_i32 s97, s97, 14336
    s_mul_i32 s96, s96, 14336
    s_add_u32 s96, s96, s97
    buffer_load_dwordx4 v[172:175], v155, s[80:83], s96 offen
    s_xor_b32 s96, s29, 2
    s_and_b32 s97, s96, 2
    s_and_b32 s96, s96, 3
    s_mul_i32 s97, s97, 14336
    s_mul_i32 s96, s96, 14336
    s_add_u32 s96, s96, s97
    s_add_u32 s96, s96, 7168
    buffer_load_dwordx4 v[176:179], v155, s[80:83], s96 offen
    s_xor_b32 s96, s29, 3
    s_and_b32 s97, s96, 2
    s_and_b32 s96, s96, 3
    s_mul_i32 s97, s97, 14336
    s_mul_i32 s96, s96, 14336
    s_add_u32 s96, s96, s97
    buffer_load_dwordx4 v[180:183], v155, s[80:83], s96 offen
    s_xor_b32 s96, s29, 3
    s_and_b32 s97, s96, 2
    s_and_b32 s96, s96, 3
    s_mul_i32 s97, s97, 14336
    s_mul_i32 s96, s96, 14336
    s_add_u32 s96, s96, s97
    s_add_u32 s96, s96, 7168
    buffer_load_dwordx4 v[184:187], v155, s[80:83], s96 offen
sk_54:
    s_barrier
    s_cmp_lt_u32 s76, 4
    s_cbranch_scc1 a1_49_none
    ds_read_b128 v[112:115], v22 offset:0
    ds_read_b128 v[116:119], v22 offset:1024
    ds_read_b128 v[104:107], v23 offset:4096
    ds_read_b128 v[124:127], v22 offset:3072
    ds_read_b128 v[108:111], v23 offset:5120
    ds_read_b128 v[120:123], v22 offset:2048
    s_waitcnt lgkmcnt(4)
a1_49_go:
    s_nop 0
    v_mfma_f32_32x32x16_bf16 v[56:71], v[112:115], v[4:7], v[24:39]
    v_mfma_f32_32x32x16_bf16 v[56:71], v[116:119], v[8:11], v[56:71]
    s_waitcnt lgkmcnt(3)
    v_mfma_f32_32x32x16_bf16 v[72:87], v[104:107], v[4:7], v[24:39]
    ds_read_b128 v[104:107], v23 offset:8192
    s_nop 8
    v_exp_f32 v56, v56
    v_exp_f32 v57, v57
    v_exp_f32_e64 v58, v58
    ds_read_b128 v[128:131], v23 offset:7168
    v_exp_f32 v59, v59
    v_exp_f32 v60, v60
    v_exp_f32 v61, v61
    s_waitcnt lgkmcnt(2)
    v_mfma_f32_32x32x16_bf16 v[72:87], v[108:111], v[8:11], v[72:87]
    ds_read_b128 v[108:111], v23 offset:9216
    v_exp_f32 v62, v62
    v_exp_f32 v63, v63
    v_cvt_pk_bf16_f32 v136, v56, v57
    v_cvt_pk_bf16_f32 v137, v58, v59
    v_cvt_pk_bf16_f32 v138, v60, v61
    v_cvt_pk_bf16_f32 v139, v62, v63
    v_and_b32 v136, v136, v12
    v_and_b32 v137, v137, v13
    v_and_b32 v138, v138, v14
    v_and_b32 v139, v139, v15
    v_exp_f32 v64, v64
    v_exp_f32 v65, v65
    v_mfma_f32_32x32x16_bf16 v[88:103], v[120:123], v[136:139], v[88:103]
    ds_read_b128 v[120:123], v23 offset:6144
    s_cmp_eq_u32 s75, 0
    s_cbranch_scc1 sk_56
    s_cmp_lg_u32 s26, 0
    s_cbranch_scc1 sk_55
    s_xor_b32 s96, s29, 0
    s_and_b32 s97, s96, 2
    s_and_b32 s96, s96, 3
    s_mul_i32 s97, s97, 14336
    s_mul_i32 s96, s96, 14336
    s_add_u32 s96, s96, s97
    buffer_load_dwordx4 v[188:191], v155, s[4:7], s96 offen
    s_xor_b32 s96, s29, 0
    s_and_b32 s97, s96, 2
    s_and_b32 s96, s96, 3
    s_mul_i32 s97, s97, 14336
    s_mul_i32 s96, s96, 14336
    s_add_u32 s96, s96, s97
    s_add_u32 s96, s96, 7168
    buffer_load_dwordx4 v[192:195], v155, s[4:7], s96 offen
sk_55:
sk_56:
    v_exp_f32 v66, v66
    v_exp_f32 v67, v67
    v_exp_f32 v68, v68
    v_exp_f32 v69, v69
    v_mfma_f32_16x16x32_bf16 v[44:47], v[40:43], v[136:139], v[44:47]
    v_exp_f32 v70, v70
    v_exp_f32 v71, v71
    v_cvt_pk_bf16_f32 v140, v64, v65
    v_cvt_pk_bf16_f32 v141, v66, v67
    v_cvt_pk_bf16_f32 v142, v68, v69
    v_cvt_pk_bf16_f32 v143, v70, v71
    v_and_b32 v140, v140, v16
    v_and_b32 v141, v141, v17
    v_and_b32_e64 v142, v142, v18
    v_and_b32 v143, v143, v19
    s_cmp_eq_u32 s75, 0
    s_cbranch_scc1 sk_58
    s_cmp_lg_u32 s26, 0
    s_cbranch_scc1 sk_57
    s_xor_b32 s96, s29, 1
    s_and_b32 s97, s96, 2
    s_and_b32 s96, s96, 3
    s_mul_i32 s97, s97, 14336
    s_mul_i32 s96, s96, 14336
    s_add_u32 s96, s96, s97
    buffer_load_dwordx4 v[196:199], v155, s[4:7], s96 offen
    s_xor_b32 s96, s29, 1
    s_and_b32 s97, s96, 2
    s_and_b32 s96, s96, 3
    s_mul_i32 s97, s97, 14336
    s_mul_i32 s96, s96, 14336
    s_add_u32 s96, s96, s97
    s_add_u32 s96, s96, 7168
    buffer_load_dwordx4 v[200:203], v155, s[4:7], s96 offen
sk_57:
sk_58:
    s_cmp_eq_u32 s74, 1
    s_cbranch_scc1 a1_49_e0
    s_cmp_eq_u32 s74, 2
    s_cbranch_scc1 a1_49_t1
    s_waitcnt lgkmcnt(3)
    v_mfma_f32_32x32x16_bf16 v[56:71], v[104:107], v[4:7], v[24:39]
    ds_read_b128 v[104:107], v23 offset:12288
    v_exp_f32 v72, v72
    v_exp_f32 v73, v73
    v_exp_f32_e64 v74, v74
    v_mfma_f32_32x32x16_bf16 v[88:103], v[124:127], v[140:143], v[88:103]
    ds_read_b128 v[124:127], v23 offset:11264
    v_exp_f32 v75, v75
    v_exp_f32 v76, v76
    v_exp_f32 v77, v77
    s_waitcnt lgkmcnt(2)
    v_mfma_f32_32x32x16_bf16 v[56:71], v[108:111], v[8:11], v[56:71]
    ds_read_b128 v[108:111], v23 offset:13312
    v_exp_f32 v78, v78
    v_exp_f32 v79, v79
    v_cvt_pk_bf16_f32 v136, v72, v73
    v_cvt_pk_bf16_f32 v137, v74, v75
    v_mfma_f32_16x16x32_bf16 v[44:47], v[40:43], v[140:143], v[44:47]
    v_cvt_pk_bf16_f32 v138, v76, v77
    v_cvt_pk_bf16_f32 v139, v78, v79
    v_exp_f32 v80, v80
    v_exp_f32 v81, v81
    v_mfma_f32_32x32x16_bf16 v[88:103], v[120:123], v[136:139], v[88:103]
    ds_read_b128 v[120:123], v23 offset:10240
    s_cmp_eq_u32 s75, 0
    s_cbranch_scc1 sk_60
    s_cmp_lg_u32 s26, 0
    s_cbranch_scc1 sk_59
    s_xor_b32 s96, s29, 2
    s_and_b32 s97, s96, 2
    s_and_b32 s96, s96, 3
    s_mul_i32 s97, s97, 14336
    s_mul_i32 s96, s96, 14336
    s_add_u32 s96, s96, s97
    buffer_load_dwordx4 v[204:207], v155, s[4:7], s96 offen
sk_59:
sk_60:
    v_exp_f32 v82, v82
    v_exp_f32 v83, v83
    v_exp_f32 v84, v84
    v_exp_f32 v85, v85
    v_mfma_f32_16x16x32_bf16 v[44:47], v[40:43], v[136:139], v[44:47]
    v_exp_f32 v86, v86
    v_exp_f32 v87, v87
    v_cvt_pk_bf16_f32 v140, v80, v81
    v_cvt_pk_bf16_f32 v141, v82, v83
    v_cvt_pk_bf16_f32 v142, v84, v85
    v_cvt_pk_bf16_f32 v143, v86, v87
    s_cmp_eq_u32 s75, 0
    s_cbranch_scc1 sk_62
    s_cmp_lg_u32 s26, 0
    s_cbranch_scc1 sk_61
    s_xor_b32 s96, s29, 2
    s_and_b32 s97, s96, 2
    s_and_b32 s96, s96, 3
    s_mul_i32 s97, s97, 14336
    s_mul_i32 s96, s96, 14336
    s_add_u32 s96, s96, s97
    s_add_u32 s96, s96, 7168
    buffer_load_dwordx4 v[208:211], v155, s[4:7], s96 offen
sk_61:
sk_62:
    s_cmp_eq_u32 s74, 3
    s_cbranch_scc1 a1_49_t0
    s_waitcnt lgkmcnt(3)
    v_mfma_f32_32x32x16_bf16 v[72:87], v[104:107], v[4:7], v[24:39]
    ds_read_b128 v[104:107], v23 offset:16384
    v_exp_f32 v56, v56
    v_exp_f32 v57, v57
    v_exp_f32 v58, v58
    v_mfma_f32_32x32x16_bf16 v[88:103], v[128:131], v[140:143], v[88:103]
    ds_read_b128 v[128:131], v23 offset:15360
    v_exp_f32 v59, v59
    v_exp_f32 v60, v60
    v_exp_f32 v61, v61
    s_waitcnt lgkmcnt(2)
    v_mfma_f32_32x32x16_bf16 v[72:87], v[108:111], v[8:11], v[72:87]
    ds_read_b128 v[108:111], v23 offset:17408
    v_exp_f32 v62, v62
    v_exp_f32 v63, v63
    v_cvt_pk_bf16_f32 v136, v56, v57
    v_cvt_pk_bf16_f32 v137, v58, v59
    v_mfma_f32_16x16x32_bf16 v[44:47], v[40:43], v[140:143], v[44:47]
    v_cvt_pk_bf16_f32 v138, v60, v61
    v_cvt_pk_bf16_f32 v139, v62, v63
    v_exp_f32 v64, v64
    v_exp_f32 v65, v65
    v_mfma_f32_32x32x16_bf16 v[88:103], v[120:123], v[136:139], v[88:103]
    ds_read_b128 v[120:123], v23 offset:14336
    s_cmp_eq_u32 s75, 0
    s_cbranch_scc1 sk_64
    s_cmp_lg_u32 s26, 0
    s_cbranch_scc1 sk_63
    s_xor_b32 s96, s29, 3
    s_and_b32 s97, s96, 2
    s_and_b32 s96, s96, 3
    s_mul_i32 s97, s97, 14336
    s_mul_i32 s96, s96, 14336
    s_add_u32 s96, s96, s97
    buffer_load_dwordx4 v[212:215], v155, s[4:7], s96 offen
sk_63:
sk_64:
    v_exp_f32 v66, v66
    v_exp_f32 v67, v67
    v_exp_f32 v68, v68
    v_exp_f32 v69, v69
    v_mfma_f32_16x16x32_bf16 v[44:47], v[40:43], v[136:139], v[44:47]
    v_exp_f32 v70, v70
    v_exp_f32 v71, v71
    v_cvt_pk_bf16_f32 v140, v64, v65
    v_cvt_pk_bf16_f32 v141, v66, v67
    v_cvt_pk_bf16_f32 v142, v68, v69
    v_cvt_pk_bf16_f32 v143, v70, v71
    s_cmp_eq_u32 s75, 0
    s_cbranch_scc1 sk_66
    s_barrier
    s_cmp_lg_u32 s26, 0
    s_cbranch_scc1 sk_65
    s_xor_b32 s96, s29, 3
    s_and_b32 s97, s96, 2
    s_and_b32 s96, s96, 3
    s_mul_i32 s97, s97, 14336
    s_mul_i32 s96, s96, 14336
    s_add_u32 s96, s96, s97
    s_add_u32 s96, s96, 7168
    buffer_load_dwordx4 v[216:219], v155, s[4:7], s96 offen
sk_65:
sk_66:
    s_cmp_eq_u32 s74, 4
    s_cbranch_scc1 a1_49_t1
    s_waitcnt lgkmcnt(3)
    v_mfma_f32_32x32x16_bf16 v[56:71], v[104:107], v[4:7], v[24:39]
    ds_read_b128 v[104:107], v23 offset:20480
    v_exp_f32 v72, v72
    v_exp_f32 v73, v73
    v_exp_f32_e64 v74, v74
    v_mfma_f32_32x32x16_bf16 v[88:103], v[124:127], v[140:143], v[88:103]
    ds_read_b128 v[124:127], v23 offset:19456
    v_exp_f32 v75, v75
    v_exp_f32 v76, v76
    v_exp_f32 v77, v77
    s_waitcnt lgkmcnt(2)
    v_mfma_f32_32x32x16_bf16 v[56:71], v[108:111], v[8:11], v[56:71]
    ds_read_b128 v[108:111], v23 offset:21504
    v_exp_f32 v78, v78
    v_exp_f32 v79, v79
    v_cvt_pk_bf16_f32 v136, v72, v73
    v_cvt_pk_bf16_f32 v137, v74, v75
    v_mfma_f32_16x16x32_bf16 v[44:47], v[40:43], v[140:143], v[44:47]
    v_cvt_pk_bf16_f32 v138, v76, v77
    v_cvt_pk_bf16_f32 v139, v78, v79
    v_exp_f32 v80, v80
    v_exp_f32 v81, v81
    v_mfma_f32_32x32x16_bf16 v[88:103], v[120:123], v[136:139], v[88:103]
    ds_read_b128 v[120:123], v23 offset:18432
    v_exp_f32 v82, v82
    v_exp_f32 v83, v83
    v_exp_f32 v84, v84
    v_exp_f32 v85, v85
    v_mfma_f32_16x16x32_bf16 v[44:47], v[40:43], v[136:139], v[44:47]
    v_exp_f32 v86, v86
    v_exp_f32 v87, v87
    v_cvt_pk_bf16_f32 v140, v80, v81
    v_cvt_pk_bf16_f32 v141, v82, v83
    v_cvt_pk_bf16_f32 v142, v84, v85
    v_cvt_pk_bf16_f32 v143, v86, v87
    s_cmp_eq_u32 s74, 5
    s_cbranch_scc1 a1_49_t0
    s_waitcnt lgkmcnt(3)
    v_mfma_f32_32x32x16_bf16 v[72:87], v[104:107], v[4:7], v[24:39]
    ds_read_b128 v[104:107], v23 offset:24576
    v_exp_f32 v56, v56
    v_exp_f32 v57, v57
    v_exp_f32 v58, v58
    v_mfma_f32_32x32x16_bf16 v[88:103], v[128:131], v[140:143], v[88:103]
    ds_read_b128 v[128:131], v23 offset:23552
    v_exp_f32 v59, v59
    v_exp_f32 v60, v60
    v_exp_f32 v61, v61
    s_waitcnt lgkmcnt(2)
    v_mfma_f32_32x32x16_bf16 v[72:87], v[108:111], v[8:11], v[72:87]
    ds_read_b128 v[108:111], v23 offset:25600
    v_exp_f32 v62, v62
    v_exp_f32 v63, v63
    v_cvt_pk_bf16_f32 v136, v56, v57
    v_cvt_pk_bf16_f32 v137, v58, v59
    v_mfma_f32_16x16x32_bf16 v[44:47], v[40:43], v[140:143], v[44:47]
    v_cvt_pk_bf16_f32 v138, v60, v61
    v_cvt_pk_bf16_f32 v139, v62, v63
    v_exp_f32 v64, v64
    v_exp_f32 v65, v65
    v_mfma_f32_32x32x16_bf16 v[88:103], v[120:123], v[136:139], v[88:103]
    ds_read_b128 v[120:123], v23 offset:22528
    v_exp_f32 v66, v66
    v_exp_f32 v67, v67
    v_exp_f32 v68, v68
    v_exp_f32 v69, v69
    v_mfma_f32_16x16x32_bf16 v[44:47], v[40:43], v[136:139], v[44:47]
    v_exp_f32 v70, v70
    v_exp_f32 v71, v71
    v_cvt_pk_bf16_f32 v140, v64, v65
    v_cvt_pk_bf16_f32 v141, v66, v67
    v_cvt_pk_bf16_f32 v142, v68, v69
    v_cvt_pk_bf16_f32 v143, v70, v71
    s_cmp_eq_u32 s74, 6
    s_cbranch_scc1 a1_49_t1
    s_waitcnt lgkmcnt(3)
    v_mfma_f32_32x32x16_bf16 v[56:71], v[104:107], v[4:7], v[24:39]
    ds_read_b128 v[104:107], v23 offset:28672
    v_exp_f32 v72, v72
    v_exp_f32 v73, v73
    v_exp_f32 v74, v74
    v_mfma_f32_32x32x16_bf16 v[88:103], v[124:127], v[140:143], v[88:103]
    ds_read_b128 v[124:127], v23 offset:27648
    v_exp_f32 v75, v75
    v_exp_f32 v76, v76
    v_exp_f32 v77, v77
    s_waitcnt lgkmcnt(2)
    v_mfma_f32_32x32x16_bf16 v[56:71], v[108:111], v[8:11], v[56:71]
    ds_read_b128 v[108:111], v23 offset:29696
    v_exp_f32 v78, v78
    v_exp_f32 v79, v79
    v_cvt_pk_bf16_f32 v136, v72, v73
    v_cvt_pk_bf16_f32 v137, v74, v75
    v_mfma_f32_16x16x32_bf16 v[44:47], v[40:43], v[140:143], v[44:47]
    v_cvt_pk_bf16_f32 v138, v76, v77
    v_cvt_pk_bf16_f32 v139, v78, v79
    v_exp_f32 v80, v80
    v_exp_f32 v81, v81
    v_mfma_f32_32x32x16_bf16 v[88:103], v[120:123], v[136:139], v[88:103]
    ds_read_b128 v[120:123], v23 offset:26624
    v_exp_f32 v82, v82
    v_exp_f32 v83, v83
    v_exp_f32 v84, v84
    v_exp_f32 v85, v85
    v_mfma_f32_16x16x32_bf16 v[44:47], v[40:43], v[136:139], v[44:47]
    v_exp_f32 v86, v86
    v_exp_f32 v87, v87
    v_cvt_pk_bf16_f32 v140, v80, v81
    v_cvt_pk_bf16_f32 v141, v82, v83
    v_cvt_pk_bf16_f32 v142, v84, v85
    v_cvt_pk_bf16_f32 v143, v86, v87
    s_cmp_eq_u32 s74, 7
    s_cbranch_scc1 a1_49_t0
    s_waitcnt lgkmcnt(3)
    v_mfma_f32_32x32x16_bf16 v[72:87], v[104:107], v[4:7], v[24:39]
    ds_read_b128 v[104:107], v23 offset:24576
    v_exp_f32 v56, v56
    v_exp_f32 v57, v57
    v_exp_f32 v58, v58
    v_mfma_f32_32x32x16_bf16 v[88:103], v[128:131], v[140:143], v[88:103]
    ds_read_b128 v[128:131], v23 offset:31744
    v_exp_f32 v59, v59
    v_exp_f32 v60, v60
    v_exp_f32 v61, v61
    s_waitcnt lgkmcnt(2)
    v_mfma_f32_32x32x16_bf16 v[72:87], v[108:111], v[8:11], v[72:87]
    ds_read_b128 v[108:111], v23 offset:25600
    v_exp_f32 v62, v62
    v_exp_f32 v63, v63
    v_cvt_pk_bf16_f32 v136, v56, v57
    v_cvt_pk_bf16_f32 v137, v58, v59
    v_mfma_f32_16x16x32_bf16 v[44:47], v[40:43], v[140:143], v[44:47]
    v_cvt_pk_bf16_f32 v138, v60, v61
    v_cvt_pk_bf16_f32 v139, v62, v63
    v_exp_f32 v64, v64
    v_exp_f32 v65, v65
    v_mfma_f32_32x32x16_bf16 v[88:103], v[120:123], v[136:139], v[88:103]
    ds_read_b128 v[120:123], v23 offset:30720
    v_exp_f32 v66, v66
    v_exp_f32 v67, v67
    v_exp_f32 v68, v68
    v_exp_f32 v69, v69
    v_mfma_f32_16x16x32_bf16 v[44:47], v[40:43], v[136:139], v[44:47]
    v_exp_f32 v70, v70
    v_exp_f32 v71, v71
    v_cvt_pk_bf16_f32 v140, v64, v65
    v_cvt_pk_bf16_f32 v141, v66, v67
    v_cvt_pk_bf16_f32 v142, v68, v69
    v_cvt_pk_bf16_f32 v143, v70, v71
a1_49_t1:
    v_exp_f32 v72, v72
    v_exp_f32 v73, v73
    v_exp_f32_e64 v74, v74
    v_mfma_f32_32x32x16_bf16 v[88:103], v[124:127], v[140:143], v[88:103]
    v_exp_f32 v75, v75
    v_exp_f32 v76, v76
    v_exp_f32 v77, v77
    v_exp_f32 v78, v78
    v_exp_f32_e64 v79, v79
    v_cvt_pk_bf16_f32 v136, v72, v73
    v_cvt_pk_bf16_f32 v137, v74, v75
    v_mfma_f32_16x16x32_bf16 v[44:47], v[40:43], v[140:143], v[44:47]
    v_cvt_pk_bf16_f32 v138, v76, v77
    v_cvt_pk_bf16_f32 v139, v78, v79
    v_exp_f32_e64 v80, v80
    v_exp_f32 v81, v81
    s_waitcnt lgkmcnt(0)
    v_mfma_f32_32x32x16_bf16 v[88:103], v[120:123], v[136:139], v[88:103]
    v_exp_f32 v82, v82
    v_exp_f32 v83, v83
    v_exp_f32 v84, v84
    v_exp_f32 v85, v85
    v_mfma_f32_16x16x32_bf16 v[44:47], v[40:43], v[136:139], v[44:47]
    v_exp_f32 v86, v86
    v_exp_f32 v87, v87
    v_cvt_pk_bf16_f32 v140, v80, v81
    v_cvt_pk_bf16_f32 v141, v82, v83
    v_cvt_pk_bf16_f32 v142, v84, v85
    v_cvt_pk_bf16_f32 v143, v86, v87
a1_49_e1:
    s_cmp_eq_u32 s75, 0
    s_nop 0
    v_mfma_f32_16x16x32_bf16 v[44:47], v[40:43], v[140:143], v[44:47]
    v_mfma_f32_32x32x16_bf16 v[88:103], v[128:131], v[140:143], v[88:103]
    s_cbranch_scc1 a1_49_mid
    s_branch a1_49_fin
    s_nop 0
a1_49_t0:
    v_exp_f32 v56, v56
    v_exp_f32 v57, v57
    v_exp_f32 v58, v58
    v_mfma_f32_32x32x16_bf16 v[88:103], v[128:131], v[140:143], v[88:103]
    v_exp_f32 v59, v59
    v_exp_f32 v60, v60
    v_exp_f32 v61, v61
    v_exp_f32 v62, v62
    v_exp_f32_e64 v63, v63
    v_cvt_pk_bf16_f32 v136, v56, v57
    v_cvt_pk_bf16_f32 v137, v58, v59
    v_mfma_f32_16x16x32_bf16 v[44:47], v[40:43], v[140:143], v[44:47]
    v_cvt_pk_bf16_f32 v138, v60, v61
    v_cvt_pk_bf16_f32 v139, v62, v63
    v_exp_f32_e64 v64, v64
    v_exp_f32 v65, v65
    s_waitcnt lgkmcnt(0)
    v_mfma_f32_32x32x16_bf16 v[88:103], v[120:123], v[136:139], v[88:103]
    v_exp_f32 v66, v66
    v_exp_f32 v67, v67
    v_exp_f32 v68, v68
    v_exp_f32 v69, v69
    v_mfma_f32_16x16x32_bf16 v[44:47], v[40:43], v[136:139], v[44:47]
    v_exp_f32 v70, v70
    v_exp_f32 v71, v71
    v_cvt_pk_bf16_f32 v140, v64, v65
    v_cvt_pk_bf16_f32 v141, v66, v67
    v_cvt_pk_bf16_f32 v142, v68, v69
    v_cvt_pk_bf16_f32 v143, v70, v71
a1_49_e0:
    s_cmp_eq_u32 s75, 0
    s_nop 0
    v_mfma_f32_16x16x32_bf16 v[44:47], v[40:43], v[140:143], v[44:47]
    v_mfma_f32_32x32x16_bf16 v[88:103], v[124:127], v[140:143], v[88:103]
    s_cbranch_scc1 a1_49_mid
    s_branch a1_49_fin
    s_nop 0
a1_49_none:
    s_cmp_lg_u32 s26, 0
    s_cbranch_scc1 sk_67
    s_xor_b32 s96, s29, 0
    s_and_b32 s97, s96, 2
    s_and_b32 s96, s96, 3
    s_mul_i32 s97, s97, 14336
    s_mul_i32 s96, s96, 14336
    s_add_u32 s96, s96, s97
    buffer_load_dwordx4 v[188:191], v155, s[4:7], s96 offen
    s_xor_b32 s96, s29, 0
    s_and_b32 s97, s96, 2
    s_and_b32 s96, s96, 3
    s_mul_i32 s97, s97, 14336
    s_mul_i32 s96, s96, 14336
    s_add_u32 s96, s96, s97
    s_add_u32 s96, s96, 7168
    buffer_load_dwordx4 v[192:195], v155, s[4:7], s96 offen
sk_67:
    s_cmp_lg_u32 s26, 0
    s_cbranch_scc1 sk_68
    s_xor_b32 s96, s29, 1
    s_and_b32 s97, s96, 2
    s_and_b32 s96, s96, 3
    s_mul_i32 s97, s97, 14336
    s_mul_i32 s96, s96, 14336
    s_add_u32 s96, s96, s97
    buffer_load_dwordx4 v[196:199], v155, s[4:7], s96 offen
    s_xor_b32 s96, s29, 1
    s_and_b32 s97, s96, 2
    s_and_b32 s96, s96, 3
    s_mul_i32 s97, s97, 14336
    s_mul_i32 s96, s96, 14336
    s_add_u32 s96, s96, s97
    s_add_u32 s96, s96, 7168
    buffer_load_dwordx4 v[200:203], v155, s[4:7], s96 offen
sk_68:
    s_cmp_lg_u32 s26, 0
    s_cbranch_scc1 sk_69
    s_xor_b32 s96, s29, 2
    s_and_b32 s97, s96, 2
    s_and_b32 s96, s96, 3
    s_mul_i32 s97, s97, 14336
    s_mul_i32 s96, s96, 14336
    s_add_u32 s96, s96, s97
    buffer_load_dwordx4 v[204:207], v155, s[4:7], s96 offen
sk_69:
    s_cmp_lg_u32 s26, 0
    s_cbranch_scc1 sk_70
    s_xor_b32 s96, s29, 2
    s_and_b32 s97, s96, 2
    s_and_b32 s96, s96, 3
    s_mul_i32 s97, s97, 14336
    s_mul_i32 s96, s96, 14336
    s_add_u32 s96, s96, s97
    s_add_u32 s96, s96, 7168
    buffer_load_dwordx4 v[208:211], v155, s[4:7], s96 offen
sk_70:
    s_cmp_lg_u32 s26, 0
    s_cbranch_scc1 sk_71
    s_xor_b32 s96, s29, 3
    s_and_b32 s97, s96, 2
    s_and_b32 s96, s96, 3
    s_mul_i32 s97, s97, 14336
    s_mul_i32 s96, s96, 14336
    s_add_u32 s96, s96, s97
    buffer_load_dwordx4 v[212:215], v155, s[4:7], s96 offen
sk_71:
    s_barrier
    s_cmp_lg_u32 s26, 0
    s_cbranch_scc1 sk_72
    s_xor_b32 s96, s29, 3
    s_and_b32 s97, s96, 2
    s_and_b32 s96, s96, 3
    s_mul_i32 s97, s97, 14336
    s_mul_i32 s96, s96, 14336
    s_add_u32 s96, s96, s97
    s_add_u32 s96, s96, 7168
    buffer_load_dwordx4 v[216:219], v155, s[4:7], s96 offen
sk_72:
a1_49_fin:
    s_lshl_b32 s36, s76, 17
    s_lshr_b32 s33, s26, 8
    s_add_u32 s36, s36, s33
    s_add_u32 s36, s36, 0x2808000
    s_lshl_b32 s33, s25, 11
    s_add_u32 s33, s33, s36
    s_lshl_b32 s30, s24, 9
    s_and_b32 s31, s76, 3
    s_lshl_b32 s31, s31, 6
    s_add_u32 s30, s30, s31
    s_add_u32 s30, s30, s26
    s_add_u32 s30, s30, 0xdd2100
    s_lshl_b32 s31, s25, 2
    s_add_u32 s31, s31, s30
    v_cmp_ngt_f32 vcc, 0x5d800000, v44
    v_rcp_f32_e64 v22, v44
    s_cbranch_vccnz att_exact1
att_ret1:
    s_nop 3
    v_pk_mul_f32 v[88:89], v[88:89], v[22:23] op_sel_hi:[1,0]
    v_pk_mul_f32 v[90:91], v[90:91], v[22:23] op_sel_hi:[1,0]
    v_pk_mul_f32 v[92:93], v[92:93], v[22:23] op_sel_hi:[1,0]
    v_pk_mul_f32 v[94:95], v[94:95], v[22:23] op_sel_hi:[1,0]
    v_pk_mul_f32 v[96:97], v[96:97], v[22:23] op_sel_hi:[1,0]
    v_pk_mul_f32 v[98:99], v[98:99], v[22:23] op_sel_hi:[1,0]
    v_pk_mul_f32 v[100:101], v[100:101], v[22:23] op_sel_hi:[1,0]
    v_pk_mul_f32 v[102:103], v[102:103], v[22:23] op_sel_hi:[1,0]
    v_cvt_pk_bf16_f32 v88, v88, v89
    v_cvt_pk_bf16_f32 v89, v90, v91
    v_cvt_pk_bf16_f32 v90, v92, v93
    v_cvt_pk_bf16_f32 v91, v94, v95
    v_cvt_pk_bf16_f32 v92, v96, v97
    v_cvt_pk_bf16_f32 v93, v98, v99
    v_cvt_pk_bf16_f32 v94, v100, v101
    v_cvt_pk_bf16_f32 v95, v102, v103
    s_cmp_gt_u32 s77, s26
    s_cbranch_scc1 lc_73
    buffer_store_dwordx4 v[88:91], v253, s[20:23], s33 offen sc1
    buffer_store_dwordx4 v[92:95], v253, s[20:23], s33 offen offset:1024 sc1
    s_branch lc_74
    s_nop 0
lc_73:
    buffer_store_dwordx4 v[88:91], v253, s[20:23], s33 offen
    buffer_store_dwordx4 v[92:95], v253, s[20:23], s33 offen offset:1024
lc_74:
    v_mov_b32_e64 v154, s88
    s_mov_b64 exec, 1
    s_waitcnt vmcnt(0)
    s_cmp_lg_u32 s77, 0
    s_cbranch_scc1 lc_75
    buffer_store_dword v154, v253, s[20:23], s31 offen sc1
    s_branch lc_76
    s_nop 0
lc_75:
    buffer_store_dword v154, v253, s[20:23], s31 offen
lc_76:
    s_mov_b64 exec, -1
    s_cmp_lg_u32 s26, 0
    s_cbranch_scc1 sk_77
    s_mov_b32 s96, 0
    buffer_load_dwordx4 v[220:223], v153, s[12:15], s96 offen
    s_mov_b32 s96, 2048
    buffer_load_dwordx4 v[224:227], v153, s[12:15], s96 offen
    s_mov_b32 s96, 4096
    buffer_load_dwordx4 v[228:231], v153, s[12:15], s96 offen
    s_mov_b32 s96, 6144
    buffer_load_dwordx4 v[232:235], v153, s[12:15], s96 offen
    s_mov_b32 s96, 8192
    buffer_load_dwordx4 v[236:239], v153, s[12:15], s96 offen
    s_mov_b32 s96, 10240
    buffer_load_dwordx4 v[240:243], v153, s[12:15], s96 offen
    s_mov_b32 s96, 12288
    buffer_load_dwordx4 v[244:247], v153, s[12:15], s96 offen
    s_mov_b32 s96, 14336
    buffer_load_dwordx4 v[248:251], v153, s[12:15], s96 offen
sk_77:
    v_bfe_u32 v20, v252, 3, 2
    v_lshrrev_b32_e64 v21, 5, v252
    v_lshl_add_u32 v20, v21, 3, v20
    s_lshr_b32 s32, s28, 1
    s_lshl_b32 s32, s32, 4
    s_and_b32 s33, s28, 1
    s_lshl_b32 s33, s33, 2
    s_add_u32 s32, s32, s33
    v_add_u32 v20, s32, v20
    v_lshlrev_b32 v20, 11, v20
    v_lshrrev_b32 v21, 2, v252
    v_and_b32 v21, 4, v21
    v_xor_b32 v21, v21, v252
    v_and_b32 v21, 7, v21
    v_lshl_add_u32 v20, v21, 4, v20
    s_lshl_b32 s32, s98, 7
    v_add_u32 v14, s32, v20
    s_lshl_b32 s32, s28, 9
    s_sub_u32 s34, s29, 224
    s_lshl_b32 s34, s34, 2
    s_mul_i32 s35, s28, 2
    s_and_b32 s33, s35, 3
    s_add_u32 s34, s34, s33
    s_cmp_lt_u32 s35, 4
    s_cselect_b32 s89, s34, -1
    v_and_b32 v23, 1, v252
    v_add_u32 v23, s34, v23
    v_lshrrev_b32_e64 v22, 5, v252
    v_and_or_b32 v23, v23, -2, v22
    v_lshrrev_b32_e64 v22, 1, v252
    s_cmp_lt_u32 s29, 224
    s_cselect_b32 s32, s32, 0
    s_cselect_b64 vcc, -1, 0
    v_cndmask_b32_e64 v22, v23, v22, vcc
    v_lshl_add_u32 v22, v22, 4, s32
    s_mov_b32 s79, s26
    s_cmp_lg_u32 s26, 0
    s_cbranch_scc1 sk_78
    s_waitcnt vmcnt(0)
    s_getpc_b64 s[32:33]
pc_79:
    s_sub_u32 s32, s32, pc_79-interleave_layers__sliding_block__moe_arch_mod__prompt_kernel
    s_subb_u32 s33, s33, 0
    s_lshr_b32 s34, s2, 3
    s_lshl_b32 s34, s34, 2
    s_add_u32 s34, s34, s28
    s_and_b32 s34, s34, 127
    s_lshl_b32 s34, s34, 7
    v_lshl_add_u32 v19, v252, 14, s34
    s_mov_b32 s34, k_exit-interleave_layers__sliding_block__moe_arch_mod__prompt_kernel
    s_mov_b32 s35, 0x20000
    buffer_load_dword v19, v19, s[32:35], 0 offen
    s_lshr_b32 s30, s16, 7
    s_sub_u32 s30, 3, s30
    s_and_b32 s30, s30, 7
    s_and_b32 s31, s24, 1
    s_lshl_b32 s31, s31, 3
    s_add_u32 s30, s30, s31
    s_and_b32 s31, s24, 14
    s_add_u32 s35, s31, s30
    s_lshl_b32 s31, s25, 2
    s_add_u32 s31, s31, s28
    s_mul_i32 s31, s31, 6144
    s_lshl_b32 s30, s30, 7
    s_add_u32 s30, s30, s31
    v_min_u32_e64 v18, 2, v252
    v_lshl_add_u32 v18, v18, 11, s30
    s_add_u32 s30, s35, 14
    s_and_b32 s30, s30, 15
    s_mul_i32 s30, s30, 393216
    buffer_load_dword v19, v18, s[16:19], s30 offen
    s_add_u32 s30, s35, 15
    s_and_b32 s30, s30, 15
    s_mul_i32 s30, s30, 393216
    buffer_load_dword v19, v18, s[16:19], s30 offen
    s_add_u32 s30, s35, 0
    s_and_b32 s30, s30, 15
    s_mul_i32 s30, s30, 393216
    buffer_load_dword v19, v18, s[16:19], s30 offen
    s_add_u32 s30, s35, 1
    s_and_b32 s30, s30, 15
    s_mul_i32 s30, s30, 393216
    buffer_load_dword v19, v18, s[16:19], s30 offen
    s_add_u32 s30, s35, 2
    s_and_b32 s30, s30, 15
    s_mul_i32 s30, s30, 393216
    buffer_load_dword v19, v18, s[16:19], s30 offen
    s_add_u32 s30, s35, 3
    s_and_b32 s30, s30, 15
    s_mul_i32 s30, s30, 393216
    buffer_load_dword v19, v18, s[16:19], s30 offen
    s_mov_b32 s30, 0x05040100
    s_mov_b32 s31, 0x07060302
    v_perm_b32 v155, v160, v156, s30
    v_perm_b32 v160, v160, v156, s31
    v_perm_b32 v156, v161, v157, s30
    v_perm_b32 v161, v161, v157, s31
    v_perm_b32 v157, v162, v158, s30
    v_perm_b32 v162, v162, v158, s31
    v_perm_b32 v158, v163, v159, s30
    v_perm_b32 v163, v163, v159, s31
    v_perm_b32 v159, v168, v164, s30
    v_perm_b32 v168, v168, v164, s31
    v_perm_b32 v164, v169, v165, s30
    v_perm_b32 v169, v169, v165, s31
    v_perm_b32 v165, v170, v166, s30
    v_perm_b32 v170, v170, v166, s31
    v_perm_b32 v166, v171, v167, s30
    v_perm_b32 v171, v171, v167, s31
    v_perm_b32 v167, v176, v172, s30
    v_perm_b32 v176, v176, v172, s31
    v_perm_b32 v172, v177, v173, s30
    v_perm_b32 v177, v177, v173, s31
    v_perm_b32 v173, v178, v174, s30
    v_perm_b32 v178, v178, v174, s31
    v_perm_b32 v174, v179, v175, s30
    v_perm_b32 v179, v179, v175, s31
    v_perm_b32 v175, v184, v180, s30
    v_perm_b32 v184, v184, v180, s31
    v_perm_b32 v180, v185, v181, s30
    v_perm_b32 v185, v185, v181, s31
    v_perm_b32 v181, v186, v182, s30
    v_perm_b32 v186, v186, v182, s31
    v_perm_b32 v182, v187, v183, s30
    v_perm_b32 v187, v187, v183, s31
    v_perm_b32 v183, v192, v188, s30
    v_perm_b32 v192, v192, v188, s31
    v_perm_b32 v188, v193, v189, s30
    v_perm_b32 v193, v193, v189, s31
    v_perm_b32 v189, v194, v190, s30
    v_perm_b32 v194, v194, v190, s31
    v_perm_b32 v190, v195, v191, s30
    v_perm_b32 v195, v195, v191, s31
    v_perm_b32 v191, v200, v196, s30
    v_perm_b32 v200, v200, v196, s31
    v_perm_b32 v196, v201, v197, s30
    v_perm_b32 v201, v201, v197, s31
    v_perm_b32 v197, v202, v198, s30
    v_perm_b32 v202, v202, v198, s31
    v_perm_b32 v198, v203, v199, s30
    v_perm_b32 v203, v203, v199, s31
    v_perm_b32 v199, v208, v204, s30
    v_perm_b32 v208, v208, v204, s31
    v_perm_b32 v204, v209, v205, s30
    v_perm_b32 v209, v209, v205, s31
    v_perm_b32 v205, v210, v206, s30
    v_perm_b32 v210, v210, v206, s31
    v_perm_b32 v206, v211, v207, s30
    v_perm_b32 v211, v211, v207, s31
    v_perm_b32 v207, v216, v212, s30
    v_perm_b32 v216, v216, v212, s31
    v_perm_b32 v212, v217, v213, s30
    v_perm_b32 v217, v217, v213, s31
    v_perm_b32 v213, v218, v214, s30
    v_perm_b32 v218, v218, v214, s31
    v_perm_b32 v214, v219, v215, s30
    v_perm_b32 v219, v219, v215, s31
    v_perm_b32 v215, v224, v220, s30
    v_perm_b32 v224, v224, v220, s31
    v_perm_b32 v220, v225, v221, s30
    v_perm_b32 v225, v225, v221, s31
    v_perm_b32 v221, v226, v222, s30
    v_perm_b32 v226, v226, v222, s31
    v_perm_b32 v222, v227, v223, s30
    v_perm_b32 v227, v227, v223, s31
    v_perm_b32 v223, v232, v228, s30
    v_perm_b32 v232, v232, v228, s31
    v_perm_b32 v228, v233, v229, s30
    v_perm_b32 v233, v233, v229, s31
    v_perm_b32 v229, v234, v230, s30
    v_perm_b32 v234, v234, v230, s31
    v_perm_b32 v230, v235, v231, s30
    v_perm_b32 v235, v235, v231, s31
    v_perm_b32 v231, v240, v236, s30
    v_perm_b32 v240, v240, v236, s31
    v_perm_b32 v236, v241, v237, s30
    v_perm_b32 v241, v241, v237, s31
    v_perm_b32 v237, v242, v238, s30
    v_perm_b32 v242, v242, v238, s31
    v_perm_b32 v238, v243, v239, s30
    v_perm_b32 v243, v243, v239, s31
    v_perm_b32 v239, v248, v244, s30
    v_perm_b32 v248, v248, v244, s31
    v_perm_b32 v244, v249, v245, s30
    v_perm_b32 v249, v249, v245, s31
    v_perm_b32 v245, v250, v246, s30
    v_perm_b32 v250, v250, v246, s31
    v_perm_b32 v246, v251, v247, s30
    v_perm_b32 v251, v251, v247, s31
    v_lshrrev_b32_e64 v21, 3, v252
    s_lshl_b32 s84, s24, 18
    s_add_u32 s84, s84, s86
    s_add_u32 s84, s84, 0x2000000
    v_mul_u32_u24 v20, 6144, v21
    v_and_b32 v21, 6, v21
    v_xor_b32 v21, v21, v252
    v_and_b32 v21, 7, v21
    v_lshl_add_u32 v20, v21, 4, v20
    s_mul_i32 s32, s28, 3
    s_bfe_u32 s33, s32, 0x10001
    s_mul_i32 s33, s33, 196608
    s_and_b32 s34, s32, 1
    s_mul_i32 s34, s34, 49152
    s_add_u32 s33, s33, s34
    s_lshr_b32 s34, s32, 2
    s_lshl_b32 s34, s34, 11
    s_add_u32 s33, s33, s34
    v_add_u32 v8, s33, v20
    v_add_u32 v9, 97280, v8
    s_add_u32 s32, s32, 1
    s_bfe_u32 s33, s32, 0x10001
    s_mul_i32 s33, s33, 196608
    s_and_b32 s34, s32, 1
    s_mul_i32 s34, s34, 49152
    s_add_u32 s33, s33, s34
    s_lshr_b32 s34, s32, 2
    s_lshl_b32 s34, s34, 11
    s_add_u32 s33, s33, s34
    s_sub_u32 s33, s33, 2048
    v_add_u32 v10, s33, v20
    v_add_u32 v11, 97280, v10
    s_add_u32 s32, s32, 1
    s_bfe_u32 s33, s32, 0x10001
    s_mul_i32 s33, s33, 196608
    s_and_b32 s34, s32, 1
    s_mul_i32 s34, s34, 49152
    s_add_u32 s33, s33, s34
    s_lshr_b32 s34, s32, 2
    s_lshl_b32 s34, s34, 11
    s_add_u32 s33, s33, s34
    v_add_u32 v12, s33, v20
    v_add_u32 v13, 97280, v12
    s_sub_u32 s30, s95, 1
    s_sub_u32 s95, s94, 3
    s_mov_b32 s94, s30
    v_bfe_u32 v116, v252, 4, 1
    v_lshlrev_b32 v116, 11, v116
    v_lshrrev_b32_e64 v117, 5, v252
    v_lshl_add_u32 v116, v117, 8, v116
    v_and_b32 v117, 15, v252
    v_lshl_add_u32 v116, v117, 4, v116
    s_lshl_b32 s34, s28, 12
    s_add_u32 s34, s34, 147456
    v_add_u32 v117, s34, v116
    v_and_b32 v16, 15, v252
    v_lshlrev_b32_e64 v16, 9, v16
sk_78:
    s_barrier
    s_add_u32 s96, s25, 12
    s_and_b32 s96, s96, 15
    s_lshl_b32 s96, s96, 17
    s_add_u32 s96, s96, 65536
    s_add_u32 m0, s101, 114688
    s_nop 0
    buffer_load_dwordx4 v14, s[8:11], s96 offen lds
    s_add_u32 s96, s25, 13
    s_and_b32 s96, s96, 15
    s_lshl_b32 s96, s96, 17
    s_add_u32 s96, s96, 65536
    s_add_u32 m0, s101, 118784
    s_nop 0
    buffer_load_dwordx4 v14, s[8:11], s96 offen lds
    s_add_u32 s96, s25, 14
    s_and_b32 s96, s96, 15
    s_lshl_b32 s96, s96, 17
    s_add_u32 s96, s96, 65536
    s_add_u32 m0, s101, 122880
    s_nop 0
    buffer_load_dwordx4 v14, s[8:11], s96 offen lds
    s_add_u32 s96, s25, 15
    s_and_b32 s96, s96, 15
    s_lshl_b32 s96, s96, 17
    s_add_u32 s96, s96, 65536
    s_add_u32 m0, s101, 126976
    s_nop 0
    buffer_load_dwordx4 v14, s[8:11], s96 offen lds
    s_waitcnt vmcnt(0) lgkmcnt(0)
    s_barrier
    s_cmp_lg_u32 s26, 0
    s_cbranch_scc1 l_tail
    s_mov_b32 s26, 16777216
    s_mov_b32 s36, 0
    s_add_u32 s96, s94, 0
    s_and_b32 s96, s96, 15
    s_mul_i32 s96, s96, 393216
    s_add_u32 s96, s96, s85
    s_add_u32 m0, s87, 40960
    s_nop 0
    buffer_load_dwordx4 v8, s[16:19], s96 offen offset:0 lds
    buffer_load_dwordx4 v9, s[16:19], s96 offen offset:1024 lds
    buffer_load_dwordx4 v10, s[16:19], s96 offen offset:2048 lds
    buffer_load_dwordx4 v11, s[16:19], s96 offen offset:3072 lds
    s_add_u32 m0, s87, 45056
    s_nop 0
    buffer_load_dwordx4 v12, s[16:19], s96 offen offset:0 lds
    buffer_load_dwordx4 v13, s[16:19], s96 offen offset:1024 lds
    s_add_u32 s96, s95, 1
    s_and_b32 s96, s96, 15
    s_mul_i32 s96, s96, 393216
    s_add_u32 s96, s96, s85
    s_add_u32 m0, s87, 65536
    s_nop 0
    buffer_load_dwordx4 v8, s[16:19], s96 offen offset:0 lds
    buffer_load_dwordx4 v9, s[16:19], s96 offen offset:1024 lds
    buffer_load_dwordx4 v10, s[16:19], s96 offen offset:2048 lds
    buffer_load_dwordx4 v11, s[16:19], s96 offen offset:3072 lds
    s_add_u32 m0, s87, 69632
    s_nop 0
    buffer_load_dwordx4 v12, s[16:19], s96 offen offset:0 lds
    buffer_load_dwordx4 v13, s[16:19], s96 offen offset:1024 lds
    s_add_u32 s96, s95, 1
    s_and_b32 s96, s96, 15
    s_lshl_b32 s37, 1, s96
    s_lshl_b32 s38, 1, s98
    s_or_b32 s38, s38, s37
    s_lshl_b32 s30, s99, 13
    s_add_u32 s30, s30, 0xc00000
    s_mov_b32 s78, s27
pl_80:
    buffer_load_dword v17, v16, s[20:23], s30 offen sc1
    s_waitcnt vmcnt(0)
pc_81:
    v_cmp_ne_u32 vcc, -1, v17
    s_and_b32 s36, vcc_lo, s38
    s_cselect_b64 vcc, 0, -1
    s_cbranch_vccz pd_82
    s_sub_u32 s78, s78, 1
    s_cmp_lg_u32 s78, 0
    s_cbranch_scc1 pl_80
    s_mov_b32 s27, 1
pd_82:
    s_and_b32 s36, s36, s37
    s_cmp_eq_u32 s36, 0
    s_cbranch_scc1 sk_83
    s_add_u32 s96, s95, 1
    s_and_b32 s96, s96, 15
    s_lshl_b32 s97, s96, 14
    s_add_u32 s97, s97, s84
    s_add_u32 m0, s86, 131072
    s_nop 0
    buffer_load_dwordx4 v253, s[20:23], s97 offen offset:0 sc1 lds
    buffer_load_dwordx4 v253, s[20:23], s97 offen offset:1024 sc1 lds
    buffer_load_dwordx4 v253, s[20:23], s97 offen offset:2048 sc1 lds
    buffer_load_dwordx4 v253, s[20:23], s97 offen offset:3072 sc1 lds
sk_83:
    s_barrier
    s_lshl_b32 s30, s99, 13
    s_add_u32 s30, s30, 0xc00000
    s_add_u32 s31, s30, 4096
    buffer_load_dwordx4 v[64:67], v253, s[20:23], s30 offen offset:0 sc1
    buffer_load_dwordx4 v[68:71], v253, s[20:23], s30 offen offset:1024 sc1
    buffer_load_dwordx4 v[72:75], v253, s[20:23], s30 offen offset:2048 sc1
    buffer_load_dwordx4 v[76:79], v253, s[20:23], s30 offen offset:3072 sc1
    buffer_load_dwordx4 v[80:83], v253, s[20:23], s31 offen offset:0 sc1
    buffer_load_dwordx4 v[84:87], v253, s[20:23], s31 offen offset:1024 sc1
    buffer_load_dwordx4 v[88:91], v253, s[20:23], s31 offen offset:2048 sc1
    buffer_load_dwordx4 v[92:95], v253, s[20:23], s31 offen offset:3072 sc1
    s_add_u32 s96, s94, 2
    s_and_b32 s96, s96, 15
    s_mul_i32 s96, s96, 393216
    s_add_u32 s96, s96, s85
    s_add_u32 m0, s87, 90112
    s_nop 0
    buffer_load_dwordx4 v8, s[16:19], s96 offen offset:0 lds
    buffer_load_dwordx4 v9, s[16:19], s96 offen offset:1024 lds
    buffer_load_dwordx4 v10, s[16:19], s96 offen offset:2048 lds
    buffer_load_dwordx4 v11, s[16:19], s96 offen offset:3072 lds
    s_add_u32 m0, s87, 94208
    s_nop 0
    buffer_load_dwordx4 v12, s[16:19], s96 offen offset:0 lds
    buffer_load_dwordx4 v13, s[16:19], s96 offen offset:1024 lds
    ds_read_b128 v[32:35], v117 offset:0
    ds_read_b128 v[36:39], v117 offset:512
    ds_read_b128 v[40:43], v117 offset:1024
    ds_read_b128 v[44:47], v117 offset:1536
    s_mov_b32 s78, s27
    s_waitcnt vmcnt(6)
    s_branch pc_85
    s_nop 0
pl_84:
    s_lshl_b32 s30, s99, 13
    s_add_u32 s30, s30, 0xc00000
    s_add_u32 s31, s30, 4096
    buffer_load_dwordx4 v[64:67], v253, s[20:23], s30 offen offset:0 sc1
    buffer_load_dwordx4 v[68:71], v253, s[20:23], s30 offen offset:1024 sc1
    buffer_load_dwordx4 v[72:75], v253, s[20:23], s30 offen offset:2048 sc1
    buffer_load_dwordx4 v[76:79], v253, s[20:23], s30 offen offset:3072 sc1
    buffer_load_dwordx4 v[80:83], v253, s[20:23], s31 offen offset:0 sc1
    buffer_load_dwordx4 v[84:87], v253, s[20:23], s31 offen offset:1024 sc1
    buffer_load_dwordx4 v[88:91], v253, s[20:23], s31 offen offset:2048 sc1
    buffer_load_dwordx4 v[92:95], v253, s[20:23], s31 offen offset:3072 sc1
    s_waitcnt vmcnt(0)
pc_85:
    v_max3_u32 v48, v64, v68, v72
    v_max3_u32 v48, v48, v76, v80
    v_max3_u32 v48, v48, v84, v88
    v_max_u32 v48, v48, v92
    v_cmp_eq_u32_e64 vcc, -1, v48
    s_cbranch_vccz pd_86
    s_sub_u32 s78, s78, 1
    s_cmp_lg_u32 s78, 0
    s_cbranch_scc1 pl_84
    s_mov_b32 s27, 1
pd_86:
    s_cmp_lg_u32 s36, 0
    s_cbranch_scc1 sk_87
    s_add_u32 s96, s95, 1
    s_and_b32 s96, s96, 15
    s_lshl_b32 s97, s96, 14
    s_add_u32 s97, s97, s84
    s_add_u32 m0, s86, 131072
    s_nop 0
    buffer_load_dwordx4 v253, s[20:23], s97 offen offset:0 sc1 lds
    buffer_load_dwordx4 v253, s[20:23], s97 offen offset:1024 sc1 lds
    buffer_load_dwordx4 v253, s[20:23], s97 offen offset:2048 sc1 lds
    buffer_load_dwordx4 v253, s[20:23], s97 offen offset:3072 sc1 lds
sk_87:
    s_add_u32 s96, s94, 2
    s_and_b32 s96, s96, 15
    s_lshl_b32 s97, s96, 14
    s_add_u32 s97, s97, s84
    s_add_u32 m0, s86, 114688
    s_nop 0
    buffer_load_dwordx4 v253, s[20:23], s97 offen offset:0 sc1 lds
    v_add_f32 v64, v64, v68
    v_add_f32 v65, v65, v69
    v_add_f32 v66, v66, v70
    v_add_f32 v67, v67, v71
    v_add_f32 v64, v64, v72
    v_add_f32 v65, v65, v73
    v_add_f32 v66, v66, v74
    v_add_f32 v67, v67, v75
    v_add_f32 v64, v64, v76
    v_add_f32 v65, v65, v77
    v_add_f32 v66, v66, v78
    v_add_f32 v67, v67, v79
    v_add_f32 v64, v64, v80
    v_add_f32 v65, v65, v81
    v_add_f32 v66, v66, v82
    v_add_f32 v67, v67, v83
    v_add_f32 v64, v64, v84
    v_add_f32 v65, v65, v85
    v_add_f32 v66, v66, v86
    v_add_f32 v67, v67, v87
    v_add_f32 v64, v64, v88
    v_add_f32 v65, v65, v89
    v_add_f32 v66, v66, v90
    v_add_f32 v67, v67, v91
    v_add_f32 v64, v64, v92
    v_add_f32_e64 v65, v65, v93
    buffer_load_dwordx4 v253, s[20:23], s97 offen offset:1024 sc1 lds
    v_add_f32 v66, v66, v94
    v_add_f32 v67, v67, v95
    v_mov_b32 v48, v64
    v_mov_b32 v49, v65
    v_mov_b32 v50, v66
    v_mov_b32 v51, v67
    v_permlane32_swap_b32 v64, v48
    v_permlane32_swap_b32 v65, v49
    v_permlane32_swap_b32 v66, v50
    v_permlane32_swap_b32 v67, v51
    v_add_f32 v64, v64, v48
    v_add_f32 v65, v65, v49
    v_add_f32 v66, v66, v50
    v_add_f32 v67, v67, v51
    v_mul_f32 v54, 0x3a800000, v64
    v_mul_f32 v65, 0x3a800000, v65
    v_fma_f32 v65, -v54, v54, v65
    v_max_f32_e64 v65, 0, v65
    v_add_f32 v55, 0x3727c5ac, v65
    v_rsq_f32 v55, v55
    s_waitcnt lgkmcnt(0)
    v_fma_f32 v52, -v54, v67, v66
    v_and_b32_e64 v53, 31, v252
    v_mul_f32 v52, v52, v55
    s_lshl_b32 s32, s99, 5
    buffer_load_dwordx4 v253, s[20:23], s97 offen offset:2048 sc1 lds
    v_add_u32 v53, s32, v53
    v_mov_b32 v48, v52
    s_nop 1
    v_max_f32_dpp v48, v48, v48 quad_perm:[1,0,3,2] row_mask:0xf bank_mask:0xf
    s_nop 1
    v_max_f32_dpp v48, v48, v48 quad_perm:[2,3,0,1] row_mask:0xf bank_mask:0xf
    s_nop 1
    v_max_f32_dpp v48, v48, v48 row_half_mirror row_mask:0xf bank_mask:0xf
    s_nop 1
    v_max_f32_dpp v48, v48, v48 row_mirror row_mask:0xf bank_mask:0xf
    v_mov_b32 v49, v48
    s_nop 1
    v_permlane16_swap_b32 v48, v49
    v_max_f32 v48, v48, v49
    v_cmp_eq_f32 vcc, v48, v52
    v_lshrrev_b32 v50, 5, v252
    v_lshlrev_b32_e64 v50, 4, v50
    s_lshr_b32 s34, s25, 3
    v_lshl_add_u32 v51, s34, 28, v50
    s_lshl_b32 s32, s99, 11
    s_lshl_b32 s33, s98, 7
    s_add_u32 s32, s32, s33
    s_add_u32 s32, s32, 0xd60000
    s_and_b32 s34, s25, 7
    s_lshl_b32 s34, s34, 6
    s_add_u32 s34, s34, s99
    s_mul_i32 s34, s34, 32
    s_add_u32 s34, s34, 0xdc0000
    s_ff1_i32_b32 s35, vcc_lo
    s_lshl_b32 s35, 1, s35
    buffer_load_dwordx4 v253, s[20:23], s97 offen offset:3072 sc1 lds
    s_mov_b32 exec_lo, s35
    s_mov_b32 exec_hi, s35
    buffer_store_dwordx4 v[52:55], v51, s[20:23], s34 offen sc1
    buffer_store_dwordx4 v[32:35], v50, s[20:23], s32 offen offset:0 sc1
    buffer_store_dwordx4 v[36:39], v50, s[20:23], s32 offen offset:32 sc1
    buffer_store_dwordx4 v[40:43], v50, s[20:23], s32 offen offset:64 sc1
    buffer_store_dwordx4 v[44:47], v50, s[20:23], s32 offen offset:96 sc1
    s_mov_b64 exec, -1
    s_waitcnt vmcnt(9) lgkmcnt(0)
    s_barrier
    s_add_u32 s96, s95, 3
    s_and_b32 s96, s96, 15
    s_lshl_b32 s97, s96, 14
    s_add_u32 s97, s97, s84
    s_add_u32 m0, s86, 147456
    s_nop 0
    buffer_load_dwordx4 v253, s[20:23], s97 offen offset:0 sc1 lds
    buffer_load_dwordx4 v253, s[20:23], s97 offen offset:1024 sc1 lds
    buffer_load_dwordx4 v253, s[20:23], s97 offen offset:2048 sc1 lds
    buffer_load_dwordx4 v253, s[20:23], s97 offen offset:3072 sc1 lds
    s_add_u32 s96, s95, 3
    s_and_b32 s96, s96, 15
    s_mul_i32 s96, s96, 393216
    s_add_u32 s96, s96, s85
    s_add_u32 m0, s87, 40960
    s_nop 0
    buffer_load_dwordx4 v8, s[16:19], s96 offen offset:0 lds
    buffer_load_dwordx4 v9, s[16:19], s96 offen offset:1024 lds
    buffer_load_dwordx4 v10, s[16:19], s96 offen offset:2048 lds
    buffer_load_dwordx4 v11, s[16:19], s96 offen offset:3072 lds
    s_add_u32 m0, s87, 45056
    s_nop 0
    buffer_load_dwordx4 v12, s[16:19], s96 offen offset:0 lds
    buffer_load_dwordx4 v13, s[16:19], s96 offen offset:1024 lds
    s_waitcnt vmcnt(15) lgkmcnt(0)
    s_barrier
    s_add_u32 s96, s94, 4
    s_and_b32 s96, s96, 15
    s_lshl_b32 s97, s96, 14
    s_add_u32 s97, s97, s84
    s_add_u32 m0, s86, 131072
    s_nop 0
    buffer_load_dwordx4 v253, s[20:23], s97 offen offset:0 sc1 lds
    buffer_load_dwordx4 v253, s[20:23], s97 offen offset:1024 sc1 lds
    v_add_f32 v56, 1.0, v55
    v_mul_f32 v57, v54, v55
    v_mul_f32_e64 v58, v56, v56
    buffer_load_dwordx4 v253, s[20:23], s97 offen offset:2048 sc1 lds
    v_sub_f32 v57, 0, v57
    v_mul_f32 v58, v58, v65
    v_add_f32 v58, 0x3727c5ac, v58
    buffer_load_dwordx4 v253, s[20:23], s97 offen offset:3072 sc1 lds
    v_rsq_f32 v58, v58
    s_nop 0
    v_mul_f32 v58, v58, v56
    v_and_b32 v48, 31, v252
    s_add_u32 s96, s94, 4
    s_and_b32 s96, s96, 15
    s_mul_i32 s96, s96, 393216
    s_add_u32 s96, s96, s85
    s_add_u32 m0, s87, 65536
    s_nop 0
    buffer_load_dwordx4 v8, s[16:19], s96 offen offset:0 lds
    v_lshrrev_b32 v49, 5, v252
    v_cmp_eq_u32 vcc, 0, v49
    v_lshlrev_b32_e64 v49, 9, v49
    buffer_load_dwordx4 v9, s[16:19], s96 offen offset:1024 lds
    v_lshl_add_u32 v48, v48, 2, v49
    s_lshl_b32 s32, s28, 7
    v_add_u32 v48, s32, v48
    buffer_load_dwordx4 v10, s[16:19], s96 offen offset:2048 lds
    v_cndmask_b32 v49, v54, v58, vcc
    v_cndmask_b32 v50, v57, v56, vcc
    ds_write_b32 v48, v49 offset:0
    buffer_load_dwordx4 v11, s[16:19], s96 offen offset:3072 lds
    ds_write_b32 v48, v50 offset:2048
    v_and_b32 v48, 15, v252
    v_lshrrev_b32 v51, 4, v252
    s_add_u32 m0, s87, 69632
    s_nop 0
    buffer_load_dwordx4 v12, s[16:19], s96 offen offset:0 lds
    v_lshl_add_u32 v48, v48, 2, v51
    s_min_u32 s32, s28, 2
    s_lshl_b32 s32, s32, 8
    buffer_load_dwordx4 v13, s[16:19], s96 offen offset:1024 lds
    v_lshl_add_u32 v48, v48, 2, s32
    ds_write_b32 v48, v2 offset:1024
    s_waitcnt vmcnt(10) lgkmcnt(0)
    s_barrier
    s_add_u32 s96, s95, 5
    s_and_b32 s96, s96, 15
    s_lshl_b32 s97, s96, 14
    s_add_u32 s97, s97, s84
    s_add_u32 m0, s86, 114688
    s_nop 0
    buffer_load_dwordx4 v253, s[20:23], s97 offen offset:0 sc1 lds
    buffer_load_dwordx4 v253, s[20:23], s97 offen offset:1024 sc1 lds
    buffer_load_dwordx4 v253, s[20:23], s97 offen offset:2048 sc1 lds
    buffer_load_dwordx4 v253, s[20:23], s97 offen offset:3072 sc1 lds
    s_add_u32 s96, s95, 5
    s_and_b32 s96, s96, 15
    s_mul_i32 s96, s96, 393216
    s_add_u32 s96, s96, s85
    s_add_u32 m0, s87, 90112
    s_nop 0
    buffer_load_dwordx4 v8, s[16:19], s96 offen offset:0 lds
    buffer_load_dwordx4 v9, s[16:19], s96 offen offset:1024 lds
    buffer_load_dwordx4 v10, s[16:19], s96 offen offset:2048 lds
    buffer_load_dwordx4 v11, s[16:19], s96 offen offset:3072 lds
    s_add_u32 m0, s87, 94208
    s_nop 0
    buffer_load_dwordx4 v12, s[16:19], s96 offen offset:0 lds
    buffer_load_dwordx4 v13, s[16:19], s96 offen offset:1024 lds
    s_waitcnt vmcnt(10) lgkmcnt(0)
    s_barrier
    s_add_u32 s32, s79, 0xdc0000
    s_lshr_b32 vcc_lo, s24, 1
    s_mul_i32 vcc_lo, vcc_lo, 2048
    s_add_u32 s32, s32, vcc_lo
    v_lshlrev_b32_e64 v20, 1, v253
    buffer_load_dwordx4 v[16:19], v20, s[20:23], s32 offen sc1
    s_add_u32 s96, s94, 6
    s_and_b32 s96, s96, 15
    s_lshl_b32 s97, s96, 14
    s_add_u32 s97, s97, s84
    s_add_u32 m0, s86, 147456
    s_nop 0
    buffer_load_dwordx4 v253, s[20:23], s97 offen offset:0 sc1 lds
    buffer_load_dwordx4 v253, s[20:23], s97 offen offset:1024 sc1 lds
    buffer_load_dwordx4 v253, s[20:23], s97 offen offset:2048 sc1 lds
    buffer_load_dwordx4 v253, s[20:23], s97 offen offset:3072 sc1 lds
    s_add_u32 s96, s94, 6
    s_and_b32 s96, s96, 15
    s_mul_i32 s96, s96, 393216
    s_add_u32 s96, s96, s85
    s_add_u32 m0, s87, 40960
    s_nop 0
    buffer_load_dwordx4 v8, s[16:19], s96 offen offset:0 lds
    buffer_load_dwordx4 v9, s[16:19], s96 offen offset:1024 lds
    buffer_load_dwordx4 v10, s[16:19], s96 offen offset:2048 lds
    buffer_load_dwordx4 v11, s[16:19], s96 offen offset:3072 lds
    s_add_u32 m0, s87, 45056
    s_nop 0
    buffer_load_dwordx4 v12, s[16:19], s96 offen offset:0 lds
    buffer_load_dwordx4 v13, s[16:19], s96 offen offset:1024 lds
    s_waitcnt vmcnt(11) lgkmcnt(0)
    s_barrier
    s_add_u32 s96, s95, 7
    s_and_b32 s96, s96, 15
    s_lshl_b32 s97, s96, 14
    s_add_u32 s97, s97, s84
    s_add_u32 m0, s86, 131072
    s_nop 0
    buffer_load_dwordx4 v253, s[20:23], s97 offen offset:0 sc1 lds
    buffer_load_dwordx4 v253, s[20:23], s97 offen offset:1024 sc1 lds
    s_mov_b32 s78, s27
    s_waitcnt vmcnt(12)
    s_branch pc_100
pl_99:
    s_add_u32 s32, s79, 0xdc0000
    s_lshr_b32 vcc_lo, s24, 1
    s_mul_i32 vcc_lo, vcc_lo, 2048
    s_add_u32 s32, s32, vcc_lo
    v_lshlrev_b32 v20, 1, v253
    buffer_load_dwordx4 v[16:19], v20, s[20:23], s32 offen sc1
    s_waitcnt vmcnt(0)
pc_100:
    v_max3_u32 v20, v16, v17, v18
    v_max_u32 v20, v20, v19
    v_cmp_eq_u32 vcc, -1, v20
    s_cbranch_vccz pd_101
    s_sub_u32 s78, s78, 1
    s_cmp_lg_u32 s78, 0
    s_cbranch_scc1 pl_99
    s_mov_b32 s27, 1
pd_101:
    buffer_load_dwordx4 v253, s[20:23], s97 offen offset:2048 sc1 lds
    buffer_load_dwordx4 v253, s[20:23], s97 offen offset:3072 sc1 lds
    s_add_u32 s96, s95, 7
    s_and_b32 s96, s96, 15
    s_mul_i32 s96, s96, 393216
    s_add_u32 s96, s96, s85
    s_add_u32 m0, s87, 65536
    s_nop 0
    buffer_load_dwordx4 v8, s[16:19], s96 offen offset:0 lds
    v_mov_b32 v20, v16
    s_nop 1
    v_max_f32_dpp v20, v20, v20 quad_perm:[1,0,3,2] row_mask:0xf bank_mask:0xf
    s_nop 1
    v_max_f32_dpp v20, v20, v20 quad_perm:[2,3,0,1] row_mask:0xf bank_mask:0xf
    s_nop 1
    v_max_f32_dpp v20, v20, v20 row_half_mirror row_mask:0xf bank_mask:0xf
    buffer_load_dwordx4 v9, s[16:19], s96 offen offset:1024 lds
    s_nop 0
    v_max_f32_dpp v20, v20, v20 row_mirror row_mask:0xf bank_mask:0xf
    v_mov_b32 v21, v20
    s_nop 1
    v_permlane16_swap_b32 v20, v21
    v_max_f32 v20, v20, v21
    v_mov_b32 v21, v20
    s_nop 1
    v_permlane32_swap_b32 v20, v21
    buffer_load_dwordx4 v10, s[16:19], s96 offen offset:2048 lds
    v_max_f32 v20, v20, v21
    v_cmp_eq_f32 vcc, v20, v16
    s_ff1_i32_b64 s32, vcc
    s_and_b32 s32, s32, 63
    v_readlane_b32 s74, v16, s32
    v_readlane_b32 s73, v17, s32
    v_readlane_b32 s75, v18, s32
    buffer_load_dwordx4 v11, s[16:19], s96 offen offset:3072 lds
    v_readlane_b32 s76, v19, s32
    s_and_b32 s73, s73, 2047
    s_lshr_b32 s33, s73, 5
    s_lshl_b32 s33, s33, 11
    s_add_u32 s33, s33, s79
    s_add_u32 s33, s33, 0xd60000
    s_add_u32 m0, s87, 69632
    s_nop 0
    buffer_load_dwordx4 v12, s[16:19], s96 offen offset:0 lds
    buffer_load_dwordx4 v[24:27], v22, s[20:23], s33 offen sc1
    v_mov_b32 v20, s73
    v_mov_b32 v21, s77
    v_mov_b32_e64 v19, 0
    ds_write_b64 v19, v[20:21] offset:3072
    s_lshr_b32 s39, s73, 5
    s_lshl_b32 s34, s24, 2
    buffer_load_dwordx4 v13, s[16:19], s96 offen offset:1024 lds
    s_sub_u32 s39, s39, s34
    s_add_u32 s39, s39, 8
    s_lshr_b32 s34, s39, 3
    s_add_u32 s34, s34, 1
    s_cmp_lt_u32 s39, 12
    s_cselect_b32 s100, s34, 0
    s_waitcnt vmcnt(11) lgkmcnt(0)
    s_barrier
    s_add_u32 s96, s94, 8
    s_and_b32 s96, s96, 15
    s_lshl_b32 s97, s96, 14
    s_add_u32 s97, s97, s84
    s_add_u32 m0, s86, 114688
    s_nop 0
    buffer_load_dwordx4 v253, s[20:23], s97 offen offset:0 sc1 lds
    buffer_load_dwordx4 v253, s[20:23], s97 offen offset:1024 sc1 lds
    s_mov_b32 s78, s27
    s_waitcnt vmcnt(3)
    s_branch pc_89
    s_nop 0
pl_88:
    s_lshr_b32 s33, s73, 5
    s_lshl_b32 s33, s33, 11
    s_add_u32 s33, s33, s79
    s_add_u32 s33, s33, 0xd60000
    buffer_load_dwordx4 v[24:27], v22, s[20:23], s33 offen sc1
    s_waitcnt vmcnt(0)
pc_89:
    v_max3_u32 v30, v24, v25, v26
    v_max_u32 v30, v30, v27
    v_cmp_eq_u32 vcc, -1, v30
    s_cbranch_vccz pd_90
    s_sub_u32 s78, s78, 1
    s_cmp_lg_u32 s78, 0
    s_cbranch_scc1 pl_88
    s_mov_b32 s27, 1
pd_90:
    buffer_load_dwordx4 v253, s[20:23], s97 offen offset:2048 sc1 lds
    buffer_load_dwordx4 v253, s[20:23], s97 offen offset:3072 sc1 lds
    s_cmp_lt_i32 s89, 0
    s_cbranch_scc1 sk_91
    v_and_b32 v30, 16, v252
    v_cmp_eq_u32 vcc, 16, v30
    v_mov_b32 v28, s76
    v_mul_f32 v29, s75, v28
    v_add_f32 v28, 1.0, v28
    v_cndmask_b32 v30, v24, v25, vcc
    v_cndmask_b32_e64 v31, v26, v27, vcc
    s_mov_b32 vcc_lo, 0xaaaaaaaa
    s_mov_b32 vcc_hi, 0xaaaaaaaa
    v_mov_b32 v96, 0xbfb8aa3b
    v_mul_f32 v96, s74, v96
    v_exp_f32 v96, v96
    v_cndmask_b32 v30, v30, v31, vcc
    v_lshlrev_b32 v92, 16, v30
    v_and_b32 v93, 0xffff0000, v30
    v_fma_f32 v92, v92, v28, -v29
    v_fma_f32 v93, v93, v28, -v29
    v_add_f32 v96, 1.0, v96
    v_rcp_f32 v96, v96
sk_91:
    s_add_u32 s96, s94, 8
    s_and_b32 s96, s96, 15
    s_mul_i32 s96, s96, 393216
    s_add_u32 s96, s96, s85
    s_add_u32 m0, s87, 90112
    s_nop 0
    buffer_load_dwordx4 v8, s[16:19], s96 offen offset:0 lds
    buffer_load_dwordx4 v9, s[16:19], s96 offen offset:1024 lds
    v_mov_b32 v28, s76
    v_mul_f32 v29, s75, v28
    v_lshlrev_b32_e64 v30, 16, v24
    v_and_b32 v31, 0xffff0000, v24
    v_fma_f32 v30, v30, v28, -v29
    v_fma_f32 v31, v31, v28, -v29
    buffer_load_dwordx4 v10, s[16:19], s96 offen offset:2048 lds
    v_cvt_pk_bf16_f32 v24, v30, v31
    v_lshlrev_b32_e64 v30, 16, v25
    v_and_b32 v31, 0xffff0000, v25
    v_fma_f32 v30, v30, v28, -v29
    v_fma_f32 v31, v31, v28, -v29
    v_cvt_pk_bf16_f32 v25, v30, v31
    v_lshlrev_b32_e64 v30, 16, v26
    v_and_b32 v31, 0xffff0000, v26
    v_fma_f32 v30, v30, v28, -v29
    v_fma_f32 v31, v31, v28, -v29
    buffer_load_dwordx4 v11, s[16:19], s96 offen offset:3072 lds
    v_cvt_pk_bf16_f32 v26, v30, v31
    v_lshlrev_b32_e64 v30, 16, v27
    v_and_b32 v31, 0xffff0000, v27
    v_fma_f32 v30, v30, v28, -v29
    v_fma_f32 v31, v31, v28, -v29
    v_cvt_pk_bf16_f32 v27, v30, v31
    s_bitcmp0_b32 s29, 0
    s_cbranch_scc1 sk_92
    v_swap_b32 v24, v25
    v_swap_b32 v26, v27
sk_92:
    s_add_u32 m0, s87, 94208
    s_nop 0
    buffer_load_dwordx4 v12, s[16:19], s96 offen offset:0 lds
    s_bitcmp0_b32 s29, 1
    s_cbranch_scc1 sk_93
    v_swap_b32 v24, v26
    v_swap_b32 v25, v27
sk_93:
    buffer_load_dwordx4 v13, s[16:19], s96 offen offset:1024 lds
    s_cmp_ge_u32 s29, 224
    s_cbranch_scc1 sk_94
    v_dot2_f32_bf16 v32, v155, v24, 0
    v_dot2_f32_bf16 v33, v160, v24, 0
    v_dot2_f32_bf16 v34, v156, v24, 0
    v_dot2_f32_bf16 v35, v161, v24, 0
    v_dot2_f32_bf16 v36, v157, v24, 0
    v_dot2_f32_bf16 v37, v162, v24, 0
    v_dot2_f32_bf16 v38, v158, v24, 0
    v_dot2_f32_bf16 v39, v163, v24, 0
    v_dot2_f32_bf16 v40, v183, v24, 0
    v_dot2_f32_bf16 v41, v192, v24, 0
    v_dot2_f32_bf16 v42, v188, v24, 0
    v_dot2_f32_bf16 v43, v193, v24, 0
    v_dot2_f32_bf16 v44, v189, v24, 0
    v_dot2_f32_bf16 v45, v194, v24, 0
    v_dot2_f32_bf16 v46, v190, v24, 0
    v_dot2_f32_bf16 v47, v195, v24, 0
    v_dot2_f32_bf16 v32, v159, v25, v32
    v_dot2_f32_bf16 v33, v168, v25, v33
    v_dot2_f32_bf16 v34, v164, v25, v34
    v_dot2_f32_bf16 v35, v169, v25, v35
    v_dot2_f32_bf16 v36, v165, v25, v36
    v_dot2_f32_bf16 v37, v170, v25, v37
    v_dot2_f32_bf16 v38, v166, v25, v38
    v_dot2_f32_bf16 v39, v171, v25, v39
    v_dot2_f32_bf16 v40, v191, v25, v40
    v_dot2_f32_bf16 v41, v200, v25, v41
    v_dot2_f32_bf16 v42, v196, v25, v42
    v_dot2_f32_bf16 v43, v201, v25, v43
    v_dot2_f32_bf16 v44, v197, v25, v44
    v_dot2_f32_bf16 v45, v202, v25, v45
    v_dot2_f32_bf16 v46, v198, v25, v46
    v_dot2_f32_bf16 v47, v203, v25, v47
    v_dot2_f32_bf16 v32, v167, v26, v32
    v_dot2_f32_bf16 v33, v176, v26, v33
    v_dot2_f32_bf16 v34, v172, v26, v34
    v_dot2_f32_bf16 v35, v177, v26, v35
    v_dot2_f32_bf16 v36, v173, v26, v36
    v_dot2_f32_bf16 v37, v178, v26, v37
    v_dot2_f32_bf16 v38, v174, v26, v38
    v_dot2_f32_bf16 v39, v179, v26, v39
    v_dot2_f32_bf16 v40, v199, v26, v40
    v_dot2_f32_bf16 v41, v208, v26, v41
    v_dot2_f32_bf16 v42, v204, v26, v42
    v_dot2_f32_bf16 v43, v209, v26, v43
    v_dot2_f32_bf16 v44, v205, v26, v44
    v_dot2_f32_bf16 v45, v210, v26, v45
    v_dot2_f32_bf16 v46, v206, v26, v46
    v_dot2_f32_bf16 v47, v211, v26, v47
    v_dot2_f32_bf16 v32, v175, v27, v32
    v_dot2_f32_bf16 v33, v184, v27, v33
    v_dot2_f32_bf16 v34, v180, v27, v34
    v_dot2_f32_bf16 v35, v185, v27, v35
    v_dot2_f32_bf16 v36, v181, v27, v36
    v_dot2_f32_bf16 v37, v186, v27, v37
    v_dot2_f32_bf16 v38, v182, v27, v38
    v_dot2_f32_bf16 v39, v187, v27, v39
    v_dot2_f32_bf16 v40, v207, v27, v40
    v_dot2_f32_bf16 v41, v216, v27, v41
    v_dot2_f32_bf16 v42, v212, v27, v42
    v_dot2_f32_bf16 v43, v217, v27, v43
    v_dot2_f32_bf16 v44, v213, v27, v44
    v_dot2_f32_bf16 v45, v218, v27, v45
    v_dot2_f32_bf16 v46, v214, v27, v46
    v_dot2_f32_bf16 v47, v219, v27, v47
sk_94:
    s_waitcnt vmcnt(10) lgkmcnt(0)
    s_barrier
    s_add_u32 s96, s95, 9
    s_and_b32 s96, s96, 15
    s_lshl_b32 s97, s96, 14
    s_add_u32 s97, s97, s84
    s_add_u32 m0, s86, 147456
    s_nop 0
    buffer_load_dwordx4 v253, s[20:23], s97 offen offset:0 sc1 lds
    buffer_load_dwordx4 v253, s[20:23], s97 offen offset:1024 sc1 lds
    v_lshrrev_b32 v31, 5, v252
    v_lshlrev_b32 v30, 6, v31
    v_permlane32_swap_b32 v32, v40
    v_permlane32_swap_b32 v33, v41
    v_permlane32_swap_b32 v34, v42
    v_permlane32_swap_b32_e64 v35, v43
    buffer_load_dwordx4 v253, s[20:23], s97 offen offset:2048 sc1 lds
    v_permlane32_swap_b32 v36, v44
    v_permlane32_swap_b32 v37, v45
    v_permlane32_swap_b32 v38, v46
    v_permlane32_swap_b32 v39, v47
    v_add_f32_e64 v32, v32, v40
    buffer_load_dwordx4 v253, s[20:23], s97 offen offset:3072 sc1 lds
    v_add_f32 v33, v33, v41
    v_add_f32 v34, v34, v42
    v_add_f32 v35, v35, v43
    v_add_f32 v36, v36, v44
    v_add_f32_e64 v37, v37, v45
    s_add_u32 s96, s95, 9
    s_and_b32 s96, s96, 15
    s_mul_i32 s96, s96, 393216
    s_add_u32 s96, s96, s85
    s_add_u32 m0, s87, 40960
    s_nop 0
    buffer_load_dwordx4 v8, s[16:19], s96 offen offset:0 lds
    v_add_f32 v38, v38, v46
    v_add_f32 v39, v39, v47
    v_and_b32_e64 v31, 1, v252
    v_lshl_add_u32 v30, v31, 5, v30
    v_permlane16_swap_b32_e64 v32, v36
    buffer_load_dwordx4 v9, s[16:19], s96 offen offset:1024 lds
    v_permlane16_swap_b32 v33, v37
    v_permlane16_swap_b32 v34, v38
    v_permlane16_swap_b32 v35, v39
    v_add_f32 v32, v32, v36
    v_add_f32 v33, v33, v37
    v_add_f32 v34, v34, v38
    buffer_load_dwordx4 v10, s[16:19], s96 offen offset:2048 lds
    v_add_f32 v35, v35, v39
    v_and_b32 v31, 16, v252
    s_lshl_b32 s32, s28, 7
    v_add3_u32 v30, v31, v30, s32
    v_add_f32_dpp v32, v32, v32 quad_perm:[2,3,0,1] row_mask:0xf bank_mask:0xf
    buffer_load_dwordx4 v11, s[16:19], s96 offen offset:3072 lds
    v_add_f32_dpp v33, v33, v33 quad_perm:[2,3,0,1] row_mask:0xf bank_mask:0xf
    v_add_f32_dpp v34, v34, v34 quad_perm:[2,3,0,1] row_mask:0xf bank_mask:0xf
    v_add_f32_dpp v35, v35, v35 quad_perm:[2,3,0,1] row_mask:0xf bank_mask:0xf
    v_add_f32_dpp v32, v32, v32 row_ror:4 row_mask:0xf bank_mask:0xf
    v_add_f32_dpp v33, v33, v33 row_ror:4 row_mask:0xf bank_mask:0xf
    s_add_u32 m0, s87, 45056
    s_nop 0
    buffer_load_dwordx4 v12, s[16:19], s96 offen offset:0 lds
    v_add_f32_dpp v34, v34, v34 row_ror:4 row_mask:0xf bank_mask:0xf
    v_add_f32_dpp v35, v35, v35 row_ror:4 row_mask:0xf bank_mask:0xf
    v_add_f32_dpp v32, v32, v32 row_ror:8 row_mask:0xf bank_mask:0xf
    v_add_f32_dpp v33, v33, v33 row_ror:8 row_mask:0xf bank_mask:0xf
    v_add_f32_dpp v34, v34, v34 row_ror:8 row_mask:0xf bank_mask:0xf
    buffer_load_dwordx4 v13, s[16:19], s96 offen offset:1024 lds
    v_add_f32_dpp v35, v35, v35 row_ror:8 row_mask:0xf bank_mask:0xf
    s_mov_b32 exec_lo, 0x00030003
    s_mov_b32 exec_hi, 0x00030003
    ds_write_b128 v30, v[32:35] offset:3328
    s_mov_b64 exec, -1
    s_waitcnt vmcnt(10) lgkmcnt(0)
    s_barrier
    s_add_u32 s96, s94, 10
    s_and_b32 s96, s96, 15
    s_lshl_b32 s97, s96, 14
    s_add_u32 s97, s97, s84
    s_add_u32 m0, s86, 131072
    s_nop 0
    buffer_load_dwordx4 v253, s[20:23], s97 offen offset:0 sc1 lds
    buffer_load_dwordx4 v253, s[20:23], s97 offen offset:1024 sc1 lds
    v_and_b32_e64 v30, 1, v252
    v_bfe_u32 v31, v252, 1, 3
    v_lshl_add_u32 v30, v30, 3, v31
    v_lshlrev_b32_e64 v30, 2, v30
    v_add_u32 v30, 3328, v30
    ds_read2_b32 v[32:33], v30 offset0:0 offset1:16
    buffer_load_dwordx4 v253, s[20:23], s97 offen offset:2048 sc1 lds
    ds_read2_b32 v[34:35], v30 offset0:32 offset1:48
    ds_read2_b32 v[36:37], v30 offset0:64 offset1:80
    ds_read2_b32 v[38:39], v30 offset0:96 offset1:112
    v_lshrrev_b32_e64 v30, 2, v252
    v_mul_u32_u24 v30, 7168, v30
    buffer_load_dwordx4 v253, s[20:23], s97 offen offset:3072 sc1 lds
    v_and_b32_e64 v31, 2, v252
    v_lshl_add_u32 v30, v31, 3, v30
    s_add_u32 s32, s29, 32
    s_lshr_b32 s32, s32, 8
    v_lshl_add_u32 v30, s32, 31, v30
    s_add_u32 s96, s94, 10
    s_and_b32 s96, s96, 15
    s_mul_i32 s96, s96, 393216
    s_add_u32 s96, s96, s85
    s_add_u32 m0, s87, 65536
    s_nop 0
    buffer_load_dwordx4 v8, s[16:19], s96 offen offset:0 lds
    s_mul_i32 s32, s28, 114688
    s_mul_i32 s33, s29, 32
    s_add_u32 s32, s32, s33
    s_add_u32 s32, s32, s79
    s_add_u32 s32, s32, 0xc80000
    buffer_load_dwordx4 v9, s[16:19], s96 offen offset:1024 lds
    s_waitcnt lgkmcnt(0)
    v_add_f32 v32, v32, v34
    v_add_f32 v33, v33, v35
    v_add_f32 v36, v36, v38
    v_add_f32 v37, v37, v39
    buffer_load_dwordx4 v10, s[16:19], s96 offen offset:2048 lds
    v_add_f32 v32, v32, v36
    v_add_f32 v33, v33, v37
    v_mul_f32 v34, 0xbfb8aa3b, v32
    v_exp_f32 v34, v34
    v_mul_f32 v32, v32, v33
    buffer_load_dwordx4 v11, s[16:19], s96 offen offset:3072 lds
    v_add_f32 v34, 1.0, v34
    v_rcp_f32 v34, v34
    s_nop 0
    v_mul_f32 v32, v32, v34
    s_nop 1
    v_mov_b32_dpp v33, v32 quad_perm:[2,3,2,3] row_mask:0xf bank_mask:0xf
    v_cvt_pk_bf16_f32 v32, v32, v33
    s_add_u32 m0, s87, 69632
    s_nop 0
    buffer_load_dwordx4 v12, s[16:19], s96 offen offset:0 lds
    ds_swizzle_b32 v36, v32 offset:0x1
    ds_swizzle_b32 v37, v32 offset:0x81
    ds_swizzle_b32 v38, v32 offset:0x101
    ds_swizzle_b32 v39, v32 offset:0x181
    s_waitcnt lgkmcnt(0)
    buffer_load_dwordx4 v13, s[16:19], s96 offen offset:1024 lds
    s_cmp_ge_u32 s29, 224
    s_cbranch_scc1 sk_95
    v_dot2_f32_bf16 v40, v215, v36, 0
    v_dot2_f32_bf16 v41, v224, v36, 0
    v_dot2_f32_bf16 v42, v220, v36, 0
    v_dot2_f32_bf16 v43, v225, v36, 0
    v_dot2_f32_bf16 v44, v221, v36, 0
    v_dot2_f32_bf16 v45, v226, v36, 0
    v_dot2_f32_bf16 v46, v222, v36, 0
    v_dot2_f32_bf16 v47, v227, v36, 0
    v_dot2_f32_bf16 v40, v223, v37, v40
    v_dot2_f32_bf16 v41, v232, v37, v41
    v_dot2_f32_bf16 v42, v228, v37, v42
    v_dot2_f32_bf16 v43, v233, v37, v43
    v_dot2_f32_bf16 v44, v229, v37, v44
    v_dot2_f32_bf16 v45, v234, v37, v45
    v_dot2_f32_bf16 v46, v230, v37, v46
    v_dot2_f32_bf16 v47, v235, v37, v47
    v_dot2_f32_bf16 v40, v231, v38, v40
    v_dot2_f32_bf16 v41, v240, v38, v41
    v_dot2_f32_bf16 v42, v236, v38, v42
    v_dot2_f32_bf16 v43, v241, v38, v43
    v_dot2_f32_bf16 v44, v237, v38, v44
    v_dot2_f32_bf16 v45, v242, v38, v45
    v_dot2_f32_bf16 v46, v238, v38, v46
    v_dot2_f32_bf16 v47, v243, v38, v47
    v_dot2_f32_bf16 v40, v239, v39, v40
    v_dot2_f32_bf16 v41, v248, v39, v41
    v_dot2_f32_bf16 v42, v244, v39, v42
    v_dot2_f32_bf16 v43, v249, v39, v43
    v_dot2_f32_bf16 v44, v245, v39, v44
    v_dot2_f32_bf16 v45, v250, v39, v45
    v_dot2_f32_bf16 v46, v246, v39, v46
    v_dot2_f32_bf16 v47, v251, v39, v47
sk_95:
    v_add_f32_dpp v40, v40, v40 quad_perm:[1,0,3,2] row_mask:0xf bank_mask:0xf
    v_add_f32_dpp v41, v41, v41 quad_perm:[1,0,3,2] row_mask:0xf bank_mask:0xf
    v_add_f32_dpp v42, v42, v42 quad_perm:[1,0,3,2] row_mask:0xf bank_mask:0xf
    v_add_f32_dpp v43, v43, v43 quad_perm:[1,0,3,2] row_mask:0xf bank_mask:0xf
    v_add_f32_dpp v44, v44, v44 quad_perm:[1,0,3,2] row_mask:0xf bank_mask:0xf
    v_add_f32_dpp v45, v45, v45 quad_perm:[1,0,3,2] row_mask:0xf bank_mask:0xf
    v_add_f32_dpp v46, v46, v46 quad_perm:[1,0,3,2] row_mask:0xf bank_mask:0xf
    v_add_f32_dpp v47, v47, v47 quad_perm:[1,0,3,2] row_mask:0xf bank_mask:0xf
    s_mov_b32 exec_lo, 0x55555555
    s_mov_b32 exec_hi, 0x55555555
    v_cvt_pk_bf16_f32 v40, v40, v41
    v_cvt_pk_bf16_f32 v41, v42, v43
    v_cvt_pk_bf16_f32 v42, v44, v45
    v_cvt_pk_bf16_f32 v43, v46, v47
    buffer_store_dwordx4 v[40:43], v30, s[20:23], s32 offen sc1
    s_mov_b64 exec, -1
    s_waitcnt vmcnt(11) lgkmcnt(0)
    s_barrier
    s_add_u32 s96, s95, 11
    s_and_b32 s96, s96, 15
    s_lshl_b32 s97, s96, 14
    s_add_u32 s97, s97, s84
    s_add_u32 m0, s86, 114688
    s_nop 0
    buffer_load_dwordx4 v253, s[20:23], s97 offen offset:0 sc1 lds
    buffer_load_dwordx4 v253, s[20:23], s97 offen offset:1024 sc1 lds
    buffer_load_dwordx4 v253, s[20:23], s97 offen offset:2048 sc1 lds
    buffer_load_dwordx4 v253, s[20:23], s97 offen offset:3072 sc1 lds
    s_add_u32 s96, s95, 11
    s_and_b32 s96, s96, 15
    s_mul_i32 s96, s96, 393216
    s_add_u32 s96, s96, s85
    s_add_u32 m0, s87, 90112
    s_nop 0
    buffer_load_dwordx4 v8, s[16:19], s96 offen offset:0 lds
    buffer_load_dwordx4 v9, s[16:19], s96 offen offset:1024 lds
    buffer_load_dwordx4 v10, s[16:19], s96 offen offset:2048 lds
    buffer_load_dwordx4 v11, s[16:19], s96 offen offset:3072 lds
    s_add_u32 m0, s87, 94208
    s_nop 0
    buffer_load_dwordx4 v12, s[16:19], s96 offen offset:0 lds
    buffer_load_dwordx4 v13, s[16:19], s96 offen offset:1024 lds
    s_waitcnt vmcnt(11) lgkmcnt(0)
    s_barrier
    s_add_u32 s96, s94, 12
    s_and_b32 s96, s96, 15
    s_lshl_b32 s97, s96, 14
    s_add_u32 s97, s97, s84
    s_add_u32 m0, s86, 147456
    s_nop 0
    buffer_load_dwordx4 v253, s[20:23], s97 offen offset:0 sc1 lds
    buffer_load_dwordx4 v253, s[20:23], s97 offen offset:1024 sc1 lds
    buffer_load_dwordx4 v253, s[20:23], s97 offen offset:2048 sc1 lds
    buffer_load_dwordx4 v253, s[20:23], s97 offen offset:3072 sc1 lds
    s_add_u32 s96, s94, 12
    s_and_b32 s96, s96, 15
    s_mul_i32 s96, s96, 393216
    s_add_u32 s96, s96, s85
    s_add_u32 m0, s87, 40960
    s_nop 0
    buffer_load_dwordx4 v8, s[16:19], s96 offen offset:0 lds
    buffer_load_dwordx4 v9, s[16:19], s96 offen offset:1024 lds
    buffer_load_dwordx4 v10, s[16:19], s96 offen offset:2048 lds
    buffer_load_dwordx4 v11, s[16:19], s96 offen offset:3072 lds
    s_add_u32 m0, s87, 45056
    s_nop 0
    buffer_load_dwordx4 v12, s[16:19], s96 offen offset:0 lds
    buffer_load_dwordx4 v13, s[16:19], s96 offen offset:1024 lds
    s_waitcnt vmcnt(10) lgkmcnt(0)
    s_barrier
    s_cmp_lt_i32 s89, 0
    s_cbranch_scc0 q_red
    s_add_u32 s96, s95, 13
    s_and_b32 s96, s96, 15
    s_lshl_b32 s97, s96, 14
    s_add_u32 s97, s97, s84
    s_add_u32 m0, s86, 131072
    s_nop 0
    buffer_load_dwordx4 v253, s[20:23], s97 offen offset:0 sc1 lds
    buffer_load_dwordx4 v253, s[20:23], s97 offen offset:1024 sc1 lds
    buffer_load_dwordx4 v253, s[20:23], s97 offen offset:2048 sc1 lds
    buffer_load_dwordx4 v253, s[20:23], s97 offen offset:3072 sc1 lds
    s_add_u32 s96, s95, 13
    s_and_b32 s96, s96, 15
    s_mul_i32 s96, s96, 393216
    s_add_u32 s96, s96, s85
    s_add_u32 m0, s87, 65536
    s_nop 0
    buffer_load_dwordx4 v8, s[16:19], s96 offen offset:0 lds
    buffer_load_dwordx4 v9, s[16:19], s96 offen offset:1024 lds
    buffer_load_dwordx4 v10, s[16:19], s96 offen offset:2048 lds
    buffer_load_dwordx4 v11, s[16:19], s96 offen offset:3072 lds
    s_add_u32 m0, s87, 69632
    s_nop 0
    buffer_load_dwordx4 v12, s[16:19], s96 offen offset:0 lds
    buffer_load_dwordx4 v13, s[16:19], s96 offen offset:1024 lds
    s_waitcnt vmcnt(10) lgkmcnt(0)
    s_barrier
    s_add_u32 s96, s94, 14
    s_and_b32 s96, s96, 15
    s_lshl_b32 s97, s96, 14
    s_add_u32 s97, s97, s84
    s_add_u32 m0, s86, 114688
    s_nop 0
    buffer_load_dwordx4 v253, s[20:23], s97 offen offset:0 sc1 lds
    buffer_load_dwordx4 v253, s[20:23], s97 offen offset:1024 sc1 lds
    buffer_load_dwordx4 v253, s[20:23], s97 offen offset:2048 sc1 lds
    buffer_load_dwordx4 v253, s[20:23], s97 offen offset:3072 sc1 lds
    s_add_u32 s96, s94, 14
    s_and_b32 s96, s96, 15
    s_mul_i32 s96, s96, 393216
    s_add_u32 s96, s96, s85
    s_add_u32 m0, s87, 90112
    s_nop 0
    buffer_load_dwordx4 v8, s[16:19], s96 offen offset:0 lds
    buffer_load_dwordx4 v9, s[16:19], s96 offen offset:1024 lds
    buffer_load_dwordx4 v10, s[16:19], s96 offen offset:2048 lds
    buffer_load_dwordx4 v11, s[16:19], s96 offen offset:3072 lds
    s_add_u32 m0, s87, 94208
    s_nop 0
    buffer_load_dwordx4 v12, s[16:19], s96 offen offset:0 lds
    buffer_load_dwordx4 v13, s[16:19], s96 offen offset:1024 lds
    s_waitcnt vmcnt(10) lgkmcnt(0)
    s_barrier
    s_add_u32 s96, s95, 15
    s_and_b32 s96, s96, 15
    s_lshl_b32 s97, s96, 14
    s_add_u32 s97, s97, s84
    s_add_u32 m0, s86, 147456
    s_nop 0
    buffer_load_dwordx4 v253, s[20:23], s97 offen offset:0 sc1 lds
    buffer_load_dwordx4 v253, s[20:23], s97 offen offset:1024 sc1 lds
    buffer_load_dwordx4 v253, s[20:23], s97 offen offset:2048 sc1 lds
    buffer_load_dwordx4 v253, s[20:23], s97 offen offset:3072 sc1 lds
    s_add_u32 s96, s95, 15
    s_and_b32 s96, s96, 15
    s_mul_i32 s96, s96, 393216
    s_add_u32 s96, s96, s85
    s_add_u32 m0, s87, 40960
    s_nop 0
    buffer_load_dwordx4 v8, s[16:19], s96 offen offset:0 lds
    buffer_load_dwordx4 v9, s[16:19], s96 offen offset:1024 lds
    buffer_load_dwordx4 v10, s[16:19], s96 offen offset:2048 lds
    buffer_load_dwordx4 v11, s[16:19], s96 offen offset:3072 lds
    s_add_u32 m0, s87, 45056
    s_nop 0
    buffer_load_dwordx4 v12, s[16:19], s96 offen offset:0 lds
    buffer_load_dwordx4 v13, s[16:19], s96 offen offset:1024 lds
    s_waitcnt vmcnt(10) lgkmcnt(0)
    s_barrier
    s_min_u32 s30, s28, 2
    s_lshl_b32 s30, s30, 13
    s_add_u32 s30, s30, 90112
    v_lshrrev_b32 v20, 2, v252
    v_bfe_u32 v21, v20, 1, 2
    v_lshlrev_b32_e64 v20, 7, v20
    v_lshl_add_u32 v20, v21, 5, v20
    v_and_b32_e64 v21, 3, v252
    v_lshl_add_u32 v20, v21, 3, v20
    v_add_u32 v144, s30, v20
    v_xor_b32 v145, 32, v144
    v_xor_b32_e64 v146, 64, v144
    v_xor_b32 v147, 96, v144
    ds_read_b64_tr_b16 v[100:101], v144 offset:0
    ds_read_b64_tr_b16 v[102:103], v144 offset:2048
    ds_read_b64_tr_b16 v[104:105], v144 offset:4096
    ds_read_b64_tr_b16 v[106:107], v144 offset:6144
    ds_read_b64_tr_b16 v[108:109], v145 offset:0
    ds_read_b64_tr_b16 v[110:111], v145 offset:2048
    ds_read_b64_tr_b16 v[112:113], v145 offset:4096
    ds_read_b64_tr_b16 v[114:115], v145 offset:6144
    ds_read_b64_tr_b16 v[116:117], v146 offset:0
    ds_read_b64_tr_b16 v[118:119], v146 offset:2048
    ds_read_b64_tr_b16 v[120:121], v146 offset:4096
    ds_read_b64_tr_b16 v[122:123], v146 offset:6144
    ds_read_b64_tr_b16 v[124:125], v147 offset:0
    ds_read_b64_tr_b16 v[126:127], v147 offset:2048
    ds_read_b64_tr_b16 v[128:129], v147 offset:4096
    ds_read_b64_tr_b16 v[130:131], v147 offset:6144
    s_getpc_b64 s[32:33]
pc_102:
    s_sub_u32 s32, s32, pc_102-interleave_layers__sliding_block__moe_arch_mod__prompt_kernel
    s_subb_u32 s33, s33, 0
    s_lshr_b32 s34, s2, 3
    s_lshl_b32 s34, s34, 2
    s_add_u32 s34, s34, s28
    s_and_b32 s34, s34, 127
    s_lshl_b32 s34, s34, 7
    v_lshl_add_u32 v154, v252, 14, s34
    s_mov_b32 s34, k_exit-interleave_layers__sliding_block__moe_arch_mod__prompt_kernel
    s_mov_b32 s35, 0x20000
    buffer_load_dword v154, v154, s[32:35], 0 offen
q_join:
    s_waitcnt vmcnt(1) lgkmcnt(0)
    s_barrier
    s_add_u32 s35, s94, 14
    s_and_b32 s35, s35, 15
    s_lshl_b32 s35, s35, 7
    s_lshr_b32 vcc_lo, s24, 1
    s_lshl_b32 vcc_lo, vcc_lo, 11
    s_add_u32 vcc_lo, vcc_lo, s35
    s_add_u32 s35, vcc_lo, 0xdc4000
    v_and_b32_e64 v19, 32, v252
    v_bfe_u32 v18, v252, 4, 1
    v_lshl_add_u32 v19, v18, 3, v19
    buffer_load_dwordx2 v[132:133], v19, s[20:23], s35 offen offset:0 sc1
    buffer_load_dwordx2 v[134:135], v19, s[20:23], s35 offen offset:16 sc1
    buffer_load_dwordx2 v[136:137], v19, s[20:23], s35 offen offset:64 sc1
    buffer_load_dwordx2 v[138:139], v19, s[20:23], s35 offen offset:80 sc1
    s_cmp_eq_u32 s100, 0
    s_cbranch_scc1 sk_104
    v_and_b32 v20, 7, v252
    v_lshrrev_b32 v21, 4, v252
    v_lshl_add_u32 v21, v20, 2, v21
    s_and_b32 s34, s73, 31
    s_and_b32 s32, s34, 7
    s_and_b32 s33, s34, 8
    s_lshl_b32 s33, s33, 1
    s_add_u32 s32, s32, s33
    s_lshr_b32 s33, s34, 4
    s_lshl_b32 s33, s33, 3
    s_add_u32 s32, s32, s33
    s_cmp_eq_u32 s28, 1
    s_cselect_b32 s34, s32, s34
    v_mov_b32_e64 v20, s34
    s_cmp_ge_u32 s28, 2
    s_cselect_b64 vcc, -1, 0
    s_cselect_b32 s32, 2048, 0
    v_cndmask_b32 v30, v20, v21, vcc
    v_cndmask_b32 v31, v21, v20, vcc
    v_lshlrev_b32_e64 v0, 4, v30
    v_bfe_u32 v20, v31, 2, 2
    v_lshl_add_u32 v0, v20, 9, v0
    v_lshrrev_b32_e64 v20, 4, v31
    v_lshl_add_u32 v0, v20, 3, v0
    v_and_b32 v20, 3, v31
    v_lshl_add_u32 v0, v20, 1, v0
    s_lshl_b32 s33, s39, 12
    s_add_u32 s33, s33, s32
    s_add_u32 s33, s33, 65536
    s_lshl_b32 s34, s39, 11
    s_add_u32 s34, s34, 32768
    s_cmp_ge_u32 s39, 8
    s_cselect_b32 s38, 1, 0
    s_movk_i32 s32, 8192
    s_cmp_eq_u32 s28, 0
    s_cselect_b32 s33, s34, s33
    s_cselect_b32 s32, s32, 49152
    s_cselect_b32 s38, s38, 1
    s_cselect_b32 s37, 0x3e8293ee, 1.0
    v_bfe_u32 v20, v252, 3, 1
    v_mul_u32_u24_e64 v20, s32, v20
    v_add3_u32 v0, v0, v20, s33
sk_104:
    s_waitcnt lgkmcnt(0)
    s_barrier
    s_mov_b32 s78, s27
    s_waitcnt vmcnt(0)
    s_branch pc_106
    s_nop 0
pl_105:
    s_add_u32 s35, s94, 14
    s_and_b32 s35, s35, 15
    s_lshl_b32 s35, s35, 7
    s_lshr_b32 vcc_lo, s24, 1
    s_lshl_b32 vcc_lo, vcc_lo, 11
    s_add_u32 vcc_lo, vcc_lo, s35
    s_add_u32 s35, vcc_lo, 0xdc4000
    v_and_b32_e64 v19, 32, v252
    v_bfe_u32 v18, v252, 4, 1
    v_lshl_add_u32 v19, v18, 3, v19
    buffer_load_dwordx2 v[132:133], v19, s[20:23], s35 offen offset:0 sc1
    buffer_load_dwordx2 v[134:135], v19, s[20:23], s35 offen offset:16 sc1
    buffer_load_dwordx2 v[136:137], v19, s[20:23], s35 offen offset:64 sc1
    buffer_load_dwordx2 v[138:139], v19, s[20:23], s35 offen offset:80 sc1
    s_waitcnt vmcnt(0)
pc_106:
    v_max3_u32 v30, v132, v133, v134
    v_max3_u32 v30, v30, v135, v136
    v_max3_u32 v30, v30, v137, v138
    v_max_u32 v30, v30, v139
    v_cmp_eq_u32 vcc, -1, v30
    s_cbranch_vccz pd_107
    s_sub_u32 s78, s78, 1
    s_cmp_lg_u32 s78, 0
    s_cbranch_scc1 pl_105
    s_mov_b32 s27, 1
pd_107:
    v_mov_b32 v140, 0
    v_mov_b32 v141, 0
    v_mov_b32 v142, 0
    v_mov_b32 v143, 0
    v_dot2c_f32_bf16 v140, v132, v100
    v_dot2c_f32_bf16 v141, v132, v108
    v_dot2c_f32_bf16 v142, v132, v116
    v_dot2c_f32_bf16 v143, v132, v124
    v_dot2c_f32_bf16 v140, v133, v101
    v_dot2c_f32_bf16 v141, v133, v109
    v_dot2c_f32_bf16 v142, v133, v117
    v_dot2c_f32_bf16 v143, v133, v125
    v_dot2c_f32_bf16 v140, v134, v102
    v_dot2c_f32_bf16 v141, v134, v110
    v_dot2c_f32_bf16 v142, v134, v118
    v_dot2c_f32_bf16 v143, v134, v126
    v_dot2c_f32_bf16 v140, v135, v103
    v_dot2c_f32_bf16 v141, v135, v111
    v_dot2c_f32_bf16 v142, v135, v119
    v_dot2c_f32_bf16 v143, v135, v127
    v_dot2c_f32_bf16 v140, v136, v104
    v_dot2c_f32_bf16 v141, v136, v112
    v_dot2c_f32_bf16 v142, v136, v120
    v_dot2c_f32_bf16 v143, v136, v128
    v_dot2c_f32_bf16 v140, v137, v105
    v_dot2c_f32_bf16 v141, v137, v113
    v_dot2c_f32_bf16 v142, v137, v121
    v_dot2c_f32_bf16 v143, v137, v129
    v_dot2c_f32_bf16 v140, v138, v106
    v_dot2c_f32_bf16 v141, v138, v114
    v_dot2c_f32_bf16 v142, v138, v122
    v_dot2c_f32_bf16 v143, v138, v130
    v_dot2c_f32_bf16 v140, v139, v107
    v_dot2c_f32_bf16 v141, v139, v115
    v_dot2c_f32_bf16 v142, v139, v123
    v_dot2c_f32_bf16 v143, v139, v131
    s_min_u32 s32, s28, 2
    s_lshl_b32 s32, s32, 12
    s_lshl_b32 s33, s25, 14
    s_add_u32 s32, s32, s33
    s_add_u32 s32, s32, 0x1d80000
    s_lshl_b32 s33, s24, 8
    s_add_u32 s32, s32, s33
    v_lshlrev_b32 v20, 2, v252
    v_permlane32_swap_b32 v140, v142
    v_permlane32_swap_b32 v141, v143
    v_add_f32 v140, v140, v142
    v_add_f32 v141, v141, v143
    s_nop 1
    v_permlane16_swap_b32 v140, v141
    v_add_f32 v140, v140, v141
    buffer_store_dword v140, v20, s[20:23], s32 offen sc1
    s_branch l_att
q_red:
    s_mul_i32 s32, s89, 3584
    s_add_u32 s32, s32, s79
    s_add_u32 s32, s32, 0xc80000
    buffer_load_dwordx4 v[60:63], v253, s[20:23], s32 offen offset:0 sc1
    buffer_load_dwordx4 v[64:67], v253, s[20:23], s32 offen offset:1024 sc1
    buffer_load_dwordx4 v[68:71], v253, s[20:23], s32 offen offset:2048 sc1
    buffer_load_dwordx4 v[72:75], v253, s[20:23], s32 offen offset:3072 sc1
    s_add_u32 s32, s32, 4096
    buffer_load_dwordx4 v[76:79], v253, s[20:23], s32 offen offset:0 sc1
    buffer_load_dwordx4 v[80:83], v253, s[20:23], s32 offen offset:1024 sc1
    buffer_load_dwordx4 v[84:87], v253, s[20:23], s32 offen offset:2048 sc1
    s_add_u32 s96, s95, 13
    s_and_b32 s96, s96, 15
    s_lshl_b32 s97, s96, 14
    s_add_u32 s97, s97, s84
    s_add_u32 m0, s86, 131072
    s_nop 0
    buffer_load_dwordx4 v253, s[20:23], s97 offen offset:0 sc1 lds
    buffer_load_dwordx4 v253, s[20:23], s97 offen offset:1024 sc1 lds
    buffer_load_dwordx4 v253, s[20:23], s97 offen offset:2048 sc1 lds
    buffer_load_dwordx4 v253, s[20:23], s97 offen offset:3072 sc1 lds
    s_add_u32 s96, s95, 13
    s_and_b32 s96, s96, 15
    s_mul_i32 s96, s96, 393216
    s_add_u32 s96, s96, s85
    s_add_u32 m0, s87, 65536
    s_nop 0
    buffer_load_dwordx4 v8, s[16:19], s96 offen offset:0 lds
    buffer_load_dwordx4 v9, s[16:19], s96 offen offset:1024 lds
    buffer_load_dwordx4 v10, s[16:19], s96 offen offset:2048 lds
    buffer_load_dwordx4 v11, s[16:19], s96 offen offset:3072 lds
    s_add_u32 m0, s87, 69632
    s_nop 0
    buffer_load_dwordx4 v12, s[16:19], s96 offen offset:0 lds
    buffer_load_dwordx4 v13, s[16:19], s96 offen offset:1024 lds
    s_waitcnt vmcnt(17) lgkmcnt(0)
    s_barrier
    s_add_u32 s96, s94, 14
    s_and_b32 s96, s96, 15
    s_lshl_b32 s97, s96, 14
    s_add_u32 s97, s97, s84
    s_add_u32 m0, s86, 114688
    s_nop 0
    buffer_load_dwordx4 v253, s[20:23], s97 offen offset:0 sc1 lds
    buffer_load_dwordx4 v253, s[20:23], s97 offen offset:1024 sc1 lds
    s_mov_b32 s78, s27
    s_waitcnt vmcnt(12)
    s_branch pc_97
    s_nop 0
pl_96:
    s_mul_i32 s32, s89, 3584
    s_add_u32 s32, s32, s79
    s_add_u32 s32, s32, 0xc80000
    buffer_load_dwordx4 v[60:63], v253, s[20:23], s32 offen offset:0 sc1
    buffer_load_dwordx4 v[64:67], v253, s[20:23], s32 offen offset:1024 sc1
    buffer_load_dwordx4 v[68:71], v253, s[20:23], s32 offen offset:2048 sc1
    buffer_load_dwordx4 v[72:75], v253, s[20:23], s32 offen offset:3072 sc1
    s_add_u32 s32, s32, 4096
    buffer_load_dwordx4 v[76:79], v253, s[20:23], s32 offen offset:0 sc1
    buffer_load_dwordx4 v[80:83], v253, s[20:23], s32 offen offset:1024 sc1
    buffer_load_dwordx4 v[84:87], v253, s[20:23], s32 offen offset:2048 sc1
    s_waitcnt vmcnt(0)
pc_97:
    v_max3_u32 v30, v60, v64, v68
    v_max3_u32 v30, v30, v72, v76
    v_max3_u32 v30, v30, v80, v84
    v_cmp_eq_u32 vcc, -1, v30
    s_cbranch_vccz pd_98
    s_sub_u32 s78, s78, 1
    s_cmp_lg_u32 s78, 0
    s_cbranch_scc1 pl_96
    s_mov_b32 s27, 1
pd_98:
    buffer_load_dwordx4 v253, s[20:23], s97 offen offset:2048 sc1 lds
    v_lshlrev_b32 v24, 16, v60
    v_and_b32 v25, 0xffff0000, v60
    v_lshlrev_b32_e64 v26, 16, v61
    v_and_b32 v27, 0xffff0000, v61
    v_lshlrev_b32_e64 v28, 16, v62
    v_and_b32 v29, 0xffff0000, v62
    v_lshlrev_b32_e64 v30, 16, v63
    v_and_b32 v31, 0xffff0000, v63
    v_lshlrev_b32_e64 v88, 16, v64
    v_and_b32 v89, 0xffff0000, v64
    v_lshlrev_b32_e64 v90, 16, v65
    v_and_b32 v91, 0xffff0000, v65
    v_add_f32_e64 v24, v24, v88
    buffer_load_dwordx4 v253, s[20:23], s97 offen offset:3072 sc1 lds
    v_add_f32 v25, v25, v89
    v_add_f32 v26, v26, v90
    v_add_f32 v27, v27, v91
    v_lshlrev_b32 v88, 16, v66
    v_and_b32 v89, 0xffff0000, v66
    v_lshlrev_b32_e64 v90, 16, v67
    v_and_b32 v91, 0xffff0000, v67
    v_add_f32 v28, v28, v88
    v_add_f32 v29, v29, v89
    v_add_f32 v30, v30, v90
    v_add_f32 v31, v31, v91
    v_lshlrev_b32_e64 v88, 16, v68
    v_and_b32 v89, 0xffff0000, v68
    v_lshlrev_b32_e64 v90, 16, v69
    v_and_b32 v91, 0xffff0000, v69
    v_add_f32 v24, v24, v88
    v_add_f32 v25, v25, v89
    v_add_f32 v26, v26, v90
    v_add_f32 v27, v27, v91
    v_lshlrev_b32_e64 v88, 16, v70
    v_and_b32 v89, 0xffff0000, v70
    s_add_u32 s96, s94, 14
    s_and_b32 s96, s96, 15
    s_mul_i32 s96, s96, 393216
    s_add_u32 s96, s96, s85
    s_add_u32 m0, s87, 90112
    s_nop 0
    buffer_load_dwordx4 v8, s[16:19], s96 offen offset:0 lds
    v_lshlrev_b32_e64 v90, 16, v71
    v_and_b32 v91, 0xffff0000, v71
    v_add_f32 v28, v28, v88
    v_add_f32 v29, v29, v89
    v_add_f32 v30, v30, v90
    v_add_f32 v31, v31, v91
    v_lshlrev_b32_e64 v88, 16, v72
    v_and_b32 v89, 0xffff0000, v72
    v_lshlrev_b32_e64 v90, 16, v73
    v_and_b32 v91, 0xffff0000, v73
    v_add_f32 v24, v24, v88
    v_add_f32 v25, v25, v89
    v_add_f32 v26, v26, v90
    v_add_f32 v27, v27, v91
    v_lshlrev_b32_e64 v88, 16, v74
    v_and_b32 v89, 0xffff0000, v74
    v_lshlrev_b32_e64 v90, 16, v75
    v_and_b32 v91, 0xffff0000, v75
    v_add_f32 v28, v28, v88
    v_add_f32 v29, v29, v89
    buffer_load_dwordx4 v9, s[16:19], s96 offen offset:1024 lds
    v_add_f32 v30, v30, v90
    v_add_f32 v31, v31, v91
    v_lshlrev_b32_e64 v88, 16, v76
    v_and_b32 v89, 0xffff0000, v76
    v_lshlrev_b32_e64 v90, 16, v77
    v_and_b32 v91, 0xffff0000, v77
    v_add_f32 v24, v24, v88
    v_add_f32 v25, v25, v89
    v_add_f32 v26, v26, v90
    v_add_f32 v27, v27, v91
    v_lshlrev_b32_e64 v88, 16, v78
    v_and_b32 v89, 0xffff0000, v78
    v_lshlrev_b32_e64 v90, 16, v79
    v_and_b32 v91, 0xffff0000, v79
    v_add_f32 v28, v28, v88
    v_add_f32 v29, v29, v89
    v_add_f32 v30, v30, v90
    v_add_f32 v31, v31, v91
    v_lshlrev_b32_e64 v88, 16, v80
    v_and_b32 v89, 0xffff0000, v80
    v_lshlrev_b32_e64 v90, 16, v81
    buffer_load_dwordx4 v10, s[16:19], s96 offen offset:2048 lds
    v_and_b32 v91, 0xffff0000, v81
    v_add_f32 v24, v24, v88
    v_add_f32 v25, v25, v89
    v_add_f32 v26, v26, v90
    v_add_f32 v27, v27, v91
    v_lshlrev_b32_e64 v88, 16, v82
    v_and_b32 v89, 0xffff0000, v82
    v_lshlrev_b32_e64 v90, 16, v83
    v_and_b32 v91, 0xffff0000, v83
    v_add_f32 v28, v28, v88
    v_add_f32 v29, v29, v89
    v_add_f32 v30, v30, v90
    v_add_f32 v31, v31, v91
    v_lshlrev_b32_e64 v88, 16, v84
    v_and_b32 v89, 0xffff0000, v84
    v_lshlrev_b32_e64 v90, 16, v85
    v_and_b32 v91, 0xffff0000, v85
    v_add_f32 v24, v24, v88
    v_add_f32 v25, v25, v89
    v_add_f32 v26, v26, v90
    v_add_f32 v27, v27, v91
    buffer_load_dwordx4 v11, s[16:19], s96 offen offset:3072 lds
    v_lshlrev_b32_e64 v88, 16, v86
    v_and_b32 v89, 0xffff0000, v86
    v_lshlrev_b32_e64 v90, 16, v87
    v_and_b32 v91, 0xffff0000, v87
    v_add_f32 v28, v28, v88
    v_add_f32 v29, v29, v89
    v_add_f32 v30, v30, v90
    v_add_f32 v31, v31, v91
    v_permlane32_swap_b32 v24, v28
    v_permlane32_swap_b32 v25, v29
    v_permlane32_swap_b32 v26, v30
    v_permlane32_swap_b32 v27, v31
    v_add_f32 v24, v24, v28
    v_add_f32 v25, v25, v29
    v_add_f32 v26, v26, v30
    v_add_f32 v27, v27, v31
    s_nop 0
    v_permlane16_swap_b32 v24, v26
    v_permlane16_swap_b32 v25, v27
    v_add_f32 v24, v24, v26
    v_add_f32_e64 v25, v25, v27
    s_nop 0
    v_add_f32_dpp v24, v24, v24 quad_perm:[2,3,0,1] row_mask:0xf bank_mask:0xf
    s_add_u32 m0, s87, 94208
    s_nop 0
    buffer_load_dwordx4 v12, s[16:19], s96 offen offset:0 lds
    v_add_f32_dpp v25, v25, v25 quad_perm:[2,3,0,1] row_mask:0xf bank_mask:0xf
    v_add_f32_dpp v24, v24, v24 row_ror:4 row_mask:0xf bank_mask:0xf
    s_nop 0
    v_add_f32_dpp v25, v25, v25 row_ror:4 row_mask:0xf bank_mask:0xf
    v_add_f32_dpp v24, v24, v24 row_ror:8 row_mask:0xf bank_mask:0xf
    s_nop 0
    v_add_f32_dpp v25, v25, v25 row_ror:8 row_mask:0xf bank_mask:0xf
    v_fma_f32 v28, v24, v96, v92
    v_fma_f32 v29, v25, v96, v93
    v_cvt_pk_bf16_f32 v24, v28, v29
    v_cvt_pk_bf16_f32 v25, v28, v29
    v_cvt_pk_bf16_f32 v26, v28, v29
    v_cvt_pk_bf16_f32 v27, v28, v29
    v_permlane16_swap_b32 v24, v25
    s_nop 0
    v_permlane16_swap_b32 v26, v27
    s_nop 1
    v_permlane32_swap_b32 v24, v26
    v_permlane32_swap_b32 v25, v27
    s_mov_b32 s32, 0xdc4000
    s_lshl_b32 s33, s89, 4
    v_lshrrev_b32 v89, 1, v252
    v_and_or_b32 v88, v253, 16, s33
    v_lshl_or_b32 v88, v89, 11, v88
    buffer_load_dwordx4 v13, s[16:19], s96 offen offset:1024 lds
    s_mov_b64 exec, 65535
    buffer_store_dwordx4 v[24:27], v88, s[20:23], s32 offen sc1
    s_mov_b64 exec, -1
    s_waitcnt vmcnt(11) lgkmcnt(0)
    s_barrier
    s_add_u32 s96, s95, 15
    s_and_b32 s96, s96, 15
    s_lshl_b32 s97, s96, 14
    s_add_u32 s97, s97, s84
    s_add_u32 m0, s86, 147456
    s_nop 0
    buffer_load_dwordx4 v253, s[20:23], s97 offen offset:0 sc1 lds
    buffer_load_dwordx4 v253, s[20:23], s97 offen offset:1024 sc1 lds
    buffer_load_dwordx4 v253, s[20:23], s97 offen offset:2048 sc1 lds
    buffer_load_dwordx4 v253, s[20:23], s97 offen offset:3072 sc1 lds
    s_add_u32 s96, s95, 15
    s_and_b32 s96, s96, 15
    s_mul_i32 s96, s96, 393216
    s_add_u32 s96, s96, s85
    s_add_u32 m0, s87, 40960
    s_nop 0
    buffer_load_dwordx4 v8, s[16:19], s96 offen offset:0 lds
    buffer_load_dwordx4 v9, s[16:19], s96 offen offset:1024 lds
    buffer_load_dwordx4 v10, s[16:19], s96 offen offset:2048 lds
    buffer_load_dwordx4 v11, s[16:19], s96 offen offset:3072 lds
    s_add_u32 m0, s87, 45056
    s_nop 0
    buffer_load_dwordx4 v12, s[16:19], s96 offen offset:0 lds
    buffer_load_dwordx4 v13, s[16:19], s96 offen offset:1024 lds
    s_waitcnt vmcnt(11) lgkmcnt(0)
    s_barrier
    s_min_u32 s30, s28, 2
    s_lshl_b32 s30, s30, 13
    s_add_u32 s30, s30, 90112
    v_lshrrev_b32 v20, 2, v252
    v_bfe_u32 v21, v20, 1, 2
    v_lshlrev_b32_e64 v20, 7, v20
    v_lshl_add_u32 v20, v21, 5, v20
    v_and_b32_e64 v21, 3, v252
    v_lshl_add_u32 v20, v21, 3, v20
    v_add_u32 v144, s30, v20
    v_xor_b32 v145, 32, v144
    v_xor_b32_e64 v146, 64, v144
    v_xor_b32 v147, 96, v144
    ds_read_b64_tr_b16 v[100:101], v144 offset:0
    ds_read_b64_tr_b16 v[102:103], v144 offset:2048
    ds_read_b64_tr_b16 v[104:105], v144 offset:4096
    ds_read_b64_tr_b16 v[106:107], v144 offset:6144
    ds_read_b64_tr_b16 v[108:109], v145 offset:0
    ds_read_b64_tr_b16 v[110:111], v145 offset:2048
    ds_read_b64_tr_b16 v[112:113], v145 offset:4096
    ds_read_b64_tr_b16 v[114:115], v145 offset:6144
    ds_read_b64_tr_b16 v[116:117], v146 offset:0
    ds_read_b64_tr_b16 v[118:119], v146 offset:2048
    ds_read_b64_tr_b16 v[120:121], v146 offset:4096
    ds_read_b64_tr_b16 v[122:123], v146 offset:6144
    ds_read_b64_tr_b16 v[124:125], v147 offset:0
    ds_read_b64_tr_b16 v[126:127], v147 offset:2048
    ds_read_b64_tr_b16 v[128:129], v147 offset:4096
    ds_read_b64_tr_b16 v[130:131], v147 offset:6144
    s_getpc_b64 s[32:33]
pc_103:
    s_sub_u32 s32, s32, pc_103-interleave_layers__sliding_block__moe_arch_mod__prompt_kernel
    s_subb_u32 s33, s33, 0
    s_lshr_b32 s34, s2, 3
    s_lshl_b32 s34, s34, 2
    s_add_u32 s34, s34, s28
    s_and_b32 s34, s34, 127
    s_lshl_b32 s34, s34, 7
    v_lshl_add_u32 v154, v252, 14, s34
    s_mov_b32 s34, k_exit-interleave_layers__sliding_block__moe_arch_mod__prompt_kernel
    s_mov_b32 s35, 0x20000
    buffer_load_dword v154, v154, s[32:35], 0 offen
    s_branch q_join
    s_nop 0
l_patch:
    s_lshr_b32 vcc_lo, s24, 1
    s_lshl_b32 vcc_lo, vcc_lo, 11
    s_add_u32 s32, vcc_lo, 0xdc4000
    buffer_load_dwordx4 v[72:75], v253, s[20:23], s32 offen offset:0 sc1
    buffer_load_dwordx4 v[76:79], v253, s[20:23], s32 offen offset:1024 sc1
    s_min_u32 s32, s28, 2
    s_lshl_b32 s32, s32, 12
    s_lshl_b32 s33, s25, 14
    s_add_u32 s32, s32, s33
    s_add_u32 s32, s32, 0x1d80000
    buffer_load_dwordx4 v[56:59], v253, s[20:23], s32 offen offset:0 sc1
    buffer_load_dwordx4 v[60:63], v253, s[20:23], s32 offen offset:1024 sc1
    buffer_load_dwordx4 v[64:67], v253, s[20:23], s32 offen offset:2048 sc1
    buffer_load_dwordx4 v[68:71], v253, s[20:23], s32 offen offset:3072 sc1
    s_mov_b32 s78, s27
    s_waitcnt vmcnt(4)
    s_branch pc_109
    s_nop 0
pl_108:
    s_lshr_b32 vcc_lo, s24, 1
    s_lshl_b32 vcc_lo, vcc_lo, 11
    s_add_u32 s32, vcc_lo, 0xdc4000
    buffer_load_dwordx4 v[72:75], v253, s[20:23], s32 offen offset:0 sc1
    buffer_load_dwordx4 v[76:79], v253, s[20:23], s32 offen offset:1024 sc1
    s_waitcnt vmcnt(0)
pc_109:
    v_max3_u32 v82, v72, v73, v74
    v_max3_u32 v82, v82, v75, v76
    v_max3_u32 v82, v82, v77, v78
    v_max_u32 v82, v82, v79
    v_cmp_eq_u32 vcc, -1, v82
    s_cbranch_vccz pd_110
    s_sub_u32 s78, s78, 1
    s_cmp_lg_u32 s78, 0
    s_cbranch_scc1 pl_108
    s_mov_b32 s27, 1
pd_110:
    v_mov_b32 v80, 0
    v_mov_b32 v81, 0
    v_dot2c_f32_bf16 v80, 0x3f803f80, v72
    v_dot2c_f32_bf16 v81, v72, v72
    v_dot2c_f32_bf16 v80, 0x3f803f80, v73
    v_dot2c_f32_bf16 v81, v73, v73
    v_dot2c_f32_bf16 v80, 0x3f803f80, v74
    v_dot2c_f32_bf16 v81, v74, v74
    v_dot2c_f32_bf16 v80, 0x3f803f80, v75
    v_dot2c_f32_bf16 v81, v75, v75
    v_dot2c_f32_bf16 v80, 0x3f803f80, v76
    v_dot2c_f32_bf16 v81, v76, v76
    v_dot2c_f32_bf16 v80, 0x3f803f80, v77
    v_dot2c_f32_bf16 v81, v77, v77
    v_dot2c_f32_bf16 v80, 0x3f803f80, v78
    v_dot2c_f32_bf16 v81, v78, v78
    v_dot2c_f32_bf16 v80, 0x3f803f80, v79
    v_dot2c_f32_bf16 v81, v79, v79
    s_nop 1
    v_add_f32_dpp v80, v80, v80 quad_perm:[1,0,3,2] row_mask:0xf bank_mask:0xf
    v_add_f32_dpp v81, v81, v81 quad_perm:[1,0,3,2] row_mask:0xf bank_mask:0xf
    s_nop 0
    v_add_f32_dpp v80, v80, v80 quad_perm:[2,3,0,1] row_mask:0xf bank_mask:0xf
    v_add_f32_dpp v81, v81, v81 quad_perm:[2,3,0,1] row_mask:0xf bank_mask:0xf
    s_nop 0
    v_add_f32_dpp v80, v80, v80 row_half_mirror row_mask:0xf bank_mask:0xf
    v_add_f32_dpp v81, v81, v81 row_half_mirror row_mask:0xf bank_mask:0xf
    s_nop 0
    v_add_f32_dpp v80, v80, v80 row_mirror row_mask:0xf bank_mask:0xf
    v_add_f32_dpp v81, v81, v81 row_mirror row_mask:0xf bank_mask:0xf
    v_mov_b32 v82, v80
    v_mov_b32 v83, v81
    s_nop 0
    v_permlane16_swap_b32 v80, v82
    v_permlane16_swap_b32 v81, v83
    v_add_f32 v80, v80, v82
    v_add_f32 v81, v81, v83
    v_mov_b32 v82, v80
    v_mov_b32 v83, v81
    s_nop 0
    v_permlane32_swap_b32 v80, v82
    v_permlane32_swap_b32 v81, v83
    v_add_f32 v80, v80, v82
    v_add_f32 v81, v81, v83
    v_mul_f32 v80, 0x3a800000, v80
    v_mul_f32 v81, 0x3a800000, v81
    v_fma_f32 v81, -v80, v80, v81
    v_max_f32_e64 v81, 0, v81
    v_add_f32 v81, 0x3727c5ac, v81
    v_rsq_f32 v81, v81
    s_mov_b32 s78, s27
    s_waitcnt vmcnt(0)
    s_branch pc_112
    s_nop 0
pl_111:
    s_min_u32 s32, s28, 2
    s_lshl_b32 s32, s32, 12
    s_lshl_b32 s33, s25, 14
    s_add_u32 s32, s32, s33
    s_add_u32 s32, s32, 0x1d80000
    buffer_load_dwordx4 v[56:59], v253, s[20:23], s32 offen offset:0 sc1
    buffer_load_dwordx4 v[60:63], v253, s[20:23], s32 offen offset:1024 sc1
    buffer_load_dwordx4 v[64:67], v253, s[20:23], s32 offen offset:2048 sc1
    buffer_load_dwordx4 v[68:71], v253, s[20:23], s32 offen offset:3072 sc1
    s_waitcnt vmcnt(0)
pc_112:
    v_max3_u32 v82, v56, v57, v58
    v_max3_u32 v82, v82, v59, v60
    v_max3_u32 v82, v82, v61, v62
    v_max3_u32 v82, v82, v63, v64
    v_max3_u32 v82, v82, v65, v66
    v_max3_u32 v82, v82, v67, v68
    v_max3_u32 v82, v82, v69, v70
    v_max_u32_e64 v82, v82, v71
    v_cmp_eq_u32 vcc, -1, v82
    s_cbranch_vccz pd_113
    s_sub_u32 s78, s78, 1
    s_cmp_lg_u32 s78, 0
    s_cbranch_scc1 pl_111
    s_mov_b32 s27, 1
pd_113:
l_zok:
    v_pk_add_f32 v[56:57], v[56:57], v[60:61]
    v_pk_add_f32 v[58:59], v[58:59], v[62:63]
    v_pk_add_f32 v[56:57], v[56:57], v[64:65]
    v_pk_add_f32 v[58:59], v[58:59], v[66:67]
    v_pk_add_f32 v[56:57], v[56:57], v[68:69]
    v_pk_add_f32 v[58:59], v[58:59], v[70:71]
    s_nop 1
    v_permlane32_swap_b32 v56, v58
    v_permlane32_swap_b32 v57, v59
    v_add_f32 v56, v56, v58
    v_add_f32 v57, v57, v59
    s_nop 1
    v_permlane16_swap_b32 v56, v57
    v_add_f32 v56, v56, v57
    v_fma_f32 v56, -v80, v2, v56
    v_mul_f32 v81, s37, v81
    v_mul_f32 v56, v56, v81
    v_cvt_pk_bf16_f32 v1, v56, v56
    s_cmp_lg_u32 s100, 2
    s_cbranch_scc1 l_pmid
    s_cmp_lg_u32 s38, 0
    s_barrier
    s_cselect_b64 exec, -1, 0
    ds_write_b16 v0, v1
    s_mov_b64 exec, -1
    s_waitcnt lgkmcnt(0)
    s_barrier
    s_branch l_patched
    s_nop 0
l_tail:
    s_load_dwordx2 s[12:13], s[0:1], 64
    s_mov_b32 s14, 0x400000
    s_mov_b32 s15, 0x20000
    s_waitcnt lgkmcnt(0)
    v_mov_b32_e64 v20, 0
    s_or_b32 s34, s72, s28
    s_cmp_lg_u32 s34, 0
    s_cbranch_scc1 sk_114
    s_mov_b32 s34, 0xdd8000
    v_mov_b32 v154, s88
    s_mov_b64 exec, 1
    s_waitcnt vmcnt(0)
    buffer_store_dword v154, v253, s[20:23], s34 offen sc1
    s_mov_b64 exec, -1
sk_114:
    s_barrier
    ds_read_b128 v[16:19], v20 offset:3072
    s_waitcnt lgkmcnt(0)
    v_readlane_b32 s74, v16, 0
    v_readlane_b32 s73, v17, 0
    v_readlane_b32 s75, v18, 0
    v_readlane_b32 s76, v19, 0
    s_and_b32 s73, s73, 2047
    s_mov_b32 s78, s27
pl_115:
    s_lshr_b32 s33, s73, 5
    s_lshl_b32 s33, s33, 11
    s_add_u32 s33, s33, s79
    s_add_u32 s33, s33, 0xd60000
    buffer_load_dwordx4 v[24:27], v22, s[20:23], s33 offen sc1
    s_waitcnt vmcnt(0)
pc_116:
    v_max3_u32 v30, v24, v25, v26
    v_max_u32 v30, v30, v27
    v_cmp_eq_u32 vcc, -1, v30
    s_cbranch_vccz pd_117
    s_sub_u32 s78, s78, 1
    s_cmp_lg_u32 s78, 0
    s_cbranch_scc1 pl_115
    s_mov_b32 s27, 1
pd_117:
    s_cmp_ge_u32 s29, 224
    s_cbranch_scc1 l_tred
    v_mov_b32 v28, s76
    v_mul_f32 v29, s75, v28
    v_lshlrev_b32 v30, 16, v24
    v_and_b32 v31, 0xffff0000, v24
    v_fma_f32 v30, v30, v28, -v29
    v_fma_f32 v31, v31, v28, -v29
    v_cvt_pk_bf16_f32 v24, v30, v31
    v_lshlrev_b32_e64 v30, 16, v25
    v_and_b32 v31, 0xffff0000, v25
    v_fma_f32 v30, v30, v28, -v29
    v_fma_f32 v31, v31, v28, -v29
    v_cvt_pk_bf16_f32 v25, v30, v31
    v_lshlrev_b32_e64 v30, 16, v26
    v_and_b32 v31, 0xffff0000, v26
    v_fma_f32 v30, v30, v28, -v29
    v_fma_f32 v31, v31, v28, -v29
    v_cvt_pk_bf16_f32 v26, v30, v31
    v_lshlrev_b32 v30, 16, v27
    v_and_b32 v31, 0xffff0000, v27
    v_fma_f32 v30, v30, v28, -v29
    v_fma_f32 v31, v31, v28, -v29
    v_cvt_pk_bf16_f32 v27, v30, v31
    s_bitcmp0_b32 s29, 0
    s_cbranch_scc1 sk_118
    v_swap_b32 v24, v25
    v_swap_b32 v26, v27
sk_118:
    s_bitcmp0_b32 s29, 1
    s_cbranch_scc1 sk_119
    v_swap_b32 v24, v26
    v_swap_b32 v25, v27
sk_119:
    s_cmp_ge_u32 s29, 224
    s_cbranch_scc1 sk_120
    v_dot2_f32_bf16 v32, v155, v24, 0
    v_dot2_f32_bf16 v33, v160, v24, 0
    v_dot2_f32_bf16 v34, v156, v24, 0
    v_dot2_f32_bf16 v35, v161, v24, 0
    v_dot2_f32_bf16 v36, v157, v24, 0
    v_dot2_f32_bf16 v37, v162, v24, 0
    v_dot2_f32_bf16 v38, v158, v24, 0
    v_dot2_f32_bf16 v39, v163, v24, 0
    v_dot2_f32_bf16 v40, v183, v24, 0
    v_dot2_f32_bf16 v41, v192, v24, 0
    v_dot2_f32_bf16 v42, v188, v24, 0
    v_dot2_f32_bf16 v43, v193, v24, 0
    v_dot2_f32_bf16 v44, v189, v24, 0
    v_dot2_f32_bf16 v45, v194, v24, 0
    v_dot2_f32_bf16 v46, v190, v24, 0
    v_dot2_f32_bf16 v47, v195, v24, 0
    v_dot2_f32_bf16 v32, v159, v25, v32
    v_dot2_f32_bf16 v33, v168, v25, v33
    v_dot2_f32_bf16 v34, v164, v25, v34
    v_dot2_f32_bf16 v35, v169, v25, v35
    v_dot2_f32_bf16 v36, v165, v25, v36
    v_dot2_f32_bf16 v37, v170, v25, v37
    v_dot2_f32_bf16 v38, v166, v25, v38
    v_dot2_f32_bf16 v39, v171, v25, v39
    v_dot2_f32_bf16 v40, v191, v25, v40
    v_dot2_f32_bf16 v41, v200, v25, v41
    v_dot2_f32_bf16 v42, v196, v25, v42
    v_dot2_f32_bf16 v43, v201, v25, v43
    v_dot2_f32_bf16 v44, v197, v25, v44
    v_dot2_f32_bf16 v45, v202, v25, v45
    v_dot2_f32_bf16 v46, v198, v25, v46
    v_dot2_f32_bf16 v47, v203, v25, v47
    v_dot2_f32_bf16 v32, v167, v26, v32
    v_dot2_f32_bf16 v33, v176, v26, v33
    v_dot2_f32_bf16 v34, v172, v26, v34
    v_dot2_f32_bf16 v35, v177, v26, v35
    v_dot2_f32_bf16 v36, v173, v26, v36
    v_dot2_f32_bf16 v37, v178, v26, v37
    v_dot2_f32_bf16 v38, v174, v26, v38
    v_dot2_f32_bf16 v39, v179, v26, v39
    v_dot2_f32_bf16 v40, v199, v26, v40
    v_dot2_f32_bf16 v41, v208, v26, v41
    v_dot2_f32_bf16 v42, v204, v26, v42
    v_dot2_f32_bf16 v43, v209, v26, v43
    v_dot2_f32_bf16 v44, v205, v26, v44
    v_dot2_f32_bf16 v45, v210, v26, v45
    v_dot2_f32_bf16 v46, v206, v26, v46
    v_dot2_f32_bf16 v47, v211, v26, v47
    v_dot2_f32_bf16 v32, v175, v27, v32
    v_dot2_f32_bf16 v33, v184, v27, v33
    v_dot2_f32_bf16 v34, v180, v27, v34
    v_dot2_f32_bf16 v35, v185, v27, v35
    v_dot2_f32_bf16 v36, v181, v27, v36
    v_dot2_f32_bf16 v37, v186, v27, v37
    v_dot2_f32_bf16 v38, v182, v27, v38
    v_dot2_f32_bf16 v39, v187, v27, v39
    v_dot2_f32_bf16 v40, v207, v27, v40
    v_dot2_f32_bf16 v41, v216, v27, v41
    v_dot2_f32_bf16 v42, v212, v27, v42
    v_dot2_f32_bf16 v43, v217, v27, v43
    v_dot2_f32_bf16 v44, v213, v27, v44
    v_dot2_f32_bf16 v45, v218, v27, v45
    v_dot2_f32_bf16 v46, v214, v27, v46
    v_dot2_f32_bf16 v47, v219, v27, v47
sk_120:
    v_lshrrev_b32 v31, 5, v252
    v_lshlrev_b32 v30, 6, v31
    v_permlane32_swap_b32 v32, v40
    v_permlane32_swap_b32 v33, v41
    v_permlane32_swap_b32 v34, v42
    v_permlane32_swap_b32 v35, v43
    v_permlane32_swap_b32 v36, v44
    v_permlane32_swap_b32 v37, v45
    v_permlane32_swap_b32 v38, v46
    v_permlane32_swap_b32 v39, v47
    v_add_f32 v32, v32, v40
    v_add_f32 v33, v33, v41
    v_add_f32 v34, v34, v42
    v_add_f32 v35, v35, v43
    v_add_f32 v36, v36, v44
    v_add_f32 v37, v37, v45
    v_add_f32 v38, v38, v46
    v_add_f32 v39, v39, v47
    v_and_b32_e64 v31, 1, v252
    v_lshl_add_u32 v30, v31, 5, v30
    v_permlane16_swap_b32 v32, v36
    v_permlane16_swap_b32 v33, v37
    v_permlane16_swap_b32 v34, v38
    v_permlane16_swap_b32 v35, v39
    v_add_f32 v32, v32, v36
    v_add_f32 v33, v33, v37
    v_add_f32 v34, v34, v38
    v_add_f32 v35, v35, v39
    v_and_b32 v31, 16, v252
    s_lshl_b32 s32, s28, 7
    v_add3_u32 v30, v31, v30, s32
    v_add_f32_dpp v32, v32, v32 quad_perm:[2,3,0,1] row_mask:0xf bank_mask:0xf
    v_add_f32_dpp v33, v33, v33 quad_perm:[2,3,0,1] row_mask:0xf bank_mask:0xf
    v_add_f32_dpp v34, v34, v34 quad_perm:[2,3,0,1] row_mask:0xf bank_mask:0xf
    v_add_f32_dpp v35, v35, v35 quad_perm:[2,3,0,1] row_mask:0xf bank_mask:0xf
    v_add_f32_dpp v32, v32, v32 row_ror:4 row_mask:0xf bank_mask:0xf
    v_add_f32_dpp v33, v33, v33 row_ror:4 row_mask:0xf bank_mask:0xf
    v_add_f32_dpp v34, v34, v34 row_ror:4 row_mask:0xf bank_mask:0xf
    v_add_f32_dpp v35, v35, v35 row_ror:4 row_mask:0xf bank_mask:0xf
    v_add_f32_dpp v32, v32, v32 row_ror:8 row_mask:0xf bank_mask:0xf
    v_add_f32_dpp v33, v33, v33 row_ror:8 row_mask:0xf bank_mask:0xf
    v_add_f32_dpp v34, v34, v34 row_ror:8 row_mask:0xf bank_mask:0xf
    v_add_f32_dpp v35, v35, v35 row_ror:8 row_mask:0xf bank_mask:0xf
    s_mov_b32 exec_lo, 0x00030003
    s_mov_b32 exec_hi, 0x00030003
    ds_write_b128 v30, v[32:35] offset:3328
    s_mov_b64 exec, -1
    s_waitcnt lgkmcnt(0)
    s_barrier
    v_and_b32 v30, 1, v252
    v_bfe_u32 v31, v252, 1, 3
    v_lshl_add_u32 v30, v30, 3, v31
    v_lshlrev_b32_e64 v30, 2, v30
    v_add_u32 v30, 3328, v30
    ds_read2_b32 v[32:33], v30 offset0:0 offset1:16
    ds_read2_b32 v[34:35], v30 offset0:32 offset1:48
    ds_read2_b32 v[36:37], v30 offset0:64 offset1:80
    ds_read2_b32 v[38:39], v30 offset0:96 offset1:112
    v_lshrrev_b32_e64 v30, 2, v252
    v_mul_u32_u24 v30, 7168, v30
    v_and_b32_e64 v31, 2, v252
    v_lshl_add_u32 v30, v31, 3, v30
    s_add_u32 s32, s29, 32
    s_lshr_b32 s32, s32, 8
    v_lshl_add_u32 v30, s32, 31, v30
    s_mul_i32 s32, s28, 114688
    s_mul_i32 s33, s29, 32
    s_add_u32 s32, s32, s33
    s_add_u32 s32, s32, s79
    s_add_u32 s32, s32, 0xc80000
    s_waitcnt lgkmcnt(0)
    v_pk_add_f32 v[32:33], v[32:33], v[34:35]
    v_pk_add_f32 v[36:37], v[36:37], v[38:39]
    v_pk_add_f32 v[32:33], v[32:33], v[36:37]
    v_mul_f32 v34, 0xbfb8aa3b, v32
    v_exp_f32 v34, v34
    v_mul_f32 v32, v32, v33
    v_add_f32_e64 v34, 1.0, v34
    v_rcp_f32 v34, v34
    s_nop 0
    v_mul_f32 v32, v32, v34
    s_nop 1
    v_mov_b32_dpp v33, v32 quad_perm:[2,3,2,3] row_mask:0xf bank_mask:0xf
    v_cvt_pk_bf16_f32 v32, v32, v33
    ds_swizzle_b32 v36, v32 offset:0x1
    ds_swizzle_b32 v37, v32 offset:0x81
    ds_swizzle_b32 v38, v32 offset:0x101
    ds_swizzle_b32 v39, v32 offset:0x181
    s_waitcnt lgkmcnt(0)
    s_cmp_ge_u32 s29, 224
    s_cbranch_scc1 sk_121
    v_dot2_f32_bf16 v40, v215, v36, 0
    v_dot2_f32_bf16 v41, v224, v36, 0
    v_dot2_f32_bf16 v42, v220, v36, 0
    v_dot2_f32_bf16 v43, v225, v36, 0
    v_dot2_f32_bf16 v44, v221, v36, 0
    v_dot2_f32_bf16 v45, v226, v36, 0
    v_dot2_f32_bf16 v46, v222, v36, 0
    v_dot2_f32_bf16 v47, v227, v36, 0
    v_dot2_f32_bf16 v40, v223, v37, v40
    v_dot2_f32_bf16 v41, v232, v37, v41
    v_dot2_f32_bf16 v42, v228, v37, v42
    v_dot2_f32_bf16 v43, v233, v37, v43
    v_dot2_f32_bf16 v44, v229, v37, v44
    v_dot2_f32_bf16 v45, v234, v37, v45
    v_dot2_f32_bf16 v46, v230, v37, v46
    v_dot2_f32_bf16 v47, v235, v37, v47
    v_dot2_f32_bf16 v40, v231, v38, v40
    v_dot2_f32_bf16 v41, v240, v38, v41
    v_dot2_f32_bf16 v42, v236, v38, v42
    v_dot2_f32_bf16 v43, v241, v38, v43
    v_dot2_f32_bf16 v44, v237, v38, v44
    v_dot2_f32_bf16 v45, v242, v38, v45
    v_dot2_f32_bf16 v46, v238, v38, v46
    v_dot2_f32_bf16 v47, v243, v38, v47
    v_dot2_f32_bf16 v40, v239, v39, v40
    v_dot2_f32_bf16 v41, v248, v39, v41
    v_dot2_f32_bf16 v42, v244, v39, v42
    v_dot2_f32_bf16 v43, v249, v39, v43
    v_dot2_f32_bf16 v44, v245, v39, v44
    v_dot2_f32_bf16 v45, v250, v39, v45
    v_dot2_f32_bf16 v46, v246, v39, v46
    v_dot2_f32_bf16 v47, v251, v39, v47
sk_121:
    v_add_f32_dpp v40, v40, v40 quad_perm:[1,0,3,2] row_mask:0xf bank_mask:0xf
    v_add_f32_dpp v41, v41, v41 quad_perm:[1,0,3,2] row_mask:0xf bank_mask:0xf
    v_add_f32_dpp v42, v42, v42 quad_perm:[1,0,3,2] row_mask:0xf bank_mask:0xf
    v_add_f32_dpp v43, v43, v43 quad_perm:[1,0,3,2] row_mask:0xf bank_mask:0xf
    v_add_f32_dpp v44, v44, v44 quad_perm:[1,0,3,2] row_mask:0xf bank_mask:0xf
    v_add_f32_dpp v45, v45, v45 quad_perm:[1,0,3,2] row_mask:0xf bank_mask:0xf
    v_add_f32_dpp v46, v46, v46 quad_perm:[1,0,3,2] row_mask:0xf bank_mask:0xf
    v_add_f32_dpp v47, v47, v47 quad_perm:[1,0,3,2] row_mask:0xf bank_mask:0xf
    s_mov_b32 exec_lo, 0x55555555
    s_mov_b32 exec_hi, 0x55555555
    v_cvt_pk_bf16_f32 v40, v40, v41
    v_cvt_pk_bf16_f32 v41, v42, v43
    v_cvt_pk_bf16_f32 v42, v44, v45
    v_cvt_pk_bf16_f32 v43, v46, v47
    buffer_store_dwordx4 v[40:43], v30, s[20:23], s32 offen sc1
    s_mov_b64 exec, -1
    s_branch k_end
    s_nop 0
l_tred:
    s_cmp_lt_i32 s89, 0
    s_cbranch_scc1 k_end
    v_and_b32 v30, 16, v252
    v_cmp_eq_u32 vcc, 16, v30
    v_mov_b32 v28, s76
    v_mul_f32 v29, s75, v28
    v_add_f32 v28, 1.0, v28
    v_cndmask_b32 v30, v24, v25, vcc
    v_cndmask_b32 v31, v26, v27, vcc
    s_mov_b32 vcc_lo, 0xaaaaaaaa
    s_mov_b32 vcc_hi, 0xaaaaaaaa
    v_mov_b32 v96, 0xbfb8aa3b
    v_mul_f32 v96, s74, v96
    v_exp_f32 v96, v96
    v_cndmask_b32 v30, v30, v31, vcc
    v_lshlrev_b32 v92, 16, v30
    v_and_b32 v93, 0xffff0000, v30
    v_fma_f32 v92, v92, v28, -v29
    v_fma_f32 v93, v93, v28, -v29
    v_add_f32_e64 v96, 1.0, v96
    v_rcp_f32 v96, v96
    s_lshl_b32 s34, s73, 11
    s_lshl_b32 s33, s89, 4
    s_add_u32 s34, s34, s33
    s_mov_b32 s78, s27
pl_122:
    s_mul_i32 s32, s89, 3584
    s_add_u32 s32, s32, s79
    s_add_u32 s32, s32, 0xc80000
    buffer_load_dwordx4 v[60:63], v253, s[20:23], s32 offen offset:0 sc1
    buffer_load_dwordx4 v[64:67], v253, s[20:23], s32 offen offset:1024 sc1
    buffer_load_dwordx4 v[68:71], v253, s[20:23], s32 offen offset:2048 sc1
    buffer_load_dwordx4 v[72:75], v253, s[20:23], s32 offen offset:3072 sc1
    s_add_u32 s32, s32, 4096
    buffer_load_dwordx4 v[76:79], v253, s[20:23], s32 offen offset:0 sc1
    buffer_load_dwordx4 v[80:83], v253, s[20:23], s32 offen offset:1024 sc1
    buffer_load_dwordx4 v[84:87], v253, s[20:23], s32 offen offset:2048 sc1
    s_waitcnt vmcnt(0)
pc_123:
    v_max3_u32 v30, v60, v64, v68
    v_max3_u32 v30, v30, v72, v76
    v_max3_u32 v30, v30, v80, v84
    v_cmp_eq_u32 vcc, -1, v30
    s_cbranch_vccz pd_124
    s_sub_u32 s78, s78, 1
    s_cmp_lg_u32 s78, 0
    s_cbranch_scc1 pl_122
    s_mov_b32 s27, 1
pd_124:
    v_lshlrev_b32 v24, 16, v60
    v_and_b32 v25, 0xffff0000, v60
    v_lshlrev_b32_e64 v26, 16, v61
    v_and_b32 v27, 0xffff0000, v61
    v_lshlrev_b32_e64 v28, 16, v62
    v_and_b32 v29, 0xffff0000, v62
    v_lshlrev_b32_e64 v30, 16, v63
    v_and_b32 v31, 0xffff0000, v63
    v_lshlrev_b32_e64 v88, 16, v64
    v_and_b32 v89, 0xffff0000, v64
    v_lshlrev_b32_e64 v90, 16, v65
    v_and_b32 v91, 0xffff0000, v65
    v_pk_add_f32 v[24:25], v[24:25], v[88:89]
    v_pk_add_f32 v[26:27], v[26:27], v[90:91]
    v_lshlrev_b32_e64 v88, 16, v66
    v_and_b32 v89, 0xffff0000, v66
    v_lshlrev_b32_e64 v90, 16, v67
    v_and_b32 v91, 0xffff0000, v67
    v_pk_add_f32 v[28:29], v[28:29], v[88:89]
    v_pk_add_f32 v[30:31], v[30:31], v[90:91]
    v_lshlrev_b32_e64 v88, 16, v68
    v_and_b32 v89, 0xffff0000, v68
    v_lshlrev_b32_e64 v90, 16, v69
    v_and_b32 v91, 0xffff0000, v69
    v_pk_add_f32 v[24:25], v[24:25], v[88:89]
    v_pk_add_f32 v[26:27], v[26:27], v[90:91]
    v_lshlrev_b32_e64 v88, 16, v70
    v_and_b32 v89, 0xffff0000, v70
    v_lshlrev_b32_e64 v90, 16, v71
    v_and_b32 v91, 0xffff0000, v71
    v_pk_add_f32 v[28:29], v[28:29], v[88:89]
    v_pk_add_f32 v[30:31], v[30:31], v[90:91]
    v_lshlrev_b32_e64 v88, 16, v72
    v_and_b32 v89, 0xffff0000, v72
    v_lshlrev_b32_e64 v90, 16, v73
    v_and_b32 v91, 0xffff0000, v73
    v_pk_add_f32 v[24:25], v[24:25], v[88:89]
    v_pk_add_f32 v[26:27], v[26:27], v[90:91]
    v_lshlrev_b32_e64 v88, 16, v74
    v_and_b32 v89, 0xffff0000, v74
    v_lshlrev_b32_e64 v90, 16, v75
    v_and_b32 v91, 0xffff0000, v75
    v_pk_add_f32 v[28:29], v[28:29], v[88:89]
    v_pk_add_f32 v[30:31], v[30:31], v[90:91]
    v_lshlrev_b32_e64 v88, 16, v76
    v_and_b32 v89, 0xffff0000, v76
    v_lshlrev_b32_e64 v90, 16, v77
    v_and_b32 v91, 0xffff0000, v77
    v_pk_add_f32 v[24:25], v[24:25], v[88:89]
    v_pk_add_f32 v[26:27], v[26:27], v[90:91]
    v_lshlrev_b32_e64 v88, 16, v78
    v_and_b32 v89, 0xffff0000, v78
    v_lshlrev_b32_e64 v90, 16, v79
    v_and_b32 v91, 0xffff0000, v79
    v_pk_add_f32 v[28:29], v[28:29], v[88:89]
    v_pk_add_f32 v[30:31], v[30:31], v[90:91]
    v_lshlrev_b32_e64 v88, 16, v80
    v_and_b32 v89, 0xffff0000, v80
    v_lshlrev_b32_e64 v90, 16, v81
    v_and_b32 v91, 0xffff0000, v81
    v_pk_add_f32 v[24:25], v[24:25], v[88:89]
    v_pk_add_f32 v[26:27], v[26:27], v[90:91]
    v_lshlrev_b32_e64 v88, 16, v82
    v_and_b32 v89, 0xffff0000, v82
    v_lshlrev_b32_e64 v90, 16, v83
    v_and_b32 v91, 0xffff0000, v83
    v_pk_add_f32 v[28:29], v[28:29], v[88:89]
    v_pk_add_f32 v[30:31], v[30:31], v[90:91]
    v_lshlrev_b32_e64 v88, 16, v84
    v_and_b32 v89, 0xffff0000, v84
    v_lshlrev_b32_e64 v90, 16, v85
    v_and_b32 v91, 0xffff0000, v85
    v_pk_add_f32 v[24:25], v[24:25], v[88:89]
    v_pk_add_f32 v[26:27], v[26:27], v[90:91]
    v_lshlrev_b32_e64 v88, 16, v86
    v_and_b32 v89, 0xffff0000, v86
    v_lshlrev_b32_e64 v90, 16, v87
    v_and_b32 v91, 0xffff0000, v87
    v_pk_add_f32 v[28:29], v[28:29], v[88:89]
    v_pk_add_f32 v[30:31], v[30:31], v[90:91]
    s_nop 0
    v_permlane32_swap_b32 v24, v28
    v_permlane32_swap_b32 v25, v29
    v_permlane32_swap_b32 v26, v30
    v_permlane32_swap_b32 v27, v31
    v_add_f32 v24, v24, v28
    v_add_f32 v25, v25, v29
    v_add_f32 v26, v26, v30
    v_add_f32 v27, v27, v31
    s_nop 0
    v_permlane16_swap_b32 v24, v26
    v_permlane16_swap_b32 v25, v27
    v_add_f32_e64 v24, v24, v26
    v_add_f32 v25, v25, v27
    s_nop 0
    v_add_f32_dpp v24, v24, v24 quad_perm:[2,3,0,1] row_mask:0xf bank_mask:0xf
    v_add_f32_dpp v25, v25, v25 quad_perm:[2,3,0,1] row_mask:0xf bank_mask:0xf
    s_nop 0
    v_add_f32_dpp v24, v24, v24 row_ror:4 row_mask:0xf bank_mask:0xf
    v_add_f32_dpp v25, v25, v25 row_ror:4 row_mask:0xf bank_mask:0xf
    s_nop 0
    v_add_f32_dpp v24, v24, v24 row_ror:8 row_mask:0xf bank_mask:0xf
    v_add_f32_dpp v25, v25, v25 row_ror:8 row_mask:0xf bank_mask:0xf
    v_fma_f32 v28, v24, v96, v92
    v_fma_f32 v29, v25, v96, v93
    v_cvt_pk_bf16_f32 v24, v28, v29
    v_cvt_pk_bf16_f32 v25, v28, v29
    v_cvt_pk_bf16_f32 v26, v28, v29
    v_cvt_pk_bf16_f32 v27, v28, v29
    v_permlane16_swap_b32 v24, v25
    s_nop 0
    v_permlane16_swap_b32 v26, v27
    s_nop 1
    v_permlane32_swap_b32_e64 v24, v26
    v_permlane32_swap_b32 v25, v27
    s_mov_b64 exec, 3
    buffer_store_dwordx4 v[24:27], v253, s[12:15], s34 offen sc1
    s_mov_b64 exec, -1
k_end:
k_exit:
    s_endpgm
    s_nop 0
att_exact0:
    s_waitcnt lgkmcnt(0)
    v_mov_b32 v20, 0xffff
    v_mov_b32 v21, 0xffff0000
    v_cndmask_b32 v22, 0, v20, s[40:41]
    v_cndmask_b32 v23, 0, v21, s[42:43]
    v_or_b32_e64 v12, v22, v23
    v_cndmask_b32 v22, 0, v20, s[44:45]
    v_cndmask_b32 v23, 0, v21, s[46:47]
    v_or_b32_e64 v13, v22, v23
    v_cndmask_b32 v22, 0, v20, s[48:49]
    v_cndmask_b32 v23, 0, v21, s[50:51]
    v_or_b32_e64 v14, v22, v23
    v_cndmask_b32 v22, 0, v20, s[52:53]
    v_cndmask_b32 v23, 0, v21, s[54:55]
    v_or_b32_e64 v15, v22, v23
    v_cndmask_b32 v22, 0, v20, s[56:57]
    v_cndmask_b32 v23, 0, v21, s[58:59]
    v_or_b32_e64 v16, v22, v23
    v_cndmask_b32 v22, 0, v20, s[60:61]
    v_cndmask_b32 v23, 0, v21, s[62:63]
    v_or_b32_e64 v17, v22, v23
    v_cndmask_b32 v22, 0, v20, s[64:65]
    v_cndmask_b32 v23, 0, v21, s[66:67]
    v_or_b32_e64 v18, v22, v23
    v_cndmask_b32 v22, 0, v20, s[68:69]
    v_cndmask_b32 v23, 0, v21, s[70:71]
    v_or_b32_e64 v19, v22, v23
    s_and_b32 s34, s76, 3
    s_lshl_b32 s33, s34, 12
    s_add_u32 s33, s33, 65536
    v_add_u32 v20, s33, v253
    v_mov_b32 v24, 0
    v_mov_b32 v25, 0
    v_mov_b32 v26, 0
    v_mov_b32 v27, 0
    v_mov_b32 v28, 0
    v_mov_b32 v29, 0
    v_mov_b32 v30, 0
    v_mov_b32 v31, 0
    v_mov_b32 v32, 0
    v_mov_b32 v33, 0
    v_mov_b32 v34, 0
    v_mov_b32 v35, 0
    v_mov_b32 v36, 0
    v_mov_b32 v37, 0
    v_mov_b32 v38, 0
    v_mov_b32 v39, 0
    ds_read_b128 v[104:107], v20 offset:32768
    ds_read_b128 v[108:111], v20 offset:33792
    ds_read_b128 v[112:115], v20 offset:28672
    ds_read_b128 v[116:119], v20 offset:29696
    s_waitcnt lgkmcnt(2)
    v_mfma_f32_32x32x16_bf16 v[40:55], v[104:107], v[4:7], 0
    v_mfma_f32_32x32x16_bf16 v[40:55], v[108:111], v[8:11], v[40:55]
    ds_read_b128 v[104:107], v20 offset:24576
    ds_read_b128 v[108:111], v20 offset:25600
    s_cmp_eq_u32 s76, 0
    s_cbranch_scc0 ng_125
    v_mov_b32 v24, 0xf149f2ca
    v_mov_b32 v25, 0xf149f2ca
    v_mov_b32 v26, 0xf149f2ca
    v_mov_b32 v27, 0xf149f2ca
    v_mov_b32 v28, 0xf149f2ca
    v_mov_b32 v29, 0xf149f2ca
    v_mov_b32 v30, 0xf149f2ca
    v_mov_b32 v31, 0xf149f2ca
    v_mov_b32 v32, 0xf149f2ca
    v_mov_b32 v33, 0xf149f2ca
    v_mov_b32 v34, 0xf149f2ca
    v_mov_b32 v35, 0xf149f2ca
    v_mov_b32 v36, 0xf149f2ca
    v_mov_b32 v37, 0xf149f2ca
    v_mov_b32 v38, 0xf149f2ca
    v_mov_b32 v39, 0xf149f2ca
ng_125:
    s_waitcnt lgkmcnt(2)
    s_nop 0
    v_mfma_f32_32x32x16_bf16 v[72:87], v[112:115], v[4:7], v[24:39]
    v_mfma_f32_32x32x16_bf16 v[72:87], v[116:119], v[8:11], v[72:87]
    ds_read_b128 v[112:115], v20 offset:20480
    ds_read_b128 v[116:119], v20 offset:21504
    s_cmp_eq_u32 s76, 1
    s_cbranch_scc0 ng_126
    s_nop 1
    v_mov_b32 v24, 0xf149f2ca
    v_mov_b32 v25, 0xf149f2ca
    v_mov_b32 v26, 0xf149f2ca
    v_mov_b32 v27, 0xf149f2ca
    v_mov_b32 v28, 0xf149f2ca
    v_mov_b32 v29, 0xf149f2ca
    v_mov_b32 v30, 0xf149f2ca
    v_mov_b32 v31, 0xf149f2ca
    v_mov_b32 v32, 0xf149f2ca
    v_mov_b32 v33, 0xf149f2ca
    v_mov_b32 v34, 0xf149f2ca
    v_mov_b32 v35, 0xf149f2ca
    v_mov_b32 v36, 0xf149f2ca
    v_mov_b32 v37, 0xf149f2ca
    v_mov_b32 v38, 0xf149f2ca
    v_mov_b32 v39, 0xf149f2ca
ng_126:
    s_waitcnt lgkmcnt(2)
    s_nop 0
    v_mfma_f32_32x32x16_bf16 v[56:71], v[104:107], v[4:7], v[24:39]
    v_mfma_f32_32x32x16_bf16 v[56:71], v[108:111], v[8:11], v[56:71]
    s_nop 3
    v_max_f32_e64 v21, v72, v73
    v_max3_f32 v21, v21, v74, v75
    v_max3_f32 v21, v21, v76, v77
    v_max3_f32 v21, v21, v78, v79
    v_max3_f32 v21, v21, v80, v81
    v_max3_f32 v21, v21, v82, v83
    v_max3_f32 v21, v21, v84, v85
    v_max3_f32 v21, v21, v86, v87
    ds_read_b128 v[104:107], v20 offset:16384
    ds_read_b128 v[108:111], v20 offset:17408
    s_cmp_eq_u32 s76, 2
    s_cbranch_scc0 ng_127
    v_mov_b32 v24, 0xf149f2ca
    v_mov_b32 v25, 0xf149f2ca
    v_mov_b32 v26, 0xf149f2ca
    v_mov_b32 v27, 0xf149f2ca
    v_mov_b32 v28, 0xf149f2ca
    v_mov_b32 v29, 0xf149f2ca
    v_mov_b32 v30, 0xf149f2ca
    v_mov_b32 v31, 0xf149f2ca
    v_mov_b32 v32, 0xf149f2ca
    v_mov_b32 v33, 0xf149f2ca
    v_mov_b32 v34, 0xf149f2ca
    v_mov_b32 v35, 0xf149f2ca
    v_mov_b32 v36, 0xf149f2ca
    v_mov_b32 v37, 0xf149f2ca
    v_mov_b32 v38, 0xf149f2ca
    v_mov_b32 v39, 0xf149f2ca
ng_127:
    s_waitcnt lgkmcnt(2)
    s_nop 0
    v_mfma_f32_32x32x16_bf16 v[72:87], v[112:115], v[4:7], v[24:39]
    v_mfma_f32_32x32x16_bf16 v[72:87], v[116:119], v[8:11], v[72:87]
    v_max3_f32 v21, v21, v56, v57
    v_max3_f32 v21, v21, v58, v59
    v_max3_f32 v21, v21, v60, v61
    v_max3_f32 v21, v21, v62, v63
    v_max3_f32 v21, v21, v64, v65
    v_max3_f32 v21, v21, v66, v67
    v_max3_f32 v21, v21, v68, v69
    v_max3_f32 v21, v21, v70, v71
    ds_read_b128 v[112:115], v20 offset:12288
    ds_read_b128 v[116:119], v20 offset:13312
    s_cmp_eq_u32 s76, 3
    s_cbranch_scc0 ng_128
    v_mov_b32 v24, 0xf149f2ca
    v_mov_b32 v25, 0xf149f2ca
    v_mov_b32 v26, 0xf149f2ca
    v_mov_b32 v27, 0xf149f2ca
    v_mov_b32 v28, 0xf149f2ca
    v_mov_b32 v29, 0xf149f2ca
    v_mov_b32 v30, 0xf149f2ca
    v_mov_b32 v31, 0xf149f2ca
    v_mov_b32 v32, 0xf149f2ca
    v_mov_b32 v33, 0xf149f2ca
    v_mov_b32 v34, 0xf149f2ca
    v_mov_b32 v35, 0xf149f2ca
    v_mov_b32 v36, 0xf149f2ca
    v_mov_b32 v37, 0xf149f2ca
    v_mov_b32 v38, 0xf149f2ca
    v_mov_b32 v39, 0xf149f2ca
ng_128:
    s_waitcnt lgkmcnt(2)
    s_nop 0
    v_mfma_f32_32x32x16_bf16 v[56:71], v[104:107], v[4:7], v[24:39]
    v_mfma_f32_32x32x16_bf16 v[56:71], v[108:111], v[8:11], v[56:71]
    v_max3_f32 v21, v21, v72, v73
    v_max3_f32 v21, v21, v74, v75
    v_max3_f32 v21, v21, v76, v77
    v_max3_f32 v21, v21, v78, v79
    v_max3_f32 v21, v21, v80, v81
    v_max3_f32 v21, v21, v82, v83
    v_max3_f32 v21, v21, v84, v85
    v_max3_f32 v21, v21, v86, v87
    ds_read_b128 v[104:107], v20 offset:8192
    ds_read_b128 v[108:111], v20 offset:9216
    s_cmp_eq_u32 s76, 4
    s_cbranch_scc0 ng_129
    v_mov_b32 v24, 0xf149f2ca
    v_mov_b32 v25, 0xf149f2ca
    v_mov_b32 v26, 0xf149f2ca
    v_mov_b32 v27, 0xf149f2ca
    v_mov_b32 v28, 0xf149f2ca
    v_mov_b32 v29, 0xf149f2ca
    v_mov_b32 v30, 0xf149f2ca
    v_mov_b32 v31, 0xf149f2ca
    v_mov_b32 v32, 0xf149f2ca
    v_mov_b32 v33, 0xf149f2ca
    v_mov_b32 v34, 0xf149f2ca
    v_mov_b32 v35, 0xf149f2ca
    v_mov_b32 v36, 0xf149f2ca
    v_mov_b32 v37, 0xf149f2ca
    v_mov_b32 v38, 0xf149f2ca
    v_mov_b32 v39, 0xf149f2ca
ng_129:
    s_waitcnt lgkmcnt(2)
    s_nop 0
    v_mfma_f32_32x32x16_bf16 v[72:87], v[112:115], v[4:7], v[24:39]
    v_mfma_f32_32x32x16_bf16 v[72:87], v[116:119], v[8:11], v[72:87]
    v_max3_f32 v21, v21, v56, v57
    v_max3_f32 v21, v21, v58, v59
    v_max3_f32 v21, v21, v60, v61
    v_max3_f32 v21, v21, v62, v63
    v_max3_f32 v21, v21, v64, v65
    v_max3_f32 v21, v21, v66, v67
    v_max3_f32 v21, v21, v68, v69
    v_max3_f32 v21, v21, v70, v71
    ds_read_b128 v[112:115], v20 offset:4096
    ds_read_b128 v[116:119], v20 offset:5120
    s_cmp_eq_u32 s76, 5
    s_cbranch_scc0 ng_130
    v_mov_b32 v24, 0xf149f2ca
    v_mov_b32 v25, 0xf149f2ca
    v_mov_b32 v26, 0xf149f2ca
    v_mov_b32 v27, 0xf149f2ca
    v_mov_b32 v28, 0xf149f2ca
    v_mov_b32 v29, 0xf149f2ca
    v_mov_b32 v30, 0xf149f2ca
    v_mov_b32 v31, 0xf149f2ca
    v_mov_b32 v32, 0xf149f2ca
    v_mov_b32 v33, 0xf149f2ca
    v_mov_b32 v34, 0xf149f2ca
    v_mov_b32 v35, 0xf149f2ca
    v_mov_b32 v36, 0xf149f2ca
    v_mov_b32 v37, 0xf149f2ca
    v_mov_b32 v38, 0xf149f2ca
    v_mov_b32 v39, 0xf149f2ca
ng_130:
    s_waitcnt lgkmcnt(2)
    s_nop 0
    v_mfma_f32_32x32x16_bf16 v[56:71], v[104:107], v[4:7], v[24:39]
    v_mfma_f32_32x32x16_bf16 v[56:71], v[108:111], v[8:11], v[56:71]
    v_max3_f32 v21, v21, v72, v73
    v_max3_f32 v21, v21, v74, v75
    v_max3_f32 v21, v21, v76, v77
    v_max3_f32 v21, v21, v78, v79
    v_max3_f32 v21, v21, v80, v81
    v_max3_f32 v21, v21, v82, v83
    v_max3_f32 v21, v21, v84, v85
    v_max3_f32 v21, v21, v86, v87
    ds_read_b128 v[104:107], v20 offset:0
    ds_read_b128 v[108:111], v20 offset:1024
    s_cmp_eq_u32 s76, 6
    s_cbranch_scc0 ng_131
    v_mov_b32 v24, 0xf149f2ca
    v_mov_b32 v25, 0xf149f2ca
    v_mov_b32 v26, 0xf149f2ca
    v_mov_b32 v27, 0xf149f2ca
    v_mov_b32 v28, 0xf149f2ca
    v_mov_b32 v29, 0xf149f2ca
    v_mov_b32 v30, 0xf149f2ca
    v_mov_b32 v31, 0xf149f2ca
    v_mov_b32 v32, 0xf149f2ca
    v_mov_b32 v33, 0xf149f2ca
    v_mov_b32 v34, 0xf149f2ca
    v_mov_b32 v35, 0xf149f2ca
    v_mov_b32 v36, 0xf149f2ca
    v_mov_b32 v37, 0xf149f2ca
    v_mov_b32 v38, 0xf149f2ca
    v_mov_b32 v39, 0xf149f2ca
ng_131:
    s_waitcnt lgkmcnt(2)
    s_nop 0
    v_mfma_f32_32x32x16_bf16 v[72:87], v[112:115], v[4:7], v[24:39]
    v_mfma_f32_32x32x16_bf16 v[72:87], v[116:119], v[8:11], v[72:87]
    v_max3_f32 v21, v21, v56, v57
    v_max3_f32 v21, v21, v58, v59
    v_max3_f32 v21, v21, v60, v61
    v_max3_f32 v21, v21, v62, v63
    v_max3_f32 v21, v21, v64, v65
    v_max3_f32 v21, v21, v66, v67
    v_max3_f32 v21, v21, v68, v69
    v_max3_f32 v21, v21, v70, v71
    s_cmp_eq_u32 s76, 7
    s_cbranch_scc0 ng_132
    v_mov_b32 v24, 0xf149f2ca
    v_mov_b32 v25, 0xf149f2ca
    v_mov_b32 v26, 0xf149f2ca
    v_mov_b32 v27, 0xf149f2ca
    v_mov_b32 v28, 0xf149f2ca
    v_mov_b32 v29, 0xf149f2ca
    v_mov_b32 v30, 0xf149f2ca
    v_mov_b32 v31, 0xf149f2ca
    v_mov_b32 v32, 0xf149f2ca
    v_mov_b32 v33, 0xf149f2ca
    v_mov_b32 v34, 0xf149f2ca
    v_mov_b32 v35, 0xf149f2ca
    v_mov_b32 v36, 0xf149f2ca
    v_mov_b32 v37, 0xf149f2ca
    v_mov_b32 v38, 0xf149f2ca
    v_mov_b32 v39, 0xf149f2ca
ng_132:
    s_waitcnt lgkmcnt(0)
    s_nop 0
    v_mfma_f32_32x32x16_bf16 v[56:71], v[104:107], v[4:7], v[24:39]
    v_mfma_f32_32x32x16_bf16 v[56:71], v[108:111], v[8:11], v[56:71]
    v_max3_f32 v21, v21, v72, v73
    v_max3_f32 v21, v21, v74, v75
    v_max3_f32 v21, v21, v76, v77
    v_max3_f32 v21, v21, v78, v79
    v_max3_f32 v21, v21, v80, v81
    v_max3_f32 v21, v21, v82, v83
    v_max3_f32 v21, v21, v84, v85
    v_max3_f32 v21, v21, v86, v87
    ds_read_b128 v[112:115], v20 offset:28672
    ds_read_b128 v[116:119], v20 offset:29696
    ds_read_b128 v[120:123], v20 offset:34816
    ds_read_b128 v[124:127], v20 offset:35840
    ds_read_b128 v[128:131], v20 offset:2048
    ds_read_b128 v[132:135], v20 offset:3072
    v_cndmask_b32 v40, v56, v40, s[40:41]
    v_cndmask_b32 v41, v57, v41, s[42:43]
    v_cndmask_b32 v42, v58, v42, s[44:45]
    v_cndmask_b32 v43, v59, v43, s[46:47]
    v_cndmask_b32 v44, v60, v44, s[48:49]
    v_cndmask_b32 v45, v61, v45, s[50:51]
    v_cndmask_b32 v46, v62, v46, s[52:53]
    v_cndmask_b32 v47, v63, v47, s[54:55]
    v_cndmask_b32 v48, v64, v48, s[56:57]
    v_cndmask_b32 v49, v65, v49, s[58:59]
    v_cndmask_b32 v50, v66, v50, s[60:61]
    v_cndmask_b32 v51, v67, v51, s[62:63]
    v_cndmask_b32 v52, v68, v52, s[64:65]
    v_cndmask_b32 v53, v69, v53, s[66:67]
    v_cndmask_b32 v54, v70, v54, s[68:69]
    v_cndmask_b32 v55, v71, v55, s[70:71]
    v_max3_f32 v21, v21, v40, v41
    v_max3_f32 v21, v21, v42, v43
    v_max3_f32 v21, v21, v44, v45
    v_max3_f32 v21, v21, v46, v47
    v_max3_f32 v21, v21, v48, v49
    v_max3_f32 v21, v21, v50, v51
    v_max3_f32 v21, v21, v52, v53
    v_max3_f32 v21, v21, v54, v55
    v_mov_b32 v152, v21
    s_nop 1
    v_permlane32_swap_b32 v21, v152
    v_max_f32 v21, v21, v152
    v_sub_f32 v24, 0, v21
    v_sub_f32 v25, 0, v21
    v_sub_f32 v26, 0, v21
    v_sub_f32 v27, 0, v21
    v_sub_f32 v28, 0, v21
    v_sub_f32 v29, 0, v21
    v_sub_f32 v30, 0, v21
    v_sub_f32 v31, 0, v21
    v_sub_f32 v32, 0, v21
    v_sub_f32 v33, 0, v21
    v_sub_f32 v34, 0, v21
    v_sub_f32 v35, 0, v21
    v_sub_f32 v36, 0, v21
    v_sub_f32 v37, 0, v21
    v_sub_f32 v38, 0, v21
    v_sub_f32 v39, 0, v21
    s_cmp_eq_u32 s76, 0
    s_cbranch_scc0 ng_133
    v_mov_b32 v24, 0xf149f2ca
    v_mov_b32 v25, 0xf149f2ca
    v_mov_b32 v26, 0xf149f2ca
    v_mov_b32 v27, 0xf149f2ca
    v_mov_b32 v28, 0xf149f2ca
    v_mov_b32 v29, 0xf149f2ca
    v_mov_b32 v30, 0xf149f2ca
    v_mov_b32 v31, 0xf149f2ca
    v_mov_b32 v32, 0xf149f2ca
    v_mov_b32 v33, 0xf149f2ca
    v_mov_b32 v34, 0xf149f2ca
    v_mov_b32 v35, 0xf149f2ca
    v_mov_b32 v36, 0xf149f2ca
    v_mov_b32 v37, 0xf149f2ca
    v_mov_b32 v38, 0xf149f2ca
    v_mov_b32 v39, 0xf149f2ca
ng_133:
    s_waitcnt lgkmcnt(4)
    s_nop 0
    v_mfma_f32_32x32x16_bf16 v[72:87], v[112:115], v[4:7], v[24:39]
    v_mfma_f32_32x32x16_bf16 v[72:87], v[116:119], v[8:11], v[72:87]
    ds_read_b128 v[104:107], v20 offset:24576
    ds_read_b128 v[108:111], v20 offset:25600
    v_sub_f32 v40, v40, v21
    v_sub_f32 v41, v41, v21
    v_sub_f32 v42, v42, v21
    v_sub_f32 v43, v43, v21
    v_sub_f32 v44, v44, v21
    v_sub_f32 v45, v45, v21
    v_sub_f32 v46, v46, v21
    v_sub_f32 v47, v47, v21
    v_sub_f32 v48, v48, v21
    v_sub_f32 v49, v49, v21
    v_sub_f32 v50, v50, v21
    v_sub_f32 v51, v51, v21
    v_sub_f32 v52, v52, v21
    v_sub_f32 v53, v53, v21
    v_sub_f32 v54, v54, v21
    v_sub_f32 v55, v55, v21
    v_exp_f32 v40, v40
    v_exp_f32 v41, v41
    v_exp_f32 v42, v42
    v_exp_f32 v43, v43
    v_exp_f32 v44, v44
    v_exp_f32 v45, v45
    v_exp_f32 v46, v46
    v_exp_f32 v47, v47
    v_exp_f32 v48, v48
    v_exp_f32 v49, v49
    v_exp_f32 v50, v50
    v_exp_f32 v51, v51
    v_exp_f32 v52, v52
    v_exp_f32 v53, v53
    v_exp_f32 v54, v54
    v_exp_f32 v55, v55
    v_add_f32 v22, v40, v41
    v_add_f32 v23, v42, v43
    v_add_f32 v22, v22, v44
    v_add_f32 v23, v23, v45
    v_add_f32 v22, v22, v46
    v_add_f32 v23, v23, v47
    v_add_f32 v22, v22, v48
    v_add_f32 v23, v23, v49
    v_add_f32 v22, v22, v50
    v_add_f32 v23, v23, v51
    v_add_f32 v22, v22, v52
    v_add_f32 v23, v23, v53
    v_add_f32 v22, v22, v54
    v_add_f32 v23, v23, v55
    v_cvt_pk_bf16_f32 v144, v40, v41
    v_cvt_pk_bf16_f32 v145, v42, v43
    v_cvt_pk_bf16_f32 v146, v44, v45
    v_cvt_pk_bf16_f32 v147, v46, v47
    v_cvt_pk_bf16_f32 v148, v48, v49
    v_cvt_pk_bf16_f32 v149, v50, v51
    v_cvt_pk_bf16_f32 v150, v52, v53
    v_cvt_pk_bf16_f32 v151, v54, v55
    v_and_b32 v136, v144, v12
    v_and_b32 v137, v145, v13
    v_and_b32 v138, v146, v14
    v_and_b32 v139, v147, v15
    v_and_b32 v140, v148, v16
    v_and_b32 v141, v149, v17
    v_and_b32 v142, v150, v18
    v_and_b32 v143, v151, v19
    v_xor_b32 v144, v144, v136
    v_xor_b32 v145, v145, v137
    v_xor_b32 v146, v146, v138
    v_xor_b32 v147, v147, v139
    v_xor_b32 v148, v148, v140
    v_xor_b32 v149, v149, v141
    v_xor_b32_e64 v150, v150, v142
    v_xor_b32 v151, v151, v143
    s_waitcnt lgkmcnt(2)
    v_mfma_f32_32x32x16_bf16 v[88:103], v[120:123], v[136:139], 0
    v_mfma_f32_32x32x16_bf16 v[88:103], v[124:127], v[140:143], v[88:103]
    v_mfma_f32_32x32x16_bf16 v[88:103], v[128:131], v[144:147], v[88:103]
    v_mfma_f32_32x32x16_bf16 v[88:103], v[132:135], v[148:151], v[88:103]
    ds_read_b128 v[128:131], v20 offset:30720
    ds_read_b128 v[132:135], v20 offset:31744
    s_cmp_eq_u32 s76, 1
    s_cbranch_scc0 ng_134
    v_mov_b32 v24, 0xf149f2ca
    v_mov_b32 v25, 0xf149f2ca
    v_mov_b32 v26, 0xf149f2ca
    v_mov_b32 v27, 0xf149f2ca
    v_mov_b32 v28, 0xf149f2ca
    v_mov_b32 v29, 0xf149f2ca
    v_mov_b32 v30, 0xf149f2ca
    v_mov_b32 v31, 0xf149f2ca
    v_mov_b32 v32, 0xf149f2ca
    v_mov_b32 v33, 0xf149f2ca
    v_mov_b32 v34, 0xf149f2ca
    v_mov_b32 v35, 0xf149f2ca
    v_mov_b32 v36, 0xf149f2ca
    v_mov_b32 v37, 0xf149f2ca
    v_mov_b32 v38, 0xf149f2ca
    v_mov_b32 v39, 0xf149f2ca
ng_134:
    s_waitcnt lgkmcnt(2)
    s_nop 0
    v_mfma_f32_32x32x16_bf16 v[56:71], v[104:107], v[4:7], v[24:39]
    v_mfma_f32_32x32x16_bf16 v[56:71], v[108:111], v[8:11], v[56:71]
    ds_read_b128 v[112:115], v20 offset:20480
    ds_read_b128 v[116:119], v20 offset:21504
    v_exp_f32 v72, v72
    v_exp_f32 v73, v73
    v_exp_f32 v74, v74
    v_exp_f32 v75, v75
    v_exp_f32 v76, v76
    v_exp_f32 v77, v77
    v_exp_f32 v78, v78
    v_exp_f32 v79, v79
    v_exp_f32 v80, v80
    v_exp_f32 v81, v81
    v_exp_f32 v82, v82
    v_exp_f32 v83, v83
    v_exp_f32 v84, v84
    v_exp_f32 v85, v85
    v_exp_f32 v86, v86
    v_exp_f32 v87, v87
    v_add_f32 v22, v22, v72
    v_add_f32 v23, v23, v73
    v_add_f32 v22, v22, v74
    v_add_f32 v23, v23, v75
    v_add_f32 v22, v22, v76
    v_add_f32 v23, v23, v77
    v_add_f32 v22, v22, v78
    v_add_f32 v23, v23, v79
    v_add_f32 v22, v22, v80
    v_add_f32 v23, v23, v81
    v_add_f32 v22, v22, v82
    v_add_f32 v23, v23, v83
    v_add_f32 v22, v22, v84
    v_add_f32 v23, v23, v85
    v_add_f32_e64 v22, v22, v86
    v_add_f32 v23, v23, v87
    v_cvt_pk_bf16_f32 v144, v72, v73
    v_cvt_pk_bf16_f32 v145, v74, v75
    v_cvt_pk_bf16_f32 v146, v76, v77
    v_cvt_pk_bf16_f32 v147, v78, v79
    v_cvt_pk_bf16_f32 v148, v80, v81
    v_cvt_pk_bf16_f32 v149, v82, v83
    v_cvt_pk_bf16_f32 v150, v84, v85
    v_cvt_pk_bf16_f32 v151, v86, v87
    s_waitcnt lgkmcnt(2)
    v_mfma_f32_32x32x16_bf16 v[88:103], v[128:131], v[144:147], v[88:103]
    v_mfma_f32_32x32x16_bf16 v[88:103], v[132:135], v[148:151], v[88:103]
    ds_read_b128 v[120:123], v20 offset:26624
    ds_read_b128 v[124:127], v20 offset:27648
    s_cmp_eq_u32 s76, 2
    s_cbranch_scc0 ng_135
    v_mov_b32 v24, 0xf149f2ca
    v_mov_b32 v25, 0xf149f2ca
    v_mov_b32 v26, 0xf149f2ca
    v_mov_b32 v27, 0xf149f2ca
    v_mov_b32 v28, 0xf149f2ca
    v_mov_b32 v29, 0xf149f2ca
    v_mov_b32 v30, 0xf149f2ca
    v_mov_b32 v31, 0xf149f2ca
    v_mov_b32 v32, 0xf149f2ca
    v_mov_b32 v33, 0xf149f2ca
    v_mov_b32 v34, 0xf149f2ca
    v_mov_b32 v35, 0xf149f2ca
    v_mov_b32 v36, 0xf149f2ca
    v_mov_b32 v37, 0xf149f2ca
    v_mov_b32 v38, 0xf149f2ca
    v_mov_b32 v39, 0xf149f2ca
ng_135:
    s_waitcnt lgkmcnt(2)
    s_nop 0
    v_mfma_f32_32x32x16_bf16 v[72:87], v[112:115], v[4:7], v[24:39]
    v_mfma_f32_32x32x16_bf16 v[72:87], v[116:119], v[8:11], v[72:87]
    ds_read_b128 v[104:107], v20 offset:16384
    ds_read_b128 v[108:111], v20 offset:17408
    v_exp_f32 v56, v56
    v_exp_f32 v57, v57
    v_exp_f32 v58, v58
    v_exp_f32 v59, v59
    v_exp_f32 v60, v60
    v_exp_f32 v61, v61
    v_exp_f32 v62, v62
    v_exp_f32 v63, v63
    v_exp_f32 v64, v64
    v_exp_f32 v65, v65
    v_exp_f32 v66, v66
    v_exp_f32 v67, v67
    v_exp_f32 v68, v68
    v_exp_f32 v69, v69
    v_exp_f32 v70, v70
    v_exp_f32 v71, v71
    v_add_f32 v22, v22, v56
    v_add_f32 v23, v23, v57
    v_add_f32 v22, v22, v58
    v_add_f32 v23, v23, v59
    v_add_f32 v22, v22, v60
    v_add_f32 v23, v23, v61
    v_add_f32 v22, v22, v62
    v_add_f32 v23, v23, v63
    v_add_f32 v22, v22, v64
    v_add_f32 v23, v23, v65
    v_add_f32 v22, v22, v66
    v_add_f32 v23, v23, v67
    v_add_f32 v22, v22, v68
    v_add_f32 v23, v23, v69
    v_add_f32_e64 v22, v22, v70
    v_add_f32 v23, v23, v71
    v_cvt_pk_bf16_f32 v136, v56, v57
    v_cvt_pk_bf16_f32 v137, v58, v59
    v_cvt_pk_bf16_f32 v138, v60, v61
    v_cvt_pk_bf16_f32 v139, v62, v63
    v_cvt_pk_bf16_f32 v140, v64, v65
    v_cvt_pk_bf16_f32 v141, v66, v67
    v_cvt_pk_bf16_f32 v142, v68, v69
    v_cvt_pk_bf16_f32 v143, v70, v71
    s_waitcnt lgkmcnt(2)
    v_mfma_f32_32x32x16_bf16 v[88:103], v[120:123], v[136:139], v[88:103]
    v_mfma_f32_32x32x16_bf16 v[88:103], v[124:127], v[140:143], v[88:103]
    ds_read_b128 v[128:131], v20 offset:22528
    ds_read_b128 v[132:135], v20 offset:23552
    s_cmp_eq_u32 s76, 3
    s_cbranch_scc0 ng_136
    v_mov_b32 v24, 0xf149f2ca
    v_mov_b32 v25, 0xf149f2ca
    v_mov_b32 v26, 0xf149f2ca
    v_mov_b32 v27, 0xf149f2ca
    v_mov_b32 v28, 0xf149f2ca
    v_mov_b32 v29, 0xf149f2ca
    v_mov_b32 v30, 0xf149f2ca
    v_mov_b32 v31, 0xf149f2ca
    v_mov_b32 v32, 0xf149f2ca
    v_mov_b32 v33, 0xf149f2ca
    v_mov_b32 v34, 0xf149f2ca
    v_mov_b32 v35, 0xf149f2ca
    v_mov_b32 v36, 0xf149f2ca
    v_mov_b32 v37, 0xf149f2ca
    v_mov_b32 v38, 0xf149f2ca
    v_mov_b32 v39, 0xf149f2ca
ng_136:
    s_waitcnt lgkmcnt(2)
    s_nop 0
    v_mfma_f32_32x32x16_bf16 v[56:71], v[104:107], v[4:7], v[24:39]
    v_mfma_f32_32x32x16_bf16 v[56:71], v[108:111], v[8:11], v[56:71]
    ds_read_b128 v[112:115], v20 offset:12288
    ds_read_b128 v[116:119], v20 offset:13312
    v_exp_f32 v72, v72
    v_exp_f32 v73, v73
    v_exp_f32 v74, v74
    v_exp_f32 v75, v75
    v_exp_f32 v76, v76
    v_exp_f32 v77, v77
    v_exp_f32 v78, v78
    v_exp_f32 v79, v79
    v_exp_f32 v80, v80
    v_exp_f32 v81, v81
    v_exp_f32 v82, v82
    v_exp_f32 v83, v83
    v_exp_f32 v84, v84
    v_exp_f32 v85, v85
    v_exp_f32 v86, v86
    v_exp_f32 v87, v87
    v_add_f32 v22, v22, v72
    v_add_f32 v23, v23, v73
    v_add_f32 v22, v22, v74
    v_add_f32 v23, v23, v75
    v_add_f32 v22, v22, v76
    v_add_f32 v23, v23, v77
    v_add_f32 v22, v22, v78
    v_add_f32 v23, v23, v79
    v_add_f32 v22, v22, v80
    v_add_f32 v23, v23, v81
    v_add_f32 v22, v22, v82
    v_add_f32 v23, v23, v83
    v_add_f32 v22, v22, v84
    v_add_f32 v23, v23, v85
    v_add_f32_e64 v22, v22, v86
    v_add_f32 v23, v23, v87
    v_cvt_pk_bf16_f32 v144, v72, v73
    v_cvt_pk_bf16_f32 v145, v74, v75
    v_cvt_pk_bf16_f32 v146, v76, v77
    v_cvt_pk_bf16_f32 v147, v78, v79
    v_cvt_pk_bf16_f32 v148, v80, v81
    v_cvt_pk_bf16_f32 v149, v82, v83
    v_cvt_pk_bf16_f32 v150, v84, v85
    v_cvt_pk_bf16_f32 v151, v86, v87
    s_waitcnt lgkmcnt(2)
    v_mfma_f32_32x32x16_bf16 v[88:103], v[128:131], v[144:147], v[88:103]
    v_mfma_f32_32x32x16_bf16 v[88:103], v[132:135], v[148:151], v[88:103]
    ds_read_b128 v[120:123], v20 offset:18432
    ds_read_b128 v[124:127], v20 offset:19456
    s_cmp_eq_u32 s76, 4
    s_cbranch_scc0 ng_137
    v_mov_b32 v24, 0xf149f2ca
    v_mov_b32 v25, 0xf149f2ca
    v_mov_b32 v26, 0xf149f2ca
    v_mov_b32 v27, 0xf149f2ca
    v_mov_b32 v28, 0xf149f2ca
    v_mov_b32 v29, 0xf149f2ca
    v_mov_b32 v30, 0xf149f2ca
    v_mov_b32 v31, 0xf149f2ca
    v_mov_b32 v32, 0xf149f2ca
    v_mov_b32 v33, 0xf149f2ca
    v_mov_b32 v34, 0xf149f2ca
    v_mov_b32 v35, 0xf149f2ca
    v_mov_b32 v36, 0xf149f2ca
    v_mov_b32 v37, 0xf149f2ca
    v_mov_b32 v38, 0xf149f2ca
    v_mov_b32 v39, 0xf149f2ca
ng_137:
    s_waitcnt lgkmcnt(2)
    s_nop 0
    v_mfma_f32_32x32x16_bf16 v[72:87], v[112:115], v[4:7], v[24:39]
    v_mfma_f32_32x32x16_bf16 v[72:87], v[116:119], v[8:11], v[72:87]
    ds_read_b128 v[104:107], v20 offset:8192
    ds_read_b128 v[108:111], v20 offset:9216
    v_exp_f32 v56, v56
    v_exp_f32 v57, v57
    v_exp_f32 v58, v58
    v_exp_f32 v59, v59
    v_exp_f32 v60, v60
    v_exp_f32 v61, v61
    v_exp_f32 v62, v62
    v_exp_f32 v63, v63
    v_exp_f32 v64, v64
    v_exp_f32 v65, v65
    v_exp_f32 v66, v66
    v_exp_f32 v67, v67
    v_exp_f32 v68, v68
    v_exp_f32 v69, v69
    v_exp_f32 v70, v70
    v_exp_f32 v71, v71
    v_add_f32 v22, v22, v56
    v_add_f32 v23, v23, v57
    v_add_f32 v22, v22, v58
    v_add_f32 v23, v23, v59
    v_add_f32 v22, v22, v60
    v_add_f32 v23, v23, v61
    v_add_f32 v22, v22, v62
    v_add_f32 v23, v23, v63
    v_add_f32 v22, v22, v64
    v_add_f32 v23, v23, v65
    v_add_f32 v22, v22, v66
    v_add_f32 v23, v23, v67
    v_add_f32 v22, v22, v68
    v_add_f32 v23, v23, v69
    v_add_f32_e64 v22, v22, v70
    v_add_f32 v23, v23, v71
    v_cvt_pk_bf16_f32 v136, v56, v57
    v_cvt_pk_bf16_f32 v137, v58, v59
    v_cvt_pk_bf16_f32 v138, v60, v61
    v_cvt_pk_bf16_f32 v139, v62, v63
    v_cvt_pk_bf16_f32 v140, v64, v65
    v_cvt_pk_bf16_f32 v141, v66, v67
    v_cvt_pk_bf16_f32 v142, v68, v69
    v_cvt_pk_bf16_f32 v143, v70, v71
    s_waitcnt lgkmcnt(2)
    v_mfma_f32_32x32x16_bf16 v[88:103], v[120:123], v[136:139], v[88:103]
    v_mfma_f32_32x32x16_bf16 v[88:103], v[124:127], v[140:143], v[88:103]
    ds_read_b128 v[128:131], v20 offset:14336
    ds_read_b128 v[132:135], v20 offset:15360
    s_cmp_eq_u32 s76, 5
    s_cbranch_scc0 ng_138
    v_mov_b32 v24, 0xf149f2ca
    v_mov_b32 v25, 0xf149f2ca
    v_mov_b32 v26, 0xf149f2ca
    v_mov_b32 v27, 0xf149f2ca
    v_mov_b32 v28, 0xf149f2ca
    v_mov_b32 v29, 0xf149f2ca
    v_mov_b32 v30, 0xf149f2ca
    v_mov_b32 v31, 0xf149f2ca
    v_mov_b32 v32, 0xf149f2ca
    v_mov_b32 v33, 0xf149f2ca
    v_mov_b32 v34, 0xf149f2ca
    v_mov_b32 v35, 0xf149f2ca
    v_mov_b32 v36, 0xf149f2ca
    v_mov_b32 v37, 0xf149f2ca
    v_mov_b32 v38, 0xf149f2ca
    v_mov_b32 v39, 0xf149f2ca
ng_138:
    s_waitcnt lgkmcnt(2)
    s_nop 0
    v_mfma_f32_32x32x16_bf16 v[56:71], v[104:107], v[4:7], v[24:39]
    v_mfma_f32_32x32x16_bf16 v[56:71], v[108:111], v[8:11], v[56:71]
    ds_read_b128 v[112:115], v20 offset:4096
    ds_read_b128 v[116:119], v20 offset:5120
    v_exp_f32 v72, v72
    v_exp_f32 v73, v73
    v_exp_f32 v74, v74
    v_exp_f32 v75, v75
    v_exp_f32 v76, v76
    v_exp_f32 v77, v77
    v_exp_f32 v78, v78
    v_exp_f32 v79, v79
    v_exp_f32 v80, v80
    v_exp_f32 v81, v81
    v_exp_f32 v82, v82
    v_exp_f32 v83, v83
    v_exp_f32 v84, v84
    v_exp_f32 v85, v85
    v_exp_f32 v86, v86
    v_exp_f32 v87, v87
    v_add_f32 v22, v22, v72
    v_add_f32 v23, v23, v73
    v_add_f32 v22, v22, v74
    v_add_f32 v23, v23, v75
    v_add_f32 v22, v22, v76
    v_add_f32 v23, v23, v77
    v_add_f32 v22, v22, v78
    v_add_f32 v23, v23, v79
    v_add_f32 v22, v22, v80
    v_add_f32 v23, v23, v81
    v_add_f32 v22, v22, v82
    v_add_f32 v23, v23, v83
    v_add_f32 v22, v22, v84
    v_add_f32 v23, v23, v85
    v_add_f32_e64 v22, v22, v86
    v_add_f32 v23, v23, v87
    v_cvt_pk_bf16_f32 v144, v72, v73
    v_cvt_pk_bf16_f32 v145, v74, v75
    v_cvt_pk_bf16_f32 v146, v76, v77
    v_cvt_pk_bf16_f32 v147, v78, v79
    v_cvt_pk_bf16_f32 v148, v80, v81
    v_cvt_pk_bf16_f32 v149, v82, v83
    v_cvt_pk_bf16_f32 v150, v84, v85
    v_cvt_pk_bf16_f32 v151, v86, v87
    s_waitcnt lgkmcnt(2)
    v_mfma_f32_32x32x16_bf16 v[88:103], v[128:131], v[144:147], v[88:103]
    v_mfma_f32_32x32x16_bf16 v[88:103], v[132:135], v[148:151], v[88:103]
    ds_read_b128 v[120:123], v20 offset:10240
    ds_read_b128 v[124:127], v20 offset:11264
    s_cmp_eq_u32 s76, 6
    s_cbranch_scc0 ng_139
    v_mov_b32 v24, 0xf149f2ca
    v_mov_b32 v25, 0xf149f2ca
    v_mov_b32 v26, 0xf149f2ca
    v_mov_b32 v27, 0xf149f2ca
    v_mov_b32 v28, 0xf149f2ca
    v_mov_b32 v29, 0xf149f2ca
    v_mov_b32 v30, 0xf149f2ca
    v_mov_b32 v31, 0xf149f2ca
    v_mov_b32 v32, 0xf149f2ca
    v_mov_b32 v33, 0xf149f2ca
    v_mov_b32 v34, 0xf149f2ca
    v_mov_b32 v35, 0xf149f2ca
    v_mov_b32 v36, 0xf149f2ca
    v_mov_b32 v37, 0xf149f2ca
    v_mov_b32 v38, 0xf149f2ca
    v_mov_b32 v39, 0xf149f2ca
ng_139:
    s_waitcnt lgkmcnt(2)
    s_nop 0
    v_mfma_f32_32x32x16_bf16 v[72:87], v[112:115], v[4:7], v[24:39]
    v_mfma_f32_32x32x16_bf16 v[72:87], v[116:119], v[8:11], v[72:87]
    v_exp_f32 v56, v56
    v_exp_f32 v57, v57
    v_exp_f32 v58, v58
    v_exp_f32 v59, v59
    v_exp_f32 v60, v60
    v_exp_f32 v61, v61
    v_exp_f32 v62, v62
    v_exp_f32 v63, v63
    v_exp_f32 v64, v64
    v_exp_f32 v65, v65
    v_exp_f32 v66, v66
    v_exp_f32 v67, v67
    v_exp_f32 v68, v68
    v_exp_f32 v69, v69
    v_exp_f32 v70, v70
    v_exp_f32 v71, v71
    v_add_f32 v22, v22, v56
    v_add_f32 v23, v23, v57
    v_add_f32 v22, v22, v58
    v_add_f32 v23, v23, v59
    v_add_f32 v22, v22, v60
    v_add_f32 v23, v23, v61
    v_add_f32 v22, v22, v62
    v_add_f32 v23, v23, v63
    v_add_f32 v22, v22, v64
    v_add_f32 v23, v23, v65
    v_add_f32 v22, v22, v66
    v_add_f32 v23, v23, v67
    v_add_f32 v22, v22, v68
    v_add_f32 v23, v23, v69
    v_add_f32 v22, v22, v70
    v_add_f32 v23, v23, v71
    v_cvt_pk_bf16_f32 v136, v56, v57
    v_cvt_pk_bf16_f32 v137, v58, v59
    v_cvt_pk_bf16_f32 v138, v60, v61
    v_cvt_pk_bf16_f32 v139, v62, v63
    v_cvt_pk_bf16_f32 v140, v64, v65
    v_cvt_pk_bf16_f32 v141, v66, v67
    v_cvt_pk_bf16_f32 v142, v68, v69
    v_cvt_pk_bf16_f32 v143, v70, v71
    s_waitcnt lgkmcnt(0)
    v_mfma_f32_32x32x16_bf16 v[88:103], v[120:123], v[136:139], v[88:103]
    v_mfma_f32_32x32x16_bf16 v[88:103], v[124:127], v[140:143], v[88:103]
    ds_read_b128 v[128:131], v20 offset:6144
    ds_read_b128 v[132:135], v20 offset:7168
    v_exp_f32 v72, v72
    v_exp_f32 v73, v73
    v_exp_f32 v74, v74
    v_exp_f32 v75, v75
    v_exp_f32 v76, v76
    v_exp_f32 v77, v77
    v_exp_f32 v78, v78
    v_exp_f32 v79, v79
    v_exp_f32 v80, v80
    v_exp_f32 v81, v81
    v_exp_f32 v82, v82
    v_exp_f32 v83, v83
    v_exp_f32 v84, v84
    v_exp_f32 v85, v85
    v_exp_f32 v86, v86
    v_exp_f32 v87, v87
    v_add_f32 v22, v22, v72
    v_add_f32 v23, v23, v73
    v_add_f32 v22, v22, v74
    v_add_f32 v23, v23, v75
    v_add_f32 v22, v22, v76
    v_add_f32 v23, v23, v77
    v_add_f32 v22, v22, v78
    v_add_f32 v23, v23, v79
    v_add_f32 v22, v22, v80
    v_add_f32 v23, v23, v81
    v_add_f32 v22, v22, v82
    v_add_f32 v23, v23, v83
    v_add_f32 v22, v22, v84
    v_add_f32 v23, v23, v85
    v_add_f32 v22, v22, v86
    v_add_f32_e64 v23, v23, v87
    v_cvt_pk_bf16_f32 v144, v72, v73
    v_cvt_pk_bf16_f32 v145, v74, v75
    v_cvt_pk_bf16_f32 v146, v76, v77
    v_cvt_pk_bf16_f32 v147, v78, v79
    v_cvt_pk_bf16_f32 v148, v80, v81
    v_cvt_pk_bf16_f32 v149, v82, v83
    v_cvt_pk_bf16_f32 v150, v84, v85
    v_cvt_pk_bf16_f32 v151, v86, v87
    s_waitcnt lgkmcnt(0)
    v_mfma_f32_32x32x16_bf16 v[88:103], v[128:131], v[144:147], v[88:103]
    v_mfma_f32_32x32x16_bf16 v[88:103], v[132:135], v[148:151], v[88:103]
    v_add_f32 v22, v22, v23
    v_mov_b32 v152, v22
    s_nop 1
    v_permlane32_swap_b32 v22, v152
    v_add_f32 v22, v22, v152
    v_rcp_f32 v22, v22
    s_lshl_b32 s33, s25, 11
    s_add_u32 s33, s33, s36
    s_branch att_ret0
    s_nop 0
att_exact1:
    s_waitcnt lgkmcnt(0)
    v_mov_b32 v20, 0xffff
    v_mov_b32 v21, 0xffff0000
    v_cndmask_b32 v22, 0, v20, s[40:41]
    v_cndmask_b32 v23, 0, v21, s[42:43]
    v_or_b32_e64 v12, v22, v23
    v_cndmask_b32 v22, 0, v20, s[44:45]
    v_cndmask_b32 v23, 0, v21, s[46:47]
    v_or_b32_e64 v13, v22, v23
    v_cndmask_b32 v22, 0, v20, s[48:49]
    v_cndmask_b32 v23, 0, v21, s[50:51]
    v_or_b32_e64 v14, v22, v23
    v_cndmask_b32 v22, 0, v20, s[52:53]
    v_cndmask_b32 v23, 0, v21, s[54:55]
    v_or_b32_e64 v15, v22, v23
    v_cndmask_b32 v22, 0, v20, s[56:57]
    v_cndmask_b32 v23, 0, v21, s[58:59]
    v_or_b32_e64 v16, v22, v23
    v_cndmask_b32 v22, 0, v20, s[60:61]
    v_cndmask_b32 v23, 0, v21, s[62:63]
    v_or_b32_e64 v17, v22, v23
    v_cndmask_b32 v22, 0, v20, s[64:65]
    v_cndmask_b32 v23, 0, v21, s[66:67]
    v_or_b32_e64 v18, v22, v23
    v_cndmask_b32 v22, 0, v20, s[68:69]
    v_cndmask_b32 v23, 0, v21, s[70:71]
    v_or_b32_e64 v19, v22, v23
    s_and_b32 s34, s76, 3
    s_lshl_b32 s33, s34, 12
    s_add_u32 s33, s33, 114688
    v_add_u32 v20, s33, v253
    v_mov_b32 v24, 0
    v_mov_b32 v25, 0
    v_mov_b32 v26, 0
    v_mov_b32 v27, 0
    v_mov_b32 v28, 0
    v_mov_b32 v29, 0
    v_mov_b32 v30, 0
    v_mov_b32 v31, 0
    v_mov_b32 v32, 0
    v_mov_b32 v33, 0
    v_mov_b32 v34, 0
    v_mov_b32 v35, 0
    v_mov_b32 v36, 0
    v_mov_b32 v37, 0
    v_mov_b32 v38, 0
    v_mov_b32 v39, 0
    ds_read_b128 v[104:107], v20 offset:32768
    ds_read_b128 v[108:111], v20 offset:33792
    ds_read_b128 v[112:115], v20 offset:28672
    ds_read_b128 v[116:119], v20 offset:29696
    s_waitcnt lgkmcnt(2)
    v_mfma_f32_32x32x16_bf16 v[40:55], v[104:107], v[4:7], 0
    v_mfma_f32_32x32x16_bf16 v[40:55], v[108:111], v[8:11], v[40:55]
    ds_read_b128 v[104:107], v20 offset:24576
    ds_read_b128 v[108:111], v20 offset:25600
    s_cmp_eq_u32 s76, 0
    s_cbranch_scc0 ng_140
    v_mov_b32 v24, 0xf149f2ca
    v_mov_b32 v25, 0xf149f2ca
    v_mov_b32 v26, 0xf149f2ca
    v_mov_b32 v27, 0xf149f2ca
    v_mov_b32 v28, 0xf149f2ca
    v_mov_b32 v29, 0xf149f2ca
    v_mov_b32 v30, 0xf149f2ca
    v_mov_b32 v31, 0xf149f2ca
    v_mov_b32 v32, 0xf149f2ca
    v_mov_b32 v33, 0xf149f2ca
    v_mov_b32 v34, 0xf149f2ca
    v_mov_b32 v35, 0xf149f2ca
    v_mov_b32 v36, 0xf149f2ca
    v_mov_b32 v37, 0xf149f2ca
    v_mov_b32 v38, 0xf149f2ca
    v_mov_b32 v39, 0xf149f2ca
ng_140:
    s_waitcnt lgkmcnt(2)
    s_nop 0
    v_mfma_f32_32x32x16_bf16 v[72:87], v[112:115], v[4:7], v[24:39]
    v_mfma_f32_32x32x16_bf16 v[72:87], v[116:119], v[8:11], v[72:87]
    ds_read_b128 v[112:115], v20 offset:20480
    ds_read_b128 v[116:119], v20 offset:21504
    s_cmp_eq_u32 s76, 1
    s_cbranch_scc0 ng_141
    s_nop 1
    v_mov_b32 v24, 0xf149f2ca
    v_mov_b32 v25, 0xf149f2ca
    v_mov_b32 v26, 0xf149f2ca
    v_mov_b32 v27, 0xf149f2ca
    v_mov_b32 v28, 0xf149f2ca
    v_mov_b32 v29, 0xf149f2ca
    v_mov_b32 v30, 0xf149f2ca
    v_mov_b32 v31, 0xf149f2ca
    v_mov_b32 v32, 0xf149f2ca
    v_mov_b32 v33, 0xf149f2ca
    v_mov_b32 v34, 0xf149f2ca
    v_mov_b32 v35, 0xf149f2ca
    v_mov_b32 v36, 0xf149f2ca
    v_mov_b32 v37, 0xf149f2ca
    v_mov_b32 v38, 0xf149f2ca
    v_mov_b32 v39, 0xf149f2ca
ng_141:
    s_waitcnt lgkmcnt(2)
    s_nop 0
    v_mfma_f32_32x32x16_bf16 v[56:71], v[104:107], v[4:7], v[24:39]
    v_mfma_f32_32x32x16_bf16 v[56:71], v[108:111], v[8:11], v[56:71]
    s_nop 3
    v_max_f32_e64 v21, v72, v73
    v_max3_f32 v21, v21, v74, v75
    v_max3_f32 v21, v21, v76, v77
    v_max3_f32 v21, v21, v78, v79
    v_max3_f32 v21, v21, v80, v81
    v_max3_f32 v21, v21, v82, v83
    v_max3_f32 v21, v21, v84, v85
    v_max3_f32 v21, v21, v86, v87
    ds_read_b128 v[104:107], v20 offset:16384
    ds_read_b128 v[108:111], v20 offset:17408
    s_cmp_eq_u32 s76, 2
    s_cbranch_scc0 ng_142
    v_mov_b32 v24, 0xf149f2ca
    v_mov_b32 v25, 0xf149f2ca
    v_mov_b32 v26, 0xf149f2ca
    v_mov_b32 v27, 0xf149f2ca
    v_mov_b32 v28, 0xf149f2ca
    v_mov_b32 v29, 0xf149f2ca
    v_mov_b32 v30, 0xf149f2ca
    v_mov_b32 v31, 0xf149f2ca
    v_mov_b32 v32, 0xf149f2ca
    v_mov_b32 v33, 0xf149f2ca
    v_mov_b32 v34, 0xf149f2ca
    v_mov_b32 v35, 0xf149f2ca
    v_mov_b32 v36, 0xf149f2ca
    v_mov_b32 v37, 0xf149f2ca
    v_mov_b32 v38, 0xf149f2ca
    v_mov_b32 v39, 0xf149f2ca
ng_142:
    s_waitcnt lgkmcnt(2)
    s_nop 0
    v_mfma_f32_32x32x16_bf16 v[72:87], v[112:115], v[4:7], v[24:39]
    v_mfma_f32_32x32x16_bf16 v[72:87], v[116:119], v[8:11], v[72:87]
    v_max3_f32 v21, v21, v56, v57
    v_max3_f32 v21, v21, v58, v59
    v_max3_f32 v21, v21, v60, v61
    v_max3_f32 v21, v21, v62, v63
    v_max3_f32 v21, v21, v64, v65
    v_max3_f32 v21, v21, v66, v67
    v_max3_f32 v21, v21, v68, v69
    v_max3_f32 v21, v21, v70, v71
    ds_read_b128 v[112:115], v20 offset:12288
    ds_read_b128 v[116:119], v20 offset:13312
    s_cmp_eq_u32 s76, 3
    s_cbranch_scc0 ng_143
    v_mov_b32 v24, 0xf149f2ca
    v_mov_b32 v25, 0xf149f2ca
    v_mov_b32 v26, 0xf149f2ca
    v_mov_b32 v27, 0xf149f2ca
    v_mov_b32 v28, 0xf149f2ca
    v_mov_b32 v29, 0xf149f2ca
    v_mov_b32 v30, 0xf149f2ca
    v_mov_b32 v31, 0xf149f2ca
    v_mov_b32 v32, 0xf149f2ca
    v_mov_b32 v33, 0xf149f2ca
    v_mov_b32 v34, 0xf149f2ca
    v_mov_b32 v35, 0xf149f2ca
    v_mov_b32 v36, 0xf149f2ca
    v_mov_b32 v37, 0xf149f2ca
    v_mov_b32 v38, 0xf149f2ca
    v_mov_b32 v39, 0xf149f2ca
ng_143:
    s_waitcnt lgkmcnt(2)
    s_nop 0
    v_mfma_f32_32x32x16_bf16 v[56:71], v[104:107], v[4:7], v[24:39]
    v_mfma_f32_32x32x16_bf16 v[56:71], v[108:111], v[8:11], v[56:71]
    v_max3_f32 v21, v21, v72, v73
    v_max3_f32 v21, v21, v74, v75
    v_max3_f32 v21, v21, v76, v77
    v_max3_f32 v21, v21, v78, v79
    v_max3_f32 v21, v21, v80, v81
    v_max3_f32 v21, v21, v82, v83
    v_max3_f32 v21, v21, v84, v85
    v_max3_f32 v21, v21, v86, v87
    ds_read_b128 v[104:107], v20 offset:8192
    ds_read_b128 v[108:111], v20 offset:9216
    s_cmp_eq_u32 s76, 4
    s_cbranch_scc0 ng_144
    v_mov_b32 v24, 0xf149f2ca
    v_mov_b32 v25, 0xf149f2ca
    v_mov_b32 v26, 0xf149f2ca
    v_mov_b32 v27, 0xf149f2ca
    v_mov_b32 v28, 0xf149f2ca
    v_mov_b32 v29, 0xf149f2ca
    v_mov_b32 v30, 0xf149f2ca
    v_mov_b32 v31, 0xf149f2ca
    v_mov_b32 v32, 0xf149f2ca
    v_mov_b32 v33, 0xf149f2ca
    v_mov_b32 v34, 0xf149f2ca
    v_mov_b32 v35, 0xf149f2ca
    v_mov_b32 v36, 0xf149f2ca
    v_mov_b32 v37, 0xf149f2ca
    v_mov_b32 v38, 0xf149f2ca
    v_mov_b32 v39, 0xf149f2ca
ng_144:
    s_waitcnt lgkmcnt(2)
    s_nop 0
    v_mfma_f32_32x32x16_bf16 v[72:87], v[112:115], v[4:7], v[24:39]
    v_mfma_f32_32x32x16_bf16 v[72:87], v[116:119], v[8:11], v[72:87]
    v_max3_f32 v21, v21, v56, v57
    v_max3_f32 v21, v21, v58, v59
    v_max3_f32 v21, v21, v60, v61
    v_max3_f32 v21, v21, v62, v63
    v_max3_f32 v21, v21, v64, v65
    v_max3_f32 v21, v21, v66, v67
    v_max3_f32 v21, v21, v68, v69
    v_max3_f32 v21, v21, v70, v71
    ds_read_b128 v[112:115], v20 offset:4096
    ds_read_b128 v[116:119], v20 offset:5120
    s_cmp_eq_u32 s76, 5
    s_cbranch_scc0 ng_145
    v_mov_b32 v24, 0xf149f2ca
    v_mov_b32 v25, 0xf149f2ca
    v_mov_b32 v26, 0xf149f2ca
    v_mov_b32 v27, 0xf149f2ca
    v_mov_b32 v28, 0xf149f2ca
    v_mov_b32 v29, 0xf149f2ca
    v_mov_b32 v30, 0xf149f2ca
    v_mov_b32 v31, 0xf149f2ca
    v_mov_b32 v32, 0xf149f2ca
    v_mov_b32 v33, 0xf149f2ca
    v_mov_b32 v34, 0xf149f2ca
    v_mov_b32 v35, 0xf149f2ca
    v_mov_b32 v36, 0xf149f2ca
    v_mov_b32 v37, 0xf149f2ca
    v_mov_b32 v38, 0xf149f2ca
    v_mov_b32 v39, 0xf149f2ca
ng_145:
    s_waitcnt lgkmcnt(2)
    s_nop 0
    v_mfma_f32_32x32x16_bf16 v[56:71], v[104:107], v[4:7], v[24:39]
    v_mfma_f32_32x32x16_bf16 v[56:71], v[108:111], v[8:11], v[56:71]
    v_max3_f32 v21, v21, v72, v73
    v_max3_f32 v21, v21, v74, v75
    v_max3_f32 v21, v21, v76, v77
    v_max3_f32 v21, v21, v78, v79
    v_max3_f32 v21, v21, v80, v81
    v_max3_f32 v21, v21, v82, v83
    v_max3_f32 v21, v21, v84, v85
    v_max3_f32 v21, v21, v86, v87
    ds_read_b128 v[104:107], v20 offset:0
    ds_read_b128 v[108:111], v20 offset:1024
    s_cmp_eq_u32 s76, 6
    s_cbranch_scc0 ng_146
    v_mov_b32 v24, 0xf149f2ca
    v_mov_b32 v25, 0xf149f2ca
    v_mov_b32 v26, 0xf149f2ca
    v_mov_b32 v27, 0xf149f2ca
    v_mov_b32 v28, 0xf149f2ca
    v_mov_b32 v29, 0xf149f2ca
    v_mov_b32 v30, 0xf149f2ca
    v_mov_b32 v31, 0xf149f2ca
    v_mov_b32 v32, 0xf149f2ca
    v_mov_b32 v33, 0xf149f2ca
    v_mov_b32 v34, 0xf149f2ca
    v_mov_b32 v35, 0xf149f2ca
    v_mov_b32 v36, 0xf149f2ca
    v_mov_b32 v37, 0xf149f2ca
    v_mov_b32 v38, 0xf149f2ca
    v_mov_b32 v39, 0xf149f2ca
ng_146:
    s_waitcnt lgkmcnt(2)
    s_nop 0
    v_mfma_f32_32x32x16_bf16 v[72:87], v[112:115], v[4:7], v[24:39]
    v_mfma_f32_32x32x16_bf16 v[72:87], v[116:119], v[8:11], v[72:87]
    v_max3_f32 v21, v21, v56, v57
    v_max3_f32 v21, v21, v58, v59
    v_max3_f32 v21, v21, v60, v61
    v_max3_f32 v21, v21, v62, v63
    v_max3_f32 v21, v21, v64, v65
    v_max3_f32 v21, v21, v66, v67
    v_max3_f32 v21, v21, v68, v69
    v_max3_f32 v21, v21, v70, v71
    s_cmp_eq_u32 s76, 7
    s_cbranch_scc0 ng_147
    v_mov_b32 v24, 0xf149f2ca
    v_mov_b32 v25, 0xf149f2ca
    v_mov_b32 v26, 0xf149f2ca
    v_mov_b32 v27, 0xf149f2ca
    v_mov_b32 v28, 0xf149f2ca
    v_mov_b32 v29, 0xf149f2ca
    v_mov_b32 v30, 0xf149f2ca
    v_mov_b32 v31, 0xf149f2ca
    v_mov_b32 v32, 0xf149f2ca
    v_mov_b32 v33, 0xf149f2ca
    v_mov_b32 v34, 0xf149f2ca
    v_mov_b32 v35, 0xf149f2ca
    v_mov_b32 v36, 0xf149f2ca
    v_mov_b32 v37, 0xf149f2ca
    v_mov_b32 v38, 0xf149f2ca
    v_mov_b32 v39, 0xf149f2ca
ng_147:
    s_waitcnt lgkmcnt(0)
    s_nop 0
    v_mfma_f32_32x32x16_bf16 v[56:71], v[104:107], v[4:7], v[24:39]
    v_mfma_f32_32x32x16_bf16 v[56:71], v[108:111], v[8:11], v[56:71]
    v_max3_f32 v21, v21, v72, v73
    v_max3_f32 v21, v21, v74, v75
    v_max3_f32 v21, v21, v76, v77
    v_max3_f32 v21, v21, v78, v79
    v_max3_f32 v21, v21, v80, v81
    v_max3_f32 v21, v21, v82, v83
    v_max3_f32 v21, v21, v84, v85
    v_max3_f32 v21, v21, v86, v87
    ds_read_b128 v[112:115], v20 offset:28672
    ds_read_b128 v[116:119], v20 offset:29696
    ds_read_b128 v[120:123], v20 offset:34816
    ds_read_b128 v[124:127], v20 offset:35840
    ds_read_b128 v[128:131], v20 offset:2048
    ds_read_b128 v[132:135], v20 offset:3072
    v_cndmask_b32 v40, v56, v40, s[40:41]
    v_cndmask_b32 v41, v57, v41, s[42:43]
    v_cndmask_b32 v42, v58, v42, s[44:45]
    v_cndmask_b32 v43, v59, v43, s[46:47]
    v_cndmask_b32 v44, v60, v44, s[48:49]
    v_cndmask_b32 v45, v61, v45, s[50:51]
    v_cndmask_b32 v46, v62, v46, s[52:53]
    v_cndmask_b32 v47, v63, v47, s[54:55]
    v_cndmask_b32 v48, v64, v48, s[56:57]
    v_cndmask_b32 v49, v65, v49, s[58:59]
    v_cndmask_b32 v50, v66, v50, s[60:61]
    v_cndmask_b32 v51, v67, v51, s[62:63]
    v_cndmask_b32 v52, v68, v52, s[64:65]
    v_cndmask_b32 v53, v69, v53, s[66:67]
    v_cndmask_b32 v54, v70, v54, s[68:69]
    v_cndmask_b32 v55, v71, v55, s[70:71]
    v_max3_f32 v21, v21, v40, v41
    v_max3_f32 v21, v21, v42, v43
    v_max3_f32 v21, v21, v44, v45
    v_max3_f32 v21, v21, v46, v47
    v_max3_f32 v21, v21, v48, v49
    v_max3_f32 v21, v21, v50, v51
    v_max3_f32 v21, v21, v52, v53
    v_max3_f32 v21, v21, v54, v55
    v_mov_b32 v152, v21
    s_nop 1
    v_permlane32_swap_b32 v21, v152
    v_max_f32 v21, v21, v152
    v_sub_f32 v24, 0, v21
    v_sub_f32 v25, 0, v21
    v_sub_f32 v26, 0, v21
    v_sub_f32 v27, 0, v21
    v_sub_f32 v28, 0, v21
    v_sub_f32 v29, 0, v21
    v_sub_f32 v30, 0, v21
    v_sub_f32 v31, 0, v21
    v_sub_f32 v32, 0, v21
    v_sub_f32 v33, 0, v21
    v_sub_f32 v34, 0, v21
    v_sub_f32 v35, 0, v21
    v_sub_f32 v36, 0, v21
    v_sub_f32 v37, 0, v21
    v_sub_f32 v38, 0, v21
    v_sub_f32 v39, 0, v21
    s_cmp_eq_u32 s76, 0
    s_cbranch_scc0 ng_148
    v_mov_b32 v24, 0xf149f2ca
    v_mov_b32 v25, 0xf149f2ca
    v_mov_b32 v26, 0xf149f2ca
    v_mov_b32 v27, 0xf149f2ca
    v_mov_b32 v28, 0xf149f2ca
    v_mov_b32 v29, 0xf149f2ca
    v_mov_b32 v30, 0xf149f2ca
    v_mov_b32 v31, 0xf149f2ca
    v_mov_b32 v32, 0xf149f2ca
    v_mov_b32 v33, 0xf149f2ca
    v_mov_b32 v34, 0xf149f2ca
    v_mov_b32 v35, 0xf149f2ca
    v_mov_b32 v36, 0xf149f2ca
    v_mov_b32 v37, 0xf149f2ca
    v_mov_b32 v38, 0xf149f2ca
    v_mov_b32 v39, 0xf149f2ca
ng_148:
    s_waitcnt lgkmcnt(4)
    s_nop 0
    v_mfma_f32_32x32x16_bf16 v[72:87], v[112:115], v[4:7], v[24:39]
    v_mfma_f32_32x32x16_bf16 v[72:87], v[116:119], v[8:11], v[72:87]
    ds_read_b128 v[104:107], v20 offset:24576
    ds_read_b128 v[108:111], v20 offset:25600
    v_sub_f32 v40, v40, v21
    v_sub_f32 v41, v41, v21
    v_sub_f32 v42, v42, v21
    v_sub_f32 v43, v43, v21
    v_sub_f32 v44, v44, v21
    v_sub_f32 v45, v45, v21
    v_sub_f32 v46, v46, v21
    v_sub_f32 v47, v47, v21
    v_sub_f32 v48, v48, v21
    v_sub_f32 v49, v49, v21
    v_sub_f32 v50, v50, v21
    v_sub_f32 v51, v51, v21
    v_sub_f32 v52, v52, v21
    v_sub_f32 v53, v53, v21
    v_sub_f32 v54, v54, v21
    v_sub_f32 v55, v55, v21
    v_exp_f32 v40, v40
    v_exp_f32 v41, v41
    v_exp_f32 v42, v42
    v_exp_f32 v43, v43
    v_exp_f32 v44, v44
    v_exp_f32 v45, v45
    v_exp_f32 v46, v46
    v_exp_f32 v47, v47
    v_exp_f32 v48, v48
    v_exp_f32 v49, v49
    v_exp_f32 v50, v50
    v_exp_f32 v51, v51
    v_exp_f32 v52, v52
    v_exp_f32 v53, v53
    v_exp_f32 v54, v54
    v_exp_f32 v55, v55
    v_add_f32 v22, v40, v41
    v_add_f32 v23, v42, v43
    v_add_f32 v22, v22, v44
    v_add_f32 v23, v23, v45
    v_add_f32 v22, v22, v46
    v_add_f32 v23, v23, v47
    v_add_f32 v22, v22, v48
    v_add_f32 v23, v23, v49
    v_add_f32 v22, v22, v50
    v_add_f32 v23, v23, v51
    v_add_f32 v22, v22, v52
    v_add_f32 v23, v23, v53
    v_add_f32 v22, v22, v54
    v_add_f32 v23, v23, v55
    v_cvt_pk_bf16_f32 v144, v40, v41
    v_cvt_pk_bf16_f32 v145, v42, v43
    v_cvt_pk_bf16_f32 v146, v44, v45
    v_cvt_pk_bf16_f32 v147, v46, v47
    v_cvt_pk_bf16_f32 v148, v48, v49
    v_cvt_pk_bf16_f32 v149, v50, v51
    v_cvt_pk_bf16_f32 v150, v52, v53
    v_cvt_pk_bf16_f32 v151, v54, v55
    v_and_b32 v136, v144, v12
    v_and_b32 v137, v145, v13
    v_and_b32 v138, v146, v14
    v_and_b32 v139, v147, v15
    v_and_b32 v140, v148, v16
    v_and_b32 v141, v149, v17
    v_and_b32 v142, v150, v18
    v_and_b32 v143, v151, v19
    v_xor_b32 v144, v144, v136
    v_xor_b32 v145, v145, v137
    v_xor_b32 v146, v146, v138
    v_xor_b32 v147, v147, v139
    v_xor_b32 v148, v148, v140
    v_xor_b32 v149, v149, v141
    v_xor_b32_e64 v150, v150, v142
    v_xor_b32 v151, v151, v143
    s_waitcnt lgkmcnt(2)
    v_mfma_f32_32x32x16_bf16 v[88:103], v[120:123], v[136:139], 0
    v_mfma_f32_32x32x16_bf16 v[88:103], v[124:127], v[140:143], v[88:103]
    v_mfma_f32_32x32x16_bf16 v[88:103], v[128:131], v[144:147], v[88:103]
    v_mfma_f32_32x32x16_bf16 v[88:103], v[132:135], v[148:151], v[88:103]
    ds_read_b128 v[128:131], v20 offset:30720
    ds_read_b128 v[132:135], v20 offset:31744
    s_cmp_eq_u32 s76, 1
    s_cbranch_scc0 ng_149
    v_mov_b32 v24, 0xf149f2ca
    v_mov_b32 v25, 0xf149f2ca
    v_mov_b32 v26, 0xf149f2ca
    v_mov_b32 v27, 0xf149f2ca
    v_mov_b32 v28, 0xf149f2ca
    v_mov_b32 v29, 0xf149f2ca
    v_mov_b32 v30, 0xf149f2ca
    v_mov_b32 v31, 0xf149f2ca
    v_mov_b32 v32, 0xf149f2ca
    v_mov_b32 v33, 0xf149f2ca
    v_mov_b32 v34, 0xf149f2ca
    v_mov_b32 v35, 0xf149f2ca
    v_mov_b32 v36, 0xf149f2ca
    v_mov_b32 v37, 0xf149f2ca
    v_mov_b32 v38, 0xf149f2ca
    v_mov_b32 v39, 0xf149f2ca
ng_149:
    s_waitcnt lgkmcnt(2)
    s_nop 0
    v_mfma_f32_32x32x16_bf16 v[56:71], v[104:107], v[4:7], v[24:39]
    v_mfma_f32_32x32x16_bf16 v[56:71], v[108:111], v[8:11], v[56:71]
    ds_read_b128 v[112:115], v20 offset:20480
    ds_read_b128 v[116:119], v20 offset:21504
    v_exp_f32 v72, v72
    v_exp_f32 v73, v73
    v_exp_f32 v74, v74
    v_exp_f32 v75, v75
    v_exp_f32 v76, v76
    v_exp_f32 v77, v77
    v_exp_f32 v78, v78
    v_exp_f32 v79, v79
    v_exp_f32 v80, v80
    v_exp_f32 v81, v81
    v_exp_f32 v82, v82
    v_exp_f32 v83, v83
    v_exp_f32 v84, v84
    v_exp_f32 v85, v85
    v_exp_f32 v86, v86
    v_exp_f32 v87, v87
    v_add_f32 v22, v22, v72
    v_add_f32 v23, v23, v73
    v_add_f32 v22, v22, v74
    v_add_f32 v23, v23, v75
    v_add_f32 v22, v22, v76
    v_add_f32 v23, v23, v77
    v_add_f32 v22, v22, v78
    v_add_f32 v23, v23, v79
    v_add_f32 v22, v22, v80
    v_add_f32 v23, v23, v81
    v_add_f32 v22, v22, v82
    v_add_f32 v23, v23, v83
    v_add_f32 v22, v22, v84
    v_add_f32 v23, v23, v85
    v_add_f32_e64 v22, v22, v86
    v_add_f32 v23, v23, v87
    v_cvt_pk_bf16_f32 v144, v72, v73
    v_cvt_pk_bf16_f32 v145, v74, v75
    v_cvt_pk_bf16_f32 v146, v76, v77
    v_cvt_pk_bf16_f32 v147, v78, v79
    v_cvt_pk_bf16_f32 v148, v80, v81
    v_cvt_pk_bf16_f32 v149, v82, v83
    v_cvt_pk_bf16_f32 v150, v84, v85
    v_cvt_pk_bf16_f32 v151, v86, v87
    s_waitcnt lgkmcnt(2)
    v_mfma_f32_32x32x16_bf16 v[88:103], v[128:131], v[144:147], v[88:103]
    v_mfma_f32_32x32x16_bf16 v[88:103], v[132:135], v[148:151], v[88:103]
    ds_read_b128 v[120:123], v20 offset:26624
    ds_read_b128 v[124:127], v20 offset:27648
    s_cmp_eq_u32 s76, 2
    s_cbranch_scc0 ng_150
    v_mov_b32 v24, 0xf149f2ca
    v_mov_b32 v25, 0xf149f2ca
    v_mov_b32 v26, 0xf149f2ca
    v_mov_b32 v27, 0xf149f2ca
    v_mov_b32 v28, 0xf149f2ca
    v_mov_b32 v29, 0xf149f2ca
    v_mov_b32 v30, 0xf149f2ca
    v_mov_b32 v31, 0xf149f2ca
    v_mov_b32 v32, 0xf149f2ca
    v_mov_b32 v33, 0xf149f2ca
    v_mov_b32 v34, 0xf149f2ca
    v_mov_b32 v35, 0xf149f2ca
    v_mov_b32 v36, 0xf149f2ca
    v_mov_b32 v37, 0xf149f2ca
    v_mov_b32 v38, 0xf149f2ca
    v_mov_b32 v39, 0xf149f2ca
ng_150:
    s_waitcnt lgkmcnt(2)
    s_nop 0
    v_mfma_f32_32x32x16_bf16 v[72:87], v[112:115], v[4:7], v[24:39]
    v_mfma_f32_32x32x16_bf16 v[72:87], v[116:119], v[8:11], v[72:87]
    ds_read_b128 v[104:107], v20 offset:16384
    ds_read_b128 v[108:111], v20 offset:17408
    v_exp_f32 v56, v56
    v_exp_f32 v57, v57
    v_exp_f32 v58, v58
    v_exp_f32 v59, v59
    v_exp_f32 v60, v60
    v_exp_f32 v61, v61
    v_exp_f32 v62, v62
    v_exp_f32 v63, v63
    v_exp_f32 v64, v64
    v_exp_f32 v65, v65
    v_exp_f32 v66, v66
    v_exp_f32 v67, v67
    v_exp_f32 v68, v68
    v_exp_f32 v69, v69
    v_exp_f32 v70, v70
    v_exp_f32 v71, v71
    v_add_f32 v22, v22, v56
    v_add_f32 v23, v23, v57
    v_add_f32 v22, v22, v58
    v_add_f32 v23, v23, v59
    v_add_f32 v22, v22, v60
    v_add_f32 v23, v23, v61
    v_add_f32 v22, v22, v62
    v_add_f32 v23, v23, v63
    v_add_f32 v22, v22, v64
    v_add_f32 v23, v23, v65
    v_add_f32 v22, v22, v66
    v_add_f32 v23, v23, v67
    v_add_f32 v22, v22, v68
    v_add_f32 v23, v23, v69
    v_add_f32_e64 v22, v22, v70
    v_add_f32 v23, v23, v71
    v_cvt_pk_bf16_f32 v136, v56, v57
    v_cvt_pk_bf16_f32 v137, v58, v59
    v_cvt_pk_bf16_f32 v138, v60, v61
    v_cvt_pk_bf16_f32 v139, v62, v63
    v_cvt_pk_bf16_f32 v140, v64, v65
    v_cvt_pk_bf16_f32 v141, v66, v67
    v_cvt_pk_bf16_f32 v142, v68, v69
    v_cvt_pk_bf16_f32 v143, v70, v71
    s_waitcnt lgkmcnt(2)
    v_mfma_f32_32x32x16_bf16 v[88:103], v[120:123], v[136:139], v[88:103]
    v_mfma_f32_32x32x16_bf16 v[88:103], v[124:127], v[140:143], v[88:103]
    ds_read_b128 v[128:131], v20 offset:22528
    ds_read_b128 v[132:135], v20 offset:23552
    s_cmp_eq_u32 s76, 3
    s_cbranch_scc0 ng_151
    v_mov_b32 v24, 0xf149f2ca
    v_mov_b32 v25, 0xf149f2ca
    v_mov_b32 v26, 0xf149f2ca
    v_mov_b32 v27, 0xf149f2ca
    v_mov_b32 v28, 0xf149f2ca
    v_mov_b32 v29, 0xf149f2ca
    v_mov_b32 v30, 0xf149f2ca
    v_mov_b32 v31, 0xf149f2ca
    v_mov_b32 v32, 0xf149f2ca
    v_mov_b32 v33, 0xf149f2ca
    v_mov_b32 v34, 0xf149f2ca
    v_mov_b32 v35, 0xf149f2ca
    v_mov_b32 v36, 0xf149f2ca
    v_mov_b32 v37, 0xf149f2ca
    v_mov_b32 v38, 0xf149f2ca
    v_mov_b32 v39, 0xf149f2ca
ng_151:
    s_waitcnt lgkmcnt(2)
    s_nop 0
    v_mfma_f32_32x32x16_bf16 v[56:71], v[104:107], v[4:7], v[24:39]
    v_mfma_f32_32x32x16_bf16 v[56:71], v[108:111], v[8:11], v[56:71]
    ds_read_b128 v[112:115], v20 offset:12288
    ds_read_b128 v[116:119], v20 offset:13312
    v_exp_f32 v72, v72
    v_exp_f32 v73, v73
    v_exp_f32 v74, v74
    v_exp_f32 v75, v75
    v_exp_f32 v76, v76
    v_exp_f32 v77, v77
    v_exp_f32 v78, v78
    v_exp_f32 v79, v79
    v_exp_f32 v80, v80
    v_exp_f32 v81, v81
    v_exp_f32 v82, v82
    v_exp_f32 v83, v83
    v_exp_f32 v84, v84
    v_exp_f32 v85, v85
    v_exp_f32 v86, v86
    v_exp_f32 v87, v87
    v_add_f32 v22, v22, v72
    v_add_f32 v23, v23, v73
    v_add_f32 v22, v22, v74
    v_add_f32 v23, v23, v75
    v_add_f32 v22, v22, v76
    v_add_f32 v23, v23, v77
    v_add_f32 v22, v22, v78
    v_add_f32 v23, v23, v79
    v_add_f32 v22, v22, v80
    v_add_f32 v23, v23, v81
    v_add_f32 v22, v22, v82
    v_add_f32 v23, v23, v83
    v_add_f32 v22, v22, v84
    v_add_f32 v23, v23, v85
    v_add_f32_e64 v22, v22, v86
    v_add_f32 v23, v23, v87
    v_cvt_pk_bf16_f32 v144, v72, v73
    v_cvt_pk_bf16_f32 v145, v74, v75
    v_cvt_pk_bf16_f32 v146, v76, v77
    v_cvt_pk_bf16_f32 v147, v78, v79
    v_cvt_pk_bf16_f32 v148, v80, v81
    v_cvt_pk_bf16_f32 v149, v82, v83
    v_cvt_pk_bf16_f32 v150, v84, v85
    v_cvt_pk_bf16_f32 v151, v86, v87
    s_waitcnt lgkmcnt(2)
    v_mfma_f32_32x32x16_bf16 v[88:103], v[128:131], v[144:147], v[88:103]
    v_mfma_f32_32x32x16_bf16 v[88:103], v[132:135], v[148:151], v[88:103]
    ds_read_b128 v[120:123], v20 offset:18432
    ds_read_b128 v[124:127], v20 offset:19456
    s_cmp_eq_u32 s76, 4
    s_cbranch_scc0 ng_152
    v_mov_b32 v24, 0xf149f2ca
    v_mov_b32 v25, 0xf149f2ca
    v_mov_b32 v26, 0xf149f2ca
    v_mov_b32 v27, 0xf149f2ca
    v_mov_b32 v28, 0xf149f2ca
    v_mov_b32 v29, 0xf149f2ca
    v_mov_b32 v30, 0xf149f2ca
    v_mov_b32 v31, 0xf149f2ca
    v_mov_b32 v32, 0xf149f2ca
    v_mov_b32 v33, 0xf149f2ca
    v_mov_b32 v34, 0xf149f2ca
    v_mov_b32 v35, 0xf149f2ca
    v_mov_b32 v36, 0xf149f2ca
    v_mov_b32 v37, 0xf149f2ca
    v_mov_b32 v38, 0xf149f2ca
    v_mov_b32 v39, 0xf149f2ca
ng_152:
    s_waitcnt lgkmcnt(2)
    s_nop 0
    v_mfma_f32_32x32x16_bf16 v[72:87], v[112:115], v[4:7], v[24:39]
    v_mfma_f32_32x32x16_bf16 v[72:87], v[116:119], v[8:11], v[72:87]
    ds_read_b128 v[104:107], v20 offset:8192
    ds_read_b128 v[108:111], v20 offset:9216
    v_exp_f32 v56, v56
    v_exp_f32 v57, v57
    v_exp_f32 v58, v58
    v_exp_f32 v59, v59
    v_exp_f32 v60, v60
    v_exp_f32 v61, v61
    v_exp_f32 v62, v62
    v_exp_f32 v63, v63
    v_exp_f32 v64, v64
    v_exp_f32 v65, v65
    v_exp_f32 v66, v66
    v_exp_f32 v67, v67
    v_exp_f32 v68, v68
    v_exp_f32 v69, v69
    v_exp_f32 v70, v70
    v_exp_f32 v71, v71
    v_add_f32 v22, v22, v56
    v_add_f32 v23, v23, v57
    v_add_f32 v22, v22, v58
    v_add_f32 v23, v23, v59
    v_add_f32 v22, v22, v60
    v_add_f32 v23, v23, v61
    v_add_f32 v22, v22, v62
    v_add_f32 v23, v23, v63
    v_add_f32 v22, v22, v64
    v_add_f32 v23, v23, v65
    v_add_f32 v22, v22, v66
    v_add_f32 v23, v23, v67
    v_add_f32 v22, v22, v68
    v_add_f32 v23, v23, v69
    v_add_f32_e64 v22, v22, v70
    v_add_f32 v23, v23, v71
    v_cvt_pk_bf16_f32 v136, v56, v57
    v_cvt_pk_bf16_f32 v137, v58, v59
    v_cvt_pk_bf16_f32 v138, v60, v61
    v_cvt_pk_bf16_f32 v139, v62, v63
    v_cvt_pk_bf16_f32 v140, v64, v65
    v_cvt_pk_bf16_f32 v141, v66, v67
    v_cvt_pk_bf16_f32 v142, v68, v69
    v_cvt_pk_bf16_f32 v143, v70, v71
    s_waitcnt lgkmcnt(2)
    v_mfma_f32_32x32x16_bf16 v[88:103], v[120:123], v[136:139], v[88:103]
    v_mfma_f32_32x32x16_bf16 v[88:103], v[124:127], v[140:143], v[88:103]
    ds_read_b128 v[128:131], v20 offset:14336
    ds_read_b128 v[132:135], v20 offset:15360
    s_cmp_eq_u32 s76, 5
    s_cbranch_scc0 ng_153
    v_mov_b32 v24, 0xf149f2ca
    v_mov_b32 v25, 0xf149f2ca
    v_mov_b32 v26, 0xf149f2ca
    v_mov_b32 v27, 0xf149f2ca
    v_mov_b32 v28, 0xf149f2ca
    v_mov_b32 v29, 0xf149f2ca
    v_mov_b32 v30, 0xf149f2ca
    v_mov_b32 v31, 0xf149f2ca
    v_mov_b32 v32, 0xf149f2ca
    v_mov_b32 v33, 0xf149f2ca
    v_mov_b32 v34, 0xf149f2ca
    v_mov_b32 v35, 0xf149f2ca
    v_mov_b32 v36, 0xf149f2ca
    v_mov_b32 v37, 0xf149f2ca
    v_mov_b32 v38, 0xf149f2ca
    v_mov_b32 v39, 0xf149f2ca
ng_153:
    s_waitcnt lgkmcnt(2)
    s_nop 0
    v_mfma_f32_32x32x16_bf16 v[56:71], v[104:107], v[4:7], v[24:39]
    v_mfma_f32_32x32x16_bf16 v[56:71], v[108:111], v[8:11], v[56:71]
    ds_read_b128 v[112:115], v20 offset:4096
    ds_read_b128 v[116:119], v20 offset:5120
    v_exp_f32 v72, v72
    v_exp_f32 v73, v73
    v_exp_f32 v74, v74
    v_exp_f32 v75, v75
    v_exp_f32 v76, v76
    v_exp_f32 v77, v77
    v_exp_f32 v78, v78
    v_exp_f32 v79, v79
    v_exp_f32 v80, v80
    v_exp_f32 v81, v81
    v_exp_f32 v82, v82
    v_exp_f32 v83, v83
    v_exp_f32 v84, v84
    v_exp_f32 v85, v85
    v_exp_f32 v86, v86
    v_exp_f32 v87, v87
    v_add_f32 v22, v22, v72
    v_add_f32 v23, v23, v73
    v_add_f32 v22, v22, v74
    v_add_f32 v23, v23, v75
    v_add_f32 v22, v22, v76
    v_add_f32 v23, v23, v77
    v_add_f32 v22, v22, v78
    v_add_f32 v23, v23, v79
    v_add_f32 v22, v22, v80
    v_add_f32 v23, v23, v81
    v_add_f32 v22, v22, v82
    v_add_f32 v23, v23, v83
    v_add_f32 v22, v22, v84
    v_add_f32 v23, v23, v85
    v_add_f32_e64 v22, v22, v86
    v_add_f32 v23, v23, v87
    v_cvt_pk_bf16_f32 v144, v72, v73
    v_cvt_pk_bf16_f32 v145, v74, v75
    v_cvt_pk_bf16_f32 v146, v76, v77
    v_cvt_pk_bf16_f32 v147, v78, v79
    v_cvt_pk_bf16_f32 v148, v80, v81
    v_cvt_pk_bf16_f32 v149, v82, v83
    v_cvt_pk_bf16_f32 v150, v84, v85
    v_cvt_pk_bf16_f32 v151, v86, v87
    s_waitcnt lgkmcnt(2)
    v_mfma_f32_32x32x16_bf16 v[88:103], v[128:131], v[144:147], v[88:103]
    v_mfma_f32_32x32x16_bf16 v[88:103], v[132:135], v[148:151], v[88:103]
    ds_read_b128 v[120:123], v20 offset:10240
    ds_read_b128 v[124:127], v20 offset:11264
    s_cmp_eq_u32 s76, 6
    s_cbranch_scc0 ng_154
    v_mov_b32 v24, 0xf149f2ca
    v_mov_b32 v25, 0xf149f2ca
    v_mov_b32 v26, 0xf149f2ca
    v_mov_b32 v27, 0xf149f2ca
    v_mov_b32 v28, 0xf149f2ca
    v_mov_b32 v29, 0xf149f2ca
    v_mov_b32 v30, 0xf149f2ca
    v_mov_b32 v31, 0xf149f2ca
    v_mov_b32 v32, 0xf149f2ca
    v_mov_b32 v33, 0xf149f2ca
    v_mov_b32 v34, 0xf149f2ca
    v_mov_b32 v35, 0xf149f2ca
    v_mov_b32 v36, 0xf149f2ca
    v_mov_b32 v37, 0xf149f2ca
    v_mov_b32 v38, 0xf149f2ca
    v_mov_b32 v39, 0xf149f2ca
ng_154:
    s_waitcnt lgkmcnt(2)
    s_nop 0
    v_mfma_f32_32x32x16_bf16 v[72:87], v[112:115], v[4:7], v[24:39]
    v_mfma_f32_32x32x16_bf16 v[72:87], v[116:119], v[8:11], v[72:87]
    v_exp_f32 v56, v56
    v_exp_f32 v57, v57
    v_exp_f32 v58, v58
    v_exp_f32 v59, v59
    v_exp_f32 v60, v60
    v_exp_f32 v61, v61
    v_exp_f32 v62, v62
    v_exp_f32 v63, v63
    v_exp_f32 v64, v64
    v_exp_f32 v65, v65
    v_exp_f32 v66, v66
    v_exp_f32 v67, v67
    v_exp_f32 v68, v68
    v_exp_f32 v69, v69
    v_exp_f32 v70, v70
    v_exp_f32 v71, v71
    v_add_f32 v22, v22, v56
    v_add_f32 v23, v23, v57
    v_add_f32 v22, v22, v58
    v_add_f32 v23, v23, v59
    v_add_f32 v22, v22, v60
    v_add_f32 v23, v23, v61
    v_add_f32 v22, v22, v62
    v_add_f32 v23, v23, v63
    v_add_f32 v22, v22, v64
    v_add_f32 v23, v23, v65
    v_add_f32 v22, v22, v66
    v_add_f32 v23, v23, v67
    v_add_f32 v22, v22, v68
    v_add_f32 v23, v23, v69
    v_add_f32 v22, v22, v70
    v_add_f32 v23, v23, v71
    v_cvt_pk_bf16_f32 v136, v56, v57
    v_cvt_pk_bf16_f32 v137, v58, v59
    v_cvt_pk_bf16_f32 v138, v60, v61
    v_cvt_pk_bf16_f32 v139, v62, v63
    v_cvt_pk_bf16_f32 v140, v64, v65
    v_cvt_pk_bf16_f32 v141, v66, v67
    v_cvt_pk_bf16_f32 v142, v68, v69
    v_cvt_pk_bf16_f32 v143, v70, v71
    s_waitcnt lgkmcnt(0)
    v_mfma_f32_32x32x16_bf16 v[88:103], v[120:123], v[136:139], v[88:103]
    v_mfma_f32_32x32x16_bf16 v[88:103], v[124:127], v[140:143], v[88:103]
    ds_read_b128 v[128:131], v20 offset:6144
    ds_read_b128 v[132:135], v20 offset:7168
    v_exp_f32 v72, v72
    v_exp_f32 v73, v73
    v_exp_f32 v74, v74
    v_exp_f32 v75, v75
    v_exp_f32 v76, v76
    v_exp_f32 v77, v77
    v_exp_f32 v78, v78
    v_exp_f32 v79, v79
    v_exp_f32 v80, v80
    v_exp_f32 v81, v81
    v_exp_f32 v82, v82
    v_exp_f32 v83, v83
    v_exp_f32 v84, v84
    v_exp_f32 v85, v85
    v_exp_f32 v86, v86
    v_exp_f32 v87, v87
    v_add_f32 v22, v22, v72
    v_add_f32 v23, v23, v73
    v_add_f32 v22, v22, v74
    v_add_f32 v23, v23, v75
    v_add_f32 v22, v22, v76
    v_add_f32 v23, v23, v77
    v_add_f32 v22, v22, v78
    v_add_f32 v23, v23, v79
    v_add_f32 v22, v22, v80
    v_add_f32 v23, v23, v81
    v_add_f32 v22, v22, v82
    v_add_f32 v23, v23, v83
    v_add_f32 v22, v22, v84
    v_add_f32 v23, v23, v85
    v_add_f32 v22, v22, v86
    v_add_f32_e64 v23, v23, v87
    v_cvt_pk_bf16_f32 v144, v72, v73
    v_cvt_pk_bf16_f32 v145, v74, v75
    v_cvt_pk_bf16_f32 v146, v76, v77
    v_cvt_pk_bf16_f32 v147, v78, v79
    v_cvt_pk_bf16_f32 v148, v80, v81
    v_cvt_pk_bf16_f32 v149, v82, v83
    v_cvt_pk_bf16_f32 v150, v84, v85
    v_cvt_pk_bf16_f32 v151, v86, v87
    s_waitcnt lgkmcnt(0)
    v_mfma_f32_32x32x16_bf16 v[88:103], v[128:131], v[144:147], v[88:103]
    v_mfma_f32_32x32x16_bf16 v[88:103], v[132:135], v[148:151], v[88:103]
    v_add_f32 v22, v22, v23
    v_mov_b32 v152, v22
    s_nop 1
    v_permlane32_swap_b32 v22, v152
    v_add_f32 v22, v22, v152
    v_rcp_f32 v22, v22
    s_lshl_b32 s33, s25, 11
    s_add_u32 s33, s33, s36
    s_branch att_ret1
.section .rodata,"a"
.p2align 6
.amdhsa_kernel interleave_layers__sliding_block__moe_arch_mod__prompt_kernel
  .amdhsa_next_free_vgpr 256
  .amdhsa_next_free_sgpr 102
  .amdhsa_accum_offset 256
  .amdhsa_group_segment_fixed_size 0
  .amdhsa_kernarg_size 88
  .amdhsa_user_sgpr_count 2
  .amdhsa_user_sgpr_kernarg_segment_ptr 1
  .amdhsa_system_sgpr_workgroup_id_x 1
.end_amdhsa_kernel
```

```asm
; @launch grid=(256,1,1) block=(512,1,1) lds=163840
.amdgcn_target "amdgcn-amd-amdhsa--gfx950"
.text
.globl interleave_layers__sliding_block__moe_arch_mod__prompt_kernel
.p2align 8
.type interleave_layers__sliding_block__moe_arch_mod__prompt_kernel,@function
interleave_layers__sliding_block__moe_arch_mod__prompt_kernel:
    s_cmp_ge_u32 s2, 256
    s_cbranch_scc1 k_exit
    s_load_dwordx4 s[4:7], s[0:1], 0
    s_load_dwordx2 s[8:9], s[0:1], 16
    s_load_dwordx2 s[20:21], s[0:1], 80
    s_load_dwordx2 s[80:81], s[0:1], 32
    v_lshrrev_b32 v1, 6, v0
    v_and_b32 v252, 63, v0
    v_readfirstlane_b32 s3, v1
    v_lshlrev_b32 v253, 4, v252
    s_and_b32 s30, s2, 7
    s_lshr_b32 s31, s2, 3
    s_and_b32 s32, s31, 1
    s_lshl_b32 s33, s30, 1
    s_add_u32 s24, s33, s32
    s_lshr_b32 s25, s31, 1
    s_add_u32 s33, s33, s25
    s_add_u32 s94, s33, s32
    s_sub_u32 s95, s33, s32
    s_add_u32 s98, s95, 15
    s_and_b32 s98, s98, 15
    s_mul_i32 s29, s30, 28
    s_lshl_b32 s32, s30, 2
    s_add_u32 s32, s32, 196
    s_cmp_lt_u32 s31, 28
    s_cselect_b32 s29, s29, s32
    s_add_u32 s29, s29, s31
    s_lshl_b32 s72, s24, 4
    s_add_u32 s72, s72, s25
    s_mov_b32 s26, 0
    s_mov_b32 s27, 20000
    s_and_b32 s28, s3, 3
    s_lshl_b32 s99, s24, 2
    s_add_u32 s99, s99, s28
    s_lshl_b32 s101, s28, 10
    s_mov_b32 s18, 0x600000
    s_mov_b32 s19, 0x20000
    s_mov_b32 s10, 0x200000
    s_mov_b32 s11, 0x20000
    s_mov_b32 s22, 0x8000000
    s_mov_b32 s23, 0x20000
    s_mov_b32 s82, 0x800
    s_mov_b32 s83, 0x20000
    s_cmp_ge_u32 s3, 4
    s_cbranch_scc1 l_start
    s_getpc_b64 s[32:33]
pc_1:
    s_sub_u32 s32, s32, pc_1-interleave_layers__sliding_block__moe_arch_mod__prompt_kernel
    s_subb_u32 s33, s33, 0
    s_lshr_b32 s34, s2, 3
    s_lshl_b32 s34, s34, 2
    s_add_u32 s34, s34, s28
    s_and_b32 s34, s34, 63
    s_lshl_b32 s34, s34, 7
    v_lshl_add_u32 v191, v252, 13, s34
    s_mov_b32 s34, k_exit-interleave_layers__sliding_block__moe_arch_mod__prompt_kernel
    s_mov_b32 s35, 0x20000
    buffer_load_dword v191, v191, s[32:35], 0 offen
    s_load_dwordx4 s[36:39], s[0:1], 40
    s_load_dwordx2 s[74:75], s[0:1], 56
    s_waitcnt lgkmcnt(0)
    s_mov_b32 s88, 0xdd8000
    s_load_dword s88, s[20:21], s88
    s_mov_b64 s[16:17], s[6:7]
    s_mov_b32 s6, 0x400000
    s_mov_b32 s7, 0x20000
    s_lshr_b32 s30, s2, 3
    s_lshl_b32 s30, s30, 2
    s_add_u32 s30, s30, s3
    s_and_b32 s31, s2, 7
    v_mul_u32_u24 v4, 9363, v252
    v_lshrrev_b32 v4, 16, v4
    v_mul_u32_u24 v5, 7, v4
    v_sub_u32 v5, v252, v5
    v_min_u32_e64 v4, 7, v4
    v_lshl_add_u32 v4, v4, 7, s30
    v_mul_u32_u24 v6, 37, v5
    v_lshrrev_b32 v6, 8, v6
    v_mul_u32_u24 v7, 7, v6
    v_sub_u32 v5, v5, v7
    v_mad_u32_u24 v6, v6, 0, 0
    v_cmp_eq_u32_e64 vcc, 2, v6
    v_mov_b32 v7, 7168
    v_mov_b32 v8, 896
    v_cndmask_b32 v7, v7, v8, vcc
    v_mul_u32_u24 v4, v4, v7
    v_mul_u32_u24 v198, 1024, v7
    v_lshl_add_u32 v4, v5, 7, v4
    v_mov_b32 v7, 917504
    v_cndmask_b32_e64 v7, v8, v7, vcc
    v_mad_u32_u24 v4, v7, s31, v4
    v_mov_b32 v196, s36
    v_mov_b32 v7, s74
    v_cndmask_b32 v196, v196, v7, vcc
    v_mov_b32 v197, s37
    v_mov_b32 v7, s75
    v_cndmask_b32 v197, v197, v7, vcc
    v_cmp_eq_u32 vcc, 1, v6
    v_mov_b32 v7, s38
    s_nop 0
    v_cndmask_b32 v196, v196, v7, vcc
    v_mov_b32 v7, s39
    v_cndmask_b32 v197, v197, v7, vcc
    v_add_co_u32 v196, vcc, v196, v4
    s_nop 1
    v_addc_co_u32 v197, vcc, 0, v197, vcc
    s_mov_b32 s30, 0x1000100
    s_mov_b32 s31, 0x1000100
    s_lshl_b32 s86, s3, 4
    s_lshr_b64 s[30:31], s[30:31], s86
    s_and_b32 s86, s30, 0xffff
    s_mul_i32 s30, s25, 6
    s_lshr_b32 s30, s30, 4
    s_lshr_b32 s86, s86, s30
    s_load_dwordx2 s[12:13], s[0:1], 64
    s_mov_b32 s14, 0x400000
    s_mov_b32 s15, 0x20000
    s_lshr_b32 s30, s16, 7
    s_sub_u32 s30, 3, s30
    s_and_b32 s30, s30, 7
    s_and_b32 s31, s24, 1
    s_lshl_b32 s31, s31, 3
    s_add_u32 s30, s30, s31
    s_and_b32 s31, s24, 14
    s_add_u32 s84, s31, s30
    s_lshl_b32 s31, s25, 2
    s_add_u32 s31, s31, s28
    s_mul_i32 s31, s31, 6144
    s_lshl_b32 s30, s30, 7
    s_add_u32 s30, s30, s31
    v_min_u32_e64 v190, 2, v252
    v_lshl_add_u32 v190, v190, 11, s30
    s_add_u32 s30, s84, 0
    s_and_b32 s30, s30, 15
    s_mul_i32 s30, s30, 393216
    buffer_load_dword v191, v190, s[16:19], s30 offen
    s_add_u32 s30, s84, 1
    s_and_b32 s30, s30, 15
    s_mul_i32 s30, s30, 393216
    buffer_load_dword v191, v190, s[16:19], s30 offen
    v_lshrrev_b32 v5, 5, v252
    v_lshlrev_b32 v6, 3, v5
    s_lshl_b32 s33, s98, 7
    buffer_load_dwordx2 v[224:225], v6, s[80:83], s33 offen offset:0
    buffer_load_dwordx2 v[226:227], v6, s[80:83], s33 offen offset:16
    buffer_load_dwordx2 v[228:229], v6, s[80:83], s33 offen offset:32
    buffer_load_dwordx2 v[230:231], v6, s[80:83], s33 offen offset:48
    buffer_load_dwordx2 v[232:233], v6, s[80:83], s33 offen offset:64
    buffer_load_dwordx2 v[234:235], v6, s[80:83], s33 offen offset:80
    buffer_load_dwordx2 v[236:237], v6, s[80:83], s33 offen offset:96
    buffer_load_dwordx2 v[238:239], v6, s[80:83], s33 offen offset:112
    s_mov_b32 s40, 0xffffffff
    s_mov_b32 s41, 0xfffffff0
    s_mov_b32 s42, 0xfffffffe
    s_mov_b32 s43, 0xffffffe0
    s_mov_b32 s44, 0xfffffffc
    s_mov_b32 s45, 0xffffffc0
    s_mov_b32 s46, 0xfffffff8
    s_mov_b32 s47, 0xffffff80
    s_mov_b32 s48, 0xffff0000
    s_mov_b32 s49, 0xfff00000
    s_mov_b32 s50, 0xfffe0000
    s_mov_b32 s51, 0xffe00000
    s_mov_b32 s52, 0xfffc0000
    s_mov_b32 s53, 0xffc00000
    s_mov_b32 s54, 0xfff80000
    s_mov_b32 s55, 0xff800000
    s_mov_b32 s56, 0xffffff00
    s_mov_b32 s57, 0xfffff000
    s_mov_b32 s58, 0xfffffe00
    s_mov_b32 s59, 0xffffe000
    s_mov_b32 s60, 0xfffffc00
    s_mov_b32 s61, 0xffffc000
    s_mov_b32 s62, 0xfffff800
    s_mov_b32 s63, 0xffff8000
    s_mov_b32 s64, 0xff000000
    s_mov_b32 s65, 0xf0000000
    s_mov_b32 s66, 0xfe000000
    s_mov_b32 s67, 0xe0000000
    s_mov_b32 s68, 0xfc000000
    s_mov_b32 s69, 0xc0000000
    s_mov_b32 s70, 0xf8000000
    s_mov_b32 s71, 0x80000000
    v_bfe_u32 v20, v252, 3, 2
    v_lshrrev_b32 v21, 5, v252
    v_lshl_add_u32 v20, v21, 3, v20
    s_lshr_b32 s32, s28, 1
    s_lshl_b32 s32, s32, 4
    s_and_b32 s33, s28, 1
    s_lshl_b32 s33, s33, 2
    s_add_u32 s32, s32, s33
    v_add_u32 v20, s32, v20
    v_lshlrev_b32 v20, 11, v20
    v_lshrrev_b32 v21, 2, v252
    v_and_b32 v21, 4, v21
    v_xor_b32 v21, v21, v252
    v_and_b32_e64 v21, 7, v21
    v_lshl_add_u32 v20, v21, 4, v20
    s_lshl_b32 s32, s98, 7
    v_add_u32 v243, s32, v20
    s_and_b32 s34, s3, 1
    s_lshr_b32 s35, s3, 1
    v_and_b32 v4, 15, v252
    v_lshrrev_b32 v7, 4, v252
    v_lshrrev_b32 v6, 1, v4
    v_xor_b32 v6, v6, v7
    v_lshlrev_b32_e64 v6, 4, v6
    v_lshl_add_u32 v6, v4, 7, v6
    s_lshl_b32 s30, s34, 13
    v_add_u32 v176, s30, v6
    v_xor_b32 v177, 64, v176
    s_lshl_b32 s30, s35, 1
    v_lshrrev_b32_e64 v20, 2, v252
    v_bfe_u32 v21, v20, 1, 2
    v_xor_b32 v21, s30, v21
    v_lshlrev_b32 v20, 7, v20
    v_lshl_add_u32 v20, v21, 5, v20
    v_and_b32_e64 v21, 3, v252
    v_lshl_add_u32 v20, v21, 3, v20
    v_add_u32 v178, 40960, v20
    v_xor_b32 v179, 32, v178
    v_and_b32 v8, 31, v252
    v_bfe_u32 v6, v8, 1, 3
    v_xor_b32 v6, v6, v5
    v_lshlrev_b32 v6, 4, v6
    v_lshl_add_u32 v6, v8, 7, v6
    s_lshl_b32 s30, s3, 12
    s_add_u32 s30, s30, 147456
    v_add_u32 v192, s30, v6
    v_xor_b32 v193, 32, v192
    v_xor_b32 v194, 64, v192
    v_xor_b32 v195, 96, v192
    s_lshl_b32 s30, s34, 8
    v_lshl_add_u32 v184, v4, 2, s30
    v_lshl_add_u32 v185, v7, 4, s30
    s_lshl_b32 s30, s35, 7
    v_lshl_add_u32 v186, v7, 4, s30
    s_add_u32 s30, s30, 1536
    v_lshl_add_u32 v187, v4, 2, s30
    s_lshl_b32 s30, s3, 7
    s_add_u32 s30, s30, 2048
    v_lshl_add_u32 v188, v8, 2, s30
    v_mov_b32 v189, 0
    v_lshlrev_b32_e64 v6, 9, v7
    v_lshl_add_u32 v245, v4, 4, v6
    v_and_b32_e64 v9, 8, v4
    v_lshl_add_u32 v244, v9, 4, v245
    s_mul_i32 s30, s35, 49152
    s_lshl_b32 s31, s34, 13
    s_add_u32 s30, s30, s31
    s_add_u32 s30, s30, 98304
    v_add_u32_e64 v246, s30, v244
    v_add_u32 v247, s30, v245
    s_lshl_b32 s30, s3, 12
    s_add_u32 s30, s30, 49152
    v_add_u32 v248, s30, v245
    s_getreg_b32 s30, hwreg(HW_REG_XCC_ID, 0, 4)
    v_mov_b32 v251, s30
    s_lshl_b32 s30, s25, 4
    s_add_u32 s30, s30, s24
    s_sub_u32 s30, s30, s72
    s_add_u32 s30, s30, 512
    v_mul_u32_u24 v249, s30, v252
    v_add_u32 v249, s72, v249
    v_lshlrev_b32 v249, 3, v249
    s_cmp_eq_u32 s3, 0
    s_cselect_b32 s89, 10, -1
    v_mov_b32 v242, 0
    v_mov_b32 v0, 0
    v_mov_b32 v1, 0
    v_mov_b32 v2, 0
    v_mov_b32 v3, 0
    v_mov_b32 v4, 0
    v_mov_b32 v5, 0
    v_mov_b32 v6, 0
    v_mov_b32 v7, 0
    v_mov_b32 v8, 0
    v_mov_b32 v9, 0
    v_mov_b32 v10, 0
    v_mov_b32 v11, 0
    v_mov_b32 v12, 0
    v_mov_b32 v13, 0
    v_mov_b32 v14, 0
    v_mov_b32 v15, 0
    v_mov_b32 v16, 0
    v_mov_b32 v17, 0
    v_mov_b32 v18, 0
    v_mov_b32 v19, 0
    v_mov_b32 v20, 0
    v_mov_b32 v21, 0
    v_mov_b32 v22, 0
    v_mov_b32 v23, 0
    v_mov_b32 v24, 0
    v_mov_b32 v25, 0
    v_mov_b32 v26, 0
    v_mov_b32 v27, 0
    v_mov_b32 v28, 0
    v_mov_b32 v29, 0
    v_mov_b32 v30, 0
    v_mov_b32 v31, 0
    v_mov_b32 v32, 0
    v_mov_b32 v33, 0
    v_mov_b32 v34, 0
    v_mov_b32 v35, 0
    v_mov_b32 v36, 0
    v_mov_b32 v37, 0
    v_mov_b32 v38, 0
    v_mov_b32 v39, 0
    v_mov_b32 v40, 0
    v_mov_b32 v41, 0
    v_mov_b32 v42, 0
    v_mov_b32 v43, 0
    v_mov_b32 v44, 0
    v_mov_b32 v45, 0
    v_mov_b32 v46, 0
    v_mov_b32 v47, 0
    v_mov_b32 v48, 0
    v_mov_b32 v49, 0
    v_mov_b32 v50, 0
    v_mov_b32 v51, 0
    v_mov_b32 v52, 0
    v_mov_b32 v53, 0
    v_mov_b32 v54, 0
    v_mov_b32 v55, 0
    v_mov_b32 v56, 0
    v_mov_b32 v57, 0
    v_mov_b32 v58, 0
    v_mov_b32 v59, 0
    v_mov_b32 v60, 0
    v_mov_b32 v61, 0
    v_mov_b32 v62, 0
    v_mov_b32 v63, 0
    v_mov_b32 v64, 0
    v_mov_b32 v65, 0
    v_mov_b32 v66, 0
    v_mov_b32 v67, 0
    v_mov_b32 v68, 0
    v_mov_b32 v69, 0
    v_mov_b32 v70, 0
    v_mov_b32 v71, 0
    v_mov_b32 v72, 0
    v_mov_b32 v73, 0
    v_mov_b32 v74, 0
    v_mov_b32 v75, 0
    v_mov_b32 v76, 0
    v_mov_b32 v77, 0
    v_mov_b32 v78, 0
    v_mov_b32 v79, 0
    v_mov_b32 v80, 0
    v_mov_b32 v81, 0
    v_mov_b32 v82, 0
    v_mov_b32 v83, 0
    v_mov_b32 v84, 0
    v_mov_b32 v85, 0
    v_mov_b32 v86, 0
    v_mov_b32 v87, 0
    v_mov_b32 v88, 0
    v_mov_b32 v89, 0
    v_mov_b32 v90, 0
    v_mov_b32 v91, 0
    v_mov_b32 v92, 0
    v_mov_b32 v93, 0
    v_mov_b32_e64 v94, 0
    v_mov_b32 v95, 0
    s_waitcnt vmcnt(0) lgkmcnt(0)
    s_add_u32 s88, s88, 0x9e3779b9
    v_mov_b32_e64 v250, s88
    v_dot2c_f32_bf16 v242, 0x3f803f80, v224
    v_dot2c_f32_bf16 v242, 0x3f803f80, v225
    v_dot2c_f32_bf16 v242, 0x3f803f80, v226
    v_dot2c_f32_bf16 v242, 0x3f803f80, v227
    v_dot2c_f32_bf16 v242, 0x3f803f80, v228
    v_dot2c_f32_bf16 v242, 0x3f803f80, v229
    v_dot2c_f32_bf16 v242, 0x3f803f80, v230
    v_dot2c_f32_bf16 v242, 0x3f803f80, v231
    v_dot2c_f32_bf16 v242, 0x3f803f80, v232
    v_dot2c_f32_bf16 v242, 0x3f803f80, v233
    v_dot2c_f32_bf16 v242, 0x3f803f80, v234
    v_dot2c_f32_bf16 v242, 0x3f803f80, v235
    v_dot2c_f32_bf16 v242, 0x3f803f80, v236
    v_dot2c_f32_bf16 v242, 0x3f803f80, v237
    v_dot2c_f32_bf16 v242, 0x3f803f80, v238
    v_dot2c_f32_bf16 v242, 0x3f803f80, v239
    s_add_u32 s30, s84, 2
    s_and_b32 s30, s30, 15
    s_mul_i32 s30, s30, 393216
    buffer_load_dword v191, v190, s[16:19], s30 offen
    s_add_u32 s30, s84, 3
    s_and_b32 s30, s30, 15
    s_mul_i32 s30, s30, 393216
    buffer_load_dword v191, v190, s[16:19], s30 offen
    s_add_u32 s30, s84, 4
    s_and_b32 s30, s30, 15
    s_mul_i32 s30, s30, 393216
    buffer_load_dword v191, v190, s[16:19], s30 offen
    s_add_u32 s30, s84, 5
    s_and_b32 s30, s30, 15
    s_mul_i32 s30, s30, 393216
    buffer_load_dword v191, v190, s[16:19], s30 offen
    s_setprio 1
e_q:
    s_mov_b32 s31, 0
    s_mov_b32 s32, 147456
    s_mov_b32 s36, 15
    v_add_u32 v180, s32, v176
    v_mov_b32 v182, v178
    v_add_u32 v181, s32, v177
    v_mov_b32 v183, v179
    s_barrier
    ds_read_b128 v[96:99], v180 offset:0
    ds_read_b64_tr_b16 v[112:113], v182 offset:0
    ds_read_b64_tr_b16 v[114:115], v182 offset:2048
    ds_read_b128 v[100:103], v180 offset:2048
    ds_read_b128 v[104:107], v180 offset:4096
    ds_read_b128 v[108:111], v180 offset:6144
    ds_read_b64_tr_b16 v[116:117], v183 offset:0
    ds_read_b64_tr_b16 v[118:119], v183 offset:2048
    ds_read_b64_tr_b16 v[120:121], v182 offset:8192
    ds_read_b64_tr_b16 v[122:123], v182 offset:10240
    ds_read_b64_tr_b16 v[124:125], v183 offset:8192
    ds_read_b64_tr_b16 v[126:127], v183 offset:10240
    ds_read_b64_tr_b16 v[128:129], v182 offset:16384
    ds_read_b64_tr_b16 v[130:131], v182 offset:18432
    ds_read_b64_tr_b16 v[132:133], v183 offset:16384
    ds_read_b64_tr_b16 v[134:135], v183 offset:18432
    s_add_u32 s85, s84, 5
e_loop:
    s_waitcnt lgkmcnt(0)
    v_mfma_f32_16x16x32_bf16 v[0:3], v[112:115], v[96:99], v[0:3]
    ds_read_b128 v[136:139], v181 offset:0
    v_mfma_f32_16x16x32_bf16 v[8:11], v[112:115], v[100:103], v[8:11]
    ds_read_b64_tr_b16 v[152:153], v182 offset:4096
    v_mfma_f32_16x16x32_bf16 v[16:19], v[112:115], v[104:107], v[16:19]
    ds_read_b64_tr_b16 v[154:155], v182 offset:6144
    v_mfma_f32_16x16x32_bf16 v[24:27], v[112:115], v[108:111], v[24:27]
    ds_read_b128 v[140:143], v181 offset:2048
    v_mfma_f32_16x16x32_bf16 v[28:31], v[116:119], v[108:111], v[28:31]
    ds_read_b128 v[144:147], v181 offset:4096
    v_mfma_f32_16x16x32_bf16 v[20:23], v[116:119], v[104:107], v[20:23]
    ds_read_b128 v[148:151], v181 offset:6144
    v_mfma_f32_16x16x32_bf16 v[12:15], v[116:119], v[100:103], v[12:15]
    ds_read_b64_tr_b16 v[156:157], v183 offset:4096
    v_mfma_f32_16x16x32_bf16 v[4:7], v[116:119], v[96:99], v[4:7]
    ds_read_b64_tr_b16 v[158:159], v183 offset:6144
    v_mfma_f32_16x16x32_bf16 v[32:35], v[120:123], v[96:99], v[32:35]
    ds_read_b64_tr_b16 v[160:161], v182 offset:12288
    v_mfma_f32_16x16x32_bf16 v[40:43], v[120:123], v[100:103], v[40:43]
    ds_read_b64_tr_b16 v[162:163], v182 offset:14336
    v_mfma_f32_16x16x32_bf16 v[48:51], v[120:123], v[104:107], v[48:51]
    ds_read_b64_tr_b16 v[164:165], v183 offset:12288
    v_mfma_f32_16x16x32_bf16 v[56:59], v[120:123], v[108:111], v[56:59]
    ds_read_b64_tr_b16 v[166:167], v183 offset:14336
    v_mfma_f32_16x16x32_bf16 v[60:63], v[124:127], v[108:111], v[60:63]
    ds_read_b64_tr_b16 v[168:169], v182 offset:20480
    v_mfma_f32_16x16x32_bf16 v[52:55], v[124:127], v[104:107], v[52:55]
    ds_read_b64_tr_b16 v[170:171], v182 offset:22528
    v_mfma_f32_16x16x32_bf16 v[44:47], v[124:127], v[100:103], v[44:47]
    ds_read_b64_tr_b16 v[172:173], v183 offset:20480
    v_mfma_f32_16x16x32_bf16 v[36:39], v[124:127], v[96:99], v[36:39]
    ds_read_b64_tr_b16 v[174:175], v183 offset:22528
    v_mfma_f32_16x16x32_bf16 v[64:67], v[96:99], v[128:131], v[64:67]
    s_cmp_eq_u32 s36, s89
    s_cbranch_scc1 e_arr
e_arr_ret:
    v_mfma_f32_16x16x32_bf16 v[68:71], v[100:103], v[128:131], v[68:71]
    s_add_u32 s31, s31, 24576
    s_sub_u32 s32, s32, 16384
    v_mfma_f32_16x16x32_bf16 v[72:75], v[104:107], v[128:131], v[72:75]
    s_cmp_ge_u32 s31, 73728
    s_cselect_b32 s31, 0, s31
    s_cselect_b32 s32, 147456, s32
    v_mfma_f32_16x16x32_bf16 v[76:79], v[108:111], v[128:131], v[76:79]
    v_add_u32 v182, s31, v178
    v_add_u32_e64 v180, s32, v176
    v_mfma_f32_16x16x32_bf16 v[92:95], v[108:111], v[132:135], v[92:95]
    v_add_u32_e64 v183, s31, v179
    v_add_u32 v181, s32, v177
    v_mfma_f32_16x16x32_bf16 v[88:91], v[104:107], v[132:135], v[88:91]
    s_add_u32 s85, s85, 1
    s_and_b32 s30, s85, 15
    v_mfma_f32_16x16x32_bf16 v[84:87], v[100:103], v[132:135], v[84:87]
    s_mul_i32 s30, s30, 393216
    s_cmp_ge_u32 s36, 6
    v_mfma_f32_16x16x32_bf16 v[80:83], v[96:99], v[132:135], v[80:83]
    s_waitcnt lgkmcnt(0)
    v_mfma_f32_16x16x32_bf16 v[0:3], v[152:155], v[136:139], v[0:3]
    s_barrier
    ds_read_b128 v[96:99], v180 offset:0
    v_mfma_f32_16x16x32_bf16 v[8:11], v[152:155], v[140:143], v[8:11]
    ds_read_b64_tr_b16 v[112:113], v182 offset:0
    v_mfma_f32_16x16x32_bf16 v[16:19], v[152:155], v[144:147], v[16:19]
    ds_read_b64_tr_b16 v[114:115], v182 offset:2048
    v_mfma_f32_16x16x32_bf16 v[24:27], v[152:155], v[148:151], v[24:27]
    ds_read_b128 v[100:103], v180 offset:2048
    v_mfma_f32_16x16x32_bf16 v[28:31], v[156:159], v[148:151], v[28:31]
    ds_read_b128 v[104:107], v180 offset:4096
    v_mfma_f32_16x16x32_bf16 v[20:23], v[156:159], v[144:147], v[20:23]
    ds_read_b128 v[108:111], v180 offset:6144
    v_mfma_f32_16x16x32_bf16 v[12:15], v[156:159], v[140:143], v[12:15]
    ds_read_b64_tr_b16 v[116:117], v183 offset:0
    v_mfma_f32_16x16x32_bf16 v[4:7], v[156:159], v[136:139], v[4:7]
    ds_read_b64_tr_b16 v[118:119], v183 offset:2048
    v_mfma_f32_16x16x32_bf16 v[32:35], v[160:163], v[136:139], v[32:35]
    ds_read_b64_tr_b16 v[120:121], v182 offset:8192
    v_mfma_f32_16x16x32_bf16 v[40:43], v[160:163], v[140:143], v[40:43]
    ds_read_b64_tr_b16 v[122:123], v182 offset:10240
    v_mfma_f32_16x16x32_bf16 v[48:51], v[160:163], v[144:147], v[48:51]
    ds_read_b64_tr_b16 v[124:125], v183 offset:8192
    v_mfma_f32_16x16x32_bf16 v[56:59], v[160:163], v[148:151], v[56:59]
    ds_read_b64_tr_b16 v[126:127], v183 offset:10240
    v_mfma_f32_16x16x32_bf16 v[60:63], v[164:167], v[148:151], v[60:63]
    ds_read_b64_tr_b16 v[128:129], v182 offset:16384
    v_mfma_f32_16x16x32_bf16 v[52:55], v[164:167], v[144:147], v[52:55]
    ds_read_b64_tr_b16 v[130:131], v182 offset:18432
    v_mfma_f32_16x16x32_bf16 v[44:47], v[164:167], v[140:143], v[44:47]
    ds_read_b64_tr_b16 v[132:133], v183 offset:16384
    v_mfma_f32_16x16x32_bf16 v[36:39], v[164:167], v[136:139], v[36:39]
    ds_read_b64_tr_b16 v[134:135], v183 offset:18432
    v_mfma_f32_16x16x32_bf16 v[64:67], v[136:139], v[168:171], v[64:67]
    s_cselect_b64 exec, 7, 0
    buffer_load_dword v191, v190, s[16:19], s30 offen
    s_mov_b64 exec, -1
    v_mfma_f32_16x16x32_bf16 v[68:71], v[140:143], v[168:171], v[68:71]
    s_bitcmp1_b32 s86, s36
    s_cbranch_scc1 e_fpf
e_fpf_ret:
    v_mfma_f32_16x16x32_bf16 v[72:75], v[144:147], v[168:171], v[72:75]
    s_sub_u32 s36, s36, 1
    s_cmp_eq_u32 s36, 0
    v_mfma_f32_16x16x32_bf16 v[76:79], v[148:151], v[168:171], v[76:79]
    v_mfma_f32_16x16x32_bf16 v[92:95], v[148:151], v[172:175], v[92:95]
    v_mfma_f32_16x16x32_bf16 v[88:91], v[144:147], v[172:175], v[88:91]
    v_mfma_f32_16x16x32_bf16 v[84:87], v[140:143], v[172:175], v[84:87]
    v_mfma_f32_16x16x32_bf16 v[80:83], v[136:139], v[172:175], v[80:83]
    s_cbranch_scc0 e_loop
    s_waitcnt lgkmcnt(0)
    v_mfma_f32_16x16x32_bf16 v[0:3], v[112:115], v[96:99], v[0:3]
    ds_read_b128 v[136:139], v181 offset:0
    v_mfma_f32_16x16x32_bf16 v[8:11], v[112:115], v[100:103], v[8:11]
    ds_read_b64_tr_b16 v[152:153], v182 offset:4096
    v_mfma_f32_16x16x32_bf16 v[16:19], v[112:115], v[104:107], v[16:19]
    ds_read_b64_tr_b16 v[154:155], v182 offset:6144
    v_mfma_f32_16x16x32_bf16 v[24:27], v[112:115], v[108:111], v[24:27]
    ds_read_b128 v[140:143], v181 offset:2048
    v_mfma_f32_16x16x32_bf16 v[28:31], v[116:119], v[108:111], v[28:31]
    ds_read_b128 v[144:147], v181 offset:4096
    v_mfma_f32_16x16x32_bf16 v[20:23], v[116:119], v[104:107], v[20:23]
    ds_read_b128 v[148:151], v181 offset:6144
    v_mfma_f32_16x16x32_bf16 v[12:15], v[116:119], v[100:103], v[12:15]
    ds_read_b64_tr_b16 v[156:157], v183 offset:4096
    v_mfma_f32_16x16x32_bf16 v[4:7], v[116:119], v[96:99], v[4:7]
    ds_read_b64_tr_b16 v[158:159], v183 offset:6144
    v_mfma_f32_16x16x32_bf16 v[32:35], v[120:123], v[96:99], v[32:35]
    ds_read_b64_tr_b16 v[160:161], v182 offset:12288
    v_mfma_f32_16x16x32_bf16 v[40:43], v[120:123], v[100:103], v[40:43]
    ds_read_b64_tr_b16 v[162:163], v182 offset:14336
    v_mfma_f32_16x16x32_bf16 v[48:51], v[120:123], v[104:107], v[48:51]
    ds_read_b64_tr_b16 v[164:165], v183 offset:12288
    v_mfma_f32_16x16x32_bf16 v[56:59], v[120:123], v[108:111], v[56:59]
    ds_read_b64_tr_b16 v[166:167], v183 offset:14336
    v_mfma_f32_16x16x32_bf16 v[60:63], v[124:127], v[108:111], v[60:63]
    ds_read_b64_tr_b16 v[168:169], v182 offset:20480
    v_mfma_f32_16x16x32_bf16 v[52:55], v[124:127], v[104:107], v[52:55]
    ds_read_b64_tr_b16 v[170:171], v182 offset:22528
    v_mfma_f32_16x16x32_bf16 v[44:47], v[124:127], v[100:103], v[44:47]
    ds_read_b64_tr_b16 v[172:173], v183 offset:20480
    v_mfma_f32_16x16x32_bf16 v[36:39], v[124:127], v[96:99], v[36:39]
    ds_read_b64_tr_b16 v[174:175], v183 offset:22528
    v_mfma_f32_16x16x32_bf16 v[64:67], v[96:99], v[128:131], v[64:67]
    s_cmp_lg_u32 s26, 0
    s_cbranch_scc1 e_nores
    ds_read_b128 v[208:211], v192
    ds_read_b128 v[212:215], v193
    ds_read_b128 v[216:219], v194
    ds_read_b128 v[220:223], v195
e_nores:
    v_mfma_f32_16x16x32_bf16 v[68:71], v[100:103], v[128:131], v[68:71]
    s_and_b32 s34, s3, 1
    s_lshr_b32 s35, s3, 1
    s_lshl_b32 s30, s25, 1
    v_mfma_f32_16x16x32_bf16 v[72:75], v[104:107], v[128:131], v[72:75]
    s_add_u32 s30, s30, s35
    s_lshl_b32 s30, s30, 6
    s_lshl_b32 s31, s24, 2
    v_mfma_f32_16x16x32_bf16 v[76:79], v[108:111], v[128:131], v[76:79]
    s_add_u32 s30, s30, s31
    s_lshl_b32 s31, s34, 1
    s_add_u32 s30, s30, s31
    v_mfma_f32_16x16x32_bf16 v[92:95], v[108:111], v[132:135], v[92:95]
    s_lshl_b32 s32, s30, 12
    s_add_u32 s32, s32, s26
    s_add_u32 s33, s32, 4096
    v_mfma_f32_16x16x32_bf16 v[88:91], v[104:107], v[132:135], v[88:91]
    v_mfma_f32_16x16x32_bf16 v[84:87], v[100:103], v[132:135], v[84:87]
    v_mfma_f32_16x16x32_bf16 v[80:83], v[96:99], v[132:135], v[80:83]
    s_waitcnt vmcnt(0) lgkmcnt(0)
    v_mfma_f32_16x16x32_bf16 v[32:35], v[160:163], v[136:139], v[32:35]
    s_barrier
    ds_read2_b32 v[204:205], v184 offset0:128 offset1:144
    ds_read_b128 v[128:131], v186 offset:1280
    v_mfma_f32_16x16x32_bf16 v[40:43], v[160:163], v[140:143], v[40:43]
    ds_read_b128 v[132:135], v186 offset:1344
    ds_read2_b32 v[192:193], v184 offset0:0 offset1:16
    v_mfma_f32_16x16x32_bf16 v[48:51], v[160:163], v[144:147], v[48:51]
    ds_read2_b32 v[206:207], v184 offset0:160 offset1:176
    ds_read2_b32 v[194:195], v184 offset0:32 offset1:48
    v_mfma_f32_16x16x32_bf16 v[56:59], v[160:163], v[148:151], v[56:59]
    ds_read2_b32 v[190:191], v187 offset0:0 offset1:16
    ds_read_b128 v[112:115], v185 offset:512
    v_mfma_f32_16x16x32_bf16 v[36:39], v[164:167], v[136:139], v[36:39]
    ds_read_b128 v[96:99], v185 offset:0
    ds_read_b128 v[116:119], v185 offset:576
    v_mfma_f32_16x16x32_bf16 v[44:47], v[164:167], v[140:143], v[44:47]
    ds_read_b128 v[100:103], v185 offset:64
    ds_read_b128 v[120:123], v185 offset:640
    v_mfma_f32_16x16x32_bf16 v[52:55], v[164:167], v[144:147], v[52:55]
    ds_read_b128 v[104:107], v185 offset:128
    ds_read_b128 v[124:127], v185 offset:704
    v_mfma_f32_16x16x32_bf16 v[60:63], v[164:167], v[148:151], v[60:63]
    ds_read_b128 v[108:111], v185 offset:192
    ds_read_b128 v[196:199], v186 offset:1024
    v_mfma_f32_16x16x32_bf16 v[64:67], v[136:139], v[168:171], v[64:67]
    ds_read_b128 v[200:203], v186 offset:1088
    ds_read2_b32 v[240:241], v188 offset0:0 offset1:128
    v_mfma_f32_16x16x32_bf16 v[68:71], v[140:143], v[168:171], v[68:71]
    ds_read_b64 v[250:251], v189 offset:3072
    v_mfma_f32_16x16x32_bf16 v[72:75], v[144:147], v[168:171], v[72:75]
    s_waitcnt lgkmcnt(13)
    v_fma_f32 v32, v128, -v204, v32
    v_fma_f32 v33, v129, -v204, v33
    v_fma_f32 v34, v130, -v204, v34
    v_mfma_f32_16x16x32_bf16 v[76:79], v[148:151], v[168:171], v[76:79]
    v_fma_f32 v35, v131, -v204, v35
    v_fma_f32 v36, v132, -v204, v36
    v_fma_f32 v37, v133, -v204, v37
    v_mfma_f32_16x16x32_bf16 v[80:83], v[136:139], v[172:175], v[80:83]
    v_fma_f32 v38, v134, -v204, v38
    v_fma_f32 v39, v135, -v204, v39
    v_mul_f32_e64 v32, v32, v192
    v_mfma_f32_16x16x32_bf16 v[84:87], v[140:143], v[172:175], v[84:87]
    v_mul_f32 v33, v33, v192
    v_mul_f32 v34, v34, v192
    v_mul_f32_e64 v35, v35, v192
    v_mfma_f32_16x16x32_bf16 v[88:91], v[144:147], v[172:175], v[88:91]
    v_mul_f32 v36, v36, v192
    v_mul_f32 v37, v37, v192
    v_mul_f32_e64 v38, v38, v192
    v_mfma_f32_16x16x32_bf16 v[92:95], v[148:151], v[172:175], v[92:95]
    v_mul_f32_e64 v39, v39, v192
    v_cvt_pk_bf16_f32 v32, v32, v33
    v_cvt_pk_bf16_f32 v33, v34, v35
    v_mfma_f32_16x16x32_bf16 v[0:3], v[152:155], v[136:139], v[0:3]
    v_cvt_pk_bf16_f32 v34, v36, v37
    v_cvt_pk_bf16_f32 v35, v38, v39
    buffer_store_dwordx4 v[32:35], v244, s[20:23], s32 offen offset:0 sc1
    v_mfma_f32_16x16x32_bf16 v[8:11], v[152:155], v[140:143], v[8:11]
    v_fma_f32 v40, v128, -v205, v40
    v_fma_f32 v41, v129, -v205, v41
    v_fma_f32 v42, v130, -v205, v42
    v_mfma_f32_16x16x32_bf16 v[16:19], v[152:155], v[144:147], v[16:19]
    v_fma_f32 v43, v131, -v205, v43
    v_fma_f32 v44, v132, -v205, v44
    v_fma_f32 v45, v133, -v205, v45
    v_mfma_f32_16x16x32_bf16 v[24:27], v[152:155], v[148:151], v[24:27]
    v_fma_f32 v46, v134, -v205, v46
    v_fma_f32 v47, v135, -v205, v47
    v_mul_f32_e64 v40, v40, v193
    v_mfma_f32_16x16x32_bf16 v[4:7], v[156:159], v[136:139], v[4:7]
    v_mul_f32 v41, v41, v193
    v_mul_f32 v42, v42, v193
    v_mul_f32_e64 v43, v43, v193
    v_mfma_f32_16x16x32_bf16 v[12:15], v[156:159], v[140:143], v[12:15]
    v_mul_f32 v44, v44, v193
    v_mul_f32 v45, v45, v193
    v_mul_f32_e64 v46, v46, v193
    v_mfma_f32_16x16x32_bf16 v[20:23], v[156:159], v[144:147], v[20:23]
    v_mul_f32 v47, v47, v193
    v_cvt_pk_bf16_f32 v40, v40, v41
    v_cvt_pk_bf16_f32 v41, v42, v43
    v_mfma_f32_16x16x32_bf16 v[28:31], v[156:159], v[148:151], v[28:31]
    v_cvt_pk_bf16_f32 v42, v44, v45
    v_cvt_pk_bf16_f32 v43, v46, v47
    buffer_store_dwordx4 v[40:43], v244, s[20:23], s32 offen offset:128 sc1
    v_pk_fma_f32 v[48:49], v[128:129], v[206:207], v[48:49] op_sel_hi:[1,0,1] neg_lo:[0,1,0] neg_hi:[0,1,0]
    v_pk_fma_f32 v[50:51], v[130:131], v[206:207], v[50:51] op_sel_hi:[1,0,1] neg_lo:[0,1,0] neg_hi:[0,1,0]
    v_pk_fma_f32 v[52:53], v[132:133], v[206:207], v[52:53] op_sel_hi:[1,0,1] neg_lo:[0,1,0] neg_hi:[0,1,0]
    v_pk_fma_f32 v[54:55], v[134:135], v[206:207], v[54:55] op_sel_hi:[1,0,1] neg_lo:[0,1,0] neg_hi:[0,1,0]
    v_pk_mul_f32 v[48:49], v[48:49], v[194:195] op_sel_hi:[1,0]
    v_pk_mul_f32 v[50:51], v[50:51], v[194:195] op_sel_hi:[1,0]
    v_pk_mul_f32 v[52:53], v[52:53], v[194:195] op_sel_hi:[1,0]
    v_pk_mul_f32 v[54:55], v[54:55], v[194:195] op_sel_hi:[1,0]
    v_cvt_pk_bf16_f32 v48, v48, v49
    v_cvt_pk_bf16_f32 v49, v50, v51
    v_cvt_pk_bf16_f32 v50, v52, v53
    v_cvt_pk_bf16_f32 v51, v54, v55
    buffer_store_dwordx4 v[48:51], v244, s[20:23], s33 offen offset:0 sc1
    v_pk_fma_f32 v[56:57], v[128:129], v[206:207], v[56:57] op_sel:[0,1,0] op_sel_hi:[1,1,1] neg_lo:[0,1,0] neg_hi:[0,1,0]
    v_pk_fma_f32 v[58:59], v[130:131], v[206:207], v[58:59] op_sel:[0,1,0] op_sel_hi:[1,1,1] neg_lo:[0,1,0] neg_hi:[0,1,0]
    v_pk_fma_f32 v[60:61], v[132:133], v[206:207], v[60:61] op_sel:[0,1,0] op_sel_hi:[1,1,1] neg_lo:[0,1,0] neg_hi:[0,1,0]
    v_pk_fma_f32 v[62:63], v[134:135], v[206:207], v[62:63] op_sel:[0,1,0] op_sel_hi:[1,1,1] neg_lo:[0,1,0] neg_hi:[0,1,0]
    v_pk_mul_f32 v[56:57], v[56:57], v[194:195] op_sel:[0,1] op_sel_hi:[1,1]
    v_pk_mul_f32 v[58:59], v[58:59], v[194:195] op_sel:[0,1] op_sel_hi:[1,1]
    v_pk_mul_f32 v[60:61], v[60:61], v[194:195] op_sel:[0,1] op_sel_hi:[1,1]
    v_pk_mul_f32 v[62:63], v[62:63], v[194:195] op_sel:[0,1] op_sel_hi:[1,1]
    v_cvt_pk_bf16_f32 v56, v56, v57
    v_cvt_pk_bf16_f32 v57, v58, v59
    v_cvt_pk_bf16_f32 v58, v60, v61
    v_cvt_pk_bf16_f32 v59, v62, v63
    buffer_store_dwordx4 v[56:59], v244, s[20:23], s33 offen offset:128 sc1
    s_waitcnt lgkmcnt(0)
    v_pk_fma_f32 v[64:65], v[112:113], v[190:191], v[64:65] op_sel_hi:[1,0,1] neg_lo:[0,1,0] neg_hi:[0,1,0]
    v_pk_fma_f32 v[66:67], v[114:115], v[190:191], v[66:67] op_sel_hi:[1,0,1] neg_lo:[0,1,0] neg_hi:[0,1,0]
    v_pk_fma_f32 v[68:69], v[116:117], v[190:191], v[68:69] op_sel_hi:[1,0,1] neg_lo:[0,1,0] neg_hi:[0,1,0]
    v_pk_fma_f32 v[70:71], v[118:119], v[190:191], v[70:71] op_sel_hi:[1,0,1] neg_lo:[0,1,0] neg_hi:[0,1,0]
    v_pk_mul_f32 v[64:65], v[64:65], v[96:97]
    v_pk_mul_f32 v[66:67], v[66:67], v[98:99]
    v_pk_mul_f32 v[68:69], v[68:69], v[100:101]
    v_pk_mul_f32 v[70:71], v[70:71], v[102:103]
    v_cvt_pk_bf16_f32 v64, v64, v65
    v_cvt_pk_bf16_f32 v65, v66, v67
    v_cvt_pk_bf16_f32 v66, v68, v69
    v_cvt_pk_bf16_f32 v67, v70, v71
    buffer_store_dwordx4 v[64:67], v245, s[20:23], s32 offen offset:2048 sc1
    v_pk_fma_f32 v[80:81], v[112:113], v[190:191], v[80:81] op_sel:[0,1,0] op_sel_hi:[1,1,1] neg_lo:[0,1,0] neg_hi:[0,1,0]
    v_pk_fma_f32 v[82:83], v[114:115], v[190:191], v[82:83] op_sel:[0,1,0] op_sel_hi:[1,1,1] neg_lo:[0,1,0] neg_hi:[0,1,0]
    v_pk_fma_f32 v[84:85], v[116:117], v[190:191], v[84:85] op_sel:[0,1,0] op_sel_hi:[1,1,1] neg_lo:[0,1,0] neg_hi:[0,1,0]
    v_pk_fma_f32 v[86:87], v[118:119], v[190:191], v[86:87] op_sel:[0,1,0] op_sel_hi:[1,1,1] neg_lo:[0,1,0] neg_hi:[0,1,0]
    v_pk_mul_f32 v[80:81], v[80:81], v[96:97]
    v_pk_mul_f32 v[82:83], v[82:83], v[98:99]
    v_pk_mul_f32 v[84:85], v[84:85], v[100:101]
    v_pk_mul_f32 v[86:87], v[86:87], v[102:103]
    v_cvt_pk_bf16_f32 v80, v80, v81
    v_cvt_pk_bf16_f32 v81, v82, v83
    v_cvt_pk_bf16_f32 v82, v84, v85
    v_cvt_pk_bf16_f32 v83, v86, v87
    buffer_store_dwordx4 v[80:83], v245, s[20:23], s32 offen offset:2304 sc1
    v_pk_fma_f32 v[72:73], v[120:121], v[190:191], v[72:73] op_sel_hi:[1,0,1] neg_lo:[0,1,0] neg_hi:[0,1,0]
    v_pk_fma_f32 v[74:75], v[122:123], v[190:191], v[74:75] op_sel_hi:[1,0,1] neg_lo:[0,1,0] neg_hi:[0,1,0]
    v_pk_fma_f32 v[76:77], v[124:125], v[190:191], v[76:77] op_sel_hi:[1,0,1] neg_lo:[0,1,0] neg_hi:[0,1,0]
    v_pk_fma_f32 v[78:79], v[126:127], v[190:191], v[78:79] op_sel_hi:[1,0,1] neg_lo:[0,1,0] neg_hi:[0,1,0]
    v_pk_mul_f32 v[72:73], v[72:73], v[104:105]
    v_pk_mul_f32 v[74:75], v[74:75], v[106:107]
    v_pk_mul_f32 v[76:77], v[76:77], v[108:109]
    v_pk_mul_f32 v[78:79], v[78:79], v[110:111]
    v_cvt_pk_bf16_f32 v72, v72, v73
    v_cvt_pk_bf16_f32 v73, v74, v75
    v_cvt_pk_bf16_f32 v74, v76, v77
    v_cvt_pk_bf16_f32 v75, v78, v79
    buffer_store_dwordx4 v[72:75], v245, s[20:23], s33 offen offset:2048 sc1
    v_pk_fma_f32 v[88:89], v[120:121], v[190:191], v[88:89] op_sel:[0,1,0] op_sel_hi:[1,1,1] neg_lo:[0,1,0] neg_hi:[0,1,0]
    v_pk_fma_f32 v[90:91], v[122:123], v[190:191], v[90:91] op_sel:[0,1,0] op_sel_hi:[1,1,1] neg_lo:[0,1,0] neg_hi:[0,1,0]
    v_pk_fma_f32 v[92:93], v[124:125], v[190:191], v[92:93] op_sel:[0,1,0] op_sel_hi:[1,1,1] neg_lo:[0,1,0] neg_hi:[0,1,0]
    v_pk_fma_f32 v[94:95], v[126:127], v[190:191], v[94:95] op_sel:[0,1,0] op_sel_hi:[1,1,1] neg_lo:[0,1,0] neg_hi:[0,1,0]
    v_pk_mul_f32 v[88:89], v[88:89], v[104:105]
    v_pk_mul_f32 v[90:91], v[90:91], v[106:107]
    v_pk_mul_f32 v[92:93], v[92:93], v[108:109]
    v_pk_mul_f32 v[94:95], v[94:95], v[110:111]
    v_cvt_pk_bf16_f32 v88, v88, v89
    v_cvt_pk_bf16_f32 v89, v90, v91
    v_cvt_pk_bf16_f32 v90, v92, v93
    v_cvt_pk_bf16_f32 v91, v94, v95
    buffer_store_dwordx4 v[88:91], v245, s[20:23], s33 offen offset:2304 sc1
    ds_write_b128 v246, v[32:35] offset:0
    v_mul_f32 v192, 0x3e8293ee, v192
    ds_write_b128 v246, v[40:43] offset:128
    v_mul_f32 v193, 0x3e8293ee, v193
    ds_write_b128 v246, v[48:51] offset:4096
    v_mul_f32 v194, 0x3e8293ee, v194
    ds_write_b128 v246, v[56:59] offset:4224
    v_mul_f32 v195, 0x3e8293ee, v195
    v_pk_fma_f32 v[0:1], v[196:197], v[204:205], v[0:1] op_sel_hi:[1,0,1] neg_lo:[0,1,0] neg_hi:[0,1,0]
    v_pk_fma_f32 v[2:3], v[198:199], v[204:205], v[2:3] op_sel_hi:[1,0,1] neg_lo:[0,1,0] neg_hi:[0,1,0]
    v_pk_fma_f32 v[4:5], v[200:201], v[204:205], v[4:5] op_sel_hi:[1,0,1] neg_lo:[0,1,0] neg_hi:[0,1,0]
    v_pk_fma_f32 v[6:7], v[202:203], v[204:205], v[6:7] op_sel_hi:[1,0,1] neg_lo:[0,1,0] neg_hi:[0,1,0]
    v_pk_mul_f32 v[0:1], v[0:1], v[192:193] op_sel_hi:[1,0]
    v_pk_mul_f32 v[2:3], v[2:3], v[192:193] op_sel_hi:[1,0]
    v_pk_mul_f32 v[4:5], v[4:5], v[192:193] op_sel_hi:[1,0]
    v_pk_mul_f32 v[6:7], v[6:7], v[192:193] op_sel_hi:[1,0]
    v_cvt_pk_bf16_f32 v0, v0, v1
    v_cvt_pk_bf16_f32 v1, v2, v3
    v_cvt_pk_bf16_f32 v2, v4, v5
    v_cvt_pk_bf16_f32 v3, v6, v7
    ds_write_b128 v247, v[64:67] offset:2048
    ds_write_b128 v248, v[0:3] offset:0
    v_pk_fma_f32 v[8:9], v[196:197], v[204:205], v[8:9] op_sel:[0,1,0] op_sel_hi:[1,1,1] neg_lo:[0,1,0] neg_hi:[0,1,0]
    v_pk_fma_f32 v[10:11], v[198:199], v[204:205], v[10:11] op_sel:[0,1,0] op_sel_hi:[1,1,1] neg_lo:[0,1,0] neg_hi:[0,1,0]
    v_pk_fma_f32 v[12:13], v[200:201], v[204:205], v[12:13] op_sel:[0,1,0] op_sel_hi:[1,1,1] neg_lo:[0,1,0] neg_hi:[0,1,0]
    v_pk_fma_f32 v[14:15], v[202:203], v[204:205], v[14:15] op_sel:[0,1,0] op_sel_hi:[1,1,1] neg_lo:[0,1,0] neg_hi:[0,1,0]
    v_pk_mul_f32 v[8:9], v[8:9], v[192:193] op_sel:[0,1] op_sel_hi:[1,1]
    v_pk_mul_f32 v[10:11], v[10:11], v[192:193] op_sel:[0,1] op_sel_hi:[1,1]
    v_pk_mul_f32 v[12:13], v[12:13], v[192:193] op_sel:[0,1] op_sel_hi:[1,1]
    v_pk_mul_f32 v[14:15], v[14:15], v[192:193] op_sel:[0,1] op_sel_hi:[1,1]
    v_cvt_pk_bf16_f32 v8, v8, v9
    v_cvt_pk_bf16_f32 v9, v10, v11
    v_cvt_pk_bf16_f32 v10, v12, v13
    v_cvt_pk_bf16_f32 v11, v14, v15
    ds_write_b128 v247, v[80:83] offset:2304
    ds_write_b128 v248, v[8:11] offset:256
    v_pk_fma_f32 v[16:17], v[196:197], v[206:207], v[16:17] op_sel_hi:[1,0,1] neg_lo:[0,1,0] neg_hi:[0,1,0]
    v_pk_fma_f32 v[18:19], v[198:199], v[206:207], v[18:19] op_sel_hi:[1,0,1] neg_lo:[0,1,0] neg_hi:[0,1,0]
    v_pk_fma_f32 v[20:21], v[200:201], v[206:207], v[20:21] op_sel_hi:[1,0,1] neg_lo:[0,1,0] neg_hi:[0,1,0]
    v_pk_fma_f32 v[22:23], v[202:203], v[206:207], v[22:23] op_sel_hi:[1,0,1] neg_lo:[0,1,0] neg_hi:[0,1,0]
    v_pk_mul_f32 v[16:17], v[16:17], v[194:195] op_sel_hi:[1,0]
    v_pk_mul_f32 v[18:19], v[18:19], v[194:195] op_sel_hi:[1,0]
    v_pk_mul_f32 v[20:21], v[20:21], v[194:195] op_sel_hi:[1,0]
    v_pk_mul_f32 v[22:23], v[22:23], v[194:195] op_sel_hi:[1,0]
    v_cvt_pk_bf16_f32 v16, v16, v17
    v_cvt_pk_bf16_f32 v17, v18, v19
    v_cvt_pk_bf16_f32 v18, v20, v21
    v_cvt_pk_bf16_f32 v19, v22, v23
    ds_write_b128 v247, v[72:75] offset:6144
    ds_write_b128 v248, v[16:19] offset:2048
    v_pk_fma_f32 v[24:25], v[196:197], v[206:207], v[24:25] op_sel:[0,1,0] op_sel_hi:[1,1,1] neg_lo:[0,1,0] neg_hi:[0,1,0]
    v_pk_fma_f32 v[26:27], v[198:199], v[206:207], v[26:27] op_sel:[0,1,0] op_sel_hi:[1,1,1] neg_lo:[0,1,0] neg_hi:[0,1,0]
    v_pk_fma_f32 v[28:29], v[200:201], v[206:207], v[28:29] op_sel:[0,1,0] op_sel_hi:[1,1,1] neg_lo:[0,1,0] neg_hi:[0,1,0]
    v_pk_fma_f32 v[30:31], v[202:203], v[206:207], v[30:31] op_sel:[0,1,0] op_sel_hi:[1,1,1] neg_lo:[0,1,0] neg_hi:[0,1,0]
    v_pk_mul_f32 v[24:25], v[24:25], v[194:195] op_sel:[0,1] op_sel_hi:[1,1]
    v_pk_mul_f32 v[26:27], v[26:27], v[194:195] op_sel:[0,1] op_sel_hi:[1,1]
    v_pk_mul_f32 v[28:29], v[28:29], v[194:195] op_sel:[0,1] op_sel_hi:[1,1]
    v_pk_mul_f32 v[30:31], v[30:31], v[194:195] op_sel:[0,1] op_sel_hi:[1,1]
    v_cvt_pk_bf16_f32 v24, v24, v25
    v_cvt_pk_bf16_f32 v25, v26, v27
    v_cvt_pk_bf16_f32 v26, v28, v29
    v_cvt_pk_bf16_f32 v27, v30, v31
    ds_write_b128 v247, v[88:91] offset:6400
    ds_write_b128 v248, v[24:27] offset:2304
    s_lshl_b32 s30, s25, 8
    s_lshl_b32 s31, s24, 4
    s_add_u32 s30, s30, s31
    s_lshl_b32 s31, s34, 3
    s_add_u32 s30, s30, s31
    s_lshl_b32 s31, s35, 2
    s_add_u32 s30, s30, s31
    s_lshl_b32 s30, s30, 3
    s_add_u32 s30, s30, s26
    s_add_u32 s30, s30, 0xe00000
    v_readfirstlane_b32 s73, v250
    v_readfirstlane_b32 s77, v251
    s_lshr_b32 s39, s73, 5
    s_lshl_b32 s34, s24, 2
    s_sub_u32 s39, s39, s34
    s_add_u32 s39, s39, 8
    s_lshr_b32 s34, s39, 3
    s_add_u32 s34, s34, 1
    s_cmp_lt_u32 s39, 12
    s_cselect_b32 s100, s34, 0
    s_cmp_lg_u32 s26, 0
    s_cbranch_scc1 sk_2
    v_permlane32_swap_b32 v208, v210
    v_permlane32_swap_b32 v209, v211
    v_permlane32_swap_b32 v212, v214
    v_permlane32_swap_b32 v213, v215
    v_permlane32_swap_b32 v216, v218
    v_permlane32_swap_b32 v217, v219
    v_permlane32_swap_b32 v220, v222
    v_permlane32_swap_b32_e64 v221, v223
sk_2:
    v_mov_b32 v20, 0xffff
    v_mov_b32 v21, 0xffff0000
    v_cndmask_b32 v22, 0, v20, s[40:41]
    v_cndmask_b32 v23, 0, v21, s[42:43]
    v_or_b32_e64 v12, v22, v23
    v_cndmask_b32 v22, 0, v20, s[44:45]
    v_cndmask_b32 v23, 0, v21, s[46:47]
    v_or_b32_e64 v13, v22, v23
    v_cndmask_b32 v22, 0, v20, s[48:49]
    v_cndmask_b32 v23, 0, v21, s[50:51]
    v_or_b32_e64 v14, v22, v23
    v_cndmask_b32 v22, 0, v20, s[52:53]
    v_cndmask_b32 v23, 0, v21, s[54:55]
    v_or_b32_e64 v15, v22, v23
    v_cndmask_b32 v22, 0, v20, s[56:57]
    v_cndmask_b32 v23, 0, v21, s[58:59]
    v_or_b32_e64 v16, v22, v23
    v_cndmask_b32 v22, 0, v20, s[60:61]
    v_cndmask_b32 v23, 0, v21, s[62:63]
    v_or_b32_e64 v17, v22, v23
    v_cndmask_b32 v22, 0, v20, s[64:65]
    v_cndmask_b32 v23, 0, v21, s[66:67]
    v_or_b32_e64 v18, v22, v23
    v_cndmask_b32 v22, 0, v20, s[68:69]
    v_cndmask_b32 v23, 0, v21, s[70:71]
    v_or_b32 v19, v22, v23
    s_xor_b32 s76, s99, 0
    s_and_b32 s34, s76, 3
    s_lshl_b32 s33, s34, 12
    s_add_u32 s33, s33, 65536
    v_add_u32_e64 v20, s33, v253
    v_add_u32 v22, 32768, v20
    v_add_u32 v23, 94208, v253
    s_add_u32 s74, s34, 1
    s_mov_b32 s75, 0
    s_lshl_b32 s34, s34, 11
    s_add_u32 s34, s34, 49152
    v_add_u32 v3, s34, v253
    v_mov_b32 v21, 0xf149f2ca
    v_cndmask_b32 v24, v21, 0, s[40:41]
    v_cndmask_b32 v25, v21, 0, s[42:43]
    v_cndmask_b32 v26, v21, 0, s[44:45]
    v_cndmask_b32 v27, v21, 0, s[46:47]
    v_cndmask_b32 v28, v21, 0, s[48:49]
    v_cndmask_b32 v29, v21, 0, s[50:51]
    v_cndmask_b32 v30, v21, 0, s[52:53]
    v_cndmask_b32 v31, v21, 0, s[54:55]
    v_cndmask_b32 v32, v21, 0, s[56:57]
    v_cndmask_b32 v33, v21, 0, s[58:59]
    v_cndmask_b32 v34, v21, 0, s[60:61]
    v_cndmask_b32 v35, v21, 0, s[62:63]
    v_cndmask_b32 v36, v21, 0, s[64:65]
    v_cndmask_b32 v37, v21, 0, s[66:67]
    v_cndmask_b32 v38, v21, 0, s[68:69]
    v_cndmask_b32 v39, v21, 0, s[70:71]
    v_lshrrev_b32 v40, 2, v252
    v_xor_b32 v40, v40, v252
    v_bfe_u32 v40, v40, 2, 1
    v_add_u32_e64 v40, -1, v40
    v_and_b32 v40, 0x3f803f80, v40
    v_mov_b32 v41, v40
    v_mov_b32 v42, v40
    v_mov_b32 v43, v40
    v_mov_b32 v44, 0
    v_mov_b32 v45, 0
    v_mov_b32 v46, 0
    v_mov_b32 v47, 0
    v_mov_b32 v88, 0
    v_mov_b32 v89, 0
    v_mov_b32 v90, 0
    v_mov_b32 v91, 0
    v_mov_b32 v92, 0
    v_mov_b32 v93, 0
    v_mov_b32 v94, 0
    v_mov_b32 v95, 0
    v_mov_b32 v96, 0
    v_mov_b32 v97, 0
    v_mov_b32 v98, 0
    v_mov_b32 v99, 0
    v_mov_b32 v100, 0
    v_mov_b32 v101, 0
    v_mov_b32 v102, 0
    v_mov_b32_e64 v103, 0
    s_cmp_lg_u32 s100, 2
    s_cbranch_scc1 sk_3
    s_and_b32 s32, s28, 1
    s_lshr_b32 s33, s28, 1
    s_add_u32 s36, s32, s24
    s_sub_u32 s36, s36, 2
    s_lshl_b32 s37, s25, 4
    s_add_u32 s37, s37, s36
    s_lshl_b32 s37, s37, 2
    s_add_u32 s37, s37, s33
    s_lshl_b32 s37, s37, 5
    s_add_u32 s37, s37, s26
    s_add_u32 s37, s37, 0xe00000
    s_lshl_b32 s38, s25, 1
    s_add_u32 s38, s38, s33
    s_lshl_b32 s38, s38, 4
    s_add_u32 s38, s38, s36
    s_lshl_b32 s38, s38, 14
    s_add_u32 s38, s38, s26
    s_mul_i32 s33, s33, 49152
    s_lshl_b32 s32, s32, 14
    s_add_u32 s39, s32, s33
    v_and_b32 v48, 8, v252
    v_lshlrev_b32 v48, 3, v48
    v_mov_b32_e64 v154, s88
    s_mov_b64 exec, 1
    s_waitcnt vmcnt(0)
    buffer_store_dword v154, v253, s[20:23], s30 offen sc1
    s_mov_b64 exec, -1
sk_3:
    s_waitcnt lgkmcnt(0)
    s_barrier
    s_cmp_lg_u32 s100, 2
    s_cbranch_scc1 sk_4
    s_lshr_b32 s34, s73, 5
    s_cmp_lg_u32 s34, s99
    s_cbranch_scc1 sk_5
    s_lshl_b32 s34, s98, 7
    s_lshr_b32 vcc_lo, s24, 1
    s_lshl_b32 vcc_lo, vcc_lo, 11
    s_add_u32 vcc_lo, vcc_lo, s34
    s_add_u32 s34, vcc_lo, 0xdc4000
    s_and_b32 s32, s73, 31
    v_and_b32 v0, 31, v252
    v_cmp_eq_u32 vcc, s32, v0
    v_lshrrev_b32 v0, 5, v252
    v_lshlrev_b32 v0, 3, v0
    s_mov_b64 exec, vcc
    buffer_load_dwordx2 v[208:209], v0, s[20:23], s34 offen offset:0 sc1
    buffer_load_dwordx2 v[210:211], v0, s[20:23], s34 offen offset:16 sc1
    buffer_load_dwordx2 v[212:213], v0, s[20:23], s34 offen offset:32 sc1
    buffer_load_dwordx2 v[214:215], v0, s[20:23], s34 offen offset:48 sc1
    buffer_load_dwordx2 v[216:217], v0, s[20:23], s34 offen offset:64 sc1
    buffer_load_dwordx2 v[218:219], v0, s[20:23], s34 offen offset:80 sc1
    buffer_load_dwordx2 v[220:221], v0, s[20:23], s34 offen offset:96 sc1
    buffer_load_dwordx2 v[222:223], v0, s[20:23], s34 offen offset:112 sc1
    v_mov_b32_e64 v240, 1.0
    v_mov_b32 v241, 0
    s_mov_b64 exec, -1
sk_5:
    s_barrier
sk_4:
    ds_read_b128 v[4:7], v3
    ds_read_b128 v[8:11], v3 offset:1024
    ds_read_b128 v[112:115], v22 offset:0
    ds_read_b128 v[116:119], v22 offset:1024
    s_waitcnt lgkmcnt(0)
    v_mfma_f32_32x32x16_bf16 v[56:71], v[112:115], v[4:7], v[24:39]
    v_mfma_f32_32x32x16_bf16 v[56:71], v[116:119], v[8:11], v[56:71]
    ds_read_b128 v[104:107], v23 offset:4096
    ds_read_b128 v[124:127], v22 offset:3072
    ds_read_b128 v[108:111], v23 offset:5120
    ds_read_b128 v[120:123], v22 offset:2048
    s_cmp_eq_u32 s100, 2
    s_cbranch_scc1 sk_7
    s_and_b32 s32, s28, 1
    s_lshr_b32 s33, s28, 1
    s_add_u32 s36, s32, s24
    s_sub_u32 s36, s36, 2
    s_lshl_b32 s37, s25, 4
    s_add_u32 s37, s37, s36
    s_lshl_b32 s37, s37, 2
    s_add_u32 s37, s37, s33
    s_lshl_b32 s37, s37, 5
    s_add_u32 s37, s37, s26
    s_add_u32 s37, s37, 0xe00000
    s_lshl_b32 s38, s25, 1
    s_add_u32 s38, s38, s33
    s_lshl_b32 s38, s38, 4
    s_add_u32 s38, s38, s36
    s_lshl_b32 s38, s38, 14
    s_add_u32 s38, s38, s26
    s_mul_i32 s33, s33, 49152
    s_lshl_b32 s32, s32, 14
    s_add_u32 s39, s32, s33
    v_and_b32 v48, 8, v252
    v_lshlrev_b32 v48, 3, v48
    v_mov_b32_e64 v154, s88
    s_mov_b64 exec, 1
    s_waitcnt vmcnt(0)
    buffer_store_dword v154, v253, s[20:23], s30 offen sc1
    s_mov_b64 exec, -1
sk_7:
    s_nop 5
    v_max3_f32 v21, v56, v57, v58
    v_max3_f32 v152, v59, v60, v61
    v_max3_f32 v21, v21, v62, v63
    v_max3_f32 v152, v152, v64, v65
    v_max3_f32 v21, v21, v66, v67
    v_max3_f32 v152, v152, v68, v69
    v_max3_f32 v21, v21, v70, v71
    v_max_f32 v21, v21, v152
    v_mov_b32 v152, v21
    s_nop 1
    v_permlane32_swap_b32 v21, v152
    v_max_f32 v21, v21, v152
    v_sub_f32 v24, 0, v21
    v_sub_f32 v25, 0, v21
    v_sub_f32 v26, 0, v21
    v_sub_f32 v27, 0, v21
    v_sub_f32 v28, 0, v21
    v_sub_f32 v29, 0, v21
    v_sub_f32 v30, 0, v21
    v_sub_f32 v31, 0, v21
    v_sub_f32 v32, 0, v21
    v_sub_f32 v33, 0, v21
    v_sub_f32 v34, 0, v21
    v_sub_f32 v35, 0, v21
    v_sub_f32 v36, 0, v21
    v_sub_f32 v37, 0, v21
    v_sub_f32 v38, 0, v21
    v_sub_f32 v39, 0, v21
    s_branch a0_6_go
    s_nop 0
a0_6_mid:
    s_cmp_ge_u32 s76, 8
    s_cselect_b32 s33, 0, -1
    v_not_b32 v12, v12
    v_or_b32 v12, s33, v12
    v_not_b32 v13, v13
    v_or_b32 v13, s33, v13
    v_not_b32 v14, v14
    v_or_b32 v14, s33, v14
    v_not_b32 v15, v15
    v_or_b32 v15, s33, v15
    v_not_b32 v16, v16
    v_or_b32 v16, s33, v16
    v_not_b32 v17, v17
    v_or_b32 v17, s33, v17
    v_not_b32 v18, v18
    v_or_b32 v18, s33, v18
    v_not_b32 v19, v19
    v_or_b32 v19, s33, v19
    s_and_b32 s32, s76, 3
    s_cmp_ge_u32 s76, 8
    s_cselect_b32 s32, s32, 4
    s_sub_u32 s74, 8, s32
    s_lshl_b32 s32, s32, 12
    s_add_u32 s32, s32, 65536
    v_add_u32 v22, s32, v253
    v_add_u32 v23, s32, v253
    s_cmp_eq_u32 s26, 0
    s_cselect_b32 s75, 2, 1
    s_cmp_lt_i32 s36, 0
    s_cbranch_scc1 sk_8
    s_mov_b32 s78, s27
pl_9:
    buffer_load_dword v49, v48, s[20:23], s37 offen sc1
    s_waitcnt vmcnt(0)
pc_10:
    v_cmp_ne_u32 vcc, s88, v49
    s_cbranch_vccz pd_11
    s_sub_u32 s78, s78, 1
    s_cmp_lg_u32 s78, 0
    s_cbranch_scc1 pl_9
    s_mov_b32 s27, 1
pd_11:
    s_mov_b32 s36, -1
    s_add_u32 m0, s39, 65536
    s_add_u32 s32, s38, 0
    buffer_load_dwordx4 v253, s[20:23], s32 offen offset:0 sc1 lds
    buffer_load_dwordx4 v253, s[20:23], s32 offen offset:1024 sc1 lds
    buffer_load_dwordx4 v253, s[20:23], s32 offen offset:2048 sc1 lds
    buffer_load_dwordx4 v253, s[20:23], s32 offen offset:3072 sc1 lds
    s_add_u32 m0, s39, 69632
    s_add_u32 s32, s38, 4096
    buffer_load_dwordx4 v253, s[20:23], s32 offen offset:0 sc1 lds
    buffer_load_dwordx4 v253, s[20:23], s32 offen offset:1024 sc1 lds
    buffer_load_dwordx4 v253, s[20:23], s32 offen offset:2048 sc1 lds
    buffer_load_dwordx4 v253, s[20:23], s32 offen offset:3072 sc1 lds
    s_add_u32 m0, s39, 73728
    s_add_u32 s32, s38, 8192
    buffer_load_dwordx4 v253, s[20:23], s32 offen offset:0 sc1 lds
    buffer_load_dwordx4 v253, s[20:23], s32 offen offset:1024 sc1 lds
    buffer_load_dwordx4 v253, s[20:23], s32 offen offset:2048 sc1 lds
    buffer_load_dwordx4 v253, s[20:23], s32 offen offset:3072 sc1 lds
    s_add_u32 m0, s39, 77824
    s_add_u32 s32, s38, 12288
    buffer_load_dwordx4 v253, s[20:23], s32 offen offset:0 sc1 lds
    buffer_load_dwordx4 v253, s[20:23], s32 offen offset:1024 sc1 lds
    buffer_load_dwordx4 v253, s[20:23], s32 offen offset:2048 sc1 lds
    buffer_load_dwordx4 v253, s[20:23], s32 offen offset:3072 sc1 lds
sk_8:
    s_cmp_eq_u32 s100, 1
    s_cselect_b32 s32, 0, s28
    s_cmp_ge_u32 s32, 2
    s_cbranch_scc1 sk_12
    s_waitcnt vmcnt(0)
sk_12:
    s_barrier
    s_cmp_lg_u32 s100, 1
    s_cbranch_scc1 sk_13
    s_barrier
sk_13:
    s_cmp_lt_u32 s76, 4
    s_cbranch_scc1 a0_6_none
    ds_read_b128 v[112:115], v22 offset:0
    ds_read_b128 v[116:119], v22 offset:1024
    ds_read_b128 v[104:107], v23 offset:4096
    ds_read_b128 v[124:127], v22 offset:3072
    ds_read_b128 v[108:111], v23 offset:5120
    ds_read_b128 v[120:123], v22 offset:2048
    s_waitcnt lgkmcnt(4)
a0_6_go:
    s_nop 0
    v_mfma_f32_32x32x16_bf16 v[56:71], v[112:115], v[4:7], v[24:39]
    v_mfma_f32_32x32x16_bf16 v[56:71], v[116:119], v[8:11], v[56:71]
    s_waitcnt lgkmcnt(3)
    v_mfma_f32_32x32x16_bf16 v[72:87], v[104:107], v[4:7], v[24:39]
    ds_read_b128 v[104:107], v23 offset:8192
    s_nop 8
    v_exp_f32 v56, v56
    v_exp_f32 v57, v57
    v_exp_f32 v58, v58
    ds_read_b128 v[128:131], v23 offset:7168
    v_exp_f32 v59, v59
    v_exp_f32 v60, v60
    v_exp_f32 v61, v61
    s_waitcnt lgkmcnt(2)
    v_mfma_f32_32x32x16_bf16 v[72:87], v[108:111], v[8:11], v[72:87]
    ds_read_b128 v[108:111], v23 offset:9216
    v_exp_f32 v62, v62
    v_exp_f32 v63, v63
    v_cvt_pk_bf16_f32 v136, v56, v57
    v_cvt_pk_bf16_f32 v137, v58, v59
    v_cvt_pk_bf16_f32 v138, v60, v61
    v_cvt_pk_bf16_f32 v139, v62, v63
    v_and_b32 v136, v136, v12
    v_and_b32 v137, v137, v13
    v_and_b32 v138, v138, v14
    v_and_b32 v139, v139, v15
    v_exp_f32 v64, v64
    v_exp_f32 v65, v65
    v_mfma_f32_32x32x16_bf16 v[88:103], v[120:123], v[136:139], v[88:103]
    ds_read_b128 v[120:123], v23 offset:6144
    s_cmp_eq_u32 s75, 0
    s_cbranch_scc1 sk_14
    s_add_u32 s96, s25, 0
    s_and_b32 s96, s96, 15
    s_lshl_b32 s96, s96, 17
    s_add_u32 m0, s101, 0
    s_nop 0
    buffer_load_dwordx4 v243, s[8:11], s96 offen lds
sk_14:
    v_exp_f32 v66, v66
    v_exp_f32 v67, v67
    v_exp_f32 v68, v68
    v_exp_f32_e64 v69, v69
    v_mfma_f32_16x16x32_bf16 v[44:47], v[40:43], v[136:139], v[44:47]
    v_exp_f32 v70, v70
    v_exp_f32 v71, v71
    v_cvt_pk_bf16_f32 v140, v64, v65
    v_cvt_pk_bf16_f32 v141, v66, v67
    v_cvt_pk_bf16_f32 v142, v68, v69
    v_cvt_pk_bf16_f32 v143, v70, v71
    v_and_b32 v140, v140, v16
    v_and_b32 v141, v141, v17
    v_and_b32_e64 v142, v142, v18
    v_and_b32 v143, v143, v19
    s_cmp_eq_u32 s75, 0
    s_cbranch_scc1 sk_15
    s_waitcnt vmcnt(1)
    s_barrier
    s_add_u32 s96, s25, 12
    s_and_b32 s96, s96, 15
    s_lshl_b32 s96, s96, 17
    s_add_u32 m0, s101, 49152
    s_nop 0
    buffer_load_dwordx4 v243, s[8:11], s96 offen lds
sk_15:
    s_cmp_eq_u32 s74, 1
    s_cbranch_scc1 a0_6_e0
    s_cmp_eq_u32 s74, 2
    s_cbranch_scc1 a0_6_t1
    s_waitcnt lgkmcnt(3)
    v_mfma_f32_32x32x16_bf16 v[56:71], v[104:107], v[4:7], v[24:39]
    ds_read_b128 v[104:107], v23 offset:12288
    v_exp_f32 v72, v72
    v_exp_f32 v73, v73
    v_exp_f32_e64 v74, v74
    v_mfma_f32_32x32x16_bf16 v[88:103], v[124:127], v[140:143], v[88:103]
    ds_read_b128 v[124:127], v23 offset:11264
    v_exp_f32 v75, v75
    v_exp_f32 v76, v76
    v_exp_f32 v77, v77
    s_waitcnt lgkmcnt(2)
    v_mfma_f32_32x32x16_bf16 v[56:71], v[108:111], v[8:11], v[56:71]
    ds_read_b128 v[108:111], v23 offset:13312
    v_exp_f32 v78, v78
    v_exp_f32 v79, v79
    v_cvt_pk_bf16_f32 v136, v72, v73
    v_cvt_pk_bf16_f32 v137, v74, v75
    v_mfma_f32_16x16x32_bf16 v[44:47], v[40:43], v[140:143], v[44:47]
    v_cvt_pk_bf16_f32 v138, v76, v77
    v_cvt_pk_bf16_f32 v139, v78, v79
    v_exp_f32 v80, v80
    v_exp_f32 v81, v81
    v_mfma_f32_32x32x16_bf16 v[88:103], v[120:123], v[136:139], v[88:103]
    ds_read_b128 v[120:123], v23 offset:10240
    s_cmp_eq_u32 s75, 0
    s_cbranch_scc1 sk_16
    s_add_u32 s96, s25, 13
    s_and_b32 s96, s96, 15
    s_lshl_b32 s96, s96, 17
    s_add_u32 m0, s101, 53248
    s_nop 0
    buffer_load_dwordx4 v243, s[8:11], s96 offen lds
sk_16:
    v_exp_f32 v82, v82
    v_exp_f32 v83, v83
    v_exp_f32 v84, v84
    v_exp_f32 v85, v85
    v_mfma_f32_16x16x32_bf16 v[44:47], v[40:43], v[136:139], v[44:47]
    v_exp_f32 v86, v86
    v_exp_f32 v87, v87
    v_cvt_pk_bf16_f32 v140, v80, v81
    v_cvt_pk_bf16_f32 v141, v82, v83
    v_cvt_pk_bf16_f32 v142, v84, v85
    v_cvt_pk_bf16_f32 v143, v86, v87
    s_cmp_eq_u32 s75, 0
    s_cbranch_scc1 sk_17
    s_add_u32 s96, s25, 14
    s_and_b32 s96, s96, 15
    s_lshl_b32 s96, s96, 17
    s_add_u32 m0, s101, 57344
    s_nop 0
    buffer_load_dwordx4 v243, s[8:11], s96 offen lds
sk_17:
    s_cmp_eq_u32 s74, 3
    s_cbranch_scc1 a0_6_t0
    s_waitcnt lgkmcnt(3)
    v_mfma_f32_32x32x16_bf16 v[72:87], v[104:107], v[4:7], v[24:39]
    ds_read_b128 v[104:107], v23 offset:16384
    v_exp_f32 v56, v56
    v_exp_f32 v57, v57
    v_exp_f32 v58, v58
    v_mfma_f32_32x32x16_bf16 v[88:103], v[128:131], v[140:143], v[88:103]
    ds_read_b128 v[128:131], v23 offset:15360
    v_exp_f32 v59, v59
    v_exp_f32 v60, v60
    v_exp_f32 v61, v61
    s_waitcnt lgkmcnt(2)
    v_mfma_f32_32x32x16_bf16 v[72:87], v[108:111], v[8:11], v[72:87]
    ds_read_b128 v[108:111], v23 offset:17408
    v_exp_f32 v62, v62
    v_exp_f32 v63, v63
    v_cvt_pk_bf16_f32 v136, v56, v57
    v_cvt_pk_bf16_f32 v137, v58, v59
    v_mfma_f32_16x16x32_bf16 v[44:47], v[40:43], v[140:143], v[44:47]
    v_cvt_pk_bf16_f32 v138, v60, v61
    v_cvt_pk_bf16_f32 v139, v62, v63
    v_exp_f32 v64, v64
    v_exp_f32 v65, v65
    v_mfma_f32_32x32x16_bf16 v[88:103], v[120:123], v[136:139], v[88:103]
    ds_read_b128 v[120:123], v23 offset:14336
    s_cmp_eq_u32 s75, 0
    s_cbranch_scc1 sk_18
    s_add_u32 s96, s25, 15
    s_and_b32 s96, s96, 15
    s_lshl_b32 s96, s96, 17
    s_add_u32 m0, s101, 61440
    s_nop 0
    buffer_load_dwordx4 v243, s[8:11], s96 offen lds
sk_18:
    v_exp_f32 v66, v66
    v_exp_f32 v67, v67
    v_exp_f32 v68, v68
    v_exp_f32 v69, v69
    v_mfma_f32_16x16x32_bf16 v[44:47], v[40:43], v[136:139], v[44:47]
    v_exp_f32 v70, v70
    v_exp_f32 v71, v71
    v_cvt_pk_bf16_f32 v140, v64, v65
    v_cvt_pk_bf16_f32 v141, v66, v67
    v_cvt_pk_bf16_f32 v142, v68, v69
    v_cvt_pk_bf16_f32 v143, v70, v71
    s_cmp_eq_u32 s74, 4
    s_cbranch_scc1 a0_6_t1
    s_waitcnt lgkmcnt(3)
    v_mfma_f32_32x32x16_bf16 v[56:71], v[104:107], v[4:7], v[24:39]
    ds_read_b128 v[104:107], v23 offset:20480
    v_exp_f32 v72, v72
    v_exp_f32 v73, v73
    v_exp_f32 v74, v74
    v_mfma_f32_32x32x16_bf16 v[88:103], v[124:127], v[140:143], v[88:103]
    ds_read_b128 v[124:127], v23 offset:19456
    v_exp_f32 v75, v75
    v_exp_f32 v76, v76
    v_exp_f32 v77, v77
    s_waitcnt lgkmcnt(2)
    v_mfma_f32_32x32x16_bf16 v[56:71], v[108:111], v[8:11], v[56:71]
    ds_read_b128 v[108:111], v23 offset:21504
    v_exp_f32 v78, v78
    v_exp_f32 v79, v79
    v_cvt_pk_bf16_f32 v136, v72, v73
    v_cvt_pk_bf16_f32 v137, v74, v75
    v_mfma_f32_16x16x32_bf16 v[44:47], v[40:43], v[140:143], v[44:47]
    v_cvt_pk_bf16_f32 v138, v76, v77
    v_cvt_pk_bf16_f32 v139, v78, v79
    v_exp_f32 v80, v80
    v_exp_f32 v81, v81
    v_mfma_f32_32x32x16_bf16 v[88:103], v[120:123], v[136:139], v[88:103]
    ds_read_b128 v[120:123], v23 offset:18432
    v_exp_f32 v82, v82
    v_exp_f32 v83, v83
    v_exp_f32 v84, v84
    v_exp_f32 v85, v85
    v_mfma_f32_16x16x32_bf16 v[44:47], v[40:43], v[136:139], v[44:47]
    v_exp_f32 v86, v86
    v_exp_f32 v87, v87
    v_cvt_pk_bf16_f32 v140, v80, v81
    v_cvt_pk_bf16_f32 v141, v82, v83
    v_cvt_pk_bf16_f32 v142, v84, v85
    v_cvt_pk_bf16_f32 v143, v86, v87
    s_cmp_eq_u32 s74, 5
    s_cbranch_scc1 a0_6_t0
    s_waitcnt lgkmcnt(3)
    v_mfma_f32_32x32x16_bf16 v[72:87], v[104:107], v[4:7], v[24:39]
    ds_read_b128 v[104:107], v23 offset:24576
    v_exp_f32 v56, v56
    v_exp_f32 v57, v57
    v_exp_f32 v58, v58
    v_mfma_f32_32x32x16_bf16 v[88:103], v[128:131], v[140:143], v[88:103]
    ds_read_b128 v[128:131], v23 offset:23552
    v_exp_f32 v59, v59
    v_exp_f32 v60, v60
    v_exp_f32 v61, v61
    s_waitcnt lgkmcnt(2)
    v_mfma_f32_32x32x16_bf16 v[72:87], v[108:111], v[8:11], v[72:87]
    ds_read_b128 v[108:111], v23 offset:25600
    v_exp_f32 v62, v62
    v_exp_f32 v63, v63
    v_cvt_pk_bf16_f32 v136, v56, v57
    v_cvt_pk_bf16_f32 v137, v58, v59
    v_mfma_f32_16x16x32_bf16 v[44:47], v[40:43], v[140:143], v[44:47]
    v_cvt_pk_bf16_f32 v138, v60, v61
    v_cvt_pk_bf16_f32 v139, v62, v63
    v_exp_f32 v64, v64
    v_exp_f32 v65, v65
    v_mfma_f32_32x32x16_bf16 v[88:103], v[120:123], v[136:139], v[88:103]
    ds_read_b128 v[120:123], v23 offset:22528
    v_exp_f32 v66, v66
    v_exp_f32 v67, v67
    v_exp_f32 v68, v68
    v_exp_f32 v69, v69
    v_mfma_f32_16x16x32_bf16 v[44:47], v[40:43], v[136:139], v[44:47]
    v_exp_f32 v70, v70
    v_exp_f32 v71, v71
    v_cvt_pk_bf16_f32 v140, v64, v65
    v_cvt_pk_bf16_f32 v141, v66, v67
    v_cvt_pk_bf16_f32 v142, v68, v69
    v_cvt_pk_bf16_f32 v143, v70, v71
    s_cmp_eq_u32 s74, 6
    s_cbranch_scc1 a0_6_t1
    s_waitcnt lgkmcnt(3)
    v_mfma_f32_32x32x16_bf16 v[56:71], v[104:107], v[4:7], v[24:39]
    ds_read_b128 v[104:107], v23 offset:28672
    v_exp_f32 v72, v72
    v_exp_f32 v73, v73
    v_exp_f32 v74, v74
    v_mfma_f32_32x32x16_bf16 v[88:103], v[124:127], v[140:143], v[88:103]
    ds_read_b128 v[124:127], v23 offset:27648
    v_exp_f32 v75, v75
    v_exp_f32 v76, v76
    v_exp_f32 v77, v77
    s_waitcnt lgkmcnt(2)
    v_mfma_f32_32x32x16_bf16 v[56:71], v[108:111], v[8:11], v[56:71]
    ds_read_b128 v[108:111], v23 offset:29696
    v_exp_f32 v78, v78
    v_exp_f32 v79, v79
    v_cvt_pk_bf16_f32 v136, v72, v73
    v_cvt_pk_bf16_f32 v137, v74, v75
    v_mfma_f32_16x16x32_bf16 v[44:47], v[40:43], v[140:143], v[44:47]
    v_cvt_pk_bf16_f32 v138, v76, v77
    v_cvt_pk_bf16_f32 v139, v78, v79
    v_exp_f32 v80, v80
    v_exp_f32 v81, v81
    v_mfma_f32_32x32x16_bf16 v[88:103], v[120:123], v[136:139], v[88:103]
    ds_read_b128 v[120:123], v23 offset:26624
    v_exp_f32 v82, v82
    v_exp_f32 v83, v83
    v_exp_f32 v84, v84
    v_exp_f32 v85, v85
    v_mfma_f32_16x16x32_bf16 v[44:47], v[40:43], v[136:139], v[44:47]
    v_exp_f32 v86, v86
    v_exp_f32 v87, v87
    v_cvt_pk_bf16_f32 v140, v80, v81
    v_cvt_pk_bf16_f32 v141, v82, v83
    v_cvt_pk_bf16_f32 v142, v84, v85
    v_cvt_pk_bf16_f32 v143, v86, v87
    s_cmp_eq_u32 s74, 7
    s_cbranch_scc1 a0_6_t0
    s_waitcnt lgkmcnt(3)
    v_mfma_f32_32x32x16_bf16 v[72:87], v[104:107], v[4:7], v[24:39]
    ds_read_b128 v[104:107], v23 offset:24576
    v_exp_f32 v56, v56
    v_exp_f32 v57, v57
    v_exp_f32 v58, v58
    v_mfma_f32_32x32x16_bf16 v[88:103], v[128:131], v[140:143], v[88:103]
    ds_read_b128 v[128:131], v23 offset:31744
    v_exp_f32 v59, v59
    v_exp_f32 v60, v60
    v_exp_f32 v61, v61
    s_waitcnt lgkmcnt(2)
    v_mfma_f32_32x32x16_bf16 v[72:87], v[108:111], v[8:11], v[72:87]
    ds_read_b128 v[108:111], v23 offset:25600
    v_exp_f32 v62, v62
    v_exp_f32 v63, v63
    v_cvt_pk_bf16_f32 v136, v56, v57
    v_cvt_pk_bf16_f32 v137, v58, v59
    v_mfma_f32_16x16x32_bf16 v[44:47], v[40:43], v[140:143], v[44:47]
    v_cvt_pk_bf16_f32 v138, v60, v61
    v_cvt_pk_bf16_f32 v139, v62, v63
    v_exp_f32 v64, v64
    v_exp_f32 v65, v65
    v_mfma_f32_32x32x16_bf16 v[88:103], v[120:123], v[136:139], v[88:103]
    ds_read_b128 v[120:123], v23 offset:30720
    v_exp_f32 v66, v66
    v_exp_f32 v67, v67
    v_exp_f32 v68, v68
    v_exp_f32 v69, v69
    v_mfma_f32_16x16x32_bf16 v[44:47], v[40:43], v[136:139], v[44:47]
    v_exp_f32 v70, v70
    v_exp_f32 v71, v71
    v_cvt_pk_bf16_f32 v140, v64, v65
    v_cvt_pk_bf16_f32 v141, v66, v67
    v_cvt_pk_bf16_f32 v142, v68, v69
    v_cvt_pk_bf16_f32 v143, v70, v71
a0_6_t1:
    v_exp_f32 v72, v72
    v_exp_f32 v73, v73
    v_exp_f32_e64 v74, v74
    v_mfma_f32_32x32x16_bf16 v[88:103], v[124:127], v[140:143], v[88:103]
    v_exp_f32 v75, v75
    v_exp_f32 v76, v76
    v_exp_f32 v77, v77
    v_exp_f32 v78, v78
    v_exp_f32_e64 v79, v79
    v_cvt_pk_bf16_f32 v136, v72, v73
    v_cvt_pk_bf16_f32 v137, v74, v75
    v_mfma_f32_16x16x32_bf16 v[44:47], v[40:43], v[140:143], v[44:47]
    v_cvt_pk_bf16_f32 v138, v76, v77
    v_cvt_pk_bf16_f32 v139, v78, v79
    v_exp_f32_e64 v80, v80
    v_exp_f32 v81, v81
    s_waitcnt lgkmcnt(0)
    v_mfma_f32_32x32x16_bf16 v[88:103], v[120:123], v[136:139], v[88:103]
    v_exp_f32 v82, v82
    v_exp_f32 v83, v83
    v_exp_f32 v84, v84
    v_exp_f32 v85, v85
    v_mfma_f32_16x16x32_bf16 v[44:47], v[40:43], v[136:139], v[44:47]
    v_exp_f32 v86, v86
    v_exp_f32 v87, v87
    v_cvt_pk_bf16_f32 v140, v80, v81
    v_cvt_pk_bf16_f32 v141, v82, v83
    v_cvt_pk_bf16_f32 v142, v84, v85
    v_cvt_pk_bf16_f32 v143, v86, v87
a0_6_e1:
    s_cmp_eq_u32 s75, 0
    s_nop 0
    v_mfma_f32_16x16x32_bf16 v[44:47], v[40:43], v[140:143], v[44:47]
    v_mfma_f32_32x32x16_bf16 v[88:103], v[128:131], v[140:143], v[88:103]
    s_cbranch_scc1 a0_6_mid
    s_branch a0_6_fin
    s_nop 0
a0_6_t0:
    v_exp_f32 v56, v56
    v_exp_f32 v57, v57
    v_exp_f32 v58, v58
    v_mfma_f32_32x32x16_bf16 v[88:103], v[128:131], v[140:143], v[88:103]
    v_exp_f32 v59, v59
    v_exp_f32 v60, v60
    v_exp_f32 v61, v61
    v_exp_f32 v62, v62
    v_exp_f32_e64 v63, v63
    v_cvt_pk_bf16_f32 v136, v56, v57
    v_cvt_pk_bf16_f32 v137, v58, v59
    v_mfma_f32_16x16x32_bf16 v[44:47], v[40:43], v[140:143], v[44:47]
    v_cvt_pk_bf16_f32 v138, v60, v61
    v_cvt_pk_bf16_f32 v139, v62, v63
    v_exp_f32_e64 v64, v64
    v_exp_f32 v65, v65
    s_waitcnt lgkmcnt(0)
    v_mfma_f32_32x32x16_bf16 v[88:103], v[120:123], v[136:139], v[88:103]
    v_exp_f32 v66, v66
    v_exp_f32 v67, v67
    v_exp_f32 v68, v68
    v_exp_f32 v69, v69
    v_mfma_f32_16x16x32_bf16 v[44:47], v[40:43], v[136:139], v[44:47]
    v_exp_f32 v70, v70
    v_exp_f32 v71, v71
    v_cvt_pk_bf16_f32 v140, v64, v65
    v_cvt_pk_bf16_f32 v141, v66, v67
    v_cvt_pk_bf16_f32 v142, v68, v69
    v_cvt_pk_bf16_f32 v143, v70, v71
a0_6_e0:
    s_cmp_eq_u32 s75, 0
    s_nop 0
    v_mfma_f32_16x16x32_bf16 v[44:47], v[40:43], v[140:143], v[44:47]
    v_mfma_f32_32x32x16_bf16 v[88:103], v[124:127], v[140:143], v[88:103]
    s_cbranch_scc1 a0_6_mid
    s_branch a0_6_fin
    s_nop 0
a0_6_none:
    s_add_u32 s96, s25, 0
    s_and_b32 s96, s96, 15
    s_lshl_b32 s96, s96, 17
    s_add_u32 m0, s101, 0
    s_nop 0
    buffer_load_dwordx4 v243, s[8:11], s96 offen lds
    s_waitcnt vmcnt(1)
    s_barrier
    s_add_u32 s96, s25, 12
    s_and_b32 s96, s96, 15
    s_lshl_b32 s96, s96, 17
    s_add_u32 m0, s101, 49152
    s_nop 0
    buffer_load_dwordx4 v243, s[8:11], s96 offen lds
    s_add_u32 s96, s25, 13
    s_and_b32 s96, s96, 15
    s_lshl_b32 s96, s96, 17
    s_add_u32 m0, s101, 53248
    s_nop 0
    buffer_load_dwordx4 v243, s[8:11], s96 offen lds
    s_add_u32 s96, s25, 14
    s_and_b32 s96, s96, 15
    s_lshl_b32 s96, s96, 17
    s_add_u32 m0, s101, 57344
    s_nop 0
    buffer_load_dwordx4 v243, s[8:11], s96 offen lds
    s_add_u32 s96, s25, 15
    s_and_b32 s96, s96, 15
    s_lshl_b32 s96, s96, 17
    s_add_u32 m0, s101, 61440
    s_nop 0
    buffer_load_dwordx4 v243, s[8:11], s96 offen lds
a0_6_fin:
    s_lshl_b32 s36, s76, 17
    s_lshr_b32 s33, s26, 8
    s_add_u32 s36, s36, s33
    s_add_u32 s36, s36, 0x2800000
    s_lshl_b32 s33, s25, 11
    s_add_u32 s33, s33, s36
    s_lshl_b32 s30, s24, 9
    s_and_b32 s31, s76, 3
    s_lshl_b32 s31, s31, 6
    s_add_u32 s30, s30, s31
    s_add_u32 s30, s30, s26
    s_add_u32 s30, s30, 0xdd2000
    s_lshl_b32 s31, s25, 2
    s_add_u32 s31, s31, s30
    v_cmp_ngt_f32 vcc, 0x5d800000, v44
    v_rcp_f32_e64 v22, v44
    s_cbranch_vccnz att_exact0
att_ret0:
    s_nop 3
    v_pk_mul_f32 v[88:89], v[88:89], v[22:23] op_sel_hi:[1,0]
    v_pk_mul_f32 v[90:91], v[90:91], v[22:23] op_sel_hi:[1,0]
    v_pk_mul_f32 v[92:93], v[92:93], v[22:23] op_sel_hi:[1,0]
    v_pk_mul_f32 v[94:95], v[94:95], v[22:23] op_sel_hi:[1,0]
    v_pk_mul_f32 v[96:97], v[96:97], v[22:23] op_sel_hi:[1,0]
    v_pk_mul_f32 v[98:99], v[98:99], v[22:23] op_sel_hi:[1,0]
    v_pk_mul_f32 v[100:101], v[100:101], v[22:23] op_sel_hi:[1,0]
    v_pk_mul_f32 v[102:103], v[102:103], v[22:23] op_sel_hi:[1,0]
    v_cvt_pk_bf16_f32 v88, v88, v89
    v_cvt_pk_bf16_f32 v89, v90, v91
    v_cvt_pk_bf16_f32 v90, v92, v93
    v_cvt_pk_bf16_f32 v91, v94, v95
    v_cvt_pk_bf16_f32 v92, v96, v97
    v_cvt_pk_bf16_f32 v93, v98, v99
    v_cvt_pk_bf16_f32 v94, v100, v101
    v_cvt_pk_bf16_f32 v95, v102, v103
    s_cmp_gt_u32 s77, s26
    s_cbranch_scc1 lc_19
    buffer_store_dwordx4 v[88:91], v253, s[20:23], s33 offen sc1
    buffer_store_dwordx4 v[92:95], v253, s[20:23], s33 offen offset:1024 sc1
    s_branch lc_20
    s_nop 0
lc_19:
    buffer_store_dwordx4 v[88:91], v253, s[20:23], s33 offen
    buffer_store_dwordx4 v[92:95], v253, s[20:23], s33 offen offset:1024
lc_20:
    v_bfe_u32 v33, v252, 2, 2
    v_lshrrev_b32_e64 v32, 5, v252
    v_lshl_add_u32 v34, v32, 3, v33
    v_lshlrev_b32 v34, 7, v34
    v_lshrrev_b32 v33, 1, v33
    v_lshl_add_u32 v34, v33, 6, v34
    v_bfe_u32 v33, v252, 4, 1
    v_lshl_add_u32 v34, v33, 5, v34
    v_and_b32_e64 v33, 3, v252
    v_lshl_add_u32 v56, v33, 3, v34
    v_xor_b32_e64 v57, 64, v56
    v_add_u32 v58, 0x10000, v56
    v_add_u32 v59, 0x10000, v57
    v_and_b32 v60, 15, v252
    v_lshlrev_b32 v60, 2, v60
    s_waitcnt vmcnt(2)
    s_and_b32 s35, s99, 3
    s_cmp_lg_u32 s35, 0
    s_cbranch_scc1 sk_21
    s_barrier
sk_21:
    v_lshlrev_b32 v0, 16, v208
    v_and_b32 v1, 0xffff0000, v208
    v_lshlrev_b32_e64 v2, 16, v209
    v_and_b32 v3, 0xffff0000, v209
    v_lshlrev_b32_e64 v4, 16, v210
    v_and_b32 v5, 0xffff0000, v210
    v_lshlrev_b32_e64 v6, 16, v211
    v_and_b32 v7, 0xffff0000, v211
    v_lshlrev_b32_e64 v8, 16, v212
    v_and_b32 v9, 0xffff0000, v212
    v_lshlrev_b32_e64 v10, 16, v213
    v_and_b32 v11, 0xffff0000, v213
    v_lshlrev_b32_e64 v12, 16, v214
    v_and_b32 v13, 0xffff0000, v214
    v_lshlrev_b32_e64 v14, 16, v215
    v_and_b32 v15, 0xffff0000, v215
    v_lshlrev_b32_e64 v16, 16, v216
    v_and_b32 v17, 0xffff0000, v216
    v_lshlrev_b32_e64 v18, 16, v217
    v_and_b32 v19, 0xffff0000, v217
    v_lshlrev_b32_e64 v20, 16, v218
    v_and_b32 v21, 0xffff0000, v218
    v_lshlrev_b32_e64 v22, 16, v219
    v_and_b32 v23, 0xffff0000, v219
    v_lshlrev_b32_e64 v24, 16, v220
    v_and_b32 v25, 0xffff0000, v220
    v_lshlrev_b32_e64 v26, 16, v221
    v_and_b32 v27, 0xffff0000, v221
    v_lshlrev_b32_e64 v28, 16, v222
    v_and_b32 v29, 0xffff0000, v222
    v_lshlrev_b32_e64 v30, 16, v223
    v_and_b32 v31, 0xffff0000, v223
    v_pk_fma_f32 v[0:1], v[0:1], v[240:241], v[240:241] op_sel:[0,0,1] op_sel_hi:[1,0,1]
    v_pk_fma_f32 v[2:3], v[2:3], v[240:241], v[240:241] op_sel:[0,0,1] op_sel_hi:[1,0,1]
    v_pk_fma_f32 v[4:5], v[4:5], v[240:241], v[240:241] op_sel:[0,0,1] op_sel_hi:[1,0,1]
    v_pk_fma_f32 v[6:7], v[6:7], v[240:241], v[240:241] op_sel:[0,0,1] op_sel_hi:[1,0,1]
    v_pk_fma_f32 v[8:9], v[8:9], v[240:241], v[240:241] op_sel:[0,0,1] op_sel_hi:[1,0,1]
    v_pk_fma_f32 v[10:11], v[10:11], v[240:241], v[240:241] op_sel:[0,0,1] op_sel_hi:[1,0,1]
    v_pk_fma_f32 v[12:13], v[12:13], v[240:241], v[240:241] op_sel:[0,0,1] op_sel_hi:[1,0,1]
    v_pk_fma_f32 v[14:15], v[14:15], v[240:241], v[240:241] op_sel:[0,0,1] op_sel_hi:[1,0,1]
    v_pk_fma_f32 v[16:17], v[16:17], v[240:241], v[240:241] op_sel:[0,0,1] op_sel_hi:[1,0,1]
    v_pk_fma_f32 v[18:19], v[18:19], v[240:241], v[240:241] op_sel:[0,0,1] op_sel_hi:[1,0,1]
    v_pk_fma_f32 v[20:21], v[20:21], v[240:241], v[240:241] op_sel:[0,0,1] op_sel_hi:[1,0,1]
    v_pk_fma_f32 v[22:23], v[22:23], v[240:241], v[240:241] op_sel:[0,0,1] op_sel_hi:[1,0,1]
    v_pk_fma_f32 v[24:25], v[24:25], v[240:241], v[240:241] op_sel:[0,0,1] op_sel_hi:[1,0,1]
    v_pk_fma_f32 v[26:27], v[26:27], v[240:241], v[240:241] op_sel:[0,0,1] op_sel_hi:[1,0,1]
    v_pk_fma_f32 v[28:29], v[28:29], v[240:241], v[240:241] op_sel:[0,0,1] op_sel_hi:[1,0,1]
    v_pk_fma_f32 v[30:31], v[30:31], v[240:241], v[240:241] op_sel:[0,0,1] op_sel_hi:[1,0,1]
    v_mov_b32_e64 v154, s88
    s_mov_b64 exec, 1
    s_waitcnt vmcnt(0)
    s_cmp_lg_u32 s77, 0
    s_cbranch_scc1 lc_22
    buffer_store_dword v154, v253, s[20:23], s31 offen sc1
    s_branch lc_23
lc_22:
    buffer_store_dword v154, v253, s[20:23], s31 offen
lc_23:
    s_mov_b64 exec, -1
    s_cmp_eq_u32 s35, 0
    s_cbranch_scc1 sk_24
    s_barrier
sk_24:
    s_add_u32 s96, s25, 0
    s_and_b32 s96, s96, 15
    s_lshl_b32 s96, s96, 17
    s_add_u32 s96, s96, 65536
    s_add_u32 m0, s101, 65536
    s_nop 0
    buffer_load_dwordx4 v243, s[8:11], s96 offen lds
    s_add_u32 s96, s25, 1
    s_and_b32 s96, s96, 15
    s_lshl_b32 s96, s96, 17
    s_add_u32 s96, s96, 65536
    s_add_u32 m0, s101, 69632
    s_nop 0
    buffer_load_dwordx4 v243, s[8:11], s96 offen lds
    s_add_u32 s96, s25, 2
    s_and_b32 s96, s96, 15
    s_lshl_b32 s96, s96, 17
    s_add_u32 s96, s96, 65536
    s_add_u32 m0, s101, 73728
    s_nop 0
    buffer_load_dwordx4 v243, s[8:11], s96 offen lds
    s_add_u32 s96, s25, 3
    s_and_b32 s96, s96, 15
    s_lshl_b32 s96, s96, 17
    s_add_u32 s96, s96, 65536
    s_add_u32 m0, s101, 77824
    s_nop 0
    buffer_load_dwordx4 v243, s[8:11], s96 offen lds
    s_add_u32 s96, s25, 4
    s_and_b32 s96, s96, 15
    s_lshl_b32 s96, s96, 17
    s_add_u32 s96, s96, 65536
    s_add_u32 m0, s101, 81920
    s_nop 0
    buffer_load_dwordx4 v243, s[8:11], s96 offen lds
    s_add_u32 s96, s25, 5
    s_and_b32 s96, s96, 15
    s_lshl_b32 s96, s96, 17
    s_add_u32 s96, s96, 65536
    s_add_u32 m0, s101, 86016
    s_nop 0
    buffer_load_dwordx4 v243, s[8:11], s96 offen lds
    s_add_u32 s96, s25, 6
    s_and_b32 s96, s96, 15
    s_lshl_b32 s96, s96, 17
    s_add_u32 s96, s96, 65536
    s_add_u32 m0, s101, 90112
    s_nop 0
    buffer_load_dwordx4 v243, s[8:11], s96 offen lds
    s_add_u32 s96, s25, 7
    s_and_b32 s96, s96, 15
    s_lshl_b32 s96, s96, 17
    s_add_u32 s96, s96, 65536
    s_add_u32 m0, s101, 94208
    s_nop 0
    buffer_load_dwordx4 v243, s[8:11], s96 offen lds
    s_add_u32 s96, s25, 8
    s_and_b32 s96, s96, 15
    s_lshl_b32 s96, s96, 17
    s_add_u32 s96, s96, 65536
    s_add_u32 m0, s101, 98304
    s_nop 0
    buffer_load_dwordx4 v243, s[8:11], s96 offen lds
    s_add_u32 s96, s25, 9
    s_and_b32 s96, s96, 15
    s_lshl_b32 s96, s96, 17
    s_add_u32 s96, s96, 65536
    s_add_u32 m0, s101, 102400
    s_nop 0
    buffer_load_dwordx4 v243, s[8:11], s96 offen lds
    s_add_u32 s96, s25, 10
    s_and_b32 s96, s96, 15
    s_lshl_b32 s96, s96, 17
    s_add_u32 s96, s96, 65536
    s_add_u32 m0, s101, 106496
    s_nop 0
    buffer_load_dwordx4 v243, s[8:11], s96 offen lds
    s_add_u32 s96, s25, 11
    s_and_b32 s96, s96, 15
    s_lshl_b32 s96, s96, 17
    s_add_u32 s96, s96, 65536
    s_add_u32 m0, s101, 110592
    s_nop 0
    buffer_load_dwordx4 v243, s[8:11], s96 offen lds
    v_bfe_u32 v100, v252, 4, 1
    v_lshlrev_b32 v100, 11, v100
    v_lshrrev_b32_e64 v101, 5, v252
    v_lshl_add_u32 v100, v101, 8, v100
    v_and_b32 v101, 15, v252
    v_lshl_add_u32 v100, v101, 4, v100
    s_lshl_b32 s34, s28, 12
    s_add_u32 s34, s34, 147456
    v_add_u32 v101, s34, v100
    s_lshl_b32 s37, s25, 11
    ds_read_b64_tr_b16 v[32:33], v56 offset:0
    ds_read_b64_tr_b16 v[34:35], v56 offset:512
    ds_read_b64_tr_b16 v[36:37], v57 offset:0
    ds_read_b64_tr_b16 v[38:39], v57 offset:512
    ds_read_b64_tr_b16 v[40:41], v56 offset:2048
    ds_read_b64_tr_b16 v[42:43], v56 offset:2560
    ds_read_b64_tr_b16 v[44:45], v57 offset:2048
    ds_read_b64_tr_b16 v[46:47], v57 offset:2560
    s_mov_b32 s78, s27
pl_25:
    buffer_load_dword v61, v60, s[20:23], s30 offen offset:0 sc1
    s_waitcnt vmcnt(0)
pc_26:
    v_cmp_ne_u32_e64 vcc, s88, v61
    s_cbranch_vccz pd_27
    s_sub_u32 s78, s78, 1
    s_cmp_lg_u32 s78, 0
    s_cbranch_scc1 pl_25
    s_mov_b32 s27, 1
pd_27:
    s_add_u32 s38, s36, s37
    buffer_load_dwordx4 v[104:107], v253, s[20:23], s38 offen offset:0 sc1
    s_add_u32 s37, s37, 2048
    s_and_b32 s37, s37, 0x7800
    buffer_load_dwordx4 v[108:111], v253, s[20:23], s38 offen offset:1024 sc1
    s_add_u32 s38, s36, s37
    buffer_load_dwordx4 v[112:115], v253, s[20:23], s38 offen offset:0 sc1
    s_add_u32 s37, s37, 2048
    s_and_b32 s37, s37, 0x7800
    buffer_load_dwordx4 v[116:119], v253, s[20:23], s38 offen offset:1024 sc1
    s_add_u32 s38, s36, s37
    buffer_load_dwordx4 v[120:123], v253, s[20:23], s38 offen offset:0 sc1
    s_add_u32 s37, s37, 2048
    s_and_b32 s37, s37, 0x7800
    buffer_load_dwordx4 v[124:127], v253, s[20:23], s38 offen offset:1024 sc1
    s_add_u32 s38, s36, s37
    buffer_load_dwordx4 v[128:131], v253, s[20:23], s38 offen offset:0 sc1
    s_add_u32 s37, s37, 2048
    s_and_b32 s37, s37, 0x7800
    buffer_load_dwordx4 v[132:135], v253, s[20:23], s38 offen offset:1024 sc1
    s_waitcnt vmcnt(7) lgkmcnt(4)
    v_mfma_f32_32x32x16_bf16 v[0:15], v[32:35], v[104:107], v[0:15]
    s_add_u32 s38, s36, s37
    buffer_load_dwordx4 v[136:139], v253, s[20:23], s38 offen offset:0 sc1
    ds_read_b64_tr_b16 v[48:49], v56 offset:4096
    ds_read_b64_tr_b16 v[50:51], v56 offset:4608
    v_mfma_f32_32x32x16_bf16 v[16:31], v[36:39], v[104:107], v[16:31]
    ds_read_b64_tr_b16 v[52:53], v57 offset:4096
    ds_read_b64_tr_b16 v[54:55], v57 offset:4608
    s_waitcnt vmcnt(7) lgkmcnt(4)
    v_mfma_f32_32x32x16_bf16 v[0:15], v[40:43], v[108:111], v[0:15]
    s_add_u32 s37, s37, 2048
    s_and_b32 s37, s37, 0x7800
    buffer_load_dwordx4 v[104:107], v253, s[20:23], s38 offen offset:1024 sc1
    ds_read_b64_tr_b16 v[32:33], v56 offset:6144
    ds_read_b64_tr_b16 v[34:35], v56 offset:6656
    v_mfma_f32_32x32x16_bf16 v[16:31], v[44:47], v[108:111], v[16:31]
    ds_read_b64_tr_b16 v[36:37], v57 offset:6144
    ds_read_b64_tr_b16 v[38:39], v57 offset:6656
    s_waitcnt vmcnt(7) lgkmcnt(4)
    v_mfma_f32_32x32x16_bf16 v[0:15], v[48:51], v[112:115], v[0:15]
    s_add_u32 s38, s36, s37
    buffer_load_dwordx4 v[108:111], v253, s[20:23], s38 offen offset:0 sc1
    ds_read_b64_tr_b16 v[40:41], v56 offset:8192
    ds_read_b64_tr_b16 v[42:43], v56 offset:8704
    v_mfma_f32_32x32x16_bf16 v[16:31], v[52:55], v[112:115], v[16:31]
    ds_read_b64_tr_b16 v[44:45], v57 offset:8192
    ds_read_b64_tr_b16 v[46:47], v57 offset:8704
    s_waitcnt vmcnt(7) lgkmcnt(4)
    v_mfma_f32_32x32x16_bf16 v[0:15], v[32:35], v[116:119], v[0:15]
    s_add_u32 s37, s37, 2048
    s_and_b32 s37, s37, 0x7800
    buffer_load_dwordx4 v[112:115], v253, s[20:23], s38 offen offset:1024 sc1
    ds_read_b64_tr_b16 v[48:49], v56 offset:10240
    ds_read_b64_tr_b16 v[50:51], v56 offset:10752
    v_mfma_f32_32x32x16_bf16 v[16:31], v[36:39], v[116:119], v[16:31]
    ds_read_b64_tr_b16 v[52:53], v57 offset:10240
    ds_read_b64_tr_b16 v[54:55], v57 offset:10752
    s_waitcnt vmcnt(7) lgkmcnt(4)
    v_mfma_f32_32x32x16_bf16 v[0:15], v[40:43], v[120:123], v[0:15]
    s_add_u32 s38, s36, s37
    buffer_load_dwordx4 v[116:119], v253, s[20:23], s38 offen offset:0 sc1
    ds_read_b64_tr_b16 v[32:33], v56 offset:12288
    ds_read_b64_tr_b16 v[34:35], v56 offset:12800
    v_mfma_f32_32x32x16_bf16 v[16:31], v[44:47], v[120:123], v[16:31]
    ds_read_b64_tr_b16 v[36:37], v57 offset:12288
    ds_read_b64_tr_b16 v[38:39], v57 offset:12800
    s_waitcnt vmcnt(7) lgkmcnt(4)
    v_mfma_f32_32x32x16_bf16 v[0:15], v[48:51], v[124:127], v[0:15]
    s_add_u32 s37, s37, 2048
    s_and_b32 s37, s37, 0x7800
    buffer_load_dwordx4 v[120:123], v253, s[20:23], s38 offen offset:1024 sc1
    ds_read_b64_tr_b16 v[40:41], v56 offset:14336
    ds_read_b64_tr_b16 v[42:43], v56 offset:14848
    v_mfma_f32_32x32x16_bf16 v[16:31], v[52:55], v[124:127], v[16:31]
    ds_read_b64_tr_b16 v[44:45], v57 offset:14336
    ds_read_b64_tr_b16 v[46:47], v57 offset:14848
    s_waitcnt vmcnt(7) lgkmcnt(4)
    v_mfma_f32_32x32x16_bf16 v[0:15], v[32:35], v[128:131], v[0:15]
    s_add_u32 s38, s36, s37
    buffer_load_dwordx4 v[124:127], v253, s[20:23], s38 offen offset:0 sc1
    ds_read_b64_tr_b16 v[48:49], v56 offset:16384
    ds_read_b64_tr_b16 v[50:51], v56 offset:16896
    v_mfma_f32_32x32x16_bf16 v[16:31], v[36:39], v[128:131], v[16:31]
    ds_read_b64_tr_b16 v[52:53], v57 offset:16384
    ds_read_b64_tr_b16 v[54:55], v57 offset:16896
    s_waitcnt vmcnt(7) lgkmcnt(4)
    v_mfma_f32_32x32x16_bf16 v[0:15], v[40:43], v[132:135], v[0:15]
    s_add_u32 s37, s37, 2048
    s_and_b32 s37, s37, 0x7800
    buffer_load_dwordx4 v[128:131], v253, s[20:23], s38 offen offset:1024 sc1
    ds_read_b64_tr_b16 v[32:33], v56 offset:18432
    ds_read_b64_tr_b16 v[34:35], v56 offset:18944
    v_mfma_f32_32x32x16_bf16 v[16:31], v[44:47], v[132:135], v[16:31]
    ds_read_b64_tr_b16 v[36:37], v57 offset:18432
    ds_read_b64_tr_b16 v[38:39], v57 offset:18944
    s_waitcnt vmcnt(7) lgkmcnt(4)
    v_mfma_f32_32x32x16_bf16 v[0:15], v[48:51], v[136:139], v[0:15]
    s_add_u32 s38, s36, s37
    buffer_load_dwordx4 v[132:135], v253, s[20:23], s38 offen offset:0 sc1
    ds_read_b64_tr_b16 v[40:41], v56 offset:20480
    ds_read_b64_tr_b16 v[42:43], v56 offset:20992
    v_mfma_f32_32x32x16_bf16 v[16:31], v[52:55], v[136:139], v[16:31]
    ds_read_b64_tr_b16 v[44:45], v57 offset:20480
    ds_read_b64_tr_b16 v[46:47], v57 offset:20992
    s_waitcnt vmcnt(7) lgkmcnt(4)
    v_mfma_f32_32x32x16_bf16 v[0:15], v[32:35], v[104:107], v[0:15]
    s_add_u32 s37, s37, 2048
    s_and_b32 s37, s37, 0x7800
    buffer_load_dwordx4 v[136:139], v253, s[20:23], s38 offen offset:1024 sc1
    ds_read_b64_tr_b16 v[48:49], v56 offset:22528
    ds_read_b64_tr_b16 v[50:51], v56 offset:23040
    v_mfma_f32_32x32x16_bf16 v[16:31], v[36:39], v[104:107], v[16:31]
    ds_read_b64_tr_b16 v[52:53], v57 offset:22528
    ds_read_b64_tr_b16 v[54:55], v57 offset:23040
    s_waitcnt vmcnt(7) lgkmcnt(4)
    v_mfma_f32_32x32x16_bf16 v[0:15], v[40:43], v[108:111], v[0:15]
    s_add_u32 s38, s36, s37
    buffer_load_dwordx4 v[104:107], v253, s[20:23], s38 offen offset:0 sc1
    ds_read_b64_tr_b16 v[32:33], v56 offset:24576
    ds_read_b64_tr_b16 v[34:35], v56 offset:25088
    v_mfma_f32_32x32x16_bf16 v[16:31], v[44:47], v[108:111], v[16:31]
    ds_read_b64_tr_b16 v[36:37], v57 offset:24576
    ds_read_b64_tr_b16 v[38:39], v57 offset:25088
    s_waitcnt vmcnt(7) lgkmcnt(4)
    v_mfma_f32_32x32x16_bf16 v[0:15], v[48:51], v[112:115], v[0:15]
    s_add_u32 s37, s37, 2048
    s_and_b32 s37, s37, 0x7800
    buffer_load_dwordx4 v[108:111], v253, s[20:23], s38 offen offset:1024 sc1
    ds_read_b64_tr_b16 v[40:41], v56 offset:26624
    ds_read_b64_tr_b16 v[42:43], v56 offset:27136
    v_mfma_f32_32x32x16_bf16 v[16:31], v[52:55], v[112:115], v[16:31]
    ds_read_b64_tr_b16 v[44:45], v57 offset:26624
    ds_read_b64_tr_b16 v[46:47], v57 offset:27136
    s_waitcnt vmcnt(7) lgkmcnt(4)
    v_mfma_f32_32x32x16_bf16 v[0:15], v[32:35], v[116:119], v[0:15]
    s_add_u32 s38, s36, s37
    buffer_load_dwordx4 v[112:115], v253, s[20:23], s38 offen offset:0 sc1
    ds_read_b64_tr_b16 v[48:49], v56 offset:28672
    ds_read_b64_tr_b16 v[50:51], v56 offset:29184
    v_mfma_f32_32x32x16_bf16 v[16:31], v[36:39], v[116:119], v[16:31]
    ds_read_b64_tr_b16 v[52:53], v57 offset:28672
    ds_read_b64_tr_b16 v[54:55], v57 offset:29184
    s_waitcnt vmcnt(7) lgkmcnt(4)
    v_mfma_f32_32x32x16_bf16 v[0:15], v[40:43], v[120:123], v[0:15]
    s_add_u32 s37, s37, 2048
    s_and_b32 s37, s37, 0x7800
    buffer_load_dwordx4 v[116:119], v253, s[20:23], s38 offen offset:1024 sc1
    ds_read_b64_tr_b16 v[32:33], v56 offset:30720
    ds_read_b64_tr_b16 v[34:35], v56 offset:31232
    v_mfma_f32_32x32x16_bf16 v[16:31], v[44:47], v[120:123], v[16:31]
    ds_read_b64_tr_b16 v[36:37], v57 offset:30720
    ds_read_b64_tr_b16 v[38:39], v57 offset:31232
    s_waitcnt vmcnt(7) lgkmcnt(4)
    v_mfma_f32_32x32x16_bf16 v[0:15], v[48:51], v[124:127], v[0:15]
    s_add_u32 s38, s36, s37
    buffer_load_dwordx4 v[120:123], v253, s[20:23], s38 offen offset:0 sc1
    ds_read_b64_tr_b16 v[40:41], v56 offset:32768
    ds_read_b64_tr_b16 v[42:43], v56 offset:33280
    v_mfma_f32_32x32x16_bf16 v[16:31], v[52:55], v[124:127], v[16:31]
    ds_read_b64_tr_b16 v[44:45], v57 offset:32768
    ds_read_b64_tr_b16 v[46:47], v57 offset:33280
    s_waitcnt vmcnt(7) lgkmcnt(4)
    v_mfma_f32_32x32x16_bf16 v[0:15], v[32:35], v[128:131], v[0:15]
    s_add_u32 s37, s37, 2048
    s_and_b32 s37, s37, 0x7800
    buffer_load_dwordx4 v[124:127], v253, s[20:23], s38 offen offset:1024 sc1
    ds_read_b64_tr_b16 v[48:49], v56 offset:34816
    ds_read_b64_tr_b16 v[50:51], v56 offset:35328
    v_mfma_f32_32x32x16_bf16 v[16:31], v[36:39], v[128:131], v[16:31]
    ds_read_b64_tr_b16 v[52:53], v57 offset:34816
    ds_read_b64_tr_b16 v[54:55], v57 offset:35328
    s_waitcnt vmcnt(7) lgkmcnt(4)
    v_mfma_f32_32x32x16_bf16 v[0:15], v[40:43], v[132:135], v[0:15]
    s_add_u32 s38, s36, s37
    buffer_load_dwordx4 v[128:131], v253, s[20:23], s38 offen offset:0 sc1
    ds_read_b64_tr_b16 v[32:33], v56 offset:36864
    ds_read_b64_tr_b16 v[34:35], v56 offset:37376
    v_mfma_f32_32x32x16_bf16 v[16:31], v[44:47], v[132:135], v[16:31]
    ds_read_b64_tr_b16 v[36:37], v57 offset:36864
    ds_read_b64_tr_b16 v[38:39], v57 offset:37376
    s_waitcnt vmcnt(7) lgkmcnt(4)
    v_mfma_f32_32x32x16_bf16 v[0:15], v[48:51], v[136:139], v[0:15]
    s_add_u32 s37, s37, 2048
    s_and_b32 s37, s37, 0x7800
    buffer_load_dwordx4 v[132:135], v253, s[20:23], s38 offen offset:1024 sc1
    ds_read_b64_tr_b16 v[40:41], v56 offset:38912
    ds_read_b64_tr_b16 v[42:43], v56 offset:39424
    v_mfma_f32_32x32x16_bf16 v[16:31], v[52:55], v[136:139], v[16:31]
    ds_read_b64_tr_b16 v[44:45], v57 offset:38912
    ds_read_b64_tr_b16 v[46:47], v57 offset:39424
    s_waitcnt vmcnt(7) lgkmcnt(4)
    v_mfma_f32_32x32x16_bf16 v[0:15], v[32:35], v[104:107], v[0:15]
    s_add_u32 s38, s36, s37
    buffer_load_dwordx4 v[136:139], v253, s[20:23], s38 offen offset:0 sc1
    ds_read_b64_tr_b16 v[48:49], v56 offset:40960
    ds_read_b64_tr_b16 v[50:51], v56 offset:41472
    v_mfma_f32_32x32x16_bf16 v[16:31], v[36:39], v[104:107], v[16:31]
    ds_read_b64_tr_b16 v[52:53], v57 offset:40960
    ds_read_b64_tr_b16 v[54:55], v57 offset:41472
    s_waitcnt vmcnt(7) lgkmcnt(4)
    v_mfma_f32_32x32x16_bf16 v[0:15], v[40:43], v[108:111], v[0:15]
    s_add_u32 s37, s37, 2048
    s_and_b32 s37, s37, 0x7800
    buffer_load_dwordx4 v[104:107], v253, s[20:23], s38 offen offset:1024 sc1
    ds_read_b64_tr_b16 v[32:33], v56 offset:43008
    ds_read_b64_tr_b16 v[34:35], v56 offset:43520
    v_mfma_f32_32x32x16_bf16 v[16:31], v[44:47], v[108:111], v[16:31]
    ds_read_b64_tr_b16 v[36:37], v57 offset:43008
    ds_read_b64_tr_b16 v[38:39], v57 offset:43520
    s_waitcnt vmcnt(7) lgkmcnt(4)
    v_mfma_f32_32x32x16_bf16 v[0:15], v[48:51], v[112:115], v[0:15]
    buffer_load_dword v61, v60, s[20:23], s30 offen offset:256 sc1
    s_add_u32 s38, s36, s37
    buffer_load_dwordx4 v[108:111], v253, s[20:23], s38 offen offset:0 sc1
    ds_read_b64_tr_b16 v[40:41], v56 offset:45056
    ds_read_b64_tr_b16 v[42:43], v56 offset:45568
    v_mfma_f32_32x32x16_bf16 v[16:31], v[52:55], v[112:115], v[16:31]
    ds_read_b64_tr_b16 v[44:45], v57 offset:45056
    ds_read_b64_tr_b16 v[46:47], v57 offset:45568
    s_waitcnt vmcnt(8) lgkmcnt(4)
    v_mfma_f32_32x32x16_bf16 v[0:15], v[32:35], v[116:119], v[0:15]
    s_add_u32 s37, s37, 2048
    s_and_b32 s37, s37, 0x7800
    buffer_load_dwordx4 v[112:115], v253, s[20:23], s38 offen offset:1024 sc1
    ds_read_b64_tr_b16 v[48:49], v56 offset:47104
    ds_read_b64_tr_b16 v[50:51], v56 offset:47616
    v_mfma_f32_32x32x16_bf16 v[16:31], v[36:39], v[116:119], v[16:31]
    ds_read_b64_tr_b16 v[52:53], v57 offset:47104
    ds_read_b64_tr_b16 v[54:55], v57 offset:47616
    s_waitcnt vmcnt(8) lgkmcnt(4)
    v_mfma_f32_32x32x16_bf16 v[0:15], v[40:43], v[120:123], v[0:15]
    s_add_u32 s38, s36, s37
    buffer_load_dwordx4 v[116:119], v253, s[20:23], s38 offen offset:0 sc1
    ds_read_b64_tr_b16 v[32:33], v56 offset:49152
    ds_read_b64_tr_b16 v[34:35], v56 offset:49664
    v_mfma_f32_32x32x16_bf16 v[16:31], v[44:47], v[120:123], v[16:31]
    ds_read_b64_tr_b16 v[36:37], v57 offset:49152
    ds_read_b64_tr_b16 v[38:39], v57 offset:49664
    s_waitcnt vmcnt(8) lgkmcnt(4)
    v_mfma_f32_32x32x16_bf16 v[0:15], v[48:51], v[124:127], v[0:15]
    s_add_u32 s37, s37, 2048
    s_and_b32 s37, s37, 0x7800
    buffer_load_dwordx4 v[120:123], v253, s[20:23], s38 offen offset:1024 sc1
    ds_read_b64_tr_b16 v[40:41], v56 offset:51200
    ds_read_b64_tr_b16 v[42:43], v56 offset:51712
    v_mfma_f32_32x32x16_bf16 v[16:31], v[52:55], v[124:127], v[16:31]
    ds_read_b64_tr_b16 v[44:45], v57 offset:51200
    ds_read_b64_tr_b16 v[46:47], v57 offset:51712
    s_waitcnt vmcnt(8) lgkmcnt(4)
    v_mfma_f32_32x32x16_bf16 v[0:15], v[32:35], v[128:131], v[0:15]
    s_mov_b32 s78, s27
    s_waitcnt vmcnt(4)
    s_branch pc_29
pl_28:
    buffer_load_dword v61, v60, s[20:23], s30 offen offset:256 sc1
    s_waitcnt vmcnt(0)
pc_29:
    v_cmp_ne_u32 vcc, s88, v61
    s_cbranch_vccz pd_30
    s_sub_u32 s78, s78, 1
    s_cmp_lg_u32 s78, 0
    s_cbranch_scc1 pl_28
    s_mov_b32 s27, 1
pd_30:
    s_add_u32 s36, s36, 32768
    s_add_u32 s38, s36, s37
    buffer_load_dwordx4 v[124:127], v253, s[20:23], s38 offen offset:0 sc1
    ds_read_b64_tr_b16 v[48:49], v56 offset:53248
    ds_read_b64_tr_b16 v[50:51], v56 offset:53760
    v_mfma_f32_32x32x16_bf16 v[16:31], v[36:39], v[128:131], v[16:31]
    ds_read_b64_tr_b16 v[52:53], v57 offset:53248
    ds_read_b64_tr_b16 v[54:55], v57 offset:53760
    s_waitcnt vmcnt(8) lgkmcnt(4)
    v_mfma_f32_32x32x16_bf16 v[0:15], v[40:43], v[132:135], v[0:15]
    s_add_u32 s37, s37, 2048
    s_and_b32 s37, s37, 0x7800
    buffer_load_dwordx4 v[128:131], v253, s[20:23], s38 offen offset:1024 sc1
    ds_read_b64_tr_b16 v[32:33], v56 offset:55296
    ds_read_b64_tr_b16 v[34:35], v56 offset:55808
    v_mfma_f32_32x32x16_bf16 v[16:31], v[44:47], v[132:135], v[16:31]
    ds_read_b64_tr_b16 v[36:37], v57 offset:55296
    ds_read_b64_tr_b16 v[38:39], v57 offset:55808
    s_waitcnt vmcnt(8) lgkmcnt(4)
    v_mfma_f32_32x32x16_bf16 v[0:15], v[48:51], v[136:139], v[0:15]
    s_add_u32 s38, s36, s37
    buffer_load_dwordx4 v[132:135], v253, s[20:23], s38 offen offset:0 sc1
    ds_read_b64_tr_b16 v[40:41], v56 offset:57344
    ds_read_b64_tr_b16 v[42:43], v56 offset:57856
    v_mfma_f32_32x32x16_bf16 v[16:31], v[52:55], v[136:139], v[16:31]
    ds_read_b64_tr_b16 v[44:45], v57 offset:57344
    ds_read_b64_tr_b16 v[46:47], v57 offset:57856
    s_waitcnt vmcnt(8) lgkmcnt(4)
    v_mfma_f32_32x32x16_bf16 v[0:15], v[32:35], v[104:107], v[0:15]
    s_add_u32 s37, s37, 2048
    s_and_b32 s37, s37, 0x7800
    buffer_load_dwordx4 v[136:139], v253, s[20:23], s38 offen offset:1024 sc1
    ds_read_b64_tr_b16 v[48:49], v56 offset:59392
    ds_read_b64_tr_b16 v[50:51], v56 offset:59904
    v_mfma_f32_32x32x16_bf16 v[16:31], v[36:39], v[104:107], v[16:31]
    ds_read_b64_tr_b16 v[52:53], v57 offset:59392
    ds_read_b64_tr_b16 v[54:55], v57 offset:59904
    s_waitcnt vmcnt(7) lgkmcnt(4)
    v_mfma_f32_32x32x16_bf16 v[0:15], v[40:43], v[108:111], v[0:15]
    s_add_u32 s38, s36, s37
    buffer_load_dwordx4 v[104:107], v253, s[20:23], s38 offen offset:0 sc1
    ds_read_b64_tr_b16 v[32:33], v56 offset:61440
    ds_read_b64_tr_b16 v[34:35], v56 offset:61952
    v_mfma_f32_32x32x16_bf16 v[16:31], v[44:47], v[108:111], v[16:31]
    ds_read_b64_tr_b16 v[36:37], v57 offset:61440
    ds_read_b64_tr_b16 v[38:39], v57 offset:61952
    s_waitcnt vmcnt(7) lgkmcnt(4)
    v_mfma_f32_32x32x16_bf16 v[0:15], v[48:51], v[112:115], v[0:15]
    s_add_u32 s37, s37, 2048
    s_and_b32 s37, s37, 0x7800
    buffer_load_dwordx4 v[108:111], v253, s[20:23], s38 offen offset:1024 sc1
    ds_read_b64_tr_b16 v[40:41], v56 offset:63488
    ds_read_b64_tr_b16 v[42:43], v56 offset:64000
    v_mfma_f32_32x32x16_bf16 v[16:31], v[52:55], v[112:115], v[16:31]
    ds_read_b64_tr_b16 v[44:45], v57 offset:63488
    ds_read_b64_tr_b16 v[46:47], v57 offset:64000
    s_barrier
    s_waitcnt vmcnt(7) lgkmcnt(4)
    v_mfma_f32_32x32x16_bf16 v[0:15], v[32:35], v[116:119], v[0:15]
    s_add_u32 s38, s36, s37
    buffer_load_dwordx4 v[112:115], v253, s[20:23], s38 offen offset:0 sc1
    ds_read_b64_tr_b16 v[48:49], v58 offset:0
    ds_read_b64_tr_b16 v[50:51], v58 offset:512
    v_mfma_f32_32x32x16_bf16 v[16:31], v[36:39], v[116:119], v[16:31]
    ds_read_b64_tr_b16 v[52:53], v59 offset:0
    ds_read_b64_tr_b16 v[54:55], v59 offset:512
    s_waitcnt vmcnt(7) lgkmcnt(4)
    v_mfma_f32_32x32x16_bf16 v[0:15], v[40:43], v[120:123], v[0:15]
    s_add_u32 s37, s37, 2048
    s_and_b32 s37, s37, 0x7800
    buffer_load_dwordx4 v[116:119], v253, s[20:23], s38 offen offset:1024 sc1
    ds_read_b64_tr_b16 v[32:33], v58 offset:2048
    ds_read_b64_tr_b16 v[34:35], v58 offset:2560
    v_mfma_f32_32x32x16_bf16 v[16:31], v[44:47], v[120:123], v[16:31]
    ds_read_b64_tr_b16 v[36:37], v59 offset:2048
    ds_read_b64_tr_b16 v[38:39], v59 offset:2560
    s_waitcnt vmcnt(7) lgkmcnt(4)
    v_mfma_f32_32x32x16_bf16 v[0:15], v[48:51], v[124:127], v[0:15]
    s_add_u32 s38, s36, s37
    buffer_load_dwordx4 v[120:123], v253, s[20:23], s38 offen offset:0 sc1
    ds_read_b64_tr_b16 v[40:41], v58 offset:4096
    ds_read_b64_tr_b16 v[42:43], v58 offset:4608
    v_mfma_f32_32x32x16_bf16 v[16:31], v[52:55], v[124:127], v[16:31]
    ds_read_b64_tr_b16 v[44:45], v59 offset:4096
    ds_read_b64_tr_b16 v[46:47], v59 offset:4608
    s_waitcnt vmcnt(7) lgkmcnt(4)
    v_mfma_f32_32x32x16_bf16 v[0:15], v[32:35], v[128:131], v[0:15]
    s_add_u32 s37, s37, 2048
    s_and_b32 s37, s37, 0x7800
    buffer_load_dwordx4 v[124:127], v253, s[20:23], s38 offen offset:1024 sc1
    ds_read_b64_tr_b16 v[48:49], v58 offset:6144
    ds_read_b64_tr_b16 v[50:51], v58 offset:6656
    v_mfma_f32_32x32x16_bf16 v[16:31], v[36:39], v[128:131], v[16:31]
    ds_read_b64_tr_b16 v[52:53], v59 offset:6144
    ds_read_b64_tr_b16 v[54:55], v59 offset:6656
    s_waitcnt vmcnt(7) lgkmcnt(4)
    v_mfma_f32_32x32x16_bf16 v[0:15], v[40:43], v[132:135], v[0:15]
    s_add_u32 s38, s36, s37
    buffer_load_dwordx4 v[128:131], v253, s[20:23], s38 offen offset:0 sc1
    ds_read_b64_tr_b16 v[32:33], v58 offset:8192
    ds_read_b64_tr_b16 v[34:35], v58 offset:8704
    v_mfma_f32_32x32x16_bf16 v[16:31], v[44:47], v[132:135], v[16:31]
    ds_read_b64_tr_b16 v[36:37], v59 offset:8192
    ds_read_b64_tr_b16 v[38:39], v59 offset:8704
    s_waitcnt vmcnt(7) lgkmcnt(4)
    v_mfma_f32_32x32x16_bf16 v[0:15], v[48:51], v[136:139], v[0:15]
    s_add_u32 s37, s37, 2048
    s_and_b32 s37, s37, 0x7800
    buffer_load_dwordx4 v[132:135], v253, s[20:23], s38 offen offset:1024 sc1
    ds_read_b64_tr_b16 v[40:41], v58 offset:10240
    ds_read_b64_tr_b16 v[42:43], v58 offset:10752
    v_mfma_f32_32x32x16_bf16 v[16:31], v[52:55], v[136:139], v[16:31]
    ds_read_b64_tr_b16 v[44:45], v59 offset:10240
    ds_read_b64_tr_b16 v[46:47], v59 offset:10752
    s_waitcnt vmcnt(7) lgkmcnt(4)
    v_mfma_f32_32x32x16_bf16 v[0:15], v[32:35], v[104:107], v[0:15]
    s_add_u32 s38, s36, s37
    buffer_load_dwordx4 v[136:139], v253, s[20:23], s38 offen offset:0 sc1
    ds_read_b64_tr_b16 v[48:49], v58 offset:12288
    ds_read_b64_tr_b16 v[50:51], v58 offset:12800
    v_mfma_f32_32x32x16_bf16 v[16:31], v[36:39], v[104:107], v[16:31]
    ds_read_b64_tr_b16 v[52:53], v59 offset:12288
    ds_read_b64_tr_b16 v[54:55], v59 offset:12800
    s_waitcnt vmcnt(7) lgkmcnt(4)
    v_mfma_f32_32x32x16_bf16 v[0:15], v[40:43], v[108:111], v[0:15]
    s_add_u32 s37, s37, 2048
    s_and_b32 s37, s37, 0x7800
    buffer_load_dwordx4 v[104:107], v253, s[20:23], s38 offen offset:1024 sc1
    ds_read_b64_tr_b16 v[32:33], v58 offset:14336
    ds_read_b64_tr_b16 v[34:35], v58 offset:14848
    v_mfma_f32_32x32x16_bf16 v[16:31], v[44:47], v[108:111], v[16:31]
    ds_read_b64_tr_b16 v[36:37], v59 offset:14336
    ds_read_b64_tr_b16 v[38:39], v59 offset:14848
    s_waitcnt vmcnt(7) lgkmcnt(4)
    v_mfma_f32_32x32x16_bf16 v[0:15], v[48:51], v[112:115], v[0:15]
    s_add_u32 s38, s36, s37
    buffer_load_dwordx4 v[108:111], v253, s[20:23], s38 offen offset:0 sc1
    ds_read_b64_tr_b16 v[40:41], v58 offset:16384
    ds_read_b64_tr_b16 v[42:43], v58 offset:16896
    v_mfma_f32_32x32x16_bf16 v[16:31], v[52:55], v[112:115], v[16:31]
    ds_read_b64_tr_b16 v[44:45], v59 offset:16384
    ds_read_b64_tr_b16 v[46:47], v59 offset:16896
    s_waitcnt vmcnt(7) lgkmcnt(4)
    v_mfma_f32_32x32x16_bf16 v[0:15], v[32:35], v[116:119], v[0:15]
    s_add_u32 s37, s37, 2048
    s_and_b32 s37, s37, 0x7800
    buffer_load_dwordx4 v[112:115], v253, s[20:23], s38 offen offset:1024 sc1
    ds_read_b64_tr_b16 v[48:49], v58 offset:18432
    ds_read_b64_tr_b16 v[50:51], v58 offset:18944
    v_mfma_f32_32x32x16_bf16 v[16:31], v[36:39], v[116:119], v[16:31]
    ds_read_b64_tr_b16 v[52:53], v59 offset:18432
    ds_read_b64_tr_b16 v[54:55], v59 offset:18944
    s_waitcnt vmcnt(7) lgkmcnt(4)
    v_mfma_f32_32x32x16_bf16 v[0:15], v[40:43], v[120:123], v[0:15]
    s_add_u32 s38, s36, s37
    buffer_load_dwordx4 v[116:119], v253, s[20:23], s38 offen offset:0 sc1
    ds_read_b64_tr_b16 v[32:33], v58 offset:20480
    ds_read_b64_tr_b16 v[34:35], v58 offset:20992
    v_mfma_f32_32x32x16_bf16 v[16:31], v[44:47], v[120:123], v[16:31]
    ds_read_b64_tr_b16 v[36:37], v59 offset:20480
    ds_read_b64_tr_b16 v[38:39], v59 offset:20992
    s_waitcnt vmcnt(7) lgkmcnt(4)
    v_mfma_f32_32x32x16_bf16 v[0:15], v[48:51], v[124:127], v[0:15]
    s_add_u32 s37, s37, 2048
    s_and_b32 s37, s37, 0x7800
    buffer_load_dwordx4 v[120:123], v253, s[20:23], s38 offen offset:1024 sc1
    ds_read_b64_tr_b16 v[40:41], v58 offset:22528
    ds_read_b64_tr_b16 v[42:43], v58 offset:23040
    v_mfma_f32_32x32x16_bf16 v[16:31], v[52:55], v[124:127], v[16:31]
    ds_read_b64_tr_b16 v[44:45], v59 offset:22528
    ds_read_b64_tr_b16 v[46:47], v59 offset:23040
    s_waitcnt vmcnt(7) lgkmcnt(4)
    v_mfma_f32_32x32x16_bf16 v[0:15], v[32:35], v[128:131], v[0:15]
    s_add_u32 s38, s36, s37
    buffer_load_dwordx4 v[124:127], v253, s[20:23], s38 offen offset:0 sc1
    ds_read_b64_tr_b16 v[48:49], v58 offset:24576
    ds_read_b64_tr_b16 v[50:51], v58 offset:25088
    v_mfma_f32_32x32x16_bf16 v[16:31], v[36:39], v[128:131], v[16:31]
    ds_read_b64_tr_b16 v[52:53], v59 offset:24576
    ds_read_b64_tr_b16 v[54:55], v59 offset:25088
    s_waitcnt vmcnt(7) lgkmcnt(4)
    v_mfma_f32_32x32x16_bf16 v[0:15], v[40:43], v[132:135], v[0:15]
    s_add_u32 s37, s37, 2048
    s_and_b32 s37, s37, 0x7800
    buffer_load_dwordx4 v[128:131], v253, s[20:23], s38 offen offset:1024 sc1
    ds_read_b64_tr_b16 v[32:33], v58 offset:26624
    ds_read_b64_tr_b16 v[34:35], v58 offset:27136
    v_mfma_f32_32x32x16_bf16 v[16:31], v[44:47], v[132:135], v[16:31]
    ds_read_b64_tr_b16 v[36:37], v59 offset:26624
    ds_read_b64_tr_b16 v[38:39], v59 offset:27136
    s_waitcnt vmcnt(7) lgkmcnt(4)
    v_mfma_f32_32x32x16_bf16 v[0:15], v[48:51], v[136:139], v[0:15]
    s_add_u32 s38, s36, s37
    buffer_load_dwordx4 v[132:135], v253, s[20:23], s38 offen offset:0 sc1
    ds_read_b64_tr_b16 v[40:41], v58 offset:28672
    ds_read_b64_tr_b16 v[42:43], v58 offset:29184
    v_mfma_f32_32x32x16_bf16 v[16:31], v[52:55], v[136:139], v[16:31]
    ds_read_b64_tr_b16 v[44:45], v59 offset:28672
    ds_read_b64_tr_b16 v[46:47], v59 offset:29184
    s_waitcnt vmcnt(7) lgkmcnt(4)
    v_mfma_f32_32x32x16_bf16 v[0:15], v[32:35], v[104:107], v[0:15]
    s_add_u32 s37, s37, 2048
    s_and_b32 s37, s37, 0x7800
    buffer_load_dwordx4 v[136:139], v253, s[20:23], s38 offen offset:1024 sc1
    ds_read_b64_tr_b16 v[48:49], v58 offset:30720
    ds_read_b64_tr_b16 v[50:51], v58 offset:31232
    v_mfma_f32_32x32x16_bf16 v[16:31], v[36:39], v[104:107], v[16:31]
    ds_read_b64_tr_b16 v[52:53], v59 offset:30720
    ds_read_b64_tr_b16 v[54:55], v59 offset:31232
    s_waitcnt vmcnt(7) lgkmcnt(4)
    v_mfma_f32_32x32x16_bf16 v[0:15], v[40:43], v[108:111], v[0:15]
    s_add_u32 s38, s36, s37
    buffer_load_dwordx4 v[104:107], v253, s[20:23], s38 offen offset:0 sc1
    ds_read_b64_tr_b16 v[32:33], v58 offset:32768
    ds_read_b64_tr_b16 v[34:35], v58 offset:33280
    v_mfma_f32_32x32x16_bf16 v[16:31], v[44:47], v[108:111], v[16:31]
    ds_read_b64_tr_b16 v[36:37], v59 offset:32768
    ds_read_b64_tr_b16 v[38:39], v59 offset:33280
    s_waitcnt vmcnt(7) lgkmcnt(4)
    v_mfma_f32_32x32x16_bf16 v[0:15], v[48:51], v[112:115], v[0:15]
    s_add_u32 s37, s37, 2048
    s_and_b32 s37, s37, 0x7800
    buffer_load_dwordx4 v[108:111], v253, s[20:23], s38 offen offset:1024 sc1
    ds_read_b64_tr_b16 v[40:41], v58 offset:34816
    ds_read_b64_tr_b16 v[42:43], v58 offset:35328
    v_mfma_f32_32x32x16_bf16 v[16:31], v[52:55], v[112:115], v[16:31]
    ds_read_b64_tr_b16 v[44:45], v59 offset:34816
    ds_read_b64_tr_b16 v[46:47], v59 offset:35328
    s_waitcnt vmcnt(7) lgkmcnt(4)
    v_mfma_f32_32x32x16_bf16 v[0:15], v[32:35], v[116:119], v[0:15]
    s_add_u32 s38, s36, s37
    buffer_load_dwordx4 v[112:115], v253, s[20:23], s38 offen offset:0 sc1
    ds_read_b64_tr_b16 v[48:49], v58 offset:36864
    ds_read_b64_tr_b16 v[50:51], v58 offset:37376
    v_mfma_f32_32x32x16_bf16 v[16:31], v[36:39], v[116:119], v[16:31]
    ds_read_b64_tr_b16 v[52:53], v59 offset:36864
    ds_read_b64_tr_b16 v[54:55], v59 offset:37376
    s_waitcnt vmcnt(7) lgkmcnt(4)
    v_mfma_f32_32x32x16_bf16 v[0:15], v[40:43], v[120:123], v[0:15]
    s_add_u32 s37, s37, 2048
    s_and_b32 s37, s37, 0x7800
    buffer_load_dwordx4 v[116:119], v253, s[20:23], s38 offen offset:1024 sc1
    ds_read_b64_tr_b16 v[32:33], v58 offset:38912
    ds_read_b64_tr_b16 v[34:35], v58 offset:39424
    v_mfma_f32_32x32x16_bf16 v[16:31], v[44:47], v[120:123], v[16:31]
    ds_read_b64_tr_b16 v[36:37], v59 offset:38912
    ds_read_b64_tr_b16 v[38:39], v59 offset:39424
    s_waitcnt vmcnt(7) lgkmcnt(4)
    v_mfma_f32_32x32x16_bf16 v[0:15], v[48:51], v[124:127], v[0:15]
    s_add_u32 s38, s36, s37
    buffer_load_dwordx4 v[120:123], v253, s[20:23], s38 offen offset:0 sc1
    ds_read_b64_tr_b16 v[40:41], v58 offset:40960
    ds_read_b64_tr_b16 v[42:43], v58 offset:41472
    v_mfma_f32_32x32x16_bf16 v[16:31], v[52:55], v[124:127], v[16:31]
    ds_read_b64_tr_b16 v[44:45], v59 offset:40960
    ds_read_b64_tr_b16 v[46:47], v59 offset:41472
    s_waitcnt vmcnt(7) lgkmcnt(4)
    v_mfma_f32_32x32x16_bf16 v[0:15], v[32:35], v[128:131], v[0:15]
    s_add_u32 s37, s37, 2048
    s_and_b32 s37, s37, 0x7800
    buffer_load_dwordx4 v[124:127], v253, s[20:23], s38 offen offset:1024 sc1
    ds_read_b64_tr_b16 v[48:49], v58 offset:43008
    ds_read_b64_tr_b16 v[50:51], v58 offset:43520
    v_mfma_f32_32x32x16_bf16 v[16:31], v[36:39], v[128:131], v[16:31]
    ds_read_b64_tr_b16 v[52:53], v59 offset:43008
    ds_read_b64_tr_b16 v[54:55], v59 offset:43520
    s_waitcnt vmcnt(7) lgkmcnt(4)
    v_mfma_f32_32x32x16_bf16 v[0:15], v[40:43], v[132:135], v[0:15]
    s_add_u32 s38, s36, s37
    buffer_load_dwordx4 v[128:131], v253, s[20:23], s38 offen offset:0 sc1
    ds_read_b64_tr_b16 v[32:33], v58 offset:45056
    ds_read_b64_tr_b16 v[34:35], v58 offset:45568
    v_mfma_f32_32x32x16_bf16 v[16:31], v[44:47], v[132:135], v[16:31]
    ds_read_b64_tr_b16 v[36:37], v59 offset:45056
    ds_read_b64_tr_b16 v[38:39], v59 offset:45568
    s_waitcnt vmcnt(7) lgkmcnt(4)
    v_mfma_f32_32x32x16_bf16 v[0:15], v[48:51], v[136:139], v[0:15]
    s_add_u32 s37, s37, 2048
    s_and_b32 s37, s37, 0x7800
    buffer_load_dwordx4 v[132:135], v253, s[20:23], s38 offen offset:1024 sc1
    ds_read_b64_tr_b16 v[40:41], v58 offset:47104
    ds_read_b64_tr_b16 v[42:43], v58 offset:47616
    v_mfma_f32_32x32x16_bf16 v[16:31], v[52:55], v[136:139], v[16:31]
    ds_read_b64_tr_b16 v[44:45], v59 offset:47104
    ds_read_b64_tr_b16 v[46:47], v59 offset:47616
    s_barrier
    s_waitcnt vmcnt(7) lgkmcnt(4)
    v_mfma_f32_32x32x16_bf16 v[0:15], v[32:35], v[104:107], v[0:15]
    s_add_u32 s38, s36, s37
    buffer_load_dwordx4 v[136:139], v253, s[20:23], s38 offen offset:0 sc1
    ds_read_b64_tr_b16 v[48:49], v58 offset:49152
    ds_read_b64_tr_b16 v[50:51], v58 offset:49664
    v_mfma_f32_32x32x16_bf16 v[16:31], v[36:39], v[104:107], v[16:31]
    ds_read_b64_tr_b16 v[52:53], v59 offset:49152
    ds_read_b64_tr_b16 v[54:55], v59 offset:49664
    s_waitcnt vmcnt(7) lgkmcnt(4)
    v_mfma_f32_32x32x16_bf16 v[0:15], v[40:43], v[108:111], v[0:15]
    s_add_u32 s37, s37, 2048
    s_and_b32 s37, s37, 0x7800
    buffer_load_dwordx4 v[104:107], v253, s[20:23], s38 offen offset:1024 sc1
    ds_read_b64_tr_b16 v[32:33], v58 offset:51200
    ds_read_b64_tr_b16 v[34:35], v58 offset:51712
    v_mfma_f32_32x32x16_bf16 v[16:31], v[44:47], v[108:111], v[16:31]
    ds_read_b64_tr_b16 v[36:37], v59 offset:51200
    ds_read_b64_tr_b16 v[38:39], v59 offset:51712
    s_waitcnt vmcnt(7) lgkmcnt(4)
    v_mfma_f32_32x32x16_bf16 v[0:15], v[48:51], v[112:115], v[0:15]
    ds_read_b64_tr_b16 v[40:41], v58 offset:53248
    ds_read_b64_tr_b16 v[42:43], v58 offset:53760
    v_mfma_f32_32x32x16_bf16 v[16:31], v[52:55], v[112:115], v[16:31]
    ds_read_b64_tr_b16 v[44:45], v59 offset:53248
    ds_read_b64_tr_b16 v[46:47], v59 offset:53760
    s_waitcnt vmcnt(6) lgkmcnt(4)
    v_mfma_f32_32x32x16_bf16 v[0:15], v[32:35], v[116:119], v[0:15]
    ds_read_b64_tr_b16 v[48:49], v58 offset:55296
    ds_read_b64_tr_b16 v[50:51], v58 offset:55808
    v_mfma_f32_32x32x16_bf16 v[16:31], v[36:39], v[116:119], v[16:31]
    ds_read_b64_tr_b16 v[52:53], v59 offset:55296
    ds_read_b64_tr_b16 v[54:55], v59 offset:55808
    s_waitcnt vmcnt(5) lgkmcnt(4)
    v_mfma_f32_32x32x16_bf16 v[0:15], v[40:43], v[120:123], v[0:15]
    ds_read_b64_tr_b16 v[32:33], v58 offset:57344
    ds_read_b64_tr_b16 v[34:35], v58 offset:57856
    v_mfma_f32_32x32x16_bf16 v[16:31], v[44:47], v[120:123], v[16:31]
    ds_read_b64_tr_b16 v[36:37], v59 offset:57344
    ds_read_b64_tr_b16 v[38:39], v59 offset:57856
    s_waitcnt vmcnt(4) lgkmcnt(4)
    v_mfma_f32_32x32x16_bf16 v[0:15], v[48:51], v[124:127], v[0:15]
    ds_read_b64_tr_b16 v[40:41], v58 offset:59392
    ds_read_b64_tr_b16 v[42:43], v58 offset:59904
    v_mfma_f32_32x32x16_bf16 v[16:31], v[52:55], v[124:127], v[16:31]
    ds_read_b64_tr_b16 v[44:45], v59 offset:59392
    ds_read_b64_tr_b16 v[46:47], v59 offset:59904
    s_waitcnt vmcnt(3) lgkmcnt(4)
    v_mfma_f32_32x32x16_bf16 v[0:15], v[32:35], v[128:131], v[0:15]
    ds_read_b64_tr_b16 v[48:49], v58 offset:61440
    ds_read_b64_tr_b16 v[50:51], v58 offset:61952
    v_mfma_f32_32x32x16_bf16 v[16:31], v[36:39], v[128:131], v[16:31]
    ds_read_b64_tr_b16 v[52:53], v59 offset:61440
    ds_read_b64_tr_b16 v[54:55], v59 offset:61952
    s_waitcnt vmcnt(2) lgkmcnt(4)
    v_mfma_f32_32x32x16_bf16 v[0:15], v[40:43], v[132:135], v[0:15]
    ds_read_b64_tr_b16 v[32:33], v58 offset:63488
    ds_read_b64_tr_b16 v[34:35], v58 offset:64000
    v_mfma_f32_32x32x16_bf16 v[16:31], v[44:47], v[132:135], v[16:31]
    ds_read_b64_tr_b16 v[36:37], v59 offset:63488
    ds_read_b64_tr_b16 v[38:39], v59 offset:64000
    s_waitcnt vmcnt(1) lgkmcnt(4)
    v_mfma_f32_32x32x16_bf16 v[0:15], v[48:51], v[136:139], v[0:15]
    v_mfma_f32_32x32x16_bf16 v[16:31], v[52:55], v[136:139], v[16:31]
    s_waitcnt vmcnt(0) lgkmcnt(0)
    v_mfma_f32_32x32x16_bf16 v[0:15], v[32:35], v[104:107], v[0:15]
    v_mfma_f32_32x32x16_bf16 v[16:31], v[36:39], v[104:107], v[16:31]
    s_lshl_b32 s35, s24, 4
    s_add_u32 s35, s35, s98
    s_lshl_b32 s35, s35, 14
    s_lshl_b32 s34, s3, 12
    s_add_u32 s35, s35, s34
    s_add_u32 s35, s35, 0x2000000
    s_lshl_b32 s30, s99, 13
    s_add_u32 s30, s30, s26
    s_add_u32 s30, s30, 0xc00000
    s_lshl_b32 s31, s98, 9
    s_add_u32 s31, s31, s30
    v_mov_b32 v96, 0
    v_mov_b32 v97, 0
    v_mov_b32 v98, 0
    v_mov_b32 v99, v242
    v_cvt_pk_bf16_f32 v208, v0, v1
    v_cvt_pk_bf16_f32 v209, v2, v3
    v_cvt_pk_bf16_f32 v210, v4, v5
    v_cvt_pk_bf16_f32 v211, v6, v7
    v_cvt_pk_bf16_f32 v212, v8, v9
    v_cvt_pk_bf16_f32 v213, v10, v11
    v_cvt_pk_bf16_f32 v214, v12, v13
    v_cvt_pk_bf16_f32 v215, v14, v15
    v_cvt_pk_bf16_f32 v216, v16, v17
    v_cvt_pk_bf16_f32 v217, v18, v19
    v_cvt_pk_bf16_f32 v218, v20, v21
    v_cvt_pk_bf16_f32 v219, v22, v23
    v_cvt_pk_bf16_f32 v220, v24, v25
    v_cvt_pk_bf16_f32 v221, v26, v27
    v_cvt_pk_bf16_f32 v222, v28, v29
    v_cvt_pk_bf16_f32 v223, v30, v31
    s_cmp_lg_u32 s26, 0
    s_cbranch_scc1 sk_31
    s_cmp_lg_u32 s77, 0
    s_cbranch_scc1 lc_32
    buffer_store_dwordx4 v[208:211], v100, s[20:23], s35 offen offset:0 sc1
    buffer_store_dwordx4 v[212:215], v100, s[20:23], s35 offen offset:512 sc1
    buffer_store_dwordx4 v[216:219], v100, s[20:23], s35 offen offset:1024 sc1
    buffer_store_dwordx4 v[220:223], v100, s[20:23], s35 offen offset:1536 sc1
    s_branch lc_33
    s_nop 0
lc_32:
    buffer_store_dwordx4 v[208:211], v100, s[20:23], s35 offen offset:0 sc1
    buffer_store_dwordx4 v[212:215], v100, s[20:23], s35 offen offset:512 sc1
    buffer_store_dwordx4 v[216:219], v100, s[20:23], s35 offen offset:1024 sc1
    buffer_store_dwordx4 v[220:223], v100, s[20:23], s35 offen offset:1536 sc1
lc_33:
    ds_write_b128 v101, v[208:211] offset:0
    ds_write_b128 v101, v[212:215] offset:512
    ds_write_b128 v101, v[216:219] offset:1024
    ds_write_b128 v101, v[220:223] offset:1536
sk_31:
    v_dot2c_f32_bf16 v96, 0x3f803f80, v208
    v_dot2c_f32_bf16 v97, v208, v208
    v_dot2c_f32_bf16 v98, v224, v208
    v_dot2c_f32_bf16 v96, 0x3f803f80, v209
    v_dot2c_f32_bf16 v97, v209, v209
    v_dot2c_f32_bf16 v98, v225, v209
    v_dot2c_f32_bf16 v96, 0x3f803f80, v210
    v_dot2c_f32_bf16 v97, v210, v210
    v_dot2c_f32_bf16 v98, v226, v210
    v_dot2c_f32_bf16 v96, 0x3f803f80, v211
    v_dot2c_f32_bf16 v97, v211, v211
    v_dot2c_f32_bf16 v98, v227, v211
    v_dot2c_f32_bf16 v96, 0x3f803f80, v212
    v_dot2c_f32_bf16 v97, v212, v212
    v_dot2c_f32_bf16 v98, v228, v212
    v_dot2c_f32_bf16 v96, 0x3f803f80, v213
    v_dot2c_f32_bf16 v97, v213, v213
    v_dot2c_f32_bf16 v98, v229, v213
    v_dot2c_f32_bf16 v96, 0x3f803f80, v214
    v_dot2c_f32_bf16 v97, v214, v214
    v_dot2c_f32_bf16 v98, v230, v214
    v_dot2c_f32_bf16 v96, 0x3f803f80, v215
    v_dot2c_f32_bf16 v97, v215, v215
    v_dot2c_f32_bf16 v98, v231, v215
    v_dot2c_f32_bf16 v96, 0x3f803f80, v216
    v_dot2c_f32_bf16 v97, v216, v216
    v_dot2c_f32_bf16 v98, v232, v216
    v_dot2c_f32_bf16 v96, 0x3f803f80, v217
    v_dot2c_f32_bf16 v97, v217, v217
    v_dot2c_f32_bf16 v98, v233, v217
    v_dot2c_f32_bf16 v96, 0x3f803f80, v218
    v_dot2c_f32_bf16 v97, v218, v218
    v_dot2c_f32_bf16 v98, v234, v218
    v_dot2c_f32_bf16 v96, 0x3f803f80, v219
    v_dot2c_f32_bf16 v97, v219, v219
    v_dot2c_f32_bf16 v98, v235, v219
    v_dot2c_f32_bf16 v96, 0x3f803f80, v220
    v_dot2c_f32_bf16 v97, v220, v220
    v_dot2c_f32_bf16 v98, v236, v220
    v_dot2c_f32_bf16 v96, 0x3f803f80, v221
    v_dot2c_f32_bf16 v97, v221, v221
    v_dot2c_f32_bf16 v98, v237, v221
    v_dot2c_f32_bf16 v96, 0x3f803f80, v222
    v_dot2c_f32_bf16 v97, v222, v222
    v_dot2c_f32_bf16 v98, v238, v222
    v_dot2c_f32_bf16 v96, 0x3f803f80, v223
    v_dot2c_f32_bf16 v97, v223, v223
    v_dot2c_f32_bf16 v98, v239, v223
    s_nop 0
    v_mov_b32 v48, v96
    v_mov_b32 v49, v97
    v_mov_b32 v50, v98
    v_mov_b32 v51, v99
    v_permlane32_swap_b32 v96, v48
    v_permlane32_swap_b32 v97, v49
    v_permlane32_swap_b32 v98, v50
    v_permlane32_swap_b32 v99, v51
    v_add_f32 v96, v96, v48
    v_add_f32 v97, v97, v49
    v_add_f32 v98, v98, v50
    v_add_f32_e64 v99, v99, v51
    s_mov_b32 exec_hi, 0
    s_waitcnt vmcnt(0)
    s_cmp_lg_u32 s77, 0
    s_cbranch_scc1 lc_34
    buffer_store_dwordx4 v[96:99], v253, s[20:23], s31 offen sc1
    s_branch lc_35
    s_nop 0
lc_34:
    buffer_store_dwordx4 v[96:99], v253, s[20:23], s31 offen
lc_35:
    s_mov_b64 exec, -1
    s_cmp_lg_u32 s26, 0
    s_cbranch_scc1 e_final
    s_mov_b32 s26, 16777216
    s_and_b32 s30, s3, 1
    s_lshl_b32 s30, s30, 13
    v_add_u32 v176, s30, v253
    v_add_u32 v177, 1024, v176
    s_lshr_b32 s30, s16, 7
    s_sub_u32 s30, 3, s30
    s_and_b32 s30, s30, 7
    s_and_b32 s31, s24, 1
    s_lshl_b32 s31, s31, 3
    s_add_u32 s30, s30, s31
    s_and_b32 s31, s24, 14
    s_add_u32 s84, s31, s30
    s_lshl_b32 s31, s25, 2
    s_add_u32 s31, s31, s28
    s_mul_i32 s31, s31, 6144
    s_lshl_b32 s30, s30, 7
    s_add_u32 s30, s30, s31
    v_min_u32_e64 v190, 2, v252
    v_lshl_add_u32 v190, v190, 11, s30
    s_add_u32 s84, s84, 14
    v_mov_b32 v0, 0
    v_mov_b32 v1, 0
    v_mov_b32 v2, 0
    v_mov_b32 v3, 0
    v_mov_b32 v4, 0
    v_mov_b32 v5, 0
    v_mov_b32 v6, 0
    v_mov_b32 v7, 0
    v_mov_b32 v8, 0
    v_mov_b32 v9, 0
    v_mov_b32 v10, 0
    v_mov_b32 v11, 0
    v_mov_b32 v12, 0
    v_mov_b32 v13, 0
    v_mov_b32 v14, 0
    v_mov_b32 v15, 0
    v_mov_b32 v16, 0
    v_mov_b32 v17, 0
    v_mov_b32 v18, 0
    v_mov_b32 v19, 0
    v_mov_b32 v20, 0
    v_mov_b32 v21, 0
    v_mov_b32 v22, 0
    v_mov_b32 v23, 0
    v_mov_b32 v24, 0
    v_mov_b32 v25, 0
    v_mov_b32 v26, 0
    v_mov_b32 v27, 0
    v_mov_b32 v28, 0
    v_mov_b32 v29, 0
    v_mov_b32 v30, 0
    v_mov_b32 v31, 0
    v_mov_b32 v32, 0
    v_mov_b32 v33, 0
    v_mov_b32 v34, 0
    v_mov_b32 v35, 0
    v_mov_b32 v36, 0
    v_mov_b32 v37, 0
    v_mov_b32 v38, 0
    v_mov_b32 v39, 0
    v_mov_b32 v40, 0
    v_mov_b32 v41, 0
    v_mov_b32 v42, 0
    v_mov_b32 v43, 0
    v_mov_b32 v44, 0
    v_mov_b32 v45, 0
    v_mov_b32 v46, 0
    v_mov_b32 v47, 0
    v_mov_b32 v48, 0
    v_mov_b32 v49, 0
    v_mov_b32 v50, 0
    v_mov_b32 v51, 0
    v_mov_b32 v52, 0
    v_mov_b32 v53, 0
    v_mov_b32 v54, 0
    v_mov_b32 v55, 0
    v_mov_b32 v56, 0
    v_mov_b32 v57, 0
    v_mov_b32 v58, 0
    v_mov_b32 v59, 0
    v_mov_b32 v60, 0
    v_mov_b32 v61, 0
    v_mov_b32 v62, 0
    v_mov_b32 v63, 0
    v_mov_b32 v64, 0
    v_mov_b32 v65, 0
    v_mov_b32 v66, 0
    v_mov_b32 v67, 0
    v_mov_b32 v68, 0
    v_mov_b32 v69, 0
    v_mov_b32 v70, 0
    v_mov_b32 v71, 0
    v_mov_b32 v72, 0
    v_mov_b32 v73, 0
    v_mov_b32 v74, 0
    v_mov_b32 v75, 0
    v_mov_b32 v76, 0
    v_mov_b32 v77, 0
    v_mov_b32 v78, 0
    v_mov_b32 v79, 0
    v_mov_b32 v80, 0
    v_mov_b32 v81, 0
    v_mov_b32 v82, 0
    v_mov_b32 v83, 0
    v_mov_b32 v84, 0
    v_mov_b32 v85, 0
    v_mov_b32 v86, 0
    v_mov_b32 v87, 0
    v_mov_b32 v88, 0
    v_mov_b32 v89, 0
    v_mov_b32 v90, 0
    v_mov_b32 v91, 0
    v_mov_b32 v92, 0
    v_mov_b32 v93, 0
    v_mov_b32 v94, 0
    v_mov_b32 v95, 0
    s_waitcnt lgkmcnt(0)
    s_branch e_q
    s_nop 0
e_fpf:
    s_bitset0_b32 s86, s36
    s_bfm_b64 exec, 56, 0
    global_load_dword v191, v[196:197], off
    v_add_co_u32 v196, vcc, v196, v198
    s_nop 1
    v_addc_co_u32 v197, vcc, 0, v197, vcc
    s_mov_b64 exec, -1
    s_branch e_fpf_ret
e_arr:
    s_mov_b64 exec, 3
    s_mov_b32 s89, 0xdd9000
    buffer_store_dwordx2 v[250:251], v249, s[20:23], s89 offen sc1
    s_mov_b64 exec, -1
    s_branch e_arr_ret
e_final:
    s_mov_b32 s78, s27
pl_36:
    s_lshl_b32 s30, s99, 13
    s_add_u32 s30, s30, 0x1c00000
    s_add_u32 s31, s30, 4096
    buffer_load_dwordx4 v[64:67], v253, s[20:23], s30 offen offset:0 sc1
    buffer_load_dwordx4 v[68:71], v253, s[20:23], s30 offen offset:1024 sc1
    buffer_load_dwordx4 v[72:75], v253, s[20:23], s30 offen offset:2048 sc1
    buffer_load_dwordx4 v[76:79], v253, s[20:23], s30 offen offset:3072 sc1
    buffer_load_dwordx4 v[80:83], v253, s[20:23], s31 offen offset:0 sc1
    buffer_load_dwordx4 v[84:87], v253, s[20:23], s31 offen offset:1024 sc1
    buffer_load_dwordx4 v[88:91], v253, s[20:23], s31 offen offset:2048 sc1
    buffer_load_dwordx4 v[92:95], v253, s[20:23], s31 offen offset:3072 sc1
    s_waitcnt vmcnt(0)
pc_37:
    v_max3_u32 v48, v64, v68, v72
    v_max3_u32 v48, v48, v76, v80
    v_max3_u32 v48, v48, v84, v88
    v_max_u32 v48, v48, v92
    v_cmp_eq_u32 vcc, -1, v48
    s_cbranch_vccz pd_38
    s_sub_u32 s78, s78, 1
    s_cmp_lg_u32 s78, 0
    s_cbranch_scc1 pl_36
    s_mov_b32 s27, 1
pd_38:
    v_pk_add_f32 v[64:65], v[64:65], v[68:69]
    v_pk_add_f32 v[66:67], v[66:67], v[70:71]
    v_pk_add_f32 v[64:65], v[64:65], v[72:73]
    v_pk_add_f32 v[66:67], v[66:67], v[74:75]
    v_pk_add_f32 v[64:65], v[64:65], v[76:77]
    v_pk_add_f32 v[66:67], v[66:67], v[78:79]
    v_pk_add_f32 v[64:65], v[64:65], v[80:81]
    v_pk_add_f32 v[66:67], v[66:67], v[82:83]
    v_pk_add_f32 v[64:65], v[64:65], v[84:85]
    v_pk_add_f32 v[66:67], v[66:67], v[86:87]
    v_pk_add_f32 v[64:65], v[64:65], v[88:89]
    v_pk_add_f32 v[66:67], v[66:67], v[90:91]
    v_pk_add_f32 v[64:65], v[64:65], v[92:93]
    v_pk_add_f32 v[66:67], v[66:67], v[94:95]
    v_mov_b32 v48, v64
    v_mov_b32 v49, v65
    v_mov_b32 v50, v66
    v_mov_b32 v51, v67
    v_permlane32_swap_b32 v64, v48
    v_permlane32_swap_b32 v65, v49
    v_permlane32_swap_b32 v66, v50
    v_permlane32_swap_b32 v67, v51
    v_add_f32 v64, v64, v48
    v_add_f32 v65, v65, v49
    v_add_f32 v66, v66, v50
    v_add_f32 v67, v67, v51
    v_mul_f32 v54, 0x3a800000, v64
    v_mul_f32 v65, 0x3a800000, v65
    v_fma_f32 v65, -v54, v54, v65
    v_max_f32_e64 v65, 0, v65
    v_add_f32 v55, 0x3727c5ac, v65
    v_rsq_f32_e64 v55, v55
    v_fma_f32 v52, -v54, v67, v66
    v_and_b32 v53, 31, v252
    v_mul_f32 v52, v52, v55
    s_lshl_b32 s32, s99, 5
    v_add_u32 v53, s32, v53
    v_mov_b32 v48, v52
    s_nop 1
    v_max_f32_dpp v48, v48, v48 quad_perm:[1,0,3,2] row_mask:0xf bank_mask:0xf
    s_nop 1
    v_max_f32_dpp v48, v48, v48 quad_perm:[2,3,0,1] row_mask:0xf bank_mask:0xf
    s_nop 1
    v_max_f32_dpp v48, v48, v48 row_half_mirror row_mask:0xf bank_mask:0xf
    s_nop 1
    v_max_f32_dpp v48, v48, v48 row_mirror row_mask:0xf bank_mask:0xf
    v_mov_b32 v49, v48
    s_nop 1
    v_permlane16_swap_b32 v48, v49
    v_max_f32 v48, v48, v49
    v_cmp_eq_f32 vcc, v48, v52
    v_lshrrev_b32 v50, 5, v252
    v_lshlrev_b32 v50, 4, v50
    s_lshr_b32 s34, s25, 3
    v_lshl_add_u32 v51, s34, 28, v50
    s_lshl_b32 s32, s99, 11
    s_lshl_b32 s33, s98, 7
    s_add_u32 s32, s32, s33
    s_add_u32 s32, s32, 0x1d60000
    s_and_b32 s34, s25, 7
    s_lshl_b32 s34, s34, 6
    s_add_u32 s34, s34, s99
    s_mul_i32 s34, s34, 32
    s_add_u32 s34, s34, 0x1dc0000
    s_ff1_i32_b32 s35, vcc_lo
    s_lshl_b32 s35, 1, s35
    s_mov_b32 exec_lo, s35
    s_mov_b32 exec_hi, s35
    buffer_store_dwordx4 v[52:55], v51, s[20:23], s34 offen sc1
    buffer_store_dwordx4 v[208:211], v50, s[20:23], s32 offen offset:0 sc1
    buffer_store_dwordx4 v[212:215], v50, s[20:23], s32 offen offset:32 sc1
    buffer_store_dwordx4 v[216:219], v50, s[20:23], s32 offen offset:64 sc1
    buffer_store_dwordx4 v[220:223], v50, s[20:23], s32 offen offset:96 sc1
    s_mov_b64 exec, -1
    s_mov_b32 s38, s35
    s_mov_b32 s39, s35
    v_add_f32 v240, 1.0, v55
    v_mul_f32 v241, v54, v55
    v_sub_f32 v241, 0, v241
    v_pk_fma_f32 v[0:1], v[0:1], v[240:241], v[240:241] op_sel:[0,0,1] op_sel_hi:[1,0,1]
    v_pk_fma_f32 v[2:3], v[2:3], v[240:241], v[240:241] op_sel:[0,0,1] op_sel_hi:[1,0,1]
    v_pk_fma_f32 v[4:5], v[4:5], v[240:241], v[240:241] op_sel:[0,0,1] op_sel_hi:[1,0,1]
    v_pk_fma_f32 v[6:7], v[6:7], v[240:241], v[240:241] op_sel:[0,0,1] op_sel_hi:[1,0,1]
    v_pk_fma_f32 v[8:9], v[8:9], v[240:241], v[240:241] op_sel:[0,0,1] op_sel_hi:[1,0,1]
    v_pk_fma_f32 v[10:11], v[10:11], v[240:241], v[240:241] op_sel:[0,0,1] op_sel_hi:[1,0,1]
    v_pk_fma_f32 v[12:13], v[12:13], v[240:241], v[240:241] op_sel:[0,0,1] op_sel_hi:[1,0,1]
    v_pk_fma_f32 v[14:15], v[14:15], v[240:241], v[240:241] op_sel:[0,0,1] op_sel_hi:[1,0,1]
    v_pk_fma_f32 v[16:17], v[16:17], v[240:241], v[240:241] op_sel:[0,0,1] op_sel_hi:[1,0,1]
    v_pk_fma_f32 v[18:19], v[18:19], v[240:241], v[240:241] op_sel:[0,0,1] op_sel_hi:[1,0,1]
    v_pk_fma_f32 v[20:21], v[20:21], v[240:241], v[240:241] op_sel:[0,0,1] op_sel_hi:[1,0,1]
    v_pk_fma_f32 v[22:23], v[22:23], v[240:241], v[240:241] op_sel:[0,0,1] op_sel_hi:[1,0,1]
    v_pk_fma_f32 v[24:25], v[24:25], v[240:241], v[240:241] op_sel:[0,0,1] op_sel_hi:[1,0,1]
    v_pk_fma_f32 v[26:27], v[26:27], v[240:241], v[240:241] op_sel:[0,0,1] op_sel_hi:[1,0,1]
    v_pk_fma_f32 v[28:29], v[28:29], v[240:241], v[240:241] op_sel:[0,0,1] op_sel_hi:[1,0,1]
    v_pk_fma_f32 v[30:31], v[30:31], v[240:241], v[240:241] op_sel:[0,0,1] op_sel_hi:[1,0,1]
    v_cvt_pk_bf16_f32 v64, v0, v1
    v_cvt_pk_bf16_f32 v65, v2, v3
    v_cvt_pk_bf16_f32 v66, v4, v5
    v_cvt_pk_bf16_f32 v67, v6, v7
    v_cvt_pk_bf16_f32 v68, v8, v9
    v_cvt_pk_bf16_f32 v69, v10, v11
    v_cvt_pk_bf16_f32 v70, v12, v13
    v_cvt_pk_bf16_f32 v71, v14, v15
    v_cvt_pk_bf16_f32 v72, v16, v17
    v_cvt_pk_bf16_f32 v73, v18, v19
    v_cvt_pk_bf16_f32 v74, v20, v21
    v_cvt_pk_bf16_f32 v75, v22, v23
    v_cvt_pk_bf16_f32 v76, v24, v25
    v_cvt_pk_bf16_f32 v77, v26, v27
    v_cvt_pk_bf16_f32 v78, v28, v29
    v_cvt_pk_bf16_f32 v79, v30, v31
    v_permlane32_swap_b32 v64, v66
    v_permlane32_swap_b32 v65, v67
    v_permlane32_swap_b32 v68, v70
    v_permlane32_swap_b32 v69, v71
    v_permlane32_swap_b32 v72, v74
    v_permlane32_swap_b32 v73, v75
    v_permlane32_swap_b32 v76, v78
    v_permlane32_swap_b32 v77, v79
    v_lshl_add_u32 v50, v53, 11, v50
    s_mov_b32 s79, s26
    s_lshl_b32 s34, s28, 12
    s_add_u32 s34, s34, 147456
    v_bfe_u32 v16, v252, 1, 3
    v_lshrrev_b32 v17, 5, v252
    v_xor_b32 v16, v16, v17
    v_and_b32 v17, 31, v252
    v_lshlrev_b32 v17, 7, v17
    v_lshl_add_u32 v16, v16, 4, v17
    v_add_u32_e64 v16, s34, v16
    ds_write_b128 v16, v[64:67]
    v_xor_b32_e64 v17, 32, v16
    ds_write_b128 v17, v[68:71]
    v_xor_b32_e64 v17, 64, v16
    ds_write_b128 v17, v[72:75]
    v_xor_b32 v17, 96, v16
    ds_write_b128 v17, v[76:79]
    v_add_u32 v18, s34, v253
    v_lshrrev_b32 v19, 4, v252
    v_xor_b32 v19, v19, v252
    v_and_b32 v19, 7, v19
    v_lshrrev_b32_e64 v20, 3, v252
    v_lshl_add_u32 v20, s99, 5, v20
    v_lshlrev_b32_e64 v20, 11, v20
    v_lshl_add_u32 v20, v19, 4, v20
    v_xor_b32 v21, 64, v20
    s_waitcnt lgkmcnt(0)
    ds_read_b128 v[24:27], v18 offset:0
    ds_read_b128 v[28:31], v18 offset:1024
    ds_read_b128 v[32:35], v18 offset:2048
    ds_read_b128 v[36:39], v18 offset:3072
    s_ff1_i32_b32 s36, s38
    s_and_b32 s37, s36, 7
    s_lshl_b32 s37, s37, 3
    s_lshl_b64 s[40:41], 0xff, s37
    s_not_b64 s[40:41], s[40:41]
    s_lshr_b32 s36, s36, 3
    s_mov_b32 s37, s33
    s_cmp_eq_u32 s36, 0
    s_cselect_b64 exec, s[40:41], -1
    s_waitcnt lgkmcnt(3)
    buffer_store_dwordx4 v[24:27], v20, s[12:15], s37 offen sc1
    s_add_u32 s37, s37, 16384
    s_cmp_eq_u32 s36, 1
    s_cselect_b64 exec, s[40:41], -1
    s_waitcnt lgkmcnt(2)
    buffer_store_dwordx4 v[28:31], v21, s[12:15], s37 offen sc1
    s_add_u32 s37, s37, 16384
    s_cmp_eq_u32 s36, 2
    s_cselect_b64 exec, s[40:41], -1
    s_waitcnt lgkmcnt(1)
    buffer_store_dwordx4 v[32:35], v20, s[12:15], s37 offen sc1
    s_add_u32 s37, s37, 16384
    s_cmp_eq_u32 s36, 3
    s_cselect_b64 exec, s[40:41], -1
    s_waitcnt lgkmcnt(0)
    buffer_store_dwordx4 v[36:39], v21, s[12:15], s37 offen sc1
    s_mov_b64 exec, -1
    s_cmp_lg_u32 s3, 0
    s_cbranch_scc1 sk_39
    s_mov_b32 s78, s27
pl_40:
    s_add_u32 s32, s79, 0xdc0000
    s_lshr_b32 vcc_lo, s24, 1
    s_mul_i32 vcc_lo, vcc_lo, 2048
    s_add_u32 s32, s32, vcc_lo
    v_lshlrev_b32 v4, 1, v253
    buffer_load_dwordx4 v[0:3], v4, s[20:23], s32 offen sc1
    s_waitcnt vmcnt(0)
pc_41:
    v_max3_u32 v4, v0, v1, v2
    v_max_u32 v4, v4, v3
    v_cmp_eq_u32 vcc, -1, v4
    s_cbranch_vccz pd_42
    s_sub_u32 s78, s78, 1
    s_cmp_lg_u32 s78, 0
    s_cbranch_scc1 pl_40
    s_mov_b32 s27, 1
pd_42:
    v_mov_b32 v4, v0
    s_nop 1
    v_max_f32_dpp v4, v4, v4 quad_perm:[1,0,3,2] row_mask:0xf bank_mask:0xf
    s_nop 1
    v_max_f32_dpp v4, v4, v4 quad_perm:[2,3,0,1] row_mask:0xf bank_mask:0xf
    s_nop 1
    v_max_f32_dpp v4, v4, v4 row_half_mirror row_mask:0xf bank_mask:0xf
    s_nop 1
    v_max_f32_dpp v4, v4, v4 row_mirror row_mask:0xf bank_mask:0xf
    v_mov_b32 v5, v4
    s_nop 1
    v_permlane16_swap_b32 v4, v5
    v_max_f32 v4, v4, v5
    v_mov_b32 v5, v4
    s_nop 1
    v_permlane32_swap_b32 v4, v5
    v_max_f32 v4, v4, v5
    v_cmp_eq_f32 vcc, v4, v0
    s_ff1_i32_b64 s32, vcc
    s_and_b32 s32, s32, 63
    s_lshl_b64 exec, 1, s32
    ds_write_b128 v189, v[0:3] offset:3072
    s_mov_b64 exec, -1
sk_39:
    s_waitcnt lgkmcnt(0)
    s_barrier
    ds_read_b32 v0, v189 offset:3076
    s_waitcnt lgkmcnt(0)
    v_and_b32 v0, 0x7ff, v0
    v_cmp_ne_u32_e64 vcc, v0, v53
    s_and_b64 exec, vcc, s[38:39]
    s_cbranch_execz k_end
    buffer_store_dwordx4 v[64:67], v50, s[12:15], s33 offen offset:0
    buffer_store_dwordx4 v[68:71], v50, s[12:15], s33 offen offset:32
    buffer_store_dwordx4 v[72:75], v50, s[12:15], s33 offen offset:64
    buffer_store_dwordx4 v[76:79], v50, s[12:15], s33 offen offset:96
    s_mov_b64 exec, -1
    s_branch k_end
    s_nop 0
l_start:
    v_lshrrev_b32 v21, 3, v252
    v_lshrrev_b32 v20, 4, v252
    v_xor_b32 v20, v20, v252
    v_and_b32 v20, 7, v20
    v_lshlrev_b32 v20, 4, v20
    v_lshl_add_u32 v4, v21, 11, v20
    v_xor_b32_e64 v5, 64, v4
    v_add_u32 v5, 15360, v5
    v_add_u32 v6, 30720, v4
    v_add_u32 v7, 30720, v5
    s_lshl_b32 s84, s99, 16
    s_lshl_b32 s85, s25, 7
    s_lshl_b32 s86, s28, 12
    s_mul_i32 s87, s28, 6144
    v_and_b32 v20, 4, v21
    v_add_u32_e64 v20, v20, v21
    v_mul_u32_u24 v20, 6144, v20
    v_and_b32 v21, 6, v21
    v_xor_b32 v21, v21, v252
    v_and_b32 v21, 7, v21
    v_lshl_add_u32 v20, v21, 4, v20
    s_mul_i32 s32, s28, 3
    s_bfe_u32 s33, s32, 0x10001
    s_mul_i32 s33, s33, 196608
    s_and_b32 s34, s32, 1
    s_mul_i32 s34, s34, 24576
    s_add_u32 s33, s33, s34
    s_lshr_b32 s34, s32, 2
    s_lshl_b32 s34, s34, 11
    s_add_u32 s33, s33, s34
    v_add_u32 v8, s33, v20
    v_add_u32 v9, 97280, v8
    s_add_u32 s32, s32, 1
    s_bfe_u32 s33, s32, 0x10001
    s_mul_i32 s33, s33, 196608
    s_and_b32 s34, s32, 1
    s_mul_i32 s34, s34, 24576
    s_add_u32 s33, s33, s34
    s_lshr_b32 s34, s32, 2
    s_lshl_b32 s34, s34, 11
    s_add_u32 s33, s33, s34
    s_sub_u32 s33, s33, 2048
    v_add_u32 v10, s33, v20
    v_add_u32 v11, 97280, v10
    s_add_u32 s32, s32, 1
    s_bfe_u32 s33, s32, 0x10001
    s_mul_i32 s33, s33, 196608
    s_and_b32 s34, s32, 1
    s_mul_i32 s34, s34, 24576
    s_add_u32 s33, s33, s34
    s_lshr_b32 s34, s32, 2
    s_lshl_b32 s34, s34, 11
    s_add_u32 s33, s33, s34
    v_add_u32 v12, s33, v20
    v_add_u32 v13, 97280, v12
    s_waitcnt lgkmcnt(0)
    s_mov_b32 s88, 0xdd8000
    s_load_dword s88, s[20:21], s88
    s_mov_b64 s[16:17], s[6:7]
    s_mov_b32 s6, 0x400000
    s_mov_b32 s7, 0x20000
    s_add_u32 s96, s94, 0
    s_and_b32 s96, s96, 15
    s_lshl_b32 s97, s96, 7
    s_add_u32 s97, s97, s84
    s_add_u32 m0, s86, 147456
    s_nop 0
    buffer_load_dwordx4 v4, s[4:7], s97 offen offset:0 lds
    buffer_load_dwordx4 v5, s[4:7], s97 offen offset:1024 lds
    buffer_load_dwordx4 v6, s[4:7], s97 offen offset:2048 lds
    buffer_load_dwordx4 v7, s[4:7], s97 offen offset:3072 lds
    s_add_u32 s96, s94, 0
    s_and_b32 s96, s96, 15
    s_mul_i32 s96, s96, 393216
    s_add_u32 s96, s96, s85
    s_add_u32 m0, s87, 40960
    s_nop 0
    buffer_load_dwordx4 v8, s[16:19], s96 offen offset:0 lds
    buffer_load_dwordx4 v9, s[16:19], s96 offen offset:1024 lds
    buffer_load_dwordx4 v10, s[16:19], s96 offen offset:2048 lds
    buffer_load_dwordx4 v11, s[16:19], s96 offen offset:3072 lds
    s_mov_b32 s40, 0xffffffff
    s_mov_b32 s41, 0xfffffff0
    s_mov_b32 s42, 0xfffffffe
    s_mov_b32 s43, 0xffffffe0
    s_mov_b32 s44, 0xfffffffc
    s_mov_b32 s45, 0xffffffc0
    s_mov_b32 s46, 0xfffffff8
    s_mov_b32 s47, 0xffffff80
    s_mov_b32 s48, 0xffff0000
    s_mov_b32 s49, 0xfff00000
    s_mov_b32 s50, 0xfffe0000
    s_mov_b32 s51, 0xffe00000
    s_mov_b32 s52, 0xfffc0000
    s_mov_b32 s53, 0xffc00000
    s_mov_b32 s54, 0xfff80000
    s_mov_b32 s55, 0xff800000
    s_mov_b32 s56, 0xffffff00
    s_mov_b32 s57, 0xfffff000
    s_mov_b32 s58, 0xfffffe00
    s_mov_b32 s59, 0xffffe000
    s_mov_b32 s60, 0xfffffc00
    s_mov_b32 s61, 0xffffc000
    s_mov_b32 s62, 0xfffff800
    s_mov_b32 s63, 0xffff8000
    s_mov_b32 s64, 0xff000000
    s_mov_b32 s65, 0xf0000000
    s_mov_b32 s66, 0xfe000000
    s_mov_b32 s67, 0xe0000000
    s_mov_b32 s68, 0xfc000000
    s_mov_b32 s69, 0xc0000000
    s_mov_b32 s70, 0xf8000000
    s_mov_b32 s71, 0x80000000
    v_bfe_u32 v20, v252, 3, 2
    v_lshrrev_b32 v21, 5, v252
    v_lshl_add_u32 v20, v21, 3, v20
    s_lshr_b32 s32, s28, 1
    s_lshl_b32 s32, s32, 4
    s_and_b32 s33, s28, 1
    s_lshl_b32 s33, s33, 2
    s_add_u32 s32, s32, s33
    v_add_u32 v20, s32, v20
    v_lshlrev_b32 v20, 11, v20
    v_lshrrev_b32 v21, 2, v252
    v_and_b32 v21, 4, v21
    v_xor_b32 v21, v21, v252
    v_and_b32_e64 v21, 7, v21
    v_lshl_add_u32 v20, v21, 4, v20
    s_lshl_b32 s32, s98, 7
    v_add_u32 v14, s32, v20
    v_lshrrev_b32 v20, 2, v252
    v_lshlrev_b32 v20, 2, v20
    v_bfe_u32 v21, v252, 1, 1
    v_add_u32_e64 v20, v20, v21
    v_mul_u32_u24 v20, 28672, v20
    v_and_b32_e64 v21, 1, v252
    v_lshl_add_u32 v20, v21, 4, v20
    s_mul_i32 s30, s28, 1835008
    s_lshl_b32 s31, s29, 5
    s_add_u32 s30, s30, s31
    v_add_u32 v155, s30, v20
    v_lshlrev_b32 v21, 14, v21
    v_lshrrev_b32_e64 v20, 1, v252
    v_lshl_add_u32 v20, v20, 4, v21
    s_lshl_b32 s30, s28, 9
    s_lshl_b32 s31, s29, 15
    s_add_u32 s30, s30, s31
    v_add_u32 v153, s30, v20
    s_load_dwordx2 s[80:81], s[0:1], 40
    s_cmp_lt_u32 s29, 224
    s_cselect_b32 s82, 0x700000, 0
    s_mov_b32 s83, 0x20000
    s_load_dwordx2 s[12:13], s[0:1], 56
    s_cmp_lt_u32 s29, 224
    s_cselect_b32 s14, 0x700000, 0
    s_mov_b32 s15, 0x20000
    s_mov_b32 s73, -1
    s_mov_b32 s100, 0
    s_sub_u32 s30, s25, s24
    s_add_u32 s30, s30, 31
    v_and_b32 v15, 16, v252
    v_mul_u32_u24 v15, s30, v15
    v_and_b32 v20, 31, v252
    v_add_lshl_u32 v15, v15, v20, 3
    s_lshl_b32 s30, s24, 7
    s_add_u32 s30, s30, 0xdd9000
    v_add_u32_e64 v15, s30, v15
    s_add_u32 m0, s87, 45056
    s_nop 0
    buffer_load_dwordx4 v12, s[16:19], s96 offen offset:0 lds
    buffer_load_dwordx4 v13, s[16:19], s96 offen offset:1024 lds
    s_add_u32 s96, s95, 1
    s_and_b32 s96, s96, 15
    s_lshl_b32 s97, s96, 7
    s_add_u32 s97, s97, s84
    s_add_u32 m0, s86, 131072
    s_nop 0
    buffer_load_dwordx4 v4, s[4:7], s97 offen offset:0 lds
    buffer_load_dwordx4 v5, s[4:7], s97 offen offset:1024 lds
    buffer_load_dwordx4 v6, s[4:7], s97 offen offset:2048 lds
    buffer_load_dwordx4 v7, s[4:7], s97 offen offset:3072 lds
    s_add_u32 s96, s95, 1
    s_and_b32 s96, s96, 15
    s_mul_i32 s96, s96, 393216
    s_add_u32 s96, s96, s85
    s_add_u32 m0, s87, 65536
    s_nop 0
    buffer_load_dwordx4 v8, s[16:19], s96 offen offset:0 lds
    buffer_load_dwordx4 v9, s[16:19], s96 offen offset:1024 lds
    buffer_load_dwordx4 v10, s[16:19], s96 offen offset:2048 lds
    s_waitcnt vmcnt(7) lgkmcnt(0)
    s_add_u32 s88, s88, 0x9e3779b9
    s_barrier
    buffer_load_dwordx4 v11, s[16:19], s96 offen offset:3072 lds
    s_add_u32 m0, s87, 69632
    s_nop 0
    buffer_load_dwordx4 v12, s[16:19], s96 offen offset:0 lds
    buffer_load_dwordx4 v13, s[16:19], s96 offen offset:1024 lds
    s_add_u32 s96, s94, 2
    s_and_b32 s96, s96, 15
    s_lshl_b32 s97, s96, 7
    s_add_u32 s97, s97, s84
    s_add_u32 m0, s86, 114688
    s_nop 0
    buffer_load_dwordx4 v4, s[4:7], s97 offen offset:0 lds
    buffer_load_dwordx4 v5, s[4:7], s97 offen offset:1024 lds
    buffer_load_dwordx4 v6, s[4:7], s97 offen offset:2048 lds
    buffer_load_dwordx4 v7, s[4:7], s97 offen offset:3072 lds
    s_add_u32 s96, s94, 2
    s_and_b32 s96, s96, 15
    s_mul_i32 s96, s96, 393216
    s_add_u32 s96, s96, s85
    s_add_u32 m0, s87, 90112
    s_nop 0
    buffer_load_dwordx4 v8, s[16:19], s96 offen offset:0 lds
    buffer_load_dwordx4 v9, s[16:19], s96 offen offset:1024 lds
    buffer_load_dwordx4 v10, s[16:19], s96 offen offset:2048 lds
    buffer_load_dwordx4 v11, s[16:19], s96 offen offset:3072 lds
    s_add_u32 m0, s87, 94208
    s_nop 0
    buffer_load_dwordx4 v12, s[16:19], s96 offen offset:0 lds
    buffer_load_dwordx4 v13, s[16:19], s96 offen offset:1024 lds
    s_waitcnt vmcnt(10) lgkmcnt(0)
    s_barrier
    s_add_u32 s96, s95, 3
    s_and_b32 s96, s96, 15
    s_lshl_b32 s97, s96, 7
    s_add_u32 s97, s97, s84
    s_add_u32 m0, s86, 147456
    s_nop 0
    buffer_load_dwordx4 v4, s[4:7], s97 offen offset:0 lds
    buffer_load_dwordx4 v5, s[4:7], s97 offen offset:1024 lds
    v_and_b32_e64 v28, 31, v252
    v_bfe_u32 v29, v28, 1, 3
    v_lshrrev_b32 v30, 5, v252
    v_xor_b32 v29, v29, v30
    v_lshlrev_b32_e64 v29, 4, v29
    v_lshl_add_u32 v28, v28, 7, v29
    s_add_u32 s30, s86, 131072
    buffer_load_dwordx4 v6, s[4:7], s97 offen offset:2048 lds
    v_add_u32 v28, s30, v28
    v_xor_b32 v29, 32, v28
    v_xor_b32_e64 v30, 64, v28
    v_xor_b32 v31, 96, v28
    ds_read_b128 v[32:35], v28
    ds_read_b128 v[36:39], v29
    ds_read_b128 v[40:43], v30
    buffer_load_dwordx4 v7, s[4:7], s97 offen offset:3072 lds
    ds_read_b128 v[44:47], v31
    s_min_u32 s30, s28, 2
    s_lshl_b32 s30, s30, 13
    s_add_u32 s30, s30, 65536
    v_lshrrev_b32_e64 v20, 2, v252
    v_bfe_u32 v21, v20, 1, 2
    v_lshlrev_b32_e64 v20, 7, v20
    s_add_u32 s96, s95, 3
    s_and_b32 s96, s96, 15
    s_mul_i32 s96, s96, 393216
    s_add_u32 s96, s96, s85
    s_add_u32 m0, s87, 40960
    s_nop 0
    buffer_load_dwordx4 v8, s[16:19], s96 offen offset:0 lds
    v_lshl_add_u32 v20, v21, 5, v20
    v_and_b32_e64 v21, 3, v252
    v_lshl_add_u32 v20, v21, 3, v20
    v_add_u32 v144, s30, v20
    v_xor_b32 v145, 32, v144
    v_xor_b32_e64 v146, 64, v144
    v_xor_b32 v147, 96, v144
    buffer_load_dwordx4 v9, s[16:19], s96 offen offset:1024 lds
    ds_read_b64_tr_b16 v[100:101], v144 offset:0
    ds_read_b64_tr_b16 v[102:103], v144 offset:2048
    ds_read_b64_tr_b16 v[104:105], v144 offset:4096
    ds_read_b64_tr_b16 v[106:107], v144 offset:6144
    ds_read_b64_tr_b16 v[108:109], v145 offset:0
    ds_read_b64_tr_b16 v[110:111], v145 offset:2048
    ds_read_b64_tr_b16 v[112:113], v145 offset:4096
    buffer_load_dwordx4 v10, s[16:19], s96 offen offset:2048 lds
    ds_read_b64_tr_b16 v[114:115], v145 offset:6144
    ds_read_b64_tr_b16 v[116:117], v146 offset:0
    ds_read_b64_tr_b16 v[118:119], v146 offset:2048
    ds_read_b64_tr_b16 v[120:121], v146 offset:4096
    ds_read_b64_tr_b16 v[122:123], v146 offset:6144
    ds_read_b64_tr_b16 v[124:125], v147 offset:0
    ds_read_b64_tr_b16 v[126:127], v147 offset:2048
    buffer_load_dwordx4 v11, s[16:19], s96 offen offset:3072 lds
    ds_read_b64_tr_b16 v[128:129], v147 offset:4096
    ds_read_b64_tr_b16 v[130:131], v147 offset:6144
    v_mov_b32 v16, -1
    v_mov_b32 v17, -1
    v_mov_b32_e64 v18, -1
    v_mov_b32 v19, -1
    s_lshr_b32 s30, s28, 1
    s_add_u32 m0, s87, 45056
    s_nop 0
    buffer_load_dwordx4 v12, s[16:19], s96 offen offset:0 lds
    s_mul_i32 s30, s30, 16777216
    s_and_b32 s31, s28, 1
    s_lshl_b32 s32, s31, 20
    s_lshl_b32 s33, s72, 10
    s_add_u32 s32, s32, s33
    s_add_u32 s32, s32, s30
    s_add_u32 s32, s32, 0xc00000
    buffer_load_dwordx4 v13, s[16:19], s96 offen offset:1024 lds
    buffer_store_dwordx4 v[16:19], v253, s[20:23], s32 offen sc1
    s_add_u32 s32, s32, 262144
    buffer_store_dwordx4 v[16:19], v253, s[20:23], s32 offen sc1
    s_add_u32 s32, s32, 262144
    buffer_store_dwordx4 v[16:19], v253, s[20:23], s32 offen sc1
    s_add_u32 s32, s32, 262144
    s_lshl_b32 s33, s72, 7
    s_add_u32 s33, s33, s30
    s_add_u32 s33, s33, 0xdc0000
    s_cmp_eq_u32 s31, 0
    s_cselect_b32 s32, s32, s33
    s_cselect_b64 exec, -1, 0xff
    buffer_store_dwordx4 v[16:19], v253, s[20:23], s32 offen sc1
    s_mov_b64 exec, -1
    s_waitcnt vmcnt(14) lgkmcnt(0)
    s_barrier
    s_add_u32 s96, s94, 4
    s_and_b32 s96, s96, 15
    s_lshl_b32 s97, s96, 7
    s_add_u32 s97, s97, s84
    s_add_u32 m0, s86, 131072
    s_nop 0
    buffer_load_dwordx4 v4, s[4:7], s97 offen offset:0 lds
    buffer_load_dwordx4 v5, s[4:7], s97 offen offset:1024 lds
    v_mov_b32_e64 v48, 0
    buffer_load_dwordx4 v6, s[4:7], s97 offen offset:2048 lds
    v_mov_b32_e64 v49, 0
    buffer_load_dwordx4 v7, s[4:7], s97 offen offset:3072 lds
    v_mov_b32_e64 v50, 0
    s_add_u32 s96, s94, 4
    s_and_b32 s96, s96, 15
    s_mul_i32 s96, s96, 393216
    s_add_u32 s96, s96, s85
    s_add_u32 m0, s87, 65536
    s_nop 0
    buffer_load_dwordx4 v8, s[16:19], s96 offen offset:0 lds
    v_mov_b32_e64 v51, 0
    buffer_load_dwordx4 v9, s[16:19], s96 offen offset:1024 lds
    v_mov_b32_e64 v140, 0
    buffer_load_dwordx4 v10, s[16:19], s96 offen offset:2048 lds
    v_mov_b32_e64 v141, 0
    buffer_load_dwordx4 v11, s[16:19], s96 offen offset:3072 lds
    v_mov_b32 v142, 0
    s_add_u32 m0, s87, 69632
    s_nop 0
    buffer_load_dwordx4 v12, s[16:19], s96 offen offset:0 lds
    v_mov_b32_e64 v143, 0
    buffer_load_dwordx4 v13, s[16:19], s96 offen offset:1024 lds
    v_dot2c_f32_bf16 v140, 0x3f803f80, v100
    v_dot2c_f32_bf16 v141, 0x3f803f80, v108
    v_dot2c_f32_bf16 v142, 0x3f803f80, v116
    v_dot2c_f32_bf16 v143, 0x3f803f80, v124
    v_dot2c_f32_bf16 v140, 0x3f803f80, v101
    v_dot2c_f32_bf16 v141, 0x3f803f80, v109
    v_dot2c_f32_bf16 v142, 0x3f803f80, v117
    v_dot2c_f32_bf16 v143, 0x3f803f80, v125
    v_dot2c_f32_bf16 v140, 0x3f803f80, v102
    v_dot2c_f32_bf16 v141, 0x3f803f80, v110
    v_dot2c_f32_bf16 v142, 0x3f803f80, v118
    v_dot2c_f32_bf16 v143, 0x3f803f80, v126
    v_dot2c_f32_bf16 v140, 0x3f803f80, v103
    v_dot2c_f32_bf16 v141, 0x3f803f80, v111
    v_dot2c_f32_bf16 v142, 0x3f803f80, v119
    v_dot2c_f32_bf16 v143, 0x3f803f80, v127
    v_dot2c_f32_bf16 v140, 0x3f803f80, v104
    v_dot2c_f32_bf16 v141, 0x3f803f80, v112
    v_dot2c_f32_bf16 v142, 0x3f803f80, v120
    v_dot2c_f32_bf16 v143, 0x3f803f80, v128
    v_dot2c_f32_bf16 v140, 0x3f803f80, v105
    v_dot2c_f32_bf16 v141, 0x3f803f80, v113
    v_dot2c_f32_bf16 v142, 0x3f803f80, v121
    v_dot2c_f32_bf16 v143, 0x3f803f80, v129
    v_dot2c_f32_bf16 v140, 0x3f803f80, v106
    v_dot2c_f32_bf16 v141, 0x3f803f80, v114
    v_dot2c_f32_bf16 v142, 0x3f803f80, v122
    v_dot2c_f32_bf16 v143, 0x3f803f80, v130
    v_dot2c_f32_bf16 v140, 0x3f803f80, v107
    v_dot2c_f32_bf16 v141, 0x3f803f80, v115
    v_dot2c_f32_bf16 v142, 0x3f803f80, v123
    v_dot2c_f32_bf16 v143, 0x3f803f80, v131
    v_dot2c_f32_bf16 v48, 0x3f803f80, v32
    v_dot2c_f32_bf16 v49, v32, v32
    v_dot2c_f32_bf16 v50, 0x3f803f80, v33
    v_dot2c_f32_bf16 v51, v33, v33
    v_dot2c_f32_bf16 v48, 0x3f803f80, v34
    v_dot2c_f32_bf16 v49, v34, v34
    v_dot2c_f32_bf16 v50, 0x3f803f80, v35
    v_dot2c_f32_bf16 v51, v35, v35
    v_dot2c_f32_bf16 v48, 0x3f803f80, v36
    v_dot2c_f32_bf16 v49, v36, v36
    v_dot2c_f32_bf16 v50, 0x3f803f80, v37
    v_dot2c_f32_bf16 v51, v37, v37
    v_dot2c_f32_bf16 v48, 0x3f803f80, v38
    v_dot2c_f32_bf16 v49, v38, v38
    v_dot2c_f32_bf16 v50, 0x3f803f80, v39
    v_dot2c_f32_bf16 v51, v39, v39
    v_dot2c_f32_bf16 v48, 0x3f803f80, v40
    v_dot2c_f32_bf16 v49, v40, v40
    v_dot2c_f32_bf16 v50, 0x3f803f80, v41
    v_dot2c_f32_bf16 v51, v41, v41
    v_dot2c_f32_bf16 v48, 0x3f803f80, v42
    v_dot2c_f32_bf16 v49, v42, v42
    v_dot2c_f32_bf16 v50, 0x3f803f80, v43
    v_dot2c_f32_bf16 v51, v43, v43
    v_dot2c_f32_bf16 v48, 0x3f803f80, v44
    v_dot2c_f32_bf16 v49, v44, v44
    v_dot2c_f32_bf16 v50, 0x3f803f80, v45
    v_dot2c_f32_bf16 v51, v45, v45
    v_dot2c_f32_bf16 v48, 0x3f803f80, v46
    v_dot2c_f32_bf16 v49, v46, v46
    v_dot2c_f32_bf16 v50, 0x3f803f80, v47
    v_dot2c_f32_bf16 v51, v47, v47
    s_waitcnt vmcnt(14) lgkmcnt(0)
    s_barrier
    s_add_u32 s96, s95, 5
    s_and_b32 s96, s96, 15
    s_lshl_b32 s97, s96, 7
    s_add_u32 s97, s97, s84
    s_add_u32 m0, s86, 114688
    s_nop 0
    buffer_load_dwordx4 v4, s[4:7], s97 offen offset:0 lds
    buffer_load_dwordx4 v5, s[4:7], s97 offen offset:1024 lds
    s_lshl_b32 s30, s99, 12
    s_lshl_b32 s31, s25, 8
    buffer_load_dwordx4 v6, s[4:7], s97 offen offset:2048 lds
    s_add_u32 s30, s30, s31
    s_add_u32 s30, s30, 0x2400000
    buffer_load_dwordx4 v7, s[4:7], s97 offen offset:3072 lds
    v_lshlrev_b32_e64 v28, 3, v252
    s_add_u32 s96, s95, 5
    s_and_b32 s96, s96, 15
    s_mul_i32 s96, s96, 393216
    s_add_u32 s96, s96, s85
    s_add_u32 m0, s87, 90112
    s_nop 0
    buffer_load_dwordx4 v8, s[16:19], s96 offen offset:0 lds
    v_add_f32 v48, v48, v50
    v_add_f32 v49, v49, v51
    buffer_load_dwordx4 v9, s[16:19], s96 offen offset:1024 lds
    v_mov_b32 v50, v48
    v_mov_b32 v51, v49
    buffer_load_dwordx4 v10, s[16:19], s96 offen offset:2048 lds
    v_permlane32_swap_b32_e64 v48, v50
    buffer_load_dwordx4 v11, s[16:19], s96 offen offset:3072 lds
    v_permlane32_swap_b32 v49, v51
    v_add_f32 v48, v48, v50
    s_add_u32 m0, s87, 94208
    s_nop 0
    buffer_load_dwordx4 v12, s[16:19], s96 offen offset:0 lds
    v_add_f32 v49, v49, v51
    buffer_load_dwordx4 v13, s[16:19], s96 offen offset:1024 lds
    s_mov_b32 exec_hi, 0
    buffer_store_dwordx2 v[48:49], v28, s[20:23], s30 offen sc1
    s_mov_b64 exec, -1
    s_min_u32 s32, s28, 2
    s_lshl_b32 s32, s32, 12
    s_lshl_b32 s33, s25, 14
    s_add_u32 s32, s32, s33
    s_add_u32 s32, s32, 0x2500000
    s_lshl_b32 s33, s24, 8
    s_add_u32 s32, s32, s33
    v_lshlrev_b32 v20, 2, v252
    v_permlane32_swap_b32 v140, v142
    v_permlane32_swap_b32 v141, v143
    v_add_f32 v140, v140, v142
    v_add_f32 v141, v141, v143
    s_nop 1
    v_permlane16_swap_b32_e64 v140, v141
    v_add_f32 v140, v140, v141
    buffer_store_dword v140, v20, s[20:23], s32 offen sc1
    s_waitcnt vmcnt(12) lgkmcnt(0)
    s_barrier
    s_add_u32 s96, s94, 6
    s_and_b32 s96, s96, 15
    s_lshl_b32 s97, s96, 7
    s_add_u32 s97, s97, s84
    s_add_u32 m0, s86, 147456
    s_nop 0
    buffer_load_dwordx4 v4, s[4:7], s97 offen offset:0 lds
    buffer_load_dwordx4 v5, s[4:7], s97 offen offset:1024 lds
    buffer_load_dwordx4 v6, s[4:7], s97 offen offset:2048 lds
    buffer_load_dwordx4 v7, s[4:7], s97 offen offset:3072 lds
    s_add_u32 s96, s94, 6
    s_and_b32 s96, s96, 15
    s_mul_i32 s96, s96, 393216
    s_add_u32 s96, s96, s85
    s_add_u32 m0, s87, 40960
    s_nop 0
    buffer_load_dwordx4 v8, s[16:19], s96 offen offset:0 lds
    buffer_load_dwordx4 v9, s[16:19], s96 offen offset:1024 lds
    buffer_load_dwordx4 v10, s[16:19], s96 offen offset:2048 lds
    buffer_load_dwordx4 v11, s[16:19], s96 offen offset:3072 lds
    s_add_u32 m0, s87, 45056
    s_nop 0
    buffer_load_dwordx4 v12, s[16:19], s96 offen offset:0 lds
    buffer_load_dwordx4 v13, s[16:19], s96 offen offset:1024 lds
    s_waitcnt vmcnt(10) lgkmcnt(0)
    s_barrier
    s_add_u32 s96, s95, 7
    s_and_b32 s96, s96, 15
    s_lshl_b32 s97, s96, 7
    s_add_u32 s97, s97, s84
    s_add_u32 m0, s86, 131072
    s_nop 0
    buffer_load_dwordx4 v4, s[4:7], s97 offen offset:0 lds
    buffer_load_dwordx4 v5, s[4:7], s97 offen offset:1024 lds
    buffer_load_dwordx4 v6, s[4:7], s97 offen offset:2048 lds
    buffer_load_dwordx4 v7, s[4:7], s97 offen offset:3072 lds
    s_add_u32 s96, s95, 7
    s_and_b32 s96, s96, 15
    s_mul_i32 s96, s96, 393216
    s_add_u32 s96, s96, s85
    s_add_u32 m0, s87, 65536
    s_nop 0
    buffer_load_dwordx4 v8, s[16:19], s96 offen offset:0 lds
    buffer_load_dwordx4 v9, s[16:19], s96 offen offset:1024 lds
    buffer_load_dwordx4 v10, s[16:19], s96 offen offset:2048 lds
    buffer_load_dwordx4 v11, s[16:19], s96 offen offset:3072 lds
    s_add_u32 m0, s87, 69632
    s_nop 0
    buffer_load_dwordx4 v12, s[16:19], s96 offen offset:0 lds
    buffer_load_dwordx4 v13, s[16:19], s96 offen offset:1024 lds
    s_waitcnt vmcnt(10) lgkmcnt(0)
    s_barrier
    s_add_u32 s96, s94, 8
    s_and_b32 s96, s96, 15
    s_lshl_b32 s97, s96, 7
    s_add_u32 s97, s97, s84
    s_add_u32 m0, s86, 114688
    s_nop 0
    buffer_load_dwordx4 v4, s[4:7], s97 offen offset:0 lds
    buffer_load_dwordx4 v5, s[4:7], s97 offen offset:1024 lds
    buffer_load_dwordx4 v6, s[4:7], s97 offen offset:2048 lds
    buffer_load_dwordx4 v7, s[4:7], s97 offen offset:3072 lds
    s_add_u32 s96, s94, 8
    s_and_b32 s96, s96, 15
    s_mul_i32 s96, s96, 393216
    s_add_u32 s96, s96, s85
    s_add_u32 m0, s87, 90112
    s_nop 0
    buffer_load_dwordx4 v8, s[16:19], s96 offen offset:0 lds
    buffer_load_dwordx4 v9, s[16:19], s96 offen offset:1024 lds
    buffer_load_dwordx4 v10, s[16:19], s96 offen offset:2048 lds
    buffer_load_dwordx4 v11, s[16:19], s96 offen offset:3072 lds
    s_add_u32 m0, s87, 94208
    s_nop 0
    buffer_load_dwordx4 v12, s[16:19], s96 offen offset:0 lds
    buffer_load_dwordx4 v13, s[16:19], s96 offen offset:1024 lds
    s_waitcnt vmcnt(10) lgkmcnt(0)
    s_barrier
    s_add_u32 s96, s95, 9
    s_and_b32 s96, s96, 15
    s_lshl_b32 s97, s96, 7
    s_add_u32 s97, s97, s84
    s_add_u32 m0, s86, 147456
    s_nop 0
    buffer_load_dwordx4 v4, s[4:7], s97 offen offset:0 lds
    buffer_load_dwordx4 v5, s[4:7], s97 offen offset:1024 lds
    buffer_load_dwordx4 v6, s[4:7], s97 offen offset:2048 lds
    buffer_load_dwordx4 v7, s[4:7], s97 offen offset:3072 lds
    s_add_u32 s96, s95, 9
    s_and_b32 s96, s96, 15
    s_mul_i32 s96, s96, 393216
    s_add_u32 s96, s96, s85
    s_add_u32 m0, s87, 40960
    s_nop 0
    buffer_load_dwordx4 v8, s[16:19], s96 offen offset:0 lds
    buffer_load_dwordx4 v9, s[16:19], s96 offen offset:1024 lds
    buffer_load_dwordx4 v10, s[16:19], s96 offen offset:2048 lds
    buffer_load_dwordx4 v11, s[16:19], s96 offen offset:3072 lds
    s_add_u32 m0, s87, 45056
    s_nop 0
    buffer_load_dwordx4 v12, s[16:19], s96 offen offset:0 lds
    buffer_load_dwordx4 v13, s[16:19], s96 offen offset:1024 lds
    s_waitcnt vmcnt(10) lgkmcnt(0)
    s_barrier
    s_add_u32 s96, s94, 10
    s_and_b32 s96, s96, 15
    s_lshl_b32 s97, s96, 7
    s_add_u32 s97, s97, s84
    s_add_u32 m0, s86, 131072
    s_nop 0
    buffer_load_dwordx4 v4, s[4:7], s97 offen offset:0 lds
    buffer_load_dwordx4 v5, s[4:7], s97 offen offset:1024 lds
    buffer_load_dwordx4 v6, s[4:7], s97 offen offset:2048 lds
    buffer_load_dwordx4 v7, s[4:7], s97 offen offset:3072 lds
    s_add_u32 s96, s94, 10
    s_and_b32 s96, s96, 15
    s_mul_i32 s96, s96, 393216
    s_add_u32 s96, s96, s85
    s_add_u32 m0, s87, 65536
    s_nop 0
    buffer_load_dwordx4 v8, s[16:19], s96 offen offset:0 lds
    buffer_load_dwordx4 v9, s[16:19], s96 offen offset:1024 lds
    buffer_load_dwordx4 v10, s[16:19], s96 offen offset:2048 lds
    buffer_load_dwordx4 v11, s[16:19], s96 offen offset:3072 lds
    s_add_u32 m0, s87, 69632
    s_nop 0
    buffer_load_dwordx4 v12, s[16:19], s96 offen offset:0 lds
    buffer_load_dwordx4 v13, s[16:19], s96 offen offset:1024 lds
    s_waitcnt vmcnt(10) lgkmcnt(0)
    s_barrier
    s_add_u32 s96, s95, 11
    s_and_b32 s96, s96, 15
    s_lshl_b32 s97, s96, 7
    s_add_u32 s97, s97, s84
    s_add_u32 m0, s86, 114688
    s_nop 0
    buffer_load_dwordx4 v4, s[4:7], s97 offen offset:0 lds
    buffer_load_dwordx4 v5, s[4:7], s97 offen offset:1024 lds
    buffer_load_dwordx4 v6, s[4:7], s97 offen offset:2048 lds
    buffer_load_dwordx4 v7, s[4:7], s97 offen offset:3072 lds
    s_add_u32 s96, s95, 11
    s_and_b32 s96, s96, 15
    s_mul_i32 s96, s96, 393216
    s_add_u32 s96, s96, s85
    s_add_u32 m0, s87, 90112
    s_nop 0
    buffer_load_dwordx4 v8, s[16:19], s96 offen offset:0 lds
    buffer_load_dwordx4 v9, s[16:19], s96 offen offset:1024 lds
    buffer_load_dwordx4 v10, s[16:19], s96 offen offset:2048 lds
    buffer_load_dwordx4 v11, s[16:19], s96 offen offset:3072 lds
    s_add_u32 m0, s87, 94208
    s_nop 0
    buffer_load_dwordx4 v12, s[16:19], s96 offen offset:0 lds
    buffer_load_dwordx4 v13, s[16:19], s96 offen offset:1024 lds
    s_waitcnt vmcnt(10) lgkmcnt(0)
    s_barrier
    s_add_u32 s96, s94, 12
    s_and_b32 s96, s96, 15
    s_lshl_b32 s97, s96, 7
    s_add_u32 s97, s97, s84
    s_add_u32 m0, s86, 147456
    s_nop 0
    buffer_load_dwordx4 v4, s[4:7], s97 offen offset:0 lds
    buffer_load_dwordx4 v5, s[4:7], s97 offen offset:1024 lds
    s_getpc_b64 s[32:33]
pc_43:
    buffer_load_dwordx4 v6, s[4:7], s97 offen offset:2048 lds
    s_sub_u32 s32, s32, pc_43-interleave_layers__sliding_block__moe_arch_mod__prompt_kernel
    s_subb_u32 s33, s33, 0
    buffer_load_dwordx4 v7, s[4:7], s97 offen offset:3072 lds
    s_lshr_b32 s34, s2, 3
    s_add_u32 s96, s94, 12
    s_and_b32 s96, s96, 15
    s_mul_i32 s96, s96, 393216
    s_add_u32 s96, s96, s85
    s_add_u32 m0, s87, 40960
    s_nop 0
    buffer_load_dwordx4 v8, s[16:19], s96 offen offset:0 lds
    s_lshl_b32 s34, s34, 2
    buffer_load_dwordx4 v9, s[16:19], s96 offen offset:1024 lds
    s_add_u32 s34, s34, s28
    s_and_b32 s34, s34, 127
    buffer_load_dwordx4 v10, s[16:19], s96 offen offset:2048 lds
    s_lshl_b32 s34, s34, 7
    buffer_load_dwordx4 v11, s[16:19], s96 offen offset:3072 lds
    v_lshl_add_u32 v154, v252, 14, s34
    s_mov_b32 s34, k_exit-interleave_layers__sliding_block__moe_arch_mod__prompt_kernel
    s_add_u32 m0, s87, 45056
    s_nop 0
    buffer_load_dwordx4 v12, s[16:19], s96 offen offset:0 lds
    s_mov_b32 s35, 0x20000
    buffer_load_dwordx4 v13, s[16:19], s96 offen offset:1024 lds
    buffer_load_dword v154, v154, s[32:35], 0 offen
    s_waitcnt vmcnt(11) lgkmcnt(0)
    s_barrier
    buffer_load_dwordx2 v[16:17], v15, s[20:23], 0 offen sc1
    s_add_u32 s96, s95, 13
    s_and_b32 s96, s96, 15
    s_lshl_b32 s97, s96, 7
    s_add_u32 s97, s97, s84
    s_add_u32 m0, s86, 131072
    s_nop 0
    buffer_load_dwordx4 v4, s[4:7], s97 offen offset:0 lds
    buffer_load_dwordx4 v5, s[4:7], s97 offen offset:1024 lds
    buffer_load_dwordx4 v6, s[4:7], s97 offen offset:2048 lds
    buffer_load_dwordx4 v7, s[4:7], s97 offen offset:3072 lds
    s_add_u32 s96, s95, 13
    s_and_b32 s96, s96, 15
    s_mul_i32 s96, s96, 393216
    s_add_u32 s96, s96, s85
    s_add_u32 m0, s87, 65536
    s_nop 0
    buffer_load_dwordx4 v8, s[16:19], s96 offen offset:0 lds
    buffer_load_dwordx4 v9, s[16:19], s96 offen offset:1024 lds
    buffer_load_dwordx4 v10, s[16:19], s96 offen offset:2048 lds
    buffer_load_dwordx4 v11, s[16:19], s96 offen offset:3072 lds
    s_add_u32 m0, s87, 69632
    s_nop 0
    buffer_load_dwordx4 v12, s[16:19], s96 offen offset:0 lds
    buffer_load_dwordx4 v13, s[16:19], s96 offen offset:1024 lds
    s_waitcnt vmcnt(12) lgkmcnt(0)
    s_barrier
    s_add_u32 s96, s94, 14
    s_and_b32 s96, s96, 15
    s_lshl_b32 s97, s96, 7
    s_add_u32 s97, s97, s84
    s_add_u32 m0, s86, 114688
    s_nop 0
    buffer_load_dwordx4 v4, s[4:7], s97 offen offset:0 lds
    buffer_load_dwordx4 v5, s[4:7], s97 offen offset:1024 lds
    buffer_load_dwordx4 v6, s[4:7], s97 offen offset:2048 lds
    buffer_load_dwordx4 v7, s[4:7], s97 offen offset:3072 lds
    s_add_u32 s96, s94, 14
    s_and_b32 s96, s96, 15
    s_mul_i32 s96, s96, 393216
    s_add_u32 s96, s96, s85
    s_add_u32 m0, s87, 90112
    s_nop 0
    buffer_load_dwordx4 v8, s[16:19], s96 offen offset:0 lds
    buffer_load_dwordx4 v9, s[16:19], s96 offen offset:1024 lds
    buffer_load_dwordx4 v10, s[16:19], s96 offen offset:2048 lds
    buffer_load_dwordx4 v11, s[16:19], s96 offen offset:3072 lds
    s_add_u32 m0, s87, 94208
    s_nop 0
    buffer_load_dwordx4 v12, s[16:19], s96 offen offset:0 lds
    buffer_load_dwordx4 v13, s[16:19], s96 offen offset:1024 lds
    s_mov_b32 s78, s27
    s_waitcnt vmcnt(20)
    s_branch pc_45
pl_44:
    buffer_load_dwordx2 v[16:17], v15, s[20:23], 0 offen sc1
    s_waitcnt vmcnt(0)
pc_45:
    v_cmp_ne_u32 vcc, s88, v16
    s_cbranch_vccz pd_46
    s_sub_u32 s78, s78, 1
    s_cmp_lg_u32 s78, 0
    s_cbranch_scc1 pl_44
    s_mov_b32 s27, 1
pd_46:
    s_getreg_b32 s30, hwreg(HW_REG_XCC_ID, 0, 4)
    v_cmp_ne_u32_e64 vcc, s30, v17
    s_and_b32 s30, vcc_lo, 0xffff
    s_cselect_b32 s77, 0, 1
    v_mov_b32 v20, s73
    v_mov_b32_e64 v21, s77
    v_mov_b32 v19, 0
    ds_write_b64 v19, v[20:21] offset:3072
    s_waitcnt vmcnt(10) lgkmcnt(0)
    s_barrier
    s_add_u32 s96, s95, 15
    s_and_b32 s96, s96, 15
    s_lshl_b32 s97, s96, 7
    s_add_u32 s97, s97, s84
    s_add_u32 m0, s86, 147456
    s_nop 0
    buffer_load_dwordx4 v4, s[4:7], s97 offen offset:0 lds
    buffer_load_dwordx4 v5, s[4:7], s97 offen offset:1024 lds
    buffer_load_dwordx4 v6, s[4:7], s97 offen offset:2048 lds
    buffer_load_dwordx4 v7, s[4:7], s97 offen offset:3072 lds
    s_add_u32 s96, s95, 15
    s_and_b32 s96, s96, 15
    s_mul_i32 s96, s96, 393216
    s_add_u32 s96, s96, s85
    s_add_u32 m0, s87, 40960
    s_nop 0
    buffer_load_dwordx4 v8, s[16:19], s96 offen offset:0 lds
    buffer_load_dwordx4 v9, s[16:19], s96 offen offset:1024 lds
    buffer_load_dwordx4 v10, s[16:19], s96 offen offset:2048 lds
    buffer_load_dwordx4 v11, s[16:19], s96 offen offset:3072 lds
    s_add_u32 m0, s87, 45056
    s_nop 0
    buffer_load_dwordx4 v12, s[16:19], s96 offen offset:0 lds
    buffer_load_dwordx4 v13, s[16:19], s96 offen offset:1024 lds
    s_waitcnt vmcnt(10) lgkmcnt(0)
    s_barrier
    s_load_dwordx2 s[4:5], s[0:1], 48
    s_cmp_lt_u32 s29, 224
    s_cselect_b32 s6, 0x700000, 0
    s_mov_b32 s7, 0x20000
    s_lshl_b32 s30, s99, 12
    s_add_u32 s30, s30, 0x2400000
    buffer_load_dwordx4 v[64:67], v253, s[20:23], s30 offen offset:0 sc1
    buffer_load_dwordx4 v[68:71], v253, s[20:23], s30 offen offset:1024 sc1
    buffer_load_dwordx4 v[72:75], v253, s[20:23], s30 offen offset:2048 sc1
    buffer_load_dwordx4 v[76:79], v253, s[20:23], s30 offen offset:3072 sc1
    s_min_u32 s32, s28, 2
    s_lshl_b32 s32, s32, 12
    s_lshl_b32 s33, s25, 14
    s_add_u32 s32, s32, s33
    s_add_u32 s32, s32, 0x2500000
    buffer_load_dwordx4 v[32:35], v253, s[20:23], s32 offen offset:0 sc1
    buffer_load_dwordx4 v[36:39], v253, s[20:23], s32 offen offset:1024 sc1
    buffer_load_dwordx4 v[40:43], v253, s[20:23], s32 offen offset:2048 sc1
    buffer_load_dwordx4 v[44:47], v253, s[20:23], s32 offen offset:3072 sc1
    s_add_u32 s96, s25, 1
    s_and_b32 s96, s96, 15
    s_lshl_b32 s96, s96, 17
    s_add_u32 m0, s101, 4096
    s_nop 0
    buffer_load_dwordx4 v14, s[8:11], s96 offen lds
    s_add_u32 s96, s25, 2
    s_and_b32 s96, s96, 15
    s_lshl_b32 s96, s96, 17
    s_add_u32 m0, s101, 8192
    s_nop 0
    buffer_load_dwordx4 v14, s[8:11], s96 offen lds
    s_add_u32 s96, s25, 3
    s_and_b32 s96, s96, 15
    s_lshl_b32 s96, s96, 17
    s_add_u32 m0, s101, 12288
    s_nop 0
    buffer_load_dwordx4 v14, s[8:11], s96 offen lds
    s_waitcnt vmcnt(11) lgkmcnt(0)
    s_barrier
    s_waitcnt vmcnt(3)
    v_add_f32 v64, v64, v68
    v_add_f32 v65, v65, v69
    v_add_f32 v66, v66, v70
    v_add_f32 v67, v67, v71
    v_add_f32 v64, v64, v72
    v_add_f32 v65, v65, v73
    v_add_f32 v66, v66, v74
    v_add_f32 v67, v67, v75
    v_add_f32 v64, v64, v76
    v_add_f32 v65, v65, v77
    v_add_f32 v66, v66, v78
    v_add_f32 v67, v67, v79
    s_nop 0
    v_permlane32_swap_b32 v64, v66
    v_permlane32_swap_b32 v65, v67
    v_add_f32 v64, v64, v66
    v_add_f32 v65, v65, v67
    v_mov_b32 v48, v64
    v_mov_b32 v49, v65
    s_nop 0
    v_permlane16_swap_b32 v64, v48
    v_permlane16_swap_b32 v65, v49
    v_add_f32 v64, v64, v48
    v_add_f32_e64 v65, v65, v49
    v_mul_f32 v54, 0x3a800000, v64
    v_mul_f32 v65, 0x3a800000, v65
    v_fma_f32 v65, -v54, v54, v65
    v_max_f32_e64 v65, 0, v65
    v_add_f32 v55, 0x3727c5ac, v65
    v_rsq_f32 v55, v55
    v_add_f32 v32, v32, v36
    v_add_f32 v33, v33, v37
    v_add_f32 v34, v34, v38
    v_add_f32 v35, v35, v39
    v_add_f32 v32, v32, v40
    v_add_f32 v33, v33, v41
    v_add_f32 v34, v34, v42
    v_add_f32 v35, v35, v43
    v_add_f32 v32, v32, v44
    v_add_f32 v33, v33, v45
    v_add_f32 v34, v34, v46
    v_add_f32 v35, v35, v47
    s_nop 0
    v_permlane32_swap_b32 v32, v34
    v_permlane32_swap_b32 v33, v35
    v_add_f32 v32, v32, v34
    v_add_f32 v33, v33, v35
    s_nop 1
    v_permlane16_swap_b32 v32, v33
    v_add_f32 v32, v32, v33
    v_mov_b32 v2, v32
    v_and_b32 v48, 15, v252
    v_lshrrev_b32 v49, 5, v252
    v_lshl_add_u32 v48, v48, 1, v49
    v_bfe_u32 v49, v252, 4, 1
    v_cmp_eq_u32 vcc, 0, v49
    v_lshlrev_b32 v49, 9, v49
    v_lshl_add_u32 v48, v48, 2, v49
    s_lshl_b32 s32, s28, 7
    v_add_u32 v48, s32, v48
    v_cndmask_b32_e64 v49, v54, v55, vcc
    v_cndmask_b32 v50, 0, 1.0, vcc
    ds_write_b32 v48, v49 offset:0
    ds_write_b32 v48, v50 offset:2048
    v_and_b32 v48, 15, v252
    v_lshrrev_b32 v51, 4, v252
    v_lshl_add_u32 v48, v48, 2, v51
    s_min_u32 s32, s28, 2
    s_lshl_b32 s32, s32, 8
    v_lshl_add_u32 v48, v48, 2, s32
    ds_write_b32 v48, v2 offset:1024
    s_waitcnt lgkmcnt(0)
    s_barrier
l_att:
    s_add_u32 s96, s25, 10
    s_and_b32 s96, s96, 15
    s_lshl_b32 s96, s96, 17
    s_add_u32 m0, s101, 40960
    s_nop 0
    buffer_load_dwordx4 v14, s[8:11], s96 offen lds
    s_add_u32 s96, s25, 11
    s_and_b32 s96, s96, 15
    s_lshl_b32 s96, s96, 17
    s_add_u32 m0, s101, 45056
    s_nop 0
    buffer_load_dwordx4 v14, s[8:11], s96 offen lds
    s_cmp_lg_u32 s26, 0
    s_cbranch_scc1 sk_47
    s_add_u32 s96, s25, 4
    s_and_b32 s96, s96, 15
    s_lshl_b32 s96, s96, 17
    s_add_u32 m0, s101, 16384
    s_nop 0
    buffer_load_dwordx4 v14, s[8:11], s96 offen lds
    s_add_u32 s96, s25, 5
    s_and_b32 s96, s96, 15
    s_lshl_b32 s96, s96, 17
    s_add_u32 m0, s101, 20480
    s_nop 0
    buffer_load_dwordx4 v14, s[8:11], s96 offen lds
    s_add_u32 s96, s25, 6
    s_and_b32 s96, s96, 15
    s_lshl_b32 s96, s96, 17
    s_add_u32 m0, s101, 24576
    s_nop 0
    buffer_load_dwordx4 v14, s[8:11], s96 offen lds
    s_add_u32 s96, s25, 7
    s_and_b32 s96, s96, 15
    s_lshl_b32 s96, s96, 17
    s_add_u32 m0, s101, 28672
    s_nop 0
    buffer_load_dwordx4 v14, s[8:11], s96 offen lds
    s_add_u32 s96, s25, 8
    s_and_b32 s96, s96, 15
    s_lshl_b32 s96, s96, 17
    s_add_u32 m0, s101, 32768
    s_nop 0
    buffer_load_dwordx4 v14, s[8:11], s96 offen lds
    s_add_u32 s96, s25, 9
    s_and_b32 s96, s96, 15
    s_lshl_b32 s96, s96, 17
    s_add_u32 m0, s101, 36864
    s_nop 0
    buffer_load_dwordx4 v14, s[8:11], s96 offen lds
sk_47:
    v_mov_b32 v20, 0xffff
    v_mov_b32 v21, 0xffff0000
    v_cndmask_b32 v22, 0, v20, s[40:41]
    v_cndmask_b32 v23, 0, v21, s[42:43]
    v_or_b32_e64 v12, v22, v23
    v_cndmask_b32 v22, 0, v20, s[44:45]
    v_cndmask_b32 v23, 0, v21, s[46:47]
    v_or_b32_e64 v13, v22, v23
    v_cndmask_b32 v22, 0, v20, s[48:49]
    v_cndmask_b32 v23, 0, v21, s[50:51]
    v_or_b32_e64 v14, v22, v23
    v_cndmask_b32 v22, 0, v20, s[52:53]
    v_cndmask_b32 v23, 0, v21, s[54:55]
    v_or_b32_e64 v15, v22, v23
    v_cndmask_b32 v22, 0, v20, s[56:57]
    v_cndmask_b32 v23, 0, v21, s[58:59]
    v_or_b32_e64 v16, v22, v23
    v_cndmask_b32 v22, 0, v20, s[60:61]
    v_cndmask_b32 v23, 0, v21, s[62:63]
    v_or_b32_e64 v17, v22, v23
    v_cndmask_b32 v22, 0, v20, s[64:65]
    v_cndmask_b32 v23, 0, v21, s[66:67]
    v_or_b32_e64 v18, v22, v23
    v_cndmask_b32 v22, 0, v20, s[68:69]
    v_cndmask_b32 v23, 0, v21, s[70:71]
    v_or_b32 v19, v22, v23
    s_xor_b32 s76, s99, 3
    s_and_b32 s34, s76, 3
    s_lshl_b32 s33, s34, 12
    s_add_u32 s33, s33, 114688
    v_add_u32_e64 v20, s33, v253
    v_add_u32 v22, 32768, v20
    v_add_u32 v23, 143360, v253
    s_add_u32 s74, s34, 1
    s_mov_b32 s75, 0
    s_lshl_b32 s34, s34, 11
    s_add_u32 s34, s34, 57344
    v_add_u32 v3, s34, v253
    v_mov_b32 v21, 0xf149f2ca
    v_cndmask_b32 v24, v21, 0, s[40:41]
    v_cndmask_b32 v25, v21, 0, s[42:43]
    v_cndmask_b32 v26, v21, 0, s[44:45]
    v_cndmask_b32 v27, v21, 0, s[46:47]
    v_cndmask_b32 v28, v21, 0, s[48:49]
    v_cndmask_b32 v29, v21, 0, s[50:51]
    v_cndmask_b32 v30, v21, 0, s[52:53]
    v_cndmask_b32 v31, v21, 0, s[54:55]
    v_cndmask_b32 v32, v21, 0, s[56:57]
    v_cndmask_b32 v33, v21, 0, s[58:59]
    v_cndmask_b32 v34, v21, 0, s[60:61]
    v_cndmask_b32 v35, v21, 0, s[62:63]
    v_cndmask_b32 v36, v21, 0, s[64:65]
    v_cndmask_b32 v37, v21, 0, s[66:67]
    v_cndmask_b32 v38, v21, 0, s[68:69]
    v_cndmask_b32 v39, v21, 0, s[70:71]
    v_lshrrev_b32 v40, 2, v252
    v_xor_b32 v40, v40, v252
    v_bfe_u32 v40, v40, 2, 1
    v_add_u32_e64 v40, -1, v40
    v_and_b32 v40, 0x3f803f80, v40
    v_mov_b32 v41, v40
    v_mov_b32 v42, v40
    v_mov_b32 v43, v40
    v_mov_b32 v44, 0
    v_mov_b32 v45, 0
    v_mov_b32 v46, 0
    v_mov_b32 v47, 0
    v_mov_b32 v88, 0
    v_mov_b32 v89, 0
    v_mov_b32 v90, 0
    v_mov_b32 v91, 0
    v_mov_b32 v92, 0
    v_mov_b32 v93, 0
    v_mov_b32 v94, 0
    v_mov_b32 v95, 0
    v_mov_b32 v96, 0
    v_mov_b32 v97, 0
    v_mov_b32 v98, 0
    v_mov_b32 v99, 0
    v_mov_b32 v100, 0
    v_mov_b32 v101, 0
    v_mov_b32 v102, 0
    v_mov_b32 v103, 0
    s_cmp_eq_u32 s100, 2
    s_cbranch_scc1 sk_48
    s_barrier
sk_48:
    s_cmp_gt_u32 s100, 1
    s_cbranch_scc1 l_patch
l_patched:
l_nohalo:
    ds_read_b128 v[4:7], v3
    ds_read_b128 v[8:11], v3 offset:1024
    ds_read_b128 v[112:115], v22 offset:0
    ds_read_b128 v[116:119], v22 offset:1024
    s_waitcnt lgkmcnt(0)
    v_mfma_f32_32x32x16_bf16 v[56:71], v[112:115], v[4:7], v[24:39]
    v_mfma_f32_32x32x16_bf16 v[56:71], v[116:119], v[8:11], v[56:71]
    ds_read_b128 v[104:107], v23 offset:4096
    ds_read_b128 v[124:127], v22 offset:3072
    ds_read_b128 v[108:111], v23 offset:5120
    ds_read_b128 v[120:123], v22 offset:2048
    s_cmp_lg_u32 s26, 0
    s_cbranch_scc1 sk_50
    s_xor_b32 s96, s29, 0
    s_and_b32 s97, s96, 2
    s_and_b32 s96, s96, 3
    s_mul_i32 s97, s97, 14336
    s_mul_i32 s96, s96, 14336
    s_add_u32 s96, s96, s97
    buffer_load_dwordx4 v[156:159], v155, s[80:83], s96 offen
    s_xor_b32 s96, s29, 0
    s_and_b32 s97, s96, 2
    s_and_b32 s96, s96, 3
    s_mul_i32 s97, s97, 14336
    s_mul_i32 s96, s96, 14336
    s_add_u32 s96, s96, s97
    s_add_u32 s96, s96, 7168
    buffer_load_dwordx4 v[160:163], v155, s[80:83], s96 offen
    s_xor_b32 s96, s29, 1
    s_and_b32 s97, s96, 2
    s_and_b32 s96, s96, 3
    s_mul_i32 s97, s97, 14336
    s_mul_i32 s96, s96, 14336
    s_add_u32 s96, s96, s97
    buffer_load_dwordx4 v[164:167], v155, s[80:83], s96 offen
sk_50:
    s_nop 5
    v_max3_f32 v21, v56, v57, v58
    v_max3_f32 v152, v59, v60, v61
    v_max3_f32 v21, v21, v62, v63
    v_max3_f32 v152, v152, v64, v65
    v_max3_f32 v21, v21, v66, v67
    v_max3_f32 v152, v152, v68, v69
    v_max3_f32 v21, v21, v70, v71
    v_max_f32 v21, v21, v152
    v_mov_b32 v152, v21
    s_nop 1
    v_permlane32_swap_b32 v21, v152
    v_max_f32 v21, v21, v152
    v_sub_f32 v24, 0, v21
    v_sub_f32 v25, 0, v21
    v_sub_f32 v26, 0, v21
    v_sub_f32 v27, 0, v21
    v_sub_f32 v28, 0, v21
    v_sub_f32 v29, 0, v21
    v_sub_f32 v30, 0, v21
    v_sub_f32 v31, 0, v21
    v_sub_f32 v32, 0, v21
    v_sub_f32 v33, 0, v21
    v_sub_f32 v34, 0, v21
    v_sub_f32 v35, 0, v21
    v_sub_f32 v36, 0, v21
    v_sub_f32 v37, 0, v21
    v_sub_f32 v38, 0, v21
    v_sub_f32 v39, 0, v21
    s_branch a1_49_go
    s_nop 0
a1_49_mid:
    s_cmp_ge_u32 s76, 8
    s_cselect_b32 s33, 0, -1
    v_not_b32 v12, v12
    v_or_b32 v12, s33, v12
    v_not_b32 v13, v13
    v_or_b32 v13, s33, v13
    v_not_b32 v14, v14
    v_or_b32 v14, s33, v14
    v_not_b32 v15, v15
    v_or_b32 v15, s33, v15
    v_not_b32 v16, v16
    v_or_b32 v16, s33, v16
    v_not_b32 v17, v17
    v_or_b32 v17, s33, v17
    v_not_b32 v18, v18
    v_or_b32 v18, s33, v18
    v_not_b32 v19, v19
    v_or_b32 v19, s33, v19
    s_and_b32 s32, s76, 3
    s_cmp_ge_u32 s76, 8
    s_cselect_b32 s32, s32, 4
    s_sub_u32 s74, 8, s32
    s_lshl_b32 s32, s32, 12
    s_add_u32 s32, s32, 114688
    v_add_u32 v22, s32, v253
    v_add_u32 v23, s32, v253
    s_cmp_eq_u32 s26, 0
    s_cselect_b32 s75, 2, 1
    s_cmp_eq_u32 s100, 1
    s_cbranch_scc1 l_patch
l_pmid:
    s_cmp_eq_u32 s100, 1
    s_cbranch_scc1 sk_51
    s_barrier
sk_51:
    s_waitcnt vmcnt(3)
    s_cmp_eq_u32 s26, 0
    s_cbranch_scc1 sk_52
    s_waitcnt vmcnt(0)
sk_52:
    s_cmp_lg_u32 s100, 1
    s_cbranch_scc1 sk_53
    s_cmp_lg_u32 s38, 0
    s_barrier
    s_cselect_b64 exec, -1, 0
    ds_write_b16 v0, v1
    s_mov_b64 exec, -1
    s_waitcnt lgkmcnt(0)
    s_barrier
sk_53:
    s_cmp_lg_u32 s26, 0
    s_cbranch_scc1 sk_54
    s_xor_b32 s96, s29, 1
    s_and_b32 s97, s96, 2
    s_and_b32 s96, s96, 3
    s_mul_i32 s97, s97, 14336
    s_mul_i32 s96, s96, 14336
    s_add_u32 s96, s96, s97
    s_add_u32 s96, s96, 7168
    buffer_load_dwordx4 v[168:171], v155, s[80:83], s96 offen
    s_xor_b32 s96, s29, 2
    s_and_b32 s97, s96, 2
    s_and_b32 s96, s96, 3
    s_mul_i32 s97, s97, 14336
    s_mul_i32 s96, s96, 14336
    s_add_u32 s96, s96, s97
    buffer_load_dwordx4 v[172:175], v155, s[80:83], s96 offen
    s_xor_b32 s96, s29, 2
    s_and_b32 s97, s96, 2
    s_and_b32 s96, s96, 3
    s_mul_i32 s97, s97, 14336
    s_mul_i32 s96, s96, 14336
    s_add_u32 s96, s96, s97
    s_add_u32 s96, s96, 7168
    buffer_load_dwordx4 v[176:179], v155, s[80:83], s96 offen
    s_xor_b32 s96, s29, 3
    s_and_b32 s97, s96, 2
    s_and_b32 s96, s96, 3
    s_mul_i32 s97, s97, 14336
    s_mul_i32 s96, s96, 14336
    s_add_u32 s96, s96, s97
    buffer_load_dwordx4 v[180:183], v155, s[80:83], s96 offen
    s_xor_b32 s96, s29, 3
    s_and_b32 s97, s96, 2
    s_and_b32 s96, s96, 3
    s_mul_i32 s97, s97, 14336
    s_mul_i32 s96, s96, 14336
    s_add_u32 s96, s96, s97
    s_add_u32 s96, s96, 7168
    buffer_load_dwordx4 v[184:187], v155, s[80:83], s96 offen
sk_54:
    s_barrier
    s_cmp_lt_u32 s76, 4
    s_cbranch_scc1 a1_49_none
    ds_read_b128 v[112:115], v22 offset:0
    ds_read_b128 v[116:119], v22 offset:1024
    ds_read_b128 v[104:107], v23 offset:4096
    ds_read_b128 v[124:127], v22 offset:3072
    ds_read_b128 v[108:111], v23 offset:5120
    ds_read_b128 v[120:123], v22 offset:2048
    s_waitcnt lgkmcnt(4)
a1_49_go:
    s_nop 0
    v_mfma_f32_32x32x16_bf16 v[56:71], v[112:115], v[4:7], v[24:39]
    v_mfma_f32_32x32x16_bf16 v[56:71], v[116:119], v[8:11], v[56:71]
    s_waitcnt lgkmcnt(3)
    v_mfma_f32_32x32x16_bf16 v[72:87], v[104:107], v[4:7], v[24:39]
    ds_read_b128 v[104:107], v23 offset:8192
    s_nop 8
    v_exp_f32 v56, v56
    v_exp_f32 v57, v57
    v_exp_f32_e64 v58, v58
    ds_read_b128 v[128:131], v23 offset:7168
    v_exp_f32 v59, v59
    v_exp_f32 v60, v60
    v_exp_f32 v61, v61
    s_waitcnt lgkmcnt(2)
    v_mfma_f32_32x32x16_bf16 v[72:87], v[108:111], v[8:11], v[72:87]
    ds_read_b128 v[108:111], v23 offset:9216
    v_exp_f32 v62, v62
    v_exp_f32 v63, v63
    v_cvt_pk_bf16_f32 v136, v56, v57
    v_cvt_pk_bf16_f32 v137, v58, v59
    v_cvt_pk_bf16_f32 v138, v60, v61
    v_cvt_pk_bf16_f32 v139, v62, v63
    v_and_b32 v136, v136, v12
    v_and_b32 v137, v137, v13
    v_and_b32 v138, v138, v14
    v_and_b32 v139, v139, v15
    v_exp_f32 v64, v64
    v_exp_f32 v65, v65
    v_mfma_f32_32x32x16_bf16 v[88:103], v[120:123], v[136:139], v[88:103]
    ds_read_b128 v[120:123], v23 offset:6144
    s_cmp_eq_u32 s75, 0
    s_cbranch_scc1 sk_56
    s_cmp_lg_u32 s26, 0
    s_cbranch_scc1 sk_55
    s_xor_b32 s96, s29, 0
    s_and_b32 s97, s96, 2
    s_and_b32 s96, s96, 3
    s_mul_i32 s97, s97, 14336
    s_mul_i32 s96, s96, 14336
    s_add_u32 s96, s96, s97
    buffer_load_dwordx4 v[188:191], v155, s[4:7], s96 offen
    s_xor_b32 s96, s29, 0
    s_and_b32 s97, s96, 2
    s_and_b32 s96, s96, 3
    s_mul_i32 s97, s97, 14336
    s_mul_i32 s96, s96, 14336
    s_add_u32 s96, s96, s97
    s_add_u32 s96, s96, 7168
    buffer_load_dwordx4 v[192:195], v155, s[4:7], s96 offen
sk_55:
sk_56:
    v_exp_f32 v66, v66
    v_exp_f32 v67, v67
    v_exp_f32 v68, v68
    v_exp_f32 v69, v69
    v_mfma_f32_16x16x32_bf16 v[44:47], v[40:43], v[136:139], v[44:47]
    v_exp_f32 v70, v70
    v_exp_f32 v71, v71
    v_cvt_pk_bf16_f32 v140, v64, v65
    v_cvt_pk_bf16_f32 v141, v66, v67
    v_cvt_pk_bf16_f32 v142, v68, v69
    v_cvt_pk_bf16_f32 v143, v70, v71
    v_and_b32 v140, v140, v16
    v_and_b32 v141, v141, v17
    v_and_b32_e64 v142, v142, v18
    v_and_b32 v143, v143, v19
    s_cmp_eq_u32 s75, 0
    s_cbranch_scc1 sk_58
    s_cmp_lg_u32 s26, 0
    s_cbranch_scc1 sk_57
    s_xor_b32 s96, s29, 1
    s_and_b32 s97, s96, 2
    s_and_b32 s96, s96, 3
    s_mul_i32 s97, s97, 14336
    s_mul_i32 s96, s96, 14336
    s_add_u32 s96, s96, s97
    buffer_load_dwordx4 v[196:199], v155, s[4:7], s96 offen
    s_xor_b32 s96, s29, 1
    s_and_b32 s97, s96, 2
    s_and_b32 s96, s96, 3
    s_mul_i32 s97, s97, 14336
    s_mul_i32 s96, s96, 14336
    s_add_u32 s96, s96, s97
    s_add_u32 s96, s96, 7168
    buffer_load_dwordx4 v[200:203], v155, s[4:7], s96 offen
sk_57:
sk_58:
    s_cmp_eq_u32 s74, 1
    s_cbranch_scc1 a1_49_e0
    s_cmp_eq_u32 s74, 2
    s_cbranch_scc1 a1_49_t1
    s_waitcnt lgkmcnt(3)
    v_mfma_f32_32x32x16_bf16 v[56:71], v[104:107], v[4:7], v[24:39]
    ds_read_b128 v[104:107], v23 offset:12288
    v_exp_f32 v72, v72
    v_exp_f32 v73, v73
    v_exp_f32_e64 v74, v74
    v_mfma_f32_32x32x16_bf16 v[88:103], v[124:127], v[140:143], v[88:103]
    ds_read_b128 v[124:127], v23 offset:11264
    v_exp_f32 v75, v75
    v_exp_f32 v76, v76
    v_exp_f32 v77, v77
    s_waitcnt lgkmcnt(2)
    v_mfma_f32_32x32x16_bf16 v[56:71], v[108:111], v[8:11], v[56:71]
    ds_read_b128 v[108:111], v23 offset:13312
    v_exp_f32 v78, v78
    v_exp_f32 v79, v79
    v_cvt_pk_bf16_f32 v136, v72, v73
    v_cvt_pk_bf16_f32 v137, v74, v75
    v_mfma_f32_16x16x32_bf16 v[44:47], v[40:43], v[140:143], v[44:47]
    v_cvt_pk_bf16_f32 v138, v76, v77
    v_cvt_pk_bf16_f32 v139, v78, v79
    v_exp_f32 v80, v80
    v_exp_f32 v81, v81
    v_mfma_f32_32x32x16_bf16 v[88:103], v[120:123], v[136:139], v[88:103]
    ds_read_b128 v[120:123], v23 offset:10240
    s_cmp_eq_u32 s75, 0
    s_cbranch_scc1 sk_60
    s_cmp_lg_u32 s26, 0
    s_cbranch_scc1 sk_59
    s_xor_b32 s96, s29, 2
    s_and_b32 s97, s96, 2
    s_and_b32 s96, s96, 3
    s_mul_i32 s97, s97, 14336
    s_mul_i32 s96, s96, 14336
    s_add_u32 s96, s96, s97
    buffer_load_dwordx4 v[204:207], v155, s[4:7], s96 offen
sk_59:
sk_60:
    v_exp_f32 v82, v82
    v_exp_f32 v83, v83
    v_exp_f32 v84, v84
    v_exp_f32 v85, v85
    v_mfma_f32_16x16x32_bf16 v[44:47], v[40:43], v[136:139], v[44:47]
    v_exp_f32 v86, v86
    v_exp_f32 v87, v87
    v_cvt_pk_bf16_f32 v140, v80, v81
    v_cvt_pk_bf16_f32 v141, v82, v83
    v_cvt_pk_bf16_f32 v142, v84, v85
    v_cvt_pk_bf16_f32 v143, v86, v87
    s_cmp_eq_u32 s75, 0
    s_cbranch_scc1 sk_62
    s_cmp_lg_u32 s26, 0
    s_cbranch_scc1 sk_61
    s_xor_b32 s96, s29, 2
    s_and_b32 s97, s96, 2
    s_and_b32 s96, s96, 3
    s_mul_i32 s97, s97, 14336
    s_mul_i32 s96, s96, 14336
    s_add_u32 s96, s96, s97
    s_add_u32 s96, s96, 7168
    buffer_load_dwordx4 v[208:211], v155, s[4:7], s96 offen
sk_61:
sk_62:
    s_cmp_eq_u32 s74, 3
    s_cbranch_scc1 a1_49_t0
    s_waitcnt lgkmcnt(3)
    v_mfma_f32_32x32x16_bf16 v[72:87], v[104:107], v[4:7], v[24:39]
    ds_read_b128 v[104:107], v23 offset:16384
    v_exp_f32 v56, v56
    v_exp_f32 v57, v57
    v_exp_f32 v58, v58
    v_mfma_f32_32x32x16_bf16 v[88:103], v[128:131], v[140:143], v[88:103]
    ds_read_b128 v[128:131], v23 offset:15360
    v_exp_f32 v59, v59
    v_exp_f32 v60, v60
    v_exp_f32 v61, v61
    s_waitcnt lgkmcnt(2)
    v_mfma_f32_32x32x16_bf16 v[72:87], v[108:111], v[8:11], v[72:87]
    ds_read_b128 v[108:111], v23 offset:17408
    v_exp_f32 v62, v62
    v_exp_f32 v63, v63
    v_cvt_pk_bf16_f32 v136, v56, v57
    v_cvt_pk_bf16_f32 v137, v58, v59
    v_mfma_f32_16x16x32_bf16 v[44:47], v[40:43], v[140:143], v[44:47]
    v_cvt_pk_bf16_f32 v138, v60, v61
    v_cvt_pk_bf16_f32 v139, v62, v63
    v_exp_f32 v64, v64
    v_exp_f32 v65, v65
    v_mfma_f32_32x32x16_bf16 v[88:103], v[120:123], v[136:139], v[88:103]
    ds_read_b128 v[120:123], v23 offset:14336
    s_cmp_eq_u32 s75, 0
    s_cbranch_scc1 sk_64
    s_cmp_lg_u32 s26, 0
    s_cbranch_scc1 sk_63
    s_xor_b32 s96, s29, 3
    s_and_b32 s97, s96, 2
    s_and_b32 s96, s96, 3
    s_mul_i32 s97, s97, 14336
    s_mul_i32 s96, s96, 14336
    s_add_u32 s96, s96, s97
    buffer_load_dwordx4 v[212:215], v155, s[4:7], s96 offen
sk_63:
sk_64:
    v_exp_f32 v66, v66
    v_exp_f32 v67, v67
    v_exp_f32 v68, v68
    v_exp_f32 v69, v69
    v_mfma_f32_16x16x32_bf16 v[44:47], v[40:43], v[136:139], v[44:47]
    v_exp_f32 v70, v70
    v_exp_f32 v71, v71
    v_cvt_pk_bf16_f32 v140, v64, v65
    v_cvt_pk_bf16_f32 v141, v66, v67
    v_cvt_pk_bf16_f32 v142, v68, v69
    v_cvt_pk_bf16_f32 v143, v70, v71
    s_cmp_eq_u32 s75, 0
    s_cbranch_scc1 sk_66
    s_barrier
    s_cmp_lg_u32 s26, 0
    s_cbranch_scc1 sk_65
    s_xor_b32 s96, s29, 3
    s_and_b32 s97, s96, 2
    s_and_b32 s96, s96, 3
    s_mul_i32 s97, s97, 14336
    s_mul_i32 s96, s96, 14336
    s_add_u32 s96, s96, s97
    s_add_u32 s96, s96, 7168
    buffer_load_dwordx4 v[216:219], v155, s[4:7], s96 offen
sk_65:
sk_66:
    s_cmp_eq_u32 s74, 4
    s_cbranch_scc1 a1_49_t1
    s_waitcnt lgkmcnt(3)
    v_mfma_f32_32x32x16_bf16 v[56:71], v[104:107], v[4:7], v[24:39]
    ds_read_b128 v[104:107], v23 offset:20480
    v_exp_f32 v72, v72
    v_exp_f32 v73, v73
    v_exp_f32_e64 v74, v74
    v_mfma_f32_32x32x16_bf16 v[88:103], v[124:127], v[140:143], v[88:103]
    ds_read_b128 v[124:127], v23 offset:19456
    v_exp_f32 v75, v75
    v_exp_f32 v76, v76
    v_exp_f32 v77, v77
    s_waitcnt lgkmcnt(2)
    v_mfma_f32_32x32x16_bf16 v[56:71], v[108:111], v[8:11], v[56:71]
    ds_read_b128 v[108:111], v23 offset:21504
    v_exp_f32 v78, v78
    v_exp_f32 v79, v79
    v_cvt_pk_bf16_f32 v136, v72, v73
    v_cvt_pk_bf16_f32 v137, v74, v75
    v_mfma_f32_16x16x32_bf16 v[44:47], v[40:43], v[140:143], v[44:47]
    v_cvt_pk_bf16_f32 v138, v76, v77
    v_cvt_pk_bf16_f32 v139, v78, v79
    v_exp_f32 v80, v80
    v_exp_f32 v81, v81
    v_mfma_f32_32x32x16_bf16 v[88:103], v[120:123], v[136:139], v[88:103]
    ds_read_b128 v[120:123], v23 offset:18432
    v_exp_f32 v82, v82
    v_exp_f32 v83, v83
    v_exp_f32 v84, v84
    v_exp_f32 v85, v85
    v_mfma_f32_16x16x32_bf16 v[44:47], v[40:43], v[136:139], v[44:47]
    v_exp_f32 v86, v86
    v_exp_f32 v87, v87
    v_cvt_pk_bf16_f32 v140, v80, v81
    v_cvt_pk_bf16_f32 v141, v82, v83
    v_cvt_pk_bf16_f32 v142, v84, v85
    v_cvt_pk_bf16_f32 v143, v86, v87
    s_cmp_eq_u32 s74, 5
    s_cbranch_scc1 a1_49_t0
    s_waitcnt lgkmcnt(3)
    v_mfma_f32_32x32x16_bf16 v[72:87], v[104:107], v[4:7], v[24:39]
    ds_read_b128 v[104:107], v23 offset:24576
    v_exp_f32 v56, v56
    v_exp_f32 v57, v57
    v_exp_f32 v58, v58
    v_mfma_f32_32x32x16_bf16 v[88:103], v[128:131], v[140:143], v[88:103]
    ds_read_b128 v[128:131], v23 offset:23552
    v_exp_f32 v59, v59
    v_exp_f32 v60, v60
    v_exp_f32 v61, v61
    s_waitcnt lgkmcnt(2)
    v_mfma_f32_32x32x16_bf16 v[72:87], v[108:111], v[8:11], v[72:87]
    ds_read_b128 v[108:111], v23 offset:25600
    v_exp_f32 v62, v62
    v_exp_f32 v63, v63
    v_cvt_pk_bf16_f32 v136, v56, v57
    v_cvt_pk_bf16_f32 v137, v58, v59
    v_mfma_f32_16x16x32_bf16 v[44:47], v[40:43], v[140:143], v[44:47]
    v_cvt_pk_bf16_f32 v138, v60, v61
    v_cvt_pk_bf16_f32 v139, v62, v63
    v_exp_f32 v64, v64
    v_exp_f32 v65, v65
    v_mfma_f32_32x32x16_bf16 v[88:103], v[120:123], v[136:139], v[88:103]
    ds_read_b128 v[120:123], v23 offset:22528
    v_exp_f32 v66, v66
    v_exp_f32 v67, v67
    v_exp_f32 v68, v68
    v_exp_f32 v69, v69
    v_mfma_f32_16x16x32_bf16 v[44:47], v[40:43], v[136:139], v[44:47]
    v_exp_f32 v70, v70
    v_exp_f32 v71, v71
    v_cvt_pk_bf16_f32 v140, v64, v65
    v_cvt_pk_bf16_f32 v141, v66, v67
    v_cvt_pk_bf16_f32 v142, v68, v69
    v_cvt_pk_bf16_f32 v143, v70, v71
    s_cmp_eq_u32 s74, 6
    s_cbranch_scc1 a1_49_t1
    s_waitcnt lgkmcnt(3)
    v_mfma_f32_32x32x16_bf16 v[56:71], v[104:107], v[4:7], v[24:39]
    ds_read_b128 v[104:107], v23 offset:28672
    v_exp_f32 v72, v72
    v_exp_f32 v73, v73
    v_exp_f32 v74, v74
    v_mfma_f32_32x32x16_bf16 v[88:103], v[124:127], v[140:143], v[88:103]
    ds_read_b128 v[124:127], v23 offset:27648
    v_exp_f32 v75, v75
    v_exp_f32 v76, v76
    v_exp_f32 v77, v77
    s_waitcnt lgkmcnt(2)
    v_mfma_f32_32x32x16_bf16 v[56:71], v[108:111], v[8:11], v[56:71]
    ds_read_b128 v[108:111], v23 offset:29696
    v_exp_f32 v78, v78
    v_exp_f32 v79, v79
    v_cvt_pk_bf16_f32 v136, v72, v73
    v_cvt_pk_bf16_f32 v137, v74, v75
    v_mfma_f32_16x16x32_bf16 v[44:47], v[40:43], v[140:143], v[44:47]
    v_cvt_pk_bf16_f32 v138, v76, v77
    v_cvt_pk_bf16_f32 v139, v78, v79
    v_exp_f32 v80, v80
    v_exp_f32 v81, v81
    v_mfma_f32_32x32x16_bf16 v[88:103], v[120:123], v[136:139], v[88:103]
    ds_read_b128 v[120:123], v23 offset:26624
    v_exp_f32 v82, v82
    v_exp_f32 v83, v83
    v_exp_f32 v84, v84
    v_exp_f32 v85, v85
    v_mfma_f32_16x16x32_bf16 v[44:47], v[40:43], v[136:139], v[44:47]
    v_exp_f32 v86, v86
    v_exp_f32 v87, v87
    v_cvt_pk_bf16_f32 v140, v80, v81
    v_cvt_pk_bf16_f32 v141, v82, v83
    v_cvt_pk_bf16_f32 v142, v84, v85
    v_cvt_pk_bf16_f32 v143, v86, v87
    s_cmp_eq_u32 s74, 7
    s_cbranch_scc1 a1_49_t0
    s_waitcnt lgkmcnt(3)
    v_mfma_f32_32x32x16_bf16 v[72:87], v[104:107], v[4:7], v[24:39]
    ds_read_b128 v[104:107], v23 offset:24576
    v_exp_f32 v56, v56
    v_exp_f32 v57, v57
    v_exp_f32 v58, v58
    v_mfma_f32_32x32x16_bf16 v[88:103], v[128:131], v[140:143], v[88:103]
    ds_read_b128 v[128:131], v23 offset:31744
    v_exp_f32 v59, v59
    v_exp_f32 v60, v60
    v_exp_f32 v61, v61
    s_waitcnt lgkmcnt(2)
    v_mfma_f32_32x32x16_bf16 v[72:87], v[108:111], v[8:11], v[72:87]
    ds_read_b128 v[108:111], v23 offset:25600
    v_exp_f32 v62, v62
    v_exp_f32 v63, v63
    v_cvt_pk_bf16_f32 v136, v56, v57
    v_cvt_pk_bf16_f32 v137, v58, v59
    v_mfma_f32_16x16x32_bf16 v[44:47], v[40:43], v[140:143], v[44:47]
    v_cvt_pk_bf16_f32 v138, v60, v61
    v_cvt_pk_bf16_f32 v139, v62, v63
    v_exp_f32 v64, v64
    v_exp_f32 v65, v65
    v_mfma_f32_32x32x16_bf16 v[88:103], v[120:123], v[136:139], v[88:103]
    ds_read_b128 v[120:123], v23 offset:30720
    v_exp_f32 v66, v66
    v_exp_f32 v67, v67
    v_exp_f32 v68, v68
    v_exp_f32 v69, v69
    v_mfma_f32_16x16x32_bf16 v[44:47], v[40:43], v[136:139], v[44:47]
    v_exp_f32 v70, v70
    v_exp_f32 v71, v71
    v_cvt_pk_bf16_f32 v140, v64, v65
    v_cvt_pk_bf16_f32 v141, v66, v67
    v_cvt_pk_bf16_f32 v142, v68, v69
    v_cvt_pk_bf16_f32 v143, v70, v71
a1_49_t1:
    v_exp_f32 v72, v72
    v_exp_f32 v73, v73
    v_exp_f32_e64 v74, v74
    v_mfma_f32_32x32x16_bf16 v[88:103], v[124:127], v[140:143], v[88:103]
    v_exp_f32 v75, v75
    v_exp_f32 v76, v76
    v_exp_f32 v77, v77
    v_exp_f32 v78, v78
    v_exp_f32_e64 v79, v79
    v_cvt_pk_bf16_f32 v136, v72, v73
    v_cvt_pk_bf16_f32 v137, v74, v75
    v_mfma_f32_16x16x32_bf16 v[44:47], v[40:43], v[140:143], v[44:47]
    v_cvt_pk_bf16_f32 v138, v76, v77
    v_cvt_pk_bf16_f32 v139, v78, v79
    v_exp_f32_e64 v80, v80
    v_exp_f32 v81, v81
    s_waitcnt lgkmcnt(0)
    v_mfma_f32_32x32x16_bf16 v[88:103], v[120:123], v[136:139], v[88:103]
    v_exp_f32 v82, v82
    v_exp_f32 v83, v83
    v_exp_f32 v84, v84
    v_exp_f32 v85, v85
    v_mfma_f32_16x16x32_bf16 v[44:47], v[40:43], v[136:139], v[44:47]
    v_exp_f32 v86, v86
    v_exp_f32 v87, v87
    v_cvt_pk_bf16_f32 v140, v80, v81
    v_cvt_pk_bf16_f32 v141, v82, v83
    v_cvt_pk_bf16_f32 v142, v84, v85
    v_cvt_pk_bf16_f32 v143, v86, v87
a1_49_e1:
    s_cmp_eq_u32 s75, 0
    s_nop 0
    v_mfma_f32_16x16x32_bf16 v[44:47], v[40:43], v[140:143], v[44:47]
    v_mfma_f32_32x32x16_bf16 v[88:103], v[128:131], v[140:143], v[88:103]
    s_cbranch_scc1 a1_49_mid
    s_branch a1_49_fin
    s_nop 0
a1_49_t0:
    v_exp_f32 v56, v56
    v_exp_f32 v57, v57
    v_exp_f32 v58, v58
    v_mfma_f32_32x32x16_bf16 v[88:103], v[128:131], v[140:143], v[88:103]
    v_exp_f32 v59, v59
    v_exp_f32 v60, v60
    v_exp_f32 v61, v61
    v_exp_f32 v62, v62
    v_exp_f32_e64 v63, v63
    v_cvt_pk_bf16_f32 v136, v56, v57
    v_cvt_pk_bf16_f32 v137, v58, v59
    v_mfma_f32_16x16x32_bf16 v[44:47], v[40:43], v[140:143], v[44:47]
    v_cvt_pk_bf16_f32 v138, v60, v61
    v_cvt_pk_bf16_f32 v139, v62, v63
    v_exp_f32_e64 v64, v64
    v_exp_f32 v65, v65
    s_waitcnt lgkmcnt(0)
    v_mfma_f32_32x32x16_bf16 v[88:103], v[120:123], v[136:139], v[88:103]
    v_exp_f32 v66, v66
    v_exp_f32 v67, v67
    v_exp_f32 v68, v68
    v_exp_f32 v69, v69
    v_mfma_f32_16x16x32_bf16 v[44:47], v[40:43], v[136:139], v[44:47]
    v_exp_f32 v70, v70
    v_exp_f32 v71, v71
    v_cvt_pk_bf16_f32 v140, v64, v65
    v_cvt_pk_bf16_f32 v141, v66, v67
    v_cvt_pk_bf16_f32 v142, v68, v69
    v_cvt_pk_bf16_f32 v143, v70, v71
a1_49_e0:
    s_cmp_eq_u32 s75, 0
    s_nop 0
    v_mfma_f32_16x16x32_bf16 v[44:47], v[40:43], v[140:143], v[44:47]
    v_mfma_f32_32x32x16_bf16 v[88:103], v[124:127], v[140:143], v[88:103]
    s_cbranch_scc1 a1_49_mid
    s_branch a1_49_fin
    s_nop 0
a1_49_none:
    s_cmp_lg_u32 s26, 0
    s_cbranch_scc1 sk_67
    s_xor_b32 s96, s29, 0
    s_and_b32 s97, s96, 2
    s_and_b32 s96, s96, 3
    s_mul_i32 s97, s97, 14336
    s_mul_i32 s96, s96, 14336
    s_add_u32 s96, s96, s97
    buffer_load_dwordx4 v[188:191], v155, s[4:7], s96 offen
    s_xor_b32 s96, s29, 0
    s_and_b32 s97, s96, 2
    s_and_b32 s96, s96, 3
    s_mul_i32 s97, s97, 14336
    s_mul_i32 s96, s96, 14336
    s_add_u32 s96, s96, s97
    s_add_u32 s96, s96, 7168
    buffer_load_dwordx4 v[192:195], v155, s[4:7], s96 offen
sk_67:
    s_cmp_lg_u32 s26, 0
    s_cbranch_scc1 sk_68
    s_xor_b32 s96, s29, 1
    s_and_b32 s97, s96, 2
    s_and_b32 s96, s96, 3
    s_mul_i32 s97, s97, 14336
    s_mul_i32 s96, s96, 14336
    s_add_u32 s96, s96, s97
    buffer_load_dwordx4 v[196:199], v155, s[4:7], s96 offen
    s_xor_b32 s96, s29, 1
    s_and_b32 s97, s96, 2
    s_and_b32 s96, s96, 3
    s_mul_i32 s97, s97, 14336
    s_mul_i32 s96, s96, 14336
    s_add_u32 s96, s96, s97
    s_add_u32 s96, s96, 7168
    buffer_load_dwordx4 v[200:203], v155, s[4:7], s96 offen
sk_68:
    s_cmp_lg_u32 s26, 0
    s_cbranch_scc1 sk_69
    s_xor_b32 s96, s29, 2
    s_and_b32 s97, s96, 2
    s_and_b32 s96, s96, 3
    s_mul_i32 s97, s97, 14336
    s_mul_i32 s96, s96, 14336
    s_add_u32 s96, s96, s97
    buffer_load_dwordx4 v[204:207], v155, s[4:7], s96 offen
sk_69:
    s_cmp_lg_u32 s26, 0
    s_cbranch_scc1 sk_70
    s_xor_b32 s96, s29, 2
    s_and_b32 s97, s96, 2
    s_and_b32 s96, s96, 3
    s_mul_i32 s97, s97, 14336
    s_mul_i32 s96, s96, 14336
    s_add_u32 s96, s96, s97
    s_add_u32 s96, s96, 7168
    buffer_load_dwordx4 v[208:211], v155, s[4:7], s96 offen
sk_70:
    s_cmp_lg_u32 s26, 0
    s_cbranch_scc1 sk_71
    s_xor_b32 s96, s29, 3
    s_and_b32 s97, s96, 2
    s_and_b32 s96, s96, 3
    s_mul_i32 s97, s97, 14336
    s_mul_i32 s96, s96, 14336
    s_add_u32 s96, s96, s97
    buffer_load_dwordx4 v[212:215], v155, s[4:7], s96 offen
sk_71:
    s_barrier
    s_cmp_lg_u32 s26, 0
    s_cbranch_scc1 sk_72
    s_xor_b32 s96, s29, 3
    s_and_b32 s97, s96, 2
    s_and_b32 s96, s96, 3
    s_mul_i32 s97, s97, 14336
    s_mul_i32 s96, s96, 14336
    s_add_u32 s96, s96, s97
    s_add_u32 s96, s96, 7168
    buffer_load_dwordx4 v[216:219], v155, s[4:7], s96 offen
sk_72:
a1_49_fin:
    s_lshl_b32 s36, s76, 17
    s_lshr_b32 s33, s26, 8
    s_add_u32 s36, s36, s33
    s_add_u32 s36, s36, 0x2808000
    s_lshl_b32 s33, s25, 11
    s_add_u32 s33, s33, s36
    s_lshl_b32 s30, s24, 9
    s_and_b32 s31, s76, 3
    s_lshl_b32 s31, s31, 6
    s_add_u32 s30, s30, s31
    s_add_u32 s30, s30, s26
    s_add_u32 s30, s30, 0xdd2100
    s_lshl_b32 s31, s25, 2
    s_add_u32 s31, s31, s30
    v_cmp_ngt_f32 vcc, 0x5d800000, v44
    v_rcp_f32_e64 v22, v44
    s_cbranch_vccnz att_exact1
att_ret1:
    s_nop 3
    v_pk_mul_f32 v[88:89], v[88:89], v[22:23] op_sel_hi:[1,0]
    v_pk_mul_f32 v[90:91], v[90:91], v[22:23] op_sel_hi:[1,0]
    v_pk_mul_f32 v[92:93], v[92:93], v[22:23] op_sel_hi:[1,0]
    v_pk_mul_f32 v[94:95], v[94:95], v[22:23] op_sel_hi:[1,0]
    v_pk_mul_f32 v[96:97], v[96:97], v[22:23] op_sel_hi:[1,0]
    v_pk_mul_f32 v[98:99], v[98:99], v[22:23] op_sel_hi:[1,0]
    v_pk_mul_f32 v[100:101], v[100:101], v[22:23] op_sel_hi:[1,0]
    v_pk_mul_f32 v[102:103], v[102:103], v[22:23] op_sel_hi:[1,0]
    v_cvt_pk_bf16_f32 v88, v88, v89
    v_cvt_pk_bf16_f32 v89, v90, v91
    v_cvt_pk_bf16_f32 v90, v92, v93
    v_cvt_pk_bf16_f32 v91, v94, v95
    v_cvt_pk_bf16_f32 v92, v96, v97
    v_cvt_pk_bf16_f32 v93, v98, v99
    v_cvt_pk_bf16_f32 v94, v100, v101
    v_cvt_pk_bf16_f32 v95, v102, v103
    s_cmp_gt_u32 s77, s26
    s_cbranch_scc1 lc_73
    buffer_store_dwordx4 v[88:91], v253, s[20:23], s33 offen sc1
    buffer_store_dwordx4 v[92:95], v253, s[20:23], s33 offen offset:1024 sc1
    s_branch lc_74
    s_nop 0
lc_73:
    buffer_store_dwordx4 v[88:91], v253, s[20:23], s33 offen
    buffer_store_dwordx4 v[92:95], v253, s[20:23], s33 offen offset:1024
lc_74:
    v_mov_b32_e64 v154, s88
    s_mov_b64 exec, 1
    s_waitcnt vmcnt(0)
    s_cmp_lg_u32 s77, 0
    s_cbranch_scc1 lc_75
    buffer_store_dword v154, v253, s[20:23], s31 offen sc1
    s_branch lc_76
    s_nop 0
lc_75:
    buffer_store_dword v154, v253, s[20:23], s31 offen
lc_76:
    s_mov_b64 exec, -1
    s_cmp_lg_u32 s26, 0
    s_cbranch_scc1 sk_77
    s_mov_b32 s96, 0
    buffer_load_dwordx4 v[220:223], v153, s[12:15], s96 offen
    s_mov_b32 s96, 2048
    buffer_load_dwordx4 v[224:227], v153, s[12:15], s96 offen
    s_mov_b32 s96, 4096
    buffer_load_dwordx4 v[228:231], v153, s[12:15], s96 offen
    s_mov_b32 s96, 6144
    buffer_load_dwordx4 v[232:235], v153, s[12:15], s96 offen
    s_mov_b32 s96, 8192
    buffer_load_dwordx4 v[236:239], v153, s[12:15], s96 offen
    s_mov_b32 s96, 10240
    buffer_load_dwordx4 v[240:243], v153, s[12:15], s96 offen
    s_mov_b32 s96, 12288
    buffer_load_dwordx4 v[244:247], v153, s[12:15], s96 offen
    s_mov_b32 s96, 14336
    buffer_load_dwordx4 v[248:251], v153, s[12:15], s96 offen
sk_77:
    v_bfe_u32 v20, v252, 3, 2
    v_lshrrev_b32_e64 v21, 5, v252
    v_lshl_add_u32 v20, v21, 3, v20
    s_lshr_b32 s32, s28, 1
    s_lshl_b32 s32, s32, 4
    s_and_b32 s33, s28, 1
    s_lshl_b32 s33, s33, 2
    s_add_u32 s32, s32, s33
    v_add_u32 v20, s32, v20
    v_lshlrev_b32 v20, 11, v20
    v_lshrrev_b32 v21, 2, v252
    v_and_b32 v21, 4, v21
    v_xor_b32 v21, v21, v252
    v_and_b32 v21, 7, v21
    v_lshl_add_u32 v20, v21, 4, v20
    s_lshl_b32 s32, s98, 7
    v_add_u32 v14, s32, v20
    s_lshl_b32 s32, s28, 9
    s_sub_u32 s34, s29, 224
    s_lshl_b32 s34, s34, 2
    s_mul_i32 s35, s28, 2
    s_and_b32 s33, s35, 3
    s_add_u32 s34, s34, s33
    s_cmp_lt_u32 s35, 4
    s_cselect_b32 s89, s34, -1
    v_and_b32 v23, 1, v252
    v_add_u32 v23, s34, v23
    v_lshrrev_b32_e64 v22, 5, v252
    v_and_or_b32 v23, v23, -2, v22
    v_lshrrev_b32_e64 v22, 1, v252
    s_cmp_lt_u32 s29, 224
    s_cselect_b32 s32, s32, 0
    s_cselect_b64 vcc, -1, 0
    v_cndmask_b32_e64 v22, v23, v22, vcc
    v_lshl_add_u32 v22, v22, 4, s32
    s_mov_b32 s79, s26
    s_cmp_lg_u32 s26, 0
    s_cbranch_scc1 sk_78
    s_waitcnt vmcnt(0)
    s_getpc_b64 s[32:33]
pc_79:
    s_sub_u32 s32, s32, pc_79-interleave_layers__sliding_block__moe_arch_mod__prompt_kernel
    s_subb_u32 s33, s33, 0
    s_lshr_b32 s34, s2, 3
    s_lshl_b32 s34, s34, 2
    s_add_u32 s34, s34, s28
    s_and_b32 s34, s34, 127
    s_lshl_b32 s34, s34, 7
    v_lshl_add_u32 v19, v252, 14, s34
    s_mov_b32 s34, k_exit-interleave_layers__sliding_block__moe_arch_mod__prompt_kernel
    s_mov_b32 s35, 0x20000
    buffer_load_dword v19, v19, s[32:35], 0 offen
    s_lshr_b32 s30, s16, 7
    s_sub_u32 s30, 3, s30
    s_and_b32 s30, s30, 7
    s_and_b32 s31, s24, 1
    s_lshl_b32 s31, s31, 3
    s_add_u32 s30, s30, s31
    s_and_b32 s31, s24, 14
    s_add_u32 s35, s31, s30
    s_lshl_b32 s31, s25, 2
    s_add_u32 s31, s31, s28
    s_mul_i32 s31, s31, 6144
    s_lshl_b32 s30, s30, 7
    s_add_u32 s30, s30, s31
    v_min_u32_e64 v18, 2, v252
    v_lshl_add_u32 v18, v18, 11, s30
    s_add_u32 s30, s35, 14
    s_and_b32 s30, s30, 15
    s_mul_i32 s30, s30, 393216
    buffer_load_dword v19, v18, s[16:19], s30 offen
    s_add_u32 s30, s35, 15
    s_and_b32 s30, s30, 15
    s_mul_i32 s30, s30, 393216
    buffer_load_dword v19, v18, s[16:19], s30 offen
    s_add_u32 s30, s35, 0
    s_and_b32 s30, s30, 15
    s_mul_i32 s30, s30, 393216
    buffer_load_dword v19, v18, s[16:19], s30 offen
    s_add_u32 s30, s35, 1
    s_and_b32 s30, s30, 15
    s_mul_i32 s30, s30, 393216
    buffer_load_dword v19, v18, s[16:19], s30 offen
    s_add_u32 s30, s35, 2
    s_and_b32 s30, s30, 15
    s_mul_i32 s30, s30, 393216
    buffer_load_dword v19, v18, s[16:19], s30 offen
    s_add_u32 s30, s35, 3
    s_and_b32 s30, s30, 15
    s_mul_i32 s30, s30, 393216
    buffer_load_dword v19, v18, s[16:19], s30 offen
    s_mov_b32 s30, 0x05040100
    s_mov_b32 s31, 0x07060302
    v_perm_b32 v155, v160, v156, s30
    v_perm_b32 v160, v160, v156, s31
    v_perm_b32 v156, v161, v157, s30
    v_perm_b32 v161, v161, v157, s31
    v_perm_b32 v157, v162, v158, s30
    v_perm_b32 v162, v162, v158, s31
    v_perm_b32 v158, v163, v159, s30
    v_perm_b32 v163, v163, v159, s31
    v_perm_b32 v159, v168, v164, s30
    v_perm_b32 v168, v168, v164, s31
    v_perm_b32 v164, v169, v165, s30
    v_perm_b32 v169, v169, v165, s31
    v_perm_b32 v165, v170, v166, s30
    v_perm_b32 v170, v170, v166, s31
    v_perm_b32 v166, v171, v167, s30
    v_perm_b32 v171, v171, v167, s31
    v_perm_b32 v167, v176, v172, s30
    v_perm_b32 v176, v176, v172, s31
    v_perm_b32 v172, v177, v173, s30
    v_perm_b32 v177, v177, v173, s31
    v_perm_b32 v173, v178, v174, s30
    v_perm_b32 v178, v178, v174, s31
    v_perm_b32 v174, v179, v175, s30
    v_perm_b32 v179, v179, v175, s31
    v_perm_b32 v175, v184, v180, s30
    v_perm_b32 v184, v184, v180, s31
    v_perm_b32 v180, v185, v181, s30
    v_perm_b32 v185, v185, v181, s31
    v_perm_b32 v181, v186, v182, s30
    v_perm_b32 v186, v186, v182, s31
    v_perm_b32 v182, v187, v183, s30
    v_perm_b32 v187, v187, v183, s31
    v_perm_b32 v183, v192, v188, s30
    v_perm_b32 v192, v192, v188, s31
    v_perm_b32 v188, v193, v189, s30
    v_perm_b32 v193, v193, v189, s31
    v_perm_b32 v189, v194, v190, s30
    v_perm_b32 v194, v194, v190, s31
    v_perm_b32 v190, v195, v191, s30
    v_perm_b32 v195, v195, v191, s31
    v_perm_b32 v191, v200, v196, s30
    v_perm_b32 v200, v200, v196, s31
    v_perm_b32 v196, v201, v197, s30
    v_perm_b32 v201, v201, v197, s31
    v_perm_b32 v197, v202, v198, s30
    v_perm_b32 v202, v202, v198, s31
    v_perm_b32 v198, v203, v199, s30
    v_perm_b32 v203, v203, v199, s31
    v_perm_b32 v199, v208, v204, s30
    v_perm_b32 v208, v208, v204, s31
    v_perm_b32 v204, v209, v205, s30
    v_perm_b32 v209, v209, v205, s31
    v_perm_b32 v205, v210, v206, s30
    v_perm_b32 v210, v210, v206, s31
    v_perm_b32 v206, v211, v207, s30
    v_perm_b32 v211, v211, v207, s31
    v_perm_b32 v207, v216, v212, s30
    v_perm_b32 v216, v216, v212, s31
    v_perm_b32 v212, v217, v213, s30
    v_perm_b32 v217, v217, v213, s31
    v_perm_b32 v213, v218, v214, s30
    v_perm_b32 v218, v218, v214, s31
    v_perm_b32 v214, v219, v215, s30
    v_perm_b32 v219, v219, v215, s31
    v_perm_b32 v215, v224, v220, s30
    v_perm_b32 v224, v224, v220, s31
    v_perm_b32 v220, v225, v221, s30
    v_perm_b32 v225, v225, v221, s31
    v_perm_b32 v221, v226, v222, s30
    v_perm_b32 v226, v226, v222, s31
    v_perm_b32 v222, v227, v223, s30
    v_perm_b32 v227, v227, v223, s31
    v_perm_b32 v223, v232, v228, s30
    v_perm_b32 v232, v232, v228, s31
    v_perm_b32 v228, v233, v229, s30
    v_perm_b32 v233, v233, v229, s31
    v_perm_b32 v229, v234, v230, s30
    v_perm_b32 v234, v234, v230, s31
    v_perm_b32 v230, v235, v231, s30
    v_perm_b32 v235, v235, v231, s31
    v_perm_b32 v231, v240, v236, s30
    v_perm_b32 v240, v240, v236, s31
    v_perm_b32 v236, v241, v237, s30
    v_perm_b32 v241, v241, v237, s31
    v_perm_b32 v237, v242, v238, s30
    v_perm_b32 v242, v242, v238, s31
    v_perm_b32 v238, v243, v239, s30
    v_perm_b32 v243, v243, v239, s31
    v_perm_b32 v239, v248, v244, s30
    v_perm_b32 v248, v248, v244, s31
    v_perm_b32 v244, v249, v245, s30
    v_perm_b32 v249, v249, v245, s31
    v_perm_b32 v245, v250, v246, s30
    v_perm_b32 v250, v250, v246, s31
    v_perm_b32 v246, v251, v247, s30
    v_perm_b32 v251, v251, v247, s31
    v_lshrrev_b32_e64 v21, 3, v252
    s_lshl_b32 s84, s24, 18
    s_add_u32 s84, s84, s86
    s_add_u32 s84, s84, 0x2000000
    v_mul_u32_u24 v20, 6144, v21
    v_and_b32 v21, 6, v21
    v_xor_b32 v21, v21, v252
    v_and_b32 v21, 7, v21
    v_lshl_add_u32 v20, v21, 4, v20
    s_mul_i32 s32, s28, 3
    s_bfe_u32 s33, s32, 0x10001
    s_mul_i32 s33, s33, 196608
    s_and_b32 s34, s32, 1
    s_mul_i32 s34, s34, 49152
    s_add_u32 s33, s33, s34
    s_lshr_b32 s34, s32, 2
    s_lshl_b32 s34, s34, 11
    s_add_u32 s33, s33, s34
    v_add_u32 v8, s33, v20
    v_add_u32 v9, 97280, v8
    s_add_u32 s32, s32, 1
    s_bfe_u32 s33, s32, 0x10001
    s_mul_i32 s33, s33, 196608
    s_and_b32 s34, s32, 1
    s_mul_i32 s34, s34, 49152
    s_add_u32 s33, s33, s34
    s_lshr_b32 s34, s32, 2
    s_lshl_b32 s34, s34, 11
    s_add_u32 s33, s33, s34
    s_sub_u32 s33, s33, 2048
    v_add_u32 v10, s33, v20
    v_add_u32 v11, 97280, v10
    s_add_u32 s32, s32, 1
    s_bfe_u32 s33, s32, 0x10001
    s_mul_i32 s33, s33, 196608
    s_and_b32 s34, s32, 1
    s_mul_i32 s34, s34, 49152
    s_add_u32 s33, s33, s34
    s_lshr_b32 s34, s32, 2
    s_lshl_b32 s34, s34, 11
    s_add_u32 s33, s33, s34
    v_add_u32 v12, s33, v20
    v_add_u32 v13, 97280, v12
    s_sub_u32 s30, s95, 1
    s_sub_u32 s95, s94, 3
    s_mov_b32 s94, s30
    v_bfe_u32 v116, v252, 4, 1
    v_lshlrev_b32 v116, 11, v116
    v_lshrrev_b32_e64 v117, 5, v252
    v_lshl_add_u32 v116, v117, 8, v116
    v_and_b32 v117, 15, v252
    v_lshl_add_u32 v116, v117, 4, v116
    s_lshl_b32 s34, s28, 12
    s_add_u32 s34, s34, 147456
    v_add_u32 v117, s34, v116
    v_and_b32 v16, 15, v252
    v_lshlrev_b32_e64 v16, 9, v16
sk_78:
    s_barrier
    s_add_u32 s96, s25, 12
    s_and_b32 s96, s96, 15
    s_lshl_b32 s96, s96, 17
    s_add_u32 s96, s96, 65536
    s_add_u32 m0, s101, 114688
    s_nop 0
    buffer_load_dwordx4 v14, s[8:11], s96 offen lds
    s_add_u32 s96, s25, 13
    s_and_b32 s96, s96, 15
    s_lshl_b32 s96, s96, 17
    s_add_u32 s96, s96, 65536
    s_add_u32 m0, s101, 118784
    s_nop 0
    buffer_load_dwordx4 v14, s[8:11], s96 offen lds
    s_add_u32 s96, s25, 14
    s_and_b32 s96, s96, 15
    s_lshl_b32 s96, s96, 17
    s_add_u32 s96, s96, 65536
    s_add_u32 m0, s101, 122880
    s_nop 0
    buffer_load_dwordx4 v14, s[8:11], s96 offen lds
    s_add_u32 s96, s25, 15
    s_and_b32 s96, s96, 15
    s_lshl_b32 s96, s96, 17
    s_add_u32 s96, s96, 65536
    s_add_u32 m0, s101, 126976
    s_nop 0
    buffer_load_dwordx4 v14, s[8:11], s96 offen lds
    s_waitcnt vmcnt(0) lgkmcnt(0)
    s_barrier
    s_cmp_lg_u32 s26, 0
    s_cbranch_scc1 l_tail
    s_mov_b32 s26, 16777216
    s_mov_b32 s36, 0
    s_add_u32 s96, s94, 0
    s_and_b32 s96, s96, 15
    s_mul_i32 s96, s96, 393216
    s_add_u32 s96, s96, s85
    s_add_u32 m0, s87, 40960
    s_nop 0
    buffer_load_dwordx4 v8, s[16:19], s96 offen offset:0 lds
    buffer_load_dwordx4 v9, s[16:19], s96 offen offset:1024 lds
    buffer_load_dwordx4 v10, s[16:19], s96 offen offset:2048 lds
    buffer_load_dwordx4 v11, s[16:19], s96 offen offset:3072 lds
    s_add_u32 m0, s87, 45056
    s_nop 0
    buffer_load_dwordx4 v12, s[16:19], s96 offen offset:0 lds
    buffer_load_dwordx4 v13, s[16:19], s96 offen offset:1024 lds
    s_add_u32 s96, s95, 1
    s_and_b32 s96, s96, 15
    s_mul_i32 s96, s96, 393216
    s_add_u32 s96, s96, s85
    s_add_u32 m0, s87, 65536
    s_nop 0
    buffer_load_dwordx4 v8, s[16:19], s96 offen offset:0 lds
    buffer_load_dwordx4 v9, s[16:19], s96 offen offset:1024 lds
    buffer_load_dwordx4 v10, s[16:19], s96 offen offset:2048 lds
    buffer_load_dwordx4 v11, s[16:19], s96 offen offset:3072 lds
    s_add_u32 m0, s87, 69632
    s_nop 0
    buffer_load_dwordx4 v12, s[16:19], s96 offen offset:0 lds
    buffer_load_dwordx4 v13, s[16:19], s96 offen offset:1024 lds
    s_add_u32 s96, s95, 1
    s_and_b32 s96, s96, 15
    s_lshl_b32 s37, 1, s96
    s_lshl_b32 s38, 1, s98
    s_or_b32 s38, s38, s37
    s_lshl_b32 s30, s99, 13
    s_add_u32 s30, s30, 0xc00000
    s_mov_b32 s78, s27
pl_80:
    buffer_load_dword v17, v16, s[20:23], s30 offen sc1
    s_waitcnt vmcnt(0)
pc_81:
    v_cmp_ne_u32 vcc, -1, v17
    s_and_b32 s36, vcc_lo, s38
    s_cselect_b64 vcc, 0, -1
    s_cbranch_vccz pd_82
    s_sub_u32 s78, s78, 1
    s_cmp_lg_u32 s78, 0
    s_cbranch_scc1 pl_80
    s_mov_b32 s27, 1
pd_82:
    s_and_b32 s36, s36, s37
    s_cmp_eq_u32 s36, 0
    s_cbranch_scc1 sk_83
    s_add_u32 s96, s95, 1
    s_and_b32 s96, s96, 15
    s_lshl_b32 s97, s96, 14
    s_add_u32 s97, s97, s84
    s_add_u32 m0, s86, 131072
    s_nop 0
    buffer_load_dwordx4 v253, s[20:23], s97 offen offset:0 sc1 lds
    buffer_load_dwordx4 v253, s[20:23], s97 offen offset:1024 sc1 lds
    buffer_load_dwordx4 v253, s[20:23], s97 offen offset:2048 sc1 lds
    buffer_load_dwordx4 v253, s[20:23], s97 offen offset:3072 sc1 lds
sk_83:
    s_barrier
    s_lshl_b32 s30, s99, 13
    s_add_u32 s30, s30, 0xc00000
    s_add_u32 s31, s30, 4096
    buffer_load_dwordx4 v[64:67], v253, s[20:23], s30 offen offset:0 sc1
    buffer_load_dwordx4 v[68:71], v253, s[20:23], s30 offen offset:1024 sc1
    buffer_load_dwordx4 v[72:75], v253, s[20:23], s30 offen offset:2048 sc1
    buffer_load_dwordx4 v[76:79], v253, s[20:23], s30 offen offset:3072 sc1
    buffer_load_dwordx4 v[80:83], v253, s[20:23], s31 offen offset:0 sc1
    buffer_load_dwordx4 v[84:87], v253, s[20:23], s31 offen offset:1024 sc1
    buffer_load_dwordx4 v[88:91], v253, s[20:23], s31 offen offset:2048 sc1
    buffer_load_dwordx4 v[92:95], v253, s[20:23], s31 offen offset:3072 sc1
    s_add_u32 s96, s94, 2
    s_and_b32 s96, s96, 15
    s_mul_i32 s96, s96, 393216
    s_add_u32 s96, s96, s85
    s_add_u32 m0, s87, 90112
    s_nop 0
    buffer_load_dwordx4 v8, s[16:19], s96 offen offset:0 lds
    buffer_load_dwordx4 v9, s[16:19], s96 offen offset:1024 lds
    buffer_load_dwordx4 v10, s[16:19], s96 offen offset:2048 lds
    buffer_load_dwordx4 v11, s[16:19], s96 offen offset:3072 lds
    s_add_u32 m0, s87, 94208
    s_nop 0
    buffer_load_dwordx4 v12, s[16:19], s96 offen offset:0 lds
    buffer_load_dwordx4 v13, s[16:19], s96 offen offset:1024 lds
    ds_read_b128 v[32:35], v117 offset:0
    ds_read_b128 v[36:39], v117 offset:512
    ds_read_b128 v[40:43], v117 offset:1024
    ds_read_b128 v[44:47], v117 offset:1536
    s_mov_b32 s78, s27
    s_waitcnt vmcnt(6)
    s_branch pc_85
    s_nop 0
pl_84:
    s_lshl_b32 s30, s99, 13
    s_add_u32 s30, s30, 0xc00000
    s_add_u32 s31, s30, 4096
    buffer_load_dwordx4 v[64:67], v253, s[20:23], s30 offen offset:0 sc1
    buffer_load_dwordx4 v[68:71], v253, s[20:23], s30 offen offset:1024 sc1
    buffer_load_dwordx4 v[72:75], v253, s[20:23], s30 offen offset:2048 sc1
    buffer_load_dwordx4 v[76:79], v253, s[20:23], s30 offen offset:3072 sc1
    buffer_load_dwordx4 v[80:83], v253, s[20:23], s31 offen offset:0 sc1
    buffer_load_dwordx4 v[84:87], v253, s[20:23], s31 offen offset:1024 sc1
    buffer_load_dwordx4 v[88:91], v253, s[20:23], s31 offen offset:2048 sc1
    buffer_load_dwordx4 v[92:95], v253, s[20:23], s31 offen offset:3072 sc1
    s_waitcnt vmcnt(0)
pc_85:
    v_max3_u32 v48, v64, v68, v72
    v_max3_u32 v48, v48, v76, v80
    v_max3_u32 v48, v48, v84, v88
    v_max_u32 v48, v48, v92
    v_cmp_eq_u32_e64 vcc, -1, v48
    s_cbranch_vccz pd_86
    s_sub_u32 s78, s78, 1
    s_cmp_lg_u32 s78, 0
    s_cbranch_scc1 pl_84
    s_mov_b32 s27, 1
pd_86:
    s_cmp_lg_u32 s36, 0
    s_cbranch_scc1 sk_87
    s_add_u32 s96, s95, 1
    s_and_b32 s96, s96, 15
    s_lshl_b32 s97, s96, 14
    s_add_u32 s97, s97, s84
    s_add_u32 m0, s86, 131072
    s_nop 0
    buffer_load_dwordx4 v253, s[20:23], s97 offen offset:0 sc1 lds
    buffer_load_dwordx4 v253, s[20:23], s97 offen offset:1024 sc1 lds
    buffer_load_dwordx4 v253, s[20:23], s97 offen offset:2048 sc1 lds
    buffer_load_dwordx4 v253, s[20:23], s97 offen offset:3072 sc1 lds
sk_87:
    s_add_u32 s96, s94, 2
    s_and_b32 s96, s96, 15
    s_lshl_b32 s97, s96, 14
    s_add_u32 s97, s97, s84
    s_add_u32 m0, s86, 114688
    s_nop 0
    buffer_load_dwordx4 v253, s[20:23], s97 offen offset:0 sc1 lds
    v_add_f32 v64, v64, v68
    v_add_f32 v65, v65, v69
    v_add_f32 v66, v66, v70
    v_add_f32 v67, v67, v71
    v_add_f32 v64, v64, v72
    v_add_f32 v65, v65, v73
    v_add_f32 v66, v66, v74
    v_add_f32 v67, v67, v75
    v_add_f32 v64, v64, v76
    v_add_f32 v65, v65, v77
    v_add_f32 v66, v66, v78
    v_add_f32 v67, v67, v79
    v_add_f32 v64, v64, v80
    v_add_f32 v65, v65, v81
    v_add_f32 v66, v66, v82
    v_add_f32 v67, v67, v83
    v_add_f32 v64, v64, v84
    v_add_f32 v65, v65, v85
    v_add_f32 v66, v66, v86
    v_add_f32 v67, v67, v87
    v_add_f32 v64, v64, v88
    v_add_f32 v65, v65, v89
    v_add_f32 v66, v66, v90
    v_add_f32 v67, v67, v91
    v_add_f32 v64, v64, v92
    v_add_f32_e64 v65, v65, v93
    buffer_load_dwordx4 v253, s[20:23], s97 offen offset:1024 sc1 lds
    v_add_f32 v66, v66, v94
    v_add_f32 v67, v67, v95
    v_mov_b32 v48, v64
    v_mov_b32 v49, v65
    v_mov_b32 v50, v66
    v_mov_b32 v51, v67
    v_permlane32_swap_b32 v64, v48
    v_permlane32_swap_b32 v65, v49
    v_permlane32_swap_b32 v66, v50
    v_permlane32_swap_b32 v67, v51
    v_add_f32 v64, v64, v48
    v_add_f32 v65, v65, v49
    v_add_f32 v66, v66, v50
    v_add_f32 v67, v67, v51
    v_mul_f32 v54, 0x3a800000, v64
    v_mul_f32 v65, 0x3a800000, v65
    v_fma_f32 v65, -v54, v54, v65
    v_max_f32_e64 v65, 0, v65
    v_add_f32 v55, 0x3727c5ac, v65
    v_rsq_f32 v55, v55
    s_waitcnt lgkmcnt(0)
    v_fma_f32 v52, -v54, v67, v66
    v_and_b32_e64 v53, 31, v252
    v_mul_f32 v52, v52, v55
    s_lshl_b32 s32, s99, 5
    buffer_load_dwordx4 v253, s[20:23], s97 offen offset:2048 sc1 lds
    v_add_u32 v53, s32, v53
    v_mov_b32 v48, v52
    s_nop 1
    v_max_f32_dpp v48, v48, v48 quad_perm:[1,0,3,2] row_mask:0xf bank_mask:0xf
    s_nop 1
    v_max_f32_dpp v48, v48, v48 quad_perm:[2,3,0,1] row_mask:0xf bank_mask:0xf
    s_nop 1
    v_max_f32_dpp v48, v48, v48 row_half_mirror row_mask:0xf bank_mask:0xf
    s_nop 1
    v_max_f32_dpp v48, v48, v48 row_mirror row_mask:0xf bank_mask:0xf
    v_mov_b32 v49, v48
    s_nop 1
    v_permlane16_swap_b32 v48, v49
    v_max_f32 v48, v48, v49
    v_cmp_eq_f32 vcc, v48, v52
    v_lshrrev_b32 v50, 5, v252
    v_lshlrev_b32_e64 v50, 4, v50
    s_lshr_b32 s34, s25, 3
    v_lshl_add_u32 v51, s34, 28, v50
    s_lshl_b32 s32, s99, 11
    s_lshl_b32 s33, s98, 7
    s_add_u32 s32, s32, s33
    s_add_u32 s32, s32, 0xd60000
    s_and_b32 s34, s25, 7
    s_lshl_b32 s34, s34, 6
    s_add_u32 s34, s34, s99
    s_mul_i32 s34, s34, 32
    s_add_u32 s34, s34, 0xdc0000
    s_ff1_i32_b32 s35, vcc_lo
    s_lshl_b32 s35, 1, s35
    buffer_load_dwordx4 v253, s[20:23], s97 offen offset:3072 sc1 lds
    s_mov_b32 exec_lo, s35
    s_mov_b32 exec_hi, s35
    buffer_store_dwordx4 v[52:55], v51, s[20:23], s34 offen sc1
    buffer_store_dwordx4 v[32:35], v50, s[20:23], s32 offen offset:0 sc1
    buffer_store_dwordx4 v[36:39], v50, s[20:23], s32 offen offset:32 sc1
    buffer_store_dwordx4 v[40:43], v50, s[20:23], s32 offen offset:64 sc1
    buffer_store_dwordx4 v[44:47], v50, s[20:23], s32 offen offset:96 sc1
    s_mov_b64 exec, -1
    s_waitcnt vmcnt(9) lgkmcnt(0)
    s_barrier
    s_add_u32 s96, s95, 3
    s_and_b32 s96, s96, 15
    s_lshl_b32 s97, s96, 14
    s_add_u32 s97, s97, s84
    s_add_u32 m0, s86, 147456
    s_nop 0
    buffer_load_dwordx4 v253, s[20:23], s97 offen offset:0 sc1 lds
    buffer_load_dwordx4 v253, s[20:23], s97 offen offset:1024 sc1 lds
    buffer_load_dwordx4 v253, s[20:23], s97 offen offset:2048 sc1 lds
    buffer_load_dwordx4 v253, s[20:23], s97 offen offset:3072 sc1 lds
    s_add_u32 s96, s95, 3
    s_and_b32 s96, s96, 15
    s_mul_i32 s96, s96, 393216
    s_add_u32 s96, s96, s85
    s_add_u32 m0, s87, 40960
    s_nop 0
    buffer_load_dwordx4 v8, s[16:19], s96 offen offset:0 lds
    buffer_load_dwordx4 v9, s[16:19], s96 offen offset:1024 lds
    buffer_load_dwordx4 v10, s[16:19], s96 offen offset:2048 lds
    buffer_load_dwordx4 v11, s[16:19], s96 offen offset:3072 lds
    s_add_u32 m0, s87, 45056
    s_nop 0
    buffer_load_dwordx4 v12, s[16:19], s96 offen offset:0 lds
    buffer_load_dwordx4 v13, s[16:19], s96 offen offset:1024 lds
    s_waitcnt vmcnt(15) lgkmcnt(0)
    s_barrier
    s_add_u32 s96, s94, 4
    s_and_b32 s96, s96, 15
    s_lshl_b32 s97, s96, 14
    s_add_u32 s97, s97, s84
    s_add_u32 m0, s86, 131072
    s_nop 0
    buffer_load_dwordx4 v253, s[20:23], s97 offen offset:0 sc1 lds
    buffer_load_dwordx4 v253, s[20:23], s97 offen offset:1024 sc1 lds
    v_add_f32 v56, 1.0, v55
    v_mul_f32 v57, v54, v55
    v_mul_f32_e64 v58, v56, v56
    buffer_load_dwordx4 v253, s[20:23], s97 offen offset:2048 sc1 lds
    v_sub_f32 v57, 0, v57
    v_mul_f32 v58, v58, v65
    v_add_f32 v58, 0x3727c5ac, v58
    buffer_load_dwordx4 v253, s[20:23], s97 offen offset:3072 sc1 lds
    v_rsq_f32 v58, v58
    s_nop 0
    v_mul_f32 v58, v58, v56
    v_and_b32 v48, 31, v252
    s_add_u32 s96, s94, 4
    s_and_b32 s96, s96, 15
    s_mul_i32 s96, s96, 393216
    s_add_u32 s96, s96, s85
    s_add_u32 m0, s87, 65536
    s_nop 0
    buffer_load_dwordx4 v8, s[16:19], s96 offen offset:0 lds
    v_lshrrev_b32 v49, 5, v252
    v_cmp_eq_u32 vcc, 0, v49
    v_lshlrev_b32_e64 v49, 9, v49
    buffer_load_dwordx4 v9, s[16:19], s96 offen offset:1024 lds
    v_lshl_add_u32 v48, v48, 2, v49
    s_lshl_b32 s32, s28, 7
    v_add_u32 v48, s32, v48
    buffer_load_dwordx4 v10, s[16:19], s96 offen offset:2048 lds
    v_cndmask_b32 v49, v54, v58, vcc
    v_cndmask_b32 v50, v57, v56, vcc
    ds_write_b32 v48, v49 offset:0
    buffer_load_dwordx4 v11, s[16:19], s96 offen offset:3072 lds
    ds_write_b32 v48, v50 offset:2048
    v_and_b32 v48, 15, v252
    v_lshrrev_b32 v51, 4, v252
    s_add_u32 m0, s87, 69632
    s_nop 0
    buffer_load_dwordx4 v12, s[16:19], s96 offen offset:0 lds
    v_lshl_add_u32 v48, v48, 2, v51
    s_min_u32 s32, s28, 2
    s_lshl_b32 s32, s32, 8
    buffer_load_dwordx4 v13, s[16:19], s96 offen offset:1024 lds
    v_lshl_add_u32 v48, v48, 2, s32
    ds_write_b32 v48, v2 offset:1024
    s_waitcnt vmcnt(10) lgkmcnt(0)
    s_barrier
    s_add_u32 s96, s95, 5
    s_and_b32 s96, s96, 15
    s_lshl_b32 s97, s96, 14
    s_add_u32 s97, s97, s84
    s_add_u32 m0, s86, 114688
    s_nop 0
    buffer_load_dwordx4 v253, s[20:23], s97 offen offset:0 sc1 lds
    buffer_load_dwordx4 v253, s[20:23], s97 offen offset:1024 sc1 lds
    buffer_load_dwordx4 v253, s[20:23], s97 offen offset:2048 sc1 lds
    buffer_load_dwordx4 v253, s[20:23], s97 offen offset:3072 sc1 lds
    s_add_u32 s96, s95, 5
    s_and_b32 s96, s96, 15
    s_mul_i32 s96, s96, 393216
    s_add_u32 s96, s96, s85
    s_add_u32 m0, s87, 90112
    s_nop 0
    buffer_load_dwordx4 v8, s[16:19], s96 offen offset:0 lds
    buffer_load_dwordx4 v9, s[16:19], s96 offen offset:1024 lds
    buffer_load_dwordx4 v10, s[16:19], s96 offen offset:2048 lds
    buffer_load_dwordx4 v11, s[16:19], s96 offen offset:3072 lds
    s_add_u32 m0, s87, 94208
    s_nop 0
    buffer_load_dwordx4 v12, s[16:19], s96 offen offset:0 lds
    buffer_load_dwordx4 v13, s[16:19], s96 offen offset:1024 lds
    s_waitcnt vmcnt(10) lgkmcnt(0)
    s_barrier
    s_add_u32 s32, s79, 0xdc0000
    s_lshr_b32 vcc_lo, s24, 1
    s_mul_i32 vcc_lo, vcc_lo, 2048
    s_add_u32 s32, s32, vcc_lo
    v_lshlrev_b32_e64 v20, 1, v253
    buffer_load_dwordx4 v[16:19], v20, s[20:23], s32 offen sc1
    s_add_u32 s96, s94, 6
    s_and_b32 s96, s96, 15
    s_lshl_b32 s97, s96, 14
    s_add_u32 s97, s97, s84
    s_add_u32 m0, s86, 147456
    s_nop 0
    buffer_load_dwordx4 v253, s[20:23], s97 offen offset:0 sc1 lds
    buffer_load_dwordx4 v253, s[20:23], s97 offen offset:1024 sc1 lds
    buffer_load_dwordx4 v253, s[20:23], s97 offen offset:2048 sc1 lds
    buffer_load_dwordx4 v253, s[20:23], s97 offen offset:3072 sc1 lds
    s_add_u32 s96, s94, 6
    s_and_b32 s96, s96, 15
    s_mul_i32 s96, s96, 393216
    s_add_u32 s96, s96, s85
    s_add_u32 m0, s87, 40960
    s_nop 0
    buffer_load_dwordx4 v8, s[16:19], s96 offen offset:0 lds
    buffer_load_dwordx4 v9, s[16:19], s96 offen offset:1024 lds
    buffer_load_dwordx4 v10, s[16:19], s96 offen offset:2048 lds
    buffer_load_dwordx4 v11, s[16:19], s96 offen offset:3072 lds
    s_add_u32 m0, s87, 45056
    s_nop 0
    buffer_load_dwordx4 v12, s[16:19], s96 offen offset:0 lds
    buffer_load_dwordx4 v13, s[16:19], s96 offen offset:1024 lds
    s_waitcnt vmcnt(11) lgkmcnt(0)
    s_barrier
    s_add_u32 s96, s95, 7
    s_and_b32 s96, s96, 15
    s_lshl_b32 s97, s96, 14
    s_add_u32 s97, s97, s84
    s_add_u32 m0, s86, 131072
    s_nop 0
    buffer_load_dwordx4 v253, s[20:23], s97 offen offset:0 sc1 lds
    buffer_load_dwordx4 v253, s[20:23], s97 offen offset:1024 sc1 lds
    s_mov_b32 s78, s27
    s_waitcnt vmcnt(12)
    s_branch pc_100
pl_99:
    s_add_u32 s32, s79, 0xdc0000
    s_lshr_b32 vcc_lo, s24, 1
    s_mul_i32 vcc_lo, vcc_lo, 2048
    s_add_u32 s32, s32, vcc_lo
    v_lshlrev_b32 v20, 1, v253
    buffer_load_dwordx4 v[16:19], v20, s[20:23], s32 offen sc1
    s_waitcnt vmcnt(0)
pc_100:
    v_max3_u32 v20, v16, v17, v18
    v_max_u32 v20, v20, v19
    v_cmp_eq_u32 vcc, -1, v20
    s_cbranch_vccz pd_101
    s_sub_u32 s78, s78, 1
    s_cmp_lg_u32 s78, 0
    s_cbranch_scc1 pl_99
    s_mov_b32 s27, 1
pd_101:
    buffer_load_dwordx4 v253, s[20:23], s97 offen offset:2048 sc1 lds
    buffer_load_dwordx4 v253, s[20:23], s97 offen offset:3072 sc1 lds
    s_add_u32 s96, s95, 7
    s_and_b32 s96, s96, 15
    s_mul_i32 s96, s96, 393216
    s_add_u32 s96, s96, s85
    s_add_u32 m0, s87, 65536
    s_nop 0
    buffer_load_dwordx4 v8, s[16:19], s96 offen offset:0 lds
    v_mov_b32 v20, v16
    s_nop 1
    v_max_f32_dpp v20, v20, v20 quad_perm:[1,0,3,2] row_mask:0xf bank_mask:0xf
    s_nop 1
    v_max_f32_dpp v20, v20, v20 quad_perm:[2,3,0,1] row_mask:0xf bank_mask:0xf
    s_nop 1
    v_max_f32_dpp v20, v20, v20 row_half_mirror row_mask:0xf bank_mask:0xf
    buffer_load_dwordx4 v9, s[16:19], s96 offen offset:1024 lds
    s_nop 0
    v_max_f32_dpp v20, v20, v20 row_mirror row_mask:0xf bank_mask:0xf
    v_mov_b32 v21, v20
    s_nop 1
    v_permlane16_swap_b32 v20, v21
    v_max_f32 v20, v20, v21
    v_mov_b32 v21, v20
    s_nop 1
    v_permlane32_swap_b32 v20, v21
    buffer_load_dwordx4 v10, s[16:19], s96 offen offset:2048 lds
    v_max_f32 v20, v20, v21
    v_cmp_eq_f32 vcc, v20, v16
    s_ff1_i32_b64 s32, vcc
    s_and_b32 s32, s32, 63
    v_readlane_b32 s74, v16, s32
    v_readlane_b32 s73, v17, s32
    v_readlane_b32 s75, v18, s32
    buffer_load_dwordx4 v11, s[16:19], s96 offen offset:3072 lds
    v_readlane_b32 s76, v19, s32
    s_and_b32 s73, s73, 2047
    s_lshr_b32 s33, s73, 5
    s_lshl_b32 s33, s33, 11
    s_add_u32 s33, s33, s79
    s_add_u32 s33, s33, 0xd60000
    s_add_u32 m0, s87, 69632
    s_nop 0
    buffer_load_dwordx4 v12, s[16:19], s96 offen offset:0 lds
    buffer_load_dwordx4 v[24:27], v22, s[20:23], s33 offen sc1
    v_mov_b32 v20, s73
    v_mov_b32 v21, s77
    v_mov_b32_e64 v19, 0
    ds_write_b64 v19, v[20:21] offset:3072
    s_lshr_b32 s39, s73, 5
    s_lshl_b32 s34, s24, 2
    buffer_load_dwordx4 v13, s[16:19], s96 offen offset:1024 lds
    s_sub_u32 s39, s39, s34
    s_add_u32 s39, s39, 8
    s_lshr_b32 s34, s39, 3
    s_add_u32 s34, s34, 1
    s_cmp_lt_u32 s39, 12
    s_cselect_b32 s100, s34, 0
    s_waitcnt vmcnt(11) lgkmcnt(0)
    s_barrier
    s_add_u32 s96, s94, 8
    s_and_b32 s96, s96, 15
    s_lshl_b32 s97, s96, 14
    s_add_u32 s97, s97, s84
    s_add_u32 m0, s86, 114688
    s_nop 0
    buffer_load_dwordx4 v253, s[20:23], s97 offen offset:0 sc1 lds
    buffer_load_dwordx4 v253, s[20:23], s97 offen offset:1024 sc1 lds
    s_mov_b32 s78, s27
    s_waitcnt vmcnt(3)
    s_branch pc_89
    s_nop 0
pl_88:
    s_lshr_b32 s33, s73, 5
    s_lshl_b32 s33, s33, 11
    s_add_u32 s33, s33, s79
    s_add_u32 s33, s33, 0xd60000
    buffer_load_dwordx4 v[24:27], v22, s[20:23], s33 offen sc1
    s_waitcnt vmcnt(0)
pc_89:
    v_max3_u32 v30, v24, v25, v26
    v_max_u32 v30, v30, v27
    v_cmp_eq_u32 vcc, -1, v30
    s_cbranch_vccz pd_90
    s_sub_u32 s78, s78, 1
    s_cmp_lg_u32 s78, 0
    s_cbranch_scc1 pl_88
    s_mov_b32 s27, 1
pd_90:
    buffer_load_dwordx4 v253, s[20:23], s97 offen offset:2048 sc1 lds
    buffer_load_dwordx4 v253, s[20:23], s97 offen offset:3072 sc1 lds
    s_cmp_lt_i32 s89, 0
    s_cbranch_scc1 sk_91
    v_and_b32 v30, 16, v252
    v_cmp_eq_u32 vcc, 16, v30
    v_mov_b32 v28, s76
    v_mul_f32 v29, s75, v28
    v_add_f32 v28, 1.0, v28
    v_cndmask_b32 v30, v24, v25, vcc
    v_cndmask_b32_e64 v31, v26, v27, vcc
    s_mov_b32 vcc_lo, 0xaaaaaaaa
    s_mov_b32 vcc_hi, 0xaaaaaaaa
    v_mov_b32 v96, 0xbfb8aa3b
    v_mul_f32 v96, s74, v96
    v_exp_f32 v96, v96
    v_cndmask_b32 v30, v30, v31, vcc
    v_lshlrev_b32 v92, 16, v30
    v_and_b32 v93, 0xffff0000, v30
    v_fma_f32 v92, v92, v28, -v29
    v_fma_f32 v93, v93, v28, -v29
    v_add_f32 v96, 1.0, v96
    v_rcp_f32 v96, v96
sk_91:
    s_add_u32 s96, s94, 8
    s_and_b32 s96, s96, 15
    s_mul_i32 s96, s96, 393216
    s_add_u32 s96, s96, s85
    s_add_u32 m0, s87, 90112
    s_nop 0
    buffer_load_dwordx4 v8, s[16:19], s96 offen offset:0 lds
    buffer_load_dwordx4 v9, s[16:19], s96 offen offset:1024 lds
    v_mov_b32 v28, s76
    v_mul_f32 v29, s75, v28
    v_lshlrev_b32_e64 v30, 16, v24
    v_and_b32 v31, 0xffff0000, v24
    v_fma_f32 v30, v30, v28, -v29
    v_fma_f32 v31, v31, v28, -v29
    buffer_load_dwordx4 v10, s[16:19], s96 offen offset:2048 lds
    v_cvt_pk_bf16_f32 v24, v30, v31
    v_lshlrev_b32_e64 v30, 16, v25
    v_and_b32 v31, 0xffff0000, v25
    v_fma_f32 v30, v30, v28, -v29
    v_fma_f32 v31, v31, v28, -v29
    v_cvt_pk_bf16_f32 v25, v30, v31
    v_lshlrev_b32_e64 v30, 16, v26
    v_and_b32 v31, 0xffff0000, v26
    v_fma_f32 v30, v30, v28, -v29
    v_fma_f32 v31, v31, v28, -v29
    buffer_load_dwordx4 v11, s[16:19], s96 offen offset:3072 lds
    v_cvt_pk_bf16_f32 v26, v30, v31
    v_lshlrev_b32_e64 v30, 16, v27
    v_and_b32 v31, 0xffff0000, v27
    v_fma_f32 v30, v30, v28, -v29
    v_fma_f32 v31, v31, v28, -v29
    v_cvt_pk_bf16_f32 v27, v30, v31
    s_bitcmp0_b32 s29, 0
    s_cbranch_scc1 sk_92
    v_swap_b32 v24, v25
    v_swap_b32 v26, v27
sk_92:
    s_add_u32 m0, s87, 94208
    s_nop 0
    buffer_load_dwordx4 v12, s[16:19], s96 offen offset:0 lds
    s_bitcmp0_b32 s29, 1
    s_cbranch_scc1 sk_93
    v_swap_b32 v24, v26
    v_swap_b32 v25, v27
sk_93:
    buffer_load_dwordx4 v13, s[16:19], s96 offen offset:1024 lds
    s_cmp_ge_u32 s29, 224
    s_cbranch_scc1 sk_94
    v_dot2_f32_bf16 v32, v155, v24, 0
    v_dot2_f32_bf16 v33, v160, v24, 0
    v_dot2_f32_bf16 v34, v156, v24, 0
    v_dot2_f32_bf16 v35, v161, v24, 0
    v_dot2_f32_bf16 v36, v157, v24, 0
    v_dot2_f32_bf16 v37, v162, v24, 0
    v_dot2_f32_bf16 v38, v158, v24, 0
    v_dot2_f32_bf16 v39, v163, v24, 0
    v_dot2_f32_bf16 v40, v183, v24, 0
    v_dot2_f32_bf16 v41, v192, v24, 0
    v_dot2_f32_bf16 v42, v188, v24, 0
    v_dot2_f32_bf16 v43, v193, v24, 0
    v_dot2_f32_bf16 v44, v189, v24, 0
    v_dot2_f32_bf16 v45, v194, v24, 0
    v_dot2_f32_bf16 v46, v190, v24, 0
    v_dot2_f32_bf16 v47, v195, v24, 0
    v_dot2_f32_bf16 v32, v159, v25, v32
    v_dot2_f32_bf16 v33, v168, v25, v33
    v_dot2_f32_bf16 v34, v164, v25, v34
    v_dot2_f32_bf16 v35, v169, v25, v35
    v_dot2_f32_bf16 v36, v165, v25, v36
    v_dot2_f32_bf16 v37, v170, v25, v37
    v_dot2_f32_bf16 v38, v166, v25, v38
    v_dot2_f32_bf16 v39, v171, v25, v39
    v_dot2_f32_bf16 v40, v191, v25, v40
    v_dot2_f32_bf16 v41, v200, v25, v41
    v_dot2_f32_bf16 v42, v196, v25, v42
    v_dot2_f32_bf16 v43, v201, v25, v43
    v_dot2_f32_bf16 v44, v197, v25, v44
    v_dot2_f32_bf16 v45, v202, v25, v45
    v_dot2_f32_bf16 v46, v198, v25, v46
    v_dot2_f32_bf16 v47, v203, v25, v47
    v_dot2_f32_bf16 v32, v167, v26, v32
    v_dot2_f32_bf16 v33, v176, v26, v33
    v_dot2_f32_bf16 v34, v172, v26, v34
    v_dot2_f32_bf16 v35, v177, v26, v35
    v_dot2_f32_bf16 v36, v173, v26, v36
    v_dot2_f32_bf16 v37, v178, v26, v37
    v_dot2_f32_bf16 v38, v174, v26, v38
    v_dot2_f32_bf16 v39, v179, v26, v39
    v_dot2_f32_bf16 v40, v199, v26, v40
    v_dot2_f32_bf16 v41, v208, v26, v41
    v_dot2_f32_bf16 v42, v204, v26, v42
    v_dot2_f32_bf16 v43, v209, v26, v43
    v_dot2_f32_bf16 v44, v205, v26, v44
    v_dot2_f32_bf16 v45, v210, v26, v45
    v_dot2_f32_bf16 v46, v206, v26, v46
    v_dot2_f32_bf16 v47, v211, v26, v47
    v_dot2_f32_bf16 v32, v175, v27, v32
    v_dot2_f32_bf16 v33, v184, v27, v33
    v_dot2_f32_bf16 v34, v180, v27, v34
    v_dot2_f32_bf16 v35, v185, v27, v35
    v_dot2_f32_bf16 v36, v181, v27, v36
    v_dot2_f32_bf16 v37, v186, v27, v37
    v_dot2_f32_bf16 v38, v182, v27, v38
    v_dot2_f32_bf16 v39, v187, v27, v39
    v_dot2_f32_bf16 v40, v207, v27, v40
    v_dot2_f32_bf16 v41, v216, v27, v41
    v_dot2_f32_bf16 v42, v212, v27, v42
    v_dot2_f32_bf16 v43, v217, v27, v43
    v_dot2_f32_bf16 v44, v213, v27, v44
    v_dot2_f32_bf16 v45, v218, v27, v45
    v_dot2_f32_bf16 v46, v214, v27, v46
    v_dot2_f32_bf16 v47, v219, v27, v47
sk_94:
    s_waitcnt vmcnt(10) lgkmcnt(0)
    s_barrier
    s_add_u32 s96, s95, 9
    s_and_b32 s96, s96, 15
    s_lshl_b32 s97, s96, 14
    s_add_u32 s97, s97, s84
    s_add_u32 m0, s86, 147456
    s_nop 0
    buffer_load_dwordx4 v253, s[20:23], s97 offen offset:0 sc1 lds
    buffer_load_dwordx4 v253, s[20:23], s97 offen offset:1024 sc1 lds
    v_lshrrev_b32 v31, 5, v252
    v_lshlrev_b32 v30, 6, v31
    v_permlane32_swap_b32 v32, v40
    v_permlane32_swap_b32 v33, v41
    v_permlane32_swap_b32 v34, v42
    v_permlane32_swap_b32_e64 v35, v43
    buffer_load_dwordx4 v253, s[20:23], s97 offen offset:2048 sc1 lds
    v_permlane32_swap_b32 v36, v44
    v_permlane32_swap_b32 v37, v45
    v_permlane32_swap_b32 v38, v46
    v_permlane32_swap_b32 v39, v47
    v_add_f32_e64 v32, v32, v40
    buffer_load_dwordx4 v253, s[20:23], s97 offen offset:3072 sc1 lds
    v_add_f32 v33, v33, v41
    v_add_f32 v34, v34, v42
    v_add_f32 v35, v35, v43
    v_add_f32 v36, v36, v44
    v_add_f32_e64 v37, v37, v45
    s_add_u32 s96, s95, 9
    s_and_b32 s96, s96, 15
    s_mul_i32 s96, s96, 393216
    s_add_u32 s96, s96, s85
    s_add_u32 m0, s87, 40960
    s_nop 0
    buffer_load_dwordx4 v8, s[16:19], s96 offen offset:0 lds
    v_add_f32 v38, v38, v46
    v_add_f32 v39, v39, v47
    v_and_b32_e64 v31, 1, v252
    v_lshl_add_u32 v30, v31, 5, v30
    v_permlane16_swap_b32_e64 v32, v36
    buffer_load_dwordx4 v9, s[16:19], s96 offen offset:1024 lds
    v_permlane16_swap_b32 v33, v37
    v_permlane16_swap_b32 v34, v38
    v_permlane16_swap_b32 v35, v39
    v_add_f32 v32, v32, v36
    v_add_f32 v33, v33, v37
    v_add_f32 v34, v34, v38
    buffer_load_dwordx4 v10, s[16:19], s96 offen offset:2048 lds
    v_add_f32 v35, v35, v39
    v_and_b32 v31, 16, v252
    s_lshl_b32 s32, s28, 7
    v_add3_u32 v30, v31, v30, s32
    v_add_f32_dpp v32, v32, v32 quad_perm:[2,3,0,1] row_mask:0xf bank_mask:0xf
    buffer_load_dwordx4 v11, s[16:19], s96 offen offset:3072 lds
    v_add_f32_dpp v33, v33, v33 quad_perm:[2,3,0,1] row_mask:0xf bank_mask:0xf
    v_add_f32_dpp v34, v34, v34 quad_perm:[2,3,0,1] row_mask:0xf bank_mask:0xf
    v_add_f32_dpp v35, v35, v35 quad_perm:[2,3,0,1] row_mask:0xf bank_mask:0xf
    v_add_f32_dpp v32, v32, v32 row_ror:4 row_mask:0xf bank_mask:0xf
    v_add_f32_dpp v33, v33, v33 row_ror:4 row_mask:0xf bank_mask:0xf
    s_add_u32 m0, s87, 45056
    s_nop 0
    buffer_load_dwordx4 v12, s[16:19], s96 offen offset:0 lds
    v_add_f32_dpp v34, v34, v34 row_ror:4 row_mask:0xf bank_mask:0xf
    v_add_f32_dpp v35, v35, v35 row_ror:4 row_mask:0xf bank_mask:0xf
    v_add_f32_dpp v32, v32, v32 row_ror:8 row_mask:0xf bank_mask:0xf
    v_add_f32_dpp v33, v33, v33 row_ror:8 row_mask:0xf bank_mask:0xf
    v_add_f32_dpp v34, v34, v34 row_ror:8 row_mask:0xf bank_mask:0xf
    buffer_load_dwordx4 v13, s[16:19], s96 offen offset:1024 lds
    v_add_f32_dpp v35, v35, v35 row_ror:8 row_mask:0xf bank_mask:0xf
    s_mov_b32 exec_lo, 0x00030003
    s_mov_b32 exec_hi, 0x00030003
    ds_write_b128 v30, v[32:35] offset:3328
    s_mov_b64 exec, -1
    s_waitcnt vmcnt(10) lgkmcnt(0)
    s_barrier
    s_add_u32 s96, s94, 10
    s_and_b32 s96, s96, 15
    s_lshl_b32 s97, s96, 14
    s_add_u32 s97, s97, s84
    s_add_u32 m0, s86, 131072
    s_nop 0
    buffer_load_dwordx4 v253, s[20:23], s97 offen offset:0 sc1 lds
    buffer_load_dwordx4 v253, s[20:23], s97 offen offset:1024 sc1 lds
    v_and_b32_e64 v30, 1, v252
    v_bfe_u32 v31, v252, 1, 3
    v_lshl_add_u32 v30, v30, 3, v31
    v_lshlrev_b32_e64 v30, 2, v30
    v_add_u32 v30, 3328, v30
    ds_read2_b32 v[32:33], v30 offset0:0 offset1:16
    buffer_load_dwordx4 v253, s[20:23], s97 offen offset:2048 sc1 lds
    ds_read2_b32 v[34:35], v30 offset0:32 offset1:48
    ds_read2_b32 v[36:37], v30 offset0:64 offset1:80
    ds_read2_b32 v[38:39], v30 offset0:96 offset1:112
    v_lshrrev_b32_e64 v30, 2, v252
    v_mul_u32_u24 v30, 7168, v30
    buffer_load_dwordx4 v253, s[20:23], s97 offen offset:3072 sc1 lds
    v_and_b32_e64 v31, 2, v252
    v_lshl_add_u32 v30, v31, 3, v30
    s_add_u32 s32, s29, 32
    s_lshr_b32 s32, s32, 8
    v_lshl_add_u32 v30, s32, 31, v30
    s_add_u32 s96, s94, 10
    s_and_b32 s96, s96, 15
    s_mul_i32 s96, s96, 393216
    s_add_u32 s96, s96, s85
    s_add_u32 m0, s87, 65536
    s_nop 0
    buffer_load_dwordx4 v8, s[16:19], s96 offen offset:0 lds
    s_mul_i32 s32, s28, 114688
    s_mul_i32 s33, s29, 32
    s_add_u32 s32, s32, s33
    s_add_u32 s32, s32, s79
    s_add_u32 s32, s32, 0xc80000
    buffer_load_dwordx4 v9, s[16:19], s96 offen offset:1024 lds
    s_waitcnt lgkmcnt(0)
    v_add_f32 v32, v32, v34
    v_add_f32 v33, v33, v35
    v_add_f32 v36, v36, v38
    v_add_f32 v37, v37, v39
    buffer_load_dwordx4 v10, s[16:19], s96 offen offset:2048 lds
    v_add_f32 v32, v32, v36
    v_add_f32 v33, v33, v37
    v_mul_f32 v34, 0xbfb8aa3b, v32
    v_exp_f32 v34, v34
    v_mul_f32 v32, v32, v33
    buffer_load_dwordx4 v11, s[16:19], s96 offen offset:3072 lds
    v_add_f32 v34, 1.0, v34
    v_rcp_f32 v34, v34
    s_nop 0
    v_mul_f32 v32, v32, v34
    s_nop 1
    v_mov_b32_dpp v33, v32 quad_perm:[2,3,2,3] row_mask:0xf bank_mask:0xf
    v_cvt_pk_bf16_f32 v32, v32, v33
    s_add_u32 m0, s87, 69632
    s_nop 0
    buffer_load_dwordx4 v12, s[16:19], s96 offen offset:0 lds
    ds_swizzle_b32 v36, v32 offset:0x1
    ds_swizzle_b32 v37, v32 offset:0x81
    ds_swizzle_b32 v38, v32 offset:0x101
    ds_swizzle_b32 v39, v32 offset:0x181
    s_waitcnt lgkmcnt(0)
    buffer_load_dwordx4 v13, s[16:19], s96 offen offset:1024 lds
    s_cmp_ge_u32 s29, 224
    s_cbranch_scc1 sk_95
    v_dot2_f32_bf16 v40, v215, v36, 0
    v_dot2_f32_bf16 v41, v224, v36, 0
    v_dot2_f32_bf16 v42, v220, v36, 0
    v_dot2_f32_bf16 v43, v225, v36, 0
    v_dot2_f32_bf16 v44, v221, v36, 0
    v_dot2_f32_bf16 v45, v226, v36, 0
    v_dot2_f32_bf16 v46, v222, v36, 0
    v_dot2_f32_bf16 v47, v227, v36, 0
    v_dot2_f32_bf16 v40, v223, v37, v40
    v_dot2_f32_bf16 v41, v232, v37, v41
    v_dot2_f32_bf16 v42, v228, v37, v42
    v_dot2_f32_bf16 v43, v233, v37, v43
    v_dot2_f32_bf16 v44, v229, v37, v44
    v_dot2_f32_bf16 v45, v234, v37, v45
    v_dot2_f32_bf16 v46, v230, v37, v46
    v_dot2_f32_bf16 v47, v235, v37, v47
    v_dot2_f32_bf16 v40, v231, v38, v40
    v_dot2_f32_bf16 v41, v240, v38, v41
    v_dot2_f32_bf16 v42, v236, v38, v42
    v_dot2_f32_bf16 v43, v241, v38, v43
    v_dot2_f32_bf16 v44, v237, v38, v44
    v_dot2_f32_bf16 v45, v242, v38, v45
    v_dot2_f32_bf16 v46, v238, v38, v46
    v_dot2_f32_bf16 v47, v243, v38, v47
    v_dot2_f32_bf16 v40, v239, v39, v40
    v_dot2_f32_bf16 v41, v248, v39, v41
    v_dot2_f32_bf16 v42, v244, v39, v42
    v_dot2_f32_bf16 v43, v249, v39, v43
    v_dot2_f32_bf16 v44, v245, v39, v44
    v_dot2_f32_bf16 v45, v250, v39, v45
    v_dot2_f32_bf16 v46, v246, v39, v46
    v_dot2_f32_bf16 v47, v251, v39, v47
sk_95:
    v_add_f32_dpp v40, v40, v40 quad_perm:[1,0,3,2] row_mask:0xf bank_mask:0xf
    v_add_f32_dpp v41, v41, v41 quad_perm:[1,0,3,2] row_mask:0xf bank_mask:0xf
    v_add_f32_dpp v42, v42, v42 quad_perm:[1,0,3,2] row_mask:0xf bank_mask:0xf
    v_add_f32_dpp v43, v43, v43 quad_perm:[1,0,3,2] row_mask:0xf bank_mask:0xf
    v_add_f32_dpp v44, v44, v44 quad_perm:[1,0,3,2] row_mask:0xf bank_mask:0xf
    v_add_f32_dpp v45, v45, v45 quad_perm:[1,0,3,2] row_mask:0xf bank_mask:0xf
    v_add_f32_dpp v46, v46, v46 quad_perm:[1,0,3,2] row_mask:0xf bank_mask:0xf
    v_add_f32_dpp v47, v47, v47 quad_perm:[1,0,3,2] row_mask:0xf bank_mask:0xf
    s_mov_b32 exec_lo, 0x55555555
    s_mov_b32 exec_hi, 0x55555555
    v_cvt_pk_bf16_f32 v40, v40, v41
    v_cvt_pk_bf16_f32 v41, v42, v43
    v_cvt_pk_bf16_f32 v42, v44, v45
    v_cvt_pk_bf16_f32 v43, v46, v47
    buffer_store_dwordx4 v[40:43], v30, s[20:23], s32 offen sc1
    s_mov_b64 exec, -1
    s_waitcnt vmcnt(11) lgkmcnt(0)
    s_barrier
    s_add_u32 s96, s95, 11
    s_and_b32 s96, s96, 15
    s_lshl_b32 s97, s96, 14
    s_add_u32 s97, s97, s84
    s_add_u32 m0, s86, 114688
    s_nop 0
    buffer_load_dwordx4 v253, s[20:23], s97 offen offset:0 sc1 lds
    buffer_load_dwordx4 v253, s[20:23], s97 offen offset:1024 sc1 lds
    buffer_load_dwordx4 v253, s[20:23], s97 offen offset:2048 sc1 lds
    buffer_load_dwordx4 v253, s[20:23], s97 offen offset:3072 sc1 lds
    s_add_u32 s96, s95, 11
    s_and_b32 s96, s96, 15
    s_mul_i32 s96, s96, 393216
    s_add_u32 s96, s96, s85
    s_add_u32 m0, s87, 90112
    s_nop 0
    buffer_load_dwordx4 v8, s[16:19], s96 offen offset:0 lds
    buffer_load_dwordx4 v9, s[16:19], s96 offen offset:1024 lds
    buffer_load_dwordx4 v10, s[16:19], s96 offen offset:2048 lds
    buffer_load_dwordx4 v11, s[16:19], s96 offen offset:3072 lds
    s_add_u32 m0, s87, 94208
    s_nop 0
    buffer_load_dwordx4 v12, s[16:19], s96 offen offset:0 lds
    buffer_load_dwordx4 v13, s[16:19], s96 offen offset:1024 lds
    s_waitcnt vmcnt(11) lgkmcnt(0)
    s_barrier
    s_add_u32 s96, s94, 12
    s_and_b32 s96, s96, 15
    s_lshl_b32 s97, s96, 14
    s_add_u32 s97, s97, s84
    s_add_u32 m0, s86, 147456
    s_nop 0
    buffer_load_dwordx4 v253, s[20:23], s97 offen offset:0 sc1 lds
    buffer_load_dwordx4 v253, s[20:23], s97 offen offset:1024 sc1 lds
    buffer_load_dwordx4 v253, s[20:23], s97 offen offset:2048 sc1 lds
    buffer_load_dwordx4 v253, s[20:23], s97 offen offset:3072 sc1 lds
    s_add_u32 s96, s94, 12
    s_and_b32 s96, s96, 15
    s_mul_i32 s96, s96, 393216
    s_add_u32 s96, s96, s85
    s_add_u32 m0, s87, 40960
    s_nop 0
    buffer_load_dwordx4 v8, s[16:19], s96 offen offset:0 lds
    buffer_load_dwordx4 v9, s[16:19], s96 offen offset:1024 lds
    buffer_load_dwordx4 v10, s[16:19], s96 offen offset:2048 lds
    buffer_load_dwordx4 v11, s[16:19], s96 offen offset:3072 lds
    s_add_u32 m0, s87, 45056
    s_nop 0
    buffer_load_dwordx4 v12, s[16:19], s96 offen offset:0 lds
    buffer_load_dwordx4 v13, s[16:19], s96 offen offset:1024 lds
    s_waitcnt vmcnt(10) lgkmcnt(0)
    s_barrier
    s_cmp_lt_i32 s89, 0
    s_cbranch_scc0 q_red
    s_add_u32 s96, s95, 13
    s_and_b32 s96, s96, 15
    s_lshl_b32 s97, s96, 14
    s_add_u32 s97, s97, s84
    s_add_u32 m0, s86, 131072
    s_nop 0
    buffer_load_dwordx4 v253, s[20:23], s97 offen offset:0 sc1 lds
    buffer_load_dwordx4 v253, s[20:23], s97 offen offset:1024 sc1 lds
    buffer_load_dwordx4 v253, s[20:23], s97 offen offset:2048 sc1 lds
    buffer_load_dwordx4 v253, s[20:23], s97 offen offset:3072 sc1 lds
    s_add_u32 s96, s95, 13
    s_and_b32 s96, s96, 15
    s_mul_i32 s96, s96, 393216
    s_add_u32 s96, s96, s85
    s_add_u32 m0, s87, 65536
    s_nop 0
    buffer_load_dwordx4 v8, s[16:19], s96 offen offset:0 lds
    buffer_load_dwordx4 v9, s[16:19], s96 offen offset:1024 lds
    buffer_load_dwordx4 v10, s[16:19], s96 offen offset:2048 lds
    buffer_load_dwordx4 v11, s[16:19], s96 offen offset:3072 lds
    s_add_u32 m0, s87, 69632
    s_nop 0
    buffer_load_dwordx4 v12, s[16:19], s96 offen offset:0 lds
    buffer_load_dwordx4 v13, s[16:19], s96 offen offset:1024 lds
    s_waitcnt vmcnt(10) lgkmcnt(0)
    s_barrier
    s_add_u32 s96, s94, 14
    s_and_b32 s96, s96, 15
    s_lshl_b32 s97, s96, 14
    s_add_u32 s97, s97, s84
    s_add_u32 m0, s86, 114688
    s_nop 0
    buffer_load_dwordx4 v253, s[20:23], s97 offen offset:0 sc1 lds
    buffer_load_dwordx4 v253, s[20:23], s97 offen offset:1024 sc1 lds
    buffer_load_dwordx4 v253, s[20:23], s97 offen offset:2048 sc1 lds
    buffer_load_dwordx4 v253, s[20:23], s97 offen offset:3072 sc1 lds
    s_add_u32 s96, s94, 14
    s_and_b32 s96, s96, 15
    s_mul_i32 s96, s96, 393216
    s_add_u32 s96, s96, s85
    s_add_u32 m0, s87, 90112
    s_nop 0
    buffer_load_dwordx4 v8, s[16:19], s96 offen offset:0 lds
    buffer_load_dwordx4 v9, s[16:19], s96 offen offset:1024 lds
    buffer_load_dwordx4 v10, s[16:19], s96 offen offset:2048 lds
    buffer_load_dwordx4 v11, s[16:19], s96 offen offset:3072 lds
    s_add_u32 m0, s87, 94208
    s_nop 0
    buffer_load_dwordx4 v12, s[16:19], s96 offen offset:0 lds
    buffer_load_dwordx4 v13, s[16:19], s96 offen offset:1024 lds
    s_waitcnt vmcnt(10) lgkmcnt(0)
    s_barrier
    s_add_u32 s96, s95, 15
    s_and_b32 s96, s96, 15
    s_lshl_b32 s97, s96, 14
    s_add_u32 s97, s97, s84
    s_add_u32 m0, s86, 147456
    s_nop 0
    buffer_load_dwordx4 v253, s[20:23], s97 offen offset:0 sc1 lds
    buffer_load_dwordx4 v253, s[20:23], s97 offen offset:1024 sc1 lds
    buffer_load_dwordx4 v253, s[20:23], s97 offen offset:2048 sc1 lds
    buffer_load_dwordx4 v253, s[20:23], s97 offen offset:3072 sc1 lds
    s_add_u32 s96, s95, 15
    s_and_b32 s96, s96, 15
    s_mul_i32 s96, s96, 393216
    s_add_u32 s96, s96, s85
    s_add_u32 m0, s87, 40960
    s_nop 0
    buffer_load_dwordx4 v8, s[16:19], s96 offen offset:0 lds
    buffer_load_dwordx4 v9, s[16:19], s96 offen offset:1024 lds
    buffer_load_dwordx4 v10, s[16:19], s96 offen offset:2048 lds
    buffer_load_dwordx4 v11, s[16:19], s96 offen offset:3072 lds
    s_add_u32 m0, s87, 45056
    s_nop 0
    buffer_load_dwordx4 v12, s[16:19], s96 offen offset:0 lds
    buffer_load_dwordx4 v13, s[16:19], s96 offen offset:1024 lds
    s_waitcnt vmcnt(10) lgkmcnt(0)
    s_barrier
    s_min_u32 s30, s28, 2
    s_lshl_b32 s30, s30, 13
    s_add_u32 s30, s30, 90112
    v_lshrrev_b32 v20, 2, v252
    v_bfe_u32 v21, v20, 1, 2
    v_lshlrev_b32_e64 v20, 7, v20
    v_lshl_add_u32 v20, v21, 5, v20
    v_and_b32_e64 v21, 3, v252
    v_lshl_add_u32 v20, v21, 3, v20
    v_add_u32 v144, s30, v20
    v_xor_b32 v145, 32, v144
    v_xor_b32_e64 v146, 64, v144
    v_xor_b32 v147, 96, v144
    ds_read_b64_tr_b16 v[100:101], v144 offset:0
    ds_read_b64_tr_b16 v[102:103], v144 offset:2048
    ds_read_b64_tr_b16 v[104:105], v144 offset:4096
    ds_read_b64_tr_b16 v[106:107], v144 offset:6144
    ds_read_b64_tr_b16 v[108:109], v145 offset:0
    ds_read_b64_tr_b16 v[110:111], v145 offset:2048
    ds_read_b64_tr_b16 v[112:113], v145 offset:4096
    ds_read_b64_tr_b16 v[114:115], v145 offset:6144
    ds_read_b64_tr_b16 v[116:117], v146 offset:0
    ds_read_b64_tr_b16 v[118:119], v146 offset:2048
    ds_read_b64_tr_b16 v[120:121], v146 offset:4096
    ds_read_b64_tr_b16 v[122:123], v146 offset:6144
    ds_read_b64_tr_b16 v[124:125], v147 offset:0
    ds_read_b64_tr_b16 v[126:127], v147 offset:2048
    ds_read_b64_tr_b16 v[128:129], v147 offset:4096
    ds_read_b64_tr_b16 v[130:131], v147 offset:6144
    s_getpc_b64 s[32:33]
pc_102:
    s_sub_u32 s32, s32, pc_102-interleave_layers__sliding_block__moe_arch_mod__prompt_kernel
    s_subb_u32 s33, s33, 0
    s_lshr_b32 s34, s2, 3
    s_lshl_b32 s34, s34, 2
    s_add_u32 s34, s34, s28
    s_and_b32 s34, s34, 127
    s_lshl_b32 s34, s34, 7
    v_lshl_add_u32 v154, v252, 14, s34
    s_mov_b32 s34, k_exit-interleave_layers__sliding_block__moe_arch_mod__prompt_kernel
    s_mov_b32 s35, 0x20000
    buffer_load_dword v154, v154, s[32:35], 0 offen
q_join:
    s_waitcnt vmcnt(1) lgkmcnt(0)
    s_barrier
    s_add_u32 s35, s94, 14
    s_and_b32 s35, s35, 15
    s_lshl_b32 s35, s35, 7
    s_lshr_b32 vcc_lo, s24, 1
    s_lshl_b32 vcc_lo, vcc_lo, 11
    s_add_u32 vcc_lo, vcc_lo, s35
    s_add_u32 s35, vcc_lo, 0xdc4000
    v_and_b32_e64 v19, 32, v252
    v_bfe_u32 v18, v252, 4, 1
    v_lshl_add_u32 v19, v18, 3, v19
    buffer_load_dwordx2 v[132:133], v19, s[20:23], s35 offen offset:0 sc1
    buffer_load_dwordx2 v[134:135], v19, s[20:23], s35 offen offset:16 sc1
    buffer_load_dwordx2 v[136:137], v19, s[20:23], s35 offen offset:64 sc1
    buffer_load_dwordx2 v[138:139], v19, s[20:23], s35 offen offset:80 sc1
    s_cmp_eq_u32 s100, 0
    s_cbranch_scc1 sk_104
    v_and_b32 v20, 7, v252
    v_lshrrev_b32 v21, 4, v252
    v_lshl_add_u32 v21, v20, 2, v21
    s_and_b32 s34, s73, 31
    s_and_b32 s32, s34, 7
    s_and_b32 s33, s34, 8
    s_lshl_b32 s33, s33, 1
    s_add_u32 s32, s32, s33
    s_lshr_b32 s33, s34, 4
    s_lshl_b32 s33, s33, 3
    s_add_u32 s32, s32, s33
    s_cmp_eq_u32 s28, 1
    s_cselect_b32 s34, s32, s34
    v_mov_b32_e64 v20, s34
    s_cmp_ge_u32 s28, 2
    s_cselect_b64 vcc, -1, 0
    s_cselect_b32 s32, 2048, 0
    v_cndmask_b32 v30, v20, v21, vcc
    v_cndmask_b32 v31, v21, v20, vcc
    v_lshlrev_b32_e64 v0, 4, v30
    v_bfe_u32 v20, v31, 2, 2
    v_lshl_add_u32 v0, v20, 9, v0
    v_lshrrev_b32_e64 v20, 4, v31
    v_lshl_add_u32 v0, v20, 3, v0
    v_and_b32 v20, 3, v31
    v_lshl_add_u32 v0, v20, 1, v0
    s_lshl_b32 s33, s39, 12
    s_add_u32 s33, s33, s32
    s_add_u32 s33, s33, 65536
    s_lshl_b32 s34, s39, 11
    s_add_u32 s34, s34, 32768
    s_cmp_ge_u32 s39, 8
    s_cselect_b32 s38, 1, 0
    s_movk_i32 s32, 8192
    s_cmp_eq_u32 s28, 0
    s_cselect_b32 s33, s34, s33
    s_cselect_b32 s32, s32, 49152
    s_cselect_b32 s38, s38, 1
    s_cselect_b32 s37, 0x3e8293ee, 1.0
    v_bfe_u32 v20, v252, 3, 1
    v_mul_u32_u24_e64 v20, s32, v20
    v_add3_u32 v0, v0, v20, s33
sk_104:
    s_waitcnt lgkmcnt(0)
    s_barrier
    s_mov_b32 s78, s27
    s_waitcnt vmcnt(0)
    s_branch pc_106
    s_nop 0
pl_105:
    s_add_u32 s35, s94, 14
    s_and_b32 s35, s35, 15
    s_lshl_b32 s35, s35, 7
    s_lshr_b32 vcc_lo, s24, 1
    s_lshl_b32 vcc_lo, vcc_lo, 11
    s_add_u32 vcc_lo, vcc_lo, s35
    s_add_u32 s35, vcc_lo, 0xdc4000
    v_and_b32_e64 v19, 32, v252
    v_bfe_u32 v18, v252, 4, 1
    v_lshl_add_u32 v19, v18, 3, v19
    buffer_load_dwordx2 v[132:133], v19, s[20:23], s35 offen offset:0 sc1
    buffer_load_dwordx2 v[134:135], v19, s[20:23], s35 offen offset:16 sc1
    buffer_load_dwordx2 v[136:137], v19, s[20:23], s35 offen offset:64 sc1
    buffer_load_dwordx2 v[138:139], v19, s[20:23], s35 offen offset:80 sc1
    s_waitcnt vmcnt(0)
pc_106:
    v_max3_u32 v30, v132, v133, v134
    v_max3_u32 v30, v30, v135, v136
    v_max3_u32 v30, v30, v137, v138
    v_max_u32 v30, v30, v139
    v_cmp_eq_u32 vcc, -1, v30
    s_cbranch_vccz pd_107
    s_sub_u32 s78, s78, 1
    s_cmp_lg_u32 s78, 0
    s_cbranch_scc1 pl_105
    s_mov_b32 s27, 1
pd_107:
    v_mov_b32 v140, 0
    v_mov_b32 v141, 0
    v_mov_b32 v142, 0
    v_mov_b32 v143, 0
    v_dot2c_f32_bf16 v140, v132, v100
    v_dot2c_f32_bf16 v141, v132, v108
    v_dot2c_f32_bf16 v142, v132, v116
    v_dot2c_f32_bf16 v143, v132, v124
    v_dot2c_f32_bf16 v140, v133, v101
    v_dot2c_f32_bf16 v141, v133, v109
    v_dot2c_f32_bf16 v142, v133, v117
    v_dot2c_f32_bf16 v143, v133, v125
    v_dot2c_f32_bf16 v140, v134, v102
    v_dot2c_f32_bf16 v141, v134, v110
    v_dot2c_f32_bf16 v142, v134, v118
    v_dot2c_f32_bf16 v143, v134, v126
    v_dot2c_f32_bf16 v140, v135, v103
    v_dot2c_f32_bf16 v141, v135, v111
    v_dot2c_f32_bf16 v142, v135, v119
    v_dot2c_f32_bf16 v143, v135, v127
    v_dot2c_f32_bf16 v140, v136, v104
    v_dot2c_f32_bf16 v141, v136, v112
    v_dot2c_f32_bf16 v142, v136, v120
    v_dot2c_f32_bf16 v143, v136, v128
    v_dot2c_f32_bf16 v140, v137, v105
    v_dot2c_f32_bf16 v141, v137, v113
    v_dot2c_f32_bf16 v142, v137, v121
    v_dot2c_f32_bf16 v143, v137, v129
    v_dot2c_f32_bf16 v140, v138, v106
    v_dot2c_f32_bf16 v141, v138, v114
    v_dot2c_f32_bf16 v142, v138, v122
    v_dot2c_f32_bf16 v143, v138, v130
    v_dot2c_f32_bf16 v140, v139, v107
    v_dot2c_f32_bf16 v141, v139, v115
    v_dot2c_f32_bf16 v142, v139, v123
    v_dot2c_f32_bf16 v143, v139, v131
    s_min_u32 s32, s28, 2
    s_lshl_b32 s32, s32, 12
    s_lshl_b32 s33, s25, 14
    s_add_u32 s32, s32, s33
    s_add_u32 s32, s32, 0x1d80000
    s_lshl_b32 s33, s24, 8
    s_add_u32 s32, s32, s33
    v_lshlrev_b32 v20, 2, v252
    v_permlane32_swap_b32 v140, v142
    v_permlane32_swap_b32 v141, v143
    v_add_f32 v140, v140, v142
    v_add_f32 v141, v141, v143
    s_nop 1
    v_permlane16_swap_b32 v140, v141
    v_add_f32 v140, v140, v141
    buffer_store_dword v140, v20, s[20:23], s32 offen sc1
    s_branch l_att
q_red:
    s_mul_i32 s32, s89, 3584
    s_add_u32 s32, s32, s79
    s_add_u32 s32, s32, 0xc80000
    buffer_load_dwordx4 v[60:63], v253, s[20:23], s32 offen offset:0 sc1
    buffer_load_dwordx4 v[64:67], v253, s[20:23], s32 offen offset:1024 sc1
    buffer_load_dwordx4 v[68:71], v253, s[20:23], s32 offen offset:2048 sc1
    buffer_load_dwordx4 v[72:75], v253, s[20:23], s32 offen offset:3072 sc1
    s_add_u32 s32, s32, 4096
    buffer_load_dwordx4 v[76:79], v253, s[20:23], s32 offen offset:0 sc1
    buffer_load_dwordx4 v[80:83], v253, s[20:23], s32 offen offset:1024 sc1
    buffer_load_dwordx4 v[84:87], v253, s[20:23], s32 offen offset:2048 sc1
    s_add_u32 s96, s95, 13
    s_and_b32 s96, s96, 15
    s_lshl_b32 s97, s96, 14
    s_add_u32 s97, s97, s84
    s_add_u32 m0, s86, 131072
    s_nop 0
    buffer_load_dwordx4 v253, s[20:23], s97 offen offset:0 sc1 lds
    buffer_load_dwordx4 v253, s[20:23], s97 offen offset:1024 sc1 lds
    buffer_load_dwordx4 v253, s[20:23], s97 offen offset:2048 sc1 lds
    buffer_load_dwordx4 v253, s[20:23], s97 offen offset:3072 sc1 lds
    s_add_u32 s96, s95, 13
    s_and_b32 s96, s96, 15
    s_mul_i32 s96, s96, 393216
    s_add_u32 s96, s96, s85
    s_add_u32 m0, s87, 65536
    s_nop 0
    buffer_load_dwordx4 v8, s[16:19], s96 offen offset:0 lds
    buffer_load_dwordx4 v9, s[16:19], s96 offen offset:1024 lds
    buffer_load_dwordx4 v10, s[16:19], s96 offen offset:2048 lds
    buffer_load_dwordx4 v11, s[16:19], s96 offen offset:3072 lds
    s_add_u32 m0, s87, 69632
    s_nop 0
    buffer_load_dwordx4 v12, s[16:19], s96 offen offset:0 lds
    buffer_load_dwordx4 v13, s[16:19], s96 offen offset:1024 lds
    s_waitcnt vmcnt(17) lgkmcnt(0)
    s_barrier
    s_add_u32 s96, s94, 14
    s_and_b32 s96, s96, 15
    s_lshl_b32 s97, s96, 14
    s_add_u32 s97, s97, s84
    s_add_u32 m0, s86, 114688
    s_nop 0
    buffer_load_dwordx4 v253, s[20:23], s97 offen offset:0 sc1 lds
    buffer_load_dwordx4 v253, s[20:23], s97 offen offset:1024 sc1 lds
    s_mov_b32 s78, s27
    s_waitcnt vmcnt(12)
    s_branch pc_97
    s_nop 0
pl_96:
    s_mul_i32 s32, s89, 3584
    s_add_u32 s32, s32, s79
    s_add_u32 s32, s32, 0xc80000
    buffer_load_dwordx4 v[60:63], v253, s[20:23], s32 offen offset:0 sc1
    buffer_load_dwordx4 v[64:67], v253, s[20:23], s32 offen offset:1024 sc1
    buffer_load_dwordx4 v[68:71], v253, s[20:23], s32 offen offset:2048 sc1
    buffer_load_dwordx4 v[72:75], v253, s[20:23], s32 offen offset:3072 sc1
    s_add_u32 s32, s32, 4096
    buffer_load_dwordx4 v[76:79], v253, s[20:23], s32 offen offset:0 sc1
    buffer_load_dwordx4 v[80:83], v253, s[20:23], s32 offen offset:1024 sc1
    buffer_load_dwordx4 v[84:87], v253, s[20:23], s32 offen offset:2048 sc1
    s_waitcnt vmcnt(0)
pc_97:
    v_max3_u32 v30, v60, v64, v68
    v_max3_u32 v30, v30, v72, v76
    v_max3_u32 v30, v30, v80, v84
    v_cmp_eq_u32 vcc, -1, v30
    s_cbranch_vccz pd_98
    s_sub_u32 s78, s78, 1
    s_cmp_lg_u32 s78, 0
    s_cbranch_scc1 pl_96
    s_mov_b32 s27, 1
pd_98:
    buffer_load_dwordx4 v253, s[20:23], s97 offen offset:2048 sc1 lds
    v_lshlrev_b32 v24, 16, v60
    v_and_b32 v25, 0xffff0000, v60
    v_lshlrev_b32_e64 v26, 16, v61
    v_and_b32 v27, 0xffff0000, v61
    v_lshlrev_b32_e64 v28, 16, v62
    v_and_b32 v29, 0xffff0000, v62
    v_lshlrev_b32_e64 v30, 16, v63
    v_and_b32 v31, 0xffff0000, v63
    v_lshlrev_b32_e64 v88, 16, v64
    v_and_b32 v89, 0xffff0000, v64
    v_lshlrev_b32_e64 v90, 16, v65
    v_and_b32 v91, 0xffff0000, v65
    v_add_f32_e64 v24, v24, v88
    buffer_load_dwordx4 v253, s[20:23], s97 offen offset:3072 sc1 lds
    v_add_f32 v25, v25, v89
    v_add_f32 v26, v26, v90
    v_add_f32 v27, v27, v91
    v_lshlrev_b32 v88, 16, v66
    v_and_b32 v89, 0xffff0000, v66
    v_lshlrev_b32_e64 v90, 16, v67
    v_and_b32 v91, 0xffff0000, v67
    v_add_f32 v28, v28, v88
    v_add_f32 v29, v29, v89
    v_add_f32 v30, v30, v90
    v_add_f32 v31, v31, v91
    v_lshlrev_b32_e64 v88, 16, v68
    v_and_b32 v89, 0xffff0000, v68
    v_lshlrev_b32_e64 v90, 16, v69
    v_and_b32 v91, 0xffff0000, v69
    v_add_f32 v24, v24, v88
    v_add_f32 v25, v25, v89
    v_add_f32 v26, v26, v90
    v_add_f32 v27, v27, v91
    v_lshlrev_b32_e64 v88, 16, v70
    v_and_b32 v89, 0xffff0000, v70
    s_add_u32 s96, s94, 14
    s_and_b32 s96, s96, 15
    s_mul_i32 s96, s96, 393216
    s_add_u32 s96, s96, s85
    s_add_u32 m0, s87, 90112
    s_nop 0
    buffer_load_dwordx4 v8, s[16:19], s96 offen offset:0 lds
    v_lshlrev_b32_e64 v90, 16, v71
    v_and_b32 v91, 0xffff0000, v71
    v_add_f32 v28, v28, v88
    v_add_f32 v29, v29, v89
    v_add_f32 v30, v30, v90
    v_add_f32 v31, v31, v91
    v_lshlrev_b32_e64 v88, 16, v72
    v_and_b32 v89, 0xffff0000, v72
    v_lshlrev_b32_e64 v90, 16, v73
    v_and_b32 v91, 0xffff0000, v73
    v_add_f32 v24, v24, v88
    v_add_f32 v25, v25, v89
    v_add_f32 v26, v26, v90
    v_add_f32 v27, v27, v91
    v_lshlrev_b32_e64 v88, 16, v74
    v_and_b32 v89, 0xffff0000, v74
    v_lshlrev_b32_e64 v90, 16, v75
    v_and_b32 v91, 0xffff0000, v75
    v_add_f32 v28, v28, v88
    v_add_f32 v29, v29, v89
    buffer_load_dwordx4 v9, s[16:19], s96 offen offset:1024 lds
    v_add_f32 v30, v30, v90
    v_add_f32 v31, v31, v91
    v_lshlrev_b32_e64 v88, 16, v76
    v_and_b32 v89, 0xffff0000, v76
    v_lshlrev_b32_e64 v90, 16, v77
    v_and_b32 v91, 0xffff0000, v77
    v_add_f32 v24, v24, v88
    v_add_f32 v25, v25, v89
    v_add_f32 v26, v26, v90
    v_add_f32 v27, v27, v91
    v_lshlrev_b32_e64 v88, 16, v78
    v_and_b32 v89, 0xffff0000, v78
    v_lshlrev_b32_e64 v90, 16, v79
    v_and_b32 v91, 0xffff0000, v79
    v_add_f32 v28, v28, v88
    v_add_f32 v29, v29, v89
    v_add_f32 v30, v30, v90
    v_add_f32 v31, v31, v91
    v_lshlrev_b32_e64 v88, 16, v80
    v_and_b32 v89, 0xffff0000, v80
    v_lshlrev_b32_e64 v90, 16, v81
    buffer_load_dwordx4 v10, s[16:19], s96 offen offset:2048 lds
    v_and_b32 v91, 0xffff0000, v81
    v_add_f32 v24, v24, v88
    v_add_f32 v25, v25, v89
    v_add_f32 v26, v26, v90
    v_add_f32 v27, v27, v91
    v_lshlrev_b32_e64 v88, 16, v82
    v_and_b32 v89, 0xffff0000, v82
    v_lshlrev_b32_e64 v90, 16, v83
    v_and_b32 v91, 0xffff0000, v83
    v_add_f32 v28, v28, v88
    v_add_f32 v29, v29, v89
    v_add_f32 v30, v30, v90
    v_add_f32 v31, v31, v91
    v_lshlrev_b32_e64 v88, 16, v84
    v_and_b32 v89, 0xffff0000, v84
    v_lshlrev_b32_e64 v90, 16, v85
    v_and_b32 v91, 0xffff0000, v85
    v_add_f32 v24, v24, v88
    v_add_f32 v25, v25, v89
    v_add_f32 v26, v26, v90
    v_add_f32 v27, v27, v91
    buffer_load_dwordx4 v11, s[16:19], s96 offen offset:3072 lds
    v_lshlrev_b32_e64 v88, 16, v86
    v_and_b32 v89, 0xffff0000, v86
    v_lshlrev_b32_e64 v90, 16, v87
    v_and_b32 v91, 0xffff0000, v87
    v_add_f32 v28, v28, v88
    v_add_f32 v29, v29, v89
    v_add_f32 v30, v30, v90
    v_add_f32 v31, v31, v91
    v_permlane32_swap_b32 v24, v28
    v_permlane32_swap_b32 v25, v29
    v_permlane32_swap_b32 v26, v30
    v_permlane32_swap_b32 v27, v31
    v_add_f32 v24, v24, v28
    v_add_f32 v25, v25, v29
    v_add_f32 v26, v26, v30
    v_add_f32 v27, v27, v31
    s_nop 0
    v_permlane16_swap_b32 v24, v26
    v_permlane16_swap_b32 v25, v27
    v_add_f32 v24, v24, v26
    v_add_f32_e64 v25, v25, v27
    s_nop 0
    v_add_f32_dpp v24, v24, v24 quad_perm:[2,3,0,1] row_mask:0xf bank_mask:0xf
    s_add_u32 m0, s87, 94208
    s_nop 0
    buffer_load_dwordx4 v12, s[16:19], s96 offen offset:0 lds
    v_add_f32_dpp v25, v25, v25 quad_perm:[2,3,0,1] row_mask:0xf bank_mask:0xf
    v_add_f32_dpp v24, v24, v24 row_ror:4 row_mask:0xf bank_mask:0xf
    s_nop 0
    v_add_f32_dpp v25, v25, v25 row_ror:4 row_mask:0xf bank_mask:0xf
    v_add_f32_dpp v24, v24, v24 row_ror:8 row_mask:0xf bank_mask:0xf
    s_nop 0
    v_add_f32_dpp v25, v25, v25 row_ror:8 row_mask:0xf bank_mask:0xf
    v_fma_f32 v28, v24, v96, v92
    v_fma_f32 v29, v25, v96, v93
    v_cvt_pk_bf16_f32 v24, v28, v29
    v_cvt_pk_bf16_f32 v25, v28, v29
    v_cvt_pk_bf16_f32 v26, v28, v29
    v_cvt_pk_bf16_f32 v27, v28, v29
    v_permlane16_swap_b32 v24, v25
    s_nop 0
    v_permlane16_swap_b32 v26, v27
    s_nop 1
    v_permlane32_swap_b32 v24, v26
    v_permlane32_swap_b32 v25, v27
    s_mov_b32 s32, 0xdc4000
    s_lshl_b32 s33, s89, 4
    v_lshrrev_b32 v89, 1, v252
    v_and_or_b32 v88, v253, 16, s33
    v_lshl_or_b32 v88, v89, 11, v88
    buffer_load_dwordx4 v13, s[16:19], s96 offen offset:1024 lds
    s_mov_b64 exec, 65535
    buffer_store_dwordx4 v[24:27], v88, s[20:23], s32 offen sc1
    s_mov_b64 exec, -1
    s_waitcnt vmcnt(11) lgkmcnt(0)
    s_barrier
    s_add_u32 s96, s95, 15
    s_and_b32 s96, s96, 15
    s_lshl_b32 s97, s96, 14
    s_add_u32 s97, s97, s84
    s_add_u32 m0, s86, 147456
    s_nop 0
    buffer_load_dwordx4 v253, s[20:23], s97 offen offset:0 sc1 lds
    buffer_load_dwordx4 v253, s[20:23], s97 offen offset:1024 sc1 lds
    buffer_load_dwordx4 v253, s[20:23], s97 offen offset:2048 sc1 lds
    buffer_load_dwordx4 v253, s[20:23], s97 offen offset:3072 sc1 lds
    s_add_u32 s96, s95, 15
    s_and_b32 s96, s96, 15
    s_mul_i32 s96, s96, 393216
    s_add_u32 s96, s96, s85
    s_add_u32 m0, s87, 40960
    s_nop 0
    buffer_load_dwordx4 v8, s[16:19], s96 offen offset:0 lds
    buffer_load_dwordx4 v9, s[16:19], s96 offen offset:1024 lds
    buffer_load_dwordx4 v10, s[16:19], s96 offen offset:2048 lds
    buffer_load_dwordx4 v11, s[16:19], s96 offen offset:3072 lds
    s_add_u32 m0, s87, 45056
    s_nop 0
    buffer_load_dwordx4 v12, s[16:19], s96 offen offset:0 lds
    buffer_load_dwordx4 v13, s[16:19], s96 offen offset:1024 lds
    s_waitcnt vmcnt(11) lgkmcnt(0)
    s_barrier
    s_min_u32 s30, s28, 2
    s_lshl_b32 s30, s30, 13
    s_add_u32 s30, s30, 90112
    v_lshrrev_b32 v20, 2, v252
    v_bfe_u32 v21, v20, 1, 2
    v_lshlrev_b32_e64 v20, 7, v20
    v_lshl_add_u32 v20, v21, 5, v20
    v_and_b32_e64 v21, 3, v252
    v_lshl_add_u32 v20, v21, 3, v20
    v_add_u32 v144, s30, v20
    v_xor_b32 v145, 32, v144
    v_xor_b32_e64 v146, 64, v144
    v_xor_b32 v147, 96, v144
    ds_read_b64_tr_b16 v[100:101], v144 offset:0
    ds_read_b64_tr_b16 v[102:103], v144 offset:2048
    ds_read_b64_tr_b16 v[104:105], v144 offset:4096
    ds_read_b64_tr_b16 v[106:107], v144 offset:6144
    ds_read_b64_tr_b16 v[108:109], v145 offset:0
    ds_read_b64_tr_b16 v[110:111], v145 offset:2048
    ds_read_b64_tr_b16 v[112:113], v145 offset:4096
    ds_read_b64_tr_b16 v[114:115], v145 offset:6144
    ds_read_b64_tr_b16 v[116:117], v146 offset:0
    ds_read_b64_tr_b16 v[118:119], v146 offset:2048
    ds_read_b64_tr_b16 v[120:121], v146 offset:4096
    ds_read_b64_tr_b16 v[122:123], v146 offset:6144
    ds_read_b64_tr_b16 v[124:125], v147 offset:0
    ds_read_b64_tr_b16 v[126:127], v147 offset:2048
    ds_read_b64_tr_b16 v[128:129], v147 offset:4096
    ds_read_b64_tr_b16 v[130:131], v147 offset:6144
    s_getpc_b64 s[32:33]
pc_103:
    s_sub_u32 s32, s32, pc_103-interleave_layers__sliding_block__moe_arch_mod__prompt_kernel
    s_subb_u32 s33, s33, 0
    s_lshr_b32 s34, s2, 3
    s_lshl_b32 s34, s34, 2
    s_add_u32 s34, s34, s28
    s_and_b32 s34, s34, 127
    s_lshl_b32 s34, s34, 7
    v_lshl_add_u32 v154, v252, 14, s34
    s_mov_b32 s34, k_exit-interleave_layers__sliding_block__moe_arch_mod__prompt_kernel
    s_mov_b32 s35, 0x20000
    buffer_load_dword v154, v154, s[32:35], 0 offen
    s_branch q_join
    s_nop 0
l_patch:
    s_lshr_b32 vcc_lo, s24, 1
    s_lshl_b32 vcc_lo, vcc_lo, 11
    s_add_u32 s32, vcc_lo, 0xdc4000
    buffer_load_dwordx4 v[72:75], v253, s[20:23], s32 offen offset:0 sc1
    buffer_load_dwordx4 v[76:79], v253, s[20:23], s32 offen offset:1024 sc1
    s_min_u32 s32, s28, 2
    s_lshl_b32 s32, s32, 12
    s_lshl_b32 s33, s25, 14
    s_add_u32 s32, s32, s33
    s_add_u32 s32, s32, 0x1d80000
    buffer_load_dwordx4 v[56:59], v253, s[20:23], s32 offen offset:0 sc1
    buffer_load_dwordx4 v[60:63], v253, s[20:23], s32 offen offset:1024 sc1
    buffer_load_dwordx4 v[64:67], v253, s[20:23], s32 offen offset:2048 sc1
    buffer_load_dwordx4 v[68:71], v253, s[20:23], s32 offen offset:3072 sc1
    s_mov_b32 s78, s27
    s_waitcnt vmcnt(4)
    s_branch pc_109
    s_nop 0
pl_108:
    s_lshr_b32 vcc_lo, s24, 1
    s_lshl_b32 vcc_lo, vcc_lo, 11
    s_add_u32 s32, vcc_lo, 0xdc4000
    buffer_load_dwordx4 v[72:75], v253, s[20:23], s32 offen offset:0 sc1
    buffer_load_dwordx4 v[76:79], v253, s[20:23], s32 offen offset:1024 sc1
    s_waitcnt vmcnt(0)
pc_109:
    v_max3_u32 v82, v72, v73, v74
    v_max3_u32 v82, v82, v75, v76
    v_max3_u32 v82, v82, v77, v78
    v_max_u32 v82, v82, v79
    v_cmp_eq_u32 vcc, -1, v82
    s_cbranch_vccz pd_110
    s_sub_u32 s78, s78, 1
    s_cmp_lg_u32 s78, 0
    s_cbranch_scc1 pl_108
    s_mov_b32 s27, 1
pd_110:
    v_mov_b32 v80, 0
    v_mov_b32 v81, 0
    v_dot2c_f32_bf16 v80, 0x3f803f80, v72
    v_dot2c_f32_bf16 v81, v72, v72
    v_dot2c_f32_bf16 v80, 0x3f803f80, v73
    v_dot2c_f32_bf16 v81, v73, v73
    v_dot2c_f32_bf16 v80, 0x3f803f80, v74
    v_dot2c_f32_bf16 v81, v74, v74
    v_dot2c_f32_bf16 v80, 0x3f803f80, v75
    v_dot2c_f32_bf16 v81, v75, v75
    v_dot2c_f32_bf16 v80, 0x3f803f80, v76
    v_dot2c_f32_bf16 v81, v76, v76
    v_dot2c_f32_bf16 v80, 0x3f803f80, v77
    v_dot2c_f32_bf16 v81, v77, v77
    v_dot2c_f32_bf16 v80, 0x3f803f80, v78
    v_dot2c_f32_bf16 v81, v78, v78
    v_dot2c_f32_bf16 v80, 0x3f803f80, v79
    v_dot2c_f32_bf16 v81, v79, v79
    s_nop 1
    v_add_f32_dpp v80, v80, v80 quad_perm:[1,0,3,2] row_mask:0xf bank_mask:0xf
    v_add_f32_dpp v81, v81, v81 quad_perm:[1,0,3,2] row_mask:0xf bank_mask:0xf
    s_nop 0
    v_add_f32_dpp v80, v80, v80 quad_perm:[2,3,0,1] row_mask:0xf bank_mask:0xf
    v_add_f32_dpp v81, v81, v81 quad_perm:[2,3,0,1] row_mask:0xf bank_mask:0xf
    s_nop 0
    v_add_f32_dpp v80, v80, v80 row_half_mirror row_mask:0xf bank_mask:0xf
    v_add_f32_dpp v81, v81, v81 row_half_mirror row_mask:0xf bank_mask:0xf
    s_nop 0
    v_add_f32_dpp v80, v80, v80 row_mirror row_mask:0xf bank_mask:0xf
    v_add_f32_dpp v81, v81, v81 row_mirror row_mask:0xf bank_mask:0xf
    v_mov_b32 v82, v80
    v_mov_b32 v83, v81
    s_nop 0
    v_permlane16_swap_b32 v80, v82
    v_permlane16_swap_b32 v81, v83
    v_add_f32 v80, v80, v82
    v_add_f32 v81, v81, v83
    v_mov_b32 v82, v80
    v_mov_b32 v83, v81
    s_nop 0
    v_permlane32_swap_b32 v80, v82
    v_permlane32_swap_b32 v81, v83
    v_add_f32 v80, v80, v82
    v_add_f32 v81, v81, v83
    v_mul_f32 v80, 0x3a800000, v80
    v_mul_f32 v81, 0x3a800000, v81
    v_fma_f32 v81, -v80, v80, v81
    v_max_f32_e64 v81, 0, v81
    v_add_f32 v81, 0x3727c5ac, v81
    v_rsq_f32 v81, v81
    s_mov_b32 s78, s27
    s_waitcnt vmcnt(0)
    s_branch pc_112
    s_nop 0
pl_111:
    s_min_u32 s32, s28, 2
    s_lshl_b32 s32, s32, 12
    s_lshl_b32 s33, s25, 14
    s_add_u32 s32, s32, s33
    s_add_u32 s32, s32, 0x1d80000
    buffer_load_dwordx4 v[56:59], v253, s[20:23], s32 offen offset:0 sc1
    buffer_load_dwordx4 v[60:63], v253, s[20:23], s32 offen offset:1024 sc1
    buffer_load_dwordx4 v[64:67], v253, s[20:23], s32 offen offset:2048 sc1
    buffer_load_dwordx4 v[68:71], v253, s[20:23], s32 offen offset:3072 sc1
    s_waitcnt vmcnt(0)
pc_112:
    v_max3_u32 v82, v56, v57, v58
    v_max3_u32 v82, v82, v59, v60
    v_max3_u32 v82, v82, v61, v62
    v_max3_u32 v82, v82, v63, v64
    v_max3_u32 v82, v82, v65, v66
    v_max3_u32 v82, v82, v67, v68
    v_max3_u32 v82, v82, v69, v70
    v_max_u32_e64 v82, v82, v71
    v_cmp_eq_u32 vcc, -1, v82
    s_cbranch_vccz pd_113
    s_sub_u32 s78, s78, 1
    s_cmp_lg_u32 s78, 0
    s_cbranch_scc1 pl_111
    s_mov_b32 s27, 1
pd_113:
l_zok:
    v_pk_add_f32 v[56:57], v[56:57], v[60:61]
    v_pk_add_f32 v[58:59], v[58:59], v[62:63]
    v_pk_add_f32 v[56:57], v[56:57], v[64:65]
    v_pk_add_f32 v[58:59], v[58:59], v[66:67]
    v_pk_add_f32 v[56:57], v[56:57], v[68:69]
    v_pk_add_f32 v[58:59], v[58:59], v[70:71]
    s_nop 1
    v_permlane32_swap_b32 v56, v58
    v_permlane32_swap_b32 v57, v59
    v_add_f32 v56, v56, v58
    v_add_f32 v57, v57, v59
    s_nop 1
    v_permlane16_swap_b32 v56, v57
    v_add_f32 v56, v56, v57
    v_fma_f32 v56, -v80, v2, v56
    v_mul_f32 v81, s37, v81
    v_mul_f32 v56, v56, v81
    v_cvt_pk_bf16_f32 v1, v56, v56
    s_cmp_lg_u32 s100, 2
    s_cbranch_scc1 l_pmid
    s_cmp_lg_u32 s38, 0
    s_barrier
    s_cselect_b64 exec, -1, 0
    ds_write_b16 v0, v1
    s_mov_b64 exec, -1
    s_waitcnt lgkmcnt(0)
    s_barrier
    s_branch l_patched
    s_nop 0
l_tail:
    s_load_dwordx2 s[12:13], s[0:1], 64
    s_mov_b32 s14, 0x400000
    s_mov_b32 s15, 0x20000
    s_waitcnt lgkmcnt(0)
    v_mov_b32_e64 v20, 0
    s_or_b32 s34, s72, s28
    s_cmp_lg_u32 s34, 0
    s_cbranch_scc1 sk_114
    s_mov_b32 s34, 0xdd8000
    v_mov_b32 v154, s88
    s_mov_b64 exec, 1
    s_waitcnt vmcnt(0)
    buffer_store_dword v154, v253, s[20:23], s34 offen sc1
    s_mov_b64 exec, -1
sk_114:
    s_barrier
    ds_read_b128 v[16:19], v20 offset:3072
    s_waitcnt lgkmcnt(0)
    v_readlane_b32 s74, v16, 0
    v_readlane_b32 s73, v17, 0
    v_readlane_b32 s75, v18, 0
    v_readlane_b32 s76, v19, 0
    s_and_b32 s73, s73, 2047
    s_mov_b32 s78, s27
pl_115:
    s_lshr_b32 s33, s73, 5
    s_lshl_b32 s33, s33, 11
    s_add_u32 s33, s33, s79
    s_add_u32 s33, s33, 0xd60000
    buffer_load_dwordx4 v[24:27], v22, s[20:23], s33 offen sc1
    s_waitcnt vmcnt(0)
pc_116:
    v_max3_u32 v30, v24, v25, v26
    v_max_u32 v30, v30, v27
    v_cmp_eq_u32 vcc, -1, v30
    s_cbranch_vccz pd_117
    s_sub_u32 s78, s78, 1
    s_cmp_lg_u32 s78, 0
    s_cbranch_scc1 pl_115
    s_mov_b32 s27, 1
pd_117:
    s_cmp_ge_u32 s29, 224
    s_cbranch_scc1 l_tred
    v_mov_b32 v28, s76
    v_mul_f32 v29, s75, v28
    v_lshlrev_b32 v30, 16, v24
    v_and_b32 v31, 0xffff0000, v24
    v_fma_f32 v30, v30, v28, -v29
    v_fma_f32 v31, v31, v28, -v29
    v_cvt_pk_bf16_f32 v24, v30, v31
    v_lshlrev_b32_e64 v30, 16, v25
    v_and_b32 v31, 0xffff0000, v25
    v_fma_f32 v30, v30, v28, -v29
    v_fma_f32 v31, v31, v28, -v29
    v_cvt_pk_bf16_f32 v25, v30, v31
    v_lshlrev_b32_e64 v30, 16, v26
    v_and_b32 v31, 0xffff0000, v26
    v_fma_f32 v30, v30, v28, -v29
    v_fma_f32 v31, v31, v28, -v29
    v_cvt_pk_bf16_f32 v26, v30, v31
    v_lshlrev_b32 v30, 16, v27
    v_and_b32 v31, 0xffff0000, v27
    v_fma_f32 v30, v30, v28, -v29
    v_fma_f32 v31, v31, v28, -v29
    v_cvt_pk_bf16_f32 v27, v30, v31
    s_bitcmp0_b32 s29, 0
    s_cbranch_scc1 sk_118
    v_swap_b32 v24, v25
    v_swap_b32 v26, v27
sk_118:
    s_bitcmp0_b32 s29, 1
    s_cbranch_scc1 sk_119
    v_swap_b32 v24, v26
    v_swap_b32 v25, v27
sk_119:
    s_cmp_ge_u32 s29, 224
    s_cbranch_scc1 sk_120
    v_dot2_f32_bf16 v32, v155, v24, 0
    v_dot2_f32_bf16 v33, v160, v24, 0
    v_dot2_f32_bf16 v34, v156, v24, 0
    v_dot2_f32_bf16 v35, v161, v24, 0
    v_dot2_f32_bf16 v36, v157, v24, 0
    v_dot2_f32_bf16 v37, v162, v24, 0
    v_dot2_f32_bf16 v38, v158, v24, 0
    v_dot2_f32_bf16 v39, v163, v24, 0
    v_dot2_f32_bf16 v40, v183, v24, 0
    v_dot2_f32_bf16 v41, v192, v24, 0
    v_dot2_f32_bf16 v42, v188, v24, 0
    v_dot2_f32_bf16 v43, v193, v24, 0
    v_dot2_f32_bf16 v44, v189, v24, 0
    v_dot2_f32_bf16 v45, v194, v24, 0
    v_dot2_f32_bf16 v46, v190, v24, 0
    v_dot2_f32_bf16 v47, v195, v24, 0
    v_dot2_f32_bf16 v32, v159, v25, v32
    v_dot2_f32_bf16 v33, v168, v25, v33
    v_dot2_f32_bf16 v34, v164, v25, v34
    v_dot2_f32_bf16 v35, v169, v25, v35
    v_dot2_f32_bf16 v36, v165, v25, v36
    v_dot2_f32_bf16 v37, v170, v25, v37
    v_dot2_f32_bf16 v38, v166, v25, v38
    v_dot2_f32_bf16 v39, v171, v25, v39
    v_dot2_f32_bf16 v40, v191, v25, v40
    v_dot2_f32_bf16 v41, v200, v25, v41
    v_dot2_f32_bf16 v42, v196, v25, v42
    v_dot2_f32_bf16 v43, v201, v25, v43
    v_dot2_f32_bf16 v44, v197, v25, v44
    v_dot2_f32_bf16 v45, v202, v25, v45
    v_dot2_f32_bf16 v46, v198, v25, v46
    v_dot2_f32_bf16 v47, v203, v25, v47
    v_dot2_f32_bf16 v32, v167, v26, v32
    v_dot2_f32_bf16 v33, v176, v26, v33
    v_dot2_f32_bf16 v34, v172, v26, v34
    v_dot2_f32_bf16 v35, v177, v26, v35
    v_dot2_f32_bf16 v36, v173, v26, v36
    v_dot2_f32_bf16 v37, v178, v26, v37
    v_dot2_f32_bf16 v38, v174, v26, v38
    v_dot2_f32_bf16 v39, v179, v26, v39
    v_dot2_f32_bf16 v40, v199, v26, v40
    v_dot2_f32_bf16 v41, v208, v26, v41
    v_dot2_f32_bf16 v42, v204, v26, v42
    v_dot2_f32_bf16 v43, v209, v26, v43
    v_dot2_f32_bf16 v44, v205, v26, v44
    v_dot2_f32_bf16 v45, v210, v26, v45
    v_dot2_f32_bf16 v46, v206, v26, v46
    v_dot2_f32_bf16 v47, v211, v26, v47
    v_dot2_f32_bf16 v32, v175, v27, v32
    v_dot2_f32_bf16 v33, v184, v27, v33
    v_dot2_f32_bf16 v34, v180, v27, v34
    v_dot2_f32_bf16 v35, v185, v27, v35
    v_dot2_f32_bf16 v36, v181, v27, v36
    v_dot2_f32_bf16 v37, v186, v27, v37
    v_dot2_f32_bf16 v38, v182, v27, v38
    v_dot2_f32_bf16 v39, v187, v27, v39
    v_dot2_f32_bf16 v40, v207, v27, v40
    v_dot2_f32_bf16 v41, v216, v27, v41
    v_dot2_f32_bf16 v42, v212, v27, v42
    v_dot2_f32_bf16 v43, v217, v27, v43
    v_dot2_f32_bf16 v44, v213, v27, v44
    v_dot2_f32_bf16 v45, v218, v27, v45
    v_dot2_f32_bf16 v46, v214, v27, v46
    v_dot2_f32_bf16 v47, v219, v27, v47
sk_120:
    v_lshrrev_b32 v31, 5, v252
    v_lshlrev_b32 v30, 6, v31
    v_permlane32_swap_b32 v32, v40
    v_permlane32_swap_b32 v33, v41
    v_permlane32_swap_b32 v34, v42
    v_permlane32_swap_b32 v35, v43
    v_permlane32_swap_b32 v36, v44
    v_permlane32_swap_b32 v37, v45
    v_permlane32_swap_b32 v38, v46
    v_permlane32_swap_b32 v39, v47
    v_add_f32 v32, v32, v40
    v_add_f32 v33, v33, v41
    v_add_f32 v34, v34, v42
    v_add_f32 v35, v35, v43
    v_add_f32 v36, v36, v44
    v_add_f32 v37, v37, v45
    v_add_f32 v38, v38, v46
    v_add_f32 v39, v39, v47
    v_and_b32_e64 v31, 1, v252
    v_lshl_add_u32 v30, v31, 5, v30
    v_permlane16_swap_b32 v32, v36
    v_permlane16_swap_b32 v33, v37
    v_permlane16_swap_b32 v34, v38
    v_permlane16_swap_b32 v35, v39
    v_add_f32 v32, v32, v36
    v_add_f32 v33, v33, v37
    v_add_f32 v34, v34, v38
    v_add_f32 v35, v35, v39
    v_and_b32 v31, 16, v252
    s_lshl_b32 s32, s28, 7
    v_add3_u32 v30, v31, v30, s32
    v_add_f32_dpp v32, v32, v32 quad_perm:[2,3,0,1] row_mask:0xf bank_mask:0xf
    v_add_f32_dpp v33, v33, v33 quad_perm:[2,3,0,1] row_mask:0xf bank_mask:0xf
    v_add_f32_dpp v34, v34, v34 quad_perm:[2,3,0,1] row_mask:0xf bank_mask:0xf
    v_add_f32_dpp v35, v35, v35 quad_perm:[2,3,0,1] row_mask:0xf bank_mask:0xf
    v_add_f32_dpp v32, v32, v32 row_ror:4 row_mask:0xf bank_mask:0xf
    v_add_f32_dpp v33, v33, v33 row_ror:4 row_mask:0xf bank_mask:0xf
    v_add_f32_dpp v34, v34, v34 row_ror:4 row_mask:0xf bank_mask:0xf
    v_add_f32_dpp v35, v35, v35 row_ror:4 row_mask:0xf bank_mask:0xf
    v_add_f32_dpp v32, v32, v32 row_ror:8 row_mask:0xf bank_mask:0xf
    v_add_f32_dpp v33, v33, v33 row_ror:8 row_mask:0xf bank_mask:0xf
    v_add_f32_dpp v34, v34, v34 row_ror:8 row_mask:0xf bank_mask:0xf
    v_add_f32_dpp v35, v35, v35 row_ror:8 row_mask:0xf bank_mask:0xf
    s_mov_b32 exec_lo, 0x00030003
    s_mov_b32 exec_hi, 0x00030003
    ds_write_b128 v30, v[32:35] offset:3328
    s_mov_b64 exec, -1
    s_waitcnt lgkmcnt(0)
    s_barrier
    v_and_b32 v30, 1, v252
    v_bfe_u32 v31, v252, 1, 3
    v_lshl_add_u32 v30, v30, 3, v31
    v_lshlrev_b32_e64 v30, 2, v30
    v_add_u32 v30, 3328, v30
    ds_read2_b32 v[32:33], v30 offset0:0 offset1:16
    ds_read2_b32 v[34:35], v30 offset0:32 offset1:48
    ds_read2_b32 v[36:37], v30 offset0:64 offset1:80
    ds_read2_b32 v[38:39], v30 offset0:96 offset1:112
    v_lshrrev_b32_e64 v30, 2, v252
    v_mul_u32_u24 v30, 7168, v30
    v_and_b32_e64 v31, 2, v252
    v_lshl_add_u32 v30, v31, 3, v30
    s_add_u32 s32, s29, 32
    s_lshr_b32 s32, s32, 8
    v_lshl_add_u32 v30, s32, 31, v30
    s_mul_i32 s32, s28, 114688
    s_mul_i32 s33, s29, 32
    s_add_u32 s32, s32, s33
    s_add_u32 s32, s32, s79
    s_add_u32 s32, s32, 0xc80000
    s_waitcnt lgkmcnt(0)
    v_pk_add_f32 v[32:33], v[32:33], v[34:35]
    v_pk_add_f32 v[36:37], v[36:37], v[38:39]
    v_pk_add_f32 v[32:33], v[32:33], v[36:37]
    v_mul_f32 v34, 0xbfb8aa3b, v32
    v_exp_f32 v34, v34
    v_mul_f32 v32, v32, v33
    v_add_f32_e64 v34, 1.0, v34
    v_rcp_f32 v34, v34
    s_nop 0
    v_mul_f32 v32, v32, v34
    s_nop 1
    v_mov_b32_dpp v33, v32 quad_perm:[2,3,2,3] row_mask:0xf bank_mask:0xf
    v_cvt_pk_bf16_f32 v32, v32, v33
    ds_swizzle_b32 v36, v32 offset:0x1
    ds_swizzle_b32 v37, v32 offset:0x81
    ds_swizzle_b32 v38, v32 offset:0x101
    ds_swizzle_b32 v39, v32 offset:0x181
    s_waitcnt lgkmcnt(0)
    s_cmp_ge_u32 s29, 224
    s_cbranch_scc1 sk_121
    v_dot2_f32_bf16 v40, v215, v36, 0
    v_dot2_f32_bf16 v41, v224, v36, 0
    v_dot2_f32_bf16 v42, v220, v36, 0
    v_dot2_f32_bf16 v43, v225, v36, 0
    v_dot2_f32_bf16 v44, v221, v36, 0
    v_dot2_f32_bf16 v45, v226, v36, 0
    v_dot2_f32_bf16 v46, v222, v36, 0
    v_dot2_f32_bf16 v47, v227, v36, 0
    v_dot2_f32_bf16 v40, v223, v37, v40
    v_dot2_f32_bf16 v41, v232, v37, v41
    v_dot2_f32_bf16 v42, v228, v37, v42
    v_dot2_f32_bf16 v43, v233, v37, v43
    v_dot2_f32_bf16 v44, v229, v37, v44
    v_dot2_f32_bf16 v45, v234, v37, v45
    v_dot2_f32_bf16 v46, v230, v37, v46
    v_dot2_f32_bf16 v47, v235, v37, v47
    v_dot2_f32_bf16 v40, v231, v38, v40
    v_dot2_f32_bf16 v41, v240, v38, v41
    v_dot2_f32_bf16 v42, v236, v38, v42
    v_dot2_f32_bf16 v43, v241, v38, v43
    v_dot2_f32_bf16 v44, v237, v38, v44
    v_dot2_f32_bf16 v45, v242, v38, v45
    v_dot2_f32_bf16 v46, v238, v38, v46
    v_dot2_f32_bf16 v47, v243, v38, v47
    v_dot2_f32_bf16 v40, v239, v39, v40
    v_dot2_f32_bf16 v41, v248, v39, v41
    v_dot2_f32_bf16 v42, v244, v39, v42
    v_dot2_f32_bf16 v43, v249, v39, v43
    v_dot2_f32_bf16 v44, v245, v39, v44
    v_dot2_f32_bf16 v45, v250, v39, v45
    v_dot2_f32_bf16 v46, v246, v39, v46
    v_dot2_f32_bf16 v47, v251, v39, v47
sk_121:
    v_add_f32_dpp v40, v40, v40 quad_perm:[1,0,3,2] row_mask:0xf bank_mask:0xf
    v_add_f32_dpp v41, v41, v41 quad_perm:[1,0,3,2] row_mask:0xf bank_mask:0xf
    v_add_f32_dpp v42, v42, v42 quad_perm:[1,0,3,2] row_mask:0xf bank_mask:0xf
    v_add_f32_dpp v43, v43, v43 quad_perm:[1,0,3,2] row_mask:0xf bank_mask:0xf
    v_add_f32_dpp v44, v44, v44 quad_perm:[1,0,3,2] row_mask:0xf bank_mask:0xf
    v_add_f32_dpp v45, v45, v45 quad_perm:[1,0,3,2] row_mask:0xf bank_mask:0xf
    v_add_f32_dpp v46, v46, v46 quad_perm:[1,0,3,2] row_mask:0xf bank_mask:0xf
    v_add_f32_dpp v47, v47, v47 quad_perm:[1,0,3,2] row_mask:0xf bank_mask:0xf
    s_mov_b32 exec_lo, 0x55555555
    s_mov_b32 exec_hi, 0x55555555
    v_cvt_pk_bf16_f32 v40, v40, v41
    v_cvt_pk_bf16_f32 v41, v42, v43
    v_cvt_pk_bf16_f32 v42, v44, v45
    v_cvt_pk_bf16_f32 v43, v46, v47
    buffer_store_dwordx4 v[40:43], v30, s[20:23], s32 offen sc1
    s_mov_b64 exec, -1
    s_branch k_end
    s_nop 0
l_tred:
    s_cmp_lt_i32 s89, 0
    s_cbranch_scc1 k_end
    v_and_b32 v30, 16, v252
    v_cmp_eq_u32 vcc, 16, v30
    v_mov_b32 v28, s76
    v_mul_f32 v29, s75, v28
    v_add_f32 v28, 1.0, v28
    v_cndmask_b32 v30, v24, v25, vcc
    v_cndmask_b32 v31, v26, v27, vcc
    s_mov_b32 vcc_lo, 0xaaaaaaaa
    s_mov_b32 vcc_hi, 0xaaaaaaaa
    v_mov_b32 v96, 0xbfb8aa3b
    v_mul_f32 v96, s74, v96
    v_exp_f32 v96, v96
    v_cndmask_b32 v30, v30, v31, vcc
    v_lshlrev_b32 v92, 16, v30
    v_and_b32 v93, 0xffff0000, v30
    v_fma_f32 v92, v92, v28, -v29
    v_fma_f32 v93, v93, v28, -v29
    v_add_f32 v96, 1.0, v96
    v_rcp_f32 v96, v96
    s_lshl_b32 s34, s73, 11
    s_lshl_b32 s33, s89, 4
    s_add_u32 s34, s34, s33
    s_mov_b64 exec, 0x3
    s_mov_b32 s78, s27
pl_122:
    s_mul_i32 s32, s89, 3584
    s_add_u32 s32, s32, s79
    s_add_u32 s32, s32, 0xc80000
    buffer_load_dwordx4 v[60:63], v253, s[20:23], s32 offen offset:0 sc1
    s_waitcnt vmcnt(0)
pc_123:
    v_cmp_eq_u32 vcc, -1, v60
    s_cbranch_vccz pd_124
    s_sub_u32 s78, s78, 1
    s_cmp_lg_u32 s78, 0
    s_cbranch_scc1 pl_122
    s_mov_b32 s27, 1
pd_124:
    s_mov_b64 exec, -1
    s_mov_b32 s78, s27
pl_125:
    s_mul_i32 s32, s89, 3584
    s_add_u32 s32, s32, s79
    s_add_u32 s32, s32, 0xc80000
    buffer_load_dwordx4 v[60:63], v253, s[20:23], s32 offen offset:0 sc1
    buffer_load_dwordx4 v[64:67], v253, s[20:23], s32 offen offset:1024 sc1
    buffer_load_dwordx4 v[68:71], v253, s[20:23], s32 offen offset:2048 sc1
    buffer_load_dwordx4 v[72:75], v253, s[20:23], s32 offen offset:3072 sc1
    s_add_u32 s32, s32, 4096
    buffer_load_dwordx4 v[76:79], v253, s[20:23], s32 offen offset:0 sc1
    buffer_load_dwordx4 v[80:83], v253, s[20:23], s32 offen offset:1024 sc1
    buffer_load_dwordx4 v[84:87], v253, s[20:23], s32 offen offset:2048 sc1
    s_waitcnt vmcnt(0)
pc_126:
    v_max3_u32 v30, v60, v64, v68
    v_max3_u32 v30, v30, v72, v76
    v_max3_u32 v30, v30, v80, v84
    v_cmp_eq_u32 vcc, -1, v30
    s_cbranch_vccz pd_127
    s_sub_u32 s78, s78, 1
    s_cmp_lg_u32 s78, 0
    s_cbranch_scc1 pl_125
    s_mov_b32 s27, 1
pd_127:
    v_lshlrev_b32 v24, 16, v60
    v_and_b32 v25, 0xffff0000, v60
    v_lshlrev_b32_e64 v26, 16, v61
    v_and_b32 v27, 0xffff0000, v61
    v_lshlrev_b32_e64 v28, 16, v62
    v_and_b32 v29, 0xffff0000, v62
    v_lshlrev_b32_e64 v30, 16, v63
    v_and_b32 v31, 0xffff0000, v63
    v_lshlrev_b32_e64 v88, 16, v64
    v_and_b32 v89, 0xffff0000, v64
    v_lshlrev_b32_e64 v90, 16, v65
    v_and_b32 v91, 0xffff0000, v65
    v_pk_add_f32 v[24:25], v[24:25], v[88:89]
    v_pk_add_f32 v[26:27], v[26:27], v[90:91]
    v_lshlrev_b32_e64 v88, 16, v66
    v_and_b32 v89, 0xffff0000, v66
    v_lshlrev_b32_e64 v90, 16, v67
    v_and_b32 v91, 0xffff0000, v67
    v_pk_add_f32 v[28:29], v[28:29], v[88:89]
    v_pk_add_f32 v[30:31], v[30:31], v[90:91]
    v_lshlrev_b32_e64 v88, 16, v68
    v_and_b32 v89, 0xffff0000, v68
    v_lshlrev_b32_e64 v90, 16, v69
    v_and_b32 v91, 0xffff0000, v69
    v_pk_add_f32 v[24:25], v[24:25], v[88:89]
    v_pk_add_f32 v[26:27], v[26:27], v[90:91]
    v_lshlrev_b32_e64 v88, 16, v70
    v_and_b32 v89, 0xffff0000, v70
    v_lshlrev_b32_e64 v90, 16, v71
    v_and_b32 v91, 0xffff0000, v71
    v_pk_add_f32 v[28:29], v[28:29], v[88:89]
    v_pk_add_f32 v[30:31], v[30:31], v[90:91]
    v_lshlrev_b32_e64 v88, 16, v72
    v_and_b32 v89, 0xffff0000, v72
    v_lshlrev_b32_e64 v90, 16, v73
    v_and_b32 v91, 0xffff0000, v73
    v_pk_add_f32 v[24:25], v[24:25], v[88:89]
    v_pk_add_f32 v[26:27], v[26:27], v[90:91]
    v_lshlrev_b32_e64 v88, 16, v74
    v_and_b32 v89, 0xffff0000, v74
    v_lshlrev_b32_e64 v90, 16, v75
    v_and_b32 v91, 0xffff0000, v75
    v_pk_add_f32 v[28:29], v[28:29], v[88:89]
    v_pk_add_f32 v[30:31], v[30:31], v[90:91]
    v_lshlrev_b32_e64 v88, 16, v76
    v_and_b32 v89, 0xffff0000, v76
    v_lshlrev_b32_e64 v90, 16, v77
    v_and_b32 v91, 0xffff0000, v77
    v_pk_add_f32 v[24:25], v[24:25], v[88:89]
    v_pk_add_f32 v[26:27], v[26:27], v[90:91]
    v_lshlrev_b32_e64 v88, 16, v78
    v_and_b32 v89, 0xffff0000, v78
    v_lshlrev_b32_e64 v90, 16, v79
    v_and_b32 v91, 0xffff0000, v79
    v_pk_add_f32 v[28:29], v[28:29], v[88:89]
    v_pk_add_f32 v[30:31], v[30:31], v[90:91]
    v_lshlrev_b32_e64 v88, 16, v80
    v_and_b32 v89, 0xffff0000, v80
    v_lshlrev_b32_e64 v90, 16, v81
    v_and_b32 v91, 0xffff0000, v81
    v_pk_add_f32 v[24:25], v[24:25], v[88:89]
    v_pk_add_f32 v[26:27], v[26:27], v[90:91]
    v_lshlrev_b32_e64 v88, 16, v82
    v_and_b32 v89, 0xffff0000, v82
    v_lshlrev_b32_e64 v90, 16, v83
    v_and_b32 v91, 0xffff0000, v83
    v_pk_add_f32 v[28:29], v[28:29], v[88:89]
    v_pk_add_f32 v[30:31], v[30:31], v[90:91]
    v_lshlrev_b32_e64 v88, 16, v84
    v_and_b32 v89, 0xffff0000, v84
    v_lshlrev_b32_e64 v90, 16, v85
    v_and_b32 v91, 0xffff0000, v85
    v_pk_add_f32 v[24:25], v[24:25], v[88:89]
    v_pk_add_f32 v[26:27], v[26:27], v[90:91]
    v_lshlrev_b32_e64 v88, 16, v86
    v_and_b32 v89, 0xffff0000, v86
    v_lshlrev_b32_e64 v90, 16, v87
    v_and_b32 v91, 0xffff0000, v87
    v_pk_add_f32 v[28:29], v[28:29], v[88:89]
    v_pk_add_f32 v[30:31], v[30:31], v[90:91]
    s_nop 0
    v_permlane32_swap_b32 v24, v28
    v_permlane32_swap_b32 v25, v29
    v_permlane32_swap_b32 v26, v30
    v_permlane32_swap_b32 v27, v31
    v_add_f32 v24, v24, v28
    v_add_f32 v25, v25, v29
    v_add_f32 v26, v26, v30
    v_add_f32 v27, v27, v31
    s_nop 0
    v_permlane16_swap_b32 v24, v26
    v_permlane16_swap_b32 v25, v27
    v_add_f32_e64 v24, v24, v26
    v_add_f32 v25, v25, v27
    s_nop 0
    v_add_f32_dpp v24, v24, v24 quad_perm:[2,3,0,1] row_mask:0xf bank_mask:0xf
    v_add_f32_dpp v25, v25, v25 quad_perm:[2,3,0,1] row_mask:0xf bank_mask:0xf
    s_nop 0
    v_add_f32_dpp v24, v24, v24 row_ror:4 row_mask:0xf bank_mask:0xf
    v_add_f32_dpp v25, v25, v25 row_ror:4 row_mask:0xf bank_mask:0xf
    s_nop 0
    v_add_f32_dpp v24, v24, v24 row_ror:8 row_mask:0xf bank_mask:0xf
    v_add_f32_dpp v25, v25, v25 row_ror:8 row_mask:0xf bank_mask:0xf
    v_fma_f32 v28, v24, v96, v92
    v_fma_f32 v29, v25, v96, v93
    v_cvt_pk_bf16_f32 v24, v28, v29
    v_cvt_pk_bf16_f32 v25, v28, v29
    v_cvt_pk_bf16_f32 v26, v28, v29
    v_cvt_pk_bf16_f32 v27, v28, v29
    v_permlane16_swap_b32 v24, v25
    s_nop 0
    v_permlane16_swap_b32 v26, v27
    s_nop 1
    v_permlane32_swap_b32_e64 v24, v26
    v_permlane32_swap_b32 v25, v27
    s_mov_b64 exec, 3
    buffer_store_dwordx4 v[24:27], v253, s[12:15], s34 offen
    s_mov_b64 exec, -1
k_end:
k_exit:
    s_endpgm
    s_nop 0
att_exact0:
    s_waitcnt lgkmcnt(0)
    v_mov_b32 v20, 0xffff
    v_mov_b32 v21, 0xffff0000
    v_cndmask_b32 v22, 0, v20, s[40:41]
    v_cndmask_b32 v23, 0, v21, s[42:43]
    v_or_b32_e64 v12, v22, v23
    v_cndmask_b32 v22, 0, v20, s[44:45]
    v_cndmask_b32 v23, 0, v21, s[46:47]
    v_or_b32_e64 v13, v22, v23
    v_cndmask_b32 v22, 0, v20, s[48:49]
    v_cndmask_b32 v23, 0, v21, s[50:51]
    v_or_b32_e64 v14, v22, v23
    v_cndmask_b32 v22, 0, v20, s[52:53]
    v_cndmask_b32 v23, 0, v21, s[54:55]
    v_or_b32_e64 v15, v22, v23
    v_cndmask_b32 v22, 0, v20, s[56:57]
    v_cndmask_b32 v23, 0, v21, s[58:59]
    v_or_b32_e64 v16, v22, v23
    v_cndmask_b32 v22, 0, v20, s[60:61]
    v_cndmask_b32 v23, 0, v21, s[62:63]
    v_or_b32_e64 v17, v22, v23
    v_cndmask_b32 v22, 0, v20, s[64:65]
    v_cndmask_b32 v23, 0, v21, s[66:67]
    v_or_b32_e64 v18, v22, v23
    v_cndmask_b32 v22, 0, v20, s[68:69]
    v_cndmask_b32 v23, 0, v21, s[70:71]
    v_or_b32_e64 v19, v22, v23
    s_and_b32 s34, s76, 3
    s_lshl_b32 s33, s34, 12
    s_add_u32 s33, s33, 65536
    v_add_u32 v20, s33, v253
    v_mov_b32 v24, 0
    v_mov_b32 v25, 0
    v_mov_b32 v26, 0
    v_mov_b32 v27, 0
    v_mov_b32 v28, 0
    v_mov_b32 v29, 0
    v_mov_b32 v30, 0
    v_mov_b32 v31, 0
    v_mov_b32 v32, 0
    v_mov_b32 v33, 0
    v_mov_b32 v34, 0
    v_mov_b32 v35, 0
    v_mov_b32 v36, 0
    v_mov_b32 v37, 0
    v_mov_b32 v38, 0
    v_mov_b32 v39, 0
    ds_read_b128 v[104:107], v20 offset:32768
    ds_read_b128 v[108:111], v20 offset:33792
    ds_read_b128 v[112:115], v20 offset:28672
    ds_read_b128 v[116:119], v20 offset:29696
    s_waitcnt lgkmcnt(2)
    v_mfma_f32_32x32x16_bf16 v[40:55], v[104:107], v[4:7], 0
    v_mfma_f32_32x32x16_bf16 v[40:55], v[108:111], v[8:11], v[40:55]
    ds_read_b128 v[104:107], v20 offset:24576
    ds_read_b128 v[108:111], v20 offset:25600
    s_cmp_eq_u32 s76, 0
    s_cbranch_scc0 ng_128
    v_mov_b32 v24, 0xf149f2ca
    v_mov_b32 v25, 0xf149f2ca
    v_mov_b32 v26, 0xf149f2ca
    v_mov_b32 v27, 0xf149f2ca
    v_mov_b32 v28, 0xf149f2ca
    v_mov_b32 v29, 0xf149f2ca
    v_mov_b32 v30, 0xf149f2ca
    v_mov_b32 v31, 0xf149f2ca
    v_mov_b32 v32, 0xf149f2ca
    v_mov_b32 v33, 0xf149f2ca
    v_mov_b32 v34, 0xf149f2ca
    v_mov_b32 v35, 0xf149f2ca
    v_mov_b32 v36, 0xf149f2ca
    v_mov_b32 v37, 0xf149f2ca
    v_mov_b32 v38, 0xf149f2ca
    v_mov_b32 v39, 0xf149f2ca
ng_128:
    s_waitcnt lgkmcnt(2)
    s_nop 0
    v_mfma_f32_32x32x16_bf16 v[72:87], v[112:115], v[4:7], v[24:39]
    v_mfma_f32_32x32x16_bf16 v[72:87], v[116:119], v[8:11], v[72:87]
    ds_read_b128 v[112:115], v20 offset:20480
    ds_read_b128 v[116:119], v20 offset:21504
    s_cmp_eq_u32 s76, 1
    s_cbranch_scc0 ng_129
    s_nop 1
    v_mov_b32 v24, 0xf149f2ca
    v_mov_b32 v25, 0xf149f2ca
    v_mov_b32 v26, 0xf149f2ca
    v_mov_b32 v27, 0xf149f2ca
    v_mov_b32 v28, 0xf149f2ca
    v_mov_b32 v29, 0xf149f2ca
    v_mov_b32 v30, 0xf149f2ca
    v_mov_b32 v31, 0xf149f2ca
    v_mov_b32 v32, 0xf149f2ca
    v_mov_b32 v33, 0xf149f2ca
    v_mov_b32 v34, 0xf149f2ca
    v_mov_b32 v35, 0xf149f2ca
    v_mov_b32 v36, 0xf149f2ca
    v_mov_b32 v37, 0xf149f2ca
    v_mov_b32 v38, 0xf149f2ca
    v_mov_b32 v39, 0xf149f2ca
ng_129:
    s_waitcnt lgkmcnt(2)
    s_nop 0
    v_mfma_f32_32x32x16_bf16 v[56:71], v[104:107], v[4:7], v[24:39]
    v_mfma_f32_32x32x16_bf16 v[56:71], v[108:111], v[8:11], v[56:71]
    s_nop 3
    v_max_f32_e64 v21, v72, v73
    v_max3_f32 v21, v21, v74, v75
    v_max3_f32 v21, v21, v76, v77
    v_max3_f32 v21, v21, v78, v79
    v_max3_f32 v21, v21, v80, v81
    v_max3_f32 v21, v21, v82, v83
    v_max3_f32 v21, v21, v84, v85
    v_max3_f32 v21, v21, v86, v87
    ds_read_b128 v[104:107], v20 offset:16384
    ds_read_b128 v[108:111], v20 offset:17408
    s_cmp_eq_u32 s76, 2
    s_cbranch_scc0 ng_130
    v_mov_b32 v24, 0xf149f2ca
    v_mov_b32 v25, 0xf149f2ca
    v_mov_b32 v26, 0xf149f2ca
    v_mov_b32 v27, 0xf149f2ca
    v_mov_b32 v28, 0xf149f2ca
    v_mov_b32 v29, 0xf149f2ca
    v_mov_b32 v30, 0xf149f2ca
    v_mov_b32 v31, 0xf149f2ca
    v_mov_b32 v32, 0xf149f2ca
    v_mov_b32 v33, 0xf149f2ca
    v_mov_b32 v34, 0xf149f2ca
    v_mov_b32 v35, 0xf149f2ca
    v_mov_b32 v36, 0xf149f2ca
    v_mov_b32 v37, 0xf149f2ca
    v_mov_b32 v38, 0xf149f2ca
    v_mov_b32 v39, 0xf149f2ca
ng_130:
    s_waitcnt lgkmcnt(2)
    s_nop 0
    v_mfma_f32_32x32x16_bf16 v[72:87], v[112:115], v[4:7], v[24:39]
    v_mfma_f32_32x32x16_bf16 v[72:87], v[116:119], v[8:11], v[72:87]
    v_max3_f32 v21, v21, v56, v57
    v_max3_f32 v21, v21, v58, v59
    v_max3_f32 v21, v21, v60, v61
    v_max3_f32 v21, v21, v62, v63
    v_max3_f32 v21, v21, v64, v65
    v_max3_f32 v21, v21, v66, v67
    v_max3_f32 v21, v21, v68, v69
    v_max3_f32 v21, v21, v70, v71
    ds_read_b128 v[112:115], v20 offset:12288
    ds_read_b128 v[116:119], v20 offset:13312
    s_cmp_eq_u32 s76, 3
    s_cbranch_scc0 ng_131
    v_mov_b32 v24, 0xf149f2ca
    v_mov_b32 v25, 0xf149f2ca
    v_mov_b32 v26, 0xf149f2ca
    v_mov_b32 v27, 0xf149f2ca
    v_mov_b32 v28, 0xf149f2ca
    v_mov_b32 v29, 0xf149f2ca
    v_mov_b32 v30, 0xf149f2ca
    v_mov_b32 v31, 0xf149f2ca
    v_mov_b32 v32, 0xf149f2ca
    v_mov_b32 v33, 0xf149f2ca
    v_mov_b32 v34, 0xf149f2ca
    v_mov_b32 v35, 0xf149f2ca
    v_mov_b32 v36, 0xf149f2ca
    v_mov_b32 v37, 0xf149f2ca
    v_mov_b32 v38, 0xf149f2ca
    v_mov_b32 v39, 0xf149f2ca
ng_131:
    s_waitcnt lgkmcnt(2)
    s_nop 0
    v_mfma_f32_32x32x16_bf16 v[56:71], v[104:107], v[4:7], v[24:39]
    v_mfma_f32_32x32x16_bf16 v[56:71], v[108:111], v[8:11], v[56:71]
    v_max3_f32 v21, v21, v72, v73
    v_max3_f32 v21, v21, v74, v75
    v_max3_f32 v21, v21, v76, v77
    v_max3_f32 v21, v21, v78, v79
    v_max3_f32 v21, v21, v80, v81
    v_max3_f32 v21, v21, v82, v83
    v_max3_f32 v21, v21, v84, v85
    v_max3_f32 v21, v21, v86, v87
    ds_read_b128 v[104:107], v20 offset:8192
    ds_read_b128 v[108:111], v20 offset:9216
    s_cmp_eq_u32 s76, 4
    s_cbranch_scc0 ng_132
    v_mov_b32 v24, 0xf149f2ca
    v_mov_b32 v25, 0xf149f2ca
    v_mov_b32 v26, 0xf149f2ca
    v_mov_b32 v27, 0xf149f2ca
    v_mov_b32 v28, 0xf149f2ca
    v_mov_b32 v29, 0xf149f2ca
    v_mov_b32 v30, 0xf149f2ca
    v_mov_b32 v31, 0xf149f2ca
    v_mov_b32 v32, 0xf149f2ca
    v_mov_b32 v33, 0xf149f2ca
    v_mov_b32 v34, 0xf149f2ca
    v_mov_b32 v35, 0xf149f2ca
    v_mov_b32 v36, 0xf149f2ca
    v_mov_b32 v37, 0xf149f2ca
    v_mov_b32 v38, 0xf149f2ca
    v_mov_b32 v39, 0xf149f2ca
ng_132:
    s_waitcnt lgkmcnt(2)
    s_nop 0
    v_mfma_f32_32x32x16_bf16 v[72:87], v[112:115], v[4:7], v[24:39]
    v_mfma_f32_32x32x16_bf16 v[72:87], v[116:119], v[8:11], v[72:87]
    v_max3_f32 v21, v21, v56, v57
    v_max3_f32 v21, v21, v58, v59
    v_max3_f32 v21, v21, v60, v61
    v_max3_f32 v21, v21, v62, v63
    v_max3_f32 v21, v21, v64, v65
    v_max3_f32 v21, v21, v66, v67
    v_max3_f32 v21, v21, v68, v69
    v_max3_f32 v21, v21, v70, v71
    ds_read_b128 v[112:115], v20 offset:4096
    ds_read_b128 v[116:119], v20 offset:5120
    s_cmp_eq_u32 s76, 5
    s_cbranch_scc0 ng_133
    v_mov_b32 v24, 0xf149f2ca
    v_mov_b32 v25, 0xf149f2ca
    v_mov_b32 v26, 0xf149f2ca
    v_mov_b32 v27, 0xf149f2ca
    v_mov_b32 v28, 0xf149f2ca
    v_mov_b32 v29, 0xf149f2ca
    v_mov_b32 v30, 0xf149f2ca
    v_mov_b32 v31, 0xf149f2ca
    v_mov_b32 v32, 0xf149f2ca
    v_mov_b32 v33, 0xf149f2ca
    v_mov_b32 v34, 0xf149f2ca
    v_mov_b32 v35, 0xf149f2ca
    v_mov_b32 v36, 0xf149f2ca
    v_mov_b32 v37, 0xf149f2ca
    v_mov_b32 v38, 0xf149f2ca
    v_mov_b32 v39, 0xf149f2ca
ng_133:
    s_waitcnt lgkmcnt(2)
    s_nop 0
    v_mfma_f32_32x32x16_bf16 v[56:71], v[104:107], v[4:7], v[24:39]
    v_mfma_f32_32x32x16_bf16 v[56:71], v[108:111], v[8:11], v[56:71]
    v_max3_f32 v21, v21, v72, v73
    v_max3_f32 v21, v21, v74, v75
    v_max3_f32 v21, v21, v76, v77
    v_max3_f32 v21, v21, v78, v79
    v_max3_f32 v21, v21, v80, v81
    v_max3_f32 v21, v21, v82, v83
    v_max3_f32 v21, v21, v84, v85
    v_max3_f32 v21, v21, v86, v87
    ds_read_b128 v[104:107], v20 offset:0
    ds_read_b128 v[108:111], v20 offset:1024
    s_cmp_eq_u32 s76, 6
    s_cbranch_scc0 ng_134
    v_mov_b32 v24, 0xf149f2ca
    v_mov_b32 v25, 0xf149f2ca
    v_mov_b32 v26, 0xf149f2ca
    v_mov_b32 v27, 0xf149f2ca
    v_mov_b32 v28, 0xf149f2ca
    v_mov_b32 v29, 0xf149f2ca
    v_mov_b32 v30, 0xf149f2ca
    v_mov_b32 v31, 0xf149f2ca
    v_mov_b32 v32, 0xf149f2ca
    v_mov_b32 v33, 0xf149f2ca
    v_mov_b32 v34, 0xf149f2ca
    v_mov_b32 v35, 0xf149f2ca
    v_mov_b32 v36, 0xf149f2ca
    v_mov_b32 v37, 0xf149f2ca
    v_mov_b32 v38, 0xf149f2ca
    v_mov_b32 v39, 0xf149f2ca
ng_134:
    s_waitcnt lgkmcnt(2)
    s_nop 0
    v_mfma_f32_32x32x16_bf16 v[72:87], v[112:115], v[4:7], v[24:39]
    v_mfma_f32_32x32x16_bf16 v[72:87], v[116:119], v[8:11], v[72:87]
    v_max3_f32 v21, v21, v56, v57
    v_max3_f32 v21, v21, v58, v59
    v_max3_f32 v21, v21, v60, v61
    v_max3_f32 v21, v21, v62, v63
    v_max3_f32 v21, v21, v64, v65
    v_max3_f32 v21, v21, v66, v67
    v_max3_f32 v21, v21, v68, v69
    v_max3_f32 v21, v21, v70, v71
    s_cmp_eq_u32 s76, 7
    s_cbranch_scc0 ng_135
    v_mov_b32 v24, 0xf149f2ca
    v_mov_b32 v25, 0xf149f2ca
    v_mov_b32 v26, 0xf149f2ca
    v_mov_b32 v27, 0xf149f2ca
    v_mov_b32 v28, 0xf149f2ca
    v_mov_b32 v29, 0xf149f2ca
    v_mov_b32 v30, 0xf149f2ca
    v_mov_b32 v31, 0xf149f2ca
    v_mov_b32 v32, 0xf149f2ca
    v_mov_b32 v33, 0xf149f2ca
    v_mov_b32 v34, 0xf149f2ca
    v_mov_b32 v35, 0xf149f2ca
    v_mov_b32 v36, 0xf149f2ca
    v_mov_b32 v37, 0xf149f2ca
    v_mov_b32 v38, 0xf149f2ca
    v_mov_b32 v39, 0xf149f2ca
ng_135:
    s_waitcnt lgkmcnt(0)
    s_nop 0
    v_mfma_f32_32x32x16_bf16 v[56:71], v[104:107], v[4:7], v[24:39]
    v_mfma_f32_32x32x16_bf16 v[56:71], v[108:111], v[8:11], v[56:71]
    v_max3_f32 v21, v21, v72, v73
    v_max3_f32 v21, v21, v74, v75
    v_max3_f32 v21, v21, v76, v77
    v_max3_f32 v21, v21, v78, v79
    v_max3_f32 v21, v21, v80, v81
    v_max3_f32 v21, v21, v82, v83
    v_max3_f32 v21, v21, v84, v85
    v_max3_f32 v21, v21, v86, v87
    ds_read_b128 v[112:115], v20 offset:28672
    ds_read_b128 v[116:119], v20 offset:29696
    ds_read_b128 v[120:123], v20 offset:34816
    ds_read_b128 v[124:127], v20 offset:35840
    ds_read_b128 v[128:131], v20 offset:2048
    ds_read_b128 v[132:135], v20 offset:3072
    v_cndmask_b32 v40, v56, v40, s[40:41]
    v_cndmask_b32 v41, v57, v41, s[42:43]
    v_cndmask_b32 v42, v58, v42, s[44:45]
    v_cndmask_b32 v43, v59, v43, s[46:47]
    v_cndmask_b32 v44, v60, v44, s[48:49]
    v_cndmask_b32 v45, v61, v45, s[50:51]
    v_cndmask_b32 v46, v62, v46, s[52:53]
    v_cndmask_b32 v47, v63, v47, s[54:55]
    v_cndmask_b32 v48, v64, v48, s[56:57]
    v_cndmask_b32 v49, v65, v49, s[58:59]
    v_cndmask_b32 v50, v66, v50, s[60:61]
    v_cndmask_b32 v51, v67, v51, s[62:63]
    v_cndmask_b32 v52, v68, v52, s[64:65]
    v_cndmask_b32 v53, v69, v53, s[66:67]
    v_cndmask_b32 v54, v70, v54, s[68:69]
    v_cndmask_b32 v55, v71, v55, s[70:71]
    v_max3_f32 v21, v21, v40, v41
    v_max3_f32 v21, v21, v42, v43
    v_max3_f32 v21, v21, v44, v45
    v_max3_f32 v21, v21, v46, v47
    v_max3_f32 v21, v21, v48, v49
    v_max3_f32 v21, v21, v50, v51
    v_max3_f32 v21, v21, v52, v53
    v_max3_f32 v21, v21, v54, v55
    v_mov_b32 v152, v21
    s_nop 1
    v_permlane32_swap_b32 v21, v152
    v_max_f32 v21, v21, v152
    v_sub_f32 v24, 0, v21
    v_sub_f32 v25, 0, v21
    v_sub_f32 v26, 0, v21
    v_sub_f32 v27, 0, v21
    v_sub_f32 v28, 0, v21
    v_sub_f32 v29, 0, v21
    v_sub_f32 v30, 0, v21
    v_sub_f32 v31, 0, v21
    v_sub_f32 v32, 0, v21
    v_sub_f32 v33, 0, v21
    v_sub_f32 v34, 0, v21
    v_sub_f32 v35, 0, v21
    v_sub_f32 v36, 0, v21
    v_sub_f32 v37, 0, v21
    v_sub_f32 v38, 0, v21
    v_sub_f32 v39, 0, v21
    s_cmp_eq_u32 s76, 0
    s_cbranch_scc0 ng_136
    v_mov_b32 v24, 0xf149f2ca
    v_mov_b32 v25, 0xf149f2ca
    v_mov_b32 v26, 0xf149f2ca
    v_mov_b32 v27, 0xf149f2ca
    v_mov_b32 v28, 0xf149f2ca
    v_mov_b32 v29, 0xf149f2ca
    v_mov_b32 v30, 0xf149f2ca
    v_mov_b32 v31, 0xf149f2ca
    v_mov_b32 v32, 0xf149f2ca
    v_mov_b32 v33, 0xf149f2ca
    v_mov_b32 v34, 0xf149f2ca
    v_mov_b32 v35, 0xf149f2ca
    v_mov_b32 v36, 0xf149f2ca
    v_mov_b32 v37, 0xf149f2ca
    v_mov_b32 v38, 0xf149f2ca
    v_mov_b32 v39, 0xf149f2ca
ng_136:
    s_waitcnt lgkmcnt(4)
    s_nop 0
    v_mfma_f32_32x32x16_bf16 v[72:87], v[112:115], v[4:7], v[24:39]
    v_mfma_f32_32x32x16_bf16 v[72:87], v[116:119], v[8:11], v[72:87]
    ds_read_b128 v[104:107], v20 offset:24576
    ds_read_b128 v[108:111], v20 offset:25600
    v_sub_f32 v40, v40, v21
    v_sub_f32 v41, v41, v21
    v_sub_f32 v42, v42, v21
    v_sub_f32 v43, v43, v21
    v_sub_f32 v44, v44, v21
    v_sub_f32 v45, v45, v21
    v_sub_f32 v46, v46, v21
    v_sub_f32 v47, v47, v21
    v_sub_f32 v48, v48, v21
    v_sub_f32 v49, v49, v21
    v_sub_f32 v50, v50, v21
    v_sub_f32 v51, v51, v21
    v_sub_f32 v52, v52, v21
    v_sub_f32 v53, v53, v21
    v_sub_f32 v54, v54, v21
    v_sub_f32 v55, v55, v21
    v_exp_f32 v40, v40
    v_exp_f32 v41, v41
    v_exp_f32 v42, v42
    v_exp_f32 v43, v43
    v_exp_f32 v44, v44
    v_exp_f32 v45, v45
    v_exp_f32 v46, v46
    v_exp_f32 v47, v47
    v_exp_f32 v48, v48
    v_exp_f32 v49, v49
    v_exp_f32 v50, v50
    v_exp_f32 v51, v51
    v_exp_f32 v52, v52
    v_exp_f32 v53, v53
    v_exp_f32 v54, v54
    v_exp_f32 v55, v55
    v_add_f32 v22, v40, v41
    v_add_f32 v23, v42, v43
    v_add_f32 v22, v22, v44
    v_add_f32 v23, v23, v45
    v_add_f32 v22, v22, v46
    v_add_f32 v23, v23, v47
    v_add_f32 v22, v22, v48
    v_add_f32 v23, v23, v49
    v_add_f32 v22, v22, v50
    v_add_f32 v23, v23, v51
    v_add_f32 v22, v22, v52
    v_add_f32 v23, v23, v53
    v_add_f32 v22, v22, v54
    v_add_f32 v23, v23, v55
    v_cvt_pk_bf16_f32 v144, v40, v41
    v_cvt_pk_bf16_f32 v145, v42, v43
    v_cvt_pk_bf16_f32 v146, v44, v45
    v_cvt_pk_bf16_f32 v147, v46, v47
    v_cvt_pk_bf16_f32 v148, v48, v49
    v_cvt_pk_bf16_f32 v149, v50, v51
    v_cvt_pk_bf16_f32 v150, v52, v53
    v_cvt_pk_bf16_f32 v151, v54, v55
    v_and_b32 v136, v144, v12
    v_and_b32 v137, v145, v13
    v_and_b32 v138, v146, v14
    v_and_b32 v139, v147, v15
    v_and_b32 v140, v148, v16
    v_and_b32 v141, v149, v17
    v_and_b32 v142, v150, v18
    v_and_b32 v143, v151, v19
    v_xor_b32 v144, v144, v136
    v_xor_b32 v145, v145, v137
    v_xor_b32 v146, v146, v138
    v_xor_b32 v147, v147, v139
    v_xor_b32 v148, v148, v140
    v_xor_b32 v149, v149, v141
    v_xor_b32_e64 v150, v150, v142
    v_xor_b32 v151, v151, v143
    s_waitcnt lgkmcnt(2)
    v_mfma_f32_32x32x16_bf16 v[88:103], v[120:123], v[136:139], 0
    v_mfma_f32_32x32x16_bf16 v[88:103], v[124:127], v[140:143], v[88:103]
    v_mfma_f32_32x32x16_bf16 v[88:103], v[128:131], v[144:147], v[88:103]
    v_mfma_f32_32x32x16_bf16 v[88:103], v[132:135], v[148:151], v[88:103]
    ds_read_b128 v[128:131], v20 offset:30720
    ds_read_b128 v[132:135], v20 offset:31744
    s_cmp_eq_u32 s76, 1
    s_cbranch_scc0 ng_137
    v_mov_b32 v24, 0xf149f2ca
    v_mov_b32 v25, 0xf149f2ca
    v_mov_b32 v26, 0xf149f2ca
    v_mov_b32 v27, 0xf149f2ca
    v_mov_b32 v28, 0xf149f2ca
    v_mov_b32 v29, 0xf149f2ca
    v_mov_b32 v30, 0xf149f2ca
    v_mov_b32 v31, 0xf149f2ca
    v_mov_b32 v32, 0xf149f2ca
    v_mov_b32 v33, 0xf149f2ca
    v_mov_b32 v34, 0xf149f2ca
    v_mov_b32 v35, 0xf149f2ca
    v_mov_b32 v36, 0xf149f2ca
    v_mov_b32 v37, 0xf149f2ca
    v_mov_b32 v38, 0xf149f2ca
    v_mov_b32 v39, 0xf149f2ca
ng_137:
    s_waitcnt lgkmcnt(2)
    s_nop 0
    v_mfma_f32_32x32x16_bf16 v[56:71], v[104:107], v[4:7], v[24:39]
    v_mfma_f32_32x32x16_bf16 v[56:71], v[108:111], v[8:11], v[56:71]
    ds_read_b128 v[112:115], v20 offset:20480
    ds_read_b128 v[116:119], v20 offset:21504
    v_exp_f32 v72, v72
    v_exp_f32 v73, v73
    v_exp_f32 v74, v74
    v_exp_f32 v75, v75
    v_exp_f32 v76, v76
    v_exp_f32 v77, v77
    v_exp_f32 v78, v78
    v_exp_f32 v79, v79
    v_exp_f32 v80, v80
    v_exp_f32 v81, v81
    v_exp_f32 v82, v82
    v_exp_f32 v83, v83
    v_exp_f32 v84, v84
    v_exp_f32 v85, v85
    v_exp_f32 v86, v86
    v_exp_f32 v87, v87
    v_add_f32 v22, v22, v72
    v_add_f32 v23, v23, v73
    v_add_f32 v22, v22, v74
    v_add_f32 v23, v23, v75
    v_add_f32 v22, v22, v76
    v_add_f32 v23, v23, v77
    v_add_f32 v22, v22, v78
    v_add_f32 v23, v23, v79
    v_add_f32 v22, v22, v80
    v_add_f32 v23, v23, v81
    v_add_f32 v22, v22, v82
    v_add_f32 v23, v23, v83
    v_add_f32 v22, v22, v84
    v_add_f32 v23, v23, v85
    v_add_f32_e64 v22, v22, v86
    v_add_f32 v23, v23, v87
    v_cvt_pk_bf16_f32 v144, v72, v73
    v_cvt_pk_bf16_f32 v145, v74, v75
    v_cvt_pk_bf16_f32 v146, v76, v77
    v_cvt_pk_bf16_f32 v147, v78, v79
    v_cvt_pk_bf16_f32 v148, v80, v81
    v_cvt_pk_bf16_f32 v149, v82, v83
    v_cvt_pk_bf16_f32 v150, v84, v85
    v_cvt_pk_bf16_f32 v151, v86, v87
    s_waitcnt lgkmcnt(2)
    v_mfma_f32_32x32x16_bf16 v[88:103], v[128:131], v[144:147], v[88:103]
    v_mfma_f32_32x32x16_bf16 v[88:103], v[132:135], v[148:151], v[88:103]
    ds_read_b128 v[120:123], v20 offset:26624
    ds_read_b128 v[124:127], v20 offset:27648
    s_cmp_eq_u32 s76, 2
    s_cbranch_scc0 ng_138
    v_mov_b32 v24, 0xf149f2ca
    v_mov_b32 v25, 0xf149f2ca
    v_mov_b32 v26, 0xf149f2ca
    v_mov_b32 v27, 0xf149f2ca
    v_mov_b32 v28, 0xf149f2ca
    v_mov_b32 v29, 0xf149f2ca
    v_mov_b32 v30, 0xf149f2ca
    v_mov_b32 v31, 0xf149f2ca
    v_mov_b32 v32, 0xf149f2ca
    v_mov_b32 v33, 0xf149f2ca
    v_mov_b32 v34, 0xf149f2ca
    v_mov_b32 v35, 0xf149f2ca
    v_mov_b32 v36, 0xf149f2ca
    v_mov_b32 v37, 0xf149f2ca
    v_mov_b32 v38, 0xf149f2ca
    v_mov_b32 v39, 0xf149f2ca
ng_138:
    s_waitcnt lgkmcnt(2)
    s_nop 0
    v_mfma_f32_32x32x16_bf16 v[72:87], v[112:115], v[4:7], v[24:39]
    v_mfma_f32_32x32x16_bf16 v[72:87], v[116:119], v[8:11], v[72:87]
    ds_read_b128 v[104:107], v20 offset:16384
    ds_read_b128 v[108:111], v20 offset:17408
    v_exp_f32 v56, v56
    v_exp_f32 v57, v57
    v_exp_f32 v58, v58
    v_exp_f32 v59, v59
    v_exp_f32 v60, v60
    v_exp_f32 v61, v61
    v_exp_f32 v62, v62
    v_exp_f32 v63, v63
    v_exp_f32 v64, v64
    v_exp_f32 v65, v65
    v_exp_f32 v66, v66
    v_exp_f32 v67, v67
    v_exp_f32 v68, v68
    v_exp_f32 v69, v69
    v_exp_f32 v70, v70
    v_exp_f32 v71, v71
    v_add_f32 v22, v22, v56
    v_add_f32 v23, v23, v57
    v_add_f32 v22, v22, v58
    v_add_f32 v23, v23, v59
    v_add_f32 v22, v22, v60
    v_add_f32 v23, v23, v61
    v_add_f32 v22, v22, v62
    v_add_f32 v23, v23, v63
    v_add_f32 v22, v22, v64
    v_add_f32 v23, v23, v65
    v_add_f32 v22, v22, v66
    v_add_f32 v23, v23, v67
    v_add_f32 v22, v22, v68
    v_add_f32 v23, v23, v69
    v_add_f32_e64 v22, v22, v70
    v_add_f32 v23, v23, v71
    v_cvt_pk_bf16_f32 v136, v56, v57
    v_cvt_pk_bf16_f32 v137, v58, v59
    v_cvt_pk_bf16_f32 v138, v60, v61
    v_cvt_pk_bf16_f32 v139, v62, v63
    v_cvt_pk_bf16_f32 v140, v64, v65
    v_cvt_pk_bf16_f32 v141, v66, v67
    v_cvt_pk_bf16_f32 v142, v68, v69
    v_cvt_pk_bf16_f32 v143, v70, v71
    s_waitcnt lgkmcnt(2)
    v_mfma_f32_32x32x16_bf16 v[88:103], v[120:123], v[136:139], v[88:103]
    v_mfma_f32_32x32x16_bf16 v[88:103], v[124:127], v[140:143], v[88:103]
    ds_read_b128 v[128:131], v20 offset:22528
    ds_read_b128 v[132:135], v20 offset:23552
    s_cmp_eq_u32 s76, 3
    s_cbranch_scc0 ng_139
    v_mov_b32 v24, 0xf149f2ca
    v_mov_b32 v25, 0xf149f2ca
    v_mov_b32 v26, 0xf149f2ca
    v_mov_b32 v27, 0xf149f2ca
    v_mov_b32 v28, 0xf149f2ca
    v_mov_b32 v29, 0xf149f2ca
    v_mov_b32 v30, 0xf149f2ca
    v_mov_b32 v31, 0xf149f2ca
    v_mov_b32 v32, 0xf149f2ca
    v_mov_b32 v33, 0xf149f2ca
    v_mov_b32 v34, 0xf149f2ca
    v_mov_b32 v35, 0xf149f2ca
    v_mov_b32 v36, 0xf149f2ca
    v_mov_b32 v37, 0xf149f2ca
    v_mov_b32 v38, 0xf149f2ca
    v_mov_b32 v39, 0xf149f2ca
ng_139:
    s_waitcnt lgkmcnt(2)
    s_nop 0
    v_mfma_f32_32x32x16_bf16 v[56:71], v[104:107], v[4:7], v[24:39]
    v_mfma_f32_32x32x16_bf16 v[56:71], v[108:111], v[8:11], v[56:71]
    ds_read_b128 v[112:115], v20 offset:12288
    ds_read_b128 v[116:119], v20 offset:13312
    v_exp_f32 v72, v72
    v_exp_f32 v73, v73
    v_exp_f32 v74, v74
    v_exp_f32 v75, v75
    v_exp_f32 v76, v76
    v_exp_f32 v77, v77
    v_exp_f32 v78, v78
    v_exp_f32 v79, v79
    v_exp_f32 v80, v80
    v_exp_f32 v81, v81
    v_exp_f32 v82, v82
    v_exp_f32 v83, v83
    v_exp_f32 v84, v84
    v_exp_f32 v85, v85
    v_exp_f32 v86, v86
    v_exp_f32 v87, v87
    v_add_f32 v22, v22, v72
    v_add_f32 v23, v23, v73
    v_add_f32 v22, v22, v74
    v_add_f32 v23, v23, v75
    v_add_f32 v22, v22, v76
    v_add_f32 v23, v23, v77
    v_add_f32 v22, v22, v78
    v_add_f32 v23, v23, v79
    v_add_f32 v22, v22, v80
    v_add_f32 v23, v23, v81
    v_add_f32 v22, v22, v82
    v_add_f32 v23, v23, v83
    v_add_f32 v22, v22, v84
    v_add_f32 v23, v23, v85
    v_add_f32_e64 v22, v22, v86
    v_add_f32 v23, v23, v87
    v_cvt_pk_bf16_f32 v144, v72, v73
    v_cvt_pk_bf16_f32 v145, v74, v75
    v_cvt_pk_bf16_f32 v146, v76, v77
    v_cvt_pk_bf16_f32 v147, v78, v79
    v_cvt_pk_bf16_f32 v148, v80, v81
    v_cvt_pk_bf16_f32 v149, v82, v83
    v_cvt_pk_bf16_f32 v150, v84, v85
    v_cvt_pk_bf16_f32 v151, v86, v87
    s_waitcnt lgkmcnt(2)
    v_mfma_f32_32x32x16_bf16 v[88:103], v[128:131], v[144:147], v[88:103]
    v_mfma_f32_32x32x16_bf16 v[88:103], v[132:135], v[148:151], v[88:103]
    ds_read_b128 v[120:123], v20 offset:18432
    ds_read_b128 v[124:127], v20 offset:19456
    s_cmp_eq_u32 s76, 4
    s_cbranch_scc0 ng_140
    v_mov_b32 v24, 0xf149f2ca
    v_mov_b32 v25, 0xf149f2ca
    v_mov_b32 v26, 0xf149f2ca
    v_mov_b32 v27, 0xf149f2ca
    v_mov_b32 v28, 0xf149f2ca
    v_mov_b32 v29, 0xf149f2ca
    v_mov_b32 v30, 0xf149f2ca
    v_mov_b32 v31, 0xf149f2ca
    v_mov_b32 v32, 0xf149f2ca
    v_mov_b32 v33, 0xf149f2ca
    v_mov_b32 v34, 0xf149f2ca
    v_mov_b32 v35, 0xf149f2ca
    v_mov_b32 v36, 0xf149f2ca
    v_mov_b32 v37, 0xf149f2ca
    v_mov_b32 v38, 0xf149f2ca
    v_mov_b32 v39, 0xf149f2ca
ng_140:
    s_waitcnt lgkmcnt(2)
    s_nop 0
    v_mfma_f32_32x32x16_bf16 v[72:87], v[112:115], v[4:7], v[24:39]
    v_mfma_f32_32x32x16_bf16 v[72:87], v[116:119], v[8:11], v[72:87]
    ds_read_b128 v[104:107], v20 offset:8192
    ds_read_b128 v[108:111], v20 offset:9216
    v_exp_f32 v56, v56
    v_exp_f32 v57, v57
    v_exp_f32 v58, v58
    v_exp_f32 v59, v59
    v_exp_f32 v60, v60
    v_exp_f32 v61, v61
    v_exp_f32 v62, v62
    v_exp_f32 v63, v63
    v_exp_f32 v64, v64
    v_exp_f32 v65, v65
    v_exp_f32 v66, v66
    v_exp_f32 v67, v67
    v_exp_f32 v68, v68
    v_exp_f32 v69, v69
    v_exp_f32 v70, v70
    v_exp_f32 v71, v71
    v_add_f32 v22, v22, v56
    v_add_f32 v23, v23, v57
    v_add_f32 v22, v22, v58
    v_add_f32 v23, v23, v59
    v_add_f32 v22, v22, v60
    v_add_f32 v23, v23, v61
    v_add_f32 v22, v22, v62
    v_add_f32 v23, v23, v63
    v_add_f32 v22, v22, v64
    v_add_f32 v23, v23, v65
    v_add_f32 v22, v22, v66
    v_add_f32 v23, v23, v67
    v_add_f32 v22, v22, v68
    v_add_f32 v23, v23, v69
    v_add_f32_e64 v22, v22, v70
    v_add_f32 v23, v23, v71
    v_cvt_pk_bf16_f32 v136, v56, v57
    v_cvt_pk_bf16_f32 v137, v58, v59
    v_cvt_pk_bf16_f32 v138, v60, v61
    v_cvt_pk_bf16_f32 v139, v62, v63
    v_cvt_pk_bf16_f32 v140, v64, v65
    v_cvt_pk_bf16_f32 v141, v66, v67
    v_cvt_pk_bf16_f32 v142, v68, v69
    v_cvt_pk_bf16_f32 v143, v70, v71
    s_waitcnt lgkmcnt(2)
    v_mfma_f32_32x32x16_bf16 v[88:103], v[120:123], v[136:139], v[88:103]
    v_mfma_f32_32x32x16_bf16 v[88:103], v[124:127], v[140:143], v[88:103]
    ds_read_b128 v[128:131], v20 offset:14336
    ds_read_b128 v[132:135], v20 offset:15360
    s_cmp_eq_u32 s76, 5
    s_cbranch_scc0 ng_141
    v_mov_b32 v24, 0xf149f2ca
    v_mov_b32 v25, 0xf149f2ca
    v_mov_b32 v26, 0xf149f2ca
    v_mov_b32 v27, 0xf149f2ca
    v_mov_b32 v28, 0xf149f2ca
    v_mov_b32 v29, 0xf149f2ca
    v_mov_b32 v30, 0xf149f2ca
    v_mov_b32 v31, 0xf149f2ca
    v_mov_b32 v32, 0xf149f2ca
    v_mov_b32 v33, 0xf149f2ca
    v_mov_b32 v34, 0xf149f2ca
    v_mov_b32 v35, 0xf149f2ca
    v_mov_b32 v36, 0xf149f2ca
    v_mov_b32 v37, 0xf149f2ca
    v_mov_b32 v38, 0xf149f2ca
    v_mov_b32 v39, 0xf149f2ca
ng_141:
    s_waitcnt lgkmcnt(2)
    s_nop 0
    v_mfma_f32_32x32x16_bf16 v[56:71], v[104:107], v[4:7], v[24:39]
    v_mfma_f32_32x32x16_bf16 v[56:71], v[108:111], v[8:11], v[56:71]
    ds_read_b128 v[112:115], v20 offset:4096
    ds_read_b128 v[116:119], v20 offset:5120
    v_exp_f32 v72, v72
    v_exp_f32 v73, v73
    v_exp_f32 v74, v74
    v_exp_f32 v75, v75
    v_exp_f32 v76, v76
    v_exp_f32 v77, v77
    v_exp_f32 v78, v78
    v_exp_f32 v79, v79
    v_exp_f32 v80, v80
    v_exp_f32 v81, v81
    v_exp_f32 v82, v82
    v_exp_f32 v83, v83
    v_exp_f32 v84, v84
    v_exp_f32 v85, v85
    v_exp_f32 v86, v86
    v_exp_f32 v87, v87
    v_add_f32 v22, v22, v72
    v_add_f32 v23, v23, v73
    v_add_f32 v22, v22, v74
    v_add_f32 v23, v23, v75
    v_add_f32 v22, v22, v76
    v_add_f32 v23, v23, v77
    v_add_f32 v22, v22, v78
    v_add_f32 v23, v23, v79
    v_add_f32 v22, v22, v80
    v_add_f32 v23, v23, v81
    v_add_f32 v22, v22, v82
    v_add_f32 v23, v23, v83
    v_add_f32 v22, v22, v84
    v_add_f32 v23, v23, v85
    v_add_f32_e64 v22, v22, v86
    v_add_f32 v23, v23, v87
    v_cvt_pk_bf16_f32 v144, v72, v73
    v_cvt_pk_bf16_f32 v145, v74, v75
    v_cvt_pk_bf16_f32 v146, v76, v77
    v_cvt_pk_bf16_f32 v147, v78, v79
    v_cvt_pk_bf16_f32 v148, v80, v81
    v_cvt_pk_bf16_f32 v149, v82, v83
    v_cvt_pk_bf16_f32 v150, v84, v85
    v_cvt_pk_bf16_f32 v151, v86, v87
    s_waitcnt lgkmcnt(2)
    v_mfma_f32_32x32x16_bf16 v[88:103], v[128:131], v[144:147], v[88:103]
    v_mfma_f32_32x32x16_bf16 v[88:103], v[132:135], v[148:151], v[88:103]
    ds_read_b128 v[120:123], v20 offset:10240
    ds_read_b128 v[124:127], v20 offset:11264
    s_cmp_eq_u32 s76, 6
    s_cbranch_scc0 ng_142
    v_mov_b32 v24, 0xf149f2ca
    v_mov_b32 v25, 0xf149f2ca
    v_mov_b32 v26, 0xf149f2ca
    v_mov_b32 v27, 0xf149f2ca
    v_mov_b32 v28, 0xf149f2ca
    v_mov_b32 v29, 0xf149f2ca
    v_mov_b32 v30, 0xf149f2ca
    v_mov_b32 v31, 0xf149f2ca
    v_mov_b32 v32, 0xf149f2ca
    v_mov_b32 v33, 0xf149f2ca
    v_mov_b32 v34, 0xf149f2ca
    v_mov_b32 v35, 0xf149f2ca
    v_mov_b32 v36, 0xf149f2ca
    v_mov_b32 v37, 0xf149f2ca
    v_mov_b32 v38, 0xf149f2ca
    v_mov_b32 v39, 0xf149f2ca
ng_142:
    s_waitcnt lgkmcnt(2)
    s_nop 0
    v_mfma_f32_32x32x16_bf16 v[72:87], v[112:115], v[4:7], v[24:39]
    v_mfma_f32_32x32x16_bf16 v[72:87], v[116:119], v[8:11], v[72:87]
    v_exp_f32 v56, v56
    v_exp_f32 v57, v57
    v_exp_f32 v58, v58
    v_exp_f32 v59, v59
    v_exp_f32 v60, v60
    v_exp_f32 v61, v61
    v_exp_f32 v62, v62
    v_exp_f32 v63, v63
    v_exp_f32 v64, v64
    v_exp_f32 v65, v65
    v_exp_f32 v66, v66
    v_exp_f32 v67, v67
    v_exp_f32 v68, v68
    v_exp_f32 v69, v69
    v_exp_f32 v70, v70
    v_exp_f32 v71, v71
    v_add_f32 v22, v22, v56
    v_add_f32 v23, v23, v57
    v_add_f32 v22, v22, v58
    v_add_f32 v23, v23, v59
    v_add_f32 v22, v22, v60
    v_add_f32 v23, v23, v61
    v_add_f32 v22, v22, v62
    v_add_f32 v23, v23, v63
    v_add_f32 v22, v22, v64
    v_add_f32 v23, v23, v65
    v_add_f32 v22, v22, v66
    v_add_f32 v23, v23, v67
    v_add_f32 v22, v22, v68
    v_add_f32 v23, v23, v69
    v_add_f32 v22, v22, v70
    v_add_f32 v23, v23, v71
    v_cvt_pk_bf16_f32 v136, v56, v57
    v_cvt_pk_bf16_f32 v137, v58, v59
    v_cvt_pk_bf16_f32 v138, v60, v61
    v_cvt_pk_bf16_f32 v139, v62, v63
    v_cvt_pk_bf16_f32 v140, v64, v65
    v_cvt_pk_bf16_f32 v141, v66, v67
    v_cvt_pk_bf16_f32 v142, v68, v69
    v_cvt_pk_bf16_f32 v143, v70, v71
    s_waitcnt lgkmcnt(0)
    v_mfma_f32_32x32x16_bf16 v[88:103], v[120:123], v[136:139], v[88:103]
    v_mfma_f32_32x32x16_bf16 v[88:103], v[124:127], v[140:143], v[88:103]
    ds_read_b128 v[128:131], v20 offset:6144
    ds_read_b128 v[132:135], v20 offset:7168
    v_exp_f32 v72, v72
    v_exp_f32 v73, v73
    v_exp_f32 v74, v74
    v_exp_f32 v75, v75
    v_exp_f32 v76, v76
    v_exp_f32 v77, v77
    v_exp_f32 v78, v78
    v_exp_f32 v79, v79
    v_exp_f32 v80, v80
    v_exp_f32 v81, v81
    v_exp_f32 v82, v82
    v_exp_f32 v83, v83
    v_exp_f32 v84, v84
    v_exp_f32 v85, v85
    v_exp_f32 v86, v86
    v_exp_f32 v87, v87
    v_add_f32 v22, v22, v72
    v_add_f32 v23, v23, v73
    v_add_f32 v22, v22, v74
    v_add_f32 v23, v23, v75
    v_add_f32 v22, v22, v76
    v_add_f32 v23, v23, v77
    v_add_f32 v22, v22, v78
    v_add_f32 v23, v23, v79
    v_add_f32 v22, v22, v80
    v_add_f32 v23, v23, v81
    v_add_f32 v22, v22, v82
    v_add_f32 v23, v23, v83
    v_add_f32 v22, v22, v84
    v_add_f32 v23, v23, v85
    v_add_f32 v22, v22, v86
    v_add_f32_e64 v23, v23, v87
    v_cvt_pk_bf16_f32 v144, v72, v73
    v_cvt_pk_bf16_f32 v145, v74, v75
    v_cvt_pk_bf16_f32 v146, v76, v77
    v_cvt_pk_bf16_f32 v147, v78, v79
    v_cvt_pk_bf16_f32 v148, v80, v81
    v_cvt_pk_bf16_f32 v149, v82, v83
    v_cvt_pk_bf16_f32 v150, v84, v85
    v_cvt_pk_bf16_f32 v151, v86, v87
    s_waitcnt lgkmcnt(0)
    v_mfma_f32_32x32x16_bf16 v[88:103], v[128:131], v[144:147], v[88:103]
    v_mfma_f32_32x32x16_bf16 v[88:103], v[132:135], v[148:151], v[88:103]
    v_add_f32 v22, v22, v23
    v_mov_b32 v152, v22
    s_nop 1
    v_permlane32_swap_b32 v22, v152
    v_add_f32 v22, v22, v152
    v_rcp_f32 v22, v22
    s_lshl_b32 s33, s25, 11
    s_add_u32 s33, s33, s36
    s_branch att_ret0
    s_nop 0
att_exact1:
    s_waitcnt lgkmcnt(0)
    v_mov_b32 v20, 0xffff
    v_mov_b32 v21, 0xffff0000
    v_cndmask_b32 v22, 0, v20, s[40:41]
    v_cndmask_b32 v23, 0, v21, s[42:43]
    v_or_b32_e64 v12, v22, v23
    v_cndmask_b32 v22, 0, v20, s[44:45]
    v_cndmask_b32 v23, 0, v21, s[46:47]
    v_or_b32_e64 v13, v22, v23
    v_cndmask_b32 v22, 0, v20, s[48:49]
    v_cndmask_b32 v23, 0, v21, s[50:51]
    v_or_b32_e64 v14, v22, v23
    v_cndmask_b32 v22, 0, v20, s[52:53]
    v_cndmask_b32 v23, 0, v21, s[54:55]
    v_or_b32_e64 v15, v22, v23
    v_cndmask_b32 v22, 0, v20, s[56:57]
    v_cndmask_b32 v23, 0, v21, s[58:59]
    v_or_b32_e64 v16, v22, v23
    v_cndmask_b32 v22, 0, v20, s[60:61]
    v_cndmask_b32 v23, 0, v21, s[62:63]
    v_or_b32_e64 v17, v22, v23
    v_cndmask_b32 v22, 0, v20, s[64:65]
    v_cndmask_b32 v23, 0, v21, s[66:67]
    v_or_b32_e64 v18, v22, v23
    v_cndmask_b32 v22, 0, v20, s[68:69]
    v_cndmask_b32 v23, 0, v21, s[70:71]
    v_or_b32_e64 v19, v22, v23
    s_and_b32 s34, s76, 3
    s_lshl_b32 s33, s34, 12
    s_add_u32 s33, s33, 114688
    v_add_u32 v20, s33, v253
    v_mov_b32 v24, 0
    v_mov_b32 v25, 0
    v_mov_b32 v26, 0
    v_mov_b32 v27, 0
    v_mov_b32 v28, 0
    v_mov_b32 v29, 0
    v_mov_b32 v30, 0
    v_mov_b32 v31, 0
    v_mov_b32 v32, 0
    v_mov_b32 v33, 0
    v_mov_b32 v34, 0
    v_mov_b32 v35, 0
    v_mov_b32 v36, 0
    v_mov_b32 v37, 0
    v_mov_b32 v38, 0
    v_mov_b32 v39, 0
    ds_read_b128 v[104:107], v20 offset:32768
    ds_read_b128 v[108:111], v20 offset:33792
    ds_read_b128 v[112:115], v20 offset:28672
    ds_read_b128 v[116:119], v20 offset:29696
    s_waitcnt lgkmcnt(2)
    v_mfma_f32_32x32x16_bf16 v[40:55], v[104:107], v[4:7], 0
    v_mfma_f32_32x32x16_bf16 v[40:55], v[108:111], v[8:11], v[40:55]
    ds_read_b128 v[104:107], v20 offset:24576
    ds_read_b128 v[108:111], v20 offset:25600
    s_cmp_eq_u32 s76, 0
    s_cbranch_scc0 ng_143
    v_mov_b32 v24, 0xf149f2ca
    v_mov_b32 v25, 0xf149f2ca
    v_mov_b32 v26, 0xf149f2ca
    v_mov_b32 v27, 0xf149f2ca
    v_mov_b32 v28, 0xf149f2ca
    v_mov_b32 v29, 0xf149f2ca
    v_mov_b32 v30, 0xf149f2ca
    v_mov_b32 v31, 0xf149f2ca
    v_mov_b32 v32, 0xf149f2ca
    v_mov_b32 v33, 0xf149f2ca
    v_mov_b32 v34, 0xf149f2ca
    v_mov_b32 v35, 0xf149f2ca
    v_mov_b32 v36, 0xf149f2ca
    v_mov_b32 v37, 0xf149f2ca
    v_mov_b32 v38, 0xf149f2ca
    v_mov_b32 v39, 0xf149f2ca
ng_143:
    s_waitcnt lgkmcnt(2)
    s_nop 0
    v_mfma_f32_32x32x16_bf16 v[72:87], v[112:115], v[4:7], v[24:39]
    v_mfma_f32_32x32x16_bf16 v[72:87], v[116:119], v[8:11], v[72:87]
    ds_read_b128 v[112:115], v20 offset:20480
    ds_read_b128 v[116:119], v20 offset:21504
    s_cmp_eq_u32 s76, 1
    s_cbranch_scc0 ng_144
    s_nop 1
    v_mov_b32 v24, 0xf149f2ca
    v_mov_b32 v25, 0xf149f2ca
    v_mov_b32 v26, 0xf149f2ca
    v_mov_b32 v27, 0xf149f2ca
    v_mov_b32 v28, 0xf149f2ca
    v_mov_b32 v29, 0xf149f2ca
    v_mov_b32 v30, 0xf149f2ca
    v_mov_b32 v31, 0xf149f2ca
    v_mov_b32 v32, 0xf149f2ca
    v_mov_b32 v33, 0xf149f2ca
    v_mov_b32 v34, 0xf149f2ca
    v_mov_b32 v35, 0xf149f2ca
    v_mov_b32 v36, 0xf149f2ca
    v_mov_b32 v37, 0xf149f2ca
    v_mov_b32 v38, 0xf149f2ca
    v_mov_b32 v39, 0xf149f2ca
ng_144:
    s_waitcnt lgkmcnt(2)
    s_nop 0
    v_mfma_f32_32x32x16_bf16 v[56:71], v[104:107], v[4:7], v[24:39]
    v_mfma_f32_32x32x16_bf16 v[56:71], v[108:111], v[8:11], v[56:71]
    s_nop 3
    v_max_f32_e64 v21, v72, v73
    v_max3_f32 v21, v21, v74, v75
    v_max3_f32 v21, v21, v76, v77
    v_max3_f32 v21, v21, v78, v79
    v_max3_f32 v21, v21, v80, v81
    v_max3_f32 v21, v21, v82, v83
    v_max3_f32 v21, v21, v84, v85
    v_max3_f32 v21, v21, v86, v87
    ds_read_b128 v[104:107], v20 offset:16384
    ds_read_b128 v[108:111], v20 offset:17408
    s_cmp_eq_u32 s76, 2
    s_cbranch_scc0 ng_145
    v_mov_b32 v24, 0xf149f2ca
    v_mov_b32 v25, 0xf149f2ca
    v_mov_b32 v26, 0xf149f2ca
    v_mov_b32 v27, 0xf149f2ca
    v_mov_b32 v28, 0xf149f2ca
    v_mov_b32 v29, 0xf149f2ca
    v_mov_b32 v30, 0xf149f2ca
    v_mov_b32 v31, 0xf149f2ca
    v_mov_b32 v32, 0xf149f2ca
    v_mov_b32 v33, 0xf149f2ca
    v_mov_b32 v34, 0xf149f2ca
    v_mov_b32 v35, 0xf149f2ca
    v_mov_b32 v36, 0xf149f2ca
    v_mov_b32 v37, 0xf149f2ca
    v_mov_b32 v38, 0xf149f2ca
    v_mov_b32 v39, 0xf149f2ca
ng_145:
    s_waitcnt lgkmcnt(2)
    s_nop 0
    v_mfma_f32_32x32x16_bf16 v[72:87], v[112:115], v[4:7], v[24:39]
    v_mfma_f32_32x32x16_bf16 v[72:87], v[116:119], v[8:11], v[72:87]
    v_max3_f32 v21, v21, v56, v57
    v_max3_f32 v21, v21, v58, v59
    v_max3_f32 v21, v21, v60, v61
    v_max3_f32 v21, v21, v62, v63
    v_max3_f32 v21, v21, v64, v65
    v_max3_f32 v21, v21, v66, v67
    v_max3_f32 v21, v21, v68, v69
    v_max3_f32 v21, v21, v70, v71
    ds_read_b128 v[112:115], v20 offset:12288
    ds_read_b128 v[116:119], v20 offset:13312
    s_cmp_eq_u32 s76, 3
    s_cbranch_scc0 ng_146
    v_mov_b32 v24, 0xf149f2ca
    v_mov_b32 v25, 0xf149f2ca
    v_mov_b32 v26, 0xf149f2ca
    v_mov_b32 v27, 0xf149f2ca
    v_mov_b32 v28, 0xf149f2ca
    v_mov_b32 v29, 0xf149f2ca
    v_mov_b32 v30, 0xf149f2ca
    v_mov_b32 v31, 0xf149f2ca
    v_mov_b32 v32, 0xf149f2ca
    v_mov_b32 v33, 0xf149f2ca
    v_mov_b32 v34, 0xf149f2ca
    v_mov_b32 v35, 0xf149f2ca
    v_mov_b32 v36, 0xf149f2ca
    v_mov_b32 v37, 0xf149f2ca
    v_mov_b32 v38, 0xf149f2ca
    v_mov_b32 v39, 0xf149f2ca
ng_146:
    s_waitcnt lgkmcnt(2)
    s_nop 0
    v_mfma_f32_32x32x16_bf16 v[56:71], v[104:107], v[4:7], v[24:39]
    v_mfma_f32_32x32x16_bf16 v[56:71], v[108:111], v[8:11], v[56:71]
    v_max3_f32 v21, v21, v72, v73
    v_max3_f32 v21, v21, v74, v75
    v_max3_f32 v21, v21, v76, v77
    v_max3_f32 v21, v21, v78, v79
    v_max3_f32 v21, v21, v80, v81
    v_max3_f32 v21, v21, v82, v83
    v_max3_f32 v21, v21, v84, v85
    v_max3_f32 v21, v21, v86, v87
    ds_read_b128 v[104:107], v20 offset:8192
    ds_read_b128 v[108:111], v20 offset:9216
    s_cmp_eq_u32 s76, 4
    s_cbranch_scc0 ng_147
    v_mov_b32 v24, 0xf149f2ca
    v_mov_b32 v25, 0xf149f2ca
    v_mov_b32 v26, 0xf149f2ca
    v_mov_b32 v27, 0xf149f2ca
    v_mov_b32 v28, 0xf149f2ca
    v_mov_b32 v29, 0xf149f2ca
    v_mov_b32 v30, 0xf149f2ca
    v_mov_b32 v31, 0xf149f2ca
    v_mov_b32 v32, 0xf149f2ca
    v_mov_b32 v33, 0xf149f2ca
    v_mov_b32 v34, 0xf149f2ca
    v_mov_b32 v35, 0xf149f2ca
    v_mov_b32 v36, 0xf149f2ca
    v_mov_b32 v37, 0xf149f2ca
    v_mov_b32 v38, 0xf149f2ca
    v_mov_b32 v39, 0xf149f2ca
ng_147:
    s_waitcnt lgkmcnt(2)
    s_nop 0
    v_mfma_f32_32x32x16_bf16 v[72:87], v[112:115], v[4:7], v[24:39]
    v_mfma_f32_32x32x16_bf16 v[72:87], v[116:119], v[8:11], v[72:87]
    v_max3_f32 v21, v21, v56, v57
    v_max3_f32 v21, v21, v58, v59
    v_max3_f32 v21, v21, v60, v61
    v_max3_f32 v21, v21, v62, v63
    v_max3_f32 v21, v21, v64, v65
    v_max3_f32 v21, v21, v66, v67
    v_max3_f32 v21, v21, v68, v69
    v_max3_f32 v21, v21, v70, v71
    ds_read_b128 v[112:115], v20 offset:4096
    ds_read_b128 v[116:119], v20 offset:5120
    s_cmp_eq_u32 s76, 5
    s_cbranch_scc0 ng_148
    v_mov_b32 v24, 0xf149f2ca
    v_mov_b32 v25, 0xf149f2ca
    v_mov_b32 v26, 0xf149f2ca
    v_mov_b32 v27, 0xf149f2ca
    v_mov_b32 v28, 0xf149f2ca
    v_mov_b32 v29, 0xf149f2ca
    v_mov_b32 v30, 0xf149f2ca
    v_mov_b32 v31, 0xf149f2ca
    v_mov_b32 v32, 0xf149f2ca
    v_mov_b32 v33, 0xf149f2ca
    v_mov_b32 v34, 0xf149f2ca
    v_mov_b32 v35, 0xf149f2ca
    v_mov_b32 v36, 0xf149f2ca
    v_mov_b32 v37, 0xf149f2ca
    v_mov_b32 v38, 0xf149f2ca
    v_mov_b32 v39, 0xf149f2ca
ng_148:
    s_waitcnt lgkmcnt(2)
    s_nop 0
    v_mfma_f32_32x32x16_bf16 v[56:71], v[104:107], v[4:7], v[24:39]
    v_mfma_f32_32x32x16_bf16 v[56:71], v[108:111], v[8:11], v[56:71]
    v_max3_f32 v21, v21, v72, v73
    v_max3_f32 v21, v21, v74, v75
    v_max3_f32 v21, v21, v76, v77
    v_max3_f32 v21, v21, v78, v79
    v_max3_f32 v21, v21, v80, v81
    v_max3_f32 v21, v21, v82, v83
    v_max3_f32 v21, v21, v84, v85
    v_max3_f32 v21, v21, v86, v87
    ds_read_b128 v[104:107], v20 offset:0
    ds_read_b128 v[108:111], v20 offset:1024
    s_cmp_eq_u32 s76, 6
    s_cbranch_scc0 ng_149
    v_mov_b32 v24, 0xf149f2ca
    v_mov_b32 v25, 0xf149f2ca
    v_mov_b32 v26, 0xf149f2ca
    v_mov_b32 v27, 0xf149f2ca
    v_mov_b32 v28, 0xf149f2ca
    v_mov_b32 v29, 0xf149f2ca
    v_mov_b32 v30, 0xf149f2ca
    v_mov_b32 v31, 0xf149f2ca
    v_mov_b32 v32, 0xf149f2ca
    v_mov_b32 v33, 0xf149f2ca
    v_mov_b32 v34, 0xf149f2ca
    v_mov_b32 v35, 0xf149f2ca
    v_mov_b32 v36, 0xf149f2ca
    v_mov_b32 v37, 0xf149f2ca
    v_mov_b32 v38, 0xf149f2ca
    v_mov_b32 v39, 0xf149f2ca
ng_149:
    s_waitcnt lgkmcnt(2)
    s_nop 0
    v_mfma_f32_32x32x16_bf16 v[72:87], v[112:115], v[4:7], v[24:39]
    v_mfma_f32_32x32x16_bf16 v[72:87], v[116:119], v[8:11], v[72:87]
    v_max3_f32 v21, v21, v56, v57
    v_max3_f32 v21, v21, v58, v59
    v_max3_f32 v21, v21, v60, v61
    v_max3_f32 v21, v21, v62, v63
    v_max3_f32 v21, v21, v64, v65
    v_max3_f32 v21, v21, v66, v67
    v_max3_f32 v21, v21, v68, v69
    v_max3_f32 v21, v21, v70, v71
    s_cmp_eq_u32 s76, 7
    s_cbranch_scc0 ng_150
    v_mov_b32 v24, 0xf149f2ca
    v_mov_b32 v25, 0xf149f2ca
    v_mov_b32 v26, 0xf149f2ca
    v_mov_b32 v27, 0xf149f2ca
    v_mov_b32 v28, 0xf149f2ca
    v_mov_b32 v29, 0xf149f2ca
    v_mov_b32 v30, 0xf149f2ca
    v_mov_b32 v31, 0xf149f2ca
    v_mov_b32 v32, 0xf149f2ca
    v_mov_b32 v33, 0xf149f2ca
    v_mov_b32 v34, 0xf149f2ca
    v_mov_b32 v35, 0xf149f2ca
    v_mov_b32 v36, 0xf149f2ca
    v_mov_b32 v37, 0xf149f2ca
    v_mov_b32 v38, 0xf149f2ca
    v_mov_b32 v39, 0xf149f2ca
ng_150:
    s_waitcnt lgkmcnt(0)
    s_nop 0
    v_mfma_f32_32x32x16_bf16 v[56:71], v[104:107], v[4:7], v[24:39]
    v_mfma_f32_32x32x16_bf16 v[56:71], v[108:111], v[8:11], v[56:71]
    v_max3_f32 v21, v21, v72, v73
    v_max3_f32 v21, v21, v74, v75
    v_max3_f32 v21, v21, v76, v77
    v_max3_f32 v21, v21, v78, v79
    v_max3_f32 v21, v21, v80, v81
    v_max3_f32 v21, v21, v82, v83
    v_max3_f32 v21, v21, v84, v85
    v_max3_f32 v21, v21, v86, v87
    ds_read_b128 v[112:115], v20 offset:28672
    ds_read_b128 v[116:119], v20 offset:29696
    ds_read_b128 v[120:123], v20 offset:34816
    ds_read_b128 v[124:127], v20 offset:35840
    ds_read_b128 v[128:131], v20 offset:2048
    ds_read_b128 v[132:135], v20 offset:3072
    v_cndmask_b32 v40, v56, v40, s[40:41]
    v_cndmask_b32 v41, v57, v41, s[42:43]
    v_cndmask_b32 v42, v58, v42, s[44:45]
    v_cndmask_b32 v43, v59, v43, s[46:47]
    v_cndmask_b32 v44, v60, v44, s[48:49]
    v_cndmask_b32 v45, v61, v45, s[50:51]
    v_cndmask_b32 v46, v62, v46, s[52:53]
    v_cndmask_b32 v47, v63, v47, s[54:55]
    v_cndmask_b32 v48, v64, v48, s[56:57]
    v_cndmask_b32 v49, v65, v49, s[58:59]
    v_cndmask_b32 v50, v66, v50, s[60:61]
    v_cndmask_b32 v51, v67, v51, s[62:63]
    v_cndmask_b32 v52, v68, v52, s[64:65]
    v_cndmask_b32 v53, v69, v53, s[66:67]
    v_cndmask_b32 v54, v70, v54, s[68:69]
    v_cndmask_b32 v55, v71, v55, s[70:71]
    v_max3_f32 v21, v21, v40, v41
    v_max3_f32 v21, v21, v42, v43
    v_max3_f32 v21, v21, v44, v45
    v_max3_f32 v21, v21, v46, v47
    v_max3_f32 v21, v21, v48, v49
    v_max3_f32 v21, v21, v50, v51
    v_max3_f32 v21, v21, v52, v53
    v_max3_f32 v21, v21, v54, v55
    v_mov_b32 v152, v21
    s_nop 1
    v_permlane32_swap_b32 v21, v152
    v_max_f32 v21, v21, v152
    v_sub_f32 v24, 0, v21
    v_sub_f32 v25, 0, v21
    v_sub_f32 v26, 0, v21
    v_sub_f32 v27, 0, v21
    v_sub_f32 v28, 0, v21
    v_sub_f32 v29, 0, v21
    v_sub_f32 v30, 0, v21
    v_sub_f32 v31, 0, v21
    v_sub_f32 v32, 0, v21
    v_sub_f32 v33, 0, v21
    v_sub_f32 v34, 0, v21
    v_sub_f32 v35, 0, v21
    v_sub_f32 v36, 0, v21
    v_sub_f32 v37, 0, v21
    v_sub_f32 v38, 0, v21
    v_sub_f32 v39, 0, v21
    s_cmp_eq_u32 s76, 0
    s_cbranch_scc0 ng_151
    v_mov_b32 v24, 0xf149f2ca
    v_mov_b32 v25, 0xf149f2ca
    v_mov_b32 v26, 0xf149f2ca
    v_mov_b32 v27, 0xf149f2ca
    v_mov_b32 v28, 0xf149f2ca
    v_mov_b32 v29, 0xf149f2ca
    v_mov_b32 v30, 0xf149f2ca
    v_mov_b32 v31, 0xf149f2ca
    v_mov_b32 v32, 0xf149f2ca
    v_mov_b32 v33, 0xf149f2ca
    v_mov_b32 v34, 0xf149f2ca
    v_mov_b32 v35, 0xf149f2ca
    v_mov_b32 v36, 0xf149f2ca
    v_mov_b32 v37, 0xf149f2ca
    v_mov_b32 v38, 0xf149f2ca
    v_mov_b32 v39, 0xf149f2ca
ng_151:
    s_waitcnt lgkmcnt(4)
    s_nop 0
    v_mfma_f32_32x32x16_bf16 v[72:87], v[112:115], v[4:7], v[24:39]
    v_mfma_f32_32x32x16_bf16 v[72:87], v[116:119], v[8:11], v[72:87]
    ds_read_b128 v[104:107], v20 offset:24576
    ds_read_b128 v[108:111], v20 offset:25600
    v_sub_f32 v40, v40, v21
    v_sub_f32 v41, v41, v21
    v_sub_f32 v42, v42, v21
    v_sub_f32 v43, v43, v21
    v_sub_f32 v44, v44, v21
    v_sub_f32 v45, v45, v21
    v_sub_f32 v46, v46, v21
    v_sub_f32 v47, v47, v21
    v_sub_f32 v48, v48, v21
    v_sub_f32 v49, v49, v21
    v_sub_f32 v50, v50, v21
    v_sub_f32 v51, v51, v21
    v_sub_f32 v52, v52, v21
    v_sub_f32 v53, v53, v21
    v_sub_f32 v54, v54, v21
    v_sub_f32 v55, v55, v21
    v_exp_f32 v40, v40
    v_exp_f32 v41, v41
    v_exp_f32 v42, v42
    v_exp_f32 v43, v43
    v_exp_f32 v44, v44
    v_exp_f32 v45, v45
    v_exp_f32 v46, v46
    v_exp_f32 v47, v47
    v_exp_f32 v48, v48
    v_exp_f32 v49, v49
    v_exp_f32 v50, v50
    v_exp_f32 v51, v51
    v_exp_f32 v52, v52
    v_exp_f32 v53, v53
    v_exp_f32 v54, v54
    v_exp_f32 v55, v55
    v_add_f32 v22, v40, v41
    v_add_f32 v23, v42, v43
    v_add_f32 v22, v22, v44
    v_add_f32 v23, v23, v45
    v_add_f32 v22, v22, v46
    v_add_f32 v23, v23, v47
    v_add_f32 v22, v22, v48
    v_add_f32 v23, v23, v49
    v_add_f32 v22, v22, v50
    v_add_f32 v23, v23, v51
    v_add_f32 v22, v22, v52
    v_add_f32 v23, v23, v53
    v_add_f32 v22, v22, v54
    v_add_f32 v23, v23, v55
    v_cvt_pk_bf16_f32 v144, v40, v41
    v_cvt_pk_bf16_f32 v145, v42, v43
    v_cvt_pk_bf16_f32 v146, v44, v45
    v_cvt_pk_bf16_f32 v147, v46, v47
    v_cvt_pk_bf16_f32 v148, v48, v49
    v_cvt_pk_bf16_f32 v149, v50, v51
    v_cvt_pk_bf16_f32 v150, v52, v53
    v_cvt_pk_bf16_f32 v151, v54, v55
    v_and_b32 v136, v144, v12
    v_and_b32 v137, v145, v13
    v_and_b32 v138, v146, v14
    v_and_b32 v139, v147, v15
    v_and_b32 v140, v148, v16
    v_and_b32 v141, v149, v17
    v_and_b32 v142, v150, v18
    v_and_b32 v143, v151, v19
    v_xor_b32 v144, v144, v136
    v_xor_b32 v145, v145, v137
    v_xor_b32 v146, v146, v138
    v_xor_b32 v147, v147, v139
    v_xor_b32 v148, v148, v140
    v_xor_b32 v149, v149, v141
    v_xor_b32_e64 v150, v150, v142
    v_xor_b32 v151, v151, v143
    s_waitcnt lgkmcnt(2)
    v_mfma_f32_32x32x16_bf16 v[88:103], v[120:123], v[136:139], 0
    v_mfma_f32_32x32x16_bf16 v[88:103], v[124:127], v[140:143], v[88:103]
    v_mfma_f32_32x32x16_bf16 v[88:103], v[128:131], v[144:147], v[88:103]
    v_mfma_f32_32x32x16_bf16 v[88:103], v[132:135], v[148:151], v[88:103]
    ds_read_b128 v[128:131], v20 offset:30720
    ds_read_b128 v[132:135], v20 offset:31744
    s_cmp_eq_u32 s76, 1
    s_cbranch_scc0 ng_152
    v_mov_b32 v24, 0xf149f2ca
    v_mov_b32 v25, 0xf149f2ca
    v_mov_b32 v26, 0xf149f2ca
    v_mov_b32 v27, 0xf149f2ca
    v_mov_b32 v28, 0xf149f2ca
    v_mov_b32 v29, 0xf149f2ca
    v_mov_b32 v30, 0xf149f2ca
    v_mov_b32 v31, 0xf149f2ca
    v_mov_b32 v32, 0xf149f2ca
    v_mov_b32 v33, 0xf149f2ca
    v_mov_b32 v34, 0xf149f2ca
    v_mov_b32 v35, 0xf149f2ca
    v_mov_b32 v36, 0xf149f2ca
    v_mov_b32 v37, 0xf149f2ca
    v_mov_b32 v38, 0xf149f2ca
    v_mov_b32 v39, 0xf149f2ca
ng_152:
    s_waitcnt lgkmcnt(2)
    s_nop 0
    v_mfma_f32_32x32x16_bf16 v[56:71], v[104:107], v[4:7], v[24:39]
    v_mfma_f32_32x32x16_bf16 v[56:71], v[108:111], v[8:11], v[56:71]
    ds_read_b128 v[112:115], v20 offset:20480
    ds_read_b128 v[116:119], v20 offset:21504
    v_exp_f32 v72, v72
    v_exp_f32 v73, v73
    v_exp_f32 v74, v74
    v_exp_f32 v75, v75
    v_exp_f32 v76, v76
    v_exp_f32 v77, v77
    v_exp_f32 v78, v78
    v_exp_f32 v79, v79
    v_exp_f32 v80, v80
    v_exp_f32 v81, v81
    v_exp_f32 v82, v82
    v_exp_f32 v83, v83
    v_exp_f32 v84, v84
    v_exp_f32 v85, v85
    v_exp_f32 v86, v86
    v_exp_f32 v87, v87
    v_add_f32 v22, v22, v72
    v_add_f32 v23, v23, v73
    v_add_f32 v22, v22, v74
    v_add_f32 v23, v23, v75
    v_add_f32 v22, v22, v76
    v_add_f32 v23, v23, v77
    v_add_f32 v22, v22, v78
    v_add_f32 v23, v23, v79
    v_add_f32 v22, v22, v80
    v_add_f32 v23, v23, v81
    v_add_f32 v22, v22, v82
    v_add_f32 v23, v23, v83
    v_add_f32 v22, v22, v84
    v_add_f32 v23, v23, v85
    v_add_f32_e64 v22, v22, v86
    v_add_f32 v23, v23, v87
    v_cvt_pk_bf16_f32 v144, v72, v73
    v_cvt_pk_bf16_f32 v145, v74, v75
    v_cvt_pk_bf16_f32 v146, v76, v77
    v_cvt_pk_bf16_f32 v147, v78, v79
    v_cvt_pk_bf16_f32 v148, v80, v81
    v_cvt_pk_bf16_f32 v149, v82, v83
    v_cvt_pk_bf16_f32 v150, v84, v85
    v_cvt_pk_bf16_f32 v151, v86, v87
    s_waitcnt lgkmcnt(2)
    v_mfma_f32_32x32x16_bf16 v[88:103], v[128:131], v[144:147], v[88:103]
    v_mfma_f32_32x32x16_bf16 v[88:103], v[132:135], v[148:151], v[88:103]
    ds_read_b128 v[120:123], v20 offset:26624
    ds_read_b128 v[124:127], v20 offset:27648
    s_cmp_eq_u32 s76, 2
    s_cbranch_scc0 ng_153
    v_mov_b32 v24, 0xf149f2ca
    v_mov_b32 v25, 0xf149f2ca
    v_mov_b32 v26, 0xf149f2ca
    v_mov_b32 v27, 0xf149f2ca
    v_mov_b32 v28, 0xf149f2ca
    v_mov_b32 v29, 0xf149f2ca
    v_mov_b32 v30, 0xf149f2ca
    v_mov_b32 v31, 0xf149f2ca
    v_mov_b32 v32, 0xf149f2ca
    v_mov_b32 v33, 0xf149f2ca
    v_mov_b32 v34, 0xf149f2ca
    v_mov_b32 v35, 0xf149f2ca
    v_mov_b32 v36, 0xf149f2ca
    v_mov_b32 v37, 0xf149f2ca
    v_mov_b32 v38, 0xf149f2ca
    v_mov_b32 v39, 0xf149f2ca
ng_153:
    s_waitcnt lgkmcnt(2)
    s_nop 0
    v_mfma_f32_32x32x16_bf16 v[72:87], v[112:115], v[4:7], v[24:39]
    v_mfma_f32_32x32x16_bf16 v[72:87], v[116:119], v[8:11], v[72:87]
    ds_read_b128 v[104:107], v20 offset:16384
    ds_read_b128 v[108:111], v20 offset:17408
    v_exp_f32 v56, v56
    v_exp_f32 v57, v57
    v_exp_f32 v58, v58
    v_exp_f32 v59, v59
    v_exp_f32 v60, v60
    v_exp_f32 v61, v61
    v_exp_f32 v62, v62
    v_exp_f32 v63, v63
    v_exp_f32 v64, v64
    v_exp_f32 v65, v65
    v_exp_f32 v66, v66
    v_exp_f32 v67, v67
    v_exp_f32 v68, v68
    v_exp_f32 v69, v69
    v_exp_f32 v70, v70
    v_exp_f32 v71, v71
    v_add_f32 v22, v22, v56
    v_add_f32 v23, v23, v57
    v_add_f32 v22, v22, v58
    v_add_f32 v23, v23, v59
    v_add_f32 v22, v22, v60
    v_add_f32 v23, v23, v61
    v_add_f32 v22, v22, v62
    v_add_f32 v23, v23, v63
    v_add_f32 v22, v22, v64
    v_add_f32 v23, v23, v65
    v_add_f32 v22, v22, v66
    v_add_f32 v23, v23, v67
    v_add_f32 v22, v22, v68
    v_add_f32 v23, v23, v69
    v_add_f32_e64 v22, v22, v70
    v_add_f32 v23, v23, v71
    v_cvt_pk_bf16_f32 v136, v56, v57
    v_cvt_pk_bf16_f32 v137, v58, v59
    v_cvt_pk_bf16_f32 v138, v60, v61
    v_cvt_pk_bf16_f32 v139, v62, v63
    v_cvt_pk_bf16_f32 v140, v64, v65
    v_cvt_pk_bf16_f32 v141, v66, v67
    v_cvt_pk_bf16_f32 v142, v68, v69
    v_cvt_pk_bf16_f32 v143, v70, v71
    s_waitcnt lgkmcnt(2)
    v_mfma_f32_32x32x16_bf16 v[88:103], v[120:123], v[136:139], v[88:103]
    v_mfma_f32_32x32x16_bf16 v[88:103], v[124:127], v[140:143], v[88:103]
    ds_read_b128 v[128:131], v20 offset:22528
    ds_read_b128 v[132:135], v20 offset:23552
    s_cmp_eq_u32 s76, 3
    s_cbranch_scc0 ng_154
    v_mov_b32 v24, 0xf149f2ca
    v_mov_b32 v25, 0xf149f2ca
    v_mov_b32 v26, 0xf149f2ca
    v_mov_b32 v27, 0xf149f2ca
    v_mov_b32 v28, 0xf149f2ca
    v_mov_b32 v29, 0xf149f2ca
    v_mov_b32 v30, 0xf149f2ca
    v_mov_b32 v31, 0xf149f2ca
    v_mov_b32 v32, 0xf149f2ca
    v_mov_b32 v33, 0xf149f2ca
    v_mov_b32 v34, 0xf149f2ca
    v_mov_b32 v35, 0xf149f2ca
    v_mov_b32 v36, 0xf149f2ca
    v_mov_b32 v37, 0xf149f2ca
    v_mov_b32 v38, 0xf149f2ca
    v_mov_b32 v39, 0xf149f2ca
ng_154:
    s_waitcnt lgkmcnt(2)
    s_nop 0
    v_mfma_f32_32x32x16_bf16 v[56:71], v[104:107], v[4:7], v[24:39]
    v_mfma_f32_32x32x16_bf16 v[56:71], v[108:111], v[8:11], v[56:71]
    ds_read_b128 v[112:115], v20 offset:12288
    ds_read_b128 v[116:119], v20 offset:13312
    v_exp_f32 v72, v72
    v_exp_f32 v73, v73
    v_exp_f32 v74, v74
    v_exp_f32 v75, v75
    v_exp_f32 v76, v76
    v_exp_f32 v77, v77
    v_exp_f32 v78, v78
    v_exp_f32 v79, v79
    v_exp_f32 v80, v80
    v_exp_f32 v81, v81
    v_exp_f32 v82, v82
    v_exp_f32 v83, v83
    v_exp_f32 v84, v84
    v_exp_f32 v85, v85
    v_exp_f32 v86, v86
    v_exp_f32 v87, v87
    v_add_f32 v22, v22, v72
    v_add_f32 v23, v23, v73
    v_add_f32 v22, v22, v74
    v_add_f32 v23, v23, v75
    v_add_f32 v22, v22, v76
    v_add_f32 v23, v23, v77
    v_add_f32 v22, v22, v78
    v_add_f32 v23, v23, v79
    v_add_f32 v22, v22, v80
    v_add_f32 v23, v23, v81
    v_add_f32 v22, v22, v82
    v_add_f32 v23, v23, v83
    v_add_f32 v22, v22, v84
    v_add_f32 v23, v23, v85
    v_add_f32_e64 v22, v22, v86
    v_add_f32 v23, v23, v87
    v_cvt_pk_bf16_f32 v144, v72, v73
    v_cvt_pk_bf16_f32 v145, v74, v75
    v_cvt_pk_bf16_f32 v146, v76, v77
    v_cvt_pk_bf16_f32 v147, v78, v79
    v_cvt_pk_bf16_f32 v148, v80, v81
    v_cvt_pk_bf16_f32 v149, v82, v83
    v_cvt_pk_bf16_f32 v150, v84, v85
    v_cvt_pk_bf16_f32 v151, v86, v87
    s_waitcnt lgkmcnt(2)
    v_mfma_f32_32x32x16_bf16 v[88:103], v[128:131], v[144:147], v[88:103]
    v_mfma_f32_32x32x16_bf16 v[88:103], v[132:135], v[148:151], v[88:103]
    ds_read_b128 v[120:123], v20 offset:18432
    ds_read_b128 v[124:127], v20 offset:19456
    s_cmp_eq_u32 s76, 4
    s_cbranch_scc0 ng_155
    v_mov_b32 v24, 0xf149f2ca
    v_mov_b32 v25, 0xf149f2ca
    v_mov_b32 v26, 0xf149f2ca
    v_mov_b32 v27, 0xf149f2ca
    v_mov_b32 v28, 0xf149f2ca
    v_mov_b32 v29, 0xf149f2ca
    v_mov_b32 v30, 0xf149f2ca
    v_mov_b32 v31, 0xf149f2ca
    v_mov_b32 v32, 0xf149f2ca
    v_mov_b32 v33, 0xf149f2ca
    v_mov_b32 v34, 0xf149f2ca
    v_mov_b32 v35, 0xf149f2ca
    v_mov_b32 v36, 0xf149f2ca
    v_mov_b32 v37, 0xf149f2ca
    v_mov_b32 v38, 0xf149f2ca
    v_mov_b32 v39, 0xf149f2ca
ng_155:
    s_waitcnt lgkmcnt(2)
    s_nop 0
    v_mfma_f32_32x32x16_bf16 v[72:87], v[112:115], v[4:7], v[24:39]
    v_mfma_f32_32x32x16_bf16 v[72:87], v[116:119], v[8:11], v[72:87]
    ds_read_b128 v[104:107], v20 offset:8192
    ds_read_b128 v[108:111], v20 offset:9216
    v_exp_f32 v56, v56
    v_exp_f32 v57, v57
    v_exp_f32 v58, v58
    v_exp_f32 v59, v59
    v_exp_f32 v60, v60
    v_exp_f32 v61, v61
    v_exp_f32 v62, v62
    v_exp_f32 v63, v63
    v_exp_f32 v64, v64
    v_exp_f32 v65, v65
    v_exp_f32 v66, v66
    v_exp_f32 v67, v67
    v_exp_f32 v68, v68
    v_exp_f32 v69, v69
    v_exp_f32 v70, v70
    v_exp_f32 v71, v71
    v_add_f32 v22, v22, v56
    v_add_f32 v23, v23, v57
    v_add_f32 v22, v22, v58
    v_add_f32 v23, v23, v59
    v_add_f32 v22, v22, v60
    v_add_f32 v23, v23, v61
    v_add_f32 v22, v22, v62
    v_add_f32 v23, v23, v63
    v_add_f32 v22, v22, v64
    v_add_f32 v23, v23, v65
    v_add_f32 v22, v22, v66
    v_add_f32 v23, v23, v67
    v_add_f32 v22, v22, v68
    v_add_f32 v23, v23, v69
    v_add_f32_e64 v22, v22, v70
    v_add_f32 v23, v23, v71
    v_cvt_pk_bf16_f32 v136, v56, v57
    v_cvt_pk_bf16_f32 v137, v58, v59
    v_cvt_pk_bf16_f32 v138, v60, v61
    v_cvt_pk_bf16_f32 v139, v62, v63
    v_cvt_pk_bf16_f32 v140, v64, v65
    v_cvt_pk_bf16_f32 v141, v66, v67
    v_cvt_pk_bf16_f32 v142, v68, v69
    v_cvt_pk_bf16_f32 v143, v70, v71
    s_waitcnt lgkmcnt(2)
    v_mfma_f32_32x32x16_bf16 v[88:103], v[120:123], v[136:139], v[88:103]
    v_mfma_f32_32x32x16_bf16 v[88:103], v[124:127], v[140:143], v[88:103]
    ds_read_b128 v[128:131], v20 offset:14336
    ds_read_b128 v[132:135], v20 offset:15360
    s_cmp_eq_u32 s76, 5
    s_cbranch_scc0 ng_156
    v_mov_b32 v24, 0xf149f2ca
    v_mov_b32 v25, 0xf149f2ca
    v_mov_b32 v26, 0xf149f2ca
    v_mov_b32 v27, 0xf149f2ca
    v_mov_b32 v28, 0xf149f2ca
    v_mov_b32 v29, 0xf149f2ca
    v_mov_b32 v30, 0xf149f2ca
    v_mov_b32 v31, 0xf149f2ca
    v_mov_b32 v32, 0xf149f2ca
    v_mov_b32 v33, 0xf149f2ca
    v_mov_b32 v34, 0xf149f2ca
    v_mov_b32 v35, 0xf149f2ca
    v_mov_b32 v36, 0xf149f2ca
    v_mov_b32 v37, 0xf149f2ca
    v_mov_b32 v38, 0xf149f2ca
    v_mov_b32 v39, 0xf149f2ca
ng_156:
    s_waitcnt lgkmcnt(2)
    s_nop 0
    v_mfma_f32_32x32x16_bf16 v[56:71], v[104:107], v[4:7], v[24:39]
    v_mfma_f32_32x32x16_bf16 v[56:71], v[108:111], v[8:11], v[56:71]
    ds_read_b128 v[112:115], v20 offset:4096
    ds_read_b128 v[116:119], v20 offset:5120
    v_exp_f32 v72, v72
    v_exp_f32 v73, v73
    v_exp_f32 v74, v74
    v_exp_f32 v75, v75
    v_exp_f32 v76, v76
    v_exp_f32 v77, v77
    v_exp_f32 v78, v78
    v_exp_f32 v79, v79
    v_exp_f32 v80, v80
    v_exp_f32 v81, v81
    v_exp_f32 v82, v82
    v_exp_f32 v83, v83
    v_exp_f32 v84, v84
    v_exp_f32 v85, v85
    v_exp_f32 v86, v86
    v_exp_f32 v87, v87
    v_add_f32 v22, v22, v72
    v_add_f32 v23, v23, v73
    v_add_f32 v22, v22, v74
    v_add_f32 v23, v23, v75
    v_add_f32 v22, v22, v76
    v_add_f32 v23, v23, v77
    v_add_f32 v22, v22, v78
    v_add_f32 v23, v23, v79
    v_add_f32 v22, v22, v80
    v_add_f32 v23, v23, v81
    v_add_f32 v22, v22, v82
    v_add_f32 v23, v23, v83
    v_add_f32 v22, v22, v84
    v_add_f32 v23, v23, v85
    v_add_f32_e64 v22, v22, v86
    v_add_f32 v23, v23, v87
    v_cvt_pk_bf16_f32 v144, v72, v73
    v_cvt_pk_bf16_f32 v145, v74, v75
    v_cvt_pk_bf16_f32 v146, v76, v77
    v_cvt_pk_bf16_f32 v147, v78, v79
    v_cvt_pk_bf16_f32 v148, v80, v81
    v_cvt_pk_bf16_f32 v149, v82, v83
    v_cvt_pk_bf16_f32 v150, v84, v85
    v_cvt_pk_bf16_f32 v151, v86, v87
    s_waitcnt lgkmcnt(2)
    v_mfma_f32_32x32x16_bf16 v[88:103], v[128:131], v[144:147], v[88:103]
    v_mfma_f32_32x32x16_bf16 v[88:103], v[132:135], v[148:151], v[88:103]
    ds_read_b128 v[120:123], v20 offset:10240
    ds_read_b128 v[124:127], v20 offset:11264
    s_cmp_eq_u32 s76, 6
    s_cbranch_scc0 ng_157
    v_mov_b32 v24, 0xf149f2ca
    v_mov_b32 v25, 0xf149f2ca
    v_mov_b32 v26, 0xf149f2ca
    v_mov_b32 v27, 0xf149f2ca
    v_mov_b32 v28, 0xf149f2ca
    v_mov_b32 v29, 0xf149f2ca
    v_mov_b32 v30, 0xf149f2ca
    v_mov_b32 v31, 0xf149f2ca
    v_mov_b32 v32, 0xf149f2ca
    v_mov_b32 v33, 0xf149f2ca
    v_mov_b32 v34, 0xf149f2ca
    v_mov_b32 v35, 0xf149f2ca
    v_mov_b32 v36, 0xf149f2ca
    v_mov_b32 v37, 0xf149f2ca
    v_mov_b32 v38, 0xf149f2ca
    v_mov_b32 v39, 0xf149f2ca
ng_157:
    s_waitcnt lgkmcnt(2)
    s_nop 0
    v_mfma_f32_32x32x16_bf16 v[72:87], v[112:115], v[4:7], v[24:39]
    v_mfma_f32_32x32x16_bf16 v[72:87], v[116:119], v[8:11], v[72:87]
    v_exp_f32 v56, v56
    v_exp_f32 v57, v57
    v_exp_f32 v58, v58
    v_exp_f32 v59, v59
    v_exp_f32 v60, v60
    v_exp_f32 v61, v61
    v_exp_f32 v62, v62
    v_exp_f32 v63, v63
    v_exp_f32 v64, v64
    v_exp_f32 v65, v65
    v_exp_f32 v66, v66
    v_exp_f32 v67, v67
    v_exp_f32 v68, v68
    v_exp_f32 v69, v69
    v_exp_f32 v70, v70
    v_exp_f32 v71, v71
    v_add_f32 v22, v22, v56
    v_add_f32 v23, v23, v57
    v_add_f32 v22, v22, v58
    v_add_f32 v23, v23, v59
    v_add_f32 v22, v22, v60
    v_add_f32 v23, v23, v61
    v_add_f32 v22, v22, v62
    v_add_f32 v23, v23, v63
    v_add_f32 v22, v22, v64
    v_add_f32 v23, v23, v65
    v_add_f32 v22, v22, v66
    v_add_f32 v23, v23, v67
    v_add_f32 v22, v22, v68
    v_add_f32 v23, v23, v69
    v_add_f32 v22, v22, v70
    v_add_f32 v23, v23, v71
    v_cvt_pk_bf16_f32 v136, v56, v57
    v_cvt_pk_bf16_f32 v137, v58, v59
    v_cvt_pk_bf16_f32 v138, v60, v61
    v_cvt_pk_bf16_f32 v139, v62, v63
    v_cvt_pk_bf16_f32 v140, v64, v65
    v_cvt_pk_bf16_f32 v141, v66, v67
    v_cvt_pk_bf16_f32 v142, v68, v69
    v_cvt_pk_bf16_f32 v143, v70, v71
    s_waitcnt lgkmcnt(0)
    v_mfma_f32_32x32x16_bf16 v[88:103], v[120:123], v[136:139], v[88:103]
    v_mfma_f32_32x32x16_bf16 v[88:103], v[124:127], v[140:143], v[88:103]
    ds_read_b128 v[128:131], v20 offset:6144
    ds_read_b128 v[132:135], v20 offset:7168
    v_exp_f32 v72, v72
    v_exp_f32 v73, v73
    v_exp_f32 v74, v74
    v_exp_f32 v75, v75
    v_exp_f32 v76, v76
    v_exp_f32 v77, v77
    v_exp_f32 v78, v78
    v_exp_f32 v79, v79
    v_exp_f32 v80, v80
    v_exp_f32 v81, v81
    v_exp_f32 v82, v82
    v_exp_f32 v83, v83
    v_exp_f32 v84, v84
    v_exp_f32 v85, v85
    v_exp_f32 v86, v86
    v_exp_f32 v87, v87
    v_add_f32 v22, v22, v72
    v_add_f32 v23, v23, v73
    v_add_f32 v22, v22, v74
    v_add_f32 v23, v23, v75
    v_add_f32 v22, v22, v76
    v_add_f32 v23, v23, v77
    v_add_f32 v22, v22, v78
    v_add_f32 v23, v23, v79
    v_add_f32 v22, v22, v80
    v_add_f32 v23, v23, v81
    v_add_f32 v22, v22, v82
    v_add_f32 v23, v23, v83
    v_add_f32 v22, v22, v84
    v_add_f32 v23, v23, v85
    v_add_f32 v22, v22, v86
    v_add_f32_e64 v23, v23, v87
    v_cvt_pk_bf16_f32 v144, v72, v73
    v_cvt_pk_bf16_f32 v145, v74, v75
    v_cvt_pk_bf16_f32 v146, v76, v77
    v_cvt_pk_bf16_f32 v147, v78, v79
    v_cvt_pk_bf16_f32 v148, v80, v81
    v_cvt_pk_bf16_f32 v149, v82, v83
    v_cvt_pk_bf16_f32 v150, v84, v85
    v_cvt_pk_bf16_f32 v151, v86, v87
    s_waitcnt lgkmcnt(0)
    v_mfma_f32_32x32x16_bf16 v[88:103], v[128:131], v[144:147], v[88:103]
    v_mfma_f32_32x32x16_bf16 v[88:103], v[132:135], v[148:151], v[88:103]
    v_add_f32 v22, v22, v23
    v_mov_b32 v152, v22
    s_nop 1
    v_permlane32_swap_b32 v22, v152
    v_add_f32 v22, v22, v152
    v_rcp_f32 v22, v22
    s_lshl_b32 s33, s25, 11
    s_add_u32 s33, s33, s36
    s_branch att_ret1
.section .rodata,"a"
.p2align 6
.amdhsa_kernel interleave_layers__sliding_block__moe_arch_mod__prompt_kernel
  .amdhsa_next_free_vgpr 256
  .amdhsa_next_free_sgpr 102
  .amdhsa_accum_offset 256
  .amdhsa_group_segment_fixed_size 0
  .amdhsa_kernarg_size 88
  .amdhsa_user_sgpr_count 2
  .amdhsa_user_sgpr_kernarg_segment_ptr 1
  .amdhsa_system_sgpr_workgroup_id_x 1
.end_amdhsa_kernel
```
